```python
import torch

def _softmax(x, axis=-1):
    return torch.softmax(x, dim=axis)
def _gelu(x):
    return torch.nn.functional.gelu(x, approximate="tanh")
def _silu(x):
    return torch.nn.functional.silu(x)
def _sigmoid(x):
    return torch.sigmoid(x)
def _layernorm(x, axis=-1, eps=1e-5):
    m = x.mean(dim=axis, keepdim=True)
    v = x.var(dim=axis, keepdim=True, unbiased=False)
    return (x - m) / torch.sqrt(v + eps)
def _scatter_add(tgt, idx, src, axis=0):
    return tgt.clone().index_add_(axis, idx, src)
def _segment_sum(src, seg, n):
    out = torch.zeros((n,) + src.shape[1:], dtype=src.dtype)
    return out.index_add_(0, seg, src)
def _pad(x, pw):
    flat = tuple(v for pair in reversed(pw) for v in pair)
    return torch.nn.functional.pad(x, flat)

kernel_name = 'recurrent_scan__sliding_local_dilated__glu_gated_geglu__prompt'

def setup_inputs():

    _w = (lambda a: (lambda t: t.to(torch.bfloat16) if t.is_floating_point() else t)(torch.as_tensor(a)))
    def _A_setup():
        B, S, D = 1, 2048, 1024
        return {
            "x": _w((lambda *s: torch.randn(*s, dtype=torch.bfloat16) * 0.05)(B, S, D)),
            "wqkv": _w((lambda *s: torch.randn(*s, dtype=torch.bfloat16) * 0.2)(D, 3 * D)),
            "wo": _w((lambda *s: torch.randn(*s, dtype=torch.bfloat16) * 0.2)(D, D)),
        }
    _A_in = _A_setup()

    def _B_setup():
        B, S, Dm, Df = 1, 2048, 1024, 3584
        return {
            "x": _w((lambda *s: torch.randn(*s, dtype=torch.bfloat16) * 0.05)(B, S, Dm)),
            "w_gate": _w((lambda *s: torch.randn(*s, dtype=torch.bfloat16) * 0.1)(Dm, Df) * (Dm ** -0.5)),
            "w_up": _w((lambda *s: torch.randn(*s, dtype=torch.bfloat16) * 0.1)(Dm, Df) * (Dm ** -0.5)),
            "w_down": _w((lambda *s: torch.randn(*s, dtype=torch.bfloat16) * 0.1)(Df, Dm) * (Df ** -0.5)),
        }
    _B_in = _B_setup()

    return {
        "A_x": _A_in["x"],
        "A_wqkv": _A_in["wqkv"],
        "A_wo": _A_in["wo"],
        "B_x": _B_in["x"],
        "B_w_gate": _B_in["w_gate"],
        "B_w_up": _B_in["w_up"],
        "B_w_down": _B_in["w_down"],
    }

def reference(A_x, A_wqkv, A_wo, B_x, B_w_gate, B_w_up, B_w_down):
    def _A_ref(x, wqkv, wo):
        B, S, D = x.shape
        H = 32; Dh = D // H
        W, dil = 8, 2
        qkv = (lambda x, *d: x.permute(*d))((x @ wqkv).reshape(B, S, 3, H, Dh), 2, 0, 3, 1, 4)
        q, k, v = qkv[0], qkv[1], qkv[2]
        scale = Dh ** -0.5
        pos = torch.arange(S)
        off = torch.arange(W) * dil
        idx = pos[:, None] - off[None, :]
        mask = idx >= 0
        idx_c = torch.where(mask, idx, 0).reshape(-1)
        kg = k[:, :, idx_c, :].reshape(B, H, S, W, Dh)
        vg = v[:, :, idx_c, :].reshape(B, H, S, W, Dh)
        logits = torch.einsum("bhsd,bhswd->bhsw", q, kg) * scale
        logits = torch.where(mask[None, None, :, :], logits, -1e9)
        attn = _softmax(logits, axis=-1)
        o = torch.einsum("bhsw,bhswd->bhsd", attn, vg)
        return (lambda x, *d: x.permute(*d))(o, 0, 2, 1, 3).reshape(B, S, D) @ wo

    def _B_ref(x, w_gate, w_up, w_down):
        g = torch.einsum("bsd,df->bsf", x, w_gate)
        u = torch.einsum("bsd,df->bsf", x, w_up)
        h = _gelu(g) * u
        return torch.einsum("bsf,fd->bsd", h, w_down)

    x = A_x
    xn = _layernorm(x, axis=-1)
    s = _A_ref(xn, A_wqkv, A_wo)
    g = _silu(_B_ref(xn, B_w_gate, B_w_up, B_w_down))
    return x + s * g
```

```asm
; @launch grid=(256,1,1) block=(512,1,1) lds=163840
.amdgcn_target "amdgcn-amd-amdhsa--gfx950"
.text
.globl recurrent_scan__sliding_local_dilated__glu_gated_geglu__prompt_kernel
.p2align 8
.type recurrent_scan__sliding_local_dilated__glu_gated_geglu__prompt_kernel,@function
recurrent_scan__sliding_local_dilated__glu_gated_geglu__prompt_kernel:
    s_cmp_ge_u32 s2, 256
    s_cbranch_scc1 L_end
    s_load_dwordx4 s[8:11], s[0:1], 0
    s_load_dwordx2 s[12:13], s[0:1], 16
    s_load_dwordx4 s[16:19], s[0:1], 32
    s_load_dwordx4 s[20:23], s[0:1], 48
    s_load_dwordx4 s[24:27], s[0:1], 64
    v_lshrrev_b32 v3, 6, v0
    v_and_b32 v1, 63, v0
    v_readfirstlane_b32 s3, v3
    s_and_b32 s84, s2, 7
    s_lshr_b32 s85, s2, 3
    s_mov_b32 s15, s85
    s_and_b32 s32, s84, 1
    s_lshl_b32 s86, s32, 3
    s_and_b32 s87, s85, 7
    s_add_u32 s28, s86, s87
    s_lshr_b32 s86, s84, 1
    s_lshl_b32 s86, s86, 2
    s_lshr_b32 s87, s85, 3
    s_add_u32 s29, s86, s87
    s_and_b32 s87, s85, 3
    s_add_u32 s30, s86, s87
    s_lshr_b32 s31, s85, 2
    s_and_b32 s4, s3, 3
    s_lshr_b32 s5, s4, 1
    s_and_b32 s6, s4, 1
    s_lshr_b32 s7, s3, 2
    s_lshl_b32 s33, s4, 10
    s_mov_b32 s35, 131072
    s_waitcnt lgkmcnt(0)
    s_mov_b32 s68, s26
    s_mov_b32 s69, s27
    s_mov_b32 s70, 0x10000000
    s_mov_b32 s71, 0x20000
    s_cmp_lg_u32 s7, 0
    s_cbranch_scc1 L_teamB
    s_setprio 1
    v_lshrrev_b32 v64, 4, v1
    v_bfe_u32 v65, v1, 2, 2
    v_and_b32 v66, 3, v1
    v_and_b32 v67, 15, v1
    v_lshrrev_b32 v68, 3, v1
    v_and_b32 v69, 7, v1
    s_lshl_b32 s85, s6, 12
    s_add_u32 s85, s85, 16384
    v_lshl_add_u32 v70, v64, 3, v65
    v_lshlrev_b32 v70, 7, v70
    v_and_b32 v71, 1, v66
    v_lshl_add_u32 v70, v71, 3, v70
    v_add_u32 v70, s85, v70
    v_and_b32 v71, 2, v65
    v_and_b32 v72, 1, v64
    v_lshl_add_u32 v71, v72, 2, v71
    v_lshrrev_b32 v72, 1, v66
    v_xor_b32 v71, v71, v72
    v_xor_b32 v72, 0, v71
    v_lshl_add_u32 v4, v72, 4, v70
    v_add_u32 v9, 40960, v4
    v_xor_b32 v72, 2, v71
    v_lshl_add_u32 v5, v72, 4, v70
    v_add_u32 v10, 40960, v5
    v_xor_b32 v72, 4, v71
    v_lshl_add_u32 v6, v72, 4, v70
    v_add_u32 v11, 40960, v6
    v_xor_b32 v72, 6, v71
    v_lshl_add_u32 v7, v72, 4, v70
    v_add_u32 v12, 40960, v7
    v_lshl_add_u32 v70, v64, 3, v65
    v_lshlrev_b32 v70, 6, v70
    v_and_b32 v71, 1, v66
    v_lshl_add_u32 v70, v71, 3, v70
    v_and_b32 v71, 1, v64
    v_xor_b32 v71, s6, v71
    v_lshl_add_u32 v70, v71, 5, v70
    v_lshrrev_b32 v71, 1, v66
    v_lshl_add_u32 v70, v71, 4, v70
    v_add_u32 v8, 16384, v70
    v_add_u32 v13, 57344, v70
    v_lshrrev_b32 v70, 1, v67
    v_xor_b32 v70, v70, v64
    v_lshlrev_b32 v70, 4, v70
    v_lshl_add_u32 v70, v67, 7, v70
    s_lshl_b32 s85, s5, 13
    v_add_u32 v16, s85, v70
    v_xor_b32 v17, 64, v16
    s_lshl_b32 s85, s28, 7
    s_lshl_b32 s86, s4, 5
    s_add_u32 s86, s85, s86
    v_add_u32 v71, s86, v68
    v_xor_b32 v70, v69, v64
    v_lshlrev_b32 v70, 4, v70
    v_lshl_add_u32 v20, v71, 11, v70
    v_xor_b32 v21, 64, v20
    v_add_u32 v21, 16384, v21
    s_lshl_b32 s85, s4, 3
    s_and_b32 s86, s4, 1
    s_lshl_b32 s86, s86, 2
    v_and_b32 v70, 2, v68
    v_xor_b32 v70, v70, v69
    v_xor_b32 v70, s86, v70
    v_add_u32 v71, s85, v68
    v_mul_u32_u24 v71, 7168, v71
    v_lshl_add_u32 v22, v70, 4, v71
    v_lshrrev_b32 v71, 2, v1
    s_lshl_b32 s86, s86, 2
    v_add_u32 v71, s86, v71
    v_mul_u32_u24 v71, 7168, v71
    v_and_b32 v70, 2, v64
    v_xor_b32 v70, v70, v66
    v_lshl_add_u32 v23, v70, 4, v71
    s_mov_b32 s36, s8
    s_mov_b32 s37, s9
    s_mov_b32 s38, 0x400000
    s_mov_b32 s39, 0x20000
    s_mul_i32 s85, s29, 320
    s_and_b32 s86, s29, 1
    s_lshl_b32 s87, s86, 6
    s_add_u32 s87, s87, s85
    s_add_u32 s40, s16, s87
    s_addc_u32 s41, s17, 0
    s_sub_u32 s42, 7340032, s87
    s_mov_b32 s43, 0x20000
    s_add_u32 s44, s18, s87
    s_addc_u32 s45, s19, 0
    s_sub_u32 s46, 7340032, s87
    s_mov_b32 s47, 0x20000
    s_xor_b32 s86, s86, 1
    s_lshl_b32 s86, s86, 8
    s_add_u32 s87, s86, s85
    s_cmp_lt_u32 s4, 2
    s_cselect_b32 s88, s16, s18
    s_cselect_b32 s89, s17, s19
    s_add_u32 s48, s88, s87
    s_addc_u32 s49, s89, 0
    s_sub_u32 s50, 7340032, s87
    s_mov_b32 s51, 0x20000
    s_mov_b32 s76, 0
    s_mov_b32 s77, 0
    s_mov_b32 s78, 0
    s_lshl_b32 s79, s4, 12
    s_add_u32 s79, s79, 116736
    s_mov_b32 s80, 116736
    s_add_u32 m0, s79, 0
    s_nop 0
    buffer_load_dwordx4 v20, s[36:39], s78 offen lds
    s_add_u32 m0, s79, 1024
    s_nop 0
    buffer_load_dwordx4 v21, s[36:39], s78 offen lds
    s_add_u32 s78, s78, 32768
    s_add_u32 m0, s79, 2048
    s_nop 0
    buffer_load_dwordx4 v20, s[36:39], s78 offen lds
    s_add_u32 m0, s79, 3072
    s_nop 0
    buffer_load_dwordx4 v21, s[36:39], s78 offen lds
    s_sub_u32 s78, s78, 32768
    s_add_u32 s78, s78, 128
    s_add_u32 s79, s79, 18432
    s_cmp_ge_u32 s79, 153600
    s_cselect_b32 s84, 55296, 0
    s_sub_u32 s79, s79, s84
    s_add_u32 m0, s33, 16384
    s_nop 0
    buffer_load_dwordx4 v22, s[40:43], s77 offen offset:0 lds
    s_add_u32 m0, s33, 20352
    s_nop 0
    buffer_load_dwordx4 v22, s[40:43], s77 offen offset:128 lds
    s_add_u32 m0, s33, 24576
    s_nop 0
    buffer_load_dwordx4 v22, s[44:47], s77 offen offset:0 lds
    s_add_u32 m0, s33, 28544
    s_nop 0
    buffer_load_dwordx4 v22, s[44:47], s77 offen offset:128 lds
    s_add_u32 m0, s33, 32768
    s_nop 0
    buffer_load_dwordx4 v23, s[48:51], s77 offen lds
    s_add_u32 s77, s77, 229376
    s_add_u32 m0, s79, 0
    s_nop 0
    buffer_load_dwordx4 v20, s[36:39], s78 offen lds
    s_add_u32 m0, s79, 1024
    s_nop 0
    buffer_load_dwordx4 v21, s[36:39], s78 offen lds
    s_add_u32 s78, s78, 32768
    s_add_u32 m0, s33, 36864
    s_nop 0
    buffer_load_dwordx4 v22, s[40:43], s77 offen offset:0 lds
    s_add_u32 m0, s33, 40832
    s_nop 0
    buffer_load_dwordx4 v22, s[40:43], s77 offen offset:128 lds
    s_add_u32 m0, s33, 45056
    s_nop 0
    buffer_load_dwordx4 v22, s[44:47], s77 offen offset:0 lds
    s_add_u32 m0, s33, 49024
    s_nop 0
    buffer_load_dwordx4 v22, s[44:47], s77 offen offset:128 lds
    s_add_u32 m0, s33, 53248
    s_nop 0
    buffer_load_dwordx4 v23, s[48:51], s77 offen lds
    s_add_u32 s77, s77, 229376
    s_add_u32 m0, s79, 2048
    s_nop 0
    buffer_load_dwordx4 v20, s[36:39], s78 offen lds
    s_add_u32 m0, s79, 3072
    s_nop 0
    buffer_load_dwordx4 v21, s[36:39], s78 offen lds
    s_sub_u32 s78, s78, 32768
    s_add_u32 s78, s78, 128
    s_add_u32 s79, s79, 18432
    s_cmp_ge_u32 s79, 153600
    s_cselect_b32 s84, 55296, 0
    s_sub_u32 s79, s79, s84
    s_add_u32 m0, s33, 57344
    s_nop 0
    buffer_load_dwordx4 v22, s[40:43], s77 offen offset:0 lds
    s_add_u32 m0, s33, 61312
    s_nop 0
    buffer_load_dwordx4 v22, s[40:43], s77 offen offset:128 lds
    s_add_u32 m0, s33, 65536
    s_nop 0
    buffer_load_dwordx4 v22, s[44:47], s77 offen offset:0 lds
    s_add_u32 m0, s33, 69504
    s_nop 0
    buffer_load_dwordx4 v22, s[44:47], s77 offen offset:128 lds
    s_add_u32 m0, s33, 73728
    s_nop 0
    buffer_load_dwordx4 v23, s[48:51], s77 offen lds
    s_add_u32 s77, s77, 229376
    s_barrier
    v_mov_b32 v88, 0
    v_mov_b32 v89, 0
    v_mov_b32 v90, 0
    v_mov_b32 v91, 0
    v_mov_b32 v92, 0
    v_mov_b32 v93, 0
    v_mov_b32 v94, 0
    v_mov_b32 v95, 0
    v_mov_b32 v96, 0
    v_mov_b32 v97, 0
    v_mov_b32 v98, 0
    v_mov_b32 v99, 0
    v_mov_b32 v100, 0
    v_mov_b32 v101, 0
    v_mov_b32 v102, 0
    v_mov_b32 v103, 0
    v_mov_b32 v104, 0
    v_mov_b32 v105, 0
    v_mov_b32 v106, 0
    v_mov_b32 v107, 0
    v_mov_b32 v108, 0
    v_mov_b32 v109, 0
    v_mov_b32 v110, 0
    v_mov_b32 v111, 0
    v_mov_b32 v112, 0
    v_mov_b32 v113, 0
    v_mov_b32 v114, 0
    v_mov_b32 v115, 0
    v_mov_b32 v116, 0
    v_mov_b32 v117, 0
    v_mov_b32 v118, 0
    v_mov_b32 v119, 0
    v_mov_b32 v120, 0
    v_mov_b32 v121, 0
    v_mov_b32 v122, 0
    v_mov_b32 v123, 0
    v_mov_b32 v124, 0
    v_mov_b32 v125, 0
    v_mov_b32 v126, 0
    v_mov_b32 v127, 0
    v_mov_b32 v128, 0
    v_mov_b32 v129, 0
    v_mov_b32 v130, 0
    v_mov_b32 v131, 0
    v_mov_b32 v132, 0
    v_mov_b32 v133, 0
    v_mov_b32 v134, 0
    v_mov_b32 v135, 0
    v_mov_b32 v136, 0
    v_mov_b32 v137, 0
    v_mov_b32 v138, 0
    v_mov_b32 v139, 0
    v_mov_b32 v140, 0
    v_mov_b32 v141, 0
    v_mov_b32 v142, 0
    v_mov_b32 v143, 0
    v_mov_b32 v144, 0
    v_mov_b32 v145, 0
    v_mov_b32 v146, 0
    v_mov_b32 v147, 0
    v_mov_b32 v148, 0
    v_mov_b32 v149, 0
    v_mov_b32 v150, 0
    v_mov_b32 v151, 0
    v_mov_b32 v152, 0
    v_mov_b32 v153, 0
    v_mov_b32 v154, 0
    v_mov_b32 v155, 0
    v_mov_b32 v156, 0
    v_mov_b32 v157, 0
    v_mov_b32 v158, 0
    v_mov_b32 v159, 0
    v_mov_b32 v160, 0
    v_mov_b32 v161, 0
    v_mov_b32 v162, 0
    v_mov_b32 v163, 0
    v_mov_b32 v164, 0
    v_mov_b32 v165, 0
    v_mov_b32 v166, 0
    v_mov_b32 v167, 0
    v_mov_b32 v168, 0
    v_mov_b32 v169, 0
    v_mov_b32 v170, 0
    v_mov_b32 v171, 0
    v_mov_b32 v172, 0
    v_mov_b32 v173, 0
    v_mov_b32 v174, 0
    v_mov_b32 v175, 0
    v_mov_b32 v176, 0
    v_mov_b32 v177, 0
    v_mov_b32 v178, 0
    v_mov_b32 v179, 0
    v_mov_b32 v180, 0
    v_mov_b32 v181, 0
    v_mov_b32 v182, 0
    v_mov_b32 v183, 0
    v_mov_b32 v184, 0
    v_mov_b32 v185, 0
    v_mov_b32 v186, 0
    v_mov_b32 v187, 0
    v_mov_b32 v188, 0
    v_mov_b32 v189, 0
    v_mov_b32 v190, 0
    v_mov_b32 v191, 0
    v_mov_b32 v192, 0
    v_mov_b32 v193, 0
    v_mov_b32 v194, 0
    v_mov_b32 v195, 0
    v_mov_b32 v196, 0
    v_mov_b32 v197, 0
    v_mov_b32 v198, 0
    v_mov_b32 v199, 0
    v_mov_b32 v200, 0
    v_mov_b32 v201, 0
    v_mov_b32 v202, 0
    v_mov_b32 v203, 0
    v_mov_b32 v204, 0
    v_mov_b32 v205, 0
    v_mov_b32 v206, 0
    v_mov_b32 v207, 0
    v_mov_b32 v208, 0
    v_mov_b32 v209, 0
    v_mov_b32 v210, 0
    v_mov_b32 v211, 0
    v_mov_b32 v212, 0
    v_mov_b32 v213, 0
    v_mov_b32 v214, 0
    v_mov_b32 v215, 0
    v_mov_b32 v216, 0
    v_mov_b32 v217, 0
    v_mov_b32 v218, 0
    v_mov_b32 v219, 0
    v_mov_b32 v220, 0
    v_mov_b32 v221, 0
    v_mov_b32 v222, 0
    v_mov_b32 v223, 0
    v_mov_b32 v224, 0
    v_mov_b32 v225, 0
    v_mov_b32 v226, 0
    v_mov_b32 v227, 0
    v_mov_b32 v228, 0
    v_mov_b32 v229, 0
    v_mov_b32 v230, 0
    v_mov_b32 v231, 0
    v_mov_b32 v232, 0
    v_mov_b32 v233, 0
    v_mov_b32 v234, 0
    v_mov_b32 v235, 0
    v_mov_b32 v236, 0
    v_mov_b32 v237, 0
    v_mov_b32 v238, 0
    v_mov_b32 v239, 0
    v_mov_b32 v240, 0
    v_mov_b32 v241, 0
    v_mov_b32 v242, 0
    v_mov_b32 v243, 0
    v_mov_b32 v244, 0
    v_mov_b32 v245, 0
    v_mov_b32 v246, 0
    v_mov_b32 v247, 0
    s_waitcnt vmcnt(14)
    s_barrier
    v_add_u32 v14, s80, v16
    v_add_u32 v15, s80, v17
    s_add_u32 s80, s80, 18432
    s_cmp_ge_u32 s80, 153600
    s_cselect_b32 s84, 55296, 0
    s_sub_u32 s80, s80, s84
    ds_read_b64_tr_b16 v[64:65], v4 offset:0
    ds_read_b64_tr_b16 v[66:67], v4 offset:512
    ds_read_b128 v[24:27], v14 offset:0
    ds_read_b128 v[28:31], v14 offset:2048
    ds_read_b128 v[32:35], v14 offset:4096
    ds_read_b128 v[36:39], v14 offset:6144
    ds_read_b64_tr_b16 v[68:69], v4 offset:8192
    ds_read_b64_tr_b16 v[70:71], v4 offset:8704
    ds_read_b64_tr_b16 v[72:73], v5 offset:0
    ds_read_b64_tr_b16 v[74:75], v5 offset:512
    s_mov_b32 s34, 7
.p2align 6
L_p1:
    s_waitcnt lgkmcnt(7)
    v_mfma_f32_16x16x32_bf16 v[88:91], v[64:67], v[24:27], v[88:91]
    ds_read_b64_tr_b16 v[76:77], v5 offset:8192
    s_waitcnt lgkmcnt(7)
    v_mfma_f32_16x16x32_bf16 v[92:95], v[64:67], v[28:31], v[92:95]
    ds_read_b64_tr_b16 v[78:79], v5 offset:8704
    s_waitcnt lgkmcnt(7)
    v_mfma_f32_16x16x32_bf16 v[96:99], v[64:67], v[32:35], v[96:99]
    ds_read_b64_tr_b16 v[80:81], v6 offset:0
    s_waitcnt lgkmcnt(7)
    v_mfma_f32_16x16x32_bf16 v[100:103], v[64:67], v[36:39], v[100:103]
    ds_read_b64_tr_b16 v[82:83], v6 offset:512
    s_waitcnt lgkmcnt(6)
    v_mfma_f32_16x16x32_bf16 v[104:107], v[68:71], v[24:27], v[104:107]
    ds_read_b64_tr_b16 v[64:65], v6 offset:8192
    v_mfma_f32_16x16x32_bf16 v[108:111], v[68:71], v[28:31], v[108:111]
    ds_read_b64_tr_b16 v[66:67], v6 offset:8704
    v_mfma_f32_16x16x32_bf16 v[112:115], v[68:71], v[32:35], v[112:115]
    s_add_u32 m0, s79, 0
    v_mfma_f32_16x16x32_bf16 v[116:119], v[68:71], v[36:39], v[116:119]
    buffer_load_dwordx4 v20, s[36:39], s78 offen lds
    s_waitcnt lgkmcnt(6)
    v_mfma_f32_16x16x32_bf16 v[120:123], v[72:75], v[24:27], v[120:123]
    ds_read_b64_tr_b16 v[68:69], v7 offset:0
    v_mfma_f32_16x16x32_bf16 v[124:127], v[72:75], v[28:31], v[124:127]
    ds_read_b64_tr_b16 v[70:71], v7 offset:512
    v_mfma_f32_16x16x32_bf16 v[128:131], v[72:75], v[32:35], v[128:131]
    s_add_u32 m0, s79, 1024
    v_mfma_f32_16x16x32_bf16 v[132:135], v[72:75], v[36:39], v[132:135]
    buffer_load_dwordx4 v21, s[36:39], s78 offen lds
    s_add_u32 s78, s78, 32768
    s_waitcnt lgkmcnt(6)
    v_mfma_f32_16x16x32_bf16 v[136:139], v[76:79], v[24:27], v[136:139]
    ds_read_b64_tr_b16 v[72:73], v7 offset:8192
    v_mfma_f32_16x16x32_bf16 v[140:143], v[76:79], v[28:31], v[140:143]
    ds_read_b64_tr_b16 v[74:75], v7 offset:8704
    v_mfma_f32_16x16x32_bf16 v[144:147], v[76:79], v[32:35], v[144:147]
    s_add_u32 m0, s33, 77824
    v_mfma_f32_16x16x32_bf16 v[148:151], v[76:79], v[36:39], v[148:151]
    buffer_load_dwordx4 v22, s[40:43], s77 offen offset:0 lds
    s_waitcnt lgkmcnt(6)
    v_mfma_f32_16x16x32_bf16 v[152:155], v[80:83], v[24:27], v[152:155]
    ds_read_b64_tr_b16 v[76:77], v8 offset:16384
    v_mfma_f32_16x16x32_bf16 v[156:159], v[80:83], v[28:31], v[156:159]
    ds_read_b64_tr_b16 v[78:79], v8 offset:16640
    v_mfma_f32_16x16x32_bf16 v[160:163], v[80:83], v[32:35], v[160:163]
    s_add_u32 m0, s33, 81792
    v_mfma_f32_16x16x32_bf16 v[164:167], v[80:83], v[36:39], v[164:167]
    buffer_load_dwordx4 v22, s[40:43], s77 offen offset:128 lds
    s_waitcnt lgkmcnt(6)
    v_mfma_f32_16x16x32_bf16 v[168:171], v[64:67], v[24:27], v[168:171]
    ds_read_b64_tr_b16 v[80:81], v8 offset:18432
    v_mfma_f32_16x16x32_bf16 v[172:175], v[64:67], v[28:31], v[172:175]
    ds_read_b64_tr_b16 v[82:83], v8 offset:18688
    v_mfma_f32_16x16x32_bf16 v[176:179], v[64:67], v[32:35], v[176:179]
    s_add_u32 m0, s33, 86016
    v_mfma_f32_16x16x32_bf16 v[180:183], v[64:67], v[36:39], v[180:183]
    buffer_load_dwordx4 v22, s[44:47], s77 offen offset:0 lds
    s_waitcnt lgkmcnt(6)
    v_mfma_f32_16x16x32_bf16 v[184:187], v[68:71], v[24:27], v[184:187]
    s_add_u32 m0, s33, 89984
    v_mfma_f32_16x16x32_bf16 v[188:191], v[68:71], v[28:31], v[188:191]
    buffer_load_dwordx4 v22, s[44:47], s77 offen offset:128 lds
    v_mfma_f32_16x16x32_bf16 v[192:195], v[68:71], v[32:35], v[192:195]
    s_add_u32 m0, s33, 94208
    v_mfma_f32_16x16x32_bf16 v[196:199], v[68:71], v[36:39], v[196:199]
    buffer_load_dwordx4 v23, s[48:51], s77 offen lds
    s_add_u32 s77, s77, 229376
    s_waitcnt vmcnt(14) lgkmcnt(0)
    s_barrier
    v_mfma_f32_16x16x32_bf16 v[200:203], v[72:75], v[24:27], v[200:203]
    ds_read_b64_tr_b16 v[64:65], v4 offset:20480
    v_mfma_f32_16x16x32_bf16 v[204:207], v[72:75], v[28:31], v[204:207]
    ds_read_b64_tr_b16 v[66:67], v4 offset:20992
    v_mfma_f32_16x16x32_bf16 v[208:211], v[72:75], v[32:35], v[208:211]
    ds_read_b128 v[40:43], v15 offset:0
    v_mfma_f32_16x16x32_bf16 v[212:215], v[72:75], v[36:39], v[212:215]
    ds_read_b128 v[44:47], v15 offset:2048
    v_mfma_f32_16x16x32_bf16 v[216:219], v[76:79], v[24:27], v[216:219]
    ds_read_b128 v[48:51], v15 offset:4096
    v_mfma_f32_16x16x32_bf16 v[220:223], v[76:79], v[28:31], v[220:223]
    ds_read_b128 v[52:55], v15 offset:6144
    v_mfma_f32_16x16x32_bf16 v[224:227], v[76:79], v[32:35], v[224:227]
    ds_read_b64_tr_b16 v[68:69], v4 offset:28672
    v_mfma_f32_16x16x32_bf16 v[228:231], v[76:79], v[36:39], v[228:231]
    ds_read_b64_tr_b16 v[70:71], v4 offset:29184
    v_mfma_f32_16x16x32_bf16 v[232:235], v[80:83], v[24:27], v[232:235]
    ds_read_b64_tr_b16 v[72:73], v5 offset:20480
    v_mfma_f32_16x16x32_bf16 v[236:239], v[80:83], v[28:31], v[236:239]
    v_mfma_f32_16x16x32_bf16 v[240:243], v[80:83], v[32:35], v[240:243]
    ds_read_b64_tr_b16 v[74:75], v5 offset:20992
    v_mfma_f32_16x16x32_bf16 v[244:247], v[80:83], v[36:39], v[244:247]
    s_waitcnt lgkmcnt(7)
    v_mfma_f32_16x16x32_bf16 v[88:91], v[64:67], v[40:43], v[88:91]
    ds_read_b64_tr_b16 v[76:77], v5 offset:28672
    s_waitcnt lgkmcnt(7)
    v_mfma_f32_16x16x32_bf16 v[92:95], v[64:67], v[44:47], v[92:95]
    ds_read_b64_tr_b16 v[78:79], v5 offset:29184
    s_waitcnt lgkmcnt(7)
    v_mfma_f32_16x16x32_bf16 v[96:99], v[64:67], v[48:51], v[96:99]
    ds_read_b64_tr_b16 v[80:81], v6 offset:20480
    s_waitcnt lgkmcnt(7)
    v_mfma_f32_16x16x32_bf16 v[100:103], v[64:67], v[52:55], v[100:103]
    ds_read_b64_tr_b16 v[82:83], v6 offset:20992
    s_waitcnt lgkmcnt(6)
    v_mfma_f32_16x16x32_bf16 v[104:107], v[68:71], v[40:43], v[104:107]
    ds_read_b64_tr_b16 v[64:65], v6 offset:28672
    v_mfma_f32_16x16x32_bf16 v[108:111], v[68:71], v[44:47], v[108:111]
    ds_read_b64_tr_b16 v[66:67], v6 offset:29184
    v_mfma_f32_16x16x32_bf16 v[112:115], v[68:71], v[48:51], v[112:115]
    s_add_u32 m0, s79, 2048
    v_mfma_f32_16x16x32_bf16 v[116:119], v[68:71], v[52:55], v[116:119]
    buffer_load_dwordx4 v20, s[36:39], s78 offen lds
    s_waitcnt lgkmcnt(6)
    v_mfma_f32_16x16x32_bf16 v[120:123], v[72:75], v[40:43], v[120:123]
    ds_read_b64_tr_b16 v[68:69], v7 offset:20480
    v_mfma_f32_16x16x32_bf16 v[124:127], v[72:75], v[44:47], v[124:127]
    ds_read_b64_tr_b16 v[70:71], v7 offset:20992
    v_mfma_f32_16x16x32_bf16 v[128:131], v[72:75], v[48:51], v[128:131]
    s_add_u32 m0, s79, 3072
    v_mfma_f32_16x16x32_bf16 v[132:135], v[72:75], v[52:55], v[132:135]
    buffer_load_dwordx4 v21, s[36:39], s78 offen lds
    s_sub_u32 s78, s78, 32768
    s_add_u32 s78, s78, 128
    s_add_u32 s79, s79, 18432
    s_cmp_ge_u32 s79, 153600
    s_cselect_b32 s84, 55296, 0
    s_sub_u32 s79, s79, s84
    s_waitcnt lgkmcnt(6)
    v_mfma_f32_16x16x32_bf16 v[136:139], v[76:79], v[40:43], v[136:139]
    ds_read_b64_tr_b16 v[72:73], v7 offset:28672
    v_mfma_f32_16x16x32_bf16 v[140:143], v[76:79], v[44:47], v[140:143]
    ds_read_b64_tr_b16 v[74:75], v7 offset:29184
    v_mfma_f32_16x16x32_bf16 v[144:147], v[76:79], v[48:51], v[144:147]
    s_add_u32 m0, s33, 16384
    v_mfma_f32_16x16x32_bf16 v[148:151], v[76:79], v[52:55], v[148:151]
    buffer_load_dwordx4 v22, s[40:43], s77 offen offset:0 lds
    s_waitcnt lgkmcnt(6)
    v_mfma_f32_16x16x32_bf16 v[152:155], v[80:83], v[40:43], v[152:155]
    ds_read_b64_tr_b16 v[76:77], v8 offset:36864
    v_mfma_f32_16x16x32_bf16 v[156:159], v[80:83], v[44:47], v[156:159]
    ds_read_b64_tr_b16 v[78:79], v8 offset:37120
    v_mfma_f32_16x16x32_bf16 v[160:163], v[80:83], v[48:51], v[160:163]
    s_add_u32 m0, s33, 20352
    v_mfma_f32_16x16x32_bf16 v[164:167], v[80:83], v[52:55], v[164:167]
    buffer_load_dwordx4 v22, s[40:43], s77 offen offset:128 lds
    s_waitcnt lgkmcnt(6)
    v_mfma_f32_16x16x32_bf16 v[168:171], v[64:67], v[40:43], v[168:171]
    ds_read_b64_tr_b16 v[80:81], v8 offset:38912
    v_mfma_f32_16x16x32_bf16 v[172:175], v[64:67], v[44:47], v[172:175]
    ds_read_b64_tr_b16 v[82:83], v8 offset:39168
    v_mfma_f32_16x16x32_bf16 v[176:179], v[64:67], v[48:51], v[176:179]
    s_add_u32 m0, s33, 24576
    v_mfma_f32_16x16x32_bf16 v[180:183], v[64:67], v[52:55], v[180:183]
    buffer_load_dwordx4 v22, s[44:47], s77 offen offset:0 lds
    s_waitcnt lgkmcnt(6)
    v_mfma_f32_16x16x32_bf16 v[184:187], v[68:71], v[40:43], v[184:187]
    v_add_u32 v14, s80, v16
    v_add_u32 v15, s80, v17
    s_add_u32 s80, s80, 18432
    s_cmp_ge_u32 s80, 153600
    s_cselect_b32 s84, 55296, 0
    s_sub_u32 s80, s80, s84
    s_add_u32 m0, s33, 28544
    v_mfma_f32_16x16x32_bf16 v[188:191], v[68:71], v[44:47], v[188:191]
    buffer_load_dwordx4 v22, s[44:47], s77 offen offset:128 lds
    v_mfma_f32_16x16x32_bf16 v[192:195], v[68:71], v[48:51], v[192:195]
    s_add_u32 m0, s33, 32768
    v_mfma_f32_16x16x32_bf16 v[196:199], v[68:71], v[52:55], v[196:199]
    buffer_load_dwordx4 v23, s[48:51], s77 offen lds
    s_add_u32 s77, s77, 229376
    s_waitcnt vmcnt(14) lgkmcnt(0)
    s_barrier
    v_mfma_f32_16x16x32_bf16 v[200:203], v[72:75], v[40:43], v[200:203]
    ds_read_b64_tr_b16 v[64:65], v9 offset:0
    v_mfma_f32_16x16x32_bf16 v[204:207], v[72:75], v[44:47], v[204:207]
    ds_read_b64_tr_b16 v[66:67], v9 offset:512
    v_mfma_f32_16x16x32_bf16 v[208:211], v[72:75], v[48:51], v[208:211]
    ds_read_b128 v[24:27], v14 offset:0
    v_mfma_f32_16x16x32_bf16 v[212:215], v[72:75], v[52:55], v[212:215]
    ds_read_b128 v[28:31], v14 offset:2048
    v_mfma_f32_16x16x32_bf16 v[216:219], v[76:79], v[40:43], v[216:219]
    ds_read_b128 v[32:35], v14 offset:4096
    v_mfma_f32_16x16x32_bf16 v[220:223], v[76:79], v[44:47], v[220:223]
    ds_read_b128 v[36:39], v14 offset:6144
    v_mfma_f32_16x16x32_bf16 v[224:227], v[76:79], v[48:51], v[224:227]
    ds_read_b64_tr_b16 v[68:69], v9 offset:8192
    v_mfma_f32_16x16x32_bf16 v[228:231], v[76:79], v[52:55], v[228:231]
    ds_read_b64_tr_b16 v[70:71], v9 offset:8704
    v_mfma_f32_16x16x32_bf16 v[232:235], v[80:83], v[40:43], v[232:235]
    ds_read_b64_tr_b16 v[72:73], v10 offset:0
    v_mfma_f32_16x16x32_bf16 v[236:239], v[80:83], v[44:47], v[236:239]
    v_mfma_f32_16x16x32_bf16 v[240:243], v[80:83], v[48:51], v[240:243]
    ds_read_b64_tr_b16 v[74:75], v10 offset:512
    v_mfma_f32_16x16x32_bf16 v[244:247], v[80:83], v[52:55], v[244:247]
    s_waitcnt lgkmcnt(7)
    v_mfma_f32_16x16x32_bf16 v[88:91], v[64:67], v[24:27], v[88:91]
    ds_read_b64_tr_b16 v[76:77], v10 offset:8192
    s_waitcnt lgkmcnt(7)
    v_mfma_f32_16x16x32_bf16 v[92:95], v[64:67], v[28:31], v[92:95]
    ds_read_b64_tr_b16 v[78:79], v10 offset:8704
    s_waitcnt lgkmcnt(7)
    v_mfma_f32_16x16x32_bf16 v[96:99], v[64:67], v[32:35], v[96:99]
    ds_read_b64_tr_b16 v[80:81], v11 offset:0
    s_waitcnt lgkmcnt(7)
    v_mfma_f32_16x16x32_bf16 v[100:103], v[64:67], v[36:39], v[100:103]
    ds_read_b64_tr_b16 v[82:83], v11 offset:512
    s_waitcnt lgkmcnt(6)
    v_mfma_f32_16x16x32_bf16 v[104:107], v[68:71], v[24:27], v[104:107]
    ds_read_b64_tr_b16 v[64:65], v11 offset:8192
    v_mfma_f32_16x16x32_bf16 v[108:111], v[68:71], v[28:31], v[108:111]
    ds_read_b64_tr_b16 v[66:67], v11 offset:8704
    v_mfma_f32_16x16x32_bf16 v[112:115], v[68:71], v[32:35], v[112:115]
    s_add_u32 m0, s79, 0
    v_mfma_f32_16x16x32_bf16 v[116:119], v[68:71], v[36:39], v[116:119]
    buffer_load_dwordx4 v20, s[36:39], s78 offen lds
    s_waitcnt lgkmcnt(6)
    v_mfma_f32_16x16x32_bf16 v[120:123], v[72:75], v[24:27], v[120:123]
    ds_read_b64_tr_b16 v[68:69], v12 offset:0
    v_mfma_f32_16x16x32_bf16 v[124:127], v[72:75], v[28:31], v[124:127]
    ds_read_b64_tr_b16 v[70:71], v12 offset:512
    v_mfma_f32_16x16x32_bf16 v[128:131], v[72:75], v[32:35], v[128:131]
    s_add_u32 m0, s79, 1024
    v_mfma_f32_16x16x32_bf16 v[132:135], v[72:75], v[36:39], v[132:135]
    buffer_load_dwordx4 v21, s[36:39], s78 offen lds
    s_add_u32 s78, s78, 32768
    s_waitcnt lgkmcnt(6)
    v_mfma_f32_16x16x32_bf16 v[136:139], v[76:79], v[24:27], v[136:139]
    ds_read_b64_tr_b16 v[72:73], v12 offset:8192
    v_mfma_f32_16x16x32_bf16 v[140:143], v[76:79], v[28:31], v[140:143]
    ds_read_b64_tr_b16 v[74:75], v12 offset:8704
    v_mfma_f32_16x16x32_bf16 v[144:147], v[76:79], v[32:35], v[144:147]
    s_add_u32 m0, s33, 36864
    v_mfma_f32_16x16x32_bf16 v[148:151], v[76:79], v[36:39], v[148:151]
    buffer_load_dwordx4 v22, s[40:43], s77 offen offset:0 lds
    s_waitcnt lgkmcnt(6)
    v_mfma_f32_16x16x32_bf16 v[152:155], v[80:83], v[24:27], v[152:155]
    ds_read_b64_tr_b16 v[76:77], v13 offset:16384
    v_mfma_f32_16x16x32_bf16 v[156:159], v[80:83], v[28:31], v[156:159]
    ds_read_b64_tr_b16 v[78:79], v13 offset:16640
    v_mfma_f32_16x16x32_bf16 v[160:163], v[80:83], v[32:35], v[160:163]
    s_add_u32 m0, s33, 40832
    v_mfma_f32_16x16x32_bf16 v[164:167], v[80:83], v[36:39], v[164:167]
    buffer_load_dwordx4 v22, s[40:43], s77 offen offset:128 lds
    s_waitcnt lgkmcnt(6)
    v_mfma_f32_16x16x32_bf16 v[168:171], v[64:67], v[24:27], v[168:171]
    ds_read_b64_tr_b16 v[80:81], v13 offset:18432
    v_mfma_f32_16x16x32_bf16 v[172:175], v[64:67], v[28:31], v[172:175]
    ds_read_b64_tr_b16 v[82:83], v13 offset:18688
    v_mfma_f32_16x16x32_bf16 v[176:179], v[64:67], v[32:35], v[176:179]
    s_add_u32 m0, s33, 45056
    v_mfma_f32_16x16x32_bf16 v[180:183], v[64:67], v[36:39], v[180:183]
    buffer_load_dwordx4 v22, s[44:47], s77 offen offset:0 lds
    s_waitcnt lgkmcnt(6)
    v_mfma_f32_16x16x32_bf16 v[184:187], v[68:71], v[24:27], v[184:187]
    s_add_u32 m0, s33, 49024
    v_mfma_f32_16x16x32_bf16 v[188:191], v[68:71], v[28:31], v[188:191]
    buffer_load_dwordx4 v22, s[44:47], s77 offen offset:128 lds
    v_mfma_f32_16x16x32_bf16 v[192:195], v[68:71], v[32:35], v[192:195]
    s_add_u32 m0, s33, 53248
    v_mfma_f32_16x16x32_bf16 v[196:199], v[68:71], v[36:39], v[196:199]
    buffer_load_dwordx4 v23, s[48:51], s77 offen lds
    s_add_u32 s77, s77, 229376
    s_waitcnt vmcnt(14) lgkmcnt(0)
    s_barrier
    v_mfma_f32_16x16x32_bf16 v[200:203], v[72:75], v[24:27], v[200:203]
    ds_read_b64_tr_b16 v[64:65], v9 offset:20480
    v_mfma_f32_16x16x32_bf16 v[204:207], v[72:75], v[28:31], v[204:207]
    ds_read_b64_tr_b16 v[66:67], v9 offset:20992
    v_mfma_f32_16x16x32_bf16 v[208:211], v[72:75], v[32:35], v[208:211]
    ds_read_b128 v[40:43], v15 offset:0
    v_mfma_f32_16x16x32_bf16 v[212:215], v[72:75], v[36:39], v[212:215]
    ds_read_b128 v[44:47], v15 offset:2048
    v_mfma_f32_16x16x32_bf16 v[216:219], v[76:79], v[24:27], v[216:219]
    ds_read_b128 v[48:51], v15 offset:4096
    v_mfma_f32_16x16x32_bf16 v[220:223], v[76:79], v[28:31], v[220:223]
    ds_read_b128 v[52:55], v15 offset:6144
    v_mfma_f32_16x16x32_bf16 v[224:227], v[76:79], v[32:35], v[224:227]
    ds_read_b64_tr_b16 v[68:69], v9 offset:28672
    v_mfma_f32_16x16x32_bf16 v[228:231], v[76:79], v[36:39], v[228:231]
    ds_read_b64_tr_b16 v[70:71], v9 offset:29184
    v_mfma_f32_16x16x32_bf16 v[232:235], v[80:83], v[24:27], v[232:235]
    ds_read_b64_tr_b16 v[72:73], v10 offset:20480
    v_mfma_f32_16x16x32_bf16 v[236:239], v[80:83], v[28:31], v[236:239]
    v_mfma_f32_16x16x32_bf16 v[240:243], v[80:83], v[32:35], v[240:243]
    ds_read_b64_tr_b16 v[74:75], v10 offset:20992
    v_mfma_f32_16x16x32_bf16 v[244:247], v[80:83], v[36:39], v[244:247]
    s_waitcnt lgkmcnt(7)
    v_mfma_f32_16x16x32_bf16 v[88:91], v[64:67], v[40:43], v[88:91]
    ds_read_b64_tr_b16 v[76:77], v10 offset:28672
    s_waitcnt lgkmcnt(7)
    v_mfma_f32_16x16x32_bf16 v[92:95], v[64:67], v[44:47], v[92:95]
    ds_read_b64_tr_b16 v[78:79], v10 offset:29184
    s_waitcnt lgkmcnt(7)
    v_mfma_f32_16x16x32_bf16 v[96:99], v[64:67], v[48:51], v[96:99]
    ds_read_b64_tr_b16 v[80:81], v11 offset:20480
    s_waitcnt lgkmcnt(7)
    v_mfma_f32_16x16x32_bf16 v[100:103], v[64:67], v[52:55], v[100:103]
    ds_read_b64_tr_b16 v[82:83], v11 offset:20992
    s_waitcnt lgkmcnt(6)
    v_mfma_f32_16x16x32_bf16 v[104:107], v[68:71], v[40:43], v[104:107]
    ds_read_b64_tr_b16 v[64:65], v11 offset:28672
    v_mfma_f32_16x16x32_bf16 v[108:111], v[68:71], v[44:47], v[108:111]
    ds_read_b64_tr_b16 v[66:67], v11 offset:29184
    v_mfma_f32_16x16x32_bf16 v[112:115], v[68:71], v[48:51], v[112:115]
    s_add_u32 m0, s79, 2048
    v_mfma_f32_16x16x32_bf16 v[116:119], v[68:71], v[52:55], v[116:119]
    buffer_load_dwordx4 v20, s[36:39], s78 offen lds
    s_waitcnt lgkmcnt(6)
    v_mfma_f32_16x16x32_bf16 v[120:123], v[72:75], v[40:43], v[120:123]
    ds_read_b64_tr_b16 v[68:69], v12 offset:20480
    v_mfma_f32_16x16x32_bf16 v[124:127], v[72:75], v[44:47], v[124:127]
    ds_read_b64_tr_b16 v[70:71], v12 offset:20992
    v_mfma_f32_16x16x32_bf16 v[128:131], v[72:75], v[48:51], v[128:131]
    s_add_u32 m0, s79, 3072
    v_mfma_f32_16x16x32_bf16 v[132:135], v[72:75], v[52:55], v[132:135]
    buffer_load_dwordx4 v21, s[36:39], s78 offen lds
    s_sub_u32 s78, s78, 32768
    s_add_u32 s78, s78, 128
    s_add_u32 s79, s79, 18432
    s_cmp_ge_u32 s79, 153600
    s_cselect_b32 s84, 55296, 0
    s_sub_u32 s79, s79, s84
    s_waitcnt lgkmcnt(6)
    v_mfma_f32_16x16x32_bf16 v[136:139], v[76:79], v[40:43], v[136:139]
    ds_read_b64_tr_b16 v[72:73], v12 offset:28672
    v_mfma_f32_16x16x32_bf16 v[140:143], v[76:79], v[44:47], v[140:143]
    ds_read_b64_tr_b16 v[74:75], v12 offset:29184
    v_mfma_f32_16x16x32_bf16 v[144:147], v[76:79], v[48:51], v[144:147]
    s_add_u32 m0, s33, 57344
    v_mfma_f32_16x16x32_bf16 v[148:151], v[76:79], v[52:55], v[148:151]
    buffer_load_dwordx4 v22, s[40:43], s77 offen offset:0 lds
    s_waitcnt lgkmcnt(6)
    v_mfma_f32_16x16x32_bf16 v[152:155], v[80:83], v[40:43], v[152:155]
    ds_read_b64_tr_b16 v[76:77], v13 offset:36864
    v_mfma_f32_16x16x32_bf16 v[156:159], v[80:83], v[44:47], v[156:159]
    ds_read_b64_tr_b16 v[78:79], v13 offset:37120
    v_mfma_f32_16x16x32_bf16 v[160:163], v[80:83], v[48:51], v[160:163]
    s_add_u32 m0, s33, 61312
    v_mfma_f32_16x16x32_bf16 v[164:167], v[80:83], v[52:55], v[164:167]
    buffer_load_dwordx4 v22, s[40:43], s77 offen offset:128 lds
    s_waitcnt lgkmcnt(6)
    v_mfma_f32_16x16x32_bf16 v[168:171], v[64:67], v[40:43], v[168:171]
    ds_read_b64_tr_b16 v[80:81], v13 offset:38912
    v_mfma_f32_16x16x32_bf16 v[172:175], v[64:67], v[44:47], v[172:175]
    ds_read_b64_tr_b16 v[82:83], v13 offset:39168
    v_mfma_f32_16x16x32_bf16 v[176:179], v[64:67], v[48:51], v[176:179]
    s_add_u32 m0, s33, 65536
    v_mfma_f32_16x16x32_bf16 v[180:183], v[64:67], v[52:55], v[180:183]
    buffer_load_dwordx4 v22, s[44:47], s77 offen offset:0 lds
    s_waitcnt lgkmcnt(6)
    v_mfma_f32_16x16x32_bf16 v[184:187], v[68:71], v[40:43], v[184:187]
    v_add_u32 v14, s80, v16
    v_add_u32 v15, s80, v17
    s_add_u32 s80, s80, 18432
    s_cmp_ge_u32 s80, 153600
    s_cselect_b32 s84, 55296, 0
    s_sub_u32 s80, s80, s84
    s_add_u32 m0, s33, 69504
    v_mfma_f32_16x16x32_bf16 v[188:191], v[68:71], v[44:47], v[188:191]
    buffer_load_dwordx4 v22, s[44:47], s77 offen offset:128 lds
    v_mfma_f32_16x16x32_bf16 v[192:195], v[68:71], v[48:51], v[192:195]
    s_add_u32 m0, s33, 73728
    v_mfma_f32_16x16x32_bf16 v[196:199], v[68:71], v[52:55], v[196:199]
    buffer_load_dwordx4 v23, s[48:51], s77 offen lds
    s_add_u32 s77, s77, 229376
    s_waitcnt vmcnt(14) lgkmcnt(0)
    s_barrier
    v_mfma_f32_16x16x32_bf16 v[200:203], v[72:75], v[40:43], v[200:203]
    ds_read_b64_tr_b16 v[64:65], v4 offset:0
    v_mfma_f32_16x16x32_bf16 v[204:207], v[72:75], v[44:47], v[204:207]
    ds_read_b64_tr_b16 v[66:67], v4 offset:512
    v_mfma_f32_16x16x32_bf16 v[208:211], v[72:75], v[48:51], v[208:211]
    ds_read_b128 v[24:27], v14 offset:0
    v_mfma_f32_16x16x32_bf16 v[212:215], v[72:75], v[52:55], v[212:215]
    ds_read_b128 v[28:31], v14 offset:2048
    v_mfma_f32_16x16x32_bf16 v[216:219], v[76:79], v[40:43], v[216:219]
    ds_read_b128 v[32:35], v14 offset:4096
    v_mfma_f32_16x16x32_bf16 v[220:223], v[76:79], v[44:47], v[220:223]
    ds_read_b128 v[36:39], v14 offset:6144
    v_mfma_f32_16x16x32_bf16 v[224:227], v[76:79], v[48:51], v[224:227]
    ds_read_b64_tr_b16 v[68:69], v4 offset:8192
    v_mfma_f32_16x16x32_bf16 v[228:231], v[76:79], v[52:55], v[228:231]
    ds_read_b64_tr_b16 v[70:71], v4 offset:8704
    v_mfma_f32_16x16x32_bf16 v[232:235], v[80:83], v[40:43], v[232:235]
    ds_read_b64_tr_b16 v[72:73], v5 offset:0
    v_mfma_f32_16x16x32_bf16 v[236:239], v[80:83], v[44:47], v[236:239]
    v_mfma_f32_16x16x32_bf16 v[240:243], v[80:83], v[48:51], v[240:243]
    ds_read_b64_tr_b16 v[74:75], v5 offset:512
    v_mfma_f32_16x16x32_bf16 v[244:247], v[80:83], v[52:55], v[244:247]
    s_sub_u32 s34, s34, 1
    s_cmp_lg_u32 s34, 0
    s_cbranch_scc1 L_p1
    s_waitcnt lgkmcnt(7)
    v_mfma_f32_16x16x32_bf16 v[88:91], v[64:67], v[24:27], v[88:91]
    ds_read_b64_tr_b16 v[76:77], v5 offset:8192
    s_waitcnt lgkmcnt(7)
    v_mfma_f32_16x16x32_bf16 v[92:95], v[64:67], v[28:31], v[92:95]
    ds_read_b64_tr_b16 v[78:79], v5 offset:8704
    s_waitcnt lgkmcnt(7)
    v_mfma_f32_16x16x32_bf16 v[96:99], v[64:67], v[32:35], v[96:99]
    ds_read_b64_tr_b16 v[80:81], v6 offset:0
    s_waitcnt lgkmcnt(7)
    v_mfma_f32_16x16x32_bf16 v[100:103], v[64:67], v[36:39], v[100:103]
    ds_read_b64_tr_b16 v[82:83], v6 offset:512
    s_waitcnt lgkmcnt(6)
    v_mfma_f32_16x16x32_bf16 v[104:107], v[68:71], v[24:27], v[104:107]
    ds_read_b64_tr_b16 v[64:65], v6 offset:8192
    v_mfma_f32_16x16x32_bf16 v[108:111], v[68:71], v[28:31], v[108:111]
    ds_read_b64_tr_b16 v[66:67], v6 offset:8704
    v_mfma_f32_16x16x32_bf16 v[112:115], v[68:71], v[32:35], v[112:115]
    s_add_u32 m0, s33, 77824
    v_mfma_f32_16x16x32_bf16 v[116:119], v[68:71], v[36:39], v[116:119]
    buffer_load_dwordx4 v22, s[40:43], s77 offen offset:0 lds
    s_waitcnt lgkmcnt(6)
    v_mfma_f32_16x16x32_bf16 v[120:123], v[72:75], v[24:27], v[120:123]
    ds_read_b64_tr_b16 v[68:69], v7 offset:0
    v_mfma_f32_16x16x32_bf16 v[124:127], v[72:75], v[28:31], v[124:127]
    ds_read_b64_tr_b16 v[70:71], v7 offset:512
    v_mfma_f32_16x16x32_bf16 v[128:131], v[72:75], v[32:35], v[128:131]
    s_add_u32 m0, s33, 81792
    v_mfma_f32_16x16x32_bf16 v[132:135], v[72:75], v[36:39], v[132:135]
    buffer_load_dwordx4 v22, s[40:43], s77 offen offset:128 lds
    s_waitcnt lgkmcnt(6)
    v_mfma_f32_16x16x32_bf16 v[136:139], v[76:79], v[24:27], v[136:139]
    ds_read_b64_tr_b16 v[72:73], v7 offset:8192
    v_mfma_f32_16x16x32_bf16 v[140:143], v[76:79], v[28:31], v[140:143]
    ds_read_b64_tr_b16 v[74:75], v7 offset:8704
    v_mfma_f32_16x16x32_bf16 v[144:147], v[76:79], v[32:35], v[144:147]
    s_add_u32 m0, s33, 86016
    v_mfma_f32_16x16x32_bf16 v[148:151], v[76:79], v[36:39], v[148:151]
    buffer_load_dwordx4 v22, s[44:47], s77 offen offset:0 lds
    s_waitcnt lgkmcnt(6)
    v_mfma_f32_16x16x32_bf16 v[152:155], v[80:83], v[24:27], v[152:155]
    ds_read_b64_tr_b16 v[76:77], v8 offset:16384
    v_mfma_f32_16x16x32_bf16 v[156:159], v[80:83], v[28:31], v[156:159]
    ds_read_b64_tr_b16 v[78:79], v8 offset:16640
    v_mfma_f32_16x16x32_bf16 v[160:163], v[80:83], v[32:35], v[160:163]
    s_add_u32 m0, s33, 89984
    v_mfma_f32_16x16x32_bf16 v[164:167], v[80:83], v[36:39], v[164:167]
    buffer_load_dwordx4 v22, s[44:47], s77 offen offset:128 lds
    s_waitcnt lgkmcnt(6)
    v_mfma_f32_16x16x32_bf16 v[168:171], v[64:67], v[24:27], v[168:171]
    ds_read_b64_tr_b16 v[80:81], v8 offset:18432
    v_mfma_f32_16x16x32_bf16 v[172:175], v[64:67], v[28:31], v[172:175]
    ds_read_b64_tr_b16 v[82:83], v8 offset:18688
    v_mfma_f32_16x16x32_bf16 v[176:179], v[64:67], v[32:35], v[176:179]
    s_add_u32 m0, s33, 94208
    v_mfma_f32_16x16x32_bf16 v[180:183], v[64:67], v[36:39], v[180:183]
    buffer_load_dwordx4 v23, s[48:51], s77 offen lds
    s_add_u32 s77, s77, 229376
    s_waitcnt lgkmcnt(6)
    v_mfma_f32_16x16x32_bf16 v[184:187], v[68:71], v[24:27], v[184:187]
    v_mfma_f32_16x16x32_bf16 v[188:191], v[68:71], v[28:31], v[188:191]
    v_mfma_f32_16x16x32_bf16 v[192:195], v[68:71], v[32:35], v[192:195]
    v_mfma_f32_16x16x32_bf16 v[196:199], v[68:71], v[36:39], v[196:199]
    s_waitcnt vmcnt(12) lgkmcnt(0)
    s_barrier
    v_mfma_f32_16x16x32_bf16 v[200:203], v[72:75], v[24:27], v[200:203]
    ds_read_b64_tr_b16 v[64:65], v4 offset:20480
    v_mfma_f32_16x16x32_bf16 v[204:207], v[72:75], v[28:31], v[204:207]
    ds_read_b64_tr_b16 v[66:67], v4 offset:20992
    v_mfma_f32_16x16x32_bf16 v[208:211], v[72:75], v[32:35], v[208:211]
    ds_read_b128 v[40:43], v15 offset:0
    v_mfma_f32_16x16x32_bf16 v[212:215], v[72:75], v[36:39], v[212:215]
    ds_read_b128 v[44:47], v15 offset:2048
    v_mfma_f32_16x16x32_bf16 v[216:219], v[76:79], v[24:27], v[216:219]
    ds_read_b128 v[48:51], v15 offset:4096
    v_mfma_f32_16x16x32_bf16 v[220:223], v[76:79], v[28:31], v[220:223]
    ds_read_b128 v[52:55], v15 offset:6144
    v_mfma_f32_16x16x32_bf16 v[224:227], v[76:79], v[32:35], v[224:227]
    ds_read_b64_tr_b16 v[68:69], v4 offset:28672
    v_mfma_f32_16x16x32_bf16 v[228:231], v[76:79], v[36:39], v[228:231]
    ds_read_b64_tr_b16 v[70:71], v4 offset:29184
    v_mfma_f32_16x16x32_bf16 v[232:235], v[80:83], v[24:27], v[232:235]
    ds_read_b64_tr_b16 v[72:73], v5 offset:20480
    v_mfma_f32_16x16x32_bf16 v[236:239], v[80:83], v[28:31], v[236:239]
    v_mfma_f32_16x16x32_bf16 v[240:243], v[80:83], v[32:35], v[240:243]
    ds_read_b64_tr_b16 v[74:75], v5 offset:20992
    v_mfma_f32_16x16x32_bf16 v[244:247], v[80:83], v[36:39], v[244:247]
    s_waitcnt lgkmcnt(7)
    v_mfma_f32_16x16x32_bf16 v[88:91], v[64:67], v[40:43], v[88:91]
    ds_read_b64_tr_b16 v[76:77], v5 offset:28672
    s_waitcnt lgkmcnt(7)
    v_mfma_f32_16x16x32_bf16 v[92:95], v[64:67], v[44:47], v[92:95]
    ds_read_b64_tr_b16 v[78:79], v5 offset:29184
    s_waitcnt lgkmcnt(7)
    v_mfma_f32_16x16x32_bf16 v[96:99], v[64:67], v[48:51], v[96:99]
    ds_read_b64_tr_b16 v[80:81], v6 offset:20480
    s_waitcnt lgkmcnt(7)
    v_mfma_f32_16x16x32_bf16 v[100:103], v[64:67], v[52:55], v[100:103]
    ds_read_b64_tr_b16 v[82:83], v6 offset:20992
    s_waitcnt lgkmcnt(6)
    v_mfma_f32_16x16x32_bf16 v[104:107], v[68:71], v[40:43], v[104:107]
    ds_read_b64_tr_b16 v[64:65], v6 offset:28672
    v_mfma_f32_16x16x32_bf16 v[108:111], v[68:71], v[44:47], v[108:111]
    v_mfma_f32_16x16x32_bf16 v[112:115], v[68:71], v[48:51], v[112:115]
    ds_read_b64_tr_b16 v[66:67], v6 offset:29184
    v_mfma_f32_16x16x32_bf16 v[116:119], v[68:71], v[52:55], v[116:119]
    s_waitcnt lgkmcnt(6)
    v_mfma_f32_16x16x32_bf16 v[120:123], v[72:75], v[40:43], v[120:123]
    ds_read_b64_tr_b16 v[68:69], v7 offset:20480
    v_mfma_f32_16x16x32_bf16 v[124:127], v[72:75], v[44:47], v[124:127]
    v_mfma_f32_16x16x32_bf16 v[128:131], v[72:75], v[48:51], v[128:131]
    ds_read_b64_tr_b16 v[70:71], v7 offset:20992
    v_mfma_f32_16x16x32_bf16 v[132:135], v[72:75], v[52:55], v[132:135]
    s_waitcnt lgkmcnt(6)
    v_mfma_f32_16x16x32_bf16 v[136:139], v[76:79], v[40:43], v[136:139]
    ds_read_b64_tr_b16 v[72:73], v7 offset:28672
    v_mfma_f32_16x16x32_bf16 v[140:143], v[76:79], v[44:47], v[140:143]
    v_mfma_f32_16x16x32_bf16 v[144:147], v[76:79], v[48:51], v[144:147]
    ds_read_b64_tr_b16 v[74:75], v7 offset:29184
    v_mfma_f32_16x16x32_bf16 v[148:151], v[76:79], v[52:55], v[148:151]
    s_waitcnt lgkmcnt(6)
    v_mfma_f32_16x16x32_bf16 v[152:155], v[80:83], v[40:43], v[152:155]
    ds_read_b64_tr_b16 v[76:77], v8 offset:36864
    v_mfma_f32_16x16x32_bf16 v[156:159], v[80:83], v[44:47], v[156:159]
    v_mfma_f32_16x16x32_bf16 v[160:163], v[80:83], v[48:51], v[160:163]
    ds_read_b64_tr_b16 v[78:79], v8 offset:37120
    v_mfma_f32_16x16x32_bf16 v[164:167], v[80:83], v[52:55], v[164:167]
    s_waitcnt lgkmcnt(6)
    v_mfma_f32_16x16x32_bf16 v[168:171], v[64:67], v[40:43], v[168:171]
    ds_read_b64_tr_b16 v[80:81], v8 offset:38912
    v_mfma_f32_16x16x32_bf16 v[172:175], v[64:67], v[44:47], v[172:175]
    v_mfma_f32_16x16x32_bf16 v[176:179], v[64:67], v[48:51], v[176:179]
    ds_read_b64_tr_b16 v[82:83], v8 offset:39168
    v_mfma_f32_16x16x32_bf16 v[180:183], v[64:67], v[52:55], v[180:183]
    s_waitcnt lgkmcnt(6)
    v_mfma_f32_16x16x32_bf16 v[184:187], v[68:71], v[40:43], v[184:187]
    v_add_u32 v14, s80, v16
    v_add_u32 v15, s80, v17
    s_add_u32 s80, s80, 18432
    s_cmp_ge_u32 s80, 153600
    s_cselect_b32 s84, 55296, 0
    s_sub_u32 s80, s80, s84
    v_mfma_f32_16x16x32_bf16 v[188:191], v[68:71], v[44:47], v[188:191]
    v_mfma_f32_16x16x32_bf16 v[192:195], v[68:71], v[48:51], v[192:195]
    v_mfma_f32_16x16x32_bf16 v[196:199], v[68:71], v[52:55], v[196:199]
    s_waitcnt vmcnt(5) lgkmcnt(0)
    s_barrier
    v_mfma_f32_16x16x32_bf16 v[200:203], v[72:75], v[40:43], v[200:203]
    ds_read_b64_tr_b16 v[64:65], v9 offset:0
    v_mfma_f32_16x16x32_bf16 v[204:207], v[72:75], v[44:47], v[204:207]
    ds_read_b64_tr_b16 v[66:67], v9 offset:512
    v_mfma_f32_16x16x32_bf16 v[208:211], v[72:75], v[48:51], v[208:211]
    ds_read_b128 v[24:27], v14 offset:0
    v_mfma_f32_16x16x32_bf16 v[212:215], v[72:75], v[52:55], v[212:215]
    ds_read_b128 v[28:31], v14 offset:2048
    v_mfma_f32_16x16x32_bf16 v[216:219], v[76:79], v[40:43], v[216:219]
    ds_read_b128 v[32:35], v14 offset:4096
    v_mfma_f32_16x16x32_bf16 v[220:223], v[76:79], v[44:47], v[220:223]
    ds_read_b128 v[36:39], v14 offset:6144
    v_mfma_f32_16x16x32_bf16 v[224:227], v[76:79], v[48:51], v[224:227]
    ds_read_b64_tr_b16 v[68:69], v9 offset:8192
    v_mfma_f32_16x16x32_bf16 v[228:231], v[76:79], v[52:55], v[228:231]
    ds_read_b64_tr_b16 v[70:71], v9 offset:8704
    v_mfma_f32_16x16x32_bf16 v[232:235], v[80:83], v[40:43], v[232:235]
    ds_read_b64_tr_b16 v[72:73], v10 offset:0
    v_mfma_f32_16x16x32_bf16 v[236:239], v[80:83], v[44:47], v[236:239]
    v_mfma_f32_16x16x32_bf16 v[240:243], v[80:83], v[48:51], v[240:243]
    ds_read_b64_tr_b16 v[74:75], v10 offset:512
    v_mfma_f32_16x16x32_bf16 v[244:247], v[80:83], v[52:55], v[244:247]
    s_waitcnt lgkmcnt(7)
    v_mfma_f32_16x16x32_bf16 v[88:91], v[64:67], v[24:27], v[88:91]
    ds_read_b64_tr_b16 v[76:77], v10 offset:8192
    s_waitcnt lgkmcnt(7)
    v_mfma_f32_16x16x32_bf16 v[92:95], v[64:67], v[28:31], v[92:95]
    ds_read_b64_tr_b16 v[78:79], v10 offset:8704
    s_waitcnt lgkmcnt(7)
    v_mfma_f32_16x16x32_bf16 v[96:99], v[64:67], v[32:35], v[96:99]
    ds_read_b64_tr_b16 v[80:81], v11 offset:0
    s_waitcnt lgkmcnt(7)
    v_mfma_f32_16x16x32_bf16 v[100:103], v[64:67], v[36:39], v[100:103]
    ds_read_b64_tr_b16 v[82:83], v11 offset:512
    s_waitcnt lgkmcnt(6)
    v_mfma_f32_16x16x32_bf16 v[104:107], v[68:71], v[24:27], v[104:107]
    ds_read_b64_tr_b16 v[64:65], v11 offset:8192
    v_mfma_f32_16x16x32_bf16 v[108:111], v[68:71], v[28:31], v[108:111]
    v_mfma_f32_16x16x32_bf16 v[112:115], v[68:71], v[32:35], v[112:115]
    ds_read_b64_tr_b16 v[66:67], v11 offset:8704
    v_mfma_f32_16x16x32_bf16 v[116:119], v[68:71], v[36:39], v[116:119]
    s_waitcnt lgkmcnt(6)
    v_mfma_f32_16x16x32_bf16 v[120:123], v[72:75], v[24:27], v[120:123]
    ds_read_b64_tr_b16 v[68:69], v12 offset:0
    v_mfma_f32_16x16x32_bf16 v[124:127], v[72:75], v[28:31], v[124:127]
    v_mfma_f32_16x16x32_bf16 v[128:131], v[72:75], v[32:35], v[128:131]
    ds_read_b64_tr_b16 v[70:71], v12 offset:512
    v_mfma_f32_16x16x32_bf16 v[132:135], v[72:75], v[36:39], v[132:135]
    s_waitcnt lgkmcnt(6)
    v_mfma_f32_16x16x32_bf16 v[136:139], v[76:79], v[24:27], v[136:139]
    ds_read_b64_tr_b16 v[72:73], v12 offset:8192
    v_mfma_f32_16x16x32_bf16 v[140:143], v[76:79], v[28:31], v[140:143]
    v_mfma_f32_16x16x32_bf16 v[144:147], v[76:79], v[32:35], v[144:147]
    ds_read_b64_tr_b16 v[74:75], v12 offset:8704
    v_mfma_f32_16x16x32_bf16 v[148:151], v[76:79], v[36:39], v[148:151]
    s_waitcnt lgkmcnt(6)
    v_mfma_f32_16x16x32_bf16 v[152:155], v[80:83], v[24:27], v[152:155]
    ds_read_b64_tr_b16 v[76:77], v13 offset:16384
    v_mfma_f32_16x16x32_bf16 v[156:159], v[80:83], v[28:31], v[156:159]
    v_mfma_f32_16x16x32_bf16 v[160:163], v[80:83], v[32:35], v[160:163]
    ds_read_b64_tr_b16 v[78:79], v13 offset:16640
    v_mfma_f32_16x16x32_bf16 v[164:167], v[80:83], v[36:39], v[164:167]
    s_waitcnt lgkmcnt(6)
    v_mfma_f32_16x16x32_bf16 v[168:171], v[64:67], v[24:27], v[168:171]
    ds_read_b64_tr_b16 v[80:81], v13 offset:18432
    v_mfma_f32_16x16x32_bf16 v[172:175], v[64:67], v[28:31], v[172:175]
    v_mfma_f32_16x16x32_bf16 v[176:179], v[64:67], v[32:35], v[176:179]
    ds_read_b64_tr_b16 v[82:83], v13 offset:18688
    v_mfma_f32_16x16x32_bf16 v[180:183], v[64:67], v[36:39], v[180:183]
    s_waitcnt lgkmcnt(6)
    v_mfma_f32_16x16x32_bf16 v[184:187], v[68:71], v[24:27], v[184:187]
    v_mfma_f32_16x16x32_bf16 v[188:191], v[68:71], v[28:31], v[188:191]
    v_mfma_f32_16x16x32_bf16 v[192:195], v[68:71], v[32:35], v[192:195]
    v_mfma_f32_16x16x32_bf16 v[196:199], v[68:71], v[36:39], v[196:199]
    s_waitcnt vmcnt(0) lgkmcnt(0)
    s_barrier
    v_mfma_f32_16x16x32_bf16 v[200:203], v[72:75], v[24:27], v[200:203]
    ds_read_b64_tr_b16 v[64:65], v9 offset:20480
    v_mfma_f32_16x16x32_bf16 v[204:207], v[72:75], v[28:31], v[204:207]
    ds_read_b64_tr_b16 v[66:67], v9 offset:20992
    v_mfma_f32_16x16x32_bf16 v[208:211], v[72:75], v[32:35], v[208:211]
    ds_read_b128 v[40:43], v15 offset:0
    v_mfma_f32_16x16x32_bf16 v[212:215], v[72:75], v[36:39], v[212:215]
    ds_read_b128 v[44:47], v15 offset:2048
    v_mfma_f32_16x16x32_bf16 v[216:219], v[76:79], v[24:27], v[216:219]
    ds_read_b128 v[48:51], v15 offset:4096
    v_mfma_f32_16x16x32_bf16 v[220:223], v[76:79], v[28:31], v[220:223]
    ds_read_b128 v[52:55], v15 offset:6144
    v_mfma_f32_16x16x32_bf16 v[224:227], v[76:79], v[32:35], v[224:227]
    ds_read_b64_tr_b16 v[68:69], v9 offset:28672
    v_mfma_f32_16x16x32_bf16 v[228:231], v[76:79], v[36:39], v[228:231]
    ds_read_b64_tr_b16 v[70:71], v9 offset:29184
    v_mfma_f32_16x16x32_bf16 v[232:235], v[80:83], v[24:27], v[232:235]
    ds_read_b64_tr_b16 v[72:73], v10 offset:20480
    v_mfma_f32_16x16x32_bf16 v[236:239], v[80:83], v[28:31], v[236:239]
    v_mfma_f32_16x16x32_bf16 v[240:243], v[80:83], v[32:35], v[240:243]
    ds_read_b64_tr_b16 v[74:75], v10 offset:20992
    v_mfma_f32_16x16x32_bf16 v[244:247], v[80:83], v[36:39], v[244:247]
    s_waitcnt lgkmcnt(7)
    v_mfma_f32_16x16x32_bf16 v[88:91], v[64:67], v[40:43], v[88:91]
    ds_read_b64_tr_b16 v[76:77], v10 offset:28672
    s_waitcnt lgkmcnt(7)
    v_mfma_f32_16x16x32_bf16 v[92:95], v[64:67], v[44:47], v[92:95]
    ds_read_b64_tr_b16 v[78:79], v10 offset:29184
    s_waitcnt lgkmcnt(7)
    v_mfma_f32_16x16x32_bf16 v[96:99], v[64:67], v[48:51], v[96:99]
    ds_read_b64_tr_b16 v[80:81], v11 offset:20480
    s_waitcnt lgkmcnt(7)
    v_mfma_f32_16x16x32_bf16 v[100:103], v[64:67], v[52:55], v[100:103]
    ds_read_b64_tr_b16 v[82:83], v11 offset:20992
    s_waitcnt lgkmcnt(6)
    v_mfma_f32_16x16x32_bf16 v[104:107], v[68:71], v[40:43], v[104:107]
    ds_read_b64_tr_b16 v[64:65], v11 offset:28672
    v_mfma_f32_16x16x32_bf16 v[108:111], v[68:71], v[44:47], v[108:111]
    v_mfma_f32_16x16x32_bf16 v[112:115], v[68:71], v[48:51], v[112:115]
    ds_read_b64_tr_b16 v[66:67], v11 offset:29184
    v_mfma_f32_16x16x32_bf16 v[116:119], v[68:71], v[52:55], v[116:119]
    s_waitcnt lgkmcnt(6)
    v_mfma_f32_16x16x32_bf16 v[120:123], v[72:75], v[40:43], v[120:123]
    ds_read_b64_tr_b16 v[68:69], v12 offset:20480
    v_mfma_f32_16x16x32_bf16 v[124:127], v[72:75], v[44:47], v[124:127]
    v_mfma_f32_16x16x32_bf16 v[128:131], v[72:75], v[48:51], v[128:131]
    ds_read_b64_tr_b16 v[70:71], v12 offset:20992
    v_mfma_f32_16x16x32_bf16 v[132:135], v[72:75], v[52:55], v[132:135]
    s_waitcnt lgkmcnt(6)
    v_mfma_f32_16x16x32_bf16 v[136:139], v[76:79], v[40:43], v[136:139]
    ds_read_b64_tr_b16 v[72:73], v12 offset:28672
    v_mfma_f32_16x16x32_bf16 v[140:143], v[76:79], v[44:47], v[140:143]
    v_mfma_f32_16x16x32_bf16 v[144:147], v[76:79], v[48:51], v[144:147]
    ds_read_b64_tr_b16 v[74:75], v12 offset:29184
    v_mfma_f32_16x16x32_bf16 v[148:151], v[76:79], v[52:55], v[148:151]
    s_waitcnt lgkmcnt(6)
    v_mfma_f32_16x16x32_bf16 v[152:155], v[80:83], v[40:43], v[152:155]
    ds_read_b64_tr_b16 v[76:77], v13 offset:36864
    v_mfma_f32_16x16x32_bf16 v[156:159], v[80:83], v[44:47], v[156:159]
    v_mfma_f32_16x16x32_bf16 v[160:163], v[80:83], v[48:51], v[160:163]
    ds_read_b64_tr_b16 v[78:79], v13 offset:37120
    v_mfma_f32_16x16x32_bf16 v[164:167], v[80:83], v[52:55], v[164:167]
    s_waitcnt lgkmcnt(6)
    v_mfma_f32_16x16x32_bf16 v[168:171], v[64:67], v[40:43], v[168:171]
    ds_read_b64_tr_b16 v[80:81], v13 offset:38912
    v_mfma_f32_16x16x32_bf16 v[172:175], v[64:67], v[44:47], v[172:175]
    v_mfma_f32_16x16x32_bf16 v[176:179], v[64:67], v[48:51], v[176:179]
    ds_read_b64_tr_b16 v[82:83], v13 offset:39168
    v_mfma_f32_16x16x32_bf16 v[180:183], v[64:67], v[52:55], v[180:183]
    s_waitcnt lgkmcnt(6)
    v_mfma_f32_16x16x32_bf16 v[184:187], v[68:71], v[40:43], v[184:187]
    v_mfma_f32_16x16x32_bf16 v[188:191], v[68:71], v[44:47], v[188:191]
    v_mfma_f32_16x16x32_bf16 v[192:195], v[68:71], v[48:51], v[192:195]
    v_mfma_f32_16x16x32_bf16 v[196:199], v[68:71], v[52:55], v[196:199]
    s_waitcnt lgkmcnt(0)
    s_barrier
    v_mfma_f32_16x16x32_bf16 v[200:203], v[72:75], v[40:43], v[200:203]
    v_mfma_f32_16x16x32_bf16 v[204:207], v[72:75], v[44:47], v[204:207]
    v_mfma_f32_16x16x32_bf16 v[208:211], v[72:75], v[48:51], v[208:211]
    v_mfma_f32_16x16x32_bf16 v[212:215], v[72:75], v[52:55], v[212:215]
    v_mfma_f32_16x16x32_bf16 v[216:219], v[76:79], v[40:43], v[216:219]
    v_mfma_f32_16x16x32_bf16 v[220:223], v[76:79], v[44:47], v[220:223]
    v_mfma_f32_16x16x32_bf16 v[224:227], v[76:79], v[48:51], v[224:227]
    v_mfma_f32_16x16x32_bf16 v[228:231], v[76:79], v[52:55], v[228:231]
    v_mfma_f32_16x16x32_bf16 v[232:235], v[80:83], v[40:43], v[232:235]
    v_mfma_f32_16x16x32_bf16 v[236:239], v[80:83], v[44:47], v[236:239]
    v_mfma_f32_16x16x32_bf16 v[240:243], v[80:83], v[48:51], v[240:243]
    v_mfma_f32_16x16x32_bf16 v[244:247], v[80:83], v[52:55], v[244:247]
    s_setprio 0
    s_lshl_b32 s84, s28, 7
    s_lshl_b32 s85, s5, 6
    s_add_u32 s84, s84, s85
    s_lshl_b32 s84, s84, 3
    s_add_u32 s84, s84, 0x1e00000
    v_and_b32 v16, 15, v1
    v_lshl_add_u32 v17, v16, 3, s84
    global_load_dwordx2 v[8:9], v17, s[26:27] offset:0 sc1
    global_load_dwordx2 v[10:11], v17, s[26:27] offset:128 sc1
    global_load_dwordx2 v[12:13], v17, s[26:27] offset:256 sc1
    global_load_dwordx2 v[14:15], v17, s[26:27] offset:384 sc1
    s_mul_i32 s84, s29, 20480
    s_add_u32 s84, s84, 0x1e10000
    v_mul_u32_u24 v16, 1280, v16
    v_and_b32 v17, 48, v1
    v_add3_u32 v16, v16, v17, s84
    s_lshl_b32 s85, s6, 8
    v_add_u32 v17, s85, v16
    s_lshl_b32 s85, s6, 6
    v_add_u32 v16, s85, v16
    global_load_dwordx4 v[24:27], v17, s[26:27] offset:0 sc1
    global_load_dwordx4 v[28:31], v17, s[26:27] offset:640 sc1
    global_load_dwordx4 v[32:35], v17, s[26:27] offset:64 sc1
    global_load_dwordx4 v[36:39], v17, s[26:27] offset:704 sc1
    global_load_dwordx4 v[40:43], v17, s[26:27] offset:128 sc1
    global_load_dwordx4 v[44:47], v17, s[26:27] offset:768 sc1
    global_load_dwordx4 v[48:51], v17, s[26:27] offset:192 sc1
    global_load_dwordx4 v[52:55], v17, s[26:27] offset:832 sc1
    global_load_dwordx4 v[56:59], v16, s[26:27] offset:512 sc1
    global_load_dwordx4 v[60:63], v16, s[26:27] offset:1152 sc1
    v_lshrrev_b32 v18, 4, v1
    v_and_b32 v19, 1, v18
    v_lshrrev_b32 v18, 1, v18
    v_lshlrev_b32 v18, 8, v18
    v_lshl_add_u32 v18, v19, 10, v18
    v_and_b32 v19, 15, v1
    v_lshl_add_u32 v4, v19, 4, v18
    s_mul_i32 s84, s28, 112
    s_mul_i32 s85, s29, 5
    s_add_u32 s84, s84, s85
    s_lshl_b32 s84, s84, 13
    s_lshl_b32 s85, s5, 12
    s_add_u32 s84, s84, s85
    s_add_u32 s84, s84, 0x400000
    s_and_b32 s85, s29, 1
    s_lshl1_add_u32 s86, s6, s85
    s_lshl_b32 s86, s86, 13
    s_add_u32 s36, s84, s86
    s_add_u32 s37, s36, 8192
    s_xor_b32 s85, s85, 1
    s_lshl_b32 s85, s85, 15
    s_add_u32 s84, s84, s85
    s_lshl_b32 s85, s6, 9
    s_add_u32 s38, s84, s85
    s_barrier
    v_mov_b32 v5, 0
    global_load_dwordx2 v[6:7], v5, s[24:25] sc1
    s_barrier
    s_waitcnt vmcnt(11)
    v_rcp_f32 v80, v9
    v_sub_f32 v64, 0, v8
    v_mul_f32 v67, v9, v9
    v_fma_f32 v81, -v9, v80, 1.0
    v_fma_f32 v80, v81, v80, v80
    v_mul_f32 v65, 0xc0135761, v80
    v_mul_f32 v81, v80, v80
    v_mul_f32 v81, v81, v80
    v_mul_f32 v66, 0xbdd2d3e8, v81
    v_rcp_f32 v80, v11
    v_sub_f32 v68, 0, v10
    v_mul_f32 v71, v11, v11
    v_fma_f32 v81, -v11, v80, 1.0
    v_fma_f32 v80, v81, v80, v80
    v_mul_f32 v69, 0xc0135761, v80
    v_mul_f32 v81, v80, v80
    v_mul_f32 v81, v81, v80
    v_mul_f32 v70, 0xbdd2d3e8, v81
    v_rcp_f32 v80, v13
    v_sub_f32 v72, 0, v12
    v_mul_f32 v75, v13, v13
    v_fma_f32 v81, -v13, v80, 1.0
    v_fma_f32 v80, v81, v80, v80
    v_mul_f32 v73, 0xc0135761, v80
    v_mul_f32 v81, v80, v80
    v_mul_f32 v81, v81, v80
    v_mul_f32 v74, 0xbdd2d3e8, v81
    v_rcp_f32 v80, v15
    v_sub_f32 v76, 0, v14
    v_mul_f32 v79, v15, v15
    v_fma_f32 v81, -v15, v80, 1.0
    v_fma_f32 v80, v81, v80, v80
    v_mul_f32 v77, 0xc0135761, v80
    v_mul_f32 v81, v80, v80
    v_mul_f32 v81, v81, v80
    v_mul_f32 v78, 0xbdd2d3e8, v81
    s_waitcnt vmcnt(9)
    v_add_f32_dpp v24, v24, v24 row_ror:8 row_mask:0xf bank_mask:0xf
    v_add_f32_dpp v25, v25, v25 row_ror:8 row_mask:0xf bank_mask:0xf
    v_add_f32_dpp v26, v26, v26 row_ror:8 row_mask:0xf bank_mask:0xf
    v_add_f32_dpp v27, v27, v27 row_ror:8 row_mask:0xf bank_mask:0xf
    v_add_f32_dpp v28, v28, v28 row_ror:8 row_mask:0xf bank_mask:0xf
    v_add_f32_dpp v29, v29, v29 row_ror:8 row_mask:0xf bank_mask:0xf
    v_add_f32_dpp v30, v30, v30 row_ror:8 row_mask:0xf bank_mask:0xf
    v_add_f32_dpp v31, v31, v31 row_ror:8 row_mask:0xf bank_mask:0xf
    v_add_f32_dpp v24, v24, v24 row_ror:4 row_mask:0xf bank_mask:0xf
    v_add_f32_dpp v25, v25, v25 row_ror:4 row_mask:0xf bank_mask:0xf
    v_add_f32_dpp v26, v26, v26 row_ror:4 row_mask:0xf bank_mask:0xf
    v_add_f32_dpp v27, v27, v27 row_ror:4 row_mask:0xf bank_mask:0xf
    v_add_f32_dpp v28, v28, v28 row_ror:4 row_mask:0xf bank_mask:0xf
    v_add_f32_dpp v29, v29, v29 row_ror:4 row_mask:0xf bank_mask:0xf
    v_add_f32_dpp v30, v30, v30 row_ror:4 row_mask:0xf bank_mask:0xf
    v_add_f32_dpp v31, v31, v31 row_ror:4 row_mask:0xf bank_mask:0xf
    v_add_f32_dpp v24, v24, v24 row_ror:2 row_mask:0xf bank_mask:0xf
    v_add_f32_dpp v25, v25, v25 row_ror:2 row_mask:0xf bank_mask:0xf
    v_add_f32_dpp v26, v26, v26 row_ror:2 row_mask:0xf bank_mask:0xf
    v_add_f32_dpp v27, v27, v27 row_ror:2 row_mask:0xf bank_mask:0xf
    v_add_f32_dpp v28, v28, v28 row_ror:2 row_mask:0xf bank_mask:0xf
    v_add_f32_dpp v29, v29, v29 row_ror:2 row_mask:0xf bank_mask:0xf
    v_add_f32_dpp v30, v30, v30 row_ror:2 row_mask:0xf bank_mask:0xf
    v_add_f32_dpp v31, v31, v31 row_ror:2 row_mask:0xf bank_mask:0xf
    v_add_f32_dpp v24, v24, v24 row_ror:1 row_mask:0xf bank_mask:0xf
    v_add_f32_dpp v25, v25, v25 row_ror:1 row_mask:0xf bank_mask:0xf
    v_add_f32_dpp v26, v26, v26 row_ror:1 row_mask:0xf bank_mask:0xf
    v_add_f32_dpp v27, v27, v27 row_ror:1 row_mask:0xf bank_mask:0xf
    v_add_f32_dpp v28, v28, v28 row_ror:1 row_mask:0xf bank_mask:0xf
    v_add_f32_dpp v29, v29, v29 row_ror:1 row_mask:0xf bank_mask:0xf
    v_add_f32_dpp v30, v30, v30 row_ror:1 row_mask:0xf bank_mask:0xf
    v_add_f32_dpp v31, v31, v31 row_ror:1 row_mask:0xf bank_mask:0xf
    v_fma_f32 v88, v24, v64, v88
    v_fma_f32 v89, v25, v64, v89
    v_fma_f32 v90, v26, v64, v90
    v_fma_f32 v91, v27, v64, v91
    v_fma_f32 v104, v28, v64, v104
    v_fma_f32 v105, v29, v64, v105
    v_fma_f32 v106, v30, v64, v106
    v_fma_f32 v107, v31, v64, v107
    s_barrier
    v_mul_f32 v80, v88, v88
    v_mul_f32 v81, v89, v89
    v_mul_f32 v82, v90, v90
    v_mul_f32 v83, v91, v91
    v_fma_f32 v80, v80, v66, v65
    v_fma_f32 v81, v81, v66, v65
    v_fma_f32 v82, v82, v66, v65
    v_fma_f32 v83, v83, v66, v65
    v_mul_f32 v80, v80, v88
    v_mul_f32 v81, v81, v89
    v_mul_f32 v82, v82, v90
    v_mul_f32 v83, v83, v91
    v_exp_f32 v80, v80
    v_mul_f32 v88, v88, v104
    v_exp_f32 v81, v81
    v_mul_f32 v89, v89, v105
    v_exp_f32 v82, v82
    v_mul_f32 v90, v90, v106
    v_exp_f32 v83, v83
    v_mul_f32 v91, v91, v107
    v_fma_f32 v80, v80, v67, v67
    v_fma_f32 v81, v81, v67, v67
    v_fma_f32 v82, v82, v67, v67
    v_fma_f32 v83, v83, v67, v67
    v_rcp_f32 v80, v80
    v_rcp_f32 v81, v81
    v_rcp_f32 v82, v82
    v_rcp_f32 v83, v83
    s_nop 0
    v_mul_f32 v88, v88, v80
    v_mul_f32 v89, v89, v81
    v_mul_f32 v90, v90, v82
    v_mul_f32 v91, v91, v83
    v_cvt_pk_bf16_f32 v88, v88, v89
    v_cvt_pk_bf16_f32 v89, v90, v91
    v_fma_f32 v92, v24, v68, v92
    v_fma_f32 v93, v25, v68, v93
    v_fma_f32 v94, v26, v68, v94
    v_fma_f32 v95, v27, v68, v95
    v_fma_f32 v108, v28, v68, v108
    v_fma_f32 v109, v29, v68, v109
    v_fma_f32 v110, v30, v68, v110
    v_fma_f32 v111, v31, v68, v111
    v_mul_f32 v80, v92, v92
    v_mul_f32 v81, v93, v93
    v_mul_f32 v82, v94, v94
    v_mul_f32 v83, v95, v95
    v_fma_f32 v80, v80, v70, v69
    v_fma_f32 v81, v81, v70, v69
    v_fma_f32 v82, v82, v70, v69
    v_fma_f32 v83, v83, v70, v69
    v_mul_f32 v80, v80, v92
    v_mul_f32 v81, v81, v93
    v_mul_f32 v82, v82, v94
    v_mul_f32 v83, v83, v95
    v_exp_f32 v80, v80
    v_mul_f32 v92, v92, v108
    v_exp_f32 v81, v81
    v_mul_f32 v93, v93, v109
    v_exp_f32 v82, v82
    v_mul_f32 v94, v94, v110
    v_exp_f32 v83, v83
    v_mul_f32 v95, v95, v111
    v_fma_f32 v80, v80, v71, v71
    v_fma_f32 v81, v81, v71, v71
    v_fma_f32 v82, v82, v71, v71
    v_fma_f32 v83, v83, v71, v71
    v_rcp_f32 v80, v80
    v_rcp_f32 v81, v81
    v_rcp_f32 v82, v82
    s_barrier
    v_rcp_f32 v83, v83
    s_nop 0
    v_mul_f32 v92, v92, v80
    v_mul_f32 v93, v93, v81
    v_mul_f32 v94, v94, v82
    v_mul_f32 v95, v95, v83
    v_cvt_pk_bf16_f32 v90, v92, v93
    v_cvt_pk_bf16_f32 v91, v94, v95
    s_nop 1
    v_permlane16_swap_b32 v88, v90
    v_permlane16_swap_b32 v89, v91
    buffer_store_dwordx4 v[88:91], v4, s[68:71], s36 offen offset:0 sc1
    v_fma_f32 v96, v24, v72, v96
    v_fma_f32 v97, v25, v72, v97
    v_fma_f32 v98, v26, v72, v98
    v_fma_f32 v99, v27, v72, v99
    v_fma_f32 v112, v28, v72, v112
    v_fma_f32 v113, v29, v72, v113
    v_fma_f32 v114, v30, v72, v114
    v_fma_f32 v115, v31, v72, v115
    v_mul_f32 v80, v96, v96
    v_mul_f32 v81, v97, v97
    v_mul_f32 v82, v98, v98
    v_mul_f32 v83, v99, v99
    v_fma_f32 v80, v80, v74, v73
    v_fma_f32 v81, v81, v74, v73
    v_fma_f32 v82, v82, v74, v73
    v_fma_f32 v83, v83, v74, v73
    v_mul_f32 v80, v80, v96
    v_mul_f32 v81, v81, v97
    v_mul_f32 v82, v82, v98
    v_mul_f32 v83, v83, v99
    v_exp_f32 v80, v80
    v_mul_f32 v96, v96, v112
    v_exp_f32 v81, v81
    v_mul_f32 v97, v97, v113
    v_exp_f32 v82, v82
    v_mul_f32 v98, v98, v114
    v_exp_f32 v83, v83
    v_mul_f32 v99, v99, v115
    v_fma_f32 v80, v80, v75, v75
    v_fma_f32 v81, v81, v75, v75
    v_fma_f32 v82, v82, v75, v75
    v_fma_f32 v83, v83, v75, v75
    v_rcp_f32 v80, v80
    v_rcp_f32 v81, v81
    v_rcp_f32 v82, v82
    v_rcp_f32 v83, v83
    s_nop 0
    v_mul_f32 v96, v96, v80
    v_mul_f32 v97, v97, v81
    v_mul_f32 v98, v98, v82
    v_mul_f32 v99, v99, v83
    v_cvt_pk_bf16_f32 v96, v96, v97
    v_cvt_pk_bf16_f32 v97, v98, v99
    v_fma_f32 v100, v24, v76, v100
    v_fma_f32 v101, v25, v76, v101
    v_fma_f32 v102, v26, v76, v102
    v_fma_f32 v103, v27, v76, v103
    v_fma_f32 v116, v28, v76, v116
    v_fma_f32 v117, v29, v76, v117
    v_fma_f32 v118, v30, v76, v118
    v_fma_f32 v119, v31, v76, v119
    v_mul_f32 v80, v100, v100
    v_mul_f32 v81, v101, v101
    v_mul_f32 v82, v102, v102
    v_mul_f32 v83, v103, v103
    v_fma_f32 v80, v80, v78, v77
    v_fma_f32 v81, v81, v78, v77
    v_fma_f32 v82, v82, v78, v77
    v_fma_f32 v83, v83, v78, v77
    s_barrier
    v_mul_f32 v80, v80, v100
    v_mul_f32 v81, v81, v101
    v_mul_f32 v82, v82, v102
    v_mul_f32 v83, v83, v103
    v_exp_f32 v80, v80
    v_mul_f32 v100, v100, v116
    v_exp_f32 v81, v81
    v_mul_f32 v101, v101, v117
    v_exp_f32 v82, v82
    v_mul_f32 v102, v102, v118
    v_exp_f32 v83, v83
    v_mul_f32 v103, v103, v119
    v_fma_f32 v80, v80, v79, v79
    v_fma_f32 v81, v81, v79, v79
    v_fma_f32 v82, v82, v79, v79
    v_fma_f32 v83, v83, v79, v79
    v_rcp_f32 v80, v80
    v_rcp_f32 v81, v81
    v_rcp_f32 v82, v82
    v_rcp_f32 v83, v83
    s_nop 0
    v_mul_f32 v100, v100, v80
    v_mul_f32 v101, v101, v81
    v_mul_f32 v102, v102, v82
    v_mul_f32 v103, v103, v83
    v_cvt_pk_bf16_f32 v98, v100, v101
    v_cvt_pk_bf16_f32 v99, v102, v103
    s_nop 1
    v_permlane16_swap_b32 v96, v98
    v_permlane16_swap_b32 v97, v99
    buffer_store_dwordx4 v[96:99], v4, s[68:71], s36 offen offset:2048 sc1
    s_waitcnt vmcnt(9)
    v_add_f32_dpp v32, v32, v32 row_ror:8 row_mask:0xf bank_mask:0xf
    v_add_f32_dpp v33, v33, v33 row_ror:8 row_mask:0xf bank_mask:0xf
    v_add_f32_dpp v34, v34, v34 row_ror:8 row_mask:0xf bank_mask:0xf
    v_add_f32_dpp v35, v35, v35 row_ror:8 row_mask:0xf bank_mask:0xf
    v_add_f32_dpp v36, v36, v36 row_ror:8 row_mask:0xf bank_mask:0xf
    v_add_f32_dpp v37, v37, v37 row_ror:8 row_mask:0xf bank_mask:0xf
    v_add_f32_dpp v38, v38, v38 row_ror:8 row_mask:0xf bank_mask:0xf
    v_add_f32_dpp v39, v39, v39 row_ror:8 row_mask:0xf bank_mask:0xf
    v_add_f32_dpp v32, v32, v32 row_ror:4 row_mask:0xf bank_mask:0xf
    v_add_f32_dpp v33, v33, v33 row_ror:4 row_mask:0xf bank_mask:0xf
    v_add_f32_dpp v34, v34, v34 row_ror:4 row_mask:0xf bank_mask:0xf
    v_add_f32_dpp v35, v35, v35 row_ror:4 row_mask:0xf bank_mask:0xf
    v_add_f32_dpp v36, v36, v36 row_ror:4 row_mask:0xf bank_mask:0xf
    v_add_f32_dpp v37, v37, v37 row_ror:4 row_mask:0xf bank_mask:0xf
    v_add_f32_dpp v38, v38, v38 row_ror:4 row_mask:0xf bank_mask:0xf
    v_add_f32_dpp v39, v39, v39 row_ror:4 row_mask:0xf bank_mask:0xf
    v_add_f32_dpp v32, v32, v32 row_ror:2 row_mask:0xf bank_mask:0xf
    v_add_f32_dpp v33, v33, v33 row_ror:2 row_mask:0xf bank_mask:0xf
    v_add_f32_dpp v34, v34, v34 row_ror:2 row_mask:0xf bank_mask:0xf
    v_add_f32_dpp v35, v35, v35 row_ror:2 row_mask:0xf bank_mask:0xf
    v_add_f32_dpp v36, v36, v36 row_ror:2 row_mask:0xf bank_mask:0xf
    v_add_f32_dpp v37, v37, v37 row_ror:2 row_mask:0xf bank_mask:0xf
    v_add_f32_dpp v38, v38, v38 row_ror:2 row_mask:0xf bank_mask:0xf
    v_add_f32_dpp v39, v39, v39 row_ror:2 row_mask:0xf bank_mask:0xf
    v_add_f32_dpp v32, v32, v32 row_ror:1 row_mask:0xf bank_mask:0xf
    v_add_f32_dpp v33, v33, v33 row_ror:1 row_mask:0xf bank_mask:0xf
    v_add_f32_dpp v34, v34, v34 row_ror:1 row_mask:0xf bank_mask:0xf
    v_add_f32_dpp v35, v35, v35 row_ror:1 row_mask:0xf bank_mask:0xf
    v_add_f32_dpp v36, v36, v36 row_ror:1 row_mask:0xf bank_mask:0xf
    v_add_f32_dpp v37, v37, v37 row_ror:1 row_mask:0xf bank_mask:0xf
    v_add_f32_dpp v38, v38, v38 row_ror:1 row_mask:0xf bank_mask:0xf
    v_add_f32_dpp v39, v39, v39 row_ror:1 row_mask:0xf bank_mask:0xf
    v_fma_f32 v120, v32, v64, v120
    v_fma_f32 v121, v33, v64, v121
    v_fma_f32 v122, v34, v64, v122
    v_fma_f32 v123, v35, v64, v123
    v_fma_f32 v136, v36, v64, v136
    v_fma_f32 v137, v37, v64, v137
    v_fma_f32 v138, v38, v64, v138
    v_fma_f32 v139, v39, v64, v139
    s_barrier
    v_mul_f32 v80, v120, v120
    v_mul_f32 v81, v121, v121
    v_mul_f32 v82, v122, v122
    v_mul_f32 v83, v123, v123
    v_fma_f32 v80, v80, v66, v65
    v_fma_f32 v81, v81, v66, v65
    v_fma_f32 v82, v82, v66, v65
    v_fma_f32 v83, v83, v66, v65
    v_mul_f32 v80, v80, v120
    v_mul_f32 v81, v81, v121
    v_mul_f32 v82, v82, v122
    v_mul_f32 v83, v83, v123
    v_exp_f32 v80, v80
    v_mul_f32 v120, v120, v136
    v_exp_f32 v81, v81
    v_mul_f32 v121, v121, v137
    v_exp_f32 v82, v82
    v_mul_f32 v122, v122, v138
    v_exp_f32 v83, v83
    v_mul_f32 v123, v123, v139
    v_fma_f32 v80, v80, v67, v67
    v_fma_f32 v81, v81, v67, v67
    v_fma_f32 v82, v82, v67, v67
    v_fma_f32 v83, v83, v67, v67
    v_rcp_f32 v80, v80
    v_rcp_f32 v81, v81
    v_rcp_f32 v82, v82
    v_rcp_f32 v83, v83
    s_nop 0
    v_mul_f32 v120, v120, v80
    v_mul_f32 v121, v121, v81
    v_mul_f32 v122, v122, v82
    v_mul_f32 v123, v123, v83
    v_cvt_pk_bf16_f32 v120, v120, v121
    v_cvt_pk_bf16_f32 v121, v122, v123
    v_fma_f32 v124, v32, v68, v124
    v_fma_f32 v125, v33, v68, v125
    v_fma_f32 v126, v34, v68, v126
    v_fma_f32 v127, v35, v68, v127
    v_fma_f32 v140, v36, v68, v140
    v_fma_f32 v141, v37, v68, v141
    v_fma_f32 v142, v38, v68, v142
    v_fma_f32 v143, v39, v68, v143
    v_mul_f32 v80, v124, v124
    v_mul_f32 v81, v125, v125
    v_mul_f32 v82, v126, v126
    v_mul_f32 v83, v127, v127
    v_fma_f32 v80, v80, v70, v69
    v_fma_f32 v81, v81, v70, v69
    v_fma_f32 v82, v82, v70, v69
    v_fma_f32 v83, v83, v70, v69
    v_mul_f32 v80, v80, v124
    v_mul_f32 v81, v81, v125
    v_mul_f32 v82, v82, v126
    v_mul_f32 v83, v83, v127
    v_exp_f32 v80, v80
    v_mul_f32 v124, v124, v140
    v_exp_f32 v81, v81
    v_mul_f32 v125, v125, v141
    v_exp_f32 v82, v82
    v_mul_f32 v126, v126, v142
    v_exp_f32 v83, v83
    v_mul_f32 v127, v127, v143
    v_fma_f32 v80, v80, v71, v71
    v_fma_f32 v81, v81, v71, v71
    v_fma_f32 v82, v82, v71, v71
    v_fma_f32 v83, v83, v71, v71
    v_rcp_f32 v80, v80
    v_rcp_f32 v81, v81
    v_rcp_f32 v82, v82
    s_barrier
    v_rcp_f32 v83, v83
    s_nop 0
    v_mul_f32 v124, v124, v80
    v_mul_f32 v125, v125, v81
    v_mul_f32 v126, v126, v82
    v_mul_f32 v127, v127, v83
    v_cvt_pk_bf16_f32 v122, v124, v125
    v_cvt_pk_bf16_f32 v123, v126, v127
    s_nop 1
    v_permlane16_swap_b32 v120, v122
    v_permlane16_swap_b32 v121, v123
    buffer_store_dwordx4 v[120:123], v4, s[68:71], s36 offen offset:512 sc1
    v_fma_f32 v128, v32, v72, v128
    v_fma_f32 v129, v33, v72, v129
    v_fma_f32 v130, v34, v72, v130
    v_fma_f32 v131, v35, v72, v131
    v_fma_f32 v144, v36, v72, v144
    v_fma_f32 v145, v37, v72, v145
    v_fma_f32 v146, v38, v72, v146
    v_fma_f32 v147, v39, v72, v147
    v_mul_f32 v80, v128, v128
    v_mul_f32 v81, v129, v129
    v_mul_f32 v82, v130, v130
    v_mul_f32 v83, v131, v131
    v_fma_f32 v80, v80, v74, v73
    v_fma_f32 v81, v81, v74, v73
    v_fma_f32 v82, v82, v74, v73
    v_fma_f32 v83, v83, v74, v73
    v_mul_f32 v80, v80, v128
    v_mul_f32 v81, v81, v129
    v_mul_f32 v82, v82, v130
    v_mul_f32 v83, v83, v131
    v_exp_f32 v80, v80
    v_mul_f32 v128, v128, v144
    v_exp_f32 v81, v81
    v_mul_f32 v129, v129, v145
    v_exp_f32 v82, v82
    v_mul_f32 v130, v130, v146
    v_exp_f32 v83, v83
    v_mul_f32 v131, v131, v147
    v_fma_f32 v80, v80, v75, v75
    v_fma_f32 v81, v81, v75, v75
    v_fma_f32 v82, v82, v75, v75
    v_fma_f32 v83, v83, v75, v75
    v_rcp_f32 v80, v80
    v_rcp_f32 v81, v81
    v_rcp_f32 v82, v82
    v_rcp_f32 v83, v83
    s_nop 0
    v_mul_f32 v128, v128, v80
    v_mul_f32 v129, v129, v81
    v_mul_f32 v130, v130, v82
    v_mul_f32 v131, v131, v83
    v_cvt_pk_bf16_f32 v128, v128, v129
    v_cvt_pk_bf16_f32 v129, v130, v131
    v_fma_f32 v132, v32, v76, v132
    v_fma_f32 v133, v33, v76, v133
    v_fma_f32 v134, v34, v76, v134
    v_fma_f32 v135, v35, v76, v135
    v_fma_f32 v148, v36, v76, v148
    v_fma_f32 v149, v37, v76, v149
    v_fma_f32 v150, v38, v76, v150
    v_fma_f32 v151, v39, v76, v151
    v_mul_f32 v80, v132, v132
    v_mul_f32 v81, v133, v133
    v_mul_f32 v82, v134, v134
    v_mul_f32 v83, v135, v135
    v_fma_f32 v80, v80, v78, v77
    v_fma_f32 v81, v81, v78, v77
    v_fma_f32 v82, v82, v78, v77
    v_fma_f32 v83, v83, v78, v77
    s_barrier
    s_waitcnt vmcnt(3)
    s_movk_i32 s98, 0x4000
L_tokA_chk:
    v_readfirstlane_b32 s100, v6
    v_readfirstlane_b32 s101, v7
    s_nop 1
    s_cmp_lg_u32 s100, 0
    s_cbranch_scc1 L_tokA_ok
    s_sub_u32 s98, s98, 1
    s_cbranch_scc1 L_tokA_ok
    s_sleep 1
    global_load_dwordx2 v[6:7], v5, s[24:25] sc1
    s_waitcnt vmcnt(0)
    s_branch L_tokA_chk
L_tokA_ok:
    v_mul_f32 v80, v80, v132
    v_mul_f32 v81, v81, v133
    v_mul_f32 v82, v82, v134
    v_mul_f32 v83, v83, v135
    v_exp_f32 v80, v80
    v_mul_f32 v132, v132, v148
    v_exp_f32 v81, v81
    v_mul_f32 v133, v133, v149
    v_exp_f32 v82, v82
    v_mul_f32 v134, v134, v150
    v_exp_f32 v83, v83
    v_mul_f32 v135, v135, v151
    v_fma_f32 v80, v80, v79, v79
    v_fma_f32 v81, v81, v79, v79
    v_fma_f32 v82, v82, v79, v79
    v_fma_f32 v83, v83, v79, v79
    v_rcp_f32 v80, v80
    v_rcp_f32 v81, v81
    v_rcp_f32 v82, v82
    v_rcp_f32 v83, v83
    s_nop 0
    v_mul_f32 v132, v132, v80
    v_mul_f32 v133, v133, v81
    v_mul_f32 v134, v134, v82
    v_mul_f32 v135, v135, v83
    v_cvt_pk_bf16_f32 v130, v132, v133
    v_cvt_pk_bf16_f32 v131, v134, v135
    s_nop 1
    v_permlane16_swap_b32 v128, v130
    v_permlane16_swap_b32 v129, v131
    buffer_store_dwordx4 v[128:131], v4, s[68:71], s36 offen offset:2560 sc1
    s_waitcnt vmcnt(9)
    v_add_f32_dpp v40, v40, v40 row_ror:8 row_mask:0xf bank_mask:0xf
    v_add_f32_dpp v41, v41, v41 row_ror:8 row_mask:0xf bank_mask:0xf
    v_add_f32_dpp v42, v42, v42 row_ror:8 row_mask:0xf bank_mask:0xf
    v_add_f32_dpp v43, v43, v43 row_ror:8 row_mask:0xf bank_mask:0xf
    v_add_f32_dpp v44, v44, v44 row_ror:8 row_mask:0xf bank_mask:0xf
    v_add_f32_dpp v45, v45, v45 row_ror:8 row_mask:0xf bank_mask:0xf
    v_add_f32_dpp v46, v46, v46 row_ror:8 row_mask:0xf bank_mask:0xf
    v_add_f32_dpp v47, v47, v47 row_ror:8 row_mask:0xf bank_mask:0xf
    v_add_f32_dpp v40, v40, v40 row_ror:4 row_mask:0xf bank_mask:0xf
    v_add_f32_dpp v41, v41, v41 row_ror:4 row_mask:0xf bank_mask:0xf
    v_add_f32_dpp v42, v42, v42 row_ror:4 row_mask:0xf bank_mask:0xf
    v_add_f32_dpp v43, v43, v43 row_ror:4 row_mask:0xf bank_mask:0xf
    v_add_f32_dpp v44, v44, v44 row_ror:4 row_mask:0xf bank_mask:0xf
    v_add_f32_dpp v45, v45, v45 row_ror:4 row_mask:0xf bank_mask:0xf
    v_add_f32_dpp v46, v46, v46 row_ror:4 row_mask:0xf bank_mask:0xf
    v_add_f32_dpp v47, v47, v47 row_ror:4 row_mask:0xf bank_mask:0xf
    v_add_f32_dpp v40, v40, v40 row_ror:2 row_mask:0xf bank_mask:0xf
    v_add_f32_dpp v41, v41, v41 row_ror:2 row_mask:0xf bank_mask:0xf
    v_add_f32_dpp v42, v42, v42 row_ror:2 row_mask:0xf bank_mask:0xf
    v_add_f32_dpp v43, v43, v43 row_ror:2 row_mask:0xf bank_mask:0xf
    v_add_f32_dpp v44, v44, v44 row_ror:2 row_mask:0xf bank_mask:0xf
    v_add_f32_dpp v45, v45, v45 row_ror:2 row_mask:0xf bank_mask:0xf
    v_add_f32_dpp v46, v46, v46 row_ror:2 row_mask:0xf bank_mask:0xf
    v_add_f32_dpp v47, v47, v47 row_ror:2 row_mask:0xf bank_mask:0xf
    v_add_f32_dpp v40, v40, v40 row_ror:1 row_mask:0xf bank_mask:0xf
    v_add_f32_dpp v41, v41, v41 row_ror:1 row_mask:0xf bank_mask:0xf
    v_add_f32_dpp v42, v42, v42 row_ror:1 row_mask:0xf bank_mask:0xf
    v_add_f32_dpp v43, v43, v43 row_ror:1 row_mask:0xf bank_mask:0xf
    v_add_f32_dpp v44, v44, v44 row_ror:1 row_mask:0xf bank_mask:0xf
    v_add_f32_dpp v45, v45, v45 row_ror:1 row_mask:0xf bank_mask:0xf
    v_add_f32_dpp v46, v46, v46 row_ror:1 row_mask:0xf bank_mask:0xf
    v_add_f32_dpp v47, v47, v47 row_ror:1 row_mask:0xf bank_mask:0xf
    v_fma_f32 v152, v40, v64, v152
    v_fma_f32 v153, v41, v64, v153
    v_fma_f32 v154, v42, v64, v154
    v_fma_f32 v155, v43, v64, v155
    v_fma_f32 v168, v44, v64, v168
    v_fma_f32 v169, v45, v64, v169
    v_fma_f32 v170, v46, v64, v170
    v_fma_f32 v171, v47, v64, v171
    s_barrier
    v_mul_f32 v80, v152, v152
    v_mul_f32 v81, v153, v153
    v_mul_f32 v82, v154, v154
    v_mul_f32 v83, v155, v155
    v_fma_f32 v80, v80, v66, v65
    v_fma_f32 v81, v81, v66, v65
    v_fma_f32 v82, v82, v66, v65
    v_fma_f32 v83, v83, v66, v65
    v_mul_f32 v80, v80, v152
    v_mul_f32 v81, v81, v153
    v_mul_f32 v82, v82, v154
    v_mul_f32 v83, v83, v155
    v_exp_f32 v80, v80
    v_mul_f32 v152, v152, v168
    v_exp_f32 v81, v81
    v_mul_f32 v153, v153, v169
    v_exp_f32 v82, v82
    v_mul_f32 v154, v154, v170
    v_exp_f32 v83, v83
    v_mul_f32 v155, v155, v171
    v_fma_f32 v80, v80, v67, v67
    v_fma_f32 v81, v81, v67, v67
    v_fma_f32 v82, v82, v67, v67
    v_fma_f32 v83, v83, v67, v67
    v_rcp_f32 v80, v80
    v_rcp_f32 v81, v81
    v_rcp_f32 v82, v82
    v_rcp_f32 v83, v83
    s_nop 0
    v_mul_f32 v152, v152, v80
    v_mul_f32 v153, v153, v81
    v_mul_f32 v154, v154, v82
    v_mul_f32 v155, v155, v83
    v_cvt_pk_bf16_f32 v152, v152, v153
    v_cvt_pk_bf16_f32 v153, v154, v155
    v_fma_f32 v156, v40, v68, v156
    v_fma_f32 v157, v41, v68, v157
    v_fma_f32 v158, v42, v68, v158
    v_fma_f32 v159, v43, v68, v159
    v_fma_f32 v172, v44, v68, v172
    v_fma_f32 v173, v45, v68, v173
    v_fma_f32 v174, v46, v68, v174
    v_fma_f32 v175, v47, v68, v175
    v_mul_f32 v80, v156, v156
    v_mul_f32 v81, v157, v157
    v_mul_f32 v82, v158, v158
    v_mul_f32 v83, v159, v159
    v_fma_f32 v80, v80, v70, v69
    v_fma_f32 v81, v81, v70, v69
    v_fma_f32 v82, v82, v70, v69
    v_fma_f32 v83, v83, v70, v69
    v_mul_f32 v80, v80, v156
    v_mul_f32 v81, v81, v157
    v_mul_f32 v82, v82, v158
    v_mul_f32 v83, v83, v159
    v_exp_f32 v80, v80
    v_mul_f32 v156, v156, v172
    v_exp_f32 v81, v81
    v_mul_f32 v157, v157, v173
    v_exp_f32 v82, v82
    v_mul_f32 v158, v158, v174
    v_exp_f32 v83, v83
    v_mul_f32 v159, v159, v175
    v_fma_f32 v80, v80, v71, v71
    v_fma_f32 v81, v81, v71, v71
    v_fma_f32 v82, v82, v71, v71
    v_fma_f32 v83, v83, v71, v71
    v_rcp_f32 v80, v80
    v_rcp_f32 v81, v81
    v_rcp_f32 v82, v82
    s_barrier
    v_rcp_f32 v83, v83
    s_nop 0
    v_mul_f32 v156, v156, v80
    v_mul_f32 v157, v157, v81
    v_mul_f32 v158, v158, v82
    v_mul_f32 v159, v159, v83
    v_cvt_pk_bf16_f32 v154, v156, v157
    v_cvt_pk_bf16_f32 v155, v158, v159
    s_nop 1
    v_permlane16_swap_b32 v152, v154
    v_permlane16_swap_b32 v153, v155
    buffer_store_dwordx4 v[152:155], v4, s[68:71], s37 offen offset:0 sc1
    v_fma_f32 v160, v40, v72, v160
    v_fma_f32 v161, v41, v72, v161
    v_fma_f32 v162, v42, v72, v162
    v_fma_f32 v163, v43, v72, v163
    v_fma_f32 v176, v44, v72, v176
    v_fma_f32 v177, v45, v72, v177
    v_fma_f32 v178, v46, v72, v178
    v_fma_f32 v179, v47, v72, v179
    v_mul_f32 v80, v160, v160
    v_mul_f32 v81, v161, v161
    v_mul_f32 v82, v162, v162
    v_mul_f32 v83, v163, v163
    v_fma_f32 v80, v80, v74, v73
    v_fma_f32 v81, v81, v74, v73
    v_fma_f32 v82, v82, v74, v73
    v_fma_f32 v83, v83, v74, v73
    v_mul_f32 v80, v80, v160
    v_mul_f32 v81, v81, v161
    v_mul_f32 v82, v82, v162
    v_mul_f32 v83, v83, v163
    v_exp_f32 v80, v80
    v_mul_f32 v160, v160, v176
    v_exp_f32 v81, v81
    v_mul_f32 v161, v161, v177
    v_exp_f32 v82, v82
    v_mul_f32 v162, v162, v178
    v_exp_f32 v83, v83
    v_mul_f32 v163, v163, v179
    v_fma_f32 v80, v80, v75, v75
    v_fma_f32 v81, v81, v75, v75
    v_fma_f32 v82, v82, v75, v75
    v_fma_f32 v83, v83, v75, v75
    v_rcp_f32 v80, v80
    v_rcp_f32 v81, v81
    v_rcp_f32 v82, v82
    v_rcp_f32 v83, v83
    s_nop 0
    v_mul_f32 v160, v160, v80
    v_mul_f32 v161, v161, v81
    v_mul_f32 v162, v162, v82
    v_mul_f32 v163, v163, v83
    v_cvt_pk_bf16_f32 v160, v160, v161
    v_cvt_pk_bf16_f32 v161, v162, v163
    v_fma_f32 v164, v40, v76, v164
    v_fma_f32 v165, v41, v76, v165
    v_fma_f32 v166, v42, v76, v166
    v_fma_f32 v167, v43, v76, v167
    v_fma_f32 v180, v44, v76, v180
    v_fma_f32 v181, v45, v76, v181
    v_fma_f32 v182, v46, v76, v182
    v_fma_f32 v183, v47, v76, v183
    v_mul_f32 v80, v164, v164
    v_mul_f32 v81, v165, v165
    v_mul_f32 v82, v166, v166
    v_mul_f32 v83, v167, v167
    v_fma_f32 v80, v80, v78, v77
    v_fma_f32 v81, v81, v78, v77
    v_fma_f32 v82, v82, v78, v77
    v_fma_f32 v83, v83, v78, v77
    s_barrier
    v_mul_f32 v80, v80, v164
    v_mul_f32 v81, v81, v165
    v_mul_f32 v82, v82, v166
    v_mul_f32 v83, v83, v167
    v_exp_f32 v80, v80
    v_mul_f32 v164, v164, v180
    v_exp_f32 v81, v81
    v_mul_f32 v165, v165, v181
    v_exp_f32 v82, v82
    v_mul_f32 v166, v166, v182
    v_exp_f32 v83, v83
    v_mul_f32 v167, v167, v183
    v_fma_f32 v80, v80, v79, v79
    v_fma_f32 v81, v81, v79, v79
    v_fma_f32 v82, v82, v79, v79
    v_fma_f32 v83, v83, v79, v79
    v_rcp_f32 v80, v80
    v_rcp_f32 v81, v81
    v_rcp_f32 v82, v82
    v_rcp_f32 v83, v83
    s_nop 0
    v_mul_f32 v164, v164, v80
    v_mul_f32 v165, v165, v81
    v_mul_f32 v166, v166, v82
    v_mul_f32 v167, v167, v83
    v_cvt_pk_bf16_f32 v162, v164, v165
    v_cvt_pk_bf16_f32 v163, v166, v167
    s_nop 1
    v_permlane16_swap_b32 v160, v162
    v_permlane16_swap_b32 v161, v163
    buffer_store_dwordx4 v[160:163], v4, s[68:71], s37 offen offset:2048 sc1
    s_waitcnt vmcnt(9)
    v_add_f32_dpp v48, v48, v48 row_ror:8 row_mask:0xf bank_mask:0xf
    v_add_f32_dpp v49, v49, v49 row_ror:8 row_mask:0xf bank_mask:0xf
    v_add_f32_dpp v50, v50, v50 row_ror:8 row_mask:0xf bank_mask:0xf
    v_add_f32_dpp v51, v51, v51 row_ror:8 row_mask:0xf bank_mask:0xf
    v_add_f32_dpp v52, v52, v52 row_ror:8 row_mask:0xf bank_mask:0xf
    v_add_f32_dpp v53, v53, v53 row_ror:8 row_mask:0xf bank_mask:0xf
    v_add_f32_dpp v54, v54, v54 row_ror:8 row_mask:0xf bank_mask:0xf
    v_add_f32_dpp v55, v55, v55 row_ror:8 row_mask:0xf bank_mask:0xf
    v_add_f32_dpp v48, v48, v48 row_ror:4 row_mask:0xf bank_mask:0xf
    v_add_f32_dpp v49, v49, v49 row_ror:4 row_mask:0xf bank_mask:0xf
    v_add_f32_dpp v50, v50, v50 row_ror:4 row_mask:0xf bank_mask:0xf
    v_add_f32_dpp v51, v51, v51 row_ror:4 row_mask:0xf bank_mask:0xf
    v_add_f32_dpp v52, v52, v52 row_ror:4 row_mask:0xf bank_mask:0xf
    v_add_f32_dpp v53, v53, v53 row_ror:4 row_mask:0xf bank_mask:0xf
    v_add_f32_dpp v54, v54, v54 row_ror:4 row_mask:0xf bank_mask:0xf
    v_add_f32_dpp v55, v55, v55 row_ror:4 row_mask:0xf bank_mask:0xf
    v_add_f32_dpp v48, v48, v48 row_ror:2 row_mask:0xf bank_mask:0xf
    v_add_f32_dpp v49, v49, v49 row_ror:2 row_mask:0xf bank_mask:0xf
    v_add_f32_dpp v50, v50, v50 row_ror:2 row_mask:0xf bank_mask:0xf
    v_add_f32_dpp v51, v51, v51 row_ror:2 row_mask:0xf bank_mask:0xf
    v_add_f32_dpp v52, v52, v52 row_ror:2 row_mask:0xf bank_mask:0xf
    v_add_f32_dpp v53, v53, v53 row_ror:2 row_mask:0xf bank_mask:0xf
    v_add_f32_dpp v54, v54, v54 row_ror:2 row_mask:0xf bank_mask:0xf
    v_add_f32_dpp v55, v55, v55 row_ror:2 row_mask:0xf bank_mask:0xf
    v_add_f32_dpp v48, v48, v48 row_ror:1 row_mask:0xf bank_mask:0xf
    v_add_f32_dpp v49, v49, v49 row_ror:1 row_mask:0xf bank_mask:0xf
    v_add_f32_dpp v50, v50, v50 row_ror:1 row_mask:0xf bank_mask:0xf
    v_add_f32_dpp v51, v51, v51 row_ror:1 row_mask:0xf bank_mask:0xf
    v_add_f32_dpp v52, v52, v52 row_ror:1 row_mask:0xf bank_mask:0xf
    v_add_f32_dpp v53, v53, v53 row_ror:1 row_mask:0xf bank_mask:0xf
    v_add_f32_dpp v54, v54, v54 row_ror:1 row_mask:0xf bank_mask:0xf
    v_add_f32_dpp v55, v55, v55 row_ror:1 row_mask:0xf bank_mask:0xf
    v_fma_f32 v184, v48, v64, v184
    v_fma_f32 v185, v49, v64, v185
    v_fma_f32 v186, v50, v64, v186
    v_fma_f32 v187, v51, v64, v187
    v_fma_f32 v200, v52, v64, v200
    v_fma_f32 v201, v53, v64, v201
    v_fma_f32 v202, v54, v64, v202
    v_fma_f32 v203, v55, v64, v203
    s_barrier
    v_mul_f32 v80, v184, v184
    v_mul_f32 v81, v185, v185
    v_mul_f32 v82, v186, v186
    v_mul_f32 v83, v187, v187
    v_fma_f32 v80, v80, v66, v65
    v_fma_f32 v81, v81, v66, v65
    v_fma_f32 v82, v82, v66, v65
    v_fma_f32 v83, v83, v66, v65
    v_mul_f32 v80, v80, v184
    v_mul_f32 v81, v81, v185
    v_mul_f32 v82, v82, v186
    v_mul_f32 v83, v83, v187
    v_exp_f32 v80, v80
    v_mul_f32 v184, v184, v200
    v_exp_f32 v81, v81
    v_mul_f32 v185, v185, v201
    v_exp_f32 v82, v82
    v_mul_f32 v186, v186, v202
    v_exp_f32 v83, v83
    v_mul_f32 v187, v187, v203
    v_fma_f32 v80, v80, v67, v67
    v_fma_f32 v81, v81, v67, v67
    v_fma_f32 v82, v82, v67, v67
    v_fma_f32 v83, v83, v67, v67
    v_rcp_f32 v80, v80
    v_rcp_f32 v81, v81
    v_rcp_f32 v82, v82
    v_rcp_f32 v83, v83
    s_nop 0
    v_mul_f32 v184, v184, v80
    v_mul_f32 v185, v185, v81
    v_mul_f32 v186, v186, v82
    v_mul_f32 v187, v187, v83
    v_cvt_pk_bf16_f32 v184, v184, v185
    v_cvt_pk_bf16_f32 v185, v186, v187
    v_fma_f32 v188, v48, v68, v188
    v_fma_f32 v189, v49, v68, v189
    v_fma_f32 v190, v50, v68, v190
    v_fma_f32 v191, v51, v68, v191
    v_fma_f32 v204, v52, v68, v204
    v_fma_f32 v205, v53, v68, v205
    v_fma_f32 v206, v54, v68, v206
    v_fma_f32 v207, v55, v68, v207
    v_mul_f32 v80, v188, v188
    v_mul_f32 v81, v189, v189
    v_mul_f32 v82, v190, v190
    v_mul_f32 v83, v191, v191
    v_fma_f32 v80, v80, v70, v69
    v_fma_f32 v81, v81, v70, v69
    v_fma_f32 v82, v82, v70, v69
    v_fma_f32 v83, v83, v70, v69
    v_mul_f32 v80, v80, v188
    v_mul_f32 v81, v81, v189
    v_mul_f32 v82, v82, v190
    v_mul_f32 v83, v83, v191
    v_exp_f32 v80, v80
    v_mul_f32 v188, v188, v204
    v_exp_f32 v81, v81
    v_mul_f32 v189, v189, v205
    v_exp_f32 v82, v82
    v_mul_f32 v190, v190, v206
    v_exp_f32 v83, v83
    v_mul_f32 v191, v191, v207
    v_fma_f32 v80, v80, v71, v71
    v_fma_f32 v81, v81, v71, v71
    v_fma_f32 v82, v82, v71, v71
    v_fma_f32 v83, v83, v71, v71
    v_rcp_f32 v80, v80
    v_rcp_f32 v81, v81
    v_rcp_f32 v82, v82
    s_barrier
    v_rcp_f32 v83, v83
    s_nop 0
    v_mul_f32 v188, v188, v80
    v_mul_f32 v189, v189, v81
    v_mul_f32 v190, v190, v82
    v_mul_f32 v191, v191, v83
    v_cvt_pk_bf16_f32 v186, v188, v189
    v_cvt_pk_bf16_f32 v187, v190, v191
    s_nop 1
    v_permlane16_swap_b32 v184, v186
    v_permlane16_swap_b32 v185, v187
    buffer_store_dwordx4 v[184:187], v4, s[68:71], s37 offen offset:512 sc1
    v_fma_f32 v192, v48, v72, v192
    v_fma_f32 v193, v49, v72, v193
    v_fma_f32 v194, v50, v72, v194
    v_fma_f32 v195, v51, v72, v195
    v_fma_f32 v208, v52, v72, v208
    v_fma_f32 v209, v53, v72, v209
    v_fma_f32 v210, v54, v72, v210
    v_fma_f32 v211, v55, v72, v211
    v_mul_f32 v80, v192, v192
    v_mul_f32 v81, v193, v193
    v_mul_f32 v82, v194, v194
    v_mul_f32 v83, v195, v195
    v_fma_f32 v80, v80, v74, v73
    v_fma_f32 v81, v81, v74, v73
    v_fma_f32 v82, v82, v74, v73
    v_fma_f32 v83, v83, v74, v73
    v_mul_f32 v80, v80, v192
    v_mul_f32 v81, v81, v193
    v_mul_f32 v82, v82, v194
    v_mul_f32 v83, v83, v195
    v_exp_f32 v80, v80
    v_mul_f32 v192, v192, v208
    v_exp_f32 v81, v81
    v_mul_f32 v193, v193, v209
    v_exp_f32 v82, v82
    v_mul_f32 v194, v194, v210
    v_exp_f32 v83, v83
    v_mul_f32 v195, v195, v211
    v_fma_f32 v80, v80, v75, v75
    v_fma_f32 v81, v81, v75, v75
    v_fma_f32 v82, v82, v75, v75
    v_fma_f32 v83, v83, v75, v75
    v_rcp_f32 v80, v80
    v_rcp_f32 v81, v81
    v_rcp_f32 v82, v82
    v_rcp_f32 v83, v83
    s_nop 0
    v_mul_f32 v192, v192, v80
    v_mul_f32 v193, v193, v81
    v_mul_f32 v194, v194, v82
    v_mul_f32 v195, v195, v83
    v_cvt_pk_bf16_f32 v192, v192, v193
    v_cvt_pk_bf16_f32 v193, v194, v195
    v_fma_f32 v196, v48, v76, v196
    v_fma_f32 v197, v49, v76, v197
    v_fma_f32 v198, v50, v76, v198
    v_fma_f32 v199, v51, v76, v199
    v_fma_f32 v212, v52, v76, v212
    v_fma_f32 v213, v53, v76, v213
    v_fma_f32 v214, v54, v76, v214
    v_fma_f32 v215, v55, v76, v215
    v_mul_f32 v80, v196, v196
    v_mul_f32 v81, v197, v197
    v_mul_f32 v82, v198, v198
    v_mul_f32 v83, v199, v199
    v_fma_f32 v80, v80, v78, v77
    v_fma_f32 v81, v81, v78, v77
    v_fma_f32 v82, v82, v78, v77
    v_fma_f32 v83, v83, v78, v77
    s_barrier
    v_mul_f32 v80, v80, v196
    v_mul_f32 v81, v81, v197
    v_mul_f32 v82, v82, v198
    v_mul_f32 v83, v83, v199
    v_exp_f32 v80, v80
    v_mul_f32 v196, v196, v212
    v_exp_f32 v81, v81
    v_mul_f32 v197, v197, v213
    v_exp_f32 v82, v82
    v_mul_f32 v198, v198, v214
    v_exp_f32 v83, v83
    v_mul_f32 v199, v199, v215
    v_fma_f32 v80, v80, v79, v79
    v_fma_f32 v81, v81, v79, v79
    v_fma_f32 v82, v82, v79, v79
    v_fma_f32 v83, v83, v79, v79
    v_rcp_f32 v80, v80
    v_rcp_f32 v81, v81
    v_rcp_f32 v82, v82
    v_rcp_f32 v83, v83
    s_nop 0
    v_mul_f32 v196, v196, v80
    v_mul_f32 v197, v197, v81
    v_mul_f32 v198, v198, v82
    v_mul_f32 v199, v199, v83
    v_cvt_pk_bf16_f32 v194, v196, v197
    v_cvt_pk_bf16_f32 v195, v198, v199
    s_nop 1
    v_permlane16_swap_b32 v192, v194
    v_permlane16_swap_b32 v193, v195
    buffer_store_dwordx4 v[192:195], v4, s[68:71], s37 offen offset:2560 sc1
    s_waitcnt vmcnt(9)
    v_add_f32_dpp v56, v56, v56 row_ror:8 row_mask:0xf bank_mask:0xf
    v_add_f32_dpp v57, v57, v57 row_ror:8 row_mask:0xf bank_mask:0xf
    v_add_f32_dpp v58, v58, v58 row_ror:8 row_mask:0xf bank_mask:0xf
    v_add_f32_dpp v59, v59, v59 row_ror:8 row_mask:0xf bank_mask:0xf
    v_add_f32_dpp v60, v60, v60 row_ror:8 row_mask:0xf bank_mask:0xf
    v_add_f32_dpp v61, v61, v61 row_ror:8 row_mask:0xf bank_mask:0xf
    v_add_f32_dpp v62, v62, v62 row_ror:8 row_mask:0xf bank_mask:0xf
    v_add_f32_dpp v63, v63, v63 row_ror:8 row_mask:0xf bank_mask:0xf
    v_add_f32_dpp v56, v56, v56 row_ror:4 row_mask:0xf bank_mask:0xf
    v_add_f32_dpp v57, v57, v57 row_ror:4 row_mask:0xf bank_mask:0xf
    v_add_f32_dpp v58, v58, v58 row_ror:4 row_mask:0xf bank_mask:0xf
    v_add_f32_dpp v59, v59, v59 row_ror:4 row_mask:0xf bank_mask:0xf
    v_add_f32_dpp v60, v60, v60 row_ror:4 row_mask:0xf bank_mask:0xf
    v_add_f32_dpp v61, v61, v61 row_ror:4 row_mask:0xf bank_mask:0xf
    v_add_f32_dpp v62, v62, v62 row_ror:4 row_mask:0xf bank_mask:0xf
    v_add_f32_dpp v63, v63, v63 row_ror:4 row_mask:0xf bank_mask:0xf
    v_add_f32_dpp v56, v56, v56 row_ror:2 row_mask:0xf bank_mask:0xf
    v_add_f32_dpp v57, v57, v57 row_ror:2 row_mask:0xf bank_mask:0xf
    v_add_f32_dpp v58, v58, v58 row_ror:2 row_mask:0xf bank_mask:0xf
    v_add_f32_dpp v59, v59, v59 row_ror:2 row_mask:0xf bank_mask:0xf
    v_add_f32_dpp v60, v60, v60 row_ror:2 row_mask:0xf bank_mask:0xf
    v_add_f32_dpp v61, v61, v61 row_ror:2 row_mask:0xf bank_mask:0xf
    v_add_f32_dpp v62, v62, v62 row_ror:2 row_mask:0xf bank_mask:0xf
    v_add_f32_dpp v63, v63, v63 row_ror:2 row_mask:0xf bank_mask:0xf
    v_add_f32_dpp v56, v56, v56 row_ror:1 row_mask:0xf bank_mask:0xf
    v_add_f32_dpp v57, v57, v57 row_ror:1 row_mask:0xf bank_mask:0xf
    v_add_f32_dpp v58, v58, v58 row_ror:1 row_mask:0xf bank_mask:0xf
    v_add_f32_dpp v59, v59, v59 row_ror:1 row_mask:0xf bank_mask:0xf
    v_add_f32_dpp v60, v60, v60 row_ror:1 row_mask:0xf bank_mask:0xf
    v_add_f32_dpp v61, v61, v61 row_ror:1 row_mask:0xf bank_mask:0xf
    v_add_f32_dpp v62, v62, v62 row_ror:1 row_mask:0xf bank_mask:0xf
    v_add_f32_dpp v63, v63, v63 row_ror:1 row_mask:0xf bank_mask:0xf
    v_fma_f32 v216, v56, v64, v216
    v_fma_f32 v217, v57, v64, v217
    v_fma_f32 v218, v58, v64, v218
    v_fma_f32 v219, v59, v64, v219
    v_fma_f32 v232, v60, v64, v232
    v_fma_f32 v233, v61, v64, v233
    v_fma_f32 v234, v62, v64, v234
    v_fma_f32 v235, v63, v64, v235
    s_barrier
    v_mul_f32 v80, v216, v216
    v_mul_f32 v81, v217, v217
    v_mul_f32 v82, v218, v218
    v_mul_f32 v83, v219, v219
    v_fma_f32 v80, v80, v66, v65
    v_fma_f32 v81, v81, v66, v65
    v_fma_f32 v82, v82, v66, v65
    v_fma_f32 v83, v83, v66, v65
    v_mul_f32 v80, v80, v216
    v_mul_f32 v81, v81, v217
    v_mul_f32 v82, v82, v218
    v_mul_f32 v83, v83, v219
    v_exp_f32 v80, v80
    v_mul_f32 v216, v216, v232
    v_exp_f32 v81, v81
    v_mul_f32 v217, v217, v233
    v_exp_f32 v82, v82
    v_mul_f32 v218, v218, v234
    v_exp_f32 v83, v83
    v_mul_f32 v219, v219, v235
    v_fma_f32 v80, v80, v67, v67
    v_fma_f32 v81, v81, v67, v67
    v_fma_f32 v82, v82, v67, v67
    v_fma_f32 v83, v83, v67, v67
    v_rcp_f32 v80, v80
    v_rcp_f32 v81, v81
    v_rcp_f32 v82, v82
    v_rcp_f32 v83, v83
    s_nop 0
    v_mul_f32 v216, v216, v80
    v_mul_f32 v217, v217, v81
    v_mul_f32 v218, v218, v82
    v_mul_f32 v219, v219, v83
    v_cvt_pk_bf16_f32 v216, v216, v217
    v_cvt_pk_bf16_f32 v217, v218, v219
    v_fma_f32 v220, v56, v68, v220
    v_fma_f32 v221, v57, v68, v221
    v_fma_f32 v222, v58, v68, v222
    v_fma_f32 v223, v59, v68, v223
    v_fma_f32 v236, v60, v68, v236
    v_fma_f32 v237, v61, v68, v237
    v_fma_f32 v238, v62, v68, v238
    v_fma_f32 v239, v63, v68, v239
    v_mul_f32 v80, v220, v220
    v_mul_f32 v81, v221, v221
    v_mul_f32 v82, v222, v222
    v_mul_f32 v83, v223, v223
    v_fma_f32 v80, v80, v70, v69
    v_fma_f32 v81, v81, v70, v69
    v_fma_f32 v82, v82, v70, v69
    v_fma_f32 v83, v83, v70, v69
    v_mul_f32 v80, v80, v220
    v_mul_f32 v81, v81, v221
    v_mul_f32 v82, v82, v222
    v_mul_f32 v83, v83, v223
    v_exp_f32 v80, v80
    v_mul_f32 v220, v220, v236
    v_exp_f32 v81, v81
    v_mul_f32 v221, v221, v237
    v_exp_f32 v82, v82
    v_mul_f32 v222, v222, v238
    v_exp_f32 v83, v83
    v_mul_f32 v223, v223, v239
    v_fma_f32 v80, v80, v71, v71
    v_fma_f32 v81, v81, v71, v71
    v_fma_f32 v82, v82, v71, v71
    v_fma_f32 v83, v83, v71, v71
    v_rcp_f32 v80, v80
    v_rcp_f32 v81, v81
    v_rcp_f32 v82, v82
    s_barrier
    v_rcp_f32 v83, v83
    s_nop 0
    v_mul_f32 v220, v220, v80
    v_mul_f32 v221, v221, v81
    v_mul_f32 v222, v222, v82
    v_mul_f32 v223, v223, v83
    v_cvt_pk_bf16_f32 v218, v220, v221
    v_cvt_pk_bf16_f32 v219, v222, v223
    s_nop 1
    v_permlane16_swap_b32 v216, v218
    v_permlane16_swap_b32 v217, v219
    buffer_store_dwordx4 v[216:219], v4, s[68:71], s38 offen offset:0 sc1
    v_fma_f32 v224, v56, v72, v224
    v_fma_f32 v225, v57, v72, v225
    v_fma_f32 v226, v58, v72, v226
    v_fma_f32 v227, v59, v72, v227
    v_fma_f32 v240, v60, v72, v240
    v_fma_f32 v241, v61, v72, v241
    v_fma_f32 v242, v62, v72, v242
    v_fma_f32 v243, v63, v72, v243
    v_mul_f32 v80, v224, v224
    v_mul_f32 v81, v225, v225
    v_mul_f32 v82, v226, v226
    v_mul_f32 v83, v227, v227
    v_fma_f32 v80, v80, v74, v73
    v_fma_f32 v81, v81, v74, v73
    v_fma_f32 v82, v82, v74, v73
    v_fma_f32 v83, v83, v74, v73
    v_mul_f32 v80, v80, v224
    v_mul_f32 v81, v81, v225
    v_mul_f32 v82, v82, v226
    v_mul_f32 v83, v83, v227
    v_exp_f32 v80, v80
    v_mul_f32 v224, v224, v240
    v_exp_f32 v81, v81
    v_mul_f32 v225, v225, v241
    v_exp_f32 v82, v82
    v_mul_f32 v226, v226, v242
    v_exp_f32 v83, v83
    v_mul_f32 v227, v227, v243
    v_fma_f32 v80, v80, v75, v75
    v_fma_f32 v81, v81, v75, v75
    v_fma_f32 v82, v82, v75, v75
    v_fma_f32 v83, v83, v75, v75
    v_rcp_f32 v80, v80
    v_rcp_f32 v81, v81
    v_rcp_f32 v82, v82
    v_rcp_f32 v83, v83
    s_nop 0
    v_mul_f32 v224, v224, v80
    v_mul_f32 v225, v225, v81
    v_mul_f32 v226, v226, v82
    v_mul_f32 v227, v227, v83
    v_cvt_pk_bf16_f32 v224, v224, v225
    v_cvt_pk_bf16_f32 v225, v226, v227
    v_fma_f32 v228, v56, v76, v228
    v_fma_f32 v229, v57, v76, v229
    v_fma_f32 v230, v58, v76, v230
    v_fma_f32 v231, v59, v76, v231
    v_fma_f32 v244, v60, v76, v244
    v_fma_f32 v245, v61, v76, v245
    v_fma_f32 v246, v62, v76, v246
    v_fma_f32 v247, v63, v76, v247
    v_mul_f32 v80, v228, v228
    v_mul_f32 v81, v229, v229
    v_mul_f32 v82, v230, v230
    v_mul_f32 v83, v231, v231
    v_fma_f32 v80, v80, v78, v77
    v_fma_f32 v81, v81, v78, v77
    v_fma_f32 v82, v82, v78, v77
    v_fma_f32 v83, v83, v78, v77
    s_barrier
    v_mul_f32 v80, v80, v228
    v_mul_f32 v81, v81, v229
    v_mul_f32 v82, v82, v230
    v_mul_f32 v83, v83, v231
    v_exp_f32 v80, v80
    v_mul_f32 v228, v228, v244
    v_exp_f32 v81, v81
    v_mul_f32 v229, v229, v245
    v_exp_f32 v82, v82
    v_mul_f32 v230, v230, v246
    v_exp_f32 v83, v83
    v_mul_f32 v231, v231, v247
    v_fma_f32 v80, v80, v79, v79
    v_fma_f32 v81, v81, v79, v79
    v_fma_f32 v82, v82, v79, v79
    v_fma_f32 v83, v83, v79, v79
    v_rcp_f32 v80, v80
    v_rcp_f32 v81, v81
    v_rcp_f32 v82, v82
    v_rcp_f32 v83, v83
    s_nop 0
    v_mul_f32 v228, v228, v80
    v_mul_f32 v229, v229, v81
    v_mul_f32 v230, v230, v82
    v_mul_f32 v231, v231, v83
    v_cvt_pk_bf16_f32 v226, v228, v229
    v_cvt_pk_bf16_f32 v227, v230, v231
    s_nop 1
    v_permlane16_swap_b32 v224, v226
    v_permlane16_swap_b32 v225, v227
    buffer_store_dwordx4 v[224:227], v4, s[68:71], s38 offen offset:2048 sc1
    s_barrier
    s_barrier
    s_barrier
    s_barrier
    s_barrier
    s_barrier
    s_waitcnt vmcnt(0)
    s_barrier
    s_cmp_lg_u32 s4, 0
    s_cbranch_scc1 L_fH1
    s_lshl_b32 s84, s28, 4
    s_add_u32 s84, s84, s29
    s_lshl_b32 s84, s84, 7
    s_add_u32 s84, s84, 0x1e88000
    v_mov_b32 v16, s84
    v_mov_b32 v18, s100
    v_mov_b32 v19, s101
    s_mov_b64 exec, 1
    global_store_dwordx2 v16, v[18:19], s[26:27] sc1
    s_mov_b64 exec, -1
L_fH1:
    s_barrier
    v_mov_b32 v88, 0
    v_mov_b32 v89, 0
    v_mov_b32 v90, 0
    v_mov_b32 v91, 0
    v_mov_b32 v92, 0
    v_mov_b32 v93, 0
    v_mov_b32 v94, 0
    v_mov_b32 v95, 0
    v_mov_b32 v96, 0
    v_mov_b32 v97, 0
    v_mov_b32 v98, 0
    v_mov_b32 v99, 0
    v_mov_b32 v100, 0
    v_mov_b32 v101, 0
    v_mov_b32 v102, 0
    v_mov_b32 v103, 0
    v_mov_b32 v104, 0
    v_mov_b32 v105, 0
    v_mov_b32 v106, 0
    v_mov_b32 v107, 0
    v_mov_b32 v108, 0
    v_mov_b32 v109, 0
    v_mov_b32 v110, 0
    v_mov_b32 v111, 0
    v_mov_b32 v112, 0
    v_mov_b32 v113, 0
    v_mov_b32 v114, 0
    v_mov_b32 v115, 0
    v_mov_b32 v116, 0
    v_mov_b32 v117, 0
    v_mov_b32 v118, 0
    v_mov_b32 v119, 0
    v_mov_b32 v120, 0
    v_mov_b32 v121, 0
    v_mov_b32 v122, 0
    v_mov_b32 v123, 0
    v_mov_b32 v124, 0
    v_mov_b32 v125, 0
    v_mov_b32 v126, 0
    v_mov_b32 v127, 0
    v_mov_b32 v128, 0
    v_mov_b32 v129, 0
    v_mov_b32 v130, 0
    v_mov_b32 v131, 0
    v_mov_b32 v132, 0
    v_mov_b32 v133, 0
    v_mov_b32 v134, 0
    v_mov_b32 v135, 0
    v_mov_b32 v136, 0
    v_mov_b32 v137, 0
    v_mov_b32 v138, 0
    v_mov_b32 v139, 0
    v_mov_b32 v140, 0
    v_mov_b32 v141, 0
    v_mov_b32 v142, 0
    v_mov_b32 v143, 0
    v_mov_b32 v144, 0
    v_mov_b32 v145, 0
    v_mov_b32 v146, 0
    v_mov_b32 v147, 0
    v_mov_b32 v148, 0
    v_mov_b32 v149, 0
    v_mov_b32 v150, 0
    v_mov_b32 v151, 0
    s_barrier
    v_and_b32 v13, 15, v1
    s_lshl_b32 s84, s30, 11
    s_add_u32 s84, s84, 0x1e88000
    v_lshl_add_u32 v13, v13, 7, s84
    global_load_dwordx2 v[14:15], v13, s[26:27] sc1
    s_barrier
    v_lshrrev_b32 v64, 4, v1
    v_bfe_u32 v65, v1, 2, 2
    v_and_b32 v66, 3, v1
    v_and_b32 v67, 15, v1
    v_lshrrev_b32 v68, 3, v1
    v_and_b32 v69, 7, v1
    s_lshl_b32 s85, s6, 2
    v_lshl_add_u32 v70, v64, 3, v65
    v_lshlrev_b32 v70, 7, v70
    v_and_b32 v71, 1, v66
    v_lshl_add_u32 v70, v71, 3, v70
    v_add_u32 v70, 0, v70
    v_and_b32 v71, 2, v65
    v_and_b32 v72, 1, v64
    v_lshl_add_u32 v71, v72, 2, v71
    v_lshrrev_b32 v72, 1, v66
    v_xor_b32 v71, v71, v72
    v_xor_b32 v71, s85, v71
    v_xor_b32 v72, 0, v71
    v_lshl_add_u32 v6, v72, 4, v70
    v_add_u32 v8, 65536, v6
    v_xor_b32 v72, 2, v71
    v_lshl_add_u32 v7, v72, 4, v70
    v_add_u32 v9, 65536, v7
    s_lshl_b32 s85, s5, 12
    v_lshl_add_u32 v4, v1, 4, s85
    v_add_u32 v5, 65536, v4
    s_lshl_b32 s85, s4, 12
    v_lshl_add_u32 v10, v1, 4, s85
    s_lshl_b32 s85, s4, 4
    v_and_b32 v70, 2, v68
    v_xor_b32 v70, v70, v69
    v_xor_b32 v70, 0, v70
    v_add_u32 v71, s85, v68
    v_mul_u32_u24 v71, 2048, v71
    v_lshl_add_u32 v11, v70, 4, v71
    s_add_u32 s85, s85, 8
    v_and_b32 v70, 2, v68
    v_xor_b32 v70, v70, v69
    v_xor_b32 v70, 4, v70
    v_add_u32 v71, s85, v68
    v_mul_u32_u24 v71, 2048, v71
    v_lshl_add_u32 v12, v70, 4, v71
    s_lshl_b32 s85, s31, 8
    s_lshl_b32 s86, s32, 7
    s_add_u32 s86, s85, s86
    s_xor_b32 s87, s86, 128
    s_add_u32 s60, s20, s86
    s_addc_u32 s61, s21, 0
    s_sub_u32 s62, 7340032, s86
    s_mov_b32 s63, 0x20000
    s_add_u32 s64, s20, s87
    s_addc_u32 s65, s21, 0
    s_sub_u32 s66, 7340032, s87
    s_mov_b32 s67, 0x20000
    s_add_u32 s56, s26, 0x400000
    s_addc_u32 s57, s27, 0
    s_mov_b32 s58, 0xe00000
    s_mov_b32 s59, 0x20000
    s_mul_i32 s82, s30, 917504
    s_mul_i32 s85, s32, 327680
    s_add_u32 s82, s82, s85
    s_mul_i32 s83, s32, 2621440
    s_mul_i32 s85, s32, 24
    s_sub_u32 s85, 40, s85
    s_lshl_b32 s93, s85, 13
    s_lshl_b32 s94, s85, 16
    s_add_u32 s94, s94, 131072
    s_barrier
    s_waitcnt vmcnt(0)
    s_movk_i32 s98, 0x4000
L_pH1_chk:
    v_cmp_ne_u64 vcc, s[100:101], v[14:15]
    s_nop 1
    s_cmp_eq_u64 vcc, 0
    s_cbranch_scc1 L_pH1_ok
    s_sub_u32 s98, s98, 1
    s_cbranch_scc1 L_pH1_ok
    s_sleep 1
    global_load_dwordx2 v[14:15], v13, s[26:27] sc1
    s_waitcnt vmcnt(0)
    s_branch L_pH1_chk
L_pH1_ok:
    s_barrier
    s_lshl_b32 m0, s33, 2
    s_nop 0
    buffer_load_dwordx4 v10, s[56:59], s82 offen offset:0 sc1 lds
    s_nop 0
    buffer_load_dwordx4 v10, s[56:59], s82 offen offset:1024 sc1 lds
    s_nop 0
    buffer_load_dwordx4 v10, s[56:59], s82 offen offset:2048 sc1 lds
    s_nop 0
    buffer_load_dwordx4 v10, s[56:59], s82 offen offset:3072 sc1 lds
    s_add_u32 s82, s82, 16384
    s_lshl1_add_u32 m0, s33, 16384
    s_nop 0
    buffer_load_dwordx4 v11, s[60:63], s83 offen lds
    s_lshl1_add_u32 m0, s33, 17408
    s_nop 0
    buffer_load_dwordx4 v12, s[60:63], s83 offen lds
    s_lshl1_add_u32 m0, s33, 24576
    s_nop 0
    buffer_load_dwordx4 v11, s[64:67], s83 offen lds
    s_lshl1_add_u32 m0, s33, 25600
    s_nop 0
    buffer_load_dwordx4 v12, s[64:67], s83 offen lds
    s_add_u32 s83, s83, 131072
    s_barrier
    s_lshl2_add_u32 m0, s33, 98304
    s_nop 0
    buffer_load_dwordx4 v10, s[56:59], s82 offen offset:0 sc1 lds
    s_nop 0
    buffer_load_dwordx4 v10, s[56:59], s82 offen offset:1024 sc1 lds
    s_nop 0
    buffer_load_dwordx4 v10, s[56:59], s82 offen offset:2048 sc1 lds
    s_nop 0
    buffer_load_dwordx4 v10, s[56:59], s82 offen offset:3072 sc1 lds
    s_add_u32 s82, s82, 16384
    s_lshl1_add_u32 m0, s33, 114688
    s_nop 0
    buffer_load_dwordx4 v11, s[60:63], s83 offen lds
    s_lshl1_add_u32 m0, s33, 115712
    s_nop 0
    buffer_load_dwordx4 v12, s[60:63], s83 offen lds
    s_lshl1_add_u32 m0, s33, 122880
    s_nop 0
    buffer_load_dwordx4 v11, s[64:67], s83 offen lds
    s_lshl1_add_u32 m0, s33, 123904
    s_nop 0
    buffer_load_dwordx4 v12, s[64:67], s83 offen lds
    s_add_u32 s83, s83, 131072
    s_barrier
    s_lshl2_add_u32 m0, s33, 32768
    s_nop 0
    buffer_load_dwordx4 v10, s[56:59], s82 offen offset:0 sc1 lds
    s_nop 0
    buffer_load_dwordx4 v10, s[56:59], s82 offen offset:1024 sc1 lds
    s_nop 0
    buffer_load_dwordx4 v10, s[56:59], s82 offen offset:2048 sc1 lds
    s_nop 0
    buffer_load_dwordx4 v10, s[56:59], s82 offen offset:3072 sc1 lds
    s_add_u32 s82, s82, 16384
    s_lshl1_add_u32 m0, s33, 49152
    s_nop 0
    buffer_load_dwordx4 v11, s[60:63], s83 offen lds
    s_lshl1_add_u32 m0, s33, 50176
    s_nop 0
    buffer_load_dwordx4 v12, s[60:63], s83 offen lds
    s_lshl1_add_u32 m0, s33, 57344
    s_nop 0
    buffer_load_dwordx4 v11, s[64:67], s83 offen lds
    s_lshl1_add_u32 m0, s33, 58368
    s_nop 0
    buffer_load_dwordx4 v12, s[64:67], s83 offen lds
    s_add_u32 s83, s83, 131072
    s_waitcnt vmcnt(16)
    s_barrier
    s_setprio 1
    s_lshl2_add_u32 m0, s33, 65536
    s_nop 0
    buffer_load_dwordx4 v10, s[56:59], s82 offen offset:0 sc1 lds
    s_nop 0
    buffer_load_dwordx4 v10, s[56:59], s82 offen offset:1024 sc1 lds
    s_nop 0
    buffer_load_dwordx4 v10, s[56:59], s82 offen offset:2048 sc1 lds
    s_nop 0
    buffer_load_dwordx4 v10, s[56:59], s82 offen offset:3072 sc1 lds
    s_add_u32 s82, s82, 16384
    ds_read_b64_tr_b16 v[40:41], v6 offset:16384
    ds_read_b64_tr_b16 v[42:43], v6 offset:16896
    ds_read_b128 v[24:27], v4 offset:0
    ds_read_b128 v[28:31], v4 offset:1024
    ds_read_b128 v[32:35], v4 offset:2048
    ds_read_b128 v[36:39], v4 offset:3072
    ds_read_b64_tr_b16 v[44:45], v7 offset:16384
    ds_read_b64_tr_b16 v[46:47], v7 offset:16896
    ds_read_b64_tr_b16 v[48:49], v6 offset:24576
    ds_read_b64_tr_b16 v[50:51], v6 offset:25088
    ds_read_b64_tr_b16 v[52:53], v7 offset:24576
    ds_read_b64_tr_b16 v[54:55], v7 offset:25088
    s_mov_b32 s34, 6
.p2align 6
L_d:
    s_cmp_eq_u32 s34, 2
    s_cselect_b32 s84, s93, 0
    s_cselect_b32 s35, s94, 131072
    s_add_u32 s82, s82, s84
    s_waitcnt lgkmcnt(9)
    v_mfma_f32_16x16x32_bf16 v[88:91], v[40:43], v[24:27], v[88:91]
    ds_read_b64_tr_b16 v[72:73], v6 offset:20480
    ds_read_b64_tr_b16 v[74:75], v6 offset:20992
    s_lshl1_add_u32 m0, s33, 81920
    s_waitcnt lgkmcnt(10)
    v_mfma_f32_16x16x32_bf16 v[92:95], v[40:43], v[28:31], v[92:95]
    ds_read_b128 v[56:59], v4 offset:8192
    buffer_load_dwordx4 v11, s[60:63], s83 offen lds
    s_waitcnt lgkmcnt(10)
    v_mfma_f32_16x16x32_bf16 v[96:99], v[40:43], v[32:35], v[96:99]
    ds_read_b128 v[60:63], v4 offset:9216
    ds_read_b128 v[64:67], v4 offset:10240
    s_waitcnt lgkmcnt(11)
    v_mfma_f32_16x16x32_bf16 v[100:103], v[40:43], v[36:39], v[100:103]
    ds_read_b128 v[68:71], v4 offset:11264
    s_waitcnt lgkmcnt(10)
    v_mfma_f32_16x16x32_bf16 v[104:107], v[44:47], v[24:27], v[104:107]
    ds_read_b64_tr_b16 v[76:77], v7 offset:20480
    ds_read_b64_tr_b16 v[78:79], v7 offset:20992
    s_lshl1_add_u32 m0, s33, 82944
    v_mfma_f32_16x16x32_bf16 v[108:111], v[44:47], v[28:31], v[108:111]
    ds_read_b64_tr_b16 v[80:81], v6 offset:28672
    buffer_load_dwordx4 v12, s[60:63], s83 offen lds
    v_mfma_f32_16x16x32_bf16 v[112:115], v[44:47], v[32:35], v[112:115]
    ds_read_b64_tr_b16 v[82:83], v6 offset:29184
    ds_read_b64_tr_b16 v[84:85], v7 offset:28672
    v_mfma_f32_16x16x32_bf16 v[116:119], v[44:47], v[36:39], v[116:119]
    ds_read_b64_tr_b16 v[86:87], v7 offset:29184
    s_waitcnt lgkmcnt(14)
    v_mfma_f32_16x16x32_bf16 v[120:123], v[48:51], v[24:27], v[120:123]
    s_lshl1_add_u32 m0, s33, 90112
    v_mfma_f32_16x16x32_bf16 v[124:127], v[48:51], v[28:31], v[124:127]
    buffer_load_dwordx4 v11, s[64:67], s83 offen lds
    v_mfma_f32_16x16x32_bf16 v[128:131], v[48:51], v[32:35], v[128:131]
    v_mfma_f32_16x16x32_bf16 v[132:135], v[48:51], v[36:39], v[132:135]
    s_waitcnt lgkmcnt(12)
    v_mfma_f32_16x16x32_bf16 v[136:139], v[52:55], v[24:27], v[136:139]
    s_lshl1_add_u32 m0, s33, 91136
    v_mfma_f32_16x16x32_bf16 v[140:143], v[52:55], v[28:31], v[140:143]
    buffer_load_dwordx4 v12, s[64:67], s83 offen lds
    s_add_u32 s83, s83, s35
    v_mfma_f32_16x16x32_bf16 v[144:147], v[52:55], v[32:35], v[144:147]
    v_mfma_f32_16x16x32_bf16 v[148:151], v[52:55], v[36:39], v[148:151]
    s_waitcnt vmcnt(16) lgkmcnt(0)
    s_barrier
    v_mfma_f32_16x16x32_bf16 v[88:91], v[72:75], v[56:59], v[88:91]
    ds_read_b64_tr_b16 v[40:41], v8 offset:49152
    ds_read_b64_tr_b16 v[42:43], v8 offset:49664
    s_lshl_b32 m0, s33, 2
    v_mfma_f32_16x16x32_bf16 v[92:95], v[72:75], v[60:63], v[92:95]
    ds_read_b128 v[24:27], v5 offset:32768
    buffer_load_dwordx4 v10, s[56:59], s82 offen offset:0 sc1 lds
    v_mfma_f32_16x16x32_bf16 v[96:99], v[72:75], v[64:67], v[96:99]
    ds_read_b128 v[28:31], v5 offset:33792
    v_mfma_f32_16x16x32_bf16 v[100:103], v[72:75], v[68:71], v[100:103]
    ds_read_b128 v[32:35], v5 offset:34816
    v_mfma_f32_16x16x32_bf16 v[104:107], v[76:79], v[56:59], v[104:107]
    ds_read_b128 v[36:39], v5 offset:35840
    v_mfma_f32_16x16x32_bf16 v[108:111], v[76:79], v[60:63], v[108:111]
    ds_read_b64_tr_b16 v[44:45], v9 offset:49152
    ds_read_b64_tr_b16 v[46:47], v9 offset:49664
    buffer_load_dwordx4 v10, s[56:59], s82 offen offset:1024 sc1 lds
    v_mfma_f32_16x16x32_bf16 v[112:115], v[76:79], v[64:67], v[112:115]
    ds_read_b64_tr_b16 v[48:49], v8 offset:57344
    v_mfma_f32_16x16x32_bf16 v[116:119], v[76:79], v[68:71], v[116:119]
    ds_read_b64_tr_b16 v[50:51], v8 offset:57856
    v_mfma_f32_16x16x32_bf16 v[120:123], v[80:83], v[56:59], v[120:123]
    ds_read_b64_tr_b16 v[52:53], v9 offset:57344
    v_mfma_f32_16x16x32_bf16 v[124:127], v[80:83], v[60:63], v[124:127]
    ds_read_b64_tr_b16 v[54:55], v9 offset:57856
    buffer_load_dwordx4 v10, s[56:59], s82 offen offset:2048 sc1 lds
    v_mfma_f32_16x16x32_bf16 v[128:131], v[80:83], v[64:67], v[128:131]
    v_mfma_f32_16x16x32_bf16 v[132:135], v[80:83], v[68:71], v[132:135]
    v_mfma_f32_16x16x32_bf16 v[136:139], v[84:87], v[56:59], v[136:139]
    v_mfma_f32_16x16x32_bf16 v[140:143], v[84:87], v[60:63], v[140:143]
    buffer_load_dwordx4 v10, s[56:59], s82 offen offset:3072 sc1 lds
    s_add_u32 s82, s82, 16384
    v_mfma_f32_16x16x32_bf16 v[144:147], v[84:87], v[64:67], v[144:147]
    v_mfma_f32_16x16x32_bf16 v[148:151], v[84:87], v[68:71], v[148:151]
    s_waitcnt lgkmcnt(9)
    v_mfma_f32_16x16x32_bf16 v[88:91], v[40:43], v[24:27], v[88:91]
    ds_read_b64_tr_b16 v[72:73], v8 offset:53248
    ds_read_b64_tr_b16 v[74:75], v8 offset:53760
    s_lshl1_add_u32 m0, s33, 16384
    s_waitcnt lgkmcnt(10)
    v_mfma_f32_16x16x32_bf16 v[92:95], v[40:43], v[28:31], v[92:95]
    ds_read_b128 v[56:59], v5 offset:40960
    buffer_load_dwordx4 v11, s[60:63], s83 offen lds
    s_waitcnt lgkmcnt(10)
    v_mfma_f32_16x16x32_bf16 v[96:99], v[40:43], v[32:35], v[96:99]
    ds_read_b128 v[60:63], v5 offset:41984
    ds_read_b128 v[64:67], v5 offset:43008
    s_waitcnt lgkmcnt(11)
    v_mfma_f32_16x16x32_bf16 v[100:103], v[40:43], v[36:39], v[100:103]
    ds_read_b128 v[68:71], v5 offset:44032
    s_waitcnt lgkmcnt(10)
    v_mfma_f32_16x16x32_bf16 v[104:107], v[44:47], v[24:27], v[104:107]
    ds_read_b64_tr_b16 v[76:77], v9 offset:53248
    ds_read_b64_tr_b16 v[78:79], v9 offset:53760
    s_lshl1_add_u32 m0, s33, 17408
    v_mfma_f32_16x16x32_bf16 v[108:111], v[44:47], v[28:31], v[108:111]
    ds_read_b64_tr_b16 v[80:81], v8 offset:61440
    buffer_load_dwordx4 v12, s[60:63], s83 offen lds
    v_mfma_f32_16x16x32_bf16 v[112:115], v[44:47], v[32:35], v[112:115]
    ds_read_b64_tr_b16 v[82:83], v8 offset:61952
    ds_read_b64_tr_b16 v[84:85], v9 offset:61440
    v_mfma_f32_16x16x32_bf16 v[116:119], v[44:47], v[36:39], v[116:119]
    ds_read_b64_tr_b16 v[86:87], v9 offset:61952
    s_waitcnt lgkmcnt(14)
    v_mfma_f32_16x16x32_bf16 v[120:123], v[48:51], v[24:27], v[120:123]
    s_lshl1_add_u32 m0, s33, 24576
    v_mfma_f32_16x16x32_bf16 v[124:127], v[48:51], v[28:31], v[124:127]
    buffer_load_dwordx4 v11, s[64:67], s83 offen lds
    v_mfma_f32_16x16x32_bf16 v[128:131], v[48:51], v[32:35], v[128:131]
    v_mfma_f32_16x16x32_bf16 v[132:135], v[48:51], v[36:39], v[132:135]
    s_waitcnt lgkmcnt(12)
    v_mfma_f32_16x16x32_bf16 v[136:139], v[52:55], v[24:27], v[136:139]
    s_lshl1_add_u32 m0, s33, 25600
    v_mfma_f32_16x16x32_bf16 v[140:143], v[52:55], v[28:31], v[140:143]
    buffer_load_dwordx4 v12, s[64:67], s83 offen lds
    s_add_u32 s83, s83, 131072
    v_mfma_f32_16x16x32_bf16 v[144:147], v[52:55], v[32:35], v[144:147]
    v_mfma_f32_16x16x32_bf16 v[148:151], v[52:55], v[36:39], v[148:151]
    s_waitcnt vmcnt(16) lgkmcnt(0)
    s_barrier
    v_mfma_f32_16x16x32_bf16 v[88:91], v[72:75], v[56:59], v[88:91]
    ds_read_b64_tr_b16 v[40:41], v6 offset:49152
    ds_read_b64_tr_b16 v[42:43], v6 offset:49664
    s_lshl2_add_u32 m0, s33, 98304
    v_mfma_f32_16x16x32_bf16 v[92:95], v[72:75], v[60:63], v[92:95]
    ds_read_b128 v[24:27], v4 offset:32768
    buffer_load_dwordx4 v10, s[56:59], s82 offen offset:0 sc1 lds
    v_mfma_f32_16x16x32_bf16 v[96:99], v[72:75], v[64:67], v[96:99]
    ds_read_b128 v[28:31], v4 offset:33792
    v_mfma_f32_16x16x32_bf16 v[100:103], v[72:75], v[68:71], v[100:103]
    ds_read_b128 v[32:35], v4 offset:34816
    v_mfma_f32_16x16x32_bf16 v[104:107], v[76:79], v[56:59], v[104:107]
    ds_read_b128 v[36:39], v4 offset:35840
    v_mfma_f32_16x16x32_bf16 v[108:111], v[76:79], v[60:63], v[108:111]
    ds_read_b64_tr_b16 v[44:45], v7 offset:49152
    ds_read_b64_tr_b16 v[46:47], v7 offset:49664
    buffer_load_dwordx4 v10, s[56:59], s82 offen offset:1024 sc1 lds
    v_mfma_f32_16x16x32_bf16 v[112:115], v[76:79], v[64:67], v[112:115]
    ds_read_b64_tr_b16 v[48:49], v6 offset:57344
    v_mfma_f32_16x16x32_bf16 v[116:119], v[76:79], v[68:71], v[116:119]
    ds_read_b64_tr_b16 v[50:51], v6 offset:57856
    v_mfma_f32_16x16x32_bf16 v[120:123], v[80:83], v[56:59], v[120:123]
    ds_read_b64_tr_b16 v[52:53], v7 offset:57344
    v_mfma_f32_16x16x32_bf16 v[124:127], v[80:83], v[60:63], v[124:127]
    ds_read_b64_tr_b16 v[54:55], v7 offset:57856
    buffer_load_dwordx4 v10, s[56:59], s82 offen offset:2048 sc1 lds
    v_mfma_f32_16x16x32_bf16 v[128:131], v[80:83], v[64:67], v[128:131]
    v_mfma_f32_16x16x32_bf16 v[132:135], v[80:83], v[68:71], v[132:135]
    v_mfma_f32_16x16x32_bf16 v[136:139], v[84:87], v[56:59], v[136:139]
    v_mfma_f32_16x16x32_bf16 v[140:143], v[84:87], v[60:63], v[140:143]
    buffer_load_dwordx4 v10, s[56:59], s82 offen offset:3072 sc1 lds
    s_add_u32 s82, s82, 16384
    v_mfma_f32_16x16x32_bf16 v[144:147], v[84:87], v[64:67], v[144:147]
    v_mfma_f32_16x16x32_bf16 v[148:151], v[84:87], v[68:71], v[148:151]
    s_waitcnt lgkmcnt(9)
    v_mfma_f32_16x16x32_bf16 v[88:91], v[40:43], v[24:27], v[88:91]
    ds_read_b64_tr_b16 v[72:73], v6 offset:53248
    ds_read_b64_tr_b16 v[74:75], v6 offset:53760
    s_lshl1_add_u32 m0, s33, 114688
    s_waitcnt lgkmcnt(10)
    v_mfma_f32_16x16x32_bf16 v[92:95], v[40:43], v[28:31], v[92:95]
    ds_read_b128 v[56:59], v4 offset:40960
    buffer_load_dwordx4 v11, s[60:63], s83 offen lds
    s_waitcnt lgkmcnt(10)
    v_mfma_f32_16x16x32_bf16 v[96:99], v[40:43], v[32:35], v[96:99]
    ds_read_b128 v[60:63], v4 offset:41984
    ds_read_b128 v[64:67], v4 offset:43008
    s_waitcnt lgkmcnt(11)
    v_mfma_f32_16x16x32_bf16 v[100:103], v[40:43], v[36:39], v[100:103]
    ds_read_b128 v[68:71], v4 offset:44032
    s_waitcnt lgkmcnt(10)
    v_mfma_f32_16x16x32_bf16 v[104:107], v[44:47], v[24:27], v[104:107]
    ds_read_b64_tr_b16 v[76:77], v7 offset:53248
    ds_read_b64_tr_b16 v[78:79], v7 offset:53760
    s_lshl1_add_u32 m0, s33, 115712
    v_mfma_f32_16x16x32_bf16 v[108:111], v[44:47], v[28:31], v[108:111]
    ds_read_b64_tr_b16 v[80:81], v6 offset:61440
    buffer_load_dwordx4 v12, s[60:63], s83 offen lds
    v_mfma_f32_16x16x32_bf16 v[112:115], v[44:47], v[32:35], v[112:115]
    ds_read_b64_tr_b16 v[82:83], v6 offset:61952
    ds_read_b64_tr_b16 v[84:85], v7 offset:61440
    v_mfma_f32_16x16x32_bf16 v[116:119], v[44:47], v[36:39], v[116:119]
    ds_read_b64_tr_b16 v[86:87], v7 offset:61952
    s_waitcnt lgkmcnt(14)
    v_mfma_f32_16x16x32_bf16 v[120:123], v[48:51], v[24:27], v[120:123]
    s_lshl1_add_u32 m0, s33, 122880
    v_mfma_f32_16x16x32_bf16 v[124:127], v[48:51], v[28:31], v[124:127]
    buffer_load_dwordx4 v11, s[64:67], s83 offen lds
    v_mfma_f32_16x16x32_bf16 v[128:131], v[48:51], v[32:35], v[128:131]
    v_mfma_f32_16x16x32_bf16 v[132:135], v[48:51], v[36:39], v[132:135]
    s_waitcnt lgkmcnt(12)
    v_mfma_f32_16x16x32_bf16 v[136:139], v[52:55], v[24:27], v[136:139]
    s_lshl1_add_u32 m0, s33, 123904
    v_mfma_f32_16x16x32_bf16 v[140:143], v[52:55], v[28:31], v[140:143]
    buffer_load_dwordx4 v12, s[64:67], s83 offen lds
    s_add_u32 s83, s83, 131072
    v_mfma_f32_16x16x32_bf16 v[144:147], v[52:55], v[32:35], v[144:147]
    v_mfma_f32_16x16x32_bf16 v[148:151], v[52:55], v[36:39], v[148:151]
    s_waitcnt vmcnt(16) lgkmcnt(0)
    s_barrier
    v_mfma_f32_16x16x32_bf16 v[88:91], v[72:75], v[56:59], v[88:91]
    ds_read_b64_tr_b16 v[40:41], v8 offset:16384
    ds_read_b64_tr_b16 v[42:43], v8 offset:16896
    s_lshl2_add_u32 m0, s33, 32768
    v_mfma_f32_16x16x32_bf16 v[92:95], v[72:75], v[60:63], v[92:95]
    ds_read_b128 v[24:27], v5 offset:0
    buffer_load_dwordx4 v10, s[56:59], s82 offen offset:0 sc1 lds
    v_mfma_f32_16x16x32_bf16 v[96:99], v[72:75], v[64:67], v[96:99]
    ds_read_b128 v[28:31], v5 offset:1024
    v_mfma_f32_16x16x32_bf16 v[100:103], v[72:75], v[68:71], v[100:103]
    ds_read_b128 v[32:35], v5 offset:2048
    v_mfma_f32_16x16x32_bf16 v[104:107], v[76:79], v[56:59], v[104:107]
    ds_read_b128 v[36:39], v5 offset:3072
    v_mfma_f32_16x16x32_bf16 v[108:111], v[76:79], v[60:63], v[108:111]
    ds_read_b64_tr_b16 v[44:45], v9 offset:16384
    ds_read_b64_tr_b16 v[46:47], v9 offset:16896
    buffer_load_dwordx4 v10, s[56:59], s82 offen offset:1024 sc1 lds
    v_mfma_f32_16x16x32_bf16 v[112:115], v[76:79], v[64:67], v[112:115]
    ds_read_b64_tr_b16 v[48:49], v8 offset:24576
    v_mfma_f32_16x16x32_bf16 v[116:119], v[76:79], v[68:71], v[116:119]
    ds_read_b64_tr_b16 v[50:51], v8 offset:25088
    v_mfma_f32_16x16x32_bf16 v[120:123], v[80:83], v[56:59], v[120:123]
    ds_read_b64_tr_b16 v[52:53], v9 offset:24576
    v_mfma_f32_16x16x32_bf16 v[124:127], v[80:83], v[60:63], v[124:127]
    ds_read_b64_tr_b16 v[54:55], v9 offset:25088
    buffer_load_dwordx4 v10, s[56:59], s82 offen offset:2048 sc1 lds
    v_mfma_f32_16x16x32_bf16 v[128:131], v[80:83], v[64:67], v[128:131]
    v_mfma_f32_16x16x32_bf16 v[132:135], v[80:83], v[68:71], v[132:135]
    v_mfma_f32_16x16x32_bf16 v[136:139], v[84:87], v[56:59], v[136:139]
    v_mfma_f32_16x16x32_bf16 v[140:143], v[84:87], v[60:63], v[140:143]
    buffer_load_dwordx4 v10, s[56:59], s82 offen offset:3072 sc1 lds
    s_add_u32 s82, s82, 16384
    v_mfma_f32_16x16x32_bf16 v[144:147], v[84:87], v[64:67], v[144:147]
    v_mfma_f32_16x16x32_bf16 v[148:151], v[84:87], v[68:71], v[148:151]
    s_waitcnt lgkmcnt(9)
    v_mfma_f32_16x16x32_bf16 v[88:91], v[40:43], v[24:27], v[88:91]
    ds_read_b64_tr_b16 v[72:73], v8 offset:20480
    ds_read_b64_tr_b16 v[74:75], v8 offset:20992
    s_lshl1_add_u32 m0, s33, 49152
    s_waitcnt lgkmcnt(10)
    v_mfma_f32_16x16x32_bf16 v[92:95], v[40:43], v[28:31], v[92:95]
    ds_read_b128 v[56:59], v5 offset:8192
    buffer_load_dwordx4 v11, s[60:63], s83 offen lds
    s_waitcnt lgkmcnt(10)
    v_mfma_f32_16x16x32_bf16 v[96:99], v[40:43], v[32:35], v[96:99]
    ds_read_b128 v[60:63], v5 offset:9216
    ds_read_b128 v[64:67], v5 offset:10240
    s_waitcnt lgkmcnt(11)
    v_mfma_f32_16x16x32_bf16 v[100:103], v[40:43], v[36:39], v[100:103]
    ds_read_b128 v[68:71], v5 offset:11264
    s_waitcnt lgkmcnt(10)
    v_mfma_f32_16x16x32_bf16 v[104:107], v[44:47], v[24:27], v[104:107]
    ds_read_b64_tr_b16 v[76:77], v9 offset:20480
    ds_read_b64_tr_b16 v[78:79], v9 offset:20992
    s_lshl1_add_u32 m0, s33, 50176
    v_mfma_f32_16x16x32_bf16 v[108:111], v[44:47], v[28:31], v[108:111]
    ds_read_b64_tr_b16 v[80:81], v8 offset:28672
    buffer_load_dwordx4 v12, s[60:63], s83 offen lds
    v_mfma_f32_16x16x32_bf16 v[112:115], v[44:47], v[32:35], v[112:115]
    ds_read_b64_tr_b16 v[82:83], v8 offset:29184
    ds_read_b64_tr_b16 v[84:85], v9 offset:28672
    v_mfma_f32_16x16x32_bf16 v[116:119], v[44:47], v[36:39], v[116:119]
    ds_read_b64_tr_b16 v[86:87], v9 offset:29184
    s_waitcnt lgkmcnt(14)
    v_mfma_f32_16x16x32_bf16 v[120:123], v[48:51], v[24:27], v[120:123]
    s_lshl1_add_u32 m0, s33, 57344
    v_mfma_f32_16x16x32_bf16 v[124:127], v[48:51], v[28:31], v[124:127]
    buffer_load_dwordx4 v11, s[64:67], s83 offen lds
    v_mfma_f32_16x16x32_bf16 v[128:131], v[48:51], v[32:35], v[128:131]
    v_mfma_f32_16x16x32_bf16 v[132:135], v[48:51], v[36:39], v[132:135]
    s_waitcnt lgkmcnt(12)
    v_mfma_f32_16x16x32_bf16 v[136:139], v[52:55], v[24:27], v[136:139]
    s_lshl1_add_u32 m0, s33, 58368
    v_mfma_f32_16x16x32_bf16 v[140:143], v[52:55], v[28:31], v[140:143]
    buffer_load_dwordx4 v12, s[64:67], s83 offen lds
    s_add_u32 s83, s83, 131072
    v_mfma_f32_16x16x32_bf16 v[144:147], v[52:55], v[32:35], v[144:147]
    v_mfma_f32_16x16x32_bf16 v[148:151], v[52:55], v[36:39], v[148:151]
    s_waitcnt vmcnt(16) lgkmcnt(0)
    s_barrier
    v_mfma_f32_16x16x32_bf16 v[88:91], v[72:75], v[56:59], v[88:91]
    ds_read_b64_tr_b16 v[40:41], v6 offset:16384
    ds_read_b64_tr_b16 v[42:43], v6 offset:16896
    s_lshl2_add_u32 m0, s33, 65536
    v_mfma_f32_16x16x32_bf16 v[92:95], v[72:75], v[60:63], v[92:95]
    ds_read_b128 v[24:27], v4 offset:0
    buffer_load_dwordx4 v10, s[56:59], s82 offen offset:0 sc1 lds
    v_mfma_f32_16x16x32_bf16 v[96:99], v[72:75], v[64:67], v[96:99]
    ds_read_b128 v[28:31], v4 offset:1024
    v_mfma_f32_16x16x32_bf16 v[100:103], v[72:75], v[68:71], v[100:103]
    ds_read_b128 v[32:35], v4 offset:2048
    v_mfma_f32_16x16x32_bf16 v[104:107], v[76:79], v[56:59], v[104:107]
    ds_read_b128 v[36:39], v4 offset:3072
    v_mfma_f32_16x16x32_bf16 v[108:111], v[76:79], v[60:63], v[108:111]
    ds_read_b64_tr_b16 v[44:45], v7 offset:16384
    ds_read_b64_tr_b16 v[46:47], v7 offset:16896
    buffer_load_dwordx4 v10, s[56:59], s82 offen offset:1024 sc1 lds
    v_mfma_f32_16x16x32_bf16 v[112:115], v[76:79], v[64:67], v[112:115]
    ds_read_b64_tr_b16 v[48:49], v6 offset:24576
    v_mfma_f32_16x16x32_bf16 v[116:119], v[76:79], v[68:71], v[116:119]
    ds_read_b64_tr_b16 v[50:51], v6 offset:25088
    v_mfma_f32_16x16x32_bf16 v[120:123], v[80:83], v[56:59], v[120:123]
    ds_read_b64_tr_b16 v[52:53], v7 offset:24576
    v_mfma_f32_16x16x32_bf16 v[124:127], v[80:83], v[60:63], v[124:127]
    ds_read_b64_tr_b16 v[54:55], v7 offset:25088
    buffer_load_dwordx4 v10, s[56:59], s82 offen offset:2048 sc1 lds
    v_mfma_f32_16x16x32_bf16 v[128:131], v[80:83], v[64:67], v[128:131]
    v_mfma_f32_16x16x32_bf16 v[132:135], v[80:83], v[68:71], v[132:135]
    v_mfma_f32_16x16x32_bf16 v[136:139], v[84:87], v[56:59], v[136:139]
    v_mfma_f32_16x16x32_bf16 v[140:143], v[84:87], v[60:63], v[140:143]
    buffer_load_dwordx4 v10, s[56:59], s82 offen offset:3072 sc1 lds
    s_add_u32 s82, s82, 16384
    v_mfma_f32_16x16x32_bf16 v[144:147], v[84:87], v[64:67], v[144:147]
    v_mfma_f32_16x16x32_bf16 v[148:151], v[84:87], v[68:71], v[148:151]
    s_sub_u32 s34, s34, 1
    s_cmp_lg_u32 s34, 0
    s_cbranch_scc1 L_d
    s_mov_b32 s35, 131072
    s_waitcnt lgkmcnt(9)
    v_mfma_f32_16x16x32_bf16 v[88:91], v[40:43], v[24:27], v[88:91]
    ds_read_b64_tr_b16 v[72:73], v6 offset:20480
    ds_read_b64_tr_b16 v[74:75], v6 offset:20992
    s_lshl1_add_u32 m0, s33, 81920
    s_waitcnt lgkmcnt(10)
    v_mfma_f32_16x16x32_bf16 v[92:95], v[40:43], v[28:31], v[92:95]
    ds_read_b128 v[56:59], v4 offset:8192
    buffer_load_dwordx4 v11, s[60:63], s83 offen lds
    s_waitcnt lgkmcnt(10)
    v_mfma_f32_16x16x32_bf16 v[96:99], v[40:43], v[32:35], v[96:99]
    ds_read_b128 v[60:63], v4 offset:9216
    ds_read_b128 v[64:67], v4 offset:10240
    s_waitcnt lgkmcnt(11)
    v_mfma_f32_16x16x32_bf16 v[100:103], v[40:43], v[36:39], v[100:103]
    ds_read_b128 v[68:71], v4 offset:11264
    s_waitcnt lgkmcnt(10)
    v_mfma_f32_16x16x32_bf16 v[104:107], v[44:47], v[24:27], v[104:107]
    ds_read_b64_tr_b16 v[76:77], v7 offset:20480
    ds_read_b64_tr_b16 v[78:79], v7 offset:20992
    s_lshl1_add_u32 m0, s33, 82944
    v_mfma_f32_16x16x32_bf16 v[108:111], v[44:47], v[28:31], v[108:111]
    ds_read_b64_tr_b16 v[80:81], v6 offset:28672
    buffer_load_dwordx4 v12, s[60:63], s83 offen lds
    v_mfma_f32_16x16x32_bf16 v[112:115], v[44:47], v[32:35], v[112:115]
    ds_read_b64_tr_b16 v[82:83], v6 offset:29184
    ds_read_b64_tr_b16 v[84:85], v7 offset:28672
    v_mfma_f32_16x16x32_bf16 v[116:119], v[44:47], v[36:39], v[116:119]
    ds_read_b64_tr_b16 v[86:87], v7 offset:29184
    s_waitcnt lgkmcnt(14)
    v_mfma_f32_16x16x32_bf16 v[120:123], v[48:51], v[24:27], v[120:123]
    s_lshl1_add_u32 m0, s33, 90112
    v_mfma_f32_16x16x32_bf16 v[124:127], v[48:51], v[28:31], v[124:127]
    buffer_load_dwordx4 v11, s[64:67], s83 offen lds
    v_mfma_f32_16x16x32_bf16 v[128:131], v[48:51], v[32:35], v[128:131]
    v_mfma_f32_16x16x32_bf16 v[132:135], v[48:51], v[36:39], v[132:135]
    s_waitcnt lgkmcnt(12)
    v_mfma_f32_16x16x32_bf16 v[136:139], v[52:55], v[24:27], v[136:139]
    s_lshl1_add_u32 m0, s33, 91136
    v_mfma_f32_16x16x32_bf16 v[140:143], v[52:55], v[28:31], v[140:143]
    buffer_load_dwordx4 v12, s[64:67], s83 offen lds
    s_add_u32 s83, s83, s35
    v_mfma_f32_16x16x32_bf16 v[144:147], v[52:55], v[32:35], v[144:147]
    v_mfma_f32_16x16x32_bf16 v[148:151], v[52:55], v[36:39], v[148:151]
    s_waitcnt vmcnt(16) lgkmcnt(0)
    s_barrier
    v_mfma_f32_16x16x32_bf16 v[88:91], v[72:75], v[56:59], v[88:91]
    ds_read_b64_tr_b16 v[40:41], v8 offset:49152
    ds_read_b64_tr_b16 v[42:43], v8 offset:49664
    v_mfma_f32_16x16x32_bf16 v[92:95], v[72:75], v[60:63], v[92:95]
    ds_read_b128 v[24:27], v5 offset:32768
    v_mfma_f32_16x16x32_bf16 v[96:99], v[72:75], v[64:67], v[96:99]
    ds_read_b128 v[28:31], v5 offset:33792
    v_mfma_f32_16x16x32_bf16 v[100:103], v[72:75], v[68:71], v[100:103]
    ds_read_b128 v[32:35], v5 offset:34816
    v_mfma_f32_16x16x32_bf16 v[104:107], v[76:79], v[56:59], v[104:107]
    ds_read_b128 v[36:39], v5 offset:35840
    v_mfma_f32_16x16x32_bf16 v[108:111], v[76:79], v[60:63], v[108:111]
    ds_read_b64_tr_b16 v[44:45], v9 offset:49152
    ds_read_b64_tr_b16 v[46:47], v9 offset:49664
    v_mfma_f32_16x16x32_bf16 v[112:115], v[76:79], v[64:67], v[112:115]
    ds_read_b64_tr_b16 v[48:49], v8 offset:57344
    v_mfma_f32_16x16x32_bf16 v[116:119], v[76:79], v[68:71], v[116:119]
    ds_read_b64_tr_b16 v[50:51], v8 offset:57856
    v_mfma_f32_16x16x32_bf16 v[120:123], v[80:83], v[56:59], v[120:123]
    ds_read_b64_tr_b16 v[52:53], v9 offset:57344
    v_mfma_f32_16x16x32_bf16 v[124:127], v[80:83], v[60:63], v[124:127]
    ds_read_b64_tr_b16 v[54:55], v9 offset:57856
    v_mfma_f32_16x16x32_bf16 v[128:131], v[80:83], v[64:67], v[128:131]
    v_mfma_f32_16x16x32_bf16 v[132:135], v[80:83], v[68:71], v[132:135]
    v_mfma_f32_16x16x32_bf16 v[136:139], v[84:87], v[56:59], v[136:139]
    v_mfma_f32_16x16x32_bf16 v[140:143], v[84:87], v[60:63], v[140:143]
    v_mfma_f32_16x16x32_bf16 v[144:147], v[84:87], v[64:67], v[144:147]
    v_mfma_f32_16x16x32_bf16 v[148:151], v[84:87], v[68:71], v[148:151]
    s_waitcnt lgkmcnt(9)
    v_mfma_f32_16x16x32_bf16 v[88:91], v[40:43], v[24:27], v[88:91]
    ds_read_b64_tr_b16 v[72:73], v8 offset:53248
    ds_read_b64_tr_b16 v[74:75], v8 offset:53760
    s_waitcnt lgkmcnt(10)
    v_mfma_f32_16x16x32_bf16 v[92:95], v[40:43], v[28:31], v[92:95]
    ds_read_b128 v[56:59], v5 offset:40960
    s_waitcnt lgkmcnt(10)
    v_mfma_f32_16x16x32_bf16 v[96:99], v[40:43], v[32:35], v[96:99]
    ds_read_b128 v[60:63], v5 offset:41984
    ds_read_b128 v[64:67], v5 offset:43008
    s_waitcnt lgkmcnt(11)
    v_mfma_f32_16x16x32_bf16 v[100:103], v[40:43], v[36:39], v[100:103]
    ds_read_b128 v[68:71], v5 offset:44032
    s_waitcnt lgkmcnt(10)
    v_mfma_f32_16x16x32_bf16 v[104:107], v[44:47], v[24:27], v[104:107]
    ds_read_b64_tr_b16 v[76:77], v9 offset:53248
    ds_read_b64_tr_b16 v[78:79], v9 offset:53760
    v_mfma_f32_16x16x32_bf16 v[108:111], v[44:47], v[28:31], v[108:111]
    ds_read_b64_tr_b16 v[80:81], v8 offset:61440
    v_mfma_f32_16x16x32_bf16 v[112:115], v[44:47], v[32:35], v[112:115]
    ds_read_b64_tr_b16 v[82:83], v8 offset:61952
    ds_read_b64_tr_b16 v[84:85], v9 offset:61440
    v_mfma_f32_16x16x32_bf16 v[116:119], v[44:47], v[36:39], v[116:119]
    ds_read_b64_tr_b16 v[86:87], v9 offset:61952
    s_waitcnt lgkmcnt(14)
    v_mfma_f32_16x16x32_bf16 v[120:123], v[48:51], v[24:27], v[120:123]
    v_mfma_f32_16x16x32_bf16 v[124:127], v[48:51], v[28:31], v[124:127]
    v_mfma_f32_16x16x32_bf16 v[128:131], v[48:51], v[32:35], v[128:131]
    v_mfma_f32_16x16x32_bf16 v[132:135], v[48:51], v[36:39], v[132:135]
    s_waitcnt lgkmcnt(12)
    v_mfma_f32_16x16x32_bf16 v[136:139], v[52:55], v[24:27], v[136:139]
    v_mfma_f32_16x16x32_bf16 v[140:143], v[52:55], v[28:31], v[140:143]
    v_mfma_f32_16x16x32_bf16 v[144:147], v[52:55], v[32:35], v[144:147]
    v_mfma_f32_16x16x32_bf16 v[148:151], v[52:55], v[36:39], v[148:151]
    s_waitcnt vmcnt(8) lgkmcnt(0)
    s_barrier
    v_mfma_f32_16x16x32_bf16 v[88:91], v[72:75], v[56:59], v[88:91]
    ds_read_b64_tr_b16 v[40:41], v6 offset:49152
    ds_read_b64_tr_b16 v[42:43], v6 offset:49664
    v_mfma_f32_16x16x32_bf16 v[92:95], v[72:75], v[60:63], v[92:95]
    ds_read_b128 v[24:27], v4 offset:32768
    v_mfma_f32_16x16x32_bf16 v[96:99], v[72:75], v[64:67], v[96:99]
    ds_read_b128 v[28:31], v4 offset:33792
    v_mfma_f32_16x16x32_bf16 v[100:103], v[72:75], v[68:71], v[100:103]
    ds_read_b128 v[32:35], v4 offset:34816
    v_mfma_f32_16x16x32_bf16 v[104:107], v[76:79], v[56:59], v[104:107]
    ds_read_b128 v[36:39], v4 offset:35840
    v_mfma_f32_16x16x32_bf16 v[108:111], v[76:79], v[60:63], v[108:111]
    ds_read_b64_tr_b16 v[44:45], v7 offset:49152
    ds_read_b64_tr_b16 v[46:47], v7 offset:49664
    v_mfma_f32_16x16x32_bf16 v[112:115], v[76:79], v[64:67], v[112:115]
    ds_read_b64_tr_b16 v[48:49], v6 offset:57344
    v_mfma_f32_16x16x32_bf16 v[116:119], v[76:79], v[68:71], v[116:119]
    ds_read_b64_tr_b16 v[50:51], v6 offset:57856
    v_mfma_f32_16x16x32_bf16 v[120:123], v[80:83], v[56:59], v[120:123]
    ds_read_b64_tr_b16 v[52:53], v7 offset:57344
    v_mfma_f32_16x16x32_bf16 v[124:127], v[80:83], v[60:63], v[124:127]
    ds_read_b64_tr_b16 v[54:55], v7 offset:57856
    v_mfma_f32_16x16x32_bf16 v[128:131], v[80:83], v[64:67], v[128:131]
    v_mfma_f32_16x16x32_bf16 v[132:135], v[80:83], v[68:71], v[132:135]
    v_mfma_f32_16x16x32_bf16 v[136:139], v[84:87], v[56:59], v[136:139]
    v_mfma_f32_16x16x32_bf16 v[140:143], v[84:87], v[60:63], v[140:143]
    v_mfma_f32_16x16x32_bf16 v[144:147], v[84:87], v[64:67], v[144:147]
    v_mfma_f32_16x16x32_bf16 v[148:151], v[84:87], v[68:71], v[148:151]
    s_waitcnt lgkmcnt(9)
    v_mfma_f32_16x16x32_bf16 v[88:91], v[40:43], v[24:27], v[88:91]
    ds_read_b64_tr_b16 v[72:73], v6 offset:53248
    ds_read_b64_tr_b16 v[74:75], v6 offset:53760
    s_waitcnt lgkmcnt(10)
    v_mfma_f32_16x16x32_bf16 v[92:95], v[40:43], v[28:31], v[92:95]
    ds_read_b128 v[56:59], v4 offset:40960
    s_waitcnt lgkmcnt(10)
    v_mfma_f32_16x16x32_bf16 v[96:99], v[40:43], v[32:35], v[96:99]
    ds_read_b128 v[60:63], v4 offset:41984
    ds_read_b128 v[64:67], v4 offset:43008
    s_waitcnt lgkmcnt(11)
    v_mfma_f32_16x16x32_bf16 v[100:103], v[40:43], v[36:39], v[100:103]
    ds_read_b128 v[68:71], v4 offset:44032
    s_waitcnt lgkmcnt(10)
    v_mfma_f32_16x16x32_bf16 v[104:107], v[44:47], v[24:27], v[104:107]
    ds_read_b64_tr_b16 v[76:77], v7 offset:53248
    ds_read_b64_tr_b16 v[78:79], v7 offset:53760
    v_mfma_f32_16x16x32_bf16 v[108:111], v[44:47], v[28:31], v[108:111]
    ds_read_b64_tr_b16 v[80:81], v6 offset:61440
    v_mfma_f32_16x16x32_bf16 v[112:115], v[44:47], v[32:35], v[112:115]
    ds_read_b64_tr_b16 v[82:83], v6 offset:61952
    ds_read_b64_tr_b16 v[84:85], v7 offset:61440
    v_mfma_f32_16x16x32_bf16 v[116:119], v[44:47], v[36:39], v[116:119]
    ds_read_b64_tr_b16 v[86:87], v7 offset:61952
    s_waitcnt lgkmcnt(14)
    v_mfma_f32_16x16x32_bf16 v[120:123], v[48:51], v[24:27], v[120:123]
    v_mfma_f32_16x16x32_bf16 v[124:127], v[48:51], v[28:31], v[124:127]
    v_mfma_f32_16x16x32_bf16 v[128:131], v[48:51], v[32:35], v[128:131]
    v_mfma_f32_16x16x32_bf16 v[132:135], v[48:51], v[36:39], v[132:135]
    s_waitcnt lgkmcnt(12)
    v_mfma_f32_16x16x32_bf16 v[136:139], v[52:55], v[24:27], v[136:139]
    v_mfma_f32_16x16x32_bf16 v[140:143], v[52:55], v[28:31], v[140:143]
    v_mfma_f32_16x16x32_bf16 v[144:147], v[52:55], v[32:35], v[144:147]
    v_mfma_f32_16x16x32_bf16 v[148:151], v[52:55], v[36:39], v[148:151]
    s_waitcnt vmcnt(0) lgkmcnt(0)
    s_barrier
    v_mfma_f32_16x16x32_bf16 v[88:91], v[72:75], v[56:59], v[88:91]
    ds_read_b64_tr_b16 v[40:41], v8 offset:16384
    ds_read_b64_tr_b16 v[42:43], v8 offset:16896
    v_mfma_f32_16x16x32_bf16 v[92:95], v[72:75], v[60:63], v[92:95]
    ds_read_b128 v[24:27], v5 offset:0
    v_mfma_f32_16x16x32_bf16 v[96:99], v[72:75], v[64:67], v[96:99]
    ds_read_b128 v[28:31], v5 offset:1024
    v_mfma_f32_16x16x32_bf16 v[100:103], v[72:75], v[68:71], v[100:103]
    ds_read_b128 v[32:35], v5 offset:2048
    v_mfma_f32_16x16x32_bf16 v[104:107], v[76:79], v[56:59], v[104:107]
    ds_read_b128 v[36:39], v5 offset:3072
    v_mfma_f32_16x16x32_bf16 v[108:111], v[76:79], v[60:63], v[108:111]
    ds_read_b64_tr_b16 v[44:45], v9 offset:16384
    ds_read_b64_tr_b16 v[46:47], v9 offset:16896
    v_mfma_f32_16x16x32_bf16 v[112:115], v[76:79], v[64:67], v[112:115]
    ds_read_b64_tr_b16 v[48:49], v8 offset:24576
    v_mfma_f32_16x16x32_bf16 v[116:119], v[76:79], v[68:71], v[116:119]
    ds_read_b64_tr_b16 v[50:51], v8 offset:25088
    v_mfma_f32_16x16x32_bf16 v[120:123], v[80:83], v[56:59], v[120:123]
    ds_read_b64_tr_b16 v[52:53], v9 offset:24576
    v_mfma_f32_16x16x32_bf16 v[124:127], v[80:83], v[60:63], v[124:127]
    ds_read_b64_tr_b16 v[54:55], v9 offset:25088
    v_mfma_f32_16x16x32_bf16 v[128:131], v[80:83], v[64:67], v[128:131]
    v_mfma_f32_16x16x32_bf16 v[132:135], v[80:83], v[68:71], v[132:135]
    v_mfma_f32_16x16x32_bf16 v[136:139], v[84:87], v[56:59], v[136:139]
    v_mfma_f32_16x16x32_bf16 v[140:143], v[84:87], v[60:63], v[140:143]
    v_mfma_f32_16x16x32_bf16 v[144:147], v[84:87], v[64:67], v[144:147]
    v_mfma_f32_16x16x32_bf16 v[148:151], v[84:87], v[68:71], v[148:151]
    s_waitcnt lgkmcnt(9)
    v_mfma_f32_16x16x32_bf16 v[88:91], v[40:43], v[24:27], v[88:91]
    ds_read_b64_tr_b16 v[72:73], v8 offset:20480
    ds_read_b64_tr_b16 v[74:75], v8 offset:20992
    s_waitcnt lgkmcnt(10)
    v_mfma_f32_16x16x32_bf16 v[92:95], v[40:43], v[28:31], v[92:95]
    ds_read_b128 v[56:59], v5 offset:8192
    s_waitcnt lgkmcnt(10)
    v_mfma_f32_16x16x32_bf16 v[96:99], v[40:43], v[32:35], v[96:99]
    ds_read_b128 v[60:63], v5 offset:9216
    ds_read_b128 v[64:67], v5 offset:10240
    s_waitcnt lgkmcnt(11)
    v_mfma_f32_16x16x32_bf16 v[100:103], v[40:43], v[36:39], v[100:103]
    ds_read_b128 v[68:71], v5 offset:11264
    s_waitcnt lgkmcnt(10)
    v_mfma_f32_16x16x32_bf16 v[104:107], v[44:47], v[24:27], v[104:107]
    ds_read_b64_tr_b16 v[76:77], v9 offset:20480
    ds_read_b64_tr_b16 v[78:79], v9 offset:20992
    v_mfma_f32_16x16x32_bf16 v[108:111], v[44:47], v[28:31], v[108:111]
    ds_read_b64_tr_b16 v[80:81], v8 offset:28672
    v_mfma_f32_16x16x32_bf16 v[112:115], v[44:47], v[32:35], v[112:115]
    ds_read_b64_tr_b16 v[82:83], v8 offset:29184
    ds_read_b64_tr_b16 v[84:85], v9 offset:28672
    v_mfma_f32_16x16x32_bf16 v[116:119], v[44:47], v[36:39], v[116:119]
    ds_read_b64_tr_b16 v[86:87], v9 offset:29184
    s_waitcnt lgkmcnt(14)
    v_mfma_f32_16x16x32_bf16 v[120:123], v[48:51], v[24:27], v[120:123]
    v_mfma_f32_16x16x32_bf16 v[124:127], v[48:51], v[28:31], v[124:127]
    v_mfma_f32_16x16x32_bf16 v[128:131], v[48:51], v[32:35], v[128:131]
    v_mfma_f32_16x16x32_bf16 v[132:135], v[48:51], v[36:39], v[132:135]
    s_waitcnt lgkmcnt(12)
    v_mfma_f32_16x16x32_bf16 v[136:139], v[52:55], v[24:27], v[136:139]
    v_mfma_f32_16x16x32_bf16 v[140:143], v[52:55], v[28:31], v[140:143]
    v_mfma_f32_16x16x32_bf16 v[144:147], v[52:55], v[32:35], v[144:147]
    v_mfma_f32_16x16x32_bf16 v[148:151], v[52:55], v[36:39], v[148:151]
    s_waitcnt lgkmcnt(0)
    s_barrier
    v_mfma_f32_16x16x32_bf16 v[88:91], v[72:75], v[56:59], v[88:91]
    v_mfma_f32_16x16x32_bf16 v[92:95], v[72:75], v[60:63], v[92:95]
    v_mfma_f32_16x16x32_bf16 v[96:99], v[72:75], v[64:67], v[96:99]
    v_mfma_f32_16x16x32_bf16 v[100:103], v[72:75], v[68:71], v[100:103]
    v_mfma_f32_16x16x32_bf16 v[104:107], v[76:79], v[56:59], v[104:107]
    v_mfma_f32_16x16x32_bf16 v[108:111], v[76:79], v[60:63], v[108:111]
    v_mfma_f32_16x16x32_bf16 v[112:115], v[76:79], v[64:67], v[112:115]
    v_mfma_f32_16x16x32_bf16 v[116:119], v[76:79], v[68:71], v[116:119]
    v_mfma_f32_16x16x32_bf16 v[120:123], v[80:83], v[56:59], v[120:123]
    v_mfma_f32_16x16x32_bf16 v[124:127], v[80:83], v[60:63], v[124:127]
    v_mfma_f32_16x16x32_bf16 v[128:131], v[80:83], v[64:67], v[128:131]
    v_mfma_f32_16x16x32_bf16 v[132:135], v[80:83], v[68:71], v[132:135]
    v_mfma_f32_16x16x32_bf16 v[136:139], v[84:87], v[56:59], v[136:139]
    v_mfma_f32_16x16x32_bf16 v[140:143], v[84:87], v[60:63], v[140:143]
    v_mfma_f32_16x16x32_bf16 v[144:147], v[84:87], v[64:67], v[144:147]
    v_mfma_f32_16x16x32_bf16 v[148:151], v[84:87], v[68:71], v[148:151]
    s_setprio 0
    s_lshl_b32 s84, s2, 15
    s_lshl_b32 s85, s4, 13
    s_add_u32 s84, s84, s85
    s_add_u32 s36, s84, 0x1600000
    s_add_u32 s37, s36, 4096
    s_xor_b32 s38, s36, 32768
    s_xor_b32 s39, s37, 32768
    v_lshlrev_b32 v4, 4, v1
    s_nop 3
    buffer_store_dwordx4 v[120:123], v4, s[68:71], s36 offen offset:0 sc1
    buffer_store_dwordx4 v[124:127], v4, s[68:71], s36 offen offset:1024 sc1
    buffer_store_dwordx4 v[128:131], v4, s[68:71], s36 offen offset:2048 sc1
    buffer_store_dwordx4 v[132:135], v4, s[68:71], s36 offen offset:3072 sc1
    buffer_store_dwordx4 v[136:139], v4, s[68:71], s37 offen offset:0 sc1
    buffer_store_dwordx4 v[140:143], v4, s[68:71], s37 offen offset:1024 sc1
    buffer_store_dwordx4 v[144:147], v4, s[68:71], s37 offen offset:2048 sc1
    buffer_store_dwordx4 v[148:151], v4, s[68:71], s37 offen offset:3072 sc1
    s_lshl_b32 s84, s4, 12
    s_add_u32 s84, s84, 131072
    v_lshl_add_u32 v5, v1, 3, s84
    s_barrier
    s_barrier
    s_barrier
    s_barrier
    s_waitcnt vmcnt(0)
    s_barrier
    s_cmp_lg_u32 s4, 0
    s_cbranch_scc1 L_fP
    s_lshl_b32 s84, s28, 4
    s_add_u32 s84, s84, s29
    s_lshl_b32 s84, s84, 7
    s_add_u32 s84, s84, 0x1ea0000
    v_mov_b32 v16, s84
    v_mov_b32 v18, s100
    v_mov_b32 v19, s101
    s_mov_b64 exec, 1
    global_store_dwordx2 v16, v[18:19], s[26:27] sc1
    s_mov_b64 exec, -1
L_fP:
    s_xor_b32 s84, s28, 8
    s_lshl_b32 s84, s84, 4
    s_add_u32 s84, s84, s29
    s_lshl_b32 s84, s84, 7
    s_add_u32 s84, s84, 0x1ea0000
    v_mov_b32 v13, s84
    s_barrier
    s_barrier
    global_load_dwordx2 v[14:15], v13, s[26:27] sc1
    s_barrier
    s_waitcnt vmcnt(0)
    s_movk_i32 s98, 0x4000
L_pP_chk:
    v_cmp_ne_u64 vcc, s[100:101], v[14:15]
    s_nop 1
    s_cmp_eq_u64 vcc, 0
    s_cbranch_scc1 L_pP_ok
    s_sub_u32 s98, s98, 1
    s_cbranch_scc1 L_pP_ok
    s_sleep 1
    global_load_dwordx2 v[14:15], v13, s[26:27] sc1
    s_waitcnt vmcnt(0)
    s_branch L_pP_chk
L_pP_ok:
    buffer_load_dwordx4 v[152:155], v4, s[68:71], s38 offen offset:0 sc1
    buffer_load_dwordx4 v[156:159], v4, s[68:71], s38 offen offset:1024 sc1
    buffer_load_dwordx4 v[160:163], v4, s[68:71], s38 offen offset:2048 sc1
    buffer_load_dwordx4 v[164:167], v4, s[68:71], s38 offen offset:3072 sc1
    buffer_load_dwordx4 v[168:171], v4, s[68:71], s39 offen offset:0 sc1
    buffer_load_dwordx4 v[172:175], v4, s[68:71], s39 offen offset:1024 sc1
    buffer_load_dwordx4 v[176:179], v4, s[68:71], s39 offen offset:2048 sc1
    buffer_load_dwordx4 v[180:183], v4, s[68:71], s39 offen offset:3072 sc1
    s_barrier
    s_barrier
    s_barrier
    s_waitcnt vmcnt(7)
    v_add_f32 v88, v88, v152
    v_add_f32 v89, v89, v153
    v_add_f32 v90, v90, v154
    v_add_f32 v91, v91, v155
    v_cvt_pk_bf16_f32 v28, v88, v89
    v_cvt_pk_bf16_f32 v29, v90, v91
    v_lshlrev_b32 v88, 16, v28
    v_and_b32 v89, 0xffff0000, v28
    v_lshlrev_b32 v90, 16, v29
    v_and_b32 v91, 0xffff0000, v29
    v_mul_f32 v24, 0xbfb8aa3b, v88
    v_mul_f32 v25, 0xbfb8aa3b, v89
    v_mul_f32 v26, 0xbfb8aa3b, v90
    v_mul_f32 v27, 0xbfb8aa3b, v91
    v_exp_f32 v24, v24
    v_exp_f32 v25, v25
    v_exp_f32 v26, v26
    v_exp_f32 v27, v27
    s_nop 0
    v_add_f32 v24, 1.0, v24
    v_add_f32 v25, 1.0, v25
    v_add_f32 v26, 1.0, v26
    v_add_f32 v27, 1.0, v27
    v_rcp_f32 v24, v24
    v_rcp_f32 v25, v25
    v_rcp_f32 v26, v26
    v_rcp_f32 v27, v27
    s_nop 0
    v_mul_f32 v24, v24, v88
    v_mul_f32 v25, v25, v89
    v_mul_f32 v26, v26, v90
    v_mul_f32 v27, v27, v91
    v_cvt_pk_bf16_f32 v88, v24, v25
    v_cvt_pk_bf16_f32 v89, v26, v27
    ds_write_b64 v5, v[88:89] offset:0
    s_waitcnt vmcnt(6)
    v_add_f32 v92, v92, v156
    v_add_f32 v93, v93, v157
    v_add_f32 v94, v94, v158
    v_add_f32 v95, v95, v159
    v_cvt_pk_bf16_f32 v28, v92, v93
    v_cvt_pk_bf16_f32 v29, v94, v95
    v_lshlrev_b32 v92, 16, v28
    v_and_b32 v93, 0xffff0000, v28
    v_lshlrev_b32 v94, 16, v29
    v_and_b32 v95, 0xffff0000, v29
    v_mul_f32 v24, 0xbfb8aa3b, v92
    v_mul_f32 v25, 0xbfb8aa3b, v93
    v_mul_f32 v26, 0xbfb8aa3b, v94
    v_mul_f32 v27, 0xbfb8aa3b, v95
    v_exp_f32 v24, v24
    v_exp_f32 v25, v25
    v_exp_f32 v26, v26
    v_exp_f32 v27, v27
    s_nop 0
    v_add_f32 v24, 1.0, v24
    v_add_f32 v25, 1.0, v25
    v_add_f32 v26, 1.0, v26
    v_add_f32 v27, 1.0, v27
    v_rcp_f32 v24, v24
    v_rcp_f32 v25, v25
    v_rcp_f32 v26, v26
    v_rcp_f32 v27, v27
    s_nop 0
    v_mul_f32 v24, v24, v92
    v_mul_f32 v25, v25, v93
    v_mul_f32 v26, v26, v94
    v_mul_f32 v27, v27, v95
    v_cvt_pk_bf16_f32 v92, v24, v25
    v_cvt_pk_bf16_f32 v93, v26, v27
    s_barrier
    ds_write_b64 v5, v[92:93] offset:512
    s_waitcnt vmcnt(5)
    v_add_f32 v96, v96, v160
    v_add_f32 v97, v97, v161
    v_add_f32 v98, v98, v162
    v_add_f32 v99, v99, v163
    v_cvt_pk_bf16_f32 v28, v96, v97
    v_cvt_pk_bf16_f32 v29, v98, v99
    v_lshlrev_b32 v96, 16, v28
    v_and_b32 v97, 0xffff0000, v28
    v_lshlrev_b32 v98, 16, v29
    v_and_b32 v99, 0xffff0000, v29
    v_mul_f32 v24, 0xbfb8aa3b, v96
    v_mul_f32 v25, 0xbfb8aa3b, v97
    v_mul_f32 v26, 0xbfb8aa3b, v98
    v_mul_f32 v27, 0xbfb8aa3b, v99
    v_exp_f32 v24, v24
    v_exp_f32 v25, v25
    v_exp_f32 v26, v26
    v_exp_f32 v27, v27
    s_nop 0
    v_add_f32 v24, 1.0, v24
    v_add_f32 v25, 1.0, v25
    v_add_f32 v26, 1.0, v26
    v_add_f32 v27, 1.0, v27
    v_rcp_f32 v24, v24
    v_rcp_f32 v25, v25
    v_rcp_f32 v26, v26
    v_rcp_f32 v27, v27
    s_nop 0
    v_mul_f32 v24, v24, v96
    v_mul_f32 v25, v25, v97
    v_mul_f32 v26, v26, v98
    v_mul_f32 v27, v27, v99
    v_cvt_pk_bf16_f32 v96, v24, v25
    v_cvt_pk_bf16_f32 v97, v26, v27
    ds_write_b64 v5, v[96:97] offset:1024
    s_waitcnt vmcnt(4)
    v_add_f32 v100, v100, v164
    v_add_f32 v101, v101, v165
    v_add_f32 v102, v102, v166
    v_add_f32 v103, v103, v167
    v_cvt_pk_bf16_f32 v28, v100, v101
    v_cvt_pk_bf16_f32 v29, v102, v103
    v_lshlrev_b32 v100, 16, v28
    v_and_b32 v101, 0xffff0000, v28
    v_lshlrev_b32 v102, 16, v29
    v_and_b32 v103, 0xffff0000, v29
    v_mul_f32 v24, 0xbfb8aa3b, v100
    v_mul_f32 v25, 0xbfb8aa3b, v101
    v_mul_f32 v26, 0xbfb8aa3b, v102
    v_mul_f32 v27, 0xbfb8aa3b, v103
    v_exp_f32 v24, v24
    v_exp_f32 v25, v25
    v_exp_f32 v26, v26
    v_exp_f32 v27, v27
    s_nop 0
    v_add_f32 v24, 1.0, v24
    v_add_f32 v25, 1.0, v25
    v_add_f32 v26, 1.0, v26
    v_add_f32 v27, 1.0, v27
    v_rcp_f32 v24, v24
    v_rcp_f32 v25, v25
    v_rcp_f32 v26, v26
    v_rcp_f32 v27, v27
    s_nop 0
    v_mul_f32 v24, v24, v100
    v_mul_f32 v25, v25, v101
    v_mul_f32 v26, v26, v102
    v_mul_f32 v27, v27, v103
    v_cvt_pk_bf16_f32 v100, v24, v25
    v_cvt_pk_bf16_f32 v101, v26, v27
    s_barrier
    ds_write_b64 v5, v[100:101] offset:1536
    s_waitcnt vmcnt(3)
    v_add_f32 v104, v104, v168
    v_add_f32 v105, v105, v169
    v_add_f32 v106, v106, v170
    v_add_f32 v107, v107, v171
    v_cvt_pk_bf16_f32 v28, v104, v105
    v_cvt_pk_bf16_f32 v29, v106, v107
    v_lshlrev_b32 v104, 16, v28
    v_and_b32 v105, 0xffff0000, v28
    v_lshlrev_b32 v106, 16, v29
    v_and_b32 v107, 0xffff0000, v29
    v_mul_f32 v24, 0xbfb8aa3b, v104
    v_mul_f32 v25, 0xbfb8aa3b, v105
    v_mul_f32 v26, 0xbfb8aa3b, v106
    v_mul_f32 v27, 0xbfb8aa3b, v107
    v_exp_f32 v24, v24
    v_exp_f32 v25, v25
    v_exp_f32 v26, v26
    v_exp_f32 v27, v27
    s_nop 0
    v_add_f32 v24, 1.0, v24
    v_add_f32 v25, 1.0, v25
    v_add_f32 v26, 1.0, v26
    v_add_f32 v27, 1.0, v27
    v_rcp_f32 v24, v24
    v_rcp_f32 v25, v25
    v_rcp_f32 v26, v26
    v_rcp_f32 v27, v27
    s_nop 0
    v_mul_f32 v24, v24, v104
    v_mul_f32 v25, v25, v105
    v_mul_f32 v26, v26, v106
    v_mul_f32 v27, v27, v107
    v_cvt_pk_bf16_f32 v104, v24, v25
    v_cvt_pk_bf16_f32 v105, v26, v27
    ds_write_b64 v5, v[104:105] offset:2048
    s_waitcnt vmcnt(2)
    v_add_f32 v108, v108, v172
    v_add_f32 v109, v109, v173
    v_add_f32 v110, v110, v174
    v_add_f32 v111, v111, v175
    v_cvt_pk_bf16_f32 v28, v108, v109
    v_cvt_pk_bf16_f32 v29, v110, v111
    v_lshlrev_b32 v108, 16, v28
    v_and_b32 v109, 0xffff0000, v28
    v_lshlrev_b32 v110, 16, v29
    v_and_b32 v111, 0xffff0000, v29
    v_mul_f32 v24, 0xbfb8aa3b, v108
    v_mul_f32 v25, 0xbfb8aa3b, v109
    v_mul_f32 v26, 0xbfb8aa3b, v110
    v_mul_f32 v27, 0xbfb8aa3b, v111
    v_exp_f32 v24, v24
    v_exp_f32 v25, v25
    v_exp_f32 v26, v26
    v_exp_f32 v27, v27
    s_nop 0
    v_add_f32 v24, 1.0, v24
    v_add_f32 v25, 1.0, v25
    v_add_f32 v26, 1.0, v26
    v_add_f32 v27, 1.0, v27
    v_rcp_f32 v24, v24
    v_rcp_f32 v25, v25
    v_rcp_f32 v26, v26
    v_rcp_f32 v27, v27
    s_nop 0
    v_mul_f32 v24, v24, v108
    v_mul_f32 v25, v25, v109
    v_mul_f32 v26, v26, v110
    v_mul_f32 v27, v27, v111
    v_cvt_pk_bf16_f32 v108, v24, v25
    v_cvt_pk_bf16_f32 v109, v26, v27
    s_barrier
    ds_write_b64 v5, v[108:109] offset:2560
    s_waitcnt vmcnt(1)
    v_add_f32 v112, v112, v176
    v_add_f32 v113, v113, v177
    v_add_f32 v114, v114, v178
    v_add_f32 v115, v115, v179
    v_cvt_pk_bf16_f32 v28, v112, v113
    v_cvt_pk_bf16_f32 v29, v114, v115
    v_lshlrev_b32 v112, 16, v28
    v_and_b32 v113, 0xffff0000, v28
    v_lshlrev_b32 v114, 16, v29
    v_and_b32 v115, 0xffff0000, v29
    v_mul_f32 v24, 0xbfb8aa3b, v112
    v_mul_f32 v25, 0xbfb8aa3b, v113
    v_mul_f32 v26, 0xbfb8aa3b, v114
    v_mul_f32 v27, 0xbfb8aa3b, v115
    v_exp_f32 v24, v24
    v_exp_f32 v25, v25
    v_exp_f32 v26, v26
    v_exp_f32 v27, v27
    s_nop 0
    v_add_f32 v24, 1.0, v24
    v_add_f32 v25, 1.0, v25
    v_add_f32 v26, 1.0, v26
    v_add_f32 v27, 1.0, v27
    v_rcp_f32 v24, v24
    v_rcp_f32 v25, v25
    v_rcp_f32 v26, v26
    v_rcp_f32 v27, v27
    s_nop 0
    v_mul_f32 v24, v24, v112
    v_mul_f32 v25, v25, v113
    v_mul_f32 v26, v26, v114
    v_mul_f32 v27, v27, v115
    v_cvt_pk_bf16_f32 v112, v24, v25
    v_cvt_pk_bf16_f32 v113, v26, v27
    ds_write_b64 v5, v[112:113] offset:3072
    s_waitcnt vmcnt(0)
    v_add_f32 v116, v116, v180
    v_add_f32 v117, v117, v181
    v_add_f32 v118, v118, v182
    v_add_f32 v119, v119, v183
    v_cvt_pk_bf16_f32 v28, v116, v117
    v_cvt_pk_bf16_f32 v29, v118, v119
    v_lshlrev_b32 v116, 16, v28
    v_and_b32 v117, 0xffff0000, v28
    v_lshlrev_b32 v118, 16, v29
    v_and_b32 v119, 0xffff0000, v29
    v_mul_f32 v24, 0xbfb8aa3b, v116
    v_mul_f32 v25, 0xbfb8aa3b, v117
    v_mul_f32 v26, 0xbfb8aa3b, v118
    v_mul_f32 v27, 0xbfb8aa3b, v119
    v_exp_f32 v24, v24
    v_exp_f32 v25, v25
    v_exp_f32 v26, v26
    v_exp_f32 v27, v27
    s_nop 0
    v_add_f32 v24, 1.0, v24
    v_add_f32 v25, 1.0, v25
    v_add_f32 v26, 1.0, v26
    v_add_f32 v27, 1.0, v27
    v_rcp_f32 v24, v24
    v_rcp_f32 v25, v25
    v_rcp_f32 v26, v26
    v_rcp_f32 v27, v27
    s_nop 0
    v_mul_f32 v24, v24, v116
    v_mul_f32 v25, v25, v117
    v_mul_f32 v26, v26, v118
    v_mul_f32 v27, v27, v119
    v_cvt_pk_bf16_f32 v116, v24, v25
    v_cvt_pk_bf16_f32 v117, v26, v27
    s_barrier
    ds_write_b64 v5, v[116:117] offset:3584
    s_waitcnt lgkmcnt(0)
    s_barrier
    s_branch L_fin
L_teamB:
    s_lshl_b32 s84, s28, 7
    s_lshl_b32 s85, s29, 3
    s_add_u32 s84, s84, s85
    s_lshl1_add_u32 s84, s4, s84
    s_lshl_b32 s90, s84, 3
    s_lshl_b32 s84, s84, 11
    v_lshl_add_u32 v4, v1, 4, s84
    s_cmp_lt_u32 s4, 2
    s_cselect_b32 s36, s16, s18
    s_cselect_b32 s37, s17, s19
    s_mov_b32 s38, 7340032
    s_mov_b32 s39, 0x20000
    s_mul_i32 s84, s29, 320
    s_and_b32 s85, s29, 1
    s_lshl_b32 s86, s85, 6
    s_add_u32 s86, s86, s84
    s_lshl_b32 s87, s6, 7
    s_add_u32 s86, s86, s87
    s_xor_b32 s85, s85, 1
    s_lshl_b32 s85, s85, 8
    s_add_u32 s85, s85, s84
    s_lshl_b32 s87, s6, 5
    s_add_u32 s85, s85, s87
    s_mul_i32 s87, s28, 458752
    s_add_u32 s86, s86, s87
    s_add_u32 s85, s85, s87
    v_lshrrev_b32 v64, 3, v1
    v_and_b32 v65, 7, v1
    v_mul_u32_u24 v64, 7168, v64
    v_lshl_add_u32 v64, v65, 4, v64
    v_add_u32 v5, s86, v64
    v_lshrrev_b32 v64, 1, v1
    v_and_b32 v65, 1, v1
    v_mul_u32_u24 v64, 7168, v64
    v_lshl_add_u32 v64, v65, 4, v64
    v_add_u32 v6, s85, v64
    s_barrier
    global_load_dwordx4 v[24:27], v4, s[8:9] offset:0
    global_load_dwordx4 v[28:31], v4, s[8:9] offset:1024
    global_load_dwordx4 v[32:35], v4, s[8:9] offset:2048
    global_load_dwordx4 v[36:39], v4, s[8:9] offset:3072
    s_lshr_b32 s85, s28, 2
    s_cmp_lg_u32 s85, 0
    s_cbranch_scc1 L_cs0
    s_mov_b32 s84, 0
    buffer_load_dwordx4 v[88:91], v5, s[36:39], s84 offen
    s_mov_b32 s84, 57344
    buffer_load_dwordx4 v[92:95], v5, s[36:39], s84 offen
    s_mov_b32 s84, 114688
    buffer_load_dwordx4 v[96:99], v5, s[36:39], s84 offen
    s_mov_b32 s84, 172032
    buffer_load_dwordx4 v[100:103], v5, s[36:39], s84 offen
    s_mov_b32 s84, 229376
    buffer_load_dwordx4 v[104:107], v5, s[36:39], s84 offen
    s_mov_b32 s84, 286720
    buffer_load_dwordx4 v[108:111], v5, s[36:39], s84 offen
    s_mov_b32 s84, 344064
    buffer_load_dwordx4 v[112:115], v5, s[36:39], s84 offen
    s_mov_b32 s84, 401408
    buffer_load_dwordx4 v[116:119], v5, s[36:39], s84 offen
    s_mov_b32 s84, 0
    buffer_load_dwordx4 v[120:123], v6, s[36:39], s84 offen
    s_mov_b32 s84, 229376
    buffer_load_dwordx4 v[124:127], v6, s[36:39], s84 offen
L_cs0:
    s_or_b32 s84, s2, s4
    s_cbranch_scc1 L_notok
    s_memrealtime s[84:85]
    v_mov_b32 v64, 0
    s_waitcnt lgkmcnt(0)
    s_or_b32 s84, s84, 1
    v_mov_b32 v66, s84
    v_mov_b32 v67, s85
    s_mov_b64 exec, 1
    global_store_dwordx2 v64, v[66:67], s[24:25] sc1
    s_mov_b64 exec, -1
L_notok:
    s_barrier
    s_barrier
    s_lshr_b32 s85, s28, 2
    s_cmp_lg_u32 s85, 1
    s_cbranch_scc1 L_cs1
    s_mov_b32 s84, 0
    buffer_load_dwordx4 v[88:91], v5, s[36:39], s84 offen
    s_mov_b32 s84, 57344
    buffer_load_dwordx4 v[92:95], v5, s[36:39], s84 offen
    s_mov_b32 s84, 114688
    buffer_load_dwordx4 v[96:99], v5, s[36:39], s84 offen
    s_mov_b32 s84, 172032
    buffer_load_dwordx4 v[100:103], v5, s[36:39], s84 offen
    s_mov_b32 s84, 229376
    buffer_load_dwordx4 v[104:107], v5, s[36:39], s84 offen
    s_mov_b32 s84, 286720
    buffer_load_dwordx4 v[108:111], v5, s[36:39], s84 offen
    s_mov_b32 s84, 344064
    buffer_load_dwordx4 v[112:115], v5, s[36:39], s84 offen
    s_mov_b32 s84, 401408
    buffer_load_dwordx4 v[116:119], v5, s[36:39], s84 offen
    s_mov_b32 s84, 0
    buffer_load_dwordx4 v[120:123], v6, s[36:39], s84 offen
    s_mov_b32 s84, 229376
    buffer_load_dwordx4 v[124:127], v6, s[36:39], s84 offen
L_cs1:
    s_barrier
    s_barrier
    s_barrier
    s_waitcnt vmcnt(0)
    v_lshlrev_b32 v40, 16, v24
    v_and_b32 v41, 0xffff0000, v24
    v_lshlrev_b32 v42, 16, v25
    v_and_b32 v43, 0xffff0000, v25
    v_lshlrev_b32 v44, 16, v26
    v_and_b32 v45, 0xffff0000, v26
    v_lshlrev_b32 v46, 16, v27
    v_and_b32 v47, 0xffff0000, v27
    v_lshlrev_b32 v48, 16, v28
    v_and_b32 v49, 0xffff0000, v28
    v_lshlrev_b32 v50, 16, v29
    v_and_b32 v51, 0xffff0000, v29
    v_lshlrev_b32 v52, 16, v30
    v_and_b32 v53, 0xffff0000, v30
    v_lshlrev_b32 v54, 16, v31
    v_and_b32 v55, 0xffff0000, v31
    v_lshlrev_b32 v56, 16, v32
    v_and_b32 v57, 0xffff0000, v32
    v_lshlrev_b32 v58, 16, v33
    v_and_b32 v59, 0xffff0000, v33
    v_lshlrev_b32 v60, 16, v34
    v_and_b32 v61, 0xffff0000, v34
    v_lshlrev_b32 v62, 16, v35
    v_and_b32 v63, 0xffff0000, v35
    v_lshlrev_b32 v64, 16, v36
    v_and_b32 v65, 0xffff0000, v36
    v_lshlrev_b32 v66, 16, v37
    v_and_b32 v67, 0xffff0000, v37
    v_lshlrev_b32 v68, 16, v38
    v_and_b32 v69, 0xffff0000, v38
    v_lshlrev_b32 v70, 16, v39
    v_and_b32 v71, 0xffff0000, v39
    v_add_f32 v72, v40, v41
    v_add_f32 v74, v56, v57
    v_add_f32 v72, v72, v42
    v_add_f32 v74, v74, v58
    v_add_f32 v72, v72, v43
    v_add_f32 v74, v74, v59
    v_add_f32 v72, v72, v44
    v_add_f32 v74, v74, v60
    v_add_f32 v72, v72, v45
    v_add_f32 v74, v74, v61
    v_add_f32 v72, v72, v46
    v_add_f32 v74, v74, v62
    v_add_f32 v72, v72, v47
    v_add_f32 v74, v74, v63
    v_add_f32 v72, v72, v48
    v_add_f32 v74, v74, v64
    v_add_f32 v72, v72, v49
    v_add_f32 v74, v74, v65
    v_add_f32 v72, v72, v50
    v_add_f32 v74, v74, v66
    v_add_f32 v72, v72, v51
    v_add_f32 v74, v74, v67
    v_add_f32 v72, v72, v52
    v_add_f32 v74, v74, v68
    v_add_f32 v72, v72, v53
    v_add_f32 v74, v74, v69
    v_add_f32 v72, v72, v54
    v_add_f32 v74, v74, v70
    v_add_f32 v72, v72, v55
    v_add_f32 v74, v74, v71
    s_nop 0
    v_add_f32_dpp v72, v72, v72 quad_perm:[1,0,3,2] row_mask:0xf bank_mask:0xf
    v_add_f32_dpp v74, v74, v74 quad_perm:[1,0,3,2] row_mask:0xf bank_mask:0xf
    s_nop 0
    v_add_f32_dpp v72, v72, v72 quad_perm:[2,3,0,1] row_mask:0xf bank_mask:0xf
    v_add_f32_dpp v74, v74, v74 quad_perm:[2,3,0,1] row_mask:0xf bank_mask:0xf
    s_nop 0
    v_add_f32_dpp v72, v72, v72 row_half_mirror row_mask:0xf bank_mask:0xf
    v_add_f32_dpp v74, v74, v74 row_half_mirror row_mask:0xf bank_mask:0xf
    s_nop 0
    v_add_f32_dpp v72, v72, v72 row_mirror row_mask:0xf bank_mask:0xf
    v_add_f32_dpp v74, v74, v74 row_mirror row_mask:0xf bank_mask:0xf
    v_mov_b32 v78, v72
    v_mov_b32 v79, v74
    s_nop 0
    v_permlane16_swap_b32 v72, v78
    v_permlane16_swap_b32 v74, v79
    v_add_f32 v72, v72, v78
    v_add_f32 v74, v74, v79
    v_mov_b32 v78, v72
    v_mov_b32 v79, v74
    s_nop 0
    v_permlane32_swap_b32 v72, v78
    s_barrier
    s_lshr_b32 s85, s28, 2
    s_cmp_lg_u32 s85, 2
    s_cbranch_scc1 L_cs2
    s_mov_b32 s84, 0
    buffer_load_dwordx4 v[88:91], v5, s[36:39], s84 offen
    s_mov_b32 s84, 57344
    buffer_load_dwordx4 v[92:95], v5, s[36:39], s84 offen
    s_mov_b32 s84, 114688
    buffer_load_dwordx4 v[96:99], v5, s[36:39], s84 offen
    s_mov_b32 s84, 172032
    buffer_load_dwordx4 v[100:103], v5, s[36:39], s84 offen
    s_mov_b32 s84, 229376
    buffer_load_dwordx4 v[104:107], v5, s[36:39], s84 offen
    s_mov_b32 s84, 286720
    buffer_load_dwordx4 v[108:111], v5, s[36:39], s84 offen
    s_mov_b32 s84, 344064
    buffer_load_dwordx4 v[112:115], v5, s[36:39], s84 offen
    s_mov_b32 s84, 401408
    buffer_load_dwordx4 v[116:119], v5, s[36:39], s84 offen
    s_mov_b32 s84, 0
    buffer_load_dwordx4 v[120:123], v6, s[36:39], s84 offen
    s_mov_b32 s84, 229376
    buffer_load_dwordx4 v[124:127], v6, s[36:39], s84 offen
L_cs2:
    v_permlane32_swap_b32 v74, v79
    v_add_f32 v72, v72, v78
    v_add_f32 v74, v74, v79
    v_mul_f32 v72, 0x3a800000, v72
    v_mul_f32 v74, 0x3a800000, v74
    v_sub_f32 v78, v40, v72
    v_sub_f32 v79, v56, v74
    v_mul_f32 v73, v78, v78
    v_mul_f32 v75, v79, v79
    v_sub_f32 v78, v41, v72
    v_sub_f32 v79, v57, v74
    v_fmac_f32 v73, v78, v78
    v_fmac_f32 v75, v79, v79
    v_sub_f32 v78, v42, v72
    v_sub_f32 v79, v58, v74
    v_fmac_f32 v73, v78, v78
    v_fmac_f32 v75, v79, v79
    v_sub_f32 v78, v43, v72
    v_sub_f32 v79, v59, v74
    v_fmac_f32 v73, v78, v78
    v_fmac_f32 v75, v79, v79
    v_sub_f32 v78, v44, v72
    v_sub_f32 v79, v60, v74
    v_fmac_f32 v73, v78, v78
    v_fmac_f32 v75, v79, v79
    v_sub_f32 v78, v45, v72
    v_sub_f32 v79, v61, v74
    v_fmac_f32 v73, v78, v78
    v_fmac_f32 v75, v79, v79
    v_sub_f32 v78, v46, v72
    v_sub_f32 v79, v62, v74
    v_fmac_f32 v73, v78, v78
    v_fmac_f32 v75, v79, v79
    v_sub_f32 v78, v47, v72
    v_sub_f32 v79, v63, v74
    v_fmac_f32 v73, v78, v78
    v_fmac_f32 v75, v79, v79
    v_sub_f32 v78, v48, v72
    v_sub_f32 v79, v64, v74
    v_fmac_f32 v73, v78, v78
    v_fmac_f32 v75, v79, v79
    v_sub_f32 v78, v49, v72
    v_sub_f32 v79, v65, v74
    v_fmac_f32 v73, v78, v78
    v_fmac_f32 v75, v79, v79
    v_sub_f32 v78, v50, v72
    v_sub_f32 v79, v66, v74
    v_fmac_f32 v73, v78, v78
    v_fmac_f32 v75, v79, v79
    v_sub_f32 v78, v51, v72
    v_sub_f32 v79, v67, v74
    v_fmac_f32 v73, v78, v78
    v_fmac_f32 v75, v79, v79
    v_sub_f32 v78, v52, v72
    v_sub_f32 v79, v68, v74
    v_fmac_f32 v73, v78, v78
    v_fmac_f32 v75, v79, v79
    v_sub_f32 v78, v53, v72
    v_sub_f32 v79, v69, v74
    v_fmac_f32 v73, v78, v78
    v_fmac_f32 v75, v79, v79
    v_sub_f32 v78, v54, v72
    v_sub_f32 v79, v70, v74
    v_fmac_f32 v73, v78, v78
    v_fmac_f32 v75, v79, v79
    v_sub_f32 v78, v55, v72
    v_sub_f32 v79, v71, v74
    v_fmac_f32 v73, v78, v78
    v_fmac_f32 v75, v79, v79
    s_nop 0
    v_add_f32_dpp v73, v73, v73 quad_perm:[1,0,3,2] row_mask:0xf bank_mask:0xf
    v_add_f32_dpp v75, v75, v75 quad_perm:[1,0,3,2] row_mask:0xf bank_mask:0xf
    s_nop 0
    v_add_f32_dpp v73, v73, v73 quad_perm:[2,3,0,1] row_mask:0xf bank_mask:0xf
    v_add_f32_dpp v75, v75, v75 quad_perm:[2,3,0,1] row_mask:0xf bank_mask:0xf
    s_nop 0
    v_add_f32_dpp v73, v73, v73 row_half_mirror row_mask:0xf bank_mask:0xf
    v_add_f32_dpp v75, v75, v75 row_half_mirror row_mask:0xf bank_mask:0xf
    s_nop 0
    v_add_f32_dpp v73, v73, v73 row_mirror row_mask:0xf bank_mask:0xf
    v_add_f32_dpp v75, v75, v75 row_mirror row_mask:0xf bank_mask:0xf
    v_mov_b32 v78, v73
    v_mov_b32 v79, v75
    s_barrier
    s_nop 0
    v_permlane16_swap_b32 v73, v78
    v_permlane16_swap_b32 v75, v79
    v_add_f32 v73, v73, v78
    v_add_f32 v75, v75, v79
    v_mov_b32 v78, v73
    v_mov_b32 v79, v75
    s_nop 0
    v_permlane32_swap_b32 v73, v78
    v_permlane32_swap_b32 v75, v79
    v_add_f32 v73, v73, v78
    v_add_f32 v75, v75, v79
    v_mul_f32 v73, 0x3a800000, v73
    v_mul_f32 v75, 0x3a800000, v75
    v_cvt_pk_bf16_f32 v72, v72, v72
    v_lshlrev_b32 v72, 16, v72
    v_cvt_pk_bf16_f32 v73, v73, v73
    v_lshlrev_b32 v73, 16, v73
    v_add_f32 v73, 0x3727c5ac, v73
    v_cvt_pk_bf16_f32 v73, v73, v73
    v_lshlrev_b32 v73, 16, v73
    v_sqrt_f32 v73, v73
    v_cvt_pk_bf16_f32 v74, v74, v74
    v_lshlrev_b32 v74, 16, v74
    v_cvt_pk_bf16_f32 v75, v75, v75
    v_lshlrev_b32 v75, 16, v75
    v_add_f32 v75, 0x3727c5ac, v75
    v_cvt_pk_bf16_f32 v75, v75, v75
    v_lshlrev_b32 v75, 16, v75
    v_sqrt_f32 v75, v75
    s_nop 0
    v_cvt_pk_bf16_f32 v73, v73, v73
    v_lshlrev_b32 v73, 16, v73
    v_rcp_f32 v76, v73
    s_nop 0
    v_cvt_pk_bf16_f32 v75, v75, v75
    v_lshlrev_b32 v75, 16, v75
    v_rcp_f32 v77, v75
    s_nop 0
    v_fma_f32 v78, -v73, v76, 1.0
    v_fma_f32 v76, v78, v76, v76
    s_nop 0
    v_fma_f32 v79, -v75, v77, 1.0
    v_fma_f32 v77, v79, v77, v77
    v_sub_f32 v80, v40, v72
    v_sub_f32 v81, v41, v72
    v_cvt_pk_bf16_f32 v80, v80, v81
    v_and_b32 v81, 0xffff0000, v80
    v_lshlrev_b32 v80, 16, v80
    v_mul_f32 v80, v80, v76
    v_mul_f32 v81, v81, v76
    v_cvt_pk_bf16_f32 v24, v80, v81
    v_sub_f32 v80, v42, v72
    v_sub_f32 v81, v43, v72
    v_cvt_pk_bf16_f32 v80, v80, v81
    v_and_b32 v81, 0xffff0000, v80
    v_lshlrev_b32 v80, 16, v80
    v_mul_f32 v80, v80, v76
    v_mul_f32 v81, v81, v76
    v_cvt_pk_bf16_f32 v25, v80, v81
    v_sub_f32 v80, v44, v72
    v_sub_f32 v81, v45, v72
    v_cvt_pk_bf16_f32 v80, v80, v81
    v_and_b32 v81, 0xffff0000, v80
    v_lshlrev_b32 v80, 16, v80
    v_mul_f32 v80, v80, v76
    v_mul_f32 v81, v81, v76
    v_cvt_pk_bf16_f32 v26, v80, v81
    v_sub_f32 v80, v46, v72
    v_sub_f32 v81, v47, v72
    v_cvt_pk_bf16_f32 v80, v80, v81
    v_and_b32 v81, 0xffff0000, v80
    v_lshlrev_b32 v80, 16, v80
    v_mul_f32 v80, v80, v76
    v_mul_f32 v81, v81, v76
    v_cvt_pk_bf16_f32 v27, v80, v81
    v_sub_f32 v80, v48, v72
    v_sub_f32 v81, v49, v72
    v_cvt_pk_bf16_f32 v80, v80, v81
    v_and_b32 v81, 0xffff0000, v80
    v_lshlrev_b32 v80, 16, v80
    s_barrier
    v_mul_f32 v80, v80, v76
    v_mul_f32 v81, v81, v76
    v_cvt_pk_bf16_f32 v28, v80, v81
    v_sub_f32 v80, v50, v72
    v_sub_f32 v81, v51, v72
    v_cvt_pk_bf16_f32 v80, v80, v81
    v_and_b32 v81, 0xffff0000, v80
    v_lshlrev_b32 v80, 16, v80
    v_mul_f32 v80, v80, v76
    v_mul_f32 v81, v81, v76
    v_cvt_pk_bf16_f32 v29, v80, v81
    v_sub_f32 v80, v52, v72
    v_sub_f32 v81, v53, v72
    v_cvt_pk_bf16_f32 v80, v80, v81
    v_and_b32 v81, 0xffff0000, v80
    v_lshlrev_b32 v80, 16, v80
    v_mul_f32 v80, v80, v76
    v_mul_f32 v81, v81, v76
    v_cvt_pk_bf16_f32 v30, v80, v81
    v_sub_f32 v80, v54, v72
    v_sub_f32 v81, v55, v72
    v_cvt_pk_bf16_f32 v80, v80, v81
    v_and_b32 v81, 0xffff0000, v80
    v_lshlrev_b32 v80, 16, v80
    v_mul_f32 v80, v80, v76
    v_mul_f32 v81, v81, v76
    v_cvt_pk_bf16_f32 v31, v80, v81
    v_sub_f32 v80, v56, v74
    v_sub_f32 v81, v57, v74
    v_cvt_pk_bf16_f32 v80, v80, v81
    v_and_b32 v81, 0xffff0000, v80
    v_lshlrev_b32 v80, 16, v80
    v_mul_f32 v80, v80, v77
    v_mul_f32 v81, v81, v77
    v_cvt_pk_bf16_f32 v32, v80, v81
    v_sub_f32 v80, v58, v74
    v_sub_f32 v81, v59, v74
    v_cvt_pk_bf16_f32 v80, v80, v81
    v_and_b32 v81, 0xffff0000, v80
    v_lshlrev_b32 v80, 16, v80
    v_mul_f32 v80, v80, v77
    v_mul_f32 v81, v81, v77
    v_cvt_pk_bf16_f32 v33, v80, v81
    v_sub_f32 v80, v60, v74
    v_sub_f32 v81, v61, v74
    v_cvt_pk_bf16_f32 v80, v80, v81
    v_and_b32 v81, 0xffff0000, v80
    v_lshlrev_b32 v80, 16, v80
    v_mul_f32 v80, v80, v77
    v_mul_f32 v81, v81, v77
    v_cvt_pk_bf16_f32 v34, v80, v81
    v_sub_f32 v80, v62, v74
    v_sub_f32 v81, v63, v74
    v_cvt_pk_bf16_f32 v80, v80, v81
    v_and_b32 v81, 0xffff0000, v80
    v_lshlrev_b32 v80, 16, v80
    v_mul_f32 v80, v80, v77
    v_mul_f32 v81, v81, v77
    v_cvt_pk_bf16_f32 v35, v80, v81
    v_sub_f32 v80, v64, v74
    v_sub_f32 v81, v65, v74
    v_cvt_pk_bf16_f32 v80, v80, v81
    v_and_b32 v81, 0xffff0000, v80
    v_lshlrev_b32 v80, 16, v80
    v_mul_f32 v80, v80, v77
    v_mul_f32 v81, v81, v77
    v_cvt_pk_bf16_f32 v36, v80, v81
    v_sub_f32 v80, v66, v74
    v_sub_f32 v81, v67, v74
    v_cvt_pk_bf16_f32 v80, v80, v81
    v_and_b32 v81, 0xffff0000, v80
    v_lshlrev_b32 v80, 16, v80
    v_mul_f32 v80, v80, v77
    v_mul_f32 v81, v81, v77
    v_cvt_pk_bf16_f32 v37, v80, v81
    v_sub_f32 v80, v68, v74
    v_sub_f32 v81, v69, v74
    v_cvt_pk_bf16_f32 v80, v80, v81
    v_and_b32 v81, 0xffff0000, v80
    v_lshlrev_b32 v80, 16, v80
    s_barrier
    v_mul_f32 v80, v80, v77
    v_mul_f32 v81, v81, v77
    v_cvt_pk_bf16_f32 v38, v80, v81
    v_sub_f32 v80, v70, v74
    v_sub_f32 v81, v71, v74
    v_cvt_pk_bf16_f32 v80, v80, v81
    v_and_b32 v81, 0xffff0000, v80
    v_lshlrev_b32 v80, 16, v80
    v_mul_f32 v80, v80, v77
    v_mul_f32 v81, v81, v77
    v_cvt_pk_bf16_f32 v39, v80, v81
    global_store_dwordx4 v4, v[24:27], s[26:27] offset:0 sc1
    global_store_dwordx4 v4, v[28:31], s[26:27] offset:1024 sc1
    global_store_dwordx4 v4, v[32:35], s[26:27] offset:2048 sc1
    global_store_dwordx4 v4, v[36:39], s[26:27] offset:3072 sc1
    s_add_u32 s90, s90, 0x1e00000
    v_mov_b32 v7, s90
    s_mov_b64 exec, 1
    global_store_dwordx4 v7, v[72:75], s[26:27] sc1
    s_mov_b64 exec, -1
    s_barrier
    s_lshr_b32 s85, s28, 2
    s_cmp_lg_u32 s85, 3
    s_cbranch_scc1 L_cs3
    s_mov_b32 s84, 0
    buffer_load_dwordx4 v[88:91], v5, s[36:39], s84 offen
    s_mov_b32 s84, 57344
    buffer_load_dwordx4 v[92:95], v5, s[36:39], s84 offen
    s_mov_b32 s84, 114688
    buffer_load_dwordx4 v[96:99], v5, s[36:39], s84 offen
    s_mov_b32 s84, 172032
    buffer_load_dwordx4 v[100:103], v5, s[36:39], s84 offen
    s_mov_b32 s84, 229376
    buffer_load_dwordx4 v[104:107], v5, s[36:39], s84 offen
    s_mov_b32 s84, 286720
    buffer_load_dwordx4 v[108:111], v5, s[36:39], s84 offen
    s_mov_b32 s84, 344064
    buffer_load_dwordx4 v[112:115], v5, s[36:39], s84 offen
    s_mov_b32 s84, 401408
    buffer_load_dwordx4 v[116:119], v5, s[36:39], s84 offen
    s_mov_b32 s84, 0
    buffer_load_dwordx4 v[120:123], v6, s[36:39], s84 offen
    s_mov_b32 s84, 229376
    buffer_load_dwordx4 v[124:127], v6, s[36:39], s84 offen
L_cs3:
    s_barrier
    s_barrier
    s_barrier
    s_barrier
    s_lshl2_add_u32 s84, s2, s4
    s_mul_i32 s84, s84, 6144
    v_min_u32 v148, 47, v1
    v_lshl_add_u32 v148, v148, 7, s84
    s_mov_b32 exec_lo, 0xffffffff
    s_mov_b32 exec_hi, 0xffff
    global_load_dword v0, v148, s[10:11]
    s_mov_b64 exec, -1
    s_waitcnt vmcnt(1)
    v_lshlrev_b32 v128, 16, v88
    v_and_b32 v129, 0xffff0000, v88
    v_lshlrev_b32 v130, 16, v89
    v_and_b32 v131, 0xffff0000, v89
    v_lshlrev_b32 v132, 16, v90
    v_and_b32 v133, 0xffff0000, v90
    v_lshlrev_b32 v134, 16, v91
    v_and_b32 v135, 0xffff0000, v91
    v_lshlrev_b32 v76, 16, v92
    v_and_b32 v92, 0xffff0000, v92
    v_add_f32 v128, v128, v76
    v_add_f32 v129, v129, v92
    v_lshlrev_b32 v76, 16, v93
    v_and_b32 v93, 0xffff0000, v93
    v_add_f32 v130, v130, v76
    v_add_f32 v131, v131, v93
    v_lshlrev_b32 v76, 16, v94
    v_and_b32 v94, 0xffff0000, v94
    v_add_f32 v132, v132, v76
    v_add_f32 v133, v133, v94
    v_lshlrev_b32 v76, 16, v95
    v_and_b32 v95, 0xffff0000, v95
    v_add_f32 v134, v134, v76
    v_add_f32 v135, v135, v95
    v_lshlrev_b32 v76, 16, v96
    v_and_b32 v96, 0xffff0000, v96
    v_add_f32 v128, v128, v76
    v_add_f32 v129, v129, v96
    v_lshlrev_b32 v76, 16, v97
    v_and_b32 v97, 0xffff0000, v97
    v_add_f32 v130, v130, v76
    v_add_f32 v131, v131, v97
    v_lshlrev_b32 v76, 16, v98
    v_and_b32 v98, 0xffff0000, v98
    v_add_f32 v132, v132, v76
    v_add_f32 v133, v133, v98
    v_lshlrev_b32 v76, 16, v99
    v_and_b32 v99, 0xffff0000, v99
    v_add_f32 v134, v134, v76
    v_add_f32 v135, v135, v99
    v_lshlrev_b32 v76, 16, v100
    v_and_b32 v100, 0xffff0000, v100
    v_add_f32 v128, v128, v76
    v_add_f32 v129, v129, v100
    v_lshlrev_b32 v76, 16, v101
    v_and_b32 v101, 0xffff0000, v101
    v_add_f32 v130, v130, v76
    v_add_f32 v131, v131, v101
    v_lshlrev_b32 v76, 16, v102
    v_and_b32 v102, 0xffff0000, v102
    v_add_f32 v132, v132, v76
    v_add_f32 v133, v133, v102
    v_lshlrev_b32 v76, 16, v103
    v_and_b32 v103, 0xffff0000, v103
    v_add_f32 v134, v134, v76
    v_add_f32 v135, v135, v103
    v_lshlrev_b32 v76, 16, v104
    v_and_b32 v104, 0xffff0000, v104
    v_add_f32 v128, v128, v76
    v_add_f32 v129, v129, v104
    v_lshlrev_b32 v76, 16, v105
    v_and_b32 v105, 0xffff0000, v105
    v_add_f32 v130, v130, v76
    v_add_f32 v131, v131, v105
    v_lshlrev_b32 v76, 16, v106
    v_and_b32 v106, 0xffff0000, v106
    v_add_f32 v132, v132, v76
    v_add_f32 v133, v133, v106
    v_lshlrev_b32 v76, 16, v107
    v_and_b32 v107, 0xffff0000, v107
    v_add_f32 v134, v134, v76
    v_add_f32 v135, v135, v107
    v_lshlrev_b32 v76, 16, v108
    v_and_b32 v108, 0xffff0000, v108
    v_add_f32 v128, v128, v76
    v_add_f32 v129, v129, v108
    v_lshlrev_b32 v76, 16, v109
    v_and_b32 v109, 0xffff0000, v109
    v_add_f32 v130, v130, v76
    v_add_f32 v131, v131, v109
    s_barrier
    v_lshlrev_b32 v76, 16, v110
    v_and_b32 v110, 0xffff0000, v110
    v_add_f32 v132, v132, v76
    v_add_f32 v133, v133, v110
    v_lshlrev_b32 v76, 16, v111
    v_and_b32 v111, 0xffff0000, v111
    v_add_f32 v134, v134, v76
    v_add_f32 v135, v135, v111
    v_lshlrev_b32 v76, 16, v112
    v_and_b32 v112, 0xffff0000, v112
    v_add_f32 v128, v128, v76
    v_add_f32 v129, v129, v112
    v_lshlrev_b32 v76, 16, v113
    v_and_b32 v113, 0xffff0000, v113
    v_add_f32 v130, v130, v76
    v_add_f32 v131, v131, v113
    v_lshlrev_b32 v76, 16, v114
    v_and_b32 v114, 0xffff0000, v114
    v_add_f32 v132, v132, v76
    v_add_f32 v133, v133, v114
    v_lshlrev_b32 v76, 16, v115
    v_and_b32 v115, 0xffff0000, v115
    v_add_f32 v134, v134, v76
    v_add_f32 v135, v135, v115
    v_lshlrev_b32 v76, 16, v116
    v_and_b32 v116, 0xffff0000, v116
    v_add_f32 v128, v128, v76
    v_add_f32 v129, v129, v116
    v_lshlrev_b32 v76, 16, v117
    v_and_b32 v117, 0xffff0000, v117
    v_add_f32 v130, v130, v76
    v_add_f32 v131, v131, v117
    v_lshlrev_b32 v76, 16, v118
    v_and_b32 v118, 0xffff0000, v118
    v_add_f32 v132, v132, v76
    v_add_f32 v133, v133, v118
    v_lshlrev_b32 v76, 16, v119
    v_and_b32 v119, 0xffff0000, v119
    v_add_f32 v134, v134, v76
    v_add_f32 v135, v135, v119
    v_lshlrev_b32 v136, 16, v120
    v_and_b32 v137, 0xffff0000, v120
    v_lshlrev_b32 v138, 16, v121
    v_and_b32 v139, 0xffff0000, v121
    v_lshlrev_b32 v140, 16, v122
    v_and_b32 v141, 0xffff0000, v122
    v_lshlrev_b32 v142, 16, v123
    v_and_b32 v143, 0xffff0000, v123
    v_lshlrev_b32 v76, 16, v124
    v_and_b32 v124, 0xffff0000, v124
    v_add_f32 v136, v136, v76
    v_add_f32 v137, v137, v124
    v_lshlrev_b32 v76, 16, v125
    v_and_b32 v125, 0xffff0000, v125
    v_add_f32 v138, v138, v76
    v_add_f32 v139, v139, v125
    v_lshlrev_b32 v76, 16, v126
    v_and_b32 v126, 0xffff0000, v126
    v_add_f32 v140, v140, v76
    v_add_f32 v141, v141, v126
    v_lshlrev_b32 v76, 16, v127
    v_and_b32 v127, 0xffff0000, v127
    v_add_f32 v142, v142, v76
    v_add_f32 v143, v143, v127
    s_nop 1
    v_permlane16_swap_b32 v128, v132
    v_permlane16_swap_b32 v129, v133
    v_permlane16_swap_b32 v130, v134
    v_permlane16_swap_b32 v131, v135
    v_permlane16_swap_b32 v136, v140
    v_permlane16_swap_b32 v137, v141
    v_permlane16_swap_b32 v138, v142
    v_permlane16_swap_b32 v139, v143
    v_add_f32 v128, v128, v132
    v_add_f32 v129, v129, v133
    v_add_f32 v130, v130, v134
    v_add_f32 v131, v131, v135
    v_add_f32 v136, v136, v140
    v_add_f32 v137, v137, v141
    v_add_f32 v138, v138, v142
    s_barrier
    v_add_f32 v139, v139, v143
    s_nop 1
    v_permlane32_swap_b32 v128, v130
    v_permlane32_swap_b32 v129, v131
    v_permlane32_swap_b32 v136, v138
    v_permlane32_swap_b32 v137, v139
    v_add_f32 v128, v128, v130
    v_add_f32 v129, v129, v131
    v_add_f32 v136, v136, v138
    v_add_f32 v137, v137, v139
    s_nop 1
    v_add_f32_dpp v128, v128, v128 row_ror:8 row_mask:0xf bank_mask:0xf
    v_add_f32_dpp v129, v129, v129 row_ror:8 row_mask:0xf bank_mask:0xf
    v_add_f32_dpp v136, v136, v136 row_ror:8 row_mask:0xf bank_mask:0xf
    v_add_f32_dpp v137, v137, v137 row_ror:8 row_mask:0xf bank_mask:0xf
    s_nop 1
    v_add_f32_dpp v136, v136, v136 row_ror:4 row_mask:0xf bank_mask:0xf
    v_add_f32_dpp v137, v137, v137 row_ror:4 row_mask:0xf bank_mask:0xf
    s_nop 1
    v_add_f32_dpp v136, v136, v136 row_ror:2 row_mask:0xf bank_mask:0xf
    v_add_f32_dpp v137, v137, v137 row_ror:2 row_mask:0xf bank_mask:0xf
    v_lshrrev_b32 v76, 4, v1
    v_and_b32 v77, 1, v76
    v_and_b32 v76, 2, v76
    v_lshlrev_b32 v76, 2, v76
    v_lshl_add_u32 v76, v77, 4, v76
    s_lshl_b32 s84, s29, 4
    s_add_u32 s84, s84, s28
    s_mul_i32 s84, s84, 1280
    s_mul_i32 s85, s5, 640
    s_add_u32 s84, s84, s85
    s_add_u32 s84, s84, 0x1e10000
    s_lshl_b32 s85, s6, 8
    s_add_u32 s85, s85, s84
    v_and_b32 v77, 7, v1
    v_lshl_add_u32 v77, v77, 5, v76
    v_add_u32 v77, s85, v77
    s_lshl_b32 s85, s6, 6
    s_add_u32 s85, s85, s84
    s_add_u32 s85, s85, 512
    v_and_b32 v78, 1, v1
    v_lshl_add_u32 v78, v78, 5, v76
    v_add_u32 v78, s85, v78
    global_store_dwordx2 v77, v[128:129], s[26:27] sc1
    global_store_dwordx2 v78, v[136:137], s[26:27] sc1
    s_barrier
    v_mov_b32 v8, 0
    global_load_dwordx2 v[10:11], v8, s[24:25] sc1
    s_barrier
    s_lshl2_add_u32 s84, s2, s4
    s_mul_i32 s85, s84, 7168
    s_add_u32 s85, s85, 5120
    s_lshl_b32 s84, s84, 11
    v_and_b32 v148, 15, v1
    v_lshlrev_b32 v148, 7, v148
    v_mov_b32 v149, 0
    s_add_u32 s86, s16, s85
    s_addc_u32 s87, s17, 0
    v_lshl_add_u64 v[150:151], v[148:149], 0, s[86:87]
    s_add_u32 s86, s18, s85
    s_addc_u32 s87, s19, 0
    v_lshl_add_u64 v[152:153], v[148:149], 0, s[86:87]
    v_cmp_lt_u32 vcc, 15, v1
    s_add_u32 s86, s12, s84
    s_addc_u32 s87, s13, 0
    v_cndmask_b32 v150, v150, v152, vcc
    v_cndmask_b32 v151, v151, v153, vcc
    v_lshl_add_u64 v[152:153], v[148:149], 0, s[86:87]
    v_cmp_lt_u32 vcc, 31, v1
    s_nop 1
    v_cndmask_b32 v150, v150, v152, vcc
    v_cndmask_b32 v151, v151, v153, vcc
    s_mov_b32 exec_lo, 0xffffffff
    s_mov_b32 exec_hi, 0xffff
    global_load_dword v0, v[150:151], off
    s_mov_b64 exec, -1
    s_barrier
    s_barrier
    s_barrier
    s_waitcnt vmcnt(1)
    s_movk_i32 s98, 0x4000
L_tokB_chk:
    v_readfirstlane_b32 s100, v10
    v_readfirstlane_b32 s101, v11
    s_nop 1
    s_cmp_lg_u32 s100, 0
    s_cbranch_scc1 L_tokB_ok
    s_sub_u32 s98, s98, 1
    s_cbranch_scc1 L_tokB_ok
    s_sleep 1
    global_load_dwordx2 v[10:11], v8, s[24:25] sc1
    s_waitcnt vmcnt(0)
    s_branch L_tokB_chk
L_tokB_ok:
    s_waitcnt vmcnt(2)
    s_barrier
    s_lshl2_add_u32 s84, s2, s4
    s_mul_i32 s84, s84, 7168
    v_min_u32 v148, 55, v1
    v_lshl_add_u32 v148, v148, 7, s84
    s_mov_b32 exec_lo, 0xffffffff
    s_mov_b32 exec_hi, 0xffffff
    global_load_dword v0, v148, s[20:21]
    s_mov_b64 exec, -1
    s_cmp_lg_u32 s4, 0
    s_cbranch_scc1 L_fLN
    s_lshl_b32 s84, s28, 4
    s_add_u32 s84, s84, s29
    s_lshl_b32 s84, s84, 7
    s_add_u32 s84, s84, 0x1e80000
    v_mov_b32 v64, s84
    v_mov_b32 v66, s100
    v_mov_b32 v67, s101
    s_mov_b64 exec, 1
    global_store_dwordx2 v64, v[66:67], s[26:27] sc1
    s_mov_b64 exec, -1
L_fLN:
    s_barrier
    s_barrier
    s_barrier
    v_and_b32 v64, 15, v1
    s_lshl_b32 s84, s28, 4
    s_sub_u32 s85, s84, 16
    s_max_i32 s85, s85, 0
    v_add_u32 v8, s84, v64
    v_add_u32 v65, s85, v64
    v_cmp_lt_u32 vcc, 15, v1
    v_lshl_add_u32 v64, v64, 4, s29
    s_nop 0
    v_cndmask_b32 v8, v8, v65, vcc
    v_cmp_lt_u32 vcc, 31, v1
    s_mov_b32 s84, 0x1e80000
    s_nop 0
    v_cndmask_b32 v8, v8, v64, vcc
    v_lshl_add_u32 v8, v8, 7, s84
    global_load_dwordx2 v[10:11], v8, s[26:27] sc1
    s_barrier
    v_mov_b32 v88, 0
    v_mov_b32 v89, 0
    v_mov_b32 v90, 0
    v_mov_b32 v91, 0
    v_mov_b32 v92, 0
    v_mov_b32 v93, 0
    v_mov_b32 v94, 0
    v_mov_b32 v95, 0
    v_mov_b32 v96, 0
    v_mov_b32 v97, 0
    v_mov_b32 v98, 0
    v_mov_b32 v99, 0
    v_mov_b32 v100, 0
    v_mov_b32 v101, 0
    v_mov_b32 v102, 0
    v_mov_b32 v103, 0
    v_mov_b32 v104, 0
    v_mov_b32 v105, 0
    v_mov_b32 v106, 0
    v_mov_b32 v107, 0
    v_mov_b32 v108, 0
    v_mov_b32 v109, 0
    v_mov_b32 v110, 0
    v_mov_b32 v111, 0
    v_mov_b32 v112, 0
    v_mov_b32 v113, 0
    v_mov_b32 v114, 0
    v_mov_b32 v115, 0
    v_mov_b32 v116, 0
    v_mov_b32 v117, 0
    v_mov_b32 v118, 0
    v_mov_b32 v119, 0
    v_mov_b32 v120, 0
    v_mov_b32 v121, 0
    v_mov_b32 v122, 0
    v_mov_b32 v123, 0
    v_mov_b32 v124, 0
    v_mov_b32 v125, 0
    v_mov_b32 v126, 0
    v_mov_b32 v127, 0
    v_mov_b32 v128, 0
    v_mov_b32 v129, 0
    v_mov_b32 v130, 0
    v_mov_b32 v131, 0
    v_mov_b32 v132, 0
    v_mov_b32 v133, 0
    v_mov_b32 v134, 0
    v_mov_b32 v135, 0
    v_mov_b32 v136, 0
    v_mov_b32 v137, 0
    v_mov_b32 v138, 0
    v_mov_b32 v139, 0
    v_mov_b32 v140, 0
    v_mov_b32 v141, 0
    v_mov_b32 v142, 0
    v_mov_b32 v143, 0
    v_mov_b32 v144, 0
    v_mov_b32 v145, 0
    v_mov_b32 v146, 0
    v_mov_b32 v147, 0
    v_mov_b32 v148, 0
    v_mov_b32 v149, 0
    v_mov_b32 v150, 0
    v_mov_b32 v151, 0
    v_mov_b32 v152, 0
    v_mov_b32 v153, 0
    v_mov_b32 v154, 0
    v_mov_b32 v155, 0
    v_mov_b32 v156, 0
    v_mov_b32 v157, 0
    v_mov_b32 v158, 0
    v_mov_b32 v159, 0
    v_mov_b32 v160, 0
    v_mov_b32 v161, 0
    v_mov_b32 v162, 0
    v_mov_b32 v163, 0
    v_mov_b32 v164, 0
    v_mov_b32 v165, 0
    v_mov_b32 v166, 0
    v_mov_b32 v167, 0
    v_mov_b32 v168, 0
    v_mov_b32 v169, 0
    v_mov_b32 v170, 0
    v_mov_b32 v171, 0
    s_barrier
    v_mov_b32 v172, 0
    v_mov_b32 v173, 0
    v_mov_b32 v174, 0
    v_mov_b32 v175, 0
    v_mov_b32 v176, 0
    v_mov_b32 v177, 0
    v_mov_b32 v178, 0
    v_mov_b32 v179, 0
    v_mov_b32 v180, 0
    v_mov_b32 v181, 0
    v_mov_b32 v182, 0
    v_mov_b32 v183, 0
    v_mov_b32 v184, 0
    v_mov_b32 v185, 0
    v_mov_b32 v186, 0
    v_mov_b32 v187, 0
    v_mov_b32 v188, 0
    v_mov_b32 v189, 0
    v_mov_b32 v190, 0
    v_mov_b32 v191, 0
    v_mov_b32 v192, 0
    v_mov_b32 v193, 0
    v_mov_b32 v194, 0
    v_mov_b32 v195, 0
    v_mov_b32 v196, 0
    v_mov_b32 v197, 0
    v_mov_b32 v198, 0
    v_mov_b32 v199, 0
    v_mov_b32 v200, 0
    v_mov_b32 v201, 0
    v_mov_b32 v202, 0
    v_mov_b32 v203, 0
    v_mov_b32 v204, 0
    v_mov_b32 v205, 0
    v_mov_b32 v206, 0
    v_mov_b32 v207, 0
    v_mov_b32 v208, 0
    v_mov_b32 v209, 0
    v_mov_b32 v210, 0
    v_mov_b32 v211, 0
    v_mov_b32 v212, 0
    v_mov_b32 v213, 0
    v_mov_b32 v214, 0
    v_mov_b32 v215, 0
    v_mov_b32 v216, 0
    v_mov_b32 v217, 0
    v_mov_b32 v218, 0
    v_mov_b32 v219, 0
    v_mov_b32 v220, 0
    v_mov_b32 v221, 0
    v_mov_b32 v222, 0
    v_mov_b32 v223, 0
    v_mov_b32 v224, 0
    v_mov_b32 v225, 0
    v_mov_b32 v226, 0
    v_mov_b32 v227, 0
    v_mov_b32 v228, 0
    v_mov_b32 v229, 0
    v_mov_b32 v230, 0
    v_mov_b32 v231, 0
    v_mov_b32 v232, 0
    v_mov_b32 v233, 0
    v_mov_b32 v234, 0
    v_mov_b32 v235, 0
    v_mov_b32 v236, 0
    v_mov_b32 v237, 0
    v_mov_b32 v238, 0
    v_mov_b32 v239, 0
    v_mov_b32 v240, 0
    v_mov_b32 v241, 0
    v_mov_b32 v242, 0
    v_mov_b32 v243, 0
    v_mov_b32 v244, 0
    v_mov_b32 v245, 0
    v_mov_b32 v246, 0
    v_mov_b32 v247, 0
    v_mov_b32 v248, 0
    v_mov_b32 v249, 0
    v_mov_b32 v250, 0
    v_mov_b32 v251, 0
    v_mov_b32 v252, 0
    v_mov_b32 v253, 0
    v_mov_b32 v254, 0
    v_mov_b32 v255, 0
    s_barrier
    s_waitcnt vmcnt(0)
    s_movk_i32 s98, 0x4000
L_pLN_chk:
    v_cmp_ne_u64 vcc, s[100:101], v[10:11]
    s_nop 1
    s_cmp_eq_u64 vcc, 0
    s_cbranch_scc1 L_pLN_ok
    s_sub_u32 s98, s98, 1
    s_cbranch_scc1 L_pLN_ok
    s_sleep 1
    global_load_dwordx2 v[10:11], v8, s[26:27] sc1
    s_waitcnt vmcnt(0)
    s_branch L_pLN_chk
L_pLN_ok:
    v_lshrrev_b32 v64, 4, v1
    v_bfe_u32 v65, v1, 2, 2
    v_and_b32 v66, 3, v1
    v_and_b32 v67, 15, v1
    v_lshrrev_b32 v68, 3, v1
    v_and_b32 v69, 7, v1
    s_lshl_b32 s85, s6, 2
    s_lshl_b32 s86, s5, 1
    s_or_b32 s85, s85, s86
    v_lshl_add_u32 v70, v64, 3, v65
    v_lshlrev_b32 v70, 7, v70
    v_and_b32 v71, 1, v66
    v_lshl_add_u32 v70, v71, 3, v70
    v_add_u32 v70, 16384, v70
    v_and_b32 v71, 2, v65
    v_and_b32 v72, 1, v64
    v_lshl_add_u32 v71, v72, 2, v71
    v_lshrrev_b32 v72, 1, v66
    v_xor_b32 v71, v71, v72
    v_xor_b32 v71, s85, v71
    v_xor_b32 v72, 0, v71
    v_lshl_add_u32 v4, v72, 4, v70
    v_add_u32 v6, 40960, v4
    v_xor_b32 v72, 2, v71
    v_lshl_add_u32 v5, v72, 4, v70
    v_add_u32 v7, 40960, v5
    v_lshrrev_b32 v70, 1, v67
    v_xor_b32 v70, v70, v64
    v_lshlrev_b32 v70, 4, v70
    v_lshl_add_u32 v70, v67, 7, v70
    s_lshl_b32 s85, s5, 13
    v_add_u32 v16, s85, v70
    v_xor_b32 v17, 64, v16
    s_sub_u32 s95, 16384, s85
    s_lshl_b32 s85, s28, 7
    s_lshl_b32 s86, s4, 5
    s_add_u32 s86, s85, s86
    v_add_u32 v71, s86, v68
    v_xor_b32 v70, v69, v64
    v_lshlrev_b32 v70, 4, v70
    v_lshl_add_u32 v20, v71, 11, v70
    v_xor_b32 v21, 64, v20
    v_add_u32 v21, 16384, v21
    s_sub_u32 s86, s85, 16
    s_max_i32 s86, s86, 0
    s_lshl_b32 s87, s4, 2
    v_add_u32 v71, s87, v68
    v_lshrrev_b32 v70, 1, v71
    v_and_b32 v70, 7, v70
    v_xor_b32 v70, v70, v69
    v_lshlrev_b32 v70, 4, v70
    v_add_u32 v71, s86, v71
    v_lshl_add_u32 v3, v71, 11, v70
    s_mul_i32 s81, s4, -3584
    s_add_u32 s81, s81, 16384
    s_lshl_b32 s85, s4, 3
    s_and_b32 s86, s4, 1
    s_lshl_b32 s86, s86, 2
    v_and_b32 v70, 2, v68
    v_xor_b32 v70, v70, v69
    v_xor_b32 v70, s86, v70
    v_add_u32 v71, s85, v68
    v_mul_u32_u24 v71, 7168, v71
    v_lshl_add_u32 v22, v70, 4, v71
    v_and_b32 v70, 2, v68
    v_xor_b32 v70, v70, v69
    v_xor_b32 v70, s86, v70
    v_add_u32 v71, s85, v68
    v_mul_u32_u24 v71, 6144, v71
    v_lshl_add_u32 v23, v70, 4, v71
    s_mov_b32 s36, s26
    s_mov_b32 s37, s27
    s_mov_b32 s38, 0x400000
    s_mov_b32 s39, 0x20000
    s_lshl_b32 s85, s29, 7
    s_add_u32 s40, s10, s85
    s_addc_u32 s41, s11, 0
    s_sub_u32 s42, 6291456, s85
    s_mov_b32 s43, 0x20000
    s_add_u32 s86, s85, 4096
    s_add_u32 s44, s10, s86
    s_addc_u32 s45, s11, 0
    s_sub_u32 s46, 6291456, s86
    s_mov_b32 s47, 0x20000
    s_add_u32 s86, s85, 5120
    s_add_u32 s48, s16, s86
    s_addc_u32 s49, s17, 0
    s_sub_u32 s50, 7340032, s86
    s_mov_b32 s51, 0x20000
    s_add_u32 s52, s18, s86
    s_addc_u32 s53, s19, 0
    s_sub_u32 s54, 7340032, s86
    s_mov_b32 s55, 0x20000
    s_mov_b32 s76, 0
    s_mov_b32 s77, 0
    s_mov_b32 s78, 0
    s_lshl_b32 s79, s4, 12
    s_add_u32 s79, s79, 135168
    s_mov_b32 s80, 135168
    s_barrier
    s_add_u32 m0, s79, 0
    s_nop 0
    buffer_load_dwordx4 v20, s[36:39], s78 offen sc1 lds
    s_add_u32 m0, s79, 1024
    s_nop 0
    buffer_load_dwordx4 v21, s[36:39], s78 offen sc1 lds
    s_add_u32 s78, s78, 32768
    s_barrier
    s_add_u32 m0, s79, 2048
    s_nop 0
    buffer_load_dwordx4 v20, s[36:39], s78 offen sc1 lds
    s_add_u32 m0, s79, 3072
    s_nop 0
    buffer_load_dwordx4 v21, s[36:39], s78 offen sc1 lds
    s_sub_u32 s78, s78, 32768
    s_add_u32 m0, s79, s81
    s_nop 0
    s_mov_b64 exec, 0xffffffff
    buffer_load_dwordx4 v3, s[36:39], s78 offen sc1 lds
    s_mov_b64 exec, -1
    s_add_u32 s78, s78, 128
    s_add_u32 s79, s79, 18432
    s_cmp_ge_u32 s79, 153600
    s_cselect_b32 s84, 55296, 0
    s_sub_u32 s79, s79, s84
    s_add_u32 m0, s33, 16384
    s_nop 0
    buffer_load_dwordx4 v23, s[40:43], s76 offen offset:0 lds
    s_add_u32 m0, s33, 18432
    s_nop 0
    buffer_load_dwordx4 v23, s[40:43], s76 offen offset:2048 lds
    s_add_u32 m0, s33, 24576
    s_nop 0
    buffer_load_dwordx4 v23, s[44:47], s76 offen offset:0 lds
    s_add_u32 m0, s33, 28672
    s_nop 0
    buffer_load_dwordx4 v22, s[48:51], s77 offen offset:0 lds
    s_add_u32 m0, s33, 32768
    s_nop 0
    buffer_load_dwordx4 v22, s[52:55], s77 offen offset:0 lds
    s_add_u32 s77, s77, 229376
    s_add_u32 s76, s76, 196608
    s_barrier
    s_add_u32 m0, s79, 0
    s_nop 0
    buffer_load_dwordx4 v20, s[36:39], s78 offen sc1 lds
    s_add_u32 m0, s79, 1024
    s_nop 0
    buffer_load_dwordx4 v21, s[36:39], s78 offen sc1 lds
    s_add_u32 s78, s78, 32768
    s_add_u32 m0, s33, 36864
    s_nop 0
    buffer_load_dwordx4 v23, s[40:43], s76 offen offset:0 lds
    s_add_u32 m0, s33, 38912
    s_nop 0
    buffer_load_dwordx4 v23, s[40:43], s76 offen offset:2048 lds
    s_add_u32 m0, s33, 45056
    s_nop 0
    buffer_load_dwordx4 v23, s[44:47], s76 offen offset:0 lds
    s_add_u32 m0, s33, 49152
    s_nop 0
    buffer_load_dwordx4 v22, s[48:51], s77 offen offset:0 lds
    s_add_u32 m0, s33, 53248
    s_nop 0
    buffer_load_dwordx4 v22, s[52:55], s77 offen offset:0 lds
    s_add_u32 s77, s77, 229376
    s_add_u32 s76, s76, 196608
    s_barrier
    s_add_u32 m0, s79, 2048
    s_nop 0
    buffer_load_dwordx4 v20, s[36:39], s78 offen sc1 lds
    s_add_u32 m0, s79, 3072
    s_nop 0
    buffer_load_dwordx4 v21, s[36:39], s78 offen sc1 lds
    s_sub_u32 s78, s78, 32768
    s_add_u32 m0, s79, s81
    s_nop 0
    s_mov_b64 exec, 0xffffffff
    buffer_load_dwordx4 v3, s[36:39], s78 offen sc1 lds
    s_mov_b64 exec, -1
    s_add_u32 s78, s78, 128
    s_add_u32 s79, s79, 18432
    s_cmp_ge_u32 s79, 153600
    s_cselect_b32 s84, 55296, 0
    s_sub_u32 s79, s79, s84
    s_add_u32 m0, s33, 57344
    s_nop 0
    buffer_load_dwordx4 v23, s[40:43], s76 offen offset:0 lds
    s_add_u32 m0, s33, 59392
    s_nop 0
    buffer_load_dwordx4 v23, s[40:43], s76 offen offset:2048 lds
    s_add_u32 m0, s33, 65536
    s_nop 0
    buffer_load_dwordx4 v23, s[44:47], s76 offen offset:0 lds
    s_add_u32 m0, s33, 69632
    s_nop 0
    buffer_load_dwordx4 v22, s[48:51], s77 offen offset:0 lds
    s_add_u32 m0, s33, 73728
    s_nop 0
    buffer_load_dwordx4 v22, s[52:55], s77 offen offset:0 lds
    s_add_u32 s77, s77, 229376
    s_add_u32 s76, s76, 196608
    s_waitcnt vmcnt(15)
    s_barrier
    s_setprio 1
    v_add_u32 v14, s80, v16
    v_add_u32 v15, s80, v17
    s_add_u32 s84, s80, s95
    v_add_u32 v18, s84, v16
    v_add_u32 v19, s84, v17
    s_add_u32 s80, s80, 18432
    s_cmp_ge_u32 s80, 153600
    s_cselect_b32 s84, 55296, 0
    s_sub_u32 s80, s80, s84
    ds_read_b64_tr_b16 v[64:65], v4 offset:4096
    ds_read_b64_tr_b16 v[66:67], v4 offset:4608
    ds_read_b128 v[24:27], v14 offset:0
    ds_read_b128 v[28:31], v14 offset:2048
    ds_read_b128 v[32:35], v14 offset:4096
    ds_read_b128 v[36:39], v14 offset:6144
    ds_read_b64_tr_b16 v[68:69], v5 offset:4096
    ds_read_b64_tr_b16 v[70:71], v5 offset:4608
    ds_read_b64_tr_b16 v[72:73], v4 offset:8192
    ds_read_b64_tr_b16 v[74:75], v4 offset:8704
    ds_read_b128 v[56:59], v18
    s_mov_b32 s34, 7
.p2align 6
L_p2:
    s_waitcnt lgkmcnt(8)
    v_mfma_f32_16x16x32_bf16 v[88:91], v[64:67], v[24:27], v[88:91]
    ds_read_b64_tr_b16 v[76:77], v5 offset:8192
    s_waitcnt lgkmcnt(8)
    v_mfma_f32_16x16x32_bf16 v[92:95], v[64:67], v[28:31], v[92:95]
    ds_read_b64_tr_b16 v[78:79], v5 offset:8704
    s_waitcnt lgkmcnt(8)
    v_mfma_f32_16x16x32_bf16 v[96:99], v[64:67], v[32:35], v[96:99]
    ds_read_b64_tr_b16 v[80:81], v4 offset:0
    s_waitcnt lgkmcnt(8)
    v_mfma_f32_16x16x32_bf16 v[100:103], v[64:67], v[36:39], v[100:103]
    ds_read_b64_tr_b16 v[82:83], v4 offset:512
    s_waitcnt lgkmcnt(4)
    v_mfma_f32_16x16x32_bf16 v[248:251], v[64:67], v[56:59], v[248:251]
    v_mfma_f32_16x16x32_bf16 v[104:107], v[68:71], v[24:27], v[104:107]
    ds_read_b64_tr_b16 v[64:65], v5 offset:0
    v_mfma_f32_16x16x32_bf16 v[108:111], v[68:71], v[28:31], v[108:111]
    ds_read_b64_tr_b16 v[66:67], v5 offset:512
    v_mfma_f32_16x16x32_bf16 v[112:115], v[68:71], v[32:35], v[112:115]
    s_add_u32 m0, s79, 0
    v_mfma_f32_16x16x32_bf16 v[116:119], v[68:71], v[36:39], v[116:119]
    buffer_load_dwordx4 v20, s[36:39], s78 offen sc1 lds
    v_mfma_f32_16x16x32_bf16 v[120:123], v[24:27], v[72:75], v[120:123]
    ds_read_b64_tr_b16 v[68:69], v4 offset:12288
    v_mfma_f32_16x16x32_bf16 v[124:127], v[28:31], v[72:75], v[124:127]
    ds_read_b64_tr_b16 v[70:71], v4 offset:12800
    v_mfma_f32_16x16x32_bf16 v[128:131], v[32:35], v[72:75], v[128:131]
    s_add_u32 m0, s79, 1024
    v_mfma_f32_16x16x32_bf16 v[132:135], v[36:39], v[72:75], v[132:135]
    buffer_load_dwordx4 v21, s[36:39], s78 offen sc1 lds
    s_add_u32 s78, s78, 32768
    v_mfma_f32_16x16x32_bf16 v[252:255], v[56:59], v[72:75], v[252:255]
    s_waitcnt lgkmcnt(6)
    v_mfma_f32_16x16x32_bf16 v[136:139], v[24:27], v[76:79], v[136:139]
    ds_read_b64_tr_b16 v[72:73], v4 offset:16384
    v_mfma_f32_16x16x32_bf16 v[140:143], v[28:31], v[76:79], v[140:143]
    ds_read_b64_tr_b16 v[74:75], v4 offset:16896
    v_mfma_f32_16x16x32_bf16 v[144:147], v[32:35], v[76:79], v[144:147]
    s_add_u32 m0, s33, 77824
    v_mfma_f32_16x16x32_bf16 v[148:151], v[36:39], v[76:79], v[148:151]
    buffer_load_dwordx4 v23, s[40:43], s76 offen offset:0 lds
    s_waitcnt lgkmcnt(6)
    v_mfma_f32_16x16x32_bf16 v[152:155], v[80:83], v[24:27], v[152:155]
    ds_read_b64_tr_b16 v[76:77], v5 offset:12288
    v_mfma_f32_16x16x32_bf16 v[156:159], v[80:83], v[28:31], v[156:159]
    ds_read_b64_tr_b16 v[78:79], v5 offset:12800
    v_mfma_f32_16x16x32_bf16 v[160:163], v[80:83], v[32:35], v[160:163]
    s_add_u32 m0, s33, 79872
    v_mfma_f32_16x16x32_bf16 v[164:167], v[80:83], v[36:39], v[164:167]
    buffer_load_dwordx4 v23, s[40:43], s76 offen offset:2048 lds
    s_waitcnt lgkmcnt(6)
    v_mfma_f32_16x16x32_bf16 v[168:171], v[64:67], v[24:27], v[168:171]
    ds_read_b64_tr_b16 v[80:81], v5 offset:16384
    v_mfma_f32_16x16x32_bf16 v[172:175], v[64:67], v[28:31], v[172:175]
    ds_read_b64_tr_b16 v[82:83], v5 offset:16896
    v_mfma_f32_16x16x32_bf16 v[176:179], v[64:67], v[32:35], v[176:179]
    s_add_u32 m0, s33, 86016
    v_mfma_f32_16x16x32_bf16 v[180:183], v[64:67], v[36:39], v[180:183]
    buffer_load_dwordx4 v23, s[44:47], s76 offen offset:0 lds
    s_waitcnt lgkmcnt(6)
    v_mfma_f32_16x16x32_bf16 v[184:187], v[68:71], v[24:27], v[184:187]
    s_add_u32 m0, s33, 90112
    v_mfma_f32_16x16x32_bf16 v[188:191], v[68:71], v[28:31], v[188:191]
    buffer_load_dwordx4 v22, s[48:51], s77 offen offset:0 lds
    v_mfma_f32_16x16x32_bf16 v[192:195], v[68:71], v[32:35], v[192:195]
    s_add_u32 m0, s33, 94208
    v_mfma_f32_16x16x32_bf16 v[196:199], v[68:71], v[36:39], v[196:199]
    buffer_load_dwordx4 v22, s[52:55], s77 offen offset:0 lds
    s_add_u32 s77, s77, 229376
    s_add_u32 s76, s76, 196608
    s_waitcnt vmcnt(15) lgkmcnt(0)
    s_barrier
    v_mfma_f32_16x16x32_bf16 v[200:203], v[72:75], v[24:27], v[200:203]
    ds_read_b64_tr_b16 v[64:65], v4 offset:24576
    v_mfma_f32_16x16x32_bf16 v[204:207], v[72:75], v[28:31], v[204:207]
    ds_read_b64_tr_b16 v[66:67], v4 offset:25088
    v_mfma_f32_16x16x32_bf16 v[208:211], v[72:75], v[32:35], v[208:211]
    ds_read_b128 v[40:43], v15 offset:0
    v_mfma_f32_16x16x32_bf16 v[212:215], v[72:75], v[36:39], v[212:215]
    ds_read_b128 v[44:47], v15 offset:2048
    v_mfma_f32_16x16x32_bf16 v[216:219], v[76:79], v[24:27], v[216:219]
    ds_read_b128 v[48:51], v15 offset:4096
    v_mfma_f32_16x16x32_bf16 v[220:223], v[76:79], v[28:31], v[220:223]
    ds_read_b128 v[52:55], v15 offset:6144
    v_mfma_f32_16x16x32_bf16 v[224:227], v[76:79], v[32:35], v[224:227]
    ds_read_b64_tr_b16 v[68:69], v5 offset:24576
    v_mfma_f32_16x16x32_bf16 v[228:231], v[76:79], v[36:39], v[228:231]
    ds_read_b64_tr_b16 v[70:71], v5 offset:25088
    v_mfma_f32_16x16x32_bf16 v[232:235], v[80:83], v[24:27], v[232:235]
    ds_read_b64_tr_b16 v[72:73], v4 offset:28672
    v_mfma_f32_16x16x32_bf16 v[236:239], v[80:83], v[28:31], v[236:239]
    ds_read_b64_tr_b16 v[74:75], v4 offset:29184
    v_mfma_f32_16x16x32_bf16 v[240:243], v[80:83], v[32:35], v[240:243]
    ds_read_b128 v[60:63], v19
    v_mfma_f32_16x16x32_bf16 v[244:247], v[80:83], v[36:39], v[244:247]
    s_waitcnt lgkmcnt(8)
    v_mfma_f32_16x16x32_bf16 v[88:91], v[64:67], v[40:43], v[88:91]
    ds_read_b64_tr_b16 v[76:77], v5 offset:28672
    s_waitcnt lgkmcnt(8)
    v_mfma_f32_16x16x32_bf16 v[92:95], v[64:67], v[44:47], v[92:95]
    ds_read_b64_tr_b16 v[78:79], v5 offset:29184
    s_waitcnt lgkmcnt(8)
    v_mfma_f32_16x16x32_bf16 v[96:99], v[64:67], v[48:51], v[96:99]
    ds_read_b64_tr_b16 v[80:81], v4 offset:20480
    s_waitcnt lgkmcnt(8)
    v_mfma_f32_16x16x32_bf16 v[100:103], v[64:67], v[52:55], v[100:103]
    ds_read_b64_tr_b16 v[82:83], v4 offset:20992
    s_waitcnt lgkmcnt(4)
    v_mfma_f32_16x16x32_bf16 v[248:251], v[64:67], v[60:63], v[248:251]
    v_mfma_f32_16x16x32_bf16 v[104:107], v[68:71], v[40:43], v[104:107]
    ds_read_b64_tr_b16 v[64:65], v5 offset:20480
    v_mfma_f32_16x16x32_bf16 v[108:111], v[68:71], v[44:47], v[108:111]
    ds_read_b64_tr_b16 v[66:67], v5 offset:20992
    v_mfma_f32_16x16x32_bf16 v[112:115], v[68:71], v[48:51], v[112:115]
    s_add_u32 m0, s79, 2048
    v_mfma_f32_16x16x32_bf16 v[116:119], v[68:71], v[52:55], v[116:119]
    buffer_load_dwordx4 v20, s[36:39], s78 offen sc1 lds
    v_mfma_f32_16x16x32_bf16 v[120:123], v[40:43], v[72:75], v[120:123]
    ds_read_b64_tr_b16 v[68:69], v4 offset:32768
    v_mfma_f32_16x16x32_bf16 v[124:127], v[44:47], v[72:75], v[124:127]
    ds_read_b64_tr_b16 v[70:71], v4 offset:33280
    v_mfma_f32_16x16x32_bf16 v[128:131], v[48:51], v[72:75], v[128:131]
    s_add_u32 m0, s79, 3072
    v_mfma_f32_16x16x32_bf16 v[132:135], v[52:55], v[72:75], v[132:135]
    buffer_load_dwordx4 v21, s[36:39], s78 offen sc1 lds
    s_sub_u32 s78, s78, 32768
    v_mfma_f32_16x16x32_bf16 v[252:255], v[60:63], v[72:75], v[252:255]
    s_waitcnt lgkmcnt(6)
    v_mfma_f32_16x16x32_bf16 v[136:139], v[40:43], v[76:79], v[136:139]
    ds_read_b64_tr_b16 v[72:73], v4 offset:36864
    v_mfma_f32_16x16x32_bf16 v[140:143], v[44:47], v[76:79], v[140:143]
    ds_read_b64_tr_b16 v[74:75], v4 offset:37376
    v_mfma_f32_16x16x32_bf16 v[144:147], v[48:51], v[76:79], v[144:147]
    s_add_u32 m0, s79, s81
    v_mfma_f32_16x16x32_bf16 v[148:151], v[52:55], v[76:79], v[148:151]
    s_mov_b64 exec, 0xffffffff
    buffer_load_dwordx4 v3, s[36:39], s78 offen sc1 lds
    s_mov_b64 exec, -1
    s_add_u32 s78, s78, 128
    s_add_u32 s79, s79, 18432
    s_cmp_ge_u32 s79, 153600
    s_cselect_b32 s84, 55296, 0
    s_sub_u32 s79, s79, s84
    s_waitcnt lgkmcnt(6)
    v_mfma_f32_16x16x32_bf16 v[152:155], v[80:83], v[40:43], v[152:155]
    ds_read_b64_tr_b16 v[76:77], v5 offset:32768
    v_mfma_f32_16x16x32_bf16 v[156:159], v[80:83], v[44:47], v[156:159]
    ds_read_b64_tr_b16 v[78:79], v5 offset:33280
    v_mfma_f32_16x16x32_bf16 v[160:163], v[80:83], v[48:51], v[160:163]
    s_add_u32 m0, s33, 16384
    v_mfma_f32_16x16x32_bf16 v[164:167], v[80:83], v[52:55], v[164:167]
    buffer_load_dwordx4 v23, s[40:43], s76 offen offset:0 lds
    s_waitcnt lgkmcnt(6)
    v_mfma_f32_16x16x32_bf16 v[168:171], v[64:67], v[40:43], v[168:171]
    ds_read_b64_tr_b16 v[80:81], v5 offset:36864
    v_mfma_f32_16x16x32_bf16 v[172:175], v[64:67], v[44:47], v[172:175]
    ds_read_b64_tr_b16 v[82:83], v5 offset:37376
    v_mfma_f32_16x16x32_bf16 v[176:179], v[64:67], v[48:51], v[176:179]
    s_add_u32 m0, s33, 18432
    v_mfma_f32_16x16x32_bf16 v[180:183], v[64:67], v[52:55], v[180:183]
    buffer_load_dwordx4 v23, s[40:43], s76 offen offset:2048 lds
    s_waitcnt lgkmcnt(6)
    v_mfma_f32_16x16x32_bf16 v[184:187], v[68:71], v[40:43], v[184:187]
    v_add_u32 v14, s80, v16
    v_add_u32 v15, s80, v17
    s_add_u32 s84, s80, s95
    v_add_u32 v18, s84, v16
    v_add_u32 v19, s84, v17
    s_add_u32 s80, s80, 18432
    s_cmp_ge_u32 s80, 153600
    s_cselect_b32 s84, 55296, 0
    s_sub_u32 s80, s80, s84
    s_add_u32 m0, s33, 24576
    v_mfma_f32_16x16x32_bf16 v[188:191], v[68:71], v[44:47], v[188:191]
    buffer_load_dwordx4 v23, s[44:47], s76 offen offset:0 lds
    s_add_u32 m0, s33, 28672
    v_mfma_f32_16x16x32_bf16 v[192:195], v[68:71], v[48:51], v[192:195]
    buffer_load_dwordx4 v22, s[48:51], s77 offen offset:0 lds
    s_add_u32 m0, s33, 32768
    v_mfma_f32_16x16x32_bf16 v[196:199], v[68:71], v[52:55], v[196:199]
    buffer_load_dwordx4 v22, s[52:55], s77 offen offset:0 lds
    s_add_u32 s77, s77, 229376
    s_add_u32 s76, s76, 196608
    s_waitcnt vmcnt(15) lgkmcnt(0)
    s_barrier
    v_mfma_f32_16x16x32_bf16 v[200:203], v[72:75], v[40:43], v[200:203]
    ds_read_b64_tr_b16 v[64:65], v6 offset:4096
    v_mfma_f32_16x16x32_bf16 v[204:207], v[72:75], v[44:47], v[204:207]
    ds_read_b64_tr_b16 v[66:67], v6 offset:4608
    v_mfma_f32_16x16x32_bf16 v[208:211], v[72:75], v[48:51], v[208:211]
    ds_read_b128 v[24:27], v14 offset:0
    v_mfma_f32_16x16x32_bf16 v[212:215], v[72:75], v[52:55], v[212:215]
    ds_read_b128 v[28:31], v14 offset:2048
    v_mfma_f32_16x16x32_bf16 v[216:219], v[76:79], v[40:43], v[216:219]
    ds_read_b128 v[32:35], v14 offset:4096
    v_mfma_f32_16x16x32_bf16 v[220:223], v[76:79], v[44:47], v[220:223]
    ds_read_b128 v[36:39], v14 offset:6144
    v_mfma_f32_16x16x32_bf16 v[224:227], v[76:79], v[48:51], v[224:227]
    ds_read_b64_tr_b16 v[68:69], v7 offset:4096
    v_mfma_f32_16x16x32_bf16 v[228:231], v[76:79], v[52:55], v[228:231]
    ds_read_b64_tr_b16 v[70:71], v7 offset:4608
    v_mfma_f32_16x16x32_bf16 v[232:235], v[80:83], v[40:43], v[232:235]
    ds_read_b64_tr_b16 v[72:73], v6 offset:8192
    v_mfma_f32_16x16x32_bf16 v[236:239], v[80:83], v[44:47], v[236:239]
    ds_read_b64_tr_b16 v[74:75], v6 offset:8704
    v_mfma_f32_16x16x32_bf16 v[240:243], v[80:83], v[48:51], v[240:243]
    ds_read_b128 v[56:59], v18
    v_mfma_f32_16x16x32_bf16 v[244:247], v[80:83], v[52:55], v[244:247]
    s_waitcnt lgkmcnt(8)
    v_mfma_f32_16x16x32_bf16 v[88:91], v[64:67], v[24:27], v[88:91]
    ds_read_b64_tr_b16 v[76:77], v7 offset:8192
    s_waitcnt lgkmcnt(8)
    v_mfma_f32_16x16x32_bf16 v[92:95], v[64:67], v[28:31], v[92:95]
    ds_read_b64_tr_b16 v[78:79], v7 offset:8704
    s_waitcnt lgkmcnt(8)
    v_mfma_f32_16x16x32_bf16 v[96:99], v[64:67], v[32:35], v[96:99]
    ds_read_b64_tr_b16 v[80:81], v6 offset:0
    s_waitcnt lgkmcnt(8)
    v_mfma_f32_16x16x32_bf16 v[100:103], v[64:67], v[36:39], v[100:103]
    ds_read_b64_tr_b16 v[82:83], v6 offset:512
    s_waitcnt lgkmcnt(4)
    v_mfma_f32_16x16x32_bf16 v[248:251], v[64:67], v[56:59], v[248:251]
    v_mfma_f32_16x16x32_bf16 v[104:107], v[68:71], v[24:27], v[104:107]
    ds_read_b64_tr_b16 v[64:65], v7 offset:0
    v_mfma_f32_16x16x32_bf16 v[108:111], v[68:71], v[28:31], v[108:111]
    ds_read_b64_tr_b16 v[66:67], v7 offset:512
    v_mfma_f32_16x16x32_bf16 v[112:115], v[68:71], v[32:35], v[112:115]
    s_add_u32 m0, s79, 0
    v_mfma_f32_16x16x32_bf16 v[116:119], v[68:71], v[36:39], v[116:119]
    buffer_load_dwordx4 v20, s[36:39], s78 offen sc1 lds
    v_mfma_f32_16x16x32_bf16 v[120:123], v[24:27], v[72:75], v[120:123]
    ds_read_b64_tr_b16 v[68:69], v6 offset:12288
    v_mfma_f32_16x16x32_bf16 v[124:127], v[28:31], v[72:75], v[124:127]
    ds_read_b64_tr_b16 v[70:71], v6 offset:12800
    v_mfma_f32_16x16x32_bf16 v[128:131], v[32:35], v[72:75], v[128:131]
    s_add_u32 m0, s79, 1024
    v_mfma_f32_16x16x32_bf16 v[132:135], v[36:39], v[72:75], v[132:135]
    buffer_load_dwordx4 v21, s[36:39], s78 offen sc1 lds
    s_add_u32 s78, s78, 32768
    v_mfma_f32_16x16x32_bf16 v[252:255], v[56:59], v[72:75], v[252:255]
    s_waitcnt lgkmcnt(6)
    v_mfma_f32_16x16x32_bf16 v[136:139], v[24:27], v[76:79], v[136:139]
    ds_read_b64_tr_b16 v[72:73], v6 offset:16384
    v_mfma_f32_16x16x32_bf16 v[140:143], v[28:31], v[76:79], v[140:143]
    ds_read_b64_tr_b16 v[74:75], v6 offset:16896
    v_mfma_f32_16x16x32_bf16 v[144:147], v[32:35], v[76:79], v[144:147]
    s_add_u32 m0, s33, 36864
    v_mfma_f32_16x16x32_bf16 v[148:151], v[36:39], v[76:79], v[148:151]
    buffer_load_dwordx4 v23, s[40:43], s76 offen offset:0 lds
    s_waitcnt lgkmcnt(6)
    v_mfma_f32_16x16x32_bf16 v[152:155], v[80:83], v[24:27], v[152:155]
    ds_read_b64_tr_b16 v[76:77], v7 offset:12288
    v_mfma_f32_16x16x32_bf16 v[156:159], v[80:83], v[28:31], v[156:159]
    ds_read_b64_tr_b16 v[78:79], v7 offset:12800
    v_mfma_f32_16x16x32_bf16 v[160:163], v[80:83], v[32:35], v[160:163]
    s_add_u32 m0, s33, 38912
    v_mfma_f32_16x16x32_bf16 v[164:167], v[80:83], v[36:39], v[164:167]
    buffer_load_dwordx4 v23, s[40:43], s76 offen offset:2048 lds
    s_waitcnt lgkmcnt(6)
    v_mfma_f32_16x16x32_bf16 v[168:171], v[64:67], v[24:27], v[168:171]
    ds_read_b64_tr_b16 v[80:81], v7 offset:16384
    v_mfma_f32_16x16x32_bf16 v[172:175], v[64:67], v[28:31], v[172:175]
    ds_read_b64_tr_b16 v[82:83], v7 offset:16896
    v_mfma_f32_16x16x32_bf16 v[176:179], v[64:67], v[32:35], v[176:179]
    s_add_u32 m0, s33, 45056
    v_mfma_f32_16x16x32_bf16 v[180:183], v[64:67], v[36:39], v[180:183]
    buffer_load_dwordx4 v23, s[44:47], s76 offen offset:0 lds
    s_waitcnt lgkmcnt(6)
    v_mfma_f32_16x16x32_bf16 v[184:187], v[68:71], v[24:27], v[184:187]
    s_add_u32 m0, s33, 49152
    v_mfma_f32_16x16x32_bf16 v[188:191], v[68:71], v[28:31], v[188:191]
    buffer_load_dwordx4 v22, s[48:51], s77 offen offset:0 lds
    v_mfma_f32_16x16x32_bf16 v[192:195], v[68:71], v[32:35], v[192:195]
    s_add_u32 m0, s33, 53248
    v_mfma_f32_16x16x32_bf16 v[196:199], v[68:71], v[36:39], v[196:199]
    buffer_load_dwordx4 v22, s[52:55], s77 offen offset:0 lds
    s_add_u32 s77, s77, 229376
    s_add_u32 s76, s76, 196608
    s_waitcnt vmcnt(15) lgkmcnt(0)
    s_barrier
    v_mfma_f32_16x16x32_bf16 v[200:203], v[72:75], v[24:27], v[200:203]
    ds_read_b64_tr_b16 v[64:65], v6 offset:24576
    v_mfma_f32_16x16x32_bf16 v[204:207], v[72:75], v[28:31], v[204:207]
    ds_read_b64_tr_b16 v[66:67], v6 offset:25088
    v_mfma_f32_16x16x32_bf16 v[208:211], v[72:75], v[32:35], v[208:211]
    ds_read_b128 v[40:43], v15 offset:0
    v_mfma_f32_16x16x32_bf16 v[212:215], v[72:75], v[36:39], v[212:215]
    ds_read_b128 v[44:47], v15 offset:2048
    v_mfma_f32_16x16x32_bf16 v[216:219], v[76:79], v[24:27], v[216:219]
    ds_read_b128 v[48:51], v15 offset:4096
    v_mfma_f32_16x16x32_bf16 v[220:223], v[76:79], v[28:31], v[220:223]
    ds_read_b128 v[52:55], v15 offset:6144
    v_mfma_f32_16x16x32_bf16 v[224:227], v[76:79], v[32:35], v[224:227]
    ds_read_b64_tr_b16 v[68:69], v7 offset:24576
    v_mfma_f32_16x16x32_bf16 v[228:231], v[76:79], v[36:39], v[228:231]
    ds_read_b64_tr_b16 v[70:71], v7 offset:25088
    v_mfma_f32_16x16x32_bf16 v[232:235], v[80:83], v[24:27], v[232:235]
    ds_read_b64_tr_b16 v[72:73], v6 offset:28672
    v_mfma_f32_16x16x32_bf16 v[236:239], v[80:83], v[28:31], v[236:239]
    ds_read_b64_tr_b16 v[74:75], v6 offset:29184
    v_mfma_f32_16x16x32_bf16 v[240:243], v[80:83], v[32:35], v[240:243]
    ds_read_b128 v[60:63], v19
    v_mfma_f32_16x16x32_bf16 v[244:247], v[80:83], v[36:39], v[244:247]
    s_waitcnt lgkmcnt(8)
    v_mfma_f32_16x16x32_bf16 v[88:91], v[64:67], v[40:43], v[88:91]
    ds_read_b64_tr_b16 v[76:77], v7 offset:28672
    s_waitcnt lgkmcnt(8)
    v_mfma_f32_16x16x32_bf16 v[92:95], v[64:67], v[44:47], v[92:95]
    ds_read_b64_tr_b16 v[78:79], v7 offset:29184
    s_waitcnt lgkmcnt(8)
    v_mfma_f32_16x16x32_bf16 v[96:99], v[64:67], v[48:51], v[96:99]
    ds_read_b64_tr_b16 v[80:81], v6 offset:20480
    s_waitcnt lgkmcnt(8)
    v_mfma_f32_16x16x32_bf16 v[100:103], v[64:67], v[52:55], v[100:103]
    ds_read_b64_tr_b16 v[82:83], v6 offset:20992
    s_waitcnt lgkmcnt(4)
    v_mfma_f32_16x16x32_bf16 v[248:251], v[64:67], v[60:63], v[248:251]
    v_mfma_f32_16x16x32_bf16 v[104:107], v[68:71], v[40:43], v[104:107]
    ds_read_b64_tr_b16 v[64:65], v7 offset:20480
    v_mfma_f32_16x16x32_bf16 v[108:111], v[68:71], v[44:47], v[108:111]
    ds_read_b64_tr_b16 v[66:67], v7 offset:20992
    v_mfma_f32_16x16x32_bf16 v[112:115], v[68:71], v[48:51], v[112:115]
    s_add_u32 m0, s79, 2048
    v_mfma_f32_16x16x32_bf16 v[116:119], v[68:71], v[52:55], v[116:119]
    buffer_load_dwordx4 v20, s[36:39], s78 offen sc1 lds
    v_mfma_f32_16x16x32_bf16 v[120:123], v[40:43], v[72:75], v[120:123]
    ds_read_b64_tr_b16 v[68:69], v6 offset:32768
    v_mfma_f32_16x16x32_bf16 v[124:127], v[44:47], v[72:75], v[124:127]
    ds_read_b64_tr_b16 v[70:71], v6 offset:33280
    v_mfma_f32_16x16x32_bf16 v[128:131], v[48:51], v[72:75], v[128:131]
    s_add_u32 m0, s79, 3072
    v_mfma_f32_16x16x32_bf16 v[132:135], v[52:55], v[72:75], v[132:135]
    buffer_load_dwordx4 v21, s[36:39], s78 offen sc1 lds
    s_sub_u32 s78, s78, 32768
    v_mfma_f32_16x16x32_bf16 v[252:255], v[60:63], v[72:75], v[252:255]
    s_waitcnt lgkmcnt(6)
    v_mfma_f32_16x16x32_bf16 v[136:139], v[40:43], v[76:79], v[136:139]
    ds_read_b64_tr_b16 v[72:73], v6 offset:36864
    v_mfma_f32_16x16x32_bf16 v[140:143], v[44:47], v[76:79], v[140:143]
    ds_read_b64_tr_b16 v[74:75], v6 offset:37376
    v_mfma_f32_16x16x32_bf16 v[144:147], v[48:51], v[76:79], v[144:147]
    s_add_u32 m0, s79, s81
    v_mfma_f32_16x16x32_bf16 v[148:151], v[52:55], v[76:79], v[148:151]
    s_mov_b64 exec, 0xffffffff
    buffer_load_dwordx4 v3, s[36:39], s78 offen sc1 lds
    s_mov_b64 exec, -1
    s_add_u32 s78, s78, 128
    s_add_u32 s79, s79, 18432
    s_cmp_ge_u32 s79, 153600
    s_cselect_b32 s84, 55296, 0
    s_sub_u32 s79, s79, s84
    s_waitcnt lgkmcnt(6)
    v_mfma_f32_16x16x32_bf16 v[152:155], v[80:83], v[40:43], v[152:155]
    ds_read_b64_tr_b16 v[76:77], v7 offset:32768
    v_mfma_f32_16x16x32_bf16 v[156:159], v[80:83], v[44:47], v[156:159]
    ds_read_b64_tr_b16 v[78:79], v7 offset:33280
    v_mfma_f32_16x16x32_bf16 v[160:163], v[80:83], v[48:51], v[160:163]
    s_add_u32 m0, s33, 57344
    v_mfma_f32_16x16x32_bf16 v[164:167], v[80:83], v[52:55], v[164:167]
    buffer_load_dwordx4 v23, s[40:43], s76 offen offset:0 lds
    s_waitcnt lgkmcnt(6)
    v_mfma_f32_16x16x32_bf16 v[168:171], v[64:67], v[40:43], v[168:171]
    ds_read_b64_tr_b16 v[80:81], v7 offset:36864
    v_mfma_f32_16x16x32_bf16 v[172:175], v[64:67], v[44:47], v[172:175]
    ds_read_b64_tr_b16 v[82:83], v7 offset:37376
    v_mfma_f32_16x16x32_bf16 v[176:179], v[64:67], v[48:51], v[176:179]
    s_add_u32 m0, s33, 59392
    v_mfma_f32_16x16x32_bf16 v[180:183], v[64:67], v[52:55], v[180:183]
    buffer_load_dwordx4 v23, s[40:43], s76 offen offset:2048 lds
    s_waitcnt lgkmcnt(6)
    v_mfma_f32_16x16x32_bf16 v[184:187], v[68:71], v[40:43], v[184:187]
    v_add_u32 v14, s80, v16
    v_add_u32 v15, s80, v17
    s_add_u32 s84, s80, s95
    v_add_u32 v18, s84, v16
    v_add_u32 v19, s84, v17
    s_add_u32 s80, s80, 18432
    s_cmp_ge_u32 s80, 153600
    s_cselect_b32 s84, 55296, 0
    s_sub_u32 s80, s80, s84
    s_add_u32 m0, s33, 65536
    v_mfma_f32_16x16x32_bf16 v[188:191], v[68:71], v[44:47], v[188:191]
    buffer_load_dwordx4 v23, s[44:47], s76 offen offset:0 lds
    s_add_u32 m0, s33, 69632
    v_mfma_f32_16x16x32_bf16 v[192:195], v[68:71], v[48:51], v[192:195]
    buffer_load_dwordx4 v22, s[48:51], s77 offen offset:0 lds
    s_add_u32 m0, s33, 73728
    v_mfma_f32_16x16x32_bf16 v[196:199], v[68:71], v[52:55], v[196:199]
    buffer_load_dwordx4 v22, s[52:55], s77 offen offset:0 lds
    s_add_u32 s77, s77, 229376
    s_add_u32 s76, s76, 196608
    s_waitcnt vmcnt(15) lgkmcnt(0)
    s_barrier
    v_mfma_f32_16x16x32_bf16 v[200:203], v[72:75], v[40:43], v[200:203]
    ds_read_b64_tr_b16 v[64:65], v4 offset:4096
    v_mfma_f32_16x16x32_bf16 v[204:207], v[72:75], v[44:47], v[204:207]
    ds_read_b64_tr_b16 v[66:67], v4 offset:4608
    v_mfma_f32_16x16x32_bf16 v[208:211], v[72:75], v[48:51], v[208:211]
    ds_read_b128 v[24:27], v14 offset:0
    v_mfma_f32_16x16x32_bf16 v[212:215], v[72:75], v[52:55], v[212:215]
    ds_read_b128 v[28:31], v14 offset:2048
    v_mfma_f32_16x16x32_bf16 v[216:219], v[76:79], v[40:43], v[216:219]
    ds_read_b128 v[32:35], v14 offset:4096
    v_mfma_f32_16x16x32_bf16 v[220:223], v[76:79], v[44:47], v[220:223]
    ds_read_b128 v[36:39], v14 offset:6144
    v_mfma_f32_16x16x32_bf16 v[224:227], v[76:79], v[48:51], v[224:227]
    ds_read_b64_tr_b16 v[68:69], v5 offset:4096
    v_mfma_f32_16x16x32_bf16 v[228:231], v[76:79], v[52:55], v[228:231]
    ds_read_b64_tr_b16 v[70:71], v5 offset:4608
    v_mfma_f32_16x16x32_bf16 v[232:235], v[80:83], v[40:43], v[232:235]
    ds_read_b64_tr_b16 v[72:73], v4 offset:8192
    v_mfma_f32_16x16x32_bf16 v[236:239], v[80:83], v[44:47], v[236:239]
    ds_read_b64_tr_b16 v[74:75], v4 offset:8704
    v_mfma_f32_16x16x32_bf16 v[240:243], v[80:83], v[48:51], v[240:243]
    ds_read_b128 v[56:59], v18
    v_mfma_f32_16x16x32_bf16 v[244:247], v[80:83], v[52:55], v[244:247]
    s_sub_u32 s34, s34, 1
    s_cmp_lg_u32 s34, 0
    s_cbranch_scc1 L_p2
    s_waitcnt lgkmcnt(8)
    v_mfma_f32_16x16x32_bf16 v[88:91], v[64:67], v[24:27], v[88:91]
    ds_read_b64_tr_b16 v[76:77], v5 offset:8192
    s_waitcnt lgkmcnt(8)
    v_mfma_f32_16x16x32_bf16 v[92:95], v[64:67], v[28:31], v[92:95]
    ds_read_b64_tr_b16 v[78:79], v5 offset:8704
    s_waitcnt lgkmcnt(8)
    v_mfma_f32_16x16x32_bf16 v[96:99], v[64:67], v[32:35], v[96:99]
    ds_read_b64_tr_b16 v[80:81], v4 offset:0
    s_waitcnt lgkmcnt(8)
    v_mfma_f32_16x16x32_bf16 v[100:103], v[64:67], v[36:39], v[100:103]
    ds_read_b64_tr_b16 v[82:83], v4 offset:512
    s_waitcnt lgkmcnt(4)
    v_mfma_f32_16x16x32_bf16 v[248:251], v[64:67], v[56:59], v[248:251]
    v_mfma_f32_16x16x32_bf16 v[104:107], v[68:71], v[24:27], v[104:107]
    ds_read_b64_tr_b16 v[64:65], v5 offset:0
    v_mfma_f32_16x16x32_bf16 v[108:111], v[68:71], v[28:31], v[108:111]
    ds_read_b64_tr_b16 v[66:67], v5 offset:512
    v_mfma_f32_16x16x32_bf16 v[112:115], v[68:71], v[32:35], v[112:115]
    s_add_u32 m0, s33, 77824
    v_mfma_f32_16x16x32_bf16 v[116:119], v[68:71], v[36:39], v[116:119]
    buffer_load_dwordx4 v23, s[40:43], s76 offen offset:0 lds
    v_mfma_f32_16x16x32_bf16 v[120:123], v[24:27], v[72:75], v[120:123]
    ds_read_b64_tr_b16 v[68:69], v4 offset:12288
    v_mfma_f32_16x16x32_bf16 v[124:127], v[28:31], v[72:75], v[124:127]
    ds_read_b64_tr_b16 v[70:71], v4 offset:12800
    v_mfma_f32_16x16x32_bf16 v[128:131], v[32:35], v[72:75], v[128:131]
    s_add_u32 m0, s33, 79872
    v_mfma_f32_16x16x32_bf16 v[132:135], v[36:39], v[72:75], v[132:135]
    buffer_load_dwordx4 v23, s[40:43], s76 offen offset:2048 lds
    v_mfma_f32_16x16x32_bf16 v[252:255], v[56:59], v[72:75], v[252:255]
    s_waitcnt lgkmcnt(6)
    v_mfma_f32_16x16x32_bf16 v[136:139], v[24:27], v[76:79], v[136:139]
    ds_read_b64_tr_b16 v[72:73], v4 offset:16384
    v_mfma_f32_16x16x32_bf16 v[140:143], v[28:31], v[76:79], v[140:143]
    ds_read_b64_tr_b16 v[74:75], v4 offset:16896
    v_mfma_f32_16x16x32_bf16 v[144:147], v[32:35], v[76:79], v[144:147]
    s_add_u32 m0, s33, 86016
    v_mfma_f32_16x16x32_bf16 v[148:151], v[36:39], v[76:79], v[148:151]
    buffer_load_dwordx4 v23, s[44:47], s76 offen offset:0 lds
    s_waitcnt lgkmcnt(6)
    v_mfma_f32_16x16x32_bf16 v[152:155], v[80:83], v[24:27], v[152:155]
    ds_read_b64_tr_b16 v[76:77], v5 offset:12288
    v_mfma_f32_16x16x32_bf16 v[156:159], v[80:83], v[28:31], v[156:159]
    ds_read_b64_tr_b16 v[78:79], v5 offset:12800
    v_mfma_f32_16x16x32_bf16 v[160:163], v[80:83], v[32:35], v[160:163]
    s_add_u32 m0, s33, 90112
    v_mfma_f32_16x16x32_bf16 v[164:167], v[80:83], v[36:39], v[164:167]
    buffer_load_dwordx4 v22, s[48:51], s77 offen offset:0 lds
    s_waitcnt lgkmcnt(6)
    v_mfma_f32_16x16x32_bf16 v[168:171], v[64:67], v[24:27], v[168:171]
    ds_read_b64_tr_b16 v[80:81], v5 offset:16384
    v_mfma_f32_16x16x32_bf16 v[172:175], v[64:67], v[28:31], v[172:175]
    ds_read_b64_tr_b16 v[82:83], v5 offset:16896
    v_mfma_f32_16x16x32_bf16 v[176:179], v[64:67], v[32:35], v[176:179]
    s_add_u32 m0, s33, 94208
    v_mfma_f32_16x16x32_bf16 v[180:183], v[64:67], v[36:39], v[180:183]
    buffer_load_dwordx4 v22, s[52:55], s77 offen offset:0 lds
    s_add_u32 s77, s77, 229376
    s_add_u32 s76, s76, 196608
    s_waitcnt lgkmcnt(6)
    v_mfma_f32_16x16x32_bf16 v[184:187], v[68:71], v[24:27], v[184:187]
    v_mfma_f32_16x16x32_bf16 v[188:191], v[68:71], v[28:31], v[188:191]
    v_mfma_f32_16x16x32_bf16 v[192:195], v[68:71], v[32:35], v[192:195]
    v_mfma_f32_16x16x32_bf16 v[196:199], v[68:71], v[36:39], v[196:199]
    s_waitcnt vmcnt(13) lgkmcnt(0)
    s_barrier
    v_mfma_f32_16x16x32_bf16 v[200:203], v[72:75], v[24:27], v[200:203]
    ds_read_b64_tr_b16 v[64:65], v4 offset:24576
    v_mfma_f32_16x16x32_bf16 v[204:207], v[72:75], v[28:31], v[204:207]
    ds_read_b64_tr_b16 v[66:67], v4 offset:25088
    v_mfma_f32_16x16x32_bf16 v[208:211], v[72:75], v[32:35], v[208:211]
    ds_read_b128 v[40:43], v15 offset:0
    v_mfma_f32_16x16x32_bf16 v[212:215], v[72:75], v[36:39], v[212:215]
    ds_read_b128 v[44:47], v15 offset:2048
    v_mfma_f32_16x16x32_bf16 v[216:219], v[76:79], v[24:27], v[216:219]
    ds_read_b128 v[48:51], v15 offset:4096
    v_mfma_f32_16x16x32_bf16 v[220:223], v[76:79], v[28:31], v[220:223]
    ds_read_b128 v[52:55], v15 offset:6144
    v_mfma_f32_16x16x32_bf16 v[224:227], v[76:79], v[32:35], v[224:227]
    ds_read_b64_tr_b16 v[68:69], v5 offset:24576
    v_mfma_f32_16x16x32_bf16 v[228:231], v[76:79], v[36:39], v[228:231]
    ds_read_b64_tr_b16 v[70:71], v5 offset:25088
    v_mfma_f32_16x16x32_bf16 v[232:235], v[80:83], v[24:27], v[232:235]
    ds_read_b64_tr_b16 v[72:73], v4 offset:28672
    v_mfma_f32_16x16x32_bf16 v[236:239], v[80:83], v[28:31], v[236:239]
    ds_read_b64_tr_b16 v[74:75], v4 offset:29184
    v_mfma_f32_16x16x32_bf16 v[240:243], v[80:83], v[32:35], v[240:243]
    ds_read_b128 v[60:63], v19
    v_mfma_f32_16x16x32_bf16 v[244:247], v[80:83], v[36:39], v[244:247]
    s_waitcnt lgkmcnt(8)
    v_mfma_f32_16x16x32_bf16 v[88:91], v[64:67], v[40:43], v[88:91]
    ds_read_b64_tr_b16 v[76:77], v5 offset:28672
    s_waitcnt lgkmcnt(8)
    v_mfma_f32_16x16x32_bf16 v[92:95], v[64:67], v[44:47], v[92:95]
    ds_read_b64_tr_b16 v[78:79], v5 offset:29184
    s_waitcnt lgkmcnt(8)
    v_mfma_f32_16x16x32_bf16 v[96:99], v[64:67], v[48:51], v[96:99]
    ds_read_b64_tr_b16 v[80:81], v4 offset:20480
    s_waitcnt lgkmcnt(8)
    v_mfma_f32_16x16x32_bf16 v[100:103], v[64:67], v[52:55], v[100:103]
    ds_read_b64_tr_b16 v[82:83], v4 offset:20992
    s_waitcnt lgkmcnt(4)
    v_mfma_f32_16x16x32_bf16 v[248:251], v[64:67], v[60:63], v[248:251]
    v_mfma_f32_16x16x32_bf16 v[104:107], v[68:71], v[40:43], v[104:107]
    ds_read_b64_tr_b16 v[64:65], v5 offset:20480
    v_mfma_f32_16x16x32_bf16 v[108:111], v[68:71], v[44:47], v[108:111]
    v_mfma_f32_16x16x32_bf16 v[112:115], v[68:71], v[48:51], v[112:115]
    ds_read_b64_tr_b16 v[66:67], v5 offset:20992
    v_mfma_f32_16x16x32_bf16 v[116:119], v[68:71], v[52:55], v[116:119]
    v_mfma_f32_16x16x32_bf16 v[120:123], v[40:43], v[72:75], v[120:123]
    ds_read_b64_tr_b16 v[68:69], v4 offset:32768
    v_mfma_f32_16x16x32_bf16 v[124:127], v[44:47], v[72:75], v[124:127]
    v_mfma_f32_16x16x32_bf16 v[128:131], v[48:51], v[72:75], v[128:131]
    ds_read_b64_tr_b16 v[70:71], v4 offset:33280
    v_mfma_f32_16x16x32_bf16 v[132:135], v[52:55], v[72:75], v[132:135]
    v_mfma_f32_16x16x32_bf16 v[252:255], v[60:63], v[72:75], v[252:255]
    s_waitcnt lgkmcnt(6)
    v_mfma_f32_16x16x32_bf16 v[136:139], v[40:43], v[76:79], v[136:139]
    ds_read_b64_tr_b16 v[72:73], v4 offset:36864
    v_mfma_f32_16x16x32_bf16 v[140:143], v[44:47], v[76:79], v[140:143]
    v_mfma_f32_16x16x32_bf16 v[144:147], v[48:51], v[76:79], v[144:147]
    ds_read_b64_tr_b16 v[74:75], v4 offset:37376
    v_mfma_f32_16x16x32_bf16 v[148:151], v[52:55], v[76:79], v[148:151]
    s_waitcnt lgkmcnt(6)
    v_mfma_f32_16x16x32_bf16 v[152:155], v[80:83], v[40:43], v[152:155]
    ds_read_b64_tr_b16 v[76:77], v5 offset:32768
    v_mfma_f32_16x16x32_bf16 v[156:159], v[80:83], v[44:47], v[156:159]
    v_mfma_f32_16x16x32_bf16 v[160:163], v[80:83], v[48:51], v[160:163]
    ds_read_b64_tr_b16 v[78:79], v5 offset:33280
    v_mfma_f32_16x16x32_bf16 v[164:167], v[80:83], v[52:55], v[164:167]
    s_waitcnt lgkmcnt(6)
    v_mfma_f32_16x16x32_bf16 v[168:171], v[64:67], v[40:43], v[168:171]
    ds_read_b64_tr_b16 v[80:81], v5 offset:36864
    v_mfma_f32_16x16x32_bf16 v[172:175], v[64:67], v[44:47], v[172:175]
    v_mfma_f32_16x16x32_bf16 v[176:179], v[64:67], v[48:51], v[176:179]
    ds_read_b64_tr_b16 v[82:83], v5 offset:37376
    v_mfma_f32_16x16x32_bf16 v[180:183], v[64:67], v[52:55], v[180:183]
    s_waitcnt lgkmcnt(6)
    v_mfma_f32_16x16x32_bf16 v[184:187], v[68:71], v[40:43], v[184:187]
    v_add_u32 v14, s80, v16
    v_add_u32 v15, s80, v17
    s_add_u32 s84, s80, s95
    v_add_u32 v18, s84, v16
    v_add_u32 v19, s84, v17
    s_add_u32 s80, s80, 18432
    s_cmp_ge_u32 s80, 153600
    s_cselect_b32 s84, 55296, 0
    s_sub_u32 s80, s80, s84
    v_mfma_f32_16x16x32_bf16 v[188:191], v[68:71], v[44:47], v[188:191]
    v_mfma_f32_16x16x32_bf16 v[192:195], v[68:71], v[48:51], v[192:195]
    v_mfma_f32_16x16x32_bf16 v[196:199], v[68:71], v[52:55], v[196:199]
    s_waitcnt vmcnt(5) lgkmcnt(0)
    s_barrier
    v_mfma_f32_16x16x32_bf16 v[200:203], v[72:75], v[40:43], v[200:203]
    ds_read_b64_tr_b16 v[64:65], v6 offset:4096
    v_mfma_f32_16x16x32_bf16 v[204:207], v[72:75], v[44:47], v[204:207]
    ds_read_b64_tr_b16 v[66:67], v6 offset:4608
    v_mfma_f32_16x16x32_bf16 v[208:211], v[72:75], v[48:51], v[208:211]
    ds_read_b128 v[24:27], v14 offset:0
    v_mfma_f32_16x16x32_bf16 v[212:215], v[72:75], v[52:55], v[212:215]
    ds_read_b128 v[28:31], v14 offset:2048
    v_mfma_f32_16x16x32_bf16 v[216:219], v[76:79], v[40:43], v[216:219]
    ds_read_b128 v[32:35], v14 offset:4096
    v_mfma_f32_16x16x32_bf16 v[220:223], v[76:79], v[44:47], v[220:223]
    ds_read_b128 v[36:39], v14 offset:6144
    v_mfma_f32_16x16x32_bf16 v[224:227], v[76:79], v[48:51], v[224:227]
    ds_read_b64_tr_b16 v[68:69], v7 offset:4096
    v_mfma_f32_16x16x32_bf16 v[228:231], v[76:79], v[52:55], v[228:231]
    ds_read_b64_tr_b16 v[70:71], v7 offset:4608
    v_mfma_f32_16x16x32_bf16 v[232:235], v[80:83], v[40:43], v[232:235]
    ds_read_b64_tr_b16 v[72:73], v6 offset:8192
    v_mfma_f32_16x16x32_bf16 v[236:239], v[80:83], v[44:47], v[236:239]
    ds_read_b64_tr_b16 v[74:75], v6 offset:8704
    v_mfma_f32_16x16x32_bf16 v[240:243], v[80:83], v[48:51], v[240:243]
    ds_read_b128 v[56:59], v18
    v_mfma_f32_16x16x32_bf16 v[244:247], v[80:83], v[52:55], v[244:247]
    s_waitcnt lgkmcnt(8)
    v_mfma_f32_16x16x32_bf16 v[88:91], v[64:67], v[24:27], v[88:91]
    ds_read_b64_tr_b16 v[76:77], v7 offset:8192
    s_waitcnt lgkmcnt(8)
    v_mfma_f32_16x16x32_bf16 v[92:95], v[64:67], v[28:31], v[92:95]
    ds_read_b64_tr_b16 v[78:79], v7 offset:8704
    s_waitcnt lgkmcnt(8)
    v_mfma_f32_16x16x32_bf16 v[96:99], v[64:67], v[32:35], v[96:99]
    ds_read_b64_tr_b16 v[80:81], v6 offset:0
    s_waitcnt lgkmcnt(8)
    v_mfma_f32_16x16x32_bf16 v[100:103], v[64:67], v[36:39], v[100:103]
    ds_read_b64_tr_b16 v[82:83], v6 offset:512
    s_waitcnt lgkmcnt(4)
    v_mfma_f32_16x16x32_bf16 v[248:251], v[64:67], v[56:59], v[248:251]
    v_mfma_f32_16x16x32_bf16 v[104:107], v[68:71], v[24:27], v[104:107]
    ds_read_b64_tr_b16 v[64:65], v7 offset:0
    v_mfma_f32_16x16x32_bf16 v[108:111], v[68:71], v[28:31], v[108:111]
    v_mfma_f32_16x16x32_bf16 v[112:115], v[68:71], v[32:35], v[112:115]
    ds_read_b64_tr_b16 v[66:67], v7 offset:512
    v_mfma_f32_16x16x32_bf16 v[116:119], v[68:71], v[36:39], v[116:119]
    v_mfma_f32_16x16x32_bf16 v[120:123], v[24:27], v[72:75], v[120:123]
    ds_read_b64_tr_b16 v[68:69], v6 offset:12288
    v_mfma_f32_16x16x32_bf16 v[124:127], v[28:31], v[72:75], v[124:127]
    v_mfma_f32_16x16x32_bf16 v[128:131], v[32:35], v[72:75], v[128:131]
    ds_read_b64_tr_b16 v[70:71], v6 offset:12800
    v_mfma_f32_16x16x32_bf16 v[132:135], v[36:39], v[72:75], v[132:135]
    v_mfma_f32_16x16x32_bf16 v[252:255], v[56:59], v[72:75], v[252:255]
    s_waitcnt lgkmcnt(6)
    v_mfma_f32_16x16x32_bf16 v[136:139], v[24:27], v[76:79], v[136:139]
    ds_read_b64_tr_b16 v[72:73], v6 offset:16384
    v_mfma_f32_16x16x32_bf16 v[140:143], v[28:31], v[76:79], v[140:143]
    v_mfma_f32_16x16x32_bf16 v[144:147], v[32:35], v[76:79], v[144:147]
    ds_read_b64_tr_b16 v[74:75], v6 offset:16896
    v_mfma_f32_16x16x32_bf16 v[148:151], v[36:39], v[76:79], v[148:151]
    s_waitcnt lgkmcnt(6)
    v_mfma_f32_16x16x32_bf16 v[152:155], v[80:83], v[24:27], v[152:155]
    ds_read_b64_tr_b16 v[76:77], v7 offset:12288
    v_mfma_f32_16x16x32_bf16 v[156:159], v[80:83], v[28:31], v[156:159]
    v_mfma_f32_16x16x32_bf16 v[160:163], v[80:83], v[32:35], v[160:163]
    ds_read_b64_tr_b16 v[78:79], v7 offset:12800
    v_mfma_f32_16x16x32_bf16 v[164:167], v[80:83], v[36:39], v[164:167]
    s_waitcnt lgkmcnt(6)
    v_mfma_f32_16x16x32_bf16 v[168:171], v[64:67], v[24:27], v[168:171]
    ds_read_b64_tr_b16 v[80:81], v7 offset:16384
    v_mfma_f32_16x16x32_bf16 v[172:175], v[64:67], v[28:31], v[172:175]
    v_mfma_f32_16x16x32_bf16 v[176:179], v[64:67], v[32:35], v[176:179]
    ds_read_b64_tr_b16 v[82:83], v7 offset:16896
    v_mfma_f32_16x16x32_bf16 v[180:183], v[64:67], v[36:39], v[180:183]
    s_waitcnt lgkmcnt(6)
    v_mfma_f32_16x16x32_bf16 v[184:187], v[68:71], v[24:27], v[184:187]
    v_mfma_f32_16x16x32_bf16 v[188:191], v[68:71], v[28:31], v[188:191]
    v_mfma_f32_16x16x32_bf16 v[192:195], v[68:71], v[32:35], v[192:195]
    v_mfma_f32_16x16x32_bf16 v[196:199], v[68:71], v[36:39], v[196:199]
    s_waitcnt vmcnt(0) lgkmcnt(0)
    s_barrier
    v_mfma_f32_16x16x32_bf16 v[200:203], v[72:75], v[24:27], v[200:203]
    ds_read_b64_tr_b16 v[64:65], v6 offset:24576
    v_mfma_f32_16x16x32_bf16 v[204:207], v[72:75], v[28:31], v[204:207]
    ds_read_b64_tr_b16 v[66:67], v6 offset:25088
    v_mfma_f32_16x16x32_bf16 v[208:211], v[72:75], v[32:35], v[208:211]
    ds_read_b128 v[40:43], v15 offset:0
    v_mfma_f32_16x16x32_bf16 v[212:215], v[72:75], v[36:39], v[212:215]
    ds_read_b128 v[44:47], v15 offset:2048
    v_mfma_f32_16x16x32_bf16 v[216:219], v[76:79], v[24:27], v[216:219]
    ds_read_b128 v[48:51], v15 offset:4096
    v_mfma_f32_16x16x32_bf16 v[220:223], v[76:79], v[28:31], v[220:223]
    ds_read_b128 v[52:55], v15 offset:6144
    v_mfma_f32_16x16x32_bf16 v[224:227], v[76:79], v[32:35], v[224:227]
    ds_read_b64_tr_b16 v[68:69], v7 offset:24576
    v_mfma_f32_16x16x32_bf16 v[228:231], v[76:79], v[36:39], v[228:231]
    ds_read_b64_tr_b16 v[70:71], v7 offset:25088
    v_mfma_f32_16x16x32_bf16 v[232:235], v[80:83], v[24:27], v[232:235]
    ds_read_b64_tr_b16 v[72:73], v6 offset:28672
    v_mfma_f32_16x16x32_bf16 v[236:239], v[80:83], v[28:31], v[236:239]
    ds_read_b64_tr_b16 v[74:75], v6 offset:29184
    v_mfma_f32_16x16x32_bf16 v[240:243], v[80:83], v[32:35], v[240:243]
    ds_read_b128 v[60:63], v19
    v_mfma_f32_16x16x32_bf16 v[244:247], v[80:83], v[36:39], v[244:247]
    s_waitcnt lgkmcnt(8)
    v_mfma_f32_16x16x32_bf16 v[88:91], v[64:67], v[40:43], v[88:91]
    ds_read_b64_tr_b16 v[76:77], v7 offset:28672
    s_waitcnt lgkmcnt(8)
    v_mfma_f32_16x16x32_bf16 v[92:95], v[64:67], v[44:47], v[92:95]
    ds_read_b64_tr_b16 v[78:79], v7 offset:29184
    s_waitcnt lgkmcnt(8)
    v_mfma_f32_16x16x32_bf16 v[96:99], v[64:67], v[48:51], v[96:99]
    ds_read_b64_tr_b16 v[80:81], v6 offset:20480
    s_waitcnt lgkmcnt(8)
    v_mfma_f32_16x16x32_bf16 v[100:103], v[64:67], v[52:55], v[100:103]
    ds_read_b64_tr_b16 v[82:83], v6 offset:20992
    s_waitcnt lgkmcnt(4)
    v_mfma_f32_16x16x32_bf16 v[248:251], v[64:67], v[60:63], v[248:251]
    v_mfma_f32_16x16x32_bf16 v[104:107], v[68:71], v[40:43], v[104:107]
    ds_read_b64_tr_b16 v[64:65], v7 offset:20480
    v_mfma_f32_16x16x32_bf16 v[108:111], v[68:71], v[44:47], v[108:111]
    v_mfma_f32_16x16x32_bf16 v[112:115], v[68:71], v[48:51], v[112:115]
    ds_read_b64_tr_b16 v[66:67], v7 offset:20992
    v_mfma_f32_16x16x32_bf16 v[116:119], v[68:71], v[52:55], v[116:119]
    v_mfma_f32_16x16x32_bf16 v[120:123], v[40:43], v[72:75], v[120:123]
    ds_read_b64_tr_b16 v[68:69], v6 offset:32768
    v_mfma_f32_16x16x32_bf16 v[124:127], v[44:47], v[72:75], v[124:127]
    v_mfma_f32_16x16x32_bf16 v[128:131], v[48:51], v[72:75], v[128:131]
    ds_read_b64_tr_b16 v[70:71], v6 offset:33280
    v_mfma_f32_16x16x32_bf16 v[132:135], v[52:55], v[72:75], v[132:135]
    v_mfma_f32_16x16x32_bf16 v[252:255], v[60:63], v[72:75], v[252:255]
    s_waitcnt lgkmcnt(6)
    v_mfma_f32_16x16x32_bf16 v[136:139], v[40:43], v[76:79], v[136:139]
    ds_read_b64_tr_b16 v[72:73], v6 offset:36864
    v_mfma_f32_16x16x32_bf16 v[140:143], v[44:47], v[76:79], v[140:143]
    v_mfma_f32_16x16x32_bf16 v[144:147], v[48:51], v[76:79], v[144:147]
    ds_read_b64_tr_b16 v[74:75], v6 offset:37376
    v_mfma_f32_16x16x32_bf16 v[148:151], v[52:55], v[76:79], v[148:151]
    s_waitcnt lgkmcnt(6)
    v_mfma_f32_16x16x32_bf16 v[152:155], v[80:83], v[40:43], v[152:155]
    ds_read_b64_tr_b16 v[76:77], v7 offset:32768
    v_mfma_f32_16x16x32_bf16 v[156:159], v[80:83], v[44:47], v[156:159]
    v_mfma_f32_16x16x32_bf16 v[160:163], v[80:83], v[48:51], v[160:163]
    ds_read_b64_tr_b16 v[78:79], v7 offset:33280
    v_mfma_f32_16x16x32_bf16 v[164:167], v[80:83], v[52:55], v[164:167]
    s_waitcnt lgkmcnt(6)
    v_mfma_f32_16x16x32_bf16 v[168:171], v[64:67], v[40:43], v[168:171]
    ds_read_b64_tr_b16 v[80:81], v7 offset:36864
    v_mfma_f32_16x16x32_bf16 v[172:175], v[64:67], v[44:47], v[172:175]
    v_mfma_f32_16x16x32_bf16 v[176:179], v[64:67], v[48:51], v[176:179]
    ds_read_b64_tr_b16 v[82:83], v7 offset:37376
    v_mfma_f32_16x16x32_bf16 v[180:183], v[64:67], v[52:55], v[180:183]
    s_waitcnt lgkmcnt(6)
    v_mfma_f32_16x16x32_bf16 v[184:187], v[68:71], v[40:43], v[184:187]
    v_mfma_f32_16x16x32_bf16 v[188:191], v[68:71], v[44:47], v[188:191]
    v_mfma_f32_16x16x32_bf16 v[192:195], v[68:71], v[48:51], v[192:195]
    v_mfma_f32_16x16x32_bf16 v[196:199], v[68:71], v[52:55], v[196:199]
    s_waitcnt lgkmcnt(0)
    s_barrier
    v_mfma_f32_16x16x32_bf16 v[200:203], v[72:75], v[40:43], v[200:203]
    v_mfma_f32_16x16x32_bf16 v[204:207], v[72:75], v[44:47], v[204:207]
    v_mfma_f32_16x16x32_bf16 v[208:211], v[72:75], v[48:51], v[208:211]
    v_mfma_f32_16x16x32_bf16 v[212:215], v[72:75], v[52:55], v[212:215]
    v_mfma_f32_16x16x32_bf16 v[216:219], v[76:79], v[40:43], v[216:219]
    v_mfma_f32_16x16x32_bf16 v[220:223], v[76:79], v[44:47], v[220:223]
    v_mfma_f32_16x16x32_bf16 v[224:227], v[76:79], v[48:51], v[224:227]
    v_mfma_f32_16x16x32_bf16 v[228:231], v[76:79], v[52:55], v[228:231]
    v_mfma_f32_16x16x32_bf16 v[232:235], v[80:83], v[40:43], v[232:235]
    v_mfma_f32_16x16x32_bf16 v[236:239], v[80:83], v[44:47], v[236:239]
    v_mfma_f32_16x16x32_bf16 v[240:243], v[80:83], v[48:51], v[240:243]
    v_mfma_f32_16x16x32_bf16 v[244:247], v[80:83], v[52:55], v[244:247]
    s_setprio 0
    s_nop 7
    s_mul_i32 s84, s6, 3072
    s_add_u32 s84, s84, 153600
    v_lshl_add_u32 v6, v1, 3, s84
    v_cvt_pk_bf16_f32 v100, v100, v101
    v_cvt_pk_bf16_f32 v101, v102, v103
    v_cvt_pk_bf16_f32 v102, v116, v117
    v_cvt_pk_bf16_f32 v103, v118, v119
    v_cvt_pk_bf16_f32 v32, v132, v133
    v_cvt_pk_bf16_f32 v33, v134, v135
    v_cvt_pk_bf16_f32 v42, v148, v149
    v_cvt_pk_bf16_f32 v43, v150, v151
    v_cvt_pk_bf16_f32 v44, v248, v249
    v_cvt_pk_bf16_f32 v45, v250, v251
    v_cvt_pk_bf16_f32 v24, v252, v253
    v_cvt_pk_bf16_f32 v25, v254, v255
    s_cmp_lg_u32 s5, 0
    s_cbranch_scc1 L_hx1
    ds_write_b64 v6, v[100:101]
    ds_write_b64 v6, v[102:103] offset:512
    ds_write_b64 v6, v[32:33] offset:1024
    ds_write_b64 v6, v[42:43] offset:1536
    s_branch L_hx2
L_hx1:
    ds_write_b64 v6, v[44:45] offset:2048
    ds_write_b64 v6, v[24:25] offset:2560
L_hx2:
    v_lshrrev_b32 v16, 4, v1
    v_and_b32 v17, 1, v16
    v_lshrrev_b32 v16, 1, v16
    v_lshlrev_b32 v16, 8, v16
    v_lshl_add_u32 v16, v17, 10, v16
    v_and_b32 v17, 15, v1
    v_lshl_add_u32 v4, v17, 4, v16
    s_mul_i32 s84, s28, 112
    s_lshl1_add_u32 s85, s29, s6
    s_add_u32 s84, s84, s85
    s_add_u32 s84, s84, 80
    s_lshl_b32 s84, s84, 13
    s_lshl_b32 s86, s5, 12
    s_add_u32 s84, s84, s86
    s_add_u32 s84, s84, 0x400000
    s_lshl_b32 s87, s5, 9
    s_add_u32 s36, s84, s87
    s_xor_b32 s87, s87, 512
    s_add_u32 s37, s84, s87
    s_lshl_b32 s84, s28, 5
    s_add_u32 s84, s84, s85
    s_lshl_b32 s84, s84, 13
    s_add_u32 s84, s84, s86
    s_add_u32 s38, s84, 0x1200000
    s_mov_b32 s56, 0xbdd2d3e8
    v_mov_b32 v73, 0xc0135761
    s_waitcnt lgkmcnt(0)
    v_mul_f32 v80, v184, v184
    v_mul_f32 v81, v185, v185
    v_mul_f32 v82, v186, v186
    v_mul_f32 v83, v187, v187
    v_fma_f32 v80, v80, s56, v73
    v_fma_f32 v81, v81, s56, v73
    v_fma_f32 v82, v82, s56, v73
    v_fma_f32 v83, v83, s56, v73
    v_mul_f32 v80, v80, v184
    v_mul_f32 v81, v81, v185
    v_mul_f32 v82, v82, v186
    v_mul_f32 v83, v83, v187
    v_exp_f32 v80, v80
    v_mul_f32 v184, v184, v200
    v_exp_f32 v81, v81
    v_mul_f32 v185, v185, v201
    v_exp_f32 v82, v82
    v_mul_f32 v186, v186, v202
    v_exp_f32 v83, v83
    v_mul_f32 v187, v187, v203
    v_add_f32 v80, 1.0, v80
    v_add_f32 v81, 1.0, v81
    v_add_f32 v82, 1.0, v82
    v_add_f32 v83, 1.0, v83
    v_rcp_f32 v80, v80
    v_rcp_f32 v81, v81
    v_rcp_f32 v82, v82
    v_rcp_f32 v83, v83
    s_nop 0
    v_mul_f32 v184, v184, v80
    v_mul_f32 v185, v185, v81
    v_mul_f32 v186, v186, v82
    v_mul_f32 v187, v187, v83
    v_cvt_pk_bf16_f32 v184, v184, v185
    v_cvt_pk_bf16_f32 v185, v186, v187
    v_mul_f32 v80, v188, v188
    v_mul_f32 v81, v189, v189
    v_mul_f32 v82, v190, v190
    v_mul_f32 v83, v191, v191
    v_fma_f32 v80, v80, s56, v73
    v_fma_f32 v81, v81, s56, v73
    v_fma_f32 v82, v82, s56, v73
    v_fma_f32 v83, v83, s56, v73
    v_mul_f32 v80, v80, v188
    v_mul_f32 v81, v81, v189
    v_mul_f32 v82, v82, v190
    v_mul_f32 v83, v83, v191
    v_exp_f32 v80, v80
    v_mul_f32 v188, v188, v204
    v_exp_f32 v81, v81
    v_mul_f32 v189, v189, v205
    v_exp_f32 v82, v82
    v_mul_f32 v190, v190, v206
    v_exp_f32 v83, v83
    v_mul_f32 v191, v191, v207
    v_add_f32 v80, 1.0, v80
    v_add_f32 v81, 1.0, v81
    v_add_f32 v82, 1.0, v82
    v_add_f32 v83, 1.0, v83
    v_rcp_f32 v80, v80
    v_rcp_f32 v81, v81
    v_rcp_f32 v82, v82
    v_rcp_f32 v83, v83
    s_nop 0
    v_mul_f32 v188, v188, v80
    v_mul_f32 v189, v189, v81
    v_mul_f32 v190, v190, v82
    v_mul_f32 v191, v191, v83
    v_cvt_pk_bf16_f32 v186, v188, v189
    v_cvt_pk_bf16_f32 v187, v190, v191
    s_barrier
    s_cmp_lg_u32 s5, 0
    s_cbranch_scc1 L_hx3
    ds_read_b64 v[46:47], v6 offset:2048
    ds_read_b64 v[34:35], v6 offset:2560
    s_branch L_hx4
L_hx3:
    ds_read_b64 v[44:45], v6 offset:512
    ds_read_b64 v[46:47], v6
    ds_read_b64 v[24:25], v6 offset:1536
    ds_read_b64 v[34:35], v6 offset:1024
L_hx4:
    s_nop 1
    v_permlane16_swap_b32 v184, v186
    v_permlane16_swap_b32 v185, v187
    buffer_store_dwordx4 v[184:187], v4, s[68:71], s36 offen offset:0 sc1
    v_mul_f32 v80, v192, v192
    v_mul_f32 v81, v193, v193
    v_mul_f32 v82, v194, v194
    v_mul_f32 v83, v195, v195
    v_fma_f32 v80, v80, s56, v73
    v_fma_f32 v81, v81, s56, v73
    v_fma_f32 v82, v82, s56, v73
    v_fma_f32 v83, v83, s56, v73
    v_mul_f32 v80, v80, v192
    v_mul_f32 v81, v81, v193
    v_mul_f32 v82, v82, v194
    v_mul_f32 v83, v83, v195
    v_exp_f32 v80, v80
    v_mul_f32 v192, v192, v208
    v_exp_f32 v81, v81
    v_mul_f32 v193, v193, v209
    v_exp_f32 v82, v82
    v_mul_f32 v194, v194, v210
    v_exp_f32 v83, v83
    v_mul_f32 v195, v195, v211
    v_add_f32 v80, 1.0, v80
    v_add_f32 v81, 1.0, v81
    v_add_f32 v82, 1.0, v82
    v_add_f32 v83, 1.0, v83
    v_rcp_f32 v80, v80
    v_rcp_f32 v81, v81
    v_rcp_f32 v82, v82
    v_rcp_f32 v83, v83
    s_nop 0
    v_mul_f32 v192, v192, v80
    v_mul_f32 v193, v193, v81
    v_mul_f32 v194, v194, v82
    v_mul_f32 v195, v195, v83
    v_cvt_pk_bf16_f32 v192, v192, v193
    v_cvt_pk_bf16_f32 v193, v194, v195
    v_mul_f32 v80, v196, v196
    v_mul_f32 v81, v197, v197
    v_mul_f32 v82, v198, v198
    v_mul_f32 v83, v199, v199
    v_fma_f32 v80, v80, s56, v73
    v_fma_f32 v81, v81, s56, v73
    v_fma_f32 v82, v82, s56, v73
    v_fma_f32 v83, v83, s56, v73
    v_mul_f32 v80, v80, v196
    v_mul_f32 v81, v81, v197
    v_mul_f32 v82, v82, v198
    v_mul_f32 v83, v83, v199
    v_exp_f32 v80, v80
    v_mul_f32 v196, v196, v212
    v_exp_f32 v81, v81
    v_mul_f32 v197, v197, v213
    v_exp_f32 v82, v82
    v_mul_f32 v198, v198, v214
    v_exp_f32 v83, v83
    v_mul_f32 v199, v199, v215
    v_add_f32 v80, 1.0, v80
    v_add_f32 v81, 1.0, v81
    v_add_f32 v82, 1.0, v82
    v_add_f32 v83, 1.0, v83
    v_rcp_f32 v80, v80
    v_rcp_f32 v81, v81
    v_rcp_f32 v82, v82
    s_barrier
    v_rcp_f32 v83, v83
    s_nop 0
    v_mul_f32 v196, v196, v80
    v_mul_f32 v197, v197, v81
    v_mul_f32 v198, v198, v82
    v_mul_f32 v199, v199, v83
    v_cvt_pk_bf16_f32 v194, v196, v197
    v_cvt_pk_bf16_f32 v195, v198, v199
    s_nop 1
    v_permlane16_swap_b32 v192, v194
    v_permlane16_swap_b32 v193, v195
    buffer_store_dwordx4 v[192:195], v4, s[68:71], s36 offen offset:2048 sc1
    v_mul_f32 v80, v216, v216
    v_mul_f32 v81, v217, v217
    v_mul_f32 v82, v218, v218
    v_mul_f32 v83, v219, v219
    v_fma_f32 v80, v80, s56, v73
    v_fma_f32 v81, v81, s56, v73
    v_fma_f32 v82, v82, s56, v73
    v_fma_f32 v83, v83, s56, v73
    v_mul_f32 v80, v80, v216
    v_mul_f32 v81, v81, v217
    v_mul_f32 v82, v82, v218
    v_mul_f32 v83, v83, v219
    v_exp_f32 v80, v80
    v_mul_f32 v216, v216, v232
    v_exp_f32 v81, v81
    v_mul_f32 v217, v217, v233
    v_exp_f32 v82, v82
    v_mul_f32 v218, v218, v234
    v_exp_f32 v83, v83
    v_mul_f32 v219, v219, v235
    v_add_f32 v80, 1.0, v80
    v_add_f32 v81, 1.0, v81
    v_add_f32 v82, 1.0, v82
    v_add_f32 v83, 1.0, v83
    v_rcp_f32 v80, v80
    v_rcp_f32 v81, v81
    v_rcp_f32 v82, v82
    v_rcp_f32 v83, v83
    s_nop 0
    v_mul_f32 v216, v216, v80
    v_mul_f32 v217, v217, v81
    v_mul_f32 v218, v218, v82
    v_mul_f32 v219, v219, v83
    v_cvt_pk_bf16_f32 v216, v216, v217
    v_cvt_pk_bf16_f32 v217, v218, v219
    v_mul_f32 v80, v220, v220
    v_mul_f32 v81, v221, v221
    v_mul_f32 v82, v222, v222
    v_mul_f32 v83, v223, v223
    v_fma_f32 v80, v80, s56, v73
    v_fma_f32 v81, v81, s56, v73
    v_fma_f32 v82, v82, s56, v73
    v_fma_f32 v83, v83, s56, v73
    v_mul_f32 v80, v80, v220
    v_mul_f32 v81, v81, v221
    v_mul_f32 v82, v82, v222
    v_mul_f32 v83, v83, v223
    v_exp_f32 v80, v80
    v_mul_f32 v220, v220, v236
    v_exp_f32 v81, v81
    v_mul_f32 v221, v221, v237
    v_exp_f32 v82, v82
    v_mul_f32 v222, v222, v238
    v_exp_f32 v83, v83
    v_mul_f32 v223, v223, v239
    v_add_f32 v80, 1.0, v80
    s_barrier
    v_add_f32 v81, 1.0, v81
    v_add_f32 v82, 1.0, v82
    v_add_f32 v83, 1.0, v83
    v_rcp_f32 v80, v80
    v_rcp_f32 v81, v81
    v_rcp_f32 v82, v82
    v_rcp_f32 v83, v83
    s_nop 0
    v_mul_f32 v220, v220, v80
    v_mul_f32 v221, v221, v81
    v_mul_f32 v222, v222, v82
    v_mul_f32 v223, v223, v83
    v_cvt_pk_bf16_f32 v218, v220, v221
    v_cvt_pk_bf16_f32 v219, v222, v223
    s_nop 1
    v_permlane16_swap_b32 v216, v218
    v_permlane16_swap_b32 v217, v219
    buffer_store_dwordx4 v[216:219], v4, s[68:71], s37 offen offset:0 sc1
    v_mul_f32 v80, v224, v224
    v_mul_f32 v81, v225, v225
    v_mul_f32 v82, v226, v226
    v_mul_f32 v83, v227, v227
    v_fma_f32 v80, v80, s56, v73
    v_fma_f32 v81, v81, s56, v73
    v_fma_f32 v82, v82, s56, v73
    v_fma_f32 v83, v83, s56, v73
    v_mul_f32 v80, v80, v224
    v_mul_f32 v81, v81, v225
    v_mul_f32 v82, v82, v226
    v_mul_f32 v83, v83, v227
    v_exp_f32 v80, v80
    v_mul_f32 v224, v224, v240
    v_exp_f32 v81, v81
    v_mul_f32 v225, v225, v241
    v_exp_f32 v82, v82
    v_mul_f32 v226, v226, v242
    v_exp_f32 v83, v83
    v_mul_f32 v227, v227, v243
    v_add_f32 v80, 1.0, v80
    v_add_f32 v81, 1.0, v81
    v_add_f32 v82, 1.0, v82
    v_add_f32 v83, 1.0, v83
    v_rcp_f32 v80, v80
    v_rcp_f32 v81, v81
    v_rcp_f32 v82, v82
    v_rcp_f32 v83, v83
    s_nop 0
    v_mul_f32 v224, v224, v80
    v_mul_f32 v225, v225, v81
    v_mul_f32 v226, v226, v82
    v_mul_f32 v227, v227, v83
    v_cvt_pk_bf16_f32 v224, v224, v225
    v_cvt_pk_bf16_f32 v225, v226, v227
    v_mul_f32 v80, v228, v228
    v_mul_f32 v81, v229, v229
    v_mul_f32 v82, v230, v230
    v_mul_f32 v83, v231, v231
    v_fma_f32 v80, v80, s56, v73
    v_fma_f32 v81, v81, s56, v73
    v_fma_f32 v82, v82, s56, v73
    v_fma_f32 v83, v83, s56, v73
    v_mul_f32 v80, v80, v228
    v_mul_f32 v81, v81, v229
    v_mul_f32 v82, v82, v230
    v_mul_f32 v83, v83, v231
    v_exp_f32 v80, v80
    v_mul_f32 v228, v228, v244
    v_exp_f32 v81, v81
    s_barrier
    v_mul_f32 v229, v229, v245
    v_exp_f32 v82, v82
    v_mul_f32 v230, v230, v246
    v_exp_f32 v83, v83
    v_mul_f32 v231, v231, v247
    v_add_f32 v80, 1.0, v80
    v_add_f32 v81, 1.0, v81
    v_add_f32 v82, 1.0, v82
    v_add_f32 v83, 1.0, v83
    v_rcp_f32 v80, v80
    v_rcp_f32 v81, v81
    v_rcp_f32 v82, v82
    v_rcp_f32 v83, v83
    s_nop 0
    v_mul_f32 v228, v228, v80
    v_mul_f32 v229, v229, v81
    v_mul_f32 v230, v230, v82
    v_mul_f32 v231, v231, v83
    v_cvt_pk_bf16_f32 v226, v228, v229
    v_cvt_pk_bf16_f32 v227, v230, v231
    s_nop 1
    v_permlane16_swap_b32 v224, v226
    v_permlane16_swap_b32 v225, v227
    buffer_store_dwordx4 v[224:227], v4, s[68:71], s37 offen offset:2048 sc1
    v_lshrrev_b32 v60, 4, v1
    v_and_b32 v61, 15, v1
    v_and_b32 v62, 1, v60
    v_xor_b32 v62, s5, v62
    v_lshrrev_b32 v63, 1, v60
    v_lshl_add_u32 v62, v62, 1, v63
    v_lshlrev_b32 v62, 8, v62
    v_lshl_add_u32 v5, v61, 4, v62
    v_lshlrev_b32 v60, 2, v60
    v_sub_u32 v60, v61, v60
    v_add_u32 v61, 16, v60
    v_and_b32 v61, 0xfffffff1, v61
    v_cmp_eq_u32 s[40:41], 0, v61
    v_add_u32 v61, 15, v60
    v_and_b32 v61, 0xfffffff1, v61
    v_cmp_eq_u32 s[42:43], 0, v61
    v_add_u32 v61, 14, v60
    v_and_b32 v61, 0xfffffff1, v61
    v_cmp_eq_u32 s[44:45], 0, v61
    v_add_u32 v61, 13, v60
    v_and_b32 v61, 0xfffffff1, v61
    v_cmp_eq_u32 s[46:47], 0, v61
    v_add_u32 v61, 0, v60
    v_and_b32 v61, 0xfffffff1, v61
    v_cmp_eq_u32 s[48:49], 0, v61
    v_add_u32 v61, -1, v60
    v_and_b32 v61, 0xfffffff1, v61
    v_cmp_eq_u32 s[50:51], 0, v61
    v_add_u32 v61, -2, v60
    v_and_b32 v61, 0xfffffff1, v61
    v_cmp_eq_u32 s[52:53], 0, v61
    v_add_u32 v61, -3, v60
    v_and_b32 v61, 0xfffffff1, v61
    v_cmp_eq_u32 s[54:55], 0, v61
    s_or_b32 s60, s28, s5
    s_cmp_eq_u32 s60, 0
    s_cselect_b64 s[60:61], 0, -1
    v_mov_b32 v72, 0xce6e6b28
    s_mov_b32 s57, 0x3e3504f3
    s_mov_b32 s58, 0x3fb8aa3b
    s_waitcnt lgkmcnt(0)
    v_cvt_pk_bf16_f32 v88, v88, v89
    v_cvt_pk_bf16_f32 v89, v90, v91
    v_cvt_pk_bf16_f32 v90, v104, v105
    v_cvt_pk_bf16_f32 v91, v106, v107
    v_cvt_pk_bf16_f32 v26, v120, v121
    v_cvt_pk_bf16_f32 v27, v122, v123
    v_cvt_pk_bf16_f32 v36, v136, v137
    v_cvt_pk_bf16_f32 v37, v138, v139
    v_cvt_pk_bf16_f32 v152, v152, v153
    v_cvt_pk_bf16_f32 v153, v154, v155
    v_cvt_pk_bf16_f32 v154, v168, v169
    v_cvt_pk_bf16_f32 v155, v170, v171
    s_nop 1
    v_mfma_f32_16x16x32_bf16 v[48:51], v[44:47], v[152:155], 0
    s_barrier
    v_mfma_f32_16x16x32_bf16 v[52:55], v[88:91], v[152:155], 0
    s_nop 7
    v_cvt_pk_bf16_f32 v56, v48, v49
    v_cvt_pk_bf16_f32 v57, v50, v51
    v_lshlrev_b32 v48, 16, v56
    v_and_b32 v49, 0xffff0000, v56
    v_lshlrev_b32 v50, 16, v57
    v_and_b32 v51, 0xffff0000, v57
    v_cvt_pk_bf16_f32 v56, v52, v53
    v_cvt_pk_bf16_f32 v57, v54, v55
    v_lshlrev_b32 v52, 16, v56
    v_and_b32 v53, 0xffff0000, v56
    v_lshlrev_b32 v54, 16, v57
    v_and_b32 v55, 0xffff0000, v57
    v_mul_f32 v48, s57, v48
    v_mul_f32 v49, s57, v49
    v_mul_f32 v50, s57, v50
    v_mul_f32 v51, s57, v51
    v_mul_f32 v52, s57, v52
    v_mul_f32 v53, s57, v53
    v_mul_f32 v54, s57, v54
    v_mul_f32 v55, s57, v55
    v_cvt_pk_bf16_f32 v56, v48, v49
    v_cvt_pk_bf16_f32 v57, v50, v51
    v_lshlrev_b32 v48, 16, v56
    v_and_b32 v49, 0xffff0000, v56
    v_lshlrev_b32 v50, 16, v57
    v_and_b32 v51, 0xffff0000, v57
    v_cvt_pk_bf16_f32 v56, v52, v53
    v_cvt_pk_bf16_f32 v57, v54, v55
    v_lshlrev_b32 v52, 16, v56
    v_and_b32 v53, 0xffff0000, v56
    v_lshlrev_b32 v54, 16, v57
    v_and_b32 v55, 0xffff0000, v57
    s_and_b64 vcc, s[40:41], s[60:61]
    v_cndmask_b32 v48, v72, v48, vcc
    s_and_b64 vcc, s[42:43], s[60:61]
    v_cndmask_b32 v49, v72, v49, vcc
    s_and_b64 vcc, s[44:45], s[60:61]
    v_cndmask_b32 v50, v72, v50, vcc
    s_and_b64 vcc, s[46:47], s[60:61]
    v_cndmask_b32 v51, v72, v51, vcc
    v_cndmask_b32 v52, v72, v52, s[48:49]
    v_cndmask_b32 v53, v72, v53, s[50:51]
    v_cndmask_b32 v54, v72, v54, s[52:53]
    v_cndmask_b32 v55, v72, v55, s[54:55]
    v_max3_f32 v60, v48, v49, v50
    v_max3_f32 v60, v60, v51, v52
    v_max3_f32 v60, v60, v53, v54
    v_max_f32 v60, v60, v55
    v_mov_b32 v61, v60
    s_nop 1
    v_permlane16_swap_b32 v60, v61
    v_max_f32 v60, v60, v61
    v_mov_b32 v61, v60
    s_nop 1
    v_permlane32_swap_b32 v60, v61
    v_max_f32 v60, v60, v61
    v_sub_f32 v48, v48, v60
    v_sub_f32 v49, v49, v60
    v_sub_f32 v50, v50, v60
    v_sub_f32 v51, v51, v60
    v_sub_f32 v52, v52, v60
    v_sub_f32 v53, v53, v60
    v_sub_f32 v54, v54, v60
    v_sub_f32 v55, v55, v60
    v_mul_f32 v48, s58, v48
    v_mul_f32 v49, s58, v49
    v_mul_f32 v50, s58, v50
    v_mul_f32 v51, s58, v51
    v_mul_f32 v52, s58, v52
    v_mul_f32 v53, s58, v53
    v_mul_f32 v54, s58, v54
    v_mul_f32 v55, s58, v55
    v_exp_f32 v48, v48
    v_exp_f32 v49, v49
    v_exp_f32 v50, v50
    s_barrier
    v_exp_f32 v51, v51
    v_exp_f32 v52, v52
    v_exp_f32 v53, v53
    v_exp_f32 v54, v54
    v_exp_f32 v55, v55
    s_nop 0
    v_add_f32 v60, v48, v49
    v_add_f32 v60, v60, v50
    v_add_f32 v60, v60, v51
    v_add_f32 v60, v60, v52
    v_add_f32 v60, v60, v53
    v_add_f32 v60, v60, v54
    v_add_f32 v60, v60, v55
    v_mov_b32 v61, v60
    s_nop 1
    v_permlane16_swap_b32 v60, v61
    v_add_f32 v60, v60, v61
    v_mov_b32 v61, v60
    s_nop 1
    v_permlane32_swap_b32 v60, v61
    v_add_f32 v60, v60, v61
    v_rcp_f32 v60, v60
    s_nop 0
    v_mul_f32 v48, v48, v60
    v_mul_f32 v49, v49, v60
    v_mul_f32 v50, v50, v60
    v_mul_f32 v51, v51, v60
    v_mul_f32 v52, v52, v60
    v_mul_f32 v53, v53, v60
    v_mul_f32 v54, v54, v60
    v_mul_f32 v55, v55, v60
    v_cvt_pk_bf16_f32 v56, v48, v49
    v_cvt_pk_bf16_f32 v57, v50, v51
    v_cvt_pk_bf16_f32 v58, v52, v53
    v_cvt_pk_bf16_f32 v59, v54, v55
    s_nop 1
    v_mfma_f32_16x16x32_bf16 v[48:51], v[24:27], v[56:59], 0
    v_mfma_f32_16x16x32_bf16 v[52:55], v[34:37], v[56:59], 0
    s_nop 7
    v_cvt_pk_bf16_f32 v64, v48, v49
    v_cvt_pk_bf16_f32 v65, v50, v51
    v_cvt_pk_bf16_f32 v66, v52, v53
    v_cvt_pk_bf16_f32 v67, v54, v55
    s_nop 1
    v_permlane16_swap_b32 v64, v66
    v_permlane16_swap_b32 v65, v67
    buffer_store_dwordx4 v[64:67], v5, s[68:71], s38 offen offset:0 sc1
    v_cvt_pk_bf16_f32 v92, v92, v93
    v_cvt_pk_bf16_f32 v93, v94, v95
    v_cvt_pk_bf16_f32 v94, v108, v109
    v_cvt_pk_bf16_f32 v95, v110, v111
    v_cvt_pk_bf16_f32 v28, v124, v125
    v_cvt_pk_bf16_f32 v29, v126, v127
    v_cvt_pk_bf16_f32 v38, v140, v141
    v_cvt_pk_bf16_f32 v39, v142, v143
    v_cvt_pk_bf16_f32 v156, v156, v157
    v_cvt_pk_bf16_f32 v157, v158, v159
    v_cvt_pk_bf16_f32 v158, v172, v173
    v_cvt_pk_bf16_f32 v159, v174, v175
    s_nop 1
    v_mfma_f32_16x16x32_bf16 v[48:51], v[88:91], v[156:159], 0
    v_mfma_f32_16x16x32_bf16 v[52:55], v[92:95], v[156:159], 0
    s_nop 7
    v_cvt_pk_bf16_f32 v56, v48, v49
    s_barrier
    v_cvt_pk_bf16_f32 v57, v50, v51
    v_lshlrev_b32 v48, 16, v56
    v_and_b32 v49, 0xffff0000, v56
    v_lshlrev_b32 v50, 16, v57
    v_and_b32 v51, 0xffff0000, v57
    v_cvt_pk_bf16_f32 v56, v52, v53
    v_cvt_pk_bf16_f32 v57, v54, v55
    v_lshlrev_b32 v52, 16, v56
    v_and_b32 v53, 0xffff0000, v56
    v_lshlrev_b32 v54, 16, v57
    v_and_b32 v55, 0xffff0000, v57
    v_mul_f32 v48, s57, v48
    v_mul_f32 v49, s57, v49
    v_mul_f32 v50, s57, v50
    v_mul_f32 v51, s57, v51
    v_mul_f32 v52, s57, v52
    v_mul_f32 v53, s57, v53
    v_mul_f32 v54, s57, v54
    v_mul_f32 v55, s57, v55
    v_cvt_pk_bf16_f32 v56, v48, v49
    v_cvt_pk_bf16_f32 v57, v50, v51
    v_lshlrev_b32 v48, 16, v56
    v_and_b32 v49, 0xffff0000, v56
    v_lshlrev_b32 v50, 16, v57
    v_and_b32 v51, 0xffff0000, v57
    v_cvt_pk_bf16_f32 v56, v52, v53
    v_cvt_pk_bf16_f32 v57, v54, v55
    v_lshlrev_b32 v52, 16, v56
    v_and_b32 v53, 0xffff0000, v56
    v_lshlrev_b32 v54, 16, v57
    v_and_b32 v55, 0xffff0000, v57
    v_cndmask_b32 v48, v72, v48, s[40:41]
    v_cndmask_b32 v49, v72, v49, s[42:43]
    v_cndmask_b32 v50, v72, v50, s[44:45]
    v_cndmask_b32 v51, v72, v51, s[46:47]
    v_cndmask_b32 v52, v72, v52, s[48:49]
    v_cndmask_b32 v53, v72, v53, s[50:51]
    v_cndmask_b32 v54, v72, v54, s[52:53]
    v_cndmask_b32 v55, v72, v55, s[54:55]
    v_max3_f32 v60, v48, v49, v50
    v_max3_f32 v60, v60, v51, v52
    v_max3_f32 v60, v60, v53, v54
    v_max_f32 v60, v60, v55
    v_mov_b32 v61, v60
    s_nop 1
    v_permlane16_swap_b32 v60, v61
    v_max_f32 v60, v60, v61
    v_mov_b32 v61, v60
    s_nop 1
    v_permlane32_swap_b32 v60, v61
    v_max_f32 v60, v60, v61
    v_sub_f32 v48, v48, v60
    v_sub_f32 v49, v49, v60
    v_sub_f32 v50, v50, v60
    v_sub_f32 v51, v51, v60
    v_sub_f32 v52, v52, v60
    v_sub_f32 v53, v53, v60
    v_sub_f32 v54, v54, v60
    v_sub_f32 v55, v55, v60
    v_mul_f32 v48, s58, v48
    v_mul_f32 v49, s58, v49
    v_mul_f32 v50, s58, v50
    v_mul_f32 v51, s58, v51
    v_mul_f32 v52, s58, v52
    v_mul_f32 v53, s58, v53
    v_mul_f32 v54, s58, v54
    v_mul_f32 v55, s58, v55
    v_exp_f32 v48, v48
    v_exp_f32 v49, v49
    v_exp_f32 v50, v50
    v_exp_f32 v51, v51
    v_exp_f32 v52, v52
    v_exp_f32 v53, v53
    v_exp_f32 v54, v54
    s_barrier
    v_exp_f32 v55, v55
    s_nop 0
    v_add_f32 v60, v48, v49
    v_add_f32 v60, v60, v50
    v_add_f32 v60, v60, v51
    v_add_f32 v60, v60, v52
    v_add_f32 v60, v60, v53
    v_add_f32 v60, v60, v54
    v_add_f32 v60, v60, v55
    v_mov_b32 v61, v60
    s_nop 1
    v_permlane16_swap_b32 v60, v61
    v_add_f32 v60, v60, v61
    v_mov_b32 v61, v60
    s_nop 1
    v_permlane32_swap_b32 v60, v61
    v_add_f32 v60, v60, v61
    v_rcp_f32 v60, v60
    s_nop 0
    v_mul_f32 v48, v48, v60
    v_mul_f32 v49, v49, v60
    v_mul_f32 v50, v50, v60
    v_mul_f32 v51, v51, v60
    v_mul_f32 v52, v52, v60
    v_mul_f32 v53, v53, v60
    v_mul_f32 v54, v54, v60
    v_mul_f32 v55, v55, v60
    v_cvt_pk_bf16_f32 v56, v48, v49
    v_cvt_pk_bf16_f32 v57, v50, v51
    v_cvt_pk_bf16_f32 v58, v52, v53
    v_cvt_pk_bf16_f32 v59, v54, v55
    s_nop 1
    v_mfma_f32_16x16x32_bf16 v[48:51], v[26:29], v[56:59], 0
    v_mfma_f32_16x16x32_bf16 v[52:55], v[36:39], v[56:59], 0
    s_nop 7
    v_cvt_pk_bf16_f32 v68, v48, v49
    v_cvt_pk_bf16_f32 v69, v50, v51
    v_cvt_pk_bf16_f32 v70, v52, v53
    v_cvt_pk_bf16_f32 v71, v54, v55
    s_nop 1
    v_permlane16_swap_b32 v68, v70
    v_permlane16_swap_b32 v69, v71
    buffer_store_dwordx4 v[68:71], v5, s[68:71], s38 offen offset:1024 sc1
    v_cvt_pk_bf16_f32 v96, v96, v97
    v_cvt_pk_bf16_f32 v97, v98, v99
    v_cvt_pk_bf16_f32 v98, v112, v113
    v_cvt_pk_bf16_f32 v99, v114, v115
    v_cvt_pk_bf16_f32 v30, v128, v129
    v_cvt_pk_bf16_f32 v31, v130, v131
    v_cvt_pk_bf16_f32 v40, v144, v145
    v_cvt_pk_bf16_f32 v41, v146, v147
    v_cvt_pk_bf16_f32 v160, v160, v161
    v_cvt_pk_bf16_f32 v161, v162, v163
    v_cvt_pk_bf16_f32 v162, v176, v177
    v_cvt_pk_bf16_f32 v163, v178, v179
    s_nop 1
    v_mfma_f32_16x16x32_bf16 v[48:51], v[92:95], v[160:163], 0
    v_mfma_f32_16x16x32_bf16 v[52:55], v[96:99], v[160:163], 0
    s_nop 7
    v_cvt_pk_bf16_f32 v56, v48, v49
    v_cvt_pk_bf16_f32 v57, v50, v51
    v_lshlrev_b32 v48, 16, v56
    v_and_b32 v49, 0xffff0000, v56
    v_lshlrev_b32 v50, 16, v57
    v_and_b32 v51, 0xffff0000, v57
    v_cvt_pk_bf16_f32 v56, v52, v53
    v_cvt_pk_bf16_f32 v57, v54, v55
    v_lshlrev_b32 v52, 16, v56
    s_barrier
    v_and_b32 v53, 0xffff0000, v56
    v_lshlrev_b32 v54, 16, v57
    v_and_b32 v55, 0xffff0000, v57
    v_mul_f32 v48, s57, v48
    v_mul_f32 v49, s57, v49
    v_mul_f32 v50, s57, v50
    v_mul_f32 v51, s57, v51
    v_mul_f32 v52, s57, v52
    v_mul_f32 v53, s57, v53
    v_mul_f32 v54, s57, v54
    v_mul_f32 v55, s57, v55
    v_cvt_pk_bf16_f32 v56, v48, v49
    v_cvt_pk_bf16_f32 v57, v50, v51
    v_lshlrev_b32 v48, 16, v56
    v_and_b32 v49, 0xffff0000, v56
    v_lshlrev_b32 v50, 16, v57
    v_and_b32 v51, 0xffff0000, v57
    v_cvt_pk_bf16_f32 v56, v52, v53
    v_cvt_pk_bf16_f32 v57, v54, v55
    v_lshlrev_b32 v52, 16, v56
    v_and_b32 v53, 0xffff0000, v56
    v_lshlrev_b32 v54, 16, v57
    v_and_b32 v55, 0xffff0000, v57
    v_cndmask_b32 v48, v72, v48, s[40:41]
    v_cndmask_b32 v49, v72, v49, s[42:43]
    v_cndmask_b32 v50, v72, v50, s[44:45]
    v_cndmask_b32 v51, v72, v51, s[46:47]
    v_cndmask_b32 v52, v72, v52, s[48:49]
    v_cndmask_b32 v53, v72, v53, s[50:51]
    v_cndmask_b32 v54, v72, v54, s[52:53]
    v_cndmask_b32 v55, v72, v55, s[54:55]
    v_max3_f32 v60, v48, v49, v50
    v_max3_f32 v60, v60, v51, v52
    v_max3_f32 v60, v60, v53, v54
    v_max_f32 v60, v60, v55
    v_mov_b32 v61, v60
    s_nop 1
    v_permlane16_swap_b32 v60, v61
    v_max_f32 v60, v60, v61
    v_mov_b32 v61, v60
    s_nop 1
    v_permlane32_swap_b32 v60, v61
    v_max_f32 v60, v60, v61
    v_sub_f32 v48, v48, v60
    v_sub_f32 v49, v49, v60
    v_sub_f32 v50, v50, v60
    v_sub_f32 v51, v51, v60
    v_sub_f32 v52, v52, v60
    v_sub_f32 v53, v53, v60
    v_sub_f32 v54, v54, v60
    v_sub_f32 v55, v55, v60
    v_mul_f32 v48, s58, v48
    v_mul_f32 v49, s58, v49
    v_mul_f32 v50, s58, v50
    v_mul_f32 v51, s58, v51
    v_mul_f32 v52, s58, v52
    v_mul_f32 v53, s58, v53
    v_mul_f32 v54, s58, v54
    v_mul_f32 v55, s58, v55
    v_exp_f32 v48, v48
    v_exp_f32 v49, v49
    v_exp_f32 v50, v50
    v_exp_f32 v51, v51
    v_exp_f32 v52, v52
    v_exp_f32 v53, v53
    v_exp_f32 v54, v54
    v_exp_f32 v55, v55
    s_nop 0
    v_add_f32 v60, v48, v49
    v_add_f32 v60, v60, v50
    v_add_f32 v60, v60, v51
    v_add_f32 v60, v60, v52
    v_add_f32 v60, v60, v53
    v_add_f32 v60, v60, v54
    s_waitcnt vmcnt(2)
    s_barrier
    s_cmp_lg_u32 s4, 0
    s_cbranch_scc1 L_fH2
    s_lshl_b32 s84, s28, 4
    s_add_u32 s84, s84, s29
    s_lshl_b32 s84, s84, 7
    s_add_u32 s84, s84, 0x1e90000
    v_mov_b32 v16, s84
    v_mov_b32 v18, s100
    v_mov_b32 v19, s101
    s_mov_b64 exec, 1
    global_store_dwordx2 v16, v[18:19], s[26:27] sc1
    s_mov_b64 exec, -1
L_fH2:
    v_add_f32 v60, v60, v55
    v_mov_b32 v61, v60
    s_nop 1
    v_permlane16_swap_b32 v60, v61
    v_add_f32 v60, v60, v61
    v_mov_b32 v61, v60
    s_nop 1
    v_permlane32_swap_b32 v60, v61
    v_add_f32 v60, v60, v61
    v_rcp_f32 v60, v60
    s_nop 0
    v_mul_f32 v48, v48, v60
    v_mul_f32 v49, v49, v60
    v_mul_f32 v50, v50, v60
    v_mul_f32 v51, v51, v60
    v_mul_f32 v52, v52, v60
    v_mul_f32 v53, v53, v60
    v_mul_f32 v54, v54, v60
    v_mul_f32 v55, v55, v60
    v_cvt_pk_bf16_f32 v56, v48, v49
    v_cvt_pk_bf16_f32 v57, v50, v51
    v_cvt_pk_bf16_f32 v58, v52, v53
    v_cvt_pk_bf16_f32 v59, v54, v55
    s_nop 1
    v_mfma_f32_16x16x32_bf16 v[48:51], v[28:31], v[56:59], 0
    v_mfma_f32_16x16x32_bf16 v[52:55], v[38:41], v[56:59], 0
    s_nop 7
    v_cvt_pk_bf16_f32 v64, v48, v49
    v_cvt_pk_bf16_f32 v65, v50, v51
    v_cvt_pk_bf16_f32 v66, v52, v53
    v_cvt_pk_bf16_f32 v67, v54, v55
    s_nop 1
    v_permlane16_swap_b32 v64, v66
    v_permlane16_swap_b32 v65, v67
    buffer_store_dwordx4 v[64:67], v5, s[68:71], s38 offen offset:2048 sc1
    v_cvt_pk_bf16_f32 v164, v164, v165
    v_cvt_pk_bf16_f32 v165, v166, v167
    v_cvt_pk_bf16_f32 v166, v180, v181
    v_cvt_pk_bf16_f32 v167, v182, v183
    s_nop 1
    v_mfma_f32_16x16x32_bf16 v[48:51], v[96:99], v[164:167], 0
    v_mfma_f32_16x16x32_bf16 v[52:55], v[100:103], v[164:167], 0
    s_nop 7
    v_cvt_pk_bf16_f32 v56, v48, v49
    v_cvt_pk_bf16_f32 v57, v50, v51
    v_lshlrev_b32 v48, 16, v56
    v_and_b32 v49, 0xffff0000, v56
    v_lshlrev_b32 v50, 16, v57
    v_and_b32 v51, 0xffff0000, v57
    v_cvt_pk_bf16_f32 v56, v52, v53
    v_cvt_pk_bf16_f32 v57, v54, v55
    v_lshlrev_b32 v52, 16, v56
    v_and_b32 v53, 0xffff0000, v56
    v_lshlrev_b32 v54, 16, v57
    v_and_b32 v55, 0xffff0000, v57
    v_mul_f32 v48, s57, v48
    v_mul_f32 v49, s57, v49
    v_mul_f32 v50, s57, v50
    v_mul_f32 v51, s57, v51
    v_mul_f32 v52, s57, v52
    v_mul_f32 v53, s57, v53
    v_mul_f32 v54, s57, v54
    v_mul_f32 v55, s57, v55
    v_cvt_pk_bf16_f32 v56, v48, v49
    v_cvt_pk_bf16_f32 v57, v50, v51
    v_lshlrev_b32 v48, 16, v56
    v_and_b32 v49, 0xffff0000, v56
    v_lshlrev_b32 v50, 16, v57
    s_barrier
    v_and_b32 v51, 0xffff0000, v57
    v_cvt_pk_bf16_f32 v56, v52, v53
    v_cvt_pk_bf16_f32 v57, v54, v55
    v_lshlrev_b32 v52, 16, v56
    v_and_b32 v53, 0xffff0000, v56
    v_lshlrev_b32 v54, 16, v57
    v_and_b32 v55, 0xffff0000, v57
    v_cndmask_b32 v48, v72, v48, s[40:41]
    v_cndmask_b32 v49, v72, v49, s[42:43]
    v_cndmask_b32 v50, v72, v50, s[44:45]
    v_cndmask_b32 v51, v72, v51, s[46:47]
    v_cndmask_b32 v52, v72, v52, s[48:49]
    v_cndmask_b32 v53, v72, v53, s[50:51]
    v_cndmask_b32 v54, v72, v54, s[52:53]
    v_cndmask_b32 v55, v72, v55, s[54:55]
    v_max3_f32 v60, v48, v49, v50
    v_max3_f32 v60, v60, v51, v52
    v_max3_f32 v60, v60, v53, v54
    v_max_f32 v60, v60, v55
    v_mov_b32 v61, v60
    s_nop 1
    v_permlane16_swap_b32 v60, v61
    v_max_f32 v60, v60, v61
    v_mov_b32 v61, v60
    s_nop 1
    v_permlane32_swap_b32 v60, v61
    v_max_f32 v60, v60, v61
    v_sub_f32 v48, v48, v60
    v_sub_f32 v49, v49, v60
    v_sub_f32 v50, v50, v60
    v_sub_f32 v51, v51, v60
    v_sub_f32 v52, v52, v60
    v_sub_f32 v53, v53, v60
    v_sub_f32 v54, v54, v60
    v_sub_f32 v55, v55, v60
    v_mul_f32 v48, s58, v48
    v_mul_f32 v49, s58, v49
    v_mul_f32 v50, s58, v50
    v_mul_f32 v51, s58, v51
    v_mul_f32 v52, s58, v52
    v_mul_f32 v53, s58, v53
    v_mul_f32 v54, s58, v54
    v_mul_f32 v55, s58, v55
    v_exp_f32 v48, v48
    v_exp_f32 v49, v49
    v_exp_f32 v50, v50
    v_exp_f32 v51, v51
    v_exp_f32 v52, v52
    v_exp_f32 v53, v53
    v_exp_f32 v54, v54
    v_exp_f32 v55, v55
    s_nop 0
    v_add_f32 v60, v48, v49
    v_add_f32 v60, v60, v50
    v_add_f32 v60, v60, v51
    v_add_f32 v60, v60, v52
    v_add_f32 v60, v60, v53
    v_add_f32 v60, v60, v54
    v_add_f32 v60, v60, v55
    v_mov_b32 v61, v60
    s_nop 1
    v_permlane16_swap_b32 v60, v61
    v_add_f32 v60, v60, v61
    v_mov_b32 v61, v60
    s_nop 1
    v_permlane32_swap_b32 v60, v61
    v_add_f32 v60, v60, v61
    v_rcp_f32 v60, v60
    s_nop 0
    v_mul_f32 v48, v48, v60
    v_mul_f32 v49, v49, v60
    v_mul_f32 v50, v50, v60
    v_mul_f32 v51, v51, v60
    v_mul_f32 v52, v52, v60
    s_barrier
    v_mul_f32 v53, v53, v60
    v_mul_f32 v54, v54, v60
    v_mul_f32 v55, v55, v60
    v_cvt_pk_bf16_f32 v56, v48, v49
    v_cvt_pk_bf16_f32 v57, v50, v51
    v_cvt_pk_bf16_f32 v58, v52, v53
    v_cvt_pk_bf16_f32 v59, v54, v55
    s_nop 1
    v_mfma_f32_16x16x32_bf16 v[48:51], v[30:33], v[56:59], 0
    v_mfma_f32_16x16x32_bf16 v[52:55], v[40:43], v[56:59], 0
    s_nop 7
    v_cvt_pk_bf16_f32 v68, v48, v49
    v_cvt_pk_bf16_f32 v69, v50, v51
    v_cvt_pk_bf16_f32 v70, v52, v53
    v_cvt_pk_bf16_f32 v71, v54, v55
    s_nop 1
    v_permlane16_swap_b32 v68, v70
    v_permlane16_swap_b32 v69, v71
    buffer_store_dwordx4 v[68:71], v5, s[68:71], s38 offen offset:3072 sc1
    s_barrier
    s_barrier
    v_and_b32 v20, 15, v1
    s_lshl_b32 s84, s30, 11
    s_add_u32 s84, s84, 0x1e90000
    v_lshl_add_u32 v20, v20, 7, s84
    global_load_dwordx2 v[22:23], v20, s[26:27] sc1
    s_barrier
    s_barrier
    s_waitcnt vmcnt(0)
    s_movk_i32 s98, 0x4000
L_pH2_chk:
    v_cmp_ne_u64 vcc, s[100:101], v[22:23]
    s_nop 1
    s_cmp_eq_u64 vcc, 0
    s_cbranch_scc1 L_pH2_ok
    s_sub_u32 s98, s98, 1
    s_cbranch_scc1 L_pH2_ok
    s_sleep 1
    global_load_dwordx2 v[22:23], v20, s[26:27] sc1
    s_waitcnt vmcnt(0)
    s_branch L_pH2_chk
L_pH2_ok:
    s_barrier
    s_barrier
    s_waitcnt vmcnt(1)
    s_barrier
    s_cmp_lg_u32 s4, 0
    s_cbranch_scc1 L_fO
    s_lshl_b32 s84, s28, 4
    s_add_u32 s84, s84, s29
    s_lshl_b32 s84, s84, 7
    s_add_u32 s84, s84, 0x1e98000
    v_mov_b32 v16, s84
    v_mov_b32 v18, s100
    v_mov_b32 v19, s101
    s_mov_b64 exec, 1
    global_store_dwordx2 v16, v[18:19], s[26:27] sc1
    s_mov_b64 exec, -1
L_fO:
    s_barrier
    s_barrier
    s_barrier
    v_and_b32 v20, 15, v1
    s_lshl_b32 s84, s30, 11
    s_add_u32 s84, s84, 0x1e98000
    v_lshl_add_u32 v20, v20, 7, s84
    global_load_dwordx2 v[22:23], v20, s[26:27] sc1
    s_barrier
    v_lshrrev_b32 v64, 4, v1
    v_bfe_u32 v65, v1, 2, 2
    v_and_b32 v66, 3, v1
    v_and_b32 v67, 15, v1
    v_lshrrev_b32 v68, 3, v1
    v_and_b32 v69, 7, v1
    s_lshl_b32 s85, s6, 2
    v_lshl_add_u32 v70, v64, 3, v65
    v_lshlrev_b32 v70, 7, v70
    v_and_b32 v71, 1, v66
    v_lshl_add_u32 v70, v71, 3, v70
    v_add_u32 v70, 0, v70
    v_and_b32 v71, 2, v65
    v_and_b32 v72, 1, v64
    v_lshl_add_u32 v71, v72, 2, v71
    v_lshrrev_b32 v72, 1, v66
    v_xor_b32 v71, v71, v72
    v_xor_b32 v71, s85, v71
    v_xor_b32 v72, 0, v71
    v_lshl_add_u32 v6, v72, 4, v70
    v_add_u32 v8, 65536, v6
    v_xor_b32 v72, 2, v71
    v_lshl_add_u32 v7, v72, 4, v70
    v_add_u32 v9, 65536, v7
    s_lshl_b32 s85, s5, 12
    v_lshl_add_u32 v4, v1, 4, s85
    v_add_u32 v5, 65536, v4
    s_lshl_b32 s85, s4, 12
    v_lshl_add_u32 v10, v1, 4, s85
    s_lshl_b32 s85, s4, 4
    v_and_b32 v70, 2, v68
    v_xor_b32 v70, v70, v69
    v_xor_b32 v70, 0, v70
    v_add_u32 v71, s85, v68
    v_mul_u32_u24 v71, 2048, v71
    v_lshl_add_u32 v11, v70, 4, v71
    s_add_u32 s85, s85, 8
    v_and_b32 v70, 2, v68
    v_xor_b32 v70, v70, v69
    v_xor_b32 v70, 4, v70
    v_add_u32 v71, s85, v68
    v_mul_u32_u24 v71, 2048, v71
    v_lshl_add_u32 v12, v70, 4, v71
    s_lshl_b32 s85, s31, 8
    s_lshl_b32 s86, s32, 7
    s_add_u32 s86, s85, s86
    s_xor_b32 s87, s86, 128
    s_add_u32 s60, s12, s86
    s_addc_u32 s61, s13, 0
    s_sub_u32 s62, 2097152, s86
    s_mov_b32 s63, 0x20000
    s_add_u32 s56, s26, 0x1200000
    s_addc_u32 s57, s27, 0
    s_mov_b32 s58, 0x400000
    s_mov_b32 s59, 0x20000
    s_lshl_b32 s82, s30, 18
    s_mov_b32 s83, 0
    v_mov_b32 v88, 0
    v_mov_b32 v89, 0
    v_mov_b32 v90, 0
    v_mov_b32 v91, 0
    v_mov_b32 v92, 0
    v_mov_b32 v93, 0
    v_mov_b32 v94, 0
    v_mov_b32 v95, 0
    v_mov_b32 v96, 0
    v_mov_b32 v97, 0
    v_mov_b32 v98, 0
    v_mov_b32 v99, 0
    v_mov_b32 v100, 0
    v_mov_b32 v101, 0
    v_mov_b32 v102, 0
    v_mov_b32 v103, 0
    v_mov_b32 v104, 0
    v_mov_b32 v105, 0
    v_mov_b32 v106, 0
    v_mov_b32 v107, 0
    v_mov_b32 v108, 0
    v_mov_b32 v109, 0
    v_mov_b32 v110, 0
    v_mov_b32 v111, 0
    v_mov_b32 v112, 0
    v_mov_b32 v113, 0
    v_mov_b32 v114, 0
    v_mov_b32 v115, 0
    v_mov_b32 v116, 0
    v_mov_b32 v117, 0
    v_mov_b32 v118, 0
    v_mov_b32 v119, 0
    s_lshl_b32 s84, s30, 7
    s_lshl_b32 s85, s5, 6
    s_add_u32 s84, s84, s85
    s_lshl_b32 s84, s84, 11
    s_lshl_b32 s85, s31, 8
    s_add_u32 s84, s84, s85
    s_lshl_b32 s85, s32, 7
    s_add_u32 s84, s84, s85
    s_lshl_b32 s85, s6, 6
    s_add_u32 s84, s84, s85
    v_and_b32 v70, 1, v64
    v_lshlrev_b32 v70, 5, v70
    v_lshrrev_b32 v71, 1, v64
    v_lshl_add_u32 v70, v71, 4, v70
    v_lshl_add_u32 v70, v67, 11, v70
    v_add_u32 v13, s84, v70
    s_mov_b32 s72, s8
    s_mov_b32 s73, s9
    s_mov_b32 s74, 0x400000
    s_mov_b32 s75, 0x20000
    s_mov_b32 s84, 0
    buffer_load_dwordx4 v[120:123], v13, s[72:75], s84 offen
    s_mov_b32 s84, 32768
    buffer_load_dwordx4 v[124:127], v13, s[72:75], s84 offen
    s_mov_b32 s84, 65536
    buffer_load_dwordx4 v[128:131], v13, s[72:75], s84 offen
    s_mov_b32 s84, 98304
    buffer_load_dwordx4 v[132:135], v13, s[72:75], s84 offen
    s_barrier
    s_waitcnt vmcnt(4)
    s_movk_i32 s98, 0x4000
L_pO_chk:
    v_cmp_ne_u64 vcc, s[100:101], v[22:23]
    s_nop 1
    s_cmp_eq_u64 vcc, 0
    s_cbranch_scc1 L_pO_ok
    s_sub_u32 s98, s98, 1
    s_cbranch_scc1 L_pO_ok
    s_sleep 1
    global_load_dwordx2 v[22:23], v20, s[26:27] sc1
    s_waitcnt vmcnt(0)
    s_branch L_pO_chk
L_pO_ok:
    s_barrier
    s_lshl_b32 m0, s33, 2
    s_nop 0
    buffer_load_dwordx4 v10, s[56:59], s82 offen offset:0 sc1 lds
    s_nop 0
    buffer_load_dwordx4 v10, s[56:59], s82 offen offset:1024 sc1 lds
    s_nop 0
    buffer_load_dwordx4 v10, s[56:59], s82 offen offset:2048 sc1 lds
    s_nop 0
    buffer_load_dwordx4 v10, s[56:59], s82 offen offset:3072 sc1 lds
    s_add_u32 s82, s82, 16384
    s_lshl1_add_u32 m0, s33, 16384
    s_nop 0
    buffer_load_dwordx4 v11, s[60:63], s83 offen lds
    s_lshl1_add_u32 m0, s33, 17408
    s_nop 0
    buffer_load_dwordx4 v12, s[60:63], s83 offen lds
    s_add_u32 s83, s83, 131072
    s_barrier
    s_lshl2_add_u32 m0, s33, 98304
    s_nop 0
    buffer_load_dwordx4 v10, s[56:59], s82 offen offset:0 sc1 lds
    s_nop 0
    buffer_load_dwordx4 v10, s[56:59], s82 offen offset:1024 sc1 lds
    s_nop 0
    buffer_load_dwordx4 v10, s[56:59], s82 offen offset:2048 sc1 lds
    s_nop 0
    buffer_load_dwordx4 v10, s[56:59], s82 offen offset:3072 sc1 lds
    s_add_u32 s82, s82, 16384
    s_lshl1_add_u32 m0, s33, 114688
    s_nop 0
    buffer_load_dwordx4 v11, s[60:63], s83 offen lds
    s_lshl1_add_u32 m0, s33, 115712
    s_nop 0
    buffer_load_dwordx4 v12, s[60:63], s83 offen lds
    s_add_u32 s83, s83, 131072
    s_barrier
    s_lshl2_add_u32 m0, s33, 32768
    s_nop 0
    buffer_load_dwordx4 v10, s[56:59], s82 offen offset:0 sc1 lds
    s_nop 0
    buffer_load_dwordx4 v10, s[56:59], s82 offen offset:1024 sc1 lds
    s_nop 0
    buffer_load_dwordx4 v10, s[56:59], s82 offen offset:2048 sc1 lds
    s_nop 0
    buffer_load_dwordx4 v10, s[56:59], s82 offen offset:3072 sc1 lds
    s_add_u32 s82, s82, 16384
    s_lshl1_add_u32 m0, s33, 49152
    s_nop 0
    buffer_load_dwordx4 v11, s[60:63], s83 offen lds
    s_lshl1_add_u32 m0, s33, 50176
    s_nop 0
    buffer_load_dwordx4 v12, s[60:63], s83 offen lds
    s_add_u32 s83, s83, 131072
    s_waitcnt vmcnt(12)
    s_barrier
    s_setprio 1
    s_lshl2_add_u32 m0, s33, 65536
    s_nop 0
    buffer_load_dwordx4 v10, s[56:59], s82 offen offset:0 sc1 lds
    s_nop 0
    buffer_load_dwordx4 v10, s[56:59], s82 offen offset:1024 sc1 lds
    s_nop 0
    buffer_load_dwordx4 v10, s[56:59], s82 offen offset:2048 sc1 lds
    ds_read_b64_tr_b16 v[40:41], v6 offset:16384
    ds_read_b64_tr_b16 v[42:43], v6 offset:16896
    ds_read_b128 v[24:27], v4 offset:0
    ds_read_b128 v[28:31], v4 offset:1024
    ds_read_b128 v[32:35], v4 offset:2048
    ds_read_b128 v[36:39], v4 offset:3072
    ds_read_b64_tr_b16 v[44:45], v7 offset:16384
    ds_read_b64_tr_b16 v[46:47], v7 offset:16896
    s_mov_b32 s34, 3
.p2align 6
L_s:
    s_waitcnt lgkmcnt(5)
    v_mfma_f32_16x16x32_bf16 v[88:91], v[40:43], v[24:27], v[88:91]
    ds_read_b64_tr_b16 v[72:73], v6 offset:20480
    ds_read_b64_tr_b16 v[74:75], v6 offset:20992
    s_waitcnt lgkmcnt(6)
    v_mfma_f32_16x16x32_bf16 v[92:95], v[40:43], v[28:31], v[92:95]
    ds_read_b128 v[56:59], v4 offset:8192
    ds_read_b128 v[60:63], v4 offset:9216
    buffer_load_dwordx4 v10, s[56:59], s82 offen offset:3072 sc1 lds
    s_add_u32 s82, s82, 16384
    s_waitcnt lgkmcnt(7)
    v_mfma_f32_16x16x32_bf16 v[96:99], v[40:43], v[32:35], v[96:99]
    ds_read_b128 v[64:67], v4 offset:10240
    ds_read_b128 v[68:71], v4 offset:11264
    s_lshl1_add_u32 m0, s33, 81920
    s_waitcnt lgkmcnt(8)
    v_mfma_f32_16x16x32_bf16 v[100:103], v[40:43], v[36:39], v[100:103]
    ds_read_b64_tr_b16 v[76:77], v7 offset:20480
    ds_read_b64_tr_b16 v[78:79], v7 offset:20992
    buffer_load_dwordx4 v11, s[60:63], s83 offen lds
    s_waitcnt lgkmcnt(8)
    v_mfma_f32_16x16x32_bf16 v[104:107], v[44:47], v[24:27], v[104:107]
    v_mfma_f32_16x16x32_bf16 v[108:111], v[44:47], v[28:31], v[108:111]
    s_lshl1_add_u32 m0, s33, 82944
    v_mfma_f32_16x16x32_bf16 v[112:115], v[44:47], v[32:35], v[112:115]
    buffer_load_dwordx4 v12, s[60:63], s83 offen lds
    s_add_u32 s83, s83, s35
    v_mfma_f32_16x16x32_bf16 v[116:119], v[44:47], v[36:39], v[116:119]
    s_waitcnt vmcnt(12) lgkmcnt(0)
    s_barrier
    v_mfma_f32_16x16x32_bf16 v[88:91], v[72:75], v[56:59], v[88:91]
    ds_read_b64_tr_b16 v[40:41], v8 offset:49152
    ds_read_b64_tr_b16 v[42:43], v8 offset:49664
    s_lshl_b32 m0, s33, 2
    v_mfma_f32_16x16x32_bf16 v[92:95], v[72:75], v[60:63], v[92:95]
    ds_read_b128 v[24:27], v5 offset:32768
    ds_read_b128 v[28:31], v5 offset:33792
    buffer_load_dwordx4 v10, s[56:59], s82 offen offset:0 sc1 lds
    v_mfma_f32_16x16x32_bf16 v[96:99], v[72:75], v[64:67], v[96:99]
    ds_read_b128 v[32:35], v5 offset:34816
    v_mfma_f32_16x16x32_bf16 v[100:103], v[72:75], v[68:71], v[100:103]
    ds_read_b128 v[36:39], v5 offset:35840
    ds_read_b64_tr_b16 v[44:45], v9 offset:49152
    buffer_load_dwordx4 v10, s[56:59], s82 offen offset:1024 sc1 lds
    v_mfma_f32_16x16x32_bf16 v[104:107], v[76:79], v[56:59], v[104:107]
    ds_read_b64_tr_b16 v[46:47], v9 offset:49664
    v_mfma_f32_16x16x32_bf16 v[108:111], v[76:79], v[60:63], v[108:111]
    v_mfma_f32_16x16x32_bf16 v[112:115], v[76:79], v[64:67], v[112:115]
    buffer_load_dwordx4 v10, s[56:59], s82 offen offset:2048 sc1 lds
    v_mfma_f32_16x16x32_bf16 v[116:119], v[76:79], v[68:71], v[116:119]
    s_waitcnt lgkmcnt(5)
    v_mfma_f32_16x16x32_bf16 v[88:91], v[40:43], v[24:27], v[88:91]
    ds_read_b64_tr_b16 v[72:73], v8 offset:53248
    ds_read_b64_tr_b16 v[74:75], v8 offset:53760
    s_waitcnt lgkmcnt(6)
    v_mfma_f32_16x16x32_bf16 v[92:95], v[40:43], v[28:31], v[92:95]
    ds_read_b128 v[56:59], v5 offset:40960
    ds_read_b128 v[60:63], v5 offset:41984
    buffer_load_dwordx4 v10, s[56:59], s82 offen offset:3072 sc1 lds
    s_add_u32 s82, s82, 16384
    s_waitcnt lgkmcnt(7)
    v_mfma_f32_16x16x32_bf16 v[96:99], v[40:43], v[32:35], v[96:99]
    ds_read_b128 v[64:67], v5 offset:43008
    ds_read_b128 v[68:71], v5 offset:44032
    s_lshl1_add_u32 m0, s33, 16384
    s_waitcnt lgkmcnt(8)
    v_mfma_f32_16x16x32_bf16 v[100:103], v[40:43], v[36:39], v[100:103]
    ds_read_b64_tr_b16 v[76:77], v9 offset:53248
    ds_read_b64_tr_b16 v[78:79], v9 offset:53760
    buffer_load_dwordx4 v11, s[60:63], s83 offen lds
    s_waitcnt lgkmcnt(8)
    v_mfma_f32_16x16x32_bf16 v[104:107], v[44:47], v[24:27], v[104:107]
    v_mfma_f32_16x16x32_bf16 v[108:111], v[44:47], v[28:31], v[108:111]
    s_lshl1_add_u32 m0, s33, 17408
    v_mfma_f32_16x16x32_bf16 v[112:115], v[44:47], v[32:35], v[112:115]
    buffer_load_dwordx4 v12, s[60:63], s83 offen lds
    s_add_u32 s83, s83, 131072
    v_mfma_f32_16x16x32_bf16 v[116:119], v[44:47], v[36:39], v[116:119]
    s_waitcnt vmcnt(12) lgkmcnt(0)
    s_barrier
    v_mfma_f32_16x16x32_bf16 v[88:91], v[72:75], v[56:59], v[88:91]
    ds_read_b64_tr_b16 v[40:41], v6 offset:49152
    ds_read_b64_tr_b16 v[42:43], v6 offset:49664
    s_lshl2_add_u32 m0, s33, 98304
    v_mfma_f32_16x16x32_bf16 v[92:95], v[72:75], v[60:63], v[92:95]
    ds_read_b128 v[24:27], v4 offset:32768
    ds_read_b128 v[28:31], v4 offset:33792
    buffer_load_dwordx4 v10, s[56:59], s82 offen offset:0 sc1 lds
    v_mfma_f32_16x16x32_bf16 v[96:99], v[72:75], v[64:67], v[96:99]
    ds_read_b128 v[32:35], v4 offset:34816
    v_mfma_f32_16x16x32_bf16 v[100:103], v[72:75], v[68:71], v[100:103]
    ds_read_b128 v[36:39], v4 offset:35840
    ds_read_b64_tr_b16 v[44:45], v7 offset:49152
    buffer_load_dwordx4 v10, s[56:59], s82 offen offset:1024 sc1 lds
    v_mfma_f32_16x16x32_bf16 v[104:107], v[76:79], v[56:59], v[104:107]
    ds_read_b64_tr_b16 v[46:47], v7 offset:49664
    v_mfma_f32_16x16x32_bf16 v[108:111], v[76:79], v[60:63], v[108:111]
    v_mfma_f32_16x16x32_bf16 v[112:115], v[76:79], v[64:67], v[112:115]
    buffer_load_dwordx4 v10, s[56:59], s82 offen offset:2048 sc1 lds
    v_mfma_f32_16x16x32_bf16 v[116:119], v[76:79], v[68:71], v[116:119]
    s_waitcnt lgkmcnt(5)
    v_mfma_f32_16x16x32_bf16 v[88:91], v[40:43], v[24:27], v[88:91]
    ds_read_b64_tr_b16 v[72:73], v6 offset:53248
    ds_read_b64_tr_b16 v[74:75], v6 offset:53760
    s_waitcnt lgkmcnt(6)
    v_mfma_f32_16x16x32_bf16 v[92:95], v[40:43], v[28:31], v[92:95]
    ds_read_b128 v[56:59], v4 offset:40960
    ds_read_b128 v[60:63], v4 offset:41984
    buffer_load_dwordx4 v10, s[56:59], s82 offen offset:3072 sc1 lds
    s_add_u32 s82, s82, 16384
    s_waitcnt lgkmcnt(7)
    v_mfma_f32_16x16x32_bf16 v[96:99], v[40:43], v[32:35], v[96:99]
    ds_read_b128 v[64:67], v4 offset:43008
    ds_read_b128 v[68:71], v4 offset:44032
    s_lshl1_add_u32 m0, s33, 114688
    s_waitcnt lgkmcnt(8)
    v_mfma_f32_16x16x32_bf16 v[100:103], v[40:43], v[36:39], v[100:103]
    ds_read_b64_tr_b16 v[76:77], v7 offset:53248
    ds_read_b64_tr_b16 v[78:79], v7 offset:53760
    buffer_load_dwordx4 v11, s[60:63], s83 offen lds
    s_waitcnt lgkmcnt(8)
    v_mfma_f32_16x16x32_bf16 v[104:107], v[44:47], v[24:27], v[104:107]
    v_mfma_f32_16x16x32_bf16 v[108:111], v[44:47], v[28:31], v[108:111]
    s_lshl1_add_u32 m0, s33, 115712
    v_mfma_f32_16x16x32_bf16 v[112:115], v[44:47], v[32:35], v[112:115]
    buffer_load_dwordx4 v12, s[60:63], s83 offen lds
    s_add_u32 s83, s83, 131072
    v_mfma_f32_16x16x32_bf16 v[116:119], v[44:47], v[36:39], v[116:119]
    s_waitcnt vmcnt(12) lgkmcnt(0)
    s_barrier
    v_mfma_f32_16x16x32_bf16 v[88:91], v[72:75], v[56:59], v[88:91]
    ds_read_b64_tr_b16 v[40:41], v8 offset:16384
    ds_read_b64_tr_b16 v[42:43], v8 offset:16896
    s_lshl2_add_u32 m0, s33, 32768
    v_mfma_f32_16x16x32_bf16 v[92:95], v[72:75], v[60:63], v[92:95]
    ds_read_b128 v[24:27], v5 offset:0
    ds_read_b128 v[28:31], v5 offset:1024
    buffer_load_dwordx4 v10, s[56:59], s82 offen offset:0 sc1 lds
    v_mfma_f32_16x16x32_bf16 v[96:99], v[72:75], v[64:67], v[96:99]
    ds_read_b128 v[32:35], v5 offset:2048
    v_mfma_f32_16x16x32_bf16 v[100:103], v[72:75], v[68:71], v[100:103]
    ds_read_b128 v[36:39], v5 offset:3072
    ds_read_b64_tr_b16 v[44:45], v9 offset:16384
    buffer_load_dwordx4 v10, s[56:59], s82 offen offset:1024 sc1 lds
    v_mfma_f32_16x16x32_bf16 v[104:107], v[76:79], v[56:59], v[104:107]
    ds_read_b64_tr_b16 v[46:47], v9 offset:16896
    v_mfma_f32_16x16x32_bf16 v[108:111], v[76:79], v[60:63], v[108:111]
    v_mfma_f32_16x16x32_bf16 v[112:115], v[76:79], v[64:67], v[112:115]
    buffer_load_dwordx4 v10, s[56:59], s82 offen offset:2048 sc1 lds
    v_mfma_f32_16x16x32_bf16 v[116:119], v[76:79], v[68:71], v[116:119]
    s_waitcnt lgkmcnt(5)
    v_mfma_f32_16x16x32_bf16 v[88:91], v[40:43], v[24:27], v[88:91]
    ds_read_b64_tr_b16 v[72:73], v8 offset:20480
    ds_read_b64_tr_b16 v[74:75], v8 offset:20992
    s_waitcnt lgkmcnt(6)
    v_mfma_f32_16x16x32_bf16 v[92:95], v[40:43], v[28:31], v[92:95]
    ds_read_b128 v[56:59], v5 offset:8192
    ds_read_b128 v[60:63], v5 offset:9216
    buffer_load_dwordx4 v10, s[56:59], s82 offen offset:3072 sc1 lds
    s_add_u32 s82, s82, 16384
    s_waitcnt lgkmcnt(7)
    v_mfma_f32_16x16x32_bf16 v[96:99], v[40:43], v[32:35], v[96:99]
    ds_read_b128 v[64:67], v5 offset:10240
    ds_read_b128 v[68:71], v5 offset:11264
    s_lshl1_add_u32 m0, s33, 49152
    s_waitcnt lgkmcnt(8)
    v_mfma_f32_16x16x32_bf16 v[100:103], v[40:43], v[36:39], v[100:103]
    ds_read_b64_tr_b16 v[76:77], v9 offset:20480
    ds_read_b64_tr_b16 v[78:79], v9 offset:20992
    buffer_load_dwordx4 v11, s[60:63], s83 offen lds
    s_waitcnt lgkmcnt(8)
    v_mfma_f32_16x16x32_bf16 v[104:107], v[44:47], v[24:27], v[104:107]
    v_mfma_f32_16x16x32_bf16 v[108:111], v[44:47], v[28:31], v[108:111]
    s_lshl1_add_u32 m0, s33, 50176
    v_mfma_f32_16x16x32_bf16 v[112:115], v[44:47], v[32:35], v[112:115]
    buffer_load_dwordx4 v12, s[60:63], s83 offen lds
    s_add_u32 s83, s83, 131072
    v_mfma_f32_16x16x32_bf16 v[116:119], v[44:47], v[36:39], v[116:119]
    s_waitcnt vmcnt(12) lgkmcnt(0)
    s_barrier
    v_mfma_f32_16x16x32_bf16 v[88:91], v[72:75], v[56:59], v[88:91]
    ds_read_b64_tr_b16 v[40:41], v6 offset:16384
    ds_read_b64_tr_b16 v[42:43], v6 offset:16896
    s_lshl2_add_u32 m0, s33, 65536
    v_mfma_f32_16x16x32_bf16 v[92:95], v[72:75], v[60:63], v[92:95]
    ds_read_b128 v[24:27], v4 offset:0
    ds_read_b128 v[28:31], v4 offset:1024
    buffer_load_dwordx4 v10, s[56:59], s82 offen offset:0 sc1 lds
    v_mfma_f32_16x16x32_bf16 v[96:99], v[72:75], v[64:67], v[96:99]
    ds_read_b128 v[32:35], v4 offset:2048
    v_mfma_f32_16x16x32_bf16 v[100:103], v[72:75], v[68:71], v[100:103]
    ds_read_b128 v[36:39], v4 offset:3072
    ds_read_b64_tr_b16 v[44:45], v7 offset:16384
    buffer_load_dwordx4 v10, s[56:59], s82 offen offset:1024 sc1 lds
    v_mfma_f32_16x16x32_bf16 v[104:107], v[76:79], v[56:59], v[104:107]
    ds_read_b64_tr_b16 v[46:47], v7 offset:16896
    v_mfma_f32_16x16x32_bf16 v[108:111], v[76:79], v[60:63], v[108:111]
    v_mfma_f32_16x16x32_bf16 v[112:115], v[76:79], v[64:67], v[112:115]
    buffer_load_dwordx4 v10, s[56:59], s82 offen offset:2048 sc1 lds
    v_mfma_f32_16x16x32_bf16 v[116:119], v[76:79], v[68:71], v[116:119]
    s_sub_u32 s34, s34, 1
    s_cmp_lg_u32 s34, 0
    s_cbranch_scc1 L_s
    s_mov_b32 s35, 131072
    s_waitcnt lgkmcnt(5)
    v_mfma_f32_16x16x32_bf16 v[88:91], v[40:43], v[24:27], v[88:91]
    ds_read_b64_tr_b16 v[72:73], v6 offset:20480
    ds_read_b64_tr_b16 v[74:75], v6 offset:20992
    s_waitcnt lgkmcnt(6)
    v_mfma_f32_16x16x32_bf16 v[92:95], v[40:43], v[28:31], v[92:95]
    ds_read_b128 v[56:59], v4 offset:8192
    ds_read_b128 v[60:63], v4 offset:9216
    buffer_load_dwordx4 v10, s[56:59], s82 offen offset:3072 sc1 lds
    s_add_u32 s82, s82, 16384
    s_waitcnt lgkmcnt(7)
    v_mfma_f32_16x16x32_bf16 v[96:99], v[40:43], v[32:35], v[96:99]
    ds_read_b128 v[64:67], v4 offset:10240
    ds_read_b128 v[68:71], v4 offset:11264
    s_lshl1_add_u32 m0, s33, 81920
    s_waitcnt lgkmcnt(8)
    v_mfma_f32_16x16x32_bf16 v[100:103], v[40:43], v[36:39], v[100:103]
    ds_read_b64_tr_b16 v[76:77], v7 offset:20480
    ds_read_b64_tr_b16 v[78:79], v7 offset:20992
    buffer_load_dwordx4 v11, s[60:63], s83 offen lds
    s_waitcnt lgkmcnt(8)
    v_mfma_f32_16x16x32_bf16 v[104:107], v[44:47], v[24:27], v[104:107]
    v_mfma_f32_16x16x32_bf16 v[108:111], v[44:47], v[28:31], v[108:111]
    s_lshl1_add_u32 m0, s33, 82944
    v_mfma_f32_16x16x32_bf16 v[112:115], v[44:47], v[32:35], v[112:115]
    buffer_load_dwordx4 v12, s[60:63], s83 offen lds
    s_add_u32 s83, s83, s35
    v_mfma_f32_16x16x32_bf16 v[116:119], v[44:47], v[36:39], v[116:119]
    s_waitcnt vmcnt(12) lgkmcnt(0)
    s_barrier
    v_mfma_f32_16x16x32_bf16 v[88:91], v[72:75], v[56:59], v[88:91]
    ds_read_b64_tr_b16 v[40:41], v8 offset:49152
    ds_read_b64_tr_b16 v[42:43], v8 offset:49664
    v_mfma_f32_16x16x32_bf16 v[92:95], v[72:75], v[60:63], v[92:95]
    ds_read_b128 v[24:27], v5 offset:32768
    ds_read_b128 v[28:31], v5 offset:33792
    v_mfma_f32_16x16x32_bf16 v[96:99], v[72:75], v[64:67], v[96:99]
    ds_read_b128 v[32:35], v5 offset:34816
    v_mfma_f32_16x16x32_bf16 v[100:103], v[72:75], v[68:71], v[100:103]
    ds_read_b128 v[36:39], v5 offset:35840
    ds_read_b64_tr_b16 v[44:45], v9 offset:49152
    v_mfma_f32_16x16x32_bf16 v[104:107], v[76:79], v[56:59], v[104:107]
    ds_read_b64_tr_b16 v[46:47], v9 offset:49664
    v_mfma_f32_16x16x32_bf16 v[108:111], v[76:79], v[60:63], v[108:111]
    v_mfma_f32_16x16x32_bf16 v[112:115], v[76:79], v[64:67], v[112:115]
    v_mfma_f32_16x16x32_bf16 v[116:119], v[76:79], v[68:71], v[116:119]
    s_waitcnt lgkmcnt(5)
    v_mfma_f32_16x16x32_bf16 v[88:91], v[40:43], v[24:27], v[88:91]
    ds_read_b64_tr_b16 v[72:73], v8 offset:53248
    ds_read_b64_tr_b16 v[74:75], v8 offset:53760
    s_waitcnt lgkmcnt(6)
    v_mfma_f32_16x16x32_bf16 v[92:95], v[40:43], v[28:31], v[92:95]
    ds_read_b128 v[56:59], v5 offset:40960
    ds_read_b128 v[60:63], v5 offset:41984
    s_waitcnt lgkmcnt(7)
    v_mfma_f32_16x16x32_bf16 v[96:99], v[40:43], v[32:35], v[96:99]
    ds_read_b128 v[64:67], v5 offset:43008
    ds_read_b128 v[68:71], v5 offset:44032
    s_waitcnt lgkmcnt(8)
    v_mfma_f32_16x16x32_bf16 v[100:103], v[40:43], v[36:39], v[100:103]
    ds_read_b64_tr_b16 v[76:77], v9 offset:53248
    ds_read_b64_tr_b16 v[78:79], v9 offset:53760
    s_waitcnt lgkmcnt(8)
    v_mfma_f32_16x16x32_bf16 v[104:107], v[44:47], v[24:27], v[104:107]
    v_mfma_f32_16x16x32_bf16 v[108:111], v[44:47], v[28:31], v[108:111]
    v_mfma_f32_16x16x32_bf16 v[112:115], v[44:47], v[32:35], v[112:115]
    v_mfma_f32_16x16x32_bf16 v[116:119], v[44:47], v[36:39], v[116:119]
    s_waitcnt vmcnt(6) lgkmcnt(0)
    s_barrier
    v_mfma_f32_16x16x32_bf16 v[88:91], v[72:75], v[56:59], v[88:91]
    ds_read_b64_tr_b16 v[40:41], v6 offset:49152
    ds_read_b64_tr_b16 v[42:43], v6 offset:49664
    v_mfma_f32_16x16x32_bf16 v[92:95], v[72:75], v[60:63], v[92:95]
    ds_read_b128 v[24:27], v4 offset:32768
    ds_read_b128 v[28:31], v4 offset:33792
    v_mfma_f32_16x16x32_bf16 v[96:99], v[72:75], v[64:67], v[96:99]
    ds_read_b128 v[32:35], v4 offset:34816
    v_mfma_f32_16x16x32_bf16 v[100:103], v[72:75], v[68:71], v[100:103]
    ds_read_b128 v[36:39], v4 offset:35840
    ds_read_b64_tr_b16 v[44:45], v7 offset:49152
    v_mfma_f32_16x16x32_bf16 v[104:107], v[76:79], v[56:59], v[104:107]
    ds_read_b64_tr_b16 v[46:47], v7 offset:49664
    v_mfma_f32_16x16x32_bf16 v[108:111], v[76:79], v[60:63], v[108:111]
    v_mfma_f32_16x16x32_bf16 v[112:115], v[76:79], v[64:67], v[112:115]
    v_mfma_f32_16x16x32_bf16 v[116:119], v[76:79], v[68:71], v[116:119]
    s_waitcnt lgkmcnt(5)
    v_mfma_f32_16x16x32_bf16 v[88:91], v[40:43], v[24:27], v[88:91]
    ds_read_b64_tr_b16 v[72:73], v6 offset:53248
    ds_read_b64_tr_b16 v[74:75], v6 offset:53760
    s_waitcnt lgkmcnt(6)
    v_mfma_f32_16x16x32_bf16 v[92:95], v[40:43], v[28:31], v[92:95]
    ds_read_b128 v[56:59], v4 offset:40960
    ds_read_b128 v[60:63], v4 offset:41984
    s_waitcnt lgkmcnt(7)
    v_mfma_f32_16x16x32_bf16 v[96:99], v[40:43], v[32:35], v[96:99]
    ds_read_b128 v[64:67], v4 offset:43008
    ds_read_b128 v[68:71], v4 offset:44032
    s_waitcnt lgkmcnt(8)
    v_mfma_f32_16x16x32_bf16 v[100:103], v[40:43], v[36:39], v[100:103]
    ds_read_b64_tr_b16 v[76:77], v7 offset:53248
    ds_read_b64_tr_b16 v[78:79], v7 offset:53760
    s_waitcnt lgkmcnt(8)
    v_mfma_f32_16x16x32_bf16 v[104:107], v[44:47], v[24:27], v[104:107]
    v_mfma_f32_16x16x32_bf16 v[108:111], v[44:47], v[28:31], v[108:111]
    v_mfma_f32_16x16x32_bf16 v[112:115], v[44:47], v[32:35], v[112:115]
    v_mfma_f32_16x16x32_bf16 v[116:119], v[44:47], v[36:39], v[116:119]
    s_waitcnt vmcnt(0) lgkmcnt(0)
    s_barrier
    v_mfma_f32_16x16x32_bf16 v[88:91], v[72:75], v[56:59], v[88:91]
    ds_read_b64_tr_b16 v[40:41], v8 offset:16384
    ds_read_b64_tr_b16 v[42:43], v8 offset:16896
    v_mfma_f32_16x16x32_bf16 v[92:95], v[72:75], v[60:63], v[92:95]
    ds_read_b128 v[24:27], v5 offset:0
    ds_read_b128 v[28:31], v5 offset:1024
    v_mfma_f32_16x16x32_bf16 v[96:99], v[72:75], v[64:67], v[96:99]
    ds_read_b128 v[32:35], v5 offset:2048
    v_mfma_f32_16x16x32_bf16 v[100:103], v[72:75], v[68:71], v[100:103]
    ds_read_b128 v[36:39], v5 offset:3072
    ds_read_b64_tr_b16 v[44:45], v9 offset:16384
    v_mfma_f32_16x16x32_bf16 v[104:107], v[76:79], v[56:59], v[104:107]
    ds_read_b64_tr_b16 v[46:47], v9 offset:16896
    v_mfma_f32_16x16x32_bf16 v[108:111], v[76:79], v[60:63], v[108:111]
    v_mfma_f32_16x16x32_bf16 v[112:115], v[76:79], v[64:67], v[112:115]
    v_mfma_f32_16x16x32_bf16 v[116:119], v[76:79], v[68:71], v[116:119]
    s_waitcnt lgkmcnt(5)
    v_mfma_f32_16x16x32_bf16 v[88:91], v[40:43], v[24:27], v[88:91]
    ds_read_b64_tr_b16 v[72:73], v8 offset:20480
    ds_read_b64_tr_b16 v[74:75], v8 offset:20992
    s_waitcnt lgkmcnt(6)
    v_mfma_f32_16x16x32_bf16 v[92:95], v[40:43], v[28:31], v[92:95]
    ds_read_b128 v[56:59], v5 offset:8192
    ds_read_b128 v[60:63], v5 offset:9216
    s_waitcnt lgkmcnt(7)
    v_mfma_f32_16x16x32_bf16 v[96:99], v[40:43], v[32:35], v[96:99]
    ds_read_b128 v[64:67], v5 offset:10240
    ds_read_b128 v[68:71], v5 offset:11264
    s_waitcnt lgkmcnt(8)
    v_mfma_f32_16x16x32_bf16 v[100:103], v[40:43], v[36:39], v[100:103]
    ds_read_b64_tr_b16 v[76:77], v9 offset:20480
    ds_read_b64_tr_b16 v[78:79], v9 offset:20992
    s_waitcnt lgkmcnt(8)
    v_mfma_f32_16x16x32_bf16 v[104:107], v[44:47], v[24:27], v[104:107]
    v_mfma_f32_16x16x32_bf16 v[108:111], v[44:47], v[28:31], v[108:111]
    v_mfma_f32_16x16x32_bf16 v[112:115], v[44:47], v[32:35], v[112:115]
    v_mfma_f32_16x16x32_bf16 v[116:119], v[44:47], v[36:39], v[116:119]
    s_waitcnt lgkmcnt(5)
    v_mfma_f32_16x16x32_bf16 v[88:91], v[72:75], v[56:59], v[88:91]
    s_waitcnt lgkmcnt(4)
    v_mfma_f32_16x16x32_bf16 v[92:95], v[72:75], v[60:63], v[92:95]
    s_waitcnt lgkmcnt(3)
    v_mfma_f32_16x16x32_bf16 v[96:99], v[72:75], v[64:67], v[96:99]
    s_waitcnt lgkmcnt(2)
    v_mfma_f32_16x16x32_bf16 v[100:103], v[72:75], v[68:71], v[100:103]
    s_waitcnt lgkmcnt(0)
    v_mfma_f32_16x16x32_bf16 v[104:107], v[76:79], v[56:59], v[104:107]
    v_mfma_f32_16x16x32_bf16 v[108:111], v[76:79], v[60:63], v[108:111]
    v_mfma_f32_16x16x32_bf16 v[112:115], v[76:79], v[64:67], v[112:115]
    v_mfma_f32_16x16x32_bf16 v[116:119], v[76:79], v[68:71], v[116:119]
    s_barrier
    s_lshl_b32 s84, s4, 12
    s_add_u32 s84, s84, 131072
    v_lshl_add_u32 v4, v1, 3, s84
    ds_read_b64 v[24:25], v4 offset:0
    ds_read_b64 v[26:27], v4 offset:512
    ds_read_b64 v[28:29], v4 offset:1024
    ds_read_b64 v[30:31], v4 offset:1536
    ds_read_b64 v[32:33], v4 offset:2048
    ds_read_b64 v[34:35], v4 offset:2560
    ds_read_b64 v[36:37], v4 offset:3072
    ds_read_b64 v[38:39], v4 offset:3584
    s_mov_b32 s72, s22
    s_mov_b32 s73, s23
    s_mov_b32 s74, 0x400000
    s_mov_b32 s75, 0x20000
    v_cvt_pk_bf16_f32 v44, v88, v89
    v_cvt_pk_bf16_f32 v45, v90, v91
    v_lshlrev_b32 v88, 16, v44
    v_and_b32 v89, 0xffff0000, v44
    v_lshlrev_b32 v90, 16, v45
    v_and_b32 v91, 0xffff0000, v45
    v_cvt_pk_bf16_f32 v44, v92, v93
    v_cvt_pk_bf16_f32 v45, v94, v95
    v_lshlrev_b32 v92, 16, v44
    v_and_b32 v93, 0xffff0000, v44
    v_lshlrev_b32 v94, 16, v45
    v_and_b32 v95, 0xffff0000, v45
    v_cvt_pk_bf16_f32 v44, v96, v97
    v_cvt_pk_bf16_f32 v45, v98, v99
    v_lshlrev_b32 v96, 16, v44
    v_and_b32 v97, 0xffff0000, v44
    v_lshlrev_b32 v98, 16, v45
    v_and_b32 v99, 0xffff0000, v45
    v_cvt_pk_bf16_f32 v44, v100, v101
    v_cvt_pk_bf16_f32 v45, v102, v103
    v_lshlrev_b32 v100, 16, v44
    v_and_b32 v101, 0xffff0000, v44
    v_lshlrev_b32 v102, 16, v45
    v_and_b32 v103, 0xffff0000, v45
    v_cvt_pk_bf16_f32 v44, v104, v105
    v_cvt_pk_bf16_f32 v45, v106, v107
    v_lshlrev_b32 v104, 16, v44
    v_and_b32 v105, 0xffff0000, v44
    v_lshlrev_b32 v106, 16, v45
    v_and_b32 v107, 0xffff0000, v45
    v_cvt_pk_bf16_f32 v44, v108, v109
    v_cvt_pk_bf16_f32 v45, v110, v111
    v_lshlrev_b32 v108, 16, v44
    v_and_b32 v109, 0xffff0000, v44
    v_lshlrev_b32 v110, 16, v45
    v_and_b32 v111, 0xffff0000, v45
    v_cvt_pk_bf16_f32 v44, v112, v113
    v_cvt_pk_bf16_f32 v45, v114, v115
    v_lshlrev_b32 v112, 16, v44
    v_and_b32 v113, 0xffff0000, v44
    v_lshlrev_b32 v114, 16, v45
    v_and_b32 v115, 0xffff0000, v45
    v_cvt_pk_bf16_f32 v44, v116, v117
    v_cvt_pk_bf16_f32 v45, v118, v119
    v_lshlrev_b32 v116, 16, v44
    v_and_b32 v117, 0xffff0000, v44
    v_lshlrev_b32 v118, 16, v45
    v_and_b32 v119, 0xffff0000, v45
    s_waitcnt lgkmcnt(0)
    v_lshlrev_b32 v40, 16, v24
    v_and_b32 v41, 0xffff0000, v24
    v_lshlrev_b32 v42, 16, v25
    v_and_b32 v43, 0xffff0000, v25
    v_mul_f32 v40, v40, v88
    v_mul_f32 v41, v41, v89
    v_mul_f32 v42, v42, v90
    v_mul_f32 v43, v43, v91
    v_cvt_pk_bf16_f32 v48, v40, v41
    v_cvt_pk_bf16_f32 v49, v42, v43
    v_lshlrev_b32 v40, 16, v32
    v_and_b32 v41, 0xffff0000, v32
    v_lshlrev_b32 v42, 16, v33
    v_and_b32 v43, 0xffff0000, v33
    v_mul_f32 v40, v40, v104
    v_mul_f32 v41, v41, v105
    v_mul_f32 v42, v42, v106
    v_mul_f32 v43, v43, v107
    v_cvt_pk_bf16_f32 v50, v40, v41
    v_cvt_pk_bf16_f32 v51, v42, v43
    s_nop 1
    v_permlane16_swap_b32 v48, v50
    v_permlane16_swap_b32 v49, v51
    v_lshlrev_b32 v40, 16, v48
    v_and_b32 v41, 0xffff0000, v48
    v_lshlrev_b32 v42, 16, v120
    v_and_b32 v43, 0xffff0000, v120
    v_add_f32 v40, v40, v42
    v_add_f32 v41, v41, v43
    v_cvt_pk_bf16_f32 v48, v40, v41
    v_lshlrev_b32 v40, 16, v49
    v_and_b32 v41, 0xffff0000, v49
    v_lshlrev_b32 v42, 16, v121
    v_and_b32 v43, 0xffff0000, v121
    v_add_f32 v40, v40, v42
    v_add_f32 v41, v41, v43
    v_cvt_pk_bf16_f32 v49, v40, v41
    v_lshlrev_b32 v40, 16, v50
    v_and_b32 v41, 0xffff0000, v50
    v_lshlrev_b32 v42, 16, v122
    v_and_b32 v43, 0xffff0000, v122
    v_add_f32 v40, v40, v42
    v_add_f32 v41, v41, v43
    v_cvt_pk_bf16_f32 v50, v40, v41
    v_lshlrev_b32 v40, 16, v51
    v_and_b32 v41, 0xffff0000, v51
    v_lshlrev_b32 v42, 16, v123
    v_and_b32 v43, 0xffff0000, v123
    v_add_f32 v40, v40, v42
    v_add_f32 v41, v41, v43
    v_cvt_pk_bf16_f32 v51, v40, v41
    s_mov_b32 s84, 0
    buffer_store_dwordx4 v[48:51], v13, s[72:75], s84 offen
    v_lshlrev_b32 v40, 16, v26
    v_and_b32 v41, 0xffff0000, v26
    v_lshlrev_b32 v42, 16, v27
    v_and_b32 v43, 0xffff0000, v27
    v_mul_f32 v40, v40, v92
    v_mul_f32 v41, v41, v93
    v_mul_f32 v42, v42, v94
    v_mul_f32 v43, v43, v95
    v_cvt_pk_bf16_f32 v52, v40, v41
    v_cvt_pk_bf16_f32 v53, v42, v43
    v_lshlrev_b32 v40, 16, v34
    v_and_b32 v41, 0xffff0000, v34
    v_lshlrev_b32 v42, 16, v35
    v_and_b32 v43, 0xffff0000, v35
    v_mul_f32 v40, v40, v108
    v_mul_f32 v41, v41, v109
    v_mul_f32 v42, v42, v110
    v_mul_f32 v43, v43, v111
    v_cvt_pk_bf16_f32 v54, v40, v41
    v_cvt_pk_bf16_f32 v55, v42, v43
    s_nop 1
    v_permlane16_swap_b32 v52, v54
    v_permlane16_swap_b32 v53, v55
    v_lshlrev_b32 v40, 16, v52
    v_and_b32 v41, 0xffff0000, v52
    v_lshlrev_b32 v42, 16, v124
    v_and_b32 v43, 0xffff0000, v124
    v_add_f32 v40, v40, v42
    v_add_f32 v41, v41, v43
    v_cvt_pk_bf16_f32 v52, v40, v41
    v_lshlrev_b32 v40, 16, v53
    v_and_b32 v41, 0xffff0000, v53
    v_lshlrev_b32 v42, 16, v125
    v_and_b32 v43, 0xffff0000, v125
    v_add_f32 v40, v40, v42
    v_add_f32 v41, v41, v43
    v_cvt_pk_bf16_f32 v53, v40, v41
    v_lshlrev_b32 v40, 16, v54
    v_and_b32 v41, 0xffff0000, v54
    v_lshlrev_b32 v42, 16, v126
    v_and_b32 v43, 0xffff0000, v126
    v_add_f32 v40, v40, v42
    v_add_f32 v41, v41, v43
    v_cvt_pk_bf16_f32 v54, v40, v41
    v_lshlrev_b32 v40, 16, v55
    v_and_b32 v41, 0xffff0000, v55
    v_lshlrev_b32 v42, 16, v127
    v_and_b32 v43, 0xffff0000, v127
    v_add_f32 v40, v40, v42
    v_add_f32 v41, v41, v43
    v_cvt_pk_bf16_f32 v55, v40, v41
    s_mov_b32 s84, 32768
    buffer_store_dwordx4 v[52:55], v13, s[72:75], s84 offen
    v_lshlrev_b32 v40, 16, v28
    v_and_b32 v41, 0xffff0000, v28
    v_lshlrev_b32 v42, 16, v29
    v_and_b32 v43, 0xffff0000, v29
    v_mul_f32 v40, v40, v96
    v_mul_f32 v41, v41, v97
    v_mul_f32 v42, v42, v98
    v_mul_f32 v43, v43, v99
    v_cvt_pk_bf16_f32 v56, v40, v41
    v_cvt_pk_bf16_f32 v57, v42, v43
    v_lshlrev_b32 v40, 16, v36
    v_and_b32 v41, 0xffff0000, v36
    v_lshlrev_b32 v42, 16, v37
    v_and_b32 v43, 0xffff0000, v37
    v_mul_f32 v40, v40, v112
    v_mul_f32 v41, v41, v113
    v_mul_f32 v42, v42, v114
    v_mul_f32 v43, v43, v115
    v_cvt_pk_bf16_f32 v58, v40, v41
    v_cvt_pk_bf16_f32 v59, v42, v43
    s_nop 1
    v_permlane16_swap_b32 v56, v58
    v_permlane16_swap_b32 v57, v59
    v_lshlrev_b32 v40, 16, v56
    v_and_b32 v41, 0xffff0000, v56
    v_lshlrev_b32 v42, 16, v128
    v_and_b32 v43, 0xffff0000, v128
    v_add_f32 v40, v40, v42
    v_add_f32 v41, v41, v43
    v_cvt_pk_bf16_f32 v56, v40, v41
    v_lshlrev_b32 v40, 16, v57
    v_and_b32 v41, 0xffff0000, v57
    v_lshlrev_b32 v42, 16, v129
    v_and_b32 v43, 0xffff0000, v129
    v_add_f32 v40, v40, v42
    v_add_f32 v41, v41, v43
    v_cvt_pk_bf16_f32 v57, v40, v41
    v_lshlrev_b32 v40, 16, v58
    v_and_b32 v41, 0xffff0000, v58
    v_lshlrev_b32 v42, 16, v130
    v_and_b32 v43, 0xffff0000, v130
    v_add_f32 v40, v40, v42
    v_add_f32 v41, v41, v43
    v_cvt_pk_bf16_f32 v58, v40, v41
    v_lshlrev_b32 v40, 16, v59
    v_and_b32 v41, 0xffff0000, v59
    v_lshlrev_b32 v42, 16, v131
    v_and_b32 v43, 0xffff0000, v131
    v_add_f32 v40, v40, v42
    v_add_f32 v41, v41, v43
    v_cvt_pk_bf16_f32 v59, v40, v41
    s_mov_b32 s84, 65536
    buffer_store_dwordx4 v[56:59], v13, s[72:75], s84 offen
    v_lshlrev_b32 v40, 16, v30
    v_and_b32 v41, 0xffff0000, v30
    v_lshlrev_b32 v42, 16, v31
    v_and_b32 v43, 0xffff0000, v31
    v_mul_f32 v40, v40, v100
    v_mul_f32 v41, v41, v101
    v_mul_f32 v42, v42, v102
    v_mul_f32 v43, v43, v103
    v_cvt_pk_bf16_f32 v60, v40, v41
    v_cvt_pk_bf16_f32 v61, v42, v43
    v_lshlrev_b32 v40, 16, v38
    v_and_b32 v41, 0xffff0000, v38
    v_lshlrev_b32 v42, 16, v39
    v_and_b32 v43, 0xffff0000, v39
    v_mul_f32 v40, v40, v116
    v_mul_f32 v41, v41, v117
    v_mul_f32 v42, v42, v118
    v_mul_f32 v43, v43, v119
    v_cvt_pk_bf16_f32 v62, v40, v41
    v_cvt_pk_bf16_f32 v63, v42, v43
    s_nop 1
    v_permlane16_swap_b32 v60, v62
    v_permlane16_swap_b32 v61, v63
    v_lshlrev_b32 v40, 16, v60
    v_and_b32 v41, 0xffff0000, v60
    v_lshlrev_b32 v42, 16, v132
    v_and_b32 v43, 0xffff0000, v132
    v_add_f32 v40, v40, v42
    v_add_f32 v41, v41, v43
    v_cvt_pk_bf16_f32 v60, v40, v41
    v_lshlrev_b32 v40, 16, v61
    v_and_b32 v41, 0xffff0000, v61
    v_lshlrev_b32 v42, 16, v133
    v_and_b32 v43, 0xffff0000, v133
    v_add_f32 v40, v40, v42
    v_add_f32 v41, v41, v43
    v_cvt_pk_bf16_f32 v61, v40, v41
    v_lshlrev_b32 v40, 16, v62
    v_and_b32 v41, 0xffff0000, v62
    v_lshlrev_b32 v42, 16, v134
    v_and_b32 v43, 0xffff0000, v134
    v_add_f32 v40, v40, v42
    v_add_f32 v41, v41, v43
    v_cvt_pk_bf16_f32 v62, v40, v41
    v_lshlrev_b32 v40, 16, v63
    v_and_b32 v41, 0xffff0000, v63
    v_lshlrev_b32 v42, 16, v135
    v_and_b32 v43, 0xffff0000, v135
    v_add_f32 v40, v40, v42
    v_add_f32 v41, v41, v43
    v_cvt_pk_bf16_f32 v63, v40, v41
    s_mov_b32 s84, 98304
    buffer_store_dwordx4 v[60:63], v13, s[72:75], s84 offen
L_fin:
L_end:
    s_endpgm
L_code_end:
.section .rodata,"a"
.p2align 6
.amdhsa_kernel recurrent_scan__sliding_local_dilated__glu_gated_geglu__prompt_kernel
  .amdhsa_next_free_vgpr 256
  .amdhsa_next_free_sgpr 102
  .amdhsa_accum_offset 256
  .amdhsa_group_segment_fixed_size 0
  .amdhsa_kernarg_size 80
  .amdhsa_user_sgpr_count 2
  .amdhsa_user_sgpr_kernarg_segment_ptr 1
  .amdhsa_system_sgpr_workgroup_id_x 1
.end_amdhsa_kernel
```

```asm
; @launch grid=(256,1,1) block=(512,1,1) lds=163840
.amdgcn_target "amdgcn-amd-amdhsa--gfx950"
.text
.globl recurrent_scan__sliding_local_dilated__glu_gated_geglu__prompt_kernel
.p2align 8
.type recurrent_scan__sliding_local_dilated__glu_gated_geglu__prompt_kernel,@function
recurrent_scan__sliding_local_dilated__glu_gated_geglu__prompt_kernel:
    s_cmp_ge_u32 s2, 256
    s_cbranch_scc1 L_end
    s_load_dwordx4 s[8:11], s[0:1], 0
    s_load_dwordx2 s[12:13], s[0:1], 16
    s_load_dwordx4 s[16:19], s[0:1], 32
    s_load_dwordx4 s[20:23], s[0:1], 48
    s_load_dwordx4 s[24:27], s[0:1], 64
    v_lshrrev_b32 v3, 6, v0
    v_and_b32 v1, 63, v0
    v_readfirstlane_b32 s3, v3
    s_and_b32 s84, s2, 7
    s_lshr_b32 s85, s2, 3
    s_mov_b32 s15, s85
    s_and_b32 s32, s84, 1
    s_lshl_b32 s86, s32, 3
    s_and_b32 s87, s85, 7
    s_add_u32 s28, s86, s87
    s_lshr_b32 s86, s84, 1
    s_lshl_b32 s86, s86, 2
    s_lshr_b32 s87, s85, 3
    s_add_u32 s29, s86, s87
    s_and_b32 s87, s85, 3
    s_add_u32 s30, s86, s87
    s_lshr_b32 s31, s85, 2
    s_and_b32 s4, s3, 3
    s_lshr_b32 s5, s4, 1
    s_and_b32 s6, s4, 1
    s_lshr_b32 s7, s3, 2
    s_lshl_b32 s33, s4, 10
    s_waitcnt lgkmcnt(0)
    s_mov_b32 s68, s26
    s_mov_b32 s69, s27
    s_mov_b32 s70, 0x10000000
    s_mov_b32 s71, 0x20000
    s_cmp_lg_u32 s7, 0
    s_cbranch_scc1 L_teamB
    s_or_b32 s91, s2, s4
    s_cbranch_scc1 L_notok
    s_memrealtime s[92:93]
    v_mov_b32 v84, 0
    s_waitcnt lgkmcnt(0)
    s_or_b32 s92, s92, 1
    v_mov_b32 v86, s92
    v_mov_b32 v87, s93
    s_mov_b64 exec, 1
    global_store_dwordx2 v84, v[86:87], s[24:25] sc1
    s_mov_b64 exec, -1
L_notok:
    v_lshrrev_b32 v64, 4, v1
    v_bfe_u32 v65, v1, 2, 2
    v_and_b32 v66, 3, v1
    v_and_b32 v67, 15, v1
    v_lshrrev_b32 v68, 3, v1
    v_and_b32 v69, 7, v1
    s_lshl_b32 s85, s6, 12
    s_add_u32 s85, s85, 16384
    v_lshl_add_u32 v70, v64, 3, v65
    v_lshlrev_b32 v70, 7, v70
    v_and_b32 v71, 1, v66
    v_lshl_add_u32 v70, v71, 3, v70
    v_add_u32 v70, s85, v70
    v_and_b32 v71, 2, v65
    v_and_b32 v72, 1, v64
    v_lshl_add_u32 v71, v72, 2, v71
    v_lshrrev_b32 v72, 1, v66
    v_xor_b32 v71, v71, v72
    v_xor_b32 v72, 0, v71
    v_lshl_add_u32 v4, v72, 4, v70
    v_add_u32 v9, 40960, v4
    v_xor_b32 v72, 2, v71
    v_lshl_add_u32 v5, v72, 4, v70
    v_add_u32 v10, 40960, v5
    v_xor_b32 v72, 4, v71
    v_lshl_add_u32 v6, v72, 4, v70
    v_add_u32 v11, 40960, v6
    v_xor_b32 v72, 6, v71
    v_lshl_add_u32 v7, v72, 4, v70
    v_add_u32 v12, 40960, v7
    v_lshl_add_u32 v70, v64, 3, v65
    v_lshlrev_b32 v70, 6, v70
    v_and_b32 v71, 1, v66
    v_lshl_add_u32 v70, v71, 3, v70
    v_and_b32 v71, 1, v64
    v_xor_b32 v71, s6, v71
    v_lshl_add_u32 v70, v71, 5, v70
    v_lshrrev_b32 v71, 1, v66
    v_lshl_add_u32 v70, v71, 4, v70
    v_add_u32 v8, 16384, v70
    v_add_u32 v13, 57344, v70
    v_lshrrev_b32 v70, 1, v67
    v_xor_b32 v70, v70, v64
    v_lshlrev_b32 v70, 4, v70
    v_lshl_add_u32 v70, v67, 7, v70
    s_lshl_b32 s85, s5, 13
    v_add_u32 v16, s85, v70
    v_xor_b32 v17, 64, v16
    s_mov_b32 s80, 116736
    s_lshl_b32 s85, s28, 7
    s_lshl_b32 s86, s4, 5
    s_add_u32 s86, s85, s86
    v_add_u32 v71, s86, v68
    v_xor_b32 v70, v69, v64
    v_lshlrev_b32 v70, 4, v70
    v_lshl_add_u32 v20, v71, 11, v70
    v_xor_b32 v21, 64, v20
    v_add_u32 v21, 16384, v21
    s_lshl_b32 s79, s4, 12
    s_lshl_b32 s86, s28, 7
    s_sub_u32 s86, s86, 16
    s_max_i32 s86, s86, 0
    s_lshl_b32 s87, s4, 2
    v_add_u32 v71, s87, v68
    v_lshrrev_b32 v70, 1, v71
    v_and_b32 v70, 7, v70
    v_xor_b32 v70, v70, v69
    v_lshlrev_b32 v70, 4, v70
    v_add_u32 v71, s86, v71
    v_lshl_add_u32 v3, v71, 11, v70
    s_lshl_b32 s81, s4, 9
    s_lshl_b32 s85, s4, 3
    s_and_b32 s86, s4, 1
    s_lshl_b32 s86, s86, 2
    v_and_b32 v70, 2, v68
    v_xor_b32 v70, v70, v69
    v_xor_b32 v70, s86, v70
    v_add_u32 v71, s85, v68
    v_mul_u32_u24 v71, 7168, v71
    v_lshl_add_u32 v22, v70, 4, v71
    v_and_b32 v70, 2, v68
    v_xor_b32 v70, v70, v69
    v_xor_b32 v70, s86, v70
    v_add_u32 v71, s85, v68
    v_mul_u32_u24 v71, 6144, v71
    v_lshl_add_u32 v23, v70, 4, v71
    s_mov_b32 s36, s26
    s_mov_b32 s37, s27
    s_mov_b32 s38, 0x400000
    s_mov_b32 s39, 0x20000
    s_lshl_b32 s85, s29, 7
    s_add_u32 s40, s10, s85
    s_addc_u32 s41, s11, 0
    s_sub_u32 s42, 6291456, s85
    s_mov_b32 s43, 0x20000
    s_add_u32 s86, s85, 4096
    s_add_u32 s44, s10, s86
    s_addc_u32 s45, s11, 0
    s_sub_u32 s46, 6291456, s86
    s_mov_b32 s47, 0x20000
    s_add_u32 s86, s85, 5120
    s_add_u32 s48, s16, s86
    s_addc_u32 s49, s17, 0
    s_sub_u32 s50, 7340032, s86
    s_mov_b32 s51, 0x20000
    s_add_u32 s52, s18, s86
    s_addc_u32 s53, s19, 0
    s_sub_u32 s54, 7340032, s86
    s_mov_b32 s55, 0x20000
    v_mov_b32 v88, 0
    v_mov_b32 v89, 0
    v_mov_b32 v90, 0
    v_mov_b32 v91, 0
    v_mov_b32 v92, 0
    v_mov_b32 v93, 0
    v_mov_b32 v94, 0
    v_mov_b32 v95, 0
    v_mov_b32 v96, 0
    v_mov_b32 v97, 0
    v_mov_b32 v98, 0
    v_mov_b32 v99, 0
    v_mov_b32 v100, 0
    v_mov_b32 v101, 0
    v_mov_b32 v102, 0
    v_mov_b32 v103, 0
    v_mov_b32 v104, 0
    v_mov_b32 v105, 0
    v_mov_b32 v106, 0
    v_mov_b32 v107, 0
    v_mov_b32 v108, 0
    v_mov_b32 v109, 0
    v_mov_b32 v110, 0
    v_mov_b32 v111, 0
    v_mov_b32 v112, 0
    v_mov_b32 v113, 0
    v_mov_b32 v114, 0
    v_mov_b32 v115, 0
    v_mov_b32 v116, 0
    v_mov_b32 v117, 0
    v_mov_b32 v118, 0
    v_mov_b32 v119, 0
    v_mov_b32 v120, 0
    v_mov_b32 v121, 0
    v_mov_b32 v122, 0
    v_mov_b32 v123, 0
    v_mov_b32 v124, 0
    v_mov_b32 v125, 0
    v_mov_b32 v126, 0
    v_mov_b32 v127, 0
    v_mov_b32 v128, 0
    v_mov_b32 v129, 0
    v_mov_b32 v130, 0
    v_mov_b32 v131, 0
    v_mov_b32 v132, 0
    v_mov_b32 v133, 0
    v_mov_b32 v134, 0
    v_mov_b32 v135, 0
    v_mov_b32 v136, 0
    v_mov_b32 v137, 0
    v_mov_b32 v138, 0
    v_mov_b32 v139, 0
    v_mov_b32 v140, 0
    v_mov_b32 v141, 0
    v_mov_b32 v142, 0
    v_mov_b32 v143, 0
    v_mov_b32 v144, 0
    v_mov_b32 v145, 0
    v_mov_b32 v146, 0
    v_mov_b32 v147, 0
    v_mov_b32 v148, 0
    v_mov_b32 v149, 0
    v_mov_b32 v150, 0
    v_mov_b32 v151, 0
    v_mov_b32 v152, 0
    v_mov_b32 v153, 0
    v_mov_b32 v154, 0
    v_mov_b32 v155, 0
    v_mov_b32 v156, 0
    v_mov_b32 v157, 0
    v_mov_b32 v158, 0
    v_mov_b32 v159, 0
    v_mov_b32 v160, 0
    v_mov_b32 v161, 0
    v_mov_b32 v162, 0
    v_mov_b32 v163, 0
    v_mov_b32 v164, 0
    v_mov_b32 v165, 0
    v_mov_b32 v166, 0
    v_mov_b32 v167, 0
    v_mov_b32 v168, 0
    v_mov_b32 v169, 0
    v_mov_b32 v170, 0
    v_mov_b32 v171, 0
    v_mov_b32 v172, 0
    v_mov_b32 v173, 0
    v_mov_b32 v174, 0
    v_mov_b32 v175, 0
    v_mov_b32 v176, 0
    v_mov_b32 v177, 0
    v_mov_b32 v178, 0
    v_mov_b32 v179, 0
    v_mov_b32 v180, 0
    v_mov_b32 v181, 0
    v_mov_b32 v182, 0
    v_mov_b32 v183, 0
    v_mov_b32 v184, 0
    v_mov_b32 v185, 0
    v_mov_b32 v186, 0
    v_mov_b32 v187, 0
    v_mov_b32 v188, 0
    v_mov_b32 v189, 0
    v_mov_b32 v190, 0
    v_mov_b32 v191, 0
    v_mov_b32 v192, 0
    v_mov_b32 v193, 0
    v_mov_b32 v194, 0
    v_mov_b32 v195, 0
    v_mov_b32 v196, 0
    v_mov_b32 v197, 0
    v_mov_b32 v198, 0
    v_mov_b32 v199, 0
    v_mov_b32 v200, 0
    v_mov_b32 v201, 0
    v_mov_b32 v202, 0
    v_mov_b32 v203, 0
    v_mov_b32 v204, 0
    v_mov_b32 v205, 0
    v_mov_b32 v206, 0
    v_mov_b32 v207, 0
    v_mov_b32 v208, 0
    v_mov_b32 v209, 0
    v_mov_b32 v210, 0
    v_mov_b32 v211, 0
    v_mov_b32 v212, 0
    v_mov_b32 v213, 0
    v_mov_b32 v214, 0
    v_mov_b32 v215, 0
    v_mov_b32 v216, 0
    v_mov_b32 v217, 0
    v_mov_b32 v218, 0
    v_mov_b32 v219, 0
    v_mov_b32 v220, 0
    v_mov_b32 v221, 0
    v_mov_b32 v222, 0
    v_mov_b32 v223, 0
    v_mov_b32 v224, 0
    v_mov_b32 v225, 0
    v_mov_b32 v226, 0
    v_mov_b32 v227, 0
    v_mov_b32 v228, 0
    v_mov_b32 v229, 0
    v_mov_b32 v230, 0
    v_mov_b32 v231, 0
    v_mov_b32 v232, 0
    v_mov_b32 v233, 0
    v_mov_b32 v234, 0
    v_mov_b32 v235, 0
    v_mov_b32 v236, 0
    v_mov_b32 v237, 0
    v_mov_b32 v238, 0
    v_mov_b32 v239, 0
    v_mov_b32 v240, 0
    v_mov_b32 v241, 0
    v_mov_b32 v242, 0
    v_mov_b32 v243, 0
    v_mov_b32 v244, 0
    v_mov_b32 v245, 0
    v_mov_b32 v246, 0
    v_mov_b32 v247, 0
    s_setprio 1
    s_barrier
    v_add_u32 v14, s80, v16
    v_add_u32 v15, s80, v17
    s_add_u32 s80, s80, 18432
    s_cmp_ge_u32 s80, 153600
    s_cselect_b32 s84, 55296, 0
    s_sub_u32 s80, s80, s84
    ds_read_b64_tr_b16 v[64:65], v4 offset:0
    ds_read_b64_tr_b16 v[66:67], v4 offset:512
    ds_read_b128 v[24:27], v14 offset:0
    ds_read_b128 v[28:31], v14 offset:2048
    ds_read_b128 v[32:35], v14 offset:4096
    ds_read_b128 v[36:39], v14 offset:6144
    ds_read_b64_tr_b16 v[68:69], v4 offset:8192
    ds_read_b64_tr_b16 v[70:71], v4 offset:8704
    ds_read_b64_tr_b16 v[72:73], v5 offset:0
    ds_read_b64_tr_b16 v[74:75], v5 offset:512
    s_mov_b32 s34, 7
.p2align 6
L_p1:
    s_waitcnt lgkmcnt(7)
    v_mfma_f32_16x16x32_bf16 v[88:91], v[64:67], v[24:27], v[88:91]
    ds_read_b64_tr_b16 v[76:77], v5 offset:8192
    s_waitcnt lgkmcnt(7)
    v_mfma_f32_16x16x32_bf16 v[92:95], v[64:67], v[28:31], v[92:95]
    ds_read_b64_tr_b16 v[78:79], v5 offset:8704
    s_waitcnt lgkmcnt(7)
    v_mfma_f32_16x16x32_bf16 v[96:99], v[64:67], v[32:35], v[96:99]
    ds_read_b64_tr_b16 v[80:81], v6 offset:0
    s_waitcnt lgkmcnt(7)
    v_mfma_f32_16x16x32_bf16 v[100:103], v[64:67], v[36:39], v[100:103]
    ds_read_b64_tr_b16 v[82:83], v6 offset:512
    s_waitcnt lgkmcnt(6)
    v_mfma_f32_16x16x32_bf16 v[104:107], v[68:71], v[24:27], v[104:107]
    ds_read_b64_tr_b16 v[64:65], v6 offset:8192
    v_mfma_f32_16x16x32_bf16 v[108:111], v[68:71], v[28:31], v[108:111]
    v_mfma_f32_16x16x32_bf16 v[112:115], v[68:71], v[32:35], v[112:115]
    ds_read_b64_tr_b16 v[66:67], v6 offset:8704
    v_mfma_f32_16x16x32_bf16 v[116:119], v[68:71], v[36:39], v[116:119]
    s_waitcnt lgkmcnt(6)
    v_mfma_f32_16x16x32_bf16 v[120:123], v[72:75], v[24:27], v[120:123]
    ds_read_b64_tr_b16 v[68:69], v7 offset:0
    v_mfma_f32_16x16x32_bf16 v[124:127], v[72:75], v[28:31], v[124:127]
    v_mfma_f32_16x16x32_bf16 v[128:131], v[72:75], v[32:35], v[128:131]
    ds_read_b64_tr_b16 v[70:71], v7 offset:512
    v_mfma_f32_16x16x32_bf16 v[132:135], v[72:75], v[36:39], v[132:135]
    s_waitcnt lgkmcnt(6)
    v_mfma_f32_16x16x32_bf16 v[136:139], v[76:79], v[24:27], v[136:139]
    ds_read_b64_tr_b16 v[72:73], v7 offset:8192
    v_mfma_f32_16x16x32_bf16 v[140:143], v[76:79], v[28:31], v[140:143]
    v_mfma_f32_16x16x32_bf16 v[144:147], v[76:79], v[32:35], v[144:147]
    ds_read_b64_tr_b16 v[74:75], v7 offset:8704
    v_mfma_f32_16x16x32_bf16 v[148:151], v[76:79], v[36:39], v[148:151]
    s_waitcnt lgkmcnt(6)
    v_mfma_f32_16x16x32_bf16 v[152:155], v[80:83], v[24:27], v[152:155]
    ds_read_b64_tr_b16 v[76:77], v8 offset:16384
    v_mfma_f32_16x16x32_bf16 v[156:159], v[80:83], v[28:31], v[156:159]
    v_mfma_f32_16x16x32_bf16 v[160:163], v[80:83], v[32:35], v[160:163]
    ds_read_b64_tr_b16 v[78:79], v8 offset:16640
    v_mfma_f32_16x16x32_bf16 v[164:167], v[80:83], v[36:39], v[164:167]
    s_waitcnt lgkmcnt(6)
    v_mfma_f32_16x16x32_bf16 v[168:171], v[64:67], v[24:27], v[168:171]
    ds_read_b64_tr_b16 v[80:81], v8 offset:18432
    v_mfma_f32_16x16x32_bf16 v[172:175], v[64:67], v[28:31], v[172:175]
    v_mfma_f32_16x16x32_bf16 v[176:179], v[64:67], v[32:35], v[176:179]
    ds_read_b64_tr_b16 v[82:83], v8 offset:18688
    v_mfma_f32_16x16x32_bf16 v[180:183], v[64:67], v[36:39], v[180:183]
    s_waitcnt lgkmcnt(6)
    v_mfma_f32_16x16x32_bf16 v[184:187], v[68:71], v[24:27], v[184:187]
    v_mfma_f32_16x16x32_bf16 v[188:191], v[68:71], v[28:31], v[188:191]
    v_mfma_f32_16x16x32_bf16 v[192:195], v[68:71], v[32:35], v[192:195]
    v_mfma_f32_16x16x32_bf16 v[196:199], v[68:71], v[36:39], v[196:199]
    s_waitcnt lgkmcnt(0)
    s_barrier
    v_mfma_f32_16x16x32_bf16 v[200:203], v[72:75], v[24:27], v[200:203]
    ds_read_b64_tr_b16 v[64:65], v4 offset:20480
    v_mfma_f32_16x16x32_bf16 v[204:207], v[72:75], v[28:31], v[204:207]
    ds_read_b64_tr_b16 v[66:67], v4 offset:20992
    v_mfma_f32_16x16x32_bf16 v[208:211], v[72:75], v[32:35], v[208:211]
    ds_read_b128 v[40:43], v15 offset:0
    v_mfma_f32_16x16x32_bf16 v[212:215], v[72:75], v[36:39], v[212:215]
    ds_read_b128 v[44:47], v15 offset:2048
    v_mfma_f32_16x16x32_bf16 v[216:219], v[76:79], v[24:27], v[216:219]
    ds_read_b128 v[48:51], v15 offset:4096
    v_mfma_f32_16x16x32_bf16 v[220:223], v[76:79], v[28:31], v[220:223]
    ds_read_b128 v[52:55], v15 offset:6144
    v_mfma_f32_16x16x32_bf16 v[224:227], v[76:79], v[32:35], v[224:227]
    ds_read_b64_tr_b16 v[68:69], v4 offset:28672
    v_mfma_f32_16x16x32_bf16 v[228:231], v[76:79], v[36:39], v[228:231]
    ds_read_b64_tr_b16 v[70:71], v4 offset:29184
    v_mfma_f32_16x16x32_bf16 v[232:235], v[80:83], v[24:27], v[232:235]
    ds_read_b64_tr_b16 v[72:73], v5 offset:20480
    v_mfma_f32_16x16x32_bf16 v[236:239], v[80:83], v[28:31], v[236:239]
    v_mfma_f32_16x16x32_bf16 v[240:243], v[80:83], v[32:35], v[240:243]
    ds_read_b64_tr_b16 v[74:75], v5 offset:20992
    v_mfma_f32_16x16x32_bf16 v[244:247], v[80:83], v[36:39], v[244:247]
    s_waitcnt lgkmcnt(7)
    v_mfma_f32_16x16x32_bf16 v[88:91], v[64:67], v[40:43], v[88:91]
    ds_read_b64_tr_b16 v[76:77], v5 offset:28672
    s_waitcnt lgkmcnt(7)
    v_mfma_f32_16x16x32_bf16 v[92:95], v[64:67], v[44:47], v[92:95]
    ds_read_b64_tr_b16 v[78:79], v5 offset:29184
    s_waitcnt lgkmcnt(7)
    v_mfma_f32_16x16x32_bf16 v[96:99], v[64:67], v[48:51], v[96:99]
    ds_read_b64_tr_b16 v[80:81], v6 offset:20480
    s_waitcnt lgkmcnt(7)
    v_mfma_f32_16x16x32_bf16 v[100:103], v[64:67], v[52:55], v[100:103]
    ds_read_b64_tr_b16 v[82:83], v6 offset:20992
    s_waitcnt lgkmcnt(6)
    v_mfma_f32_16x16x32_bf16 v[104:107], v[68:71], v[40:43], v[104:107]
    ds_read_b64_tr_b16 v[64:65], v6 offset:28672
    v_mfma_f32_16x16x32_bf16 v[108:111], v[68:71], v[44:47], v[108:111]
    v_add_u32 v14, s80, v16
    v_mfma_f32_16x16x32_bf16 v[112:115], v[68:71], v[48:51], v[112:115]
    ds_read_b64_tr_b16 v[66:67], v6 offset:29184
    v_mfma_f32_16x16x32_bf16 v[116:119], v[68:71], v[52:55], v[116:119]
    v_add_u32 v15, s80, v17
    s_waitcnt lgkmcnt(6)
    v_mfma_f32_16x16x32_bf16 v[120:123], v[72:75], v[40:43], v[120:123]
    ds_read_b64_tr_b16 v[68:69], v7 offset:20480
    v_mfma_f32_16x16x32_bf16 v[124:127], v[72:75], v[44:47], v[124:127]
    s_add_u32 s80, s80, 18432
    v_mfma_f32_16x16x32_bf16 v[128:131], v[72:75], v[48:51], v[128:131]
    ds_read_b64_tr_b16 v[70:71], v7 offset:20992
    v_mfma_f32_16x16x32_bf16 v[132:135], v[72:75], v[52:55], v[132:135]
    s_cmp_ge_u32 s80, 153600
    s_cselect_b32 s84, 55296, 0
    s_waitcnt lgkmcnt(6)
    v_mfma_f32_16x16x32_bf16 v[136:139], v[76:79], v[40:43], v[136:139]
    ds_read_b64_tr_b16 v[72:73], v7 offset:28672
    v_mfma_f32_16x16x32_bf16 v[140:143], v[76:79], v[44:47], v[140:143]
    s_sub_u32 s80, s80, s84
    v_mfma_f32_16x16x32_bf16 v[144:147], v[76:79], v[48:51], v[144:147]
    ds_read_b64_tr_b16 v[74:75], v7 offset:29184
    v_mfma_f32_16x16x32_bf16 v[148:151], v[76:79], v[52:55], v[148:151]
    s_waitcnt lgkmcnt(6)
    v_mfma_f32_16x16x32_bf16 v[152:155], v[80:83], v[40:43], v[152:155]
    ds_read_b64_tr_b16 v[76:77], v8 offset:36864
    v_mfma_f32_16x16x32_bf16 v[156:159], v[80:83], v[44:47], v[156:159]
    v_mfma_f32_16x16x32_bf16 v[160:163], v[80:83], v[48:51], v[160:163]
    ds_read_b64_tr_b16 v[78:79], v8 offset:37120
    v_mfma_f32_16x16x32_bf16 v[164:167], v[80:83], v[52:55], v[164:167]
    s_waitcnt lgkmcnt(6)
    v_mfma_f32_16x16x32_bf16 v[168:171], v[64:67], v[40:43], v[168:171]
    ds_read_b64_tr_b16 v[80:81], v8 offset:38912
    v_mfma_f32_16x16x32_bf16 v[172:175], v[64:67], v[44:47], v[172:175]
    v_mfma_f32_16x16x32_bf16 v[176:179], v[64:67], v[48:51], v[176:179]
    ds_read_b64_tr_b16 v[82:83], v8 offset:39168
    v_mfma_f32_16x16x32_bf16 v[180:183], v[64:67], v[52:55], v[180:183]
    s_waitcnt lgkmcnt(6)
    v_mfma_f32_16x16x32_bf16 v[184:187], v[68:71], v[40:43], v[184:187]
    v_mfma_f32_16x16x32_bf16 v[188:191], v[68:71], v[44:47], v[188:191]
    v_mfma_f32_16x16x32_bf16 v[192:195], v[68:71], v[48:51], v[192:195]
    v_mfma_f32_16x16x32_bf16 v[196:199], v[68:71], v[52:55], v[196:199]
    s_waitcnt lgkmcnt(0)
    s_barrier
    v_mfma_f32_16x16x32_bf16 v[200:203], v[72:75], v[40:43], v[200:203]
    ds_read_b64_tr_b16 v[64:65], v9 offset:0
    v_mfma_f32_16x16x32_bf16 v[204:207], v[72:75], v[44:47], v[204:207]
    ds_read_b64_tr_b16 v[66:67], v9 offset:512
    v_mfma_f32_16x16x32_bf16 v[208:211], v[72:75], v[48:51], v[208:211]
    ds_read_b128 v[24:27], v14 offset:0
    v_mfma_f32_16x16x32_bf16 v[212:215], v[72:75], v[52:55], v[212:215]
    ds_read_b128 v[28:31], v14 offset:2048
    v_mfma_f32_16x16x32_bf16 v[216:219], v[76:79], v[40:43], v[216:219]
    ds_read_b128 v[32:35], v14 offset:4096
    v_mfma_f32_16x16x32_bf16 v[220:223], v[76:79], v[44:47], v[220:223]
    ds_read_b128 v[36:39], v14 offset:6144
    v_mfma_f32_16x16x32_bf16 v[224:227], v[76:79], v[48:51], v[224:227]
    ds_read_b64_tr_b16 v[68:69], v9 offset:8192
    v_mfma_f32_16x16x32_bf16 v[228:231], v[76:79], v[52:55], v[228:231]
    ds_read_b64_tr_b16 v[70:71], v9 offset:8704
    v_mfma_f32_16x16x32_bf16 v[232:235], v[80:83], v[40:43], v[232:235]
    ds_read_b64_tr_b16 v[72:73], v10 offset:0
    v_mfma_f32_16x16x32_bf16 v[236:239], v[80:83], v[44:47], v[236:239]
    v_mfma_f32_16x16x32_bf16 v[240:243], v[80:83], v[48:51], v[240:243]
    ds_read_b64_tr_b16 v[74:75], v10 offset:512
    v_mfma_f32_16x16x32_bf16 v[244:247], v[80:83], v[52:55], v[244:247]
    s_waitcnt lgkmcnt(7)
    v_mfma_f32_16x16x32_bf16 v[88:91], v[64:67], v[24:27], v[88:91]
    ds_read_b64_tr_b16 v[76:77], v10 offset:8192
    s_waitcnt lgkmcnt(7)
    v_mfma_f32_16x16x32_bf16 v[92:95], v[64:67], v[28:31], v[92:95]
    ds_read_b64_tr_b16 v[78:79], v10 offset:8704
    s_waitcnt lgkmcnt(7)
    v_mfma_f32_16x16x32_bf16 v[96:99], v[64:67], v[32:35], v[96:99]
    ds_read_b64_tr_b16 v[80:81], v11 offset:0
    s_waitcnt lgkmcnt(7)
    v_mfma_f32_16x16x32_bf16 v[100:103], v[64:67], v[36:39], v[100:103]
    ds_read_b64_tr_b16 v[82:83], v11 offset:512
    s_waitcnt lgkmcnt(6)
    v_mfma_f32_16x16x32_bf16 v[104:107], v[68:71], v[24:27], v[104:107]
    ds_read_b64_tr_b16 v[64:65], v11 offset:8192
    v_mfma_f32_16x16x32_bf16 v[108:111], v[68:71], v[28:31], v[108:111]
    v_mfma_f32_16x16x32_bf16 v[112:115], v[68:71], v[32:35], v[112:115]
    ds_read_b64_tr_b16 v[66:67], v11 offset:8704
    v_mfma_f32_16x16x32_bf16 v[116:119], v[68:71], v[36:39], v[116:119]
    s_waitcnt lgkmcnt(6)
    v_mfma_f32_16x16x32_bf16 v[120:123], v[72:75], v[24:27], v[120:123]
    ds_read_b64_tr_b16 v[68:69], v12 offset:0
    v_mfma_f32_16x16x32_bf16 v[124:127], v[72:75], v[28:31], v[124:127]
    v_mfma_f32_16x16x32_bf16 v[128:131], v[72:75], v[32:35], v[128:131]
    ds_read_b64_tr_b16 v[70:71], v12 offset:512
    v_mfma_f32_16x16x32_bf16 v[132:135], v[72:75], v[36:39], v[132:135]
    s_waitcnt lgkmcnt(6)
    v_mfma_f32_16x16x32_bf16 v[136:139], v[76:79], v[24:27], v[136:139]
    ds_read_b64_tr_b16 v[72:73], v12 offset:8192
    v_mfma_f32_16x16x32_bf16 v[140:143], v[76:79], v[28:31], v[140:143]
    v_mfma_f32_16x16x32_bf16 v[144:147], v[76:79], v[32:35], v[144:147]
    ds_read_b64_tr_b16 v[74:75], v12 offset:8704
    v_mfma_f32_16x16x32_bf16 v[148:151], v[76:79], v[36:39], v[148:151]
    s_waitcnt lgkmcnt(6)
    v_mfma_f32_16x16x32_bf16 v[152:155], v[80:83], v[24:27], v[152:155]
    ds_read_b64_tr_b16 v[76:77], v13 offset:16384
    v_mfma_f32_16x16x32_bf16 v[156:159], v[80:83], v[28:31], v[156:159]
    v_mfma_f32_16x16x32_bf16 v[160:163], v[80:83], v[32:35], v[160:163]
    ds_read_b64_tr_b16 v[78:79], v13 offset:16640
    v_mfma_f32_16x16x32_bf16 v[164:167], v[80:83], v[36:39], v[164:167]
    s_waitcnt lgkmcnt(6)
    v_mfma_f32_16x16x32_bf16 v[168:171], v[64:67], v[24:27], v[168:171]
    ds_read_b64_tr_b16 v[80:81], v13 offset:18432
    v_mfma_f32_16x16x32_bf16 v[172:175], v[64:67], v[28:31], v[172:175]
    v_mfma_f32_16x16x32_bf16 v[176:179], v[64:67], v[32:35], v[176:179]
    ds_read_b64_tr_b16 v[82:83], v13 offset:18688
    v_mfma_f32_16x16x32_bf16 v[180:183], v[64:67], v[36:39], v[180:183]
    s_waitcnt lgkmcnt(6)
    v_mfma_f32_16x16x32_bf16 v[184:187], v[68:71], v[24:27], v[184:187]
    v_mfma_f32_16x16x32_bf16 v[188:191], v[68:71], v[28:31], v[188:191]
    v_mfma_f32_16x16x32_bf16 v[192:195], v[68:71], v[32:35], v[192:195]
    v_mfma_f32_16x16x32_bf16 v[196:199], v[68:71], v[36:39], v[196:199]
    s_waitcnt lgkmcnt(0)
    s_barrier
    v_mfma_f32_16x16x32_bf16 v[200:203], v[72:75], v[24:27], v[200:203]
    ds_read_b64_tr_b16 v[64:65], v9 offset:20480
    v_mfma_f32_16x16x32_bf16 v[204:207], v[72:75], v[28:31], v[204:207]
    ds_read_b64_tr_b16 v[66:67], v9 offset:20992
    v_mfma_f32_16x16x32_bf16 v[208:211], v[72:75], v[32:35], v[208:211]
    ds_read_b128 v[40:43], v15 offset:0
    v_mfma_f32_16x16x32_bf16 v[212:215], v[72:75], v[36:39], v[212:215]
    ds_read_b128 v[44:47], v15 offset:2048
    v_mfma_f32_16x16x32_bf16 v[216:219], v[76:79], v[24:27], v[216:219]
    ds_read_b128 v[48:51], v15 offset:4096
    v_mfma_f32_16x16x32_bf16 v[220:223], v[76:79], v[28:31], v[220:223]
    ds_read_b128 v[52:55], v15 offset:6144
    v_mfma_f32_16x16x32_bf16 v[224:227], v[76:79], v[32:35], v[224:227]
    ds_read_b64_tr_b16 v[68:69], v9 offset:28672
    v_mfma_f32_16x16x32_bf16 v[228:231], v[76:79], v[36:39], v[228:231]
    ds_read_b64_tr_b16 v[70:71], v9 offset:29184
    v_mfma_f32_16x16x32_bf16 v[232:235], v[80:83], v[24:27], v[232:235]
    ds_read_b64_tr_b16 v[72:73], v10 offset:20480
    v_mfma_f32_16x16x32_bf16 v[236:239], v[80:83], v[28:31], v[236:239]
    v_mfma_f32_16x16x32_bf16 v[240:243], v[80:83], v[32:35], v[240:243]
    ds_read_b64_tr_b16 v[74:75], v10 offset:20992
    v_mfma_f32_16x16x32_bf16 v[244:247], v[80:83], v[36:39], v[244:247]
    s_waitcnt lgkmcnt(7)
    v_mfma_f32_16x16x32_bf16 v[88:91], v[64:67], v[40:43], v[88:91]
    ds_read_b64_tr_b16 v[76:77], v10 offset:28672
    s_waitcnt lgkmcnt(7)
    v_mfma_f32_16x16x32_bf16 v[92:95], v[64:67], v[44:47], v[92:95]
    ds_read_b64_tr_b16 v[78:79], v10 offset:29184
    s_waitcnt lgkmcnt(7)
    v_mfma_f32_16x16x32_bf16 v[96:99], v[64:67], v[48:51], v[96:99]
    ds_read_b64_tr_b16 v[80:81], v11 offset:20480
    s_waitcnt lgkmcnt(7)
    v_mfma_f32_16x16x32_bf16 v[100:103], v[64:67], v[52:55], v[100:103]
    ds_read_b64_tr_b16 v[82:83], v11 offset:20992
    s_waitcnt lgkmcnt(6)
    v_mfma_f32_16x16x32_bf16 v[104:107], v[68:71], v[40:43], v[104:107]
    ds_read_b64_tr_b16 v[64:65], v11 offset:28672
    v_mfma_f32_16x16x32_bf16 v[108:111], v[68:71], v[44:47], v[108:111]
    v_add_u32 v14, s80, v16
    v_mfma_f32_16x16x32_bf16 v[112:115], v[68:71], v[48:51], v[112:115]
    ds_read_b64_tr_b16 v[66:67], v11 offset:29184
    v_mfma_f32_16x16x32_bf16 v[116:119], v[68:71], v[52:55], v[116:119]
    v_add_u32 v15, s80, v17
    s_waitcnt lgkmcnt(6)
    v_mfma_f32_16x16x32_bf16 v[120:123], v[72:75], v[40:43], v[120:123]
    ds_read_b64_tr_b16 v[68:69], v12 offset:20480
    v_mfma_f32_16x16x32_bf16 v[124:127], v[72:75], v[44:47], v[124:127]
    s_add_u32 s80, s80, 18432
    v_mfma_f32_16x16x32_bf16 v[128:131], v[72:75], v[48:51], v[128:131]
    ds_read_b64_tr_b16 v[70:71], v12 offset:20992
    v_mfma_f32_16x16x32_bf16 v[132:135], v[72:75], v[52:55], v[132:135]
    s_cmp_ge_u32 s80, 153600
    s_cselect_b32 s84, 55296, 0
    s_waitcnt lgkmcnt(6)
    v_mfma_f32_16x16x32_bf16 v[136:139], v[76:79], v[40:43], v[136:139]
    ds_read_b64_tr_b16 v[72:73], v12 offset:28672
    v_mfma_f32_16x16x32_bf16 v[140:143], v[76:79], v[44:47], v[140:143]
    s_sub_u32 s80, s80, s84
    v_mfma_f32_16x16x32_bf16 v[144:147], v[76:79], v[48:51], v[144:147]
    ds_read_b64_tr_b16 v[74:75], v12 offset:29184
    v_mfma_f32_16x16x32_bf16 v[148:151], v[76:79], v[52:55], v[148:151]
    s_waitcnt lgkmcnt(6)
    v_mfma_f32_16x16x32_bf16 v[152:155], v[80:83], v[40:43], v[152:155]
    ds_read_b64_tr_b16 v[76:77], v13 offset:36864
    v_mfma_f32_16x16x32_bf16 v[156:159], v[80:83], v[44:47], v[156:159]
    v_mfma_f32_16x16x32_bf16 v[160:163], v[80:83], v[48:51], v[160:163]
    ds_read_b64_tr_b16 v[78:79], v13 offset:37120
    v_mfma_f32_16x16x32_bf16 v[164:167], v[80:83], v[52:55], v[164:167]
    s_waitcnt lgkmcnt(6)
    v_mfma_f32_16x16x32_bf16 v[168:171], v[64:67], v[40:43], v[168:171]
    ds_read_b64_tr_b16 v[80:81], v13 offset:38912
    v_mfma_f32_16x16x32_bf16 v[172:175], v[64:67], v[44:47], v[172:175]
    v_mfma_f32_16x16x32_bf16 v[176:179], v[64:67], v[48:51], v[176:179]
    ds_read_b64_tr_b16 v[82:83], v13 offset:39168
    v_mfma_f32_16x16x32_bf16 v[180:183], v[64:67], v[52:55], v[180:183]
    s_waitcnt lgkmcnt(6)
    v_mfma_f32_16x16x32_bf16 v[184:187], v[68:71], v[40:43], v[184:187]
    v_mfma_f32_16x16x32_bf16 v[188:191], v[68:71], v[44:47], v[188:191]
    v_mfma_f32_16x16x32_bf16 v[192:195], v[68:71], v[48:51], v[192:195]
    v_mfma_f32_16x16x32_bf16 v[196:199], v[68:71], v[52:55], v[196:199]
    s_waitcnt lgkmcnt(0)
    s_barrier
    v_mfma_f32_16x16x32_bf16 v[200:203], v[72:75], v[40:43], v[200:203]
    ds_read_b64_tr_b16 v[64:65], v4 offset:0
    v_mfma_f32_16x16x32_bf16 v[204:207], v[72:75], v[44:47], v[204:207]
    ds_read_b64_tr_b16 v[66:67], v4 offset:512
    v_mfma_f32_16x16x32_bf16 v[208:211], v[72:75], v[48:51], v[208:211]
    ds_read_b128 v[24:27], v14 offset:0
    v_mfma_f32_16x16x32_bf16 v[212:215], v[72:75], v[52:55], v[212:215]
    ds_read_b128 v[28:31], v14 offset:2048
    v_mfma_f32_16x16x32_bf16 v[216:219], v[76:79], v[40:43], v[216:219]
    ds_read_b128 v[32:35], v14 offset:4096
    v_mfma_f32_16x16x32_bf16 v[220:223], v[76:79], v[44:47], v[220:223]
    ds_read_b128 v[36:39], v14 offset:6144
    v_mfma_f32_16x16x32_bf16 v[224:227], v[76:79], v[48:51], v[224:227]
    ds_read_b64_tr_b16 v[68:69], v4 offset:8192
    v_mfma_f32_16x16x32_bf16 v[228:231], v[76:79], v[52:55], v[228:231]
    ds_read_b64_tr_b16 v[70:71], v4 offset:8704
    v_mfma_f32_16x16x32_bf16 v[232:235], v[80:83], v[40:43], v[232:235]
    ds_read_b64_tr_b16 v[72:73], v5 offset:0
    v_mfma_f32_16x16x32_bf16 v[236:239], v[80:83], v[44:47], v[236:239]
    v_mfma_f32_16x16x32_bf16 v[240:243], v[80:83], v[48:51], v[240:243]
    ds_read_b64_tr_b16 v[74:75], v5 offset:512
    v_mfma_f32_16x16x32_bf16 v[244:247], v[80:83], v[52:55], v[244:247]
    s_sub_u32 s34, s34, 1
    s_cmp_lg_u32 s34, 0
    s_cbranch_scc1 L_p1
    s_waitcnt lgkmcnt(7)
    v_mfma_f32_16x16x32_bf16 v[88:91], v[64:67], v[24:27], v[88:91]
    ds_read_b64_tr_b16 v[76:77], v5 offset:8192
    s_waitcnt lgkmcnt(7)
    v_mfma_f32_16x16x32_bf16 v[92:95], v[64:67], v[28:31], v[92:95]
    ds_read_b64_tr_b16 v[78:79], v5 offset:8704
    s_waitcnt lgkmcnt(7)
    v_mfma_f32_16x16x32_bf16 v[96:99], v[64:67], v[32:35], v[96:99]
    ds_read_b64_tr_b16 v[80:81], v6 offset:0
    s_waitcnt lgkmcnt(7)
    v_mfma_f32_16x16x32_bf16 v[100:103], v[64:67], v[36:39], v[100:103]
    ds_read_b64_tr_b16 v[82:83], v6 offset:512
    s_waitcnt lgkmcnt(6)
    v_mfma_f32_16x16x32_bf16 v[104:107], v[68:71], v[24:27], v[104:107]
    ds_read_b64_tr_b16 v[64:65], v6 offset:8192
    v_mfma_f32_16x16x32_bf16 v[108:111], v[68:71], v[28:31], v[108:111]
    v_mfma_f32_16x16x32_bf16 v[112:115], v[68:71], v[32:35], v[112:115]
    ds_read_b64_tr_b16 v[66:67], v6 offset:8704
    v_mfma_f32_16x16x32_bf16 v[116:119], v[68:71], v[36:39], v[116:119]
    s_waitcnt lgkmcnt(6)
    v_mfma_f32_16x16x32_bf16 v[120:123], v[72:75], v[24:27], v[120:123]
    ds_read_b64_tr_b16 v[68:69], v7 offset:0
    v_mfma_f32_16x16x32_bf16 v[124:127], v[72:75], v[28:31], v[124:127]
    v_mfma_f32_16x16x32_bf16 v[128:131], v[72:75], v[32:35], v[128:131]
    ds_read_b64_tr_b16 v[70:71], v7 offset:512
    v_mfma_f32_16x16x32_bf16 v[132:135], v[72:75], v[36:39], v[132:135]
    s_waitcnt lgkmcnt(6)
    v_mfma_f32_16x16x32_bf16 v[136:139], v[76:79], v[24:27], v[136:139]
    ds_read_b64_tr_b16 v[72:73], v7 offset:8192
    v_mfma_f32_16x16x32_bf16 v[140:143], v[76:79], v[28:31], v[140:143]
    v_mfma_f32_16x16x32_bf16 v[144:147], v[76:79], v[32:35], v[144:147]
    ds_read_b64_tr_b16 v[74:75], v7 offset:8704
    v_mfma_f32_16x16x32_bf16 v[148:151], v[76:79], v[36:39], v[148:151]
    s_waitcnt lgkmcnt(6)
    v_mfma_f32_16x16x32_bf16 v[152:155], v[80:83], v[24:27], v[152:155]
    ds_read_b64_tr_b16 v[76:77], v8 offset:16384
    v_mfma_f32_16x16x32_bf16 v[156:159], v[80:83], v[28:31], v[156:159]
    v_mfma_f32_16x16x32_bf16 v[160:163], v[80:83], v[32:35], v[160:163]
    ds_read_b64_tr_b16 v[78:79], v8 offset:16640
    v_mfma_f32_16x16x32_bf16 v[164:167], v[80:83], v[36:39], v[164:167]
    s_waitcnt lgkmcnt(6)
    v_mfma_f32_16x16x32_bf16 v[168:171], v[64:67], v[24:27], v[168:171]
    ds_read_b64_tr_b16 v[80:81], v8 offset:18432
    v_mfma_f32_16x16x32_bf16 v[172:175], v[64:67], v[28:31], v[172:175]
    v_mfma_f32_16x16x32_bf16 v[176:179], v[64:67], v[32:35], v[176:179]
    ds_read_b64_tr_b16 v[82:83], v8 offset:18688
    v_mfma_f32_16x16x32_bf16 v[180:183], v[64:67], v[36:39], v[180:183]
    s_waitcnt lgkmcnt(6)
    v_mfma_f32_16x16x32_bf16 v[184:187], v[68:71], v[24:27], v[184:187]
    v_mfma_f32_16x16x32_bf16 v[188:191], v[68:71], v[28:31], v[188:191]
    v_mfma_f32_16x16x32_bf16 v[192:195], v[68:71], v[32:35], v[192:195]
    v_mfma_f32_16x16x32_bf16 v[196:199], v[68:71], v[36:39], v[196:199]
    s_waitcnt lgkmcnt(0)
    s_barrier
    v_mfma_f32_16x16x32_bf16 v[200:203], v[72:75], v[24:27], v[200:203]
    ds_read_b64_tr_b16 v[64:65], v4 offset:20480
    v_mfma_f32_16x16x32_bf16 v[204:207], v[72:75], v[28:31], v[204:207]
    ds_read_b64_tr_b16 v[66:67], v4 offset:20992
    v_mfma_f32_16x16x32_bf16 v[208:211], v[72:75], v[32:35], v[208:211]
    ds_read_b128 v[40:43], v15 offset:0
    v_mfma_f32_16x16x32_bf16 v[212:215], v[72:75], v[36:39], v[212:215]
    ds_read_b128 v[44:47], v15 offset:2048
    v_mfma_f32_16x16x32_bf16 v[216:219], v[76:79], v[24:27], v[216:219]
    ds_read_b128 v[48:51], v15 offset:4096
    v_mfma_f32_16x16x32_bf16 v[220:223], v[76:79], v[28:31], v[220:223]
    ds_read_b128 v[52:55], v15 offset:6144
    v_mfma_f32_16x16x32_bf16 v[224:227], v[76:79], v[32:35], v[224:227]
    ds_read_b64_tr_b16 v[68:69], v4 offset:28672
    v_mfma_f32_16x16x32_bf16 v[228:231], v[76:79], v[36:39], v[228:231]
    ds_read_b64_tr_b16 v[70:71], v4 offset:29184
    v_mfma_f32_16x16x32_bf16 v[232:235], v[80:83], v[24:27], v[232:235]
    ds_read_b64_tr_b16 v[72:73], v5 offset:20480
    v_mfma_f32_16x16x32_bf16 v[236:239], v[80:83], v[28:31], v[236:239]
    v_mfma_f32_16x16x32_bf16 v[240:243], v[80:83], v[32:35], v[240:243]
    ds_read_b64_tr_b16 v[74:75], v5 offset:20992
    v_mfma_f32_16x16x32_bf16 v[244:247], v[80:83], v[36:39], v[244:247]
    s_waitcnt lgkmcnt(7)
    v_mfma_f32_16x16x32_bf16 v[88:91], v[64:67], v[40:43], v[88:91]
    ds_read_b64_tr_b16 v[76:77], v5 offset:28672
    s_waitcnt lgkmcnt(7)
    v_mfma_f32_16x16x32_bf16 v[92:95], v[64:67], v[44:47], v[92:95]
    ds_read_b64_tr_b16 v[78:79], v5 offset:29184
    s_waitcnt lgkmcnt(7)
    v_mfma_f32_16x16x32_bf16 v[96:99], v[64:67], v[48:51], v[96:99]
    ds_read_b64_tr_b16 v[80:81], v6 offset:20480
    s_waitcnt lgkmcnt(7)
    v_mfma_f32_16x16x32_bf16 v[100:103], v[64:67], v[52:55], v[100:103]
    ds_read_b64_tr_b16 v[82:83], v6 offset:20992
    s_waitcnt lgkmcnt(6)
    v_mfma_f32_16x16x32_bf16 v[104:107], v[68:71], v[40:43], v[104:107]
    ds_read_b64_tr_b16 v[64:65], v6 offset:28672
    v_mfma_f32_16x16x32_bf16 v[108:111], v[68:71], v[44:47], v[108:111]
    v_add_u32 v14, s80, v16
    v_mfma_f32_16x16x32_bf16 v[112:115], v[68:71], v[48:51], v[112:115]
    ds_read_b64_tr_b16 v[66:67], v6 offset:29184
    v_mfma_f32_16x16x32_bf16 v[116:119], v[68:71], v[52:55], v[116:119]
    v_add_u32 v15, s80, v17
    s_waitcnt lgkmcnt(6)
    v_mfma_f32_16x16x32_bf16 v[120:123], v[72:75], v[40:43], v[120:123]
    ds_read_b64_tr_b16 v[68:69], v7 offset:20480
    v_mfma_f32_16x16x32_bf16 v[124:127], v[72:75], v[44:47], v[124:127]
    s_add_u32 s80, s80, 18432
    v_mfma_f32_16x16x32_bf16 v[128:131], v[72:75], v[48:51], v[128:131]
    ds_read_b64_tr_b16 v[70:71], v7 offset:20992
    v_mfma_f32_16x16x32_bf16 v[132:135], v[72:75], v[52:55], v[132:135]
    s_cmp_ge_u32 s80, 153600
    s_cselect_b32 s84, 55296, 0
    s_waitcnt lgkmcnt(6)
    v_mfma_f32_16x16x32_bf16 v[136:139], v[76:79], v[40:43], v[136:139]
    ds_read_b64_tr_b16 v[72:73], v7 offset:28672
    v_mfma_f32_16x16x32_bf16 v[140:143], v[76:79], v[44:47], v[140:143]
    s_sub_u32 s80, s80, s84
    v_mfma_f32_16x16x32_bf16 v[144:147], v[76:79], v[48:51], v[144:147]
    ds_read_b64_tr_b16 v[74:75], v7 offset:29184
    v_mfma_f32_16x16x32_bf16 v[148:151], v[76:79], v[52:55], v[148:151]
    s_waitcnt lgkmcnt(6)
    v_mfma_f32_16x16x32_bf16 v[152:155], v[80:83], v[40:43], v[152:155]
    ds_read_b64_tr_b16 v[76:77], v8 offset:36864
    v_mfma_f32_16x16x32_bf16 v[156:159], v[80:83], v[44:47], v[156:159]
    v_mfma_f32_16x16x32_bf16 v[160:163], v[80:83], v[48:51], v[160:163]
    ds_read_b64_tr_b16 v[78:79], v8 offset:37120
    v_mfma_f32_16x16x32_bf16 v[164:167], v[80:83], v[52:55], v[164:167]
    s_waitcnt lgkmcnt(6)
    v_mfma_f32_16x16x32_bf16 v[168:171], v[64:67], v[40:43], v[168:171]
    ds_read_b64_tr_b16 v[80:81], v8 offset:38912
    v_mfma_f32_16x16x32_bf16 v[172:175], v[64:67], v[44:47], v[172:175]
    v_mfma_f32_16x16x32_bf16 v[176:179], v[64:67], v[48:51], v[176:179]
    ds_read_b64_tr_b16 v[82:83], v8 offset:39168
    v_mfma_f32_16x16x32_bf16 v[180:183], v[64:67], v[52:55], v[180:183]
    s_waitcnt lgkmcnt(6)
    v_mfma_f32_16x16x32_bf16 v[184:187], v[68:71], v[40:43], v[184:187]
    v_mfma_f32_16x16x32_bf16 v[188:191], v[68:71], v[44:47], v[188:191]
    v_mfma_f32_16x16x32_bf16 v[192:195], v[68:71], v[48:51], v[192:195]
    v_mfma_f32_16x16x32_bf16 v[196:199], v[68:71], v[52:55], v[196:199]
    s_waitcnt lgkmcnt(0)
    s_barrier
    v_mfma_f32_16x16x32_bf16 v[200:203], v[72:75], v[40:43], v[200:203]
    ds_read_b64_tr_b16 v[64:65], v9 offset:0
    v_mfma_f32_16x16x32_bf16 v[204:207], v[72:75], v[44:47], v[204:207]
    ds_read_b64_tr_b16 v[66:67], v9 offset:512
    v_mfma_f32_16x16x32_bf16 v[208:211], v[72:75], v[48:51], v[208:211]
    ds_read_b128 v[24:27], v14 offset:0
    v_mfma_f32_16x16x32_bf16 v[212:215], v[72:75], v[52:55], v[212:215]
    ds_read_b128 v[28:31], v14 offset:2048
    v_mfma_f32_16x16x32_bf16 v[216:219], v[76:79], v[40:43], v[216:219]
    ds_read_b128 v[32:35], v14 offset:4096
    v_mfma_f32_16x16x32_bf16 v[220:223], v[76:79], v[44:47], v[220:223]
    ds_read_b128 v[36:39], v14 offset:6144
    v_mfma_f32_16x16x32_bf16 v[224:227], v[76:79], v[48:51], v[224:227]
    ds_read_b64_tr_b16 v[68:69], v9 offset:8192
    v_mfma_f32_16x16x32_bf16 v[228:231], v[76:79], v[52:55], v[228:231]
    ds_read_b64_tr_b16 v[70:71], v9 offset:8704
    v_mfma_f32_16x16x32_bf16 v[232:235], v[80:83], v[40:43], v[232:235]
    ds_read_b64_tr_b16 v[72:73], v10 offset:0
    v_mfma_f32_16x16x32_bf16 v[236:239], v[80:83], v[44:47], v[236:239]
    v_mfma_f32_16x16x32_bf16 v[240:243], v[80:83], v[48:51], v[240:243]
    ds_read_b64_tr_b16 v[74:75], v10 offset:512
    v_mfma_f32_16x16x32_bf16 v[244:247], v[80:83], v[52:55], v[244:247]
    s_waitcnt lgkmcnt(7)
    v_mfma_f32_16x16x32_bf16 v[88:91], v[64:67], v[24:27], v[88:91]
    ds_read_b64_tr_b16 v[76:77], v10 offset:8192
    s_waitcnt lgkmcnt(7)
    v_mfma_f32_16x16x32_bf16 v[92:95], v[64:67], v[28:31], v[92:95]
    ds_read_b64_tr_b16 v[78:79], v10 offset:8704
    s_waitcnt lgkmcnt(7)
    v_mfma_f32_16x16x32_bf16 v[96:99], v[64:67], v[32:35], v[96:99]
    ds_read_b64_tr_b16 v[80:81], v11 offset:0
    s_waitcnt lgkmcnt(7)
    v_mfma_f32_16x16x32_bf16 v[100:103], v[64:67], v[36:39], v[100:103]
    ds_read_b64_tr_b16 v[82:83], v11 offset:512
    s_waitcnt lgkmcnt(6)
    v_mfma_f32_16x16x32_bf16 v[104:107], v[68:71], v[24:27], v[104:107]
    ds_read_b64_tr_b16 v[64:65], v11 offset:8192
    v_mfma_f32_16x16x32_bf16 v[108:111], v[68:71], v[28:31], v[108:111]
    v_mfma_f32_16x16x32_bf16 v[112:115], v[68:71], v[32:35], v[112:115]
    ds_read_b64_tr_b16 v[66:67], v11 offset:8704
    v_mfma_f32_16x16x32_bf16 v[116:119], v[68:71], v[36:39], v[116:119]
    s_waitcnt lgkmcnt(6)
    v_mfma_f32_16x16x32_bf16 v[120:123], v[72:75], v[24:27], v[120:123]
    ds_read_b64_tr_b16 v[68:69], v12 offset:0
    v_mfma_f32_16x16x32_bf16 v[124:127], v[72:75], v[28:31], v[124:127]
    v_mfma_f32_16x16x32_bf16 v[128:131], v[72:75], v[32:35], v[128:131]
    ds_read_b64_tr_b16 v[70:71], v12 offset:512
    v_mfma_f32_16x16x32_bf16 v[132:135], v[72:75], v[36:39], v[132:135]
    s_waitcnt lgkmcnt(6)
    v_mfma_f32_16x16x32_bf16 v[136:139], v[76:79], v[24:27], v[136:139]
    ds_read_b64_tr_b16 v[72:73], v12 offset:8192
    v_mfma_f32_16x16x32_bf16 v[140:143], v[76:79], v[28:31], v[140:143]
    v_mfma_f32_16x16x32_bf16 v[144:147], v[76:79], v[32:35], v[144:147]
    ds_read_b64_tr_b16 v[74:75], v12 offset:8704
    v_mfma_f32_16x16x32_bf16 v[148:151], v[76:79], v[36:39], v[148:151]
    s_waitcnt lgkmcnt(6)
    v_mfma_f32_16x16x32_bf16 v[152:155], v[80:83], v[24:27], v[152:155]
    ds_read_b64_tr_b16 v[76:77], v13 offset:16384
    v_mfma_f32_16x16x32_bf16 v[156:159], v[80:83], v[28:31], v[156:159]
    v_mfma_f32_16x16x32_bf16 v[160:163], v[80:83], v[32:35], v[160:163]
    ds_read_b64_tr_b16 v[78:79], v13 offset:16640
    v_mfma_f32_16x16x32_bf16 v[164:167], v[80:83], v[36:39], v[164:167]
    s_waitcnt lgkmcnt(6)
    v_mfma_f32_16x16x32_bf16 v[168:171], v[64:67], v[24:27], v[168:171]
    ds_read_b64_tr_b16 v[80:81], v13 offset:18432
    v_mfma_f32_16x16x32_bf16 v[172:175], v[64:67], v[28:31], v[172:175]
    v_mfma_f32_16x16x32_bf16 v[176:179], v[64:67], v[32:35], v[176:179]
    ds_read_b64_tr_b16 v[82:83], v13 offset:18688
    v_mfma_f32_16x16x32_bf16 v[180:183], v[64:67], v[36:39], v[180:183]
    s_waitcnt lgkmcnt(6)
    v_mfma_f32_16x16x32_bf16 v[184:187], v[68:71], v[24:27], v[184:187]
    v_mfma_f32_16x16x32_bf16 v[188:191], v[68:71], v[28:31], v[188:191]
    v_mfma_f32_16x16x32_bf16 v[192:195], v[68:71], v[32:35], v[192:195]
    v_mfma_f32_16x16x32_bf16 v[196:199], v[68:71], v[36:39], v[196:199]
    s_waitcnt lgkmcnt(0)
    s_barrier
    v_mfma_f32_16x16x32_bf16 v[200:203], v[72:75], v[24:27], v[200:203]
    ds_read_b64_tr_b16 v[64:65], v9 offset:20480
    v_mfma_f32_16x16x32_bf16 v[204:207], v[72:75], v[28:31], v[204:207]
    ds_read_b64_tr_b16 v[66:67], v9 offset:20992
    v_mfma_f32_16x16x32_bf16 v[208:211], v[72:75], v[32:35], v[208:211]
    ds_read_b128 v[40:43], v15 offset:0
    v_mfma_f32_16x16x32_bf16 v[212:215], v[72:75], v[36:39], v[212:215]
    ds_read_b128 v[44:47], v15 offset:2048
    v_mfma_f32_16x16x32_bf16 v[216:219], v[76:79], v[24:27], v[216:219]
    ds_read_b128 v[48:51], v15 offset:4096
    v_mfma_f32_16x16x32_bf16 v[220:223], v[76:79], v[28:31], v[220:223]
    ds_read_b128 v[52:55], v15 offset:6144
    v_mfma_f32_16x16x32_bf16 v[224:227], v[76:79], v[32:35], v[224:227]
    ds_read_b64_tr_b16 v[68:69], v9 offset:28672
    v_mfma_f32_16x16x32_bf16 v[228:231], v[76:79], v[36:39], v[228:231]
    ds_read_b64_tr_b16 v[70:71], v9 offset:29184
    v_mfma_f32_16x16x32_bf16 v[232:235], v[80:83], v[24:27], v[232:235]
    ds_read_b64_tr_b16 v[72:73], v10 offset:20480
    v_mfma_f32_16x16x32_bf16 v[236:239], v[80:83], v[28:31], v[236:239]
    v_mfma_f32_16x16x32_bf16 v[240:243], v[80:83], v[32:35], v[240:243]
    ds_read_b64_tr_b16 v[74:75], v10 offset:20992
    v_mfma_f32_16x16x32_bf16 v[244:247], v[80:83], v[36:39], v[244:247]
    s_waitcnt lgkmcnt(7)
    v_mfma_f32_16x16x32_bf16 v[88:91], v[64:67], v[40:43], v[88:91]
    ds_read_b64_tr_b16 v[76:77], v10 offset:28672
    s_waitcnt lgkmcnt(7)
    v_mfma_f32_16x16x32_bf16 v[92:95], v[64:67], v[44:47], v[92:95]
    ds_read_b64_tr_b16 v[78:79], v10 offset:29184
    s_waitcnt lgkmcnt(7)
    v_mfma_f32_16x16x32_bf16 v[96:99], v[64:67], v[48:51], v[96:99]
    ds_read_b64_tr_b16 v[80:81], v11 offset:20480
    s_waitcnt lgkmcnt(7)
    v_mfma_f32_16x16x32_bf16 v[100:103], v[64:67], v[52:55], v[100:103]
    ds_read_b64_tr_b16 v[82:83], v11 offset:20992
    s_waitcnt lgkmcnt(6)
    v_mfma_f32_16x16x32_bf16 v[104:107], v[68:71], v[40:43], v[104:107]
    ds_read_b64_tr_b16 v[64:65], v11 offset:28672
    v_mfma_f32_16x16x32_bf16 v[108:111], v[68:71], v[44:47], v[108:111]
    v_mfma_f32_16x16x32_bf16 v[112:115], v[68:71], v[48:51], v[112:115]
    ds_read_b64_tr_b16 v[66:67], v11 offset:29184
    v_mfma_f32_16x16x32_bf16 v[116:119], v[68:71], v[52:55], v[116:119]
    s_waitcnt lgkmcnt(6)
    v_mfma_f32_16x16x32_bf16 v[120:123], v[72:75], v[40:43], v[120:123]
    ds_read_b64_tr_b16 v[68:69], v12 offset:20480
    v_mfma_f32_16x16x32_bf16 v[124:127], v[72:75], v[44:47], v[124:127]
    v_mfma_f32_16x16x32_bf16 v[128:131], v[72:75], v[48:51], v[128:131]
    ds_read_b64_tr_b16 v[70:71], v12 offset:20992
    v_mfma_f32_16x16x32_bf16 v[132:135], v[72:75], v[52:55], v[132:135]
    s_waitcnt lgkmcnt(6)
    v_mfma_f32_16x16x32_bf16 v[136:139], v[76:79], v[40:43], v[136:139]
    ds_read_b64_tr_b16 v[72:73], v12 offset:28672
    v_mfma_f32_16x16x32_bf16 v[140:143], v[76:79], v[44:47], v[140:143]
    v_mfma_f32_16x16x32_bf16 v[144:147], v[76:79], v[48:51], v[144:147]
    ds_read_b64_tr_b16 v[74:75], v12 offset:29184
    v_mfma_f32_16x16x32_bf16 v[148:151], v[76:79], v[52:55], v[148:151]
    s_waitcnt lgkmcnt(6)
    v_mfma_f32_16x16x32_bf16 v[152:155], v[80:83], v[40:43], v[152:155]
    ds_read_b64_tr_b16 v[76:77], v13 offset:36864
    v_mfma_f32_16x16x32_bf16 v[156:159], v[80:83], v[44:47], v[156:159]
    v_mfma_f32_16x16x32_bf16 v[160:163], v[80:83], v[48:51], v[160:163]
    ds_read_b64_tr_b16 v[78:79], v13 offset:37120
    v_mfma_f32_16x16x32_bf16 v[164:167], v[80:83], v[52:55], v[164:167]
    s_waitcnt lgkmcnt(6)
    v_mfma_f32_16x16x32_bf16 v[168:171], v[64:67], v[40:43], v[168:171]
    ds_read_b64_tr_b16 v[80:81], v13 offset:38912
    v_mfma_f32_16x16x32_bf16 v[172:175], v[64:67], v[44:47], v[172:175]
    v_mfma_f32_16x16x32_bf16 v[176:179], v[64:67], v[48:51], v[176:179]
    ds_read_b64_tr_b16 v[82:83], v13 offset:39168
    v_mfma_f32_16x16x32_bf16 v[180:183], v[64:67], v[52:55], v[180:183]
    s_waitcnt lgkmcnt(6)
    v_mfma_f32_16x16x32_bf16 v[184:187], v[68:71], v[40:43], v[184:187]
    v_mfma_f32_16x16x32_bf16 v[188:191], v[68:71], v[44:47], v[188:191]
    v_mfma_f32_16x16x32_bf16 v[192:195], v[68:71], v[48:51], v[192:195]
    v_mfma_f32_16x16x32_bf16 v[196:199], v[68:71], v[52:55], v[196:199]
    s_waitcnt lgkmcnt(0)
    s_barrier
    v_mfma_f32_16x16x32_bf16 v[200:203], v[72:75], v[40:43], v[200:203]
    v_mfma_f32_16x16x32_bf16 v[204:207], v[72:75], v[44:47], v[204:207]
    v_mfma_f32_16x16x32_bf16 v[208:211], v[72:75], v[48:51], v[208:211]
    v_mfma_f32_16x16x32_bf16 v[212:215], v[72:75], v[52:55], v[212:215]
    v_mfma_f32_16x16x32_bf16 v[216:219], v[76:79], v[40:43], v[216:219]
    v_mfma_f32_16x16x32_bf16 v[220:223], v[76:79], v[44:47], v[220:223]
    v_mfma_f32_16x16x32_bf16 v[224:227], v[76:79], v[48:51], v[224:227]
    v_mfma_f32_16x16x32_bf16 v[228:231], v[76:79], v[52:55], v[228:231]
    v_mfma_f32_16x16x32_bf16 v[232:235], v[80:83], v[40:43], v[232:235]
    v_mfma_f32_16x16x32_bf16 v[236:239], v[80:83], v[44:47], v[236:239]
    v_mfma_f32_16x16x32_bf16 v[240:243], v[80:83], v[48:51], v[240:243]
    v_mfma_f32_16x16x32_bf16 v[244:247], v[80:83], v[52:55], v[244:247]
    s_setprio 0
    s_add_u32 m0, s79, 116736
    s_mov_b32 s78, 256
    buffer_load_dwordx4 v20, s[36:39], s78 offen sc1 lds
    s_add_u32 m0, s79, 117760
    s_nop 0
    buffer_load_dwordx4 v21, s[36:39], s78 offen sc1 lds
    s_add_u32 m0, s33, 77824
    s_mov_b32 s76, 589824
    buffer_load_dwordx4 v23, s[40:43], s76 offen offset:0 lds
    s_add_u32 m0, s33, 79872
    s_nop 0
    buffer_load_dwordx4 v23, s[40:43], s76 offen offset:2048 lds
    s_add_u32 m0, s33, 86016
    s_nop 0
    buffer_load_dwordx4 v23, s[44:47], s76 offen offset:0 lds
    s_add_u32 m0, s33, 90112
    s_mov_b32 s77, 688128
    buffer_load_dwordx4 v22, s[48:51], s77 offen offset:0 lds
    s_add_u32 m0, s33, 94208
    s_nop 0
    buffer_load_dwordx4 v22, s[52:55], s77 offen offset:0 lds
    s_lshl_b32 s84, s28, 7
    s_lshl_b32 s85, s5, 6
    s_add_u32 s84, s84, s85
    s_lshl_b32 s84, s84, 3
    s_add_u32 s84, s84, 0x1e00000
    v_and_b32 v16, 15, v1
    v_lshl_add_u32 v17, v16, 3, s84
    global_load_dwordx2 v[8:9], v17, s[26:27] offset:0 sc1
    global_load_dwordx2 v[10:11], v17, s[26:27] offset:128 sc1
    global_load_dwordx2 v[12:13], v17, s[26:27] offset:256 sc1
    global_load_dwordx2 v[14:15], v17, s[26:27] offset:384 sc1
    s_mul_i32 s84, s29, 20480
    s_add_u32 s84, s84, 0x1e10000
    v_mul_u32_u24 v16, 1280, v16
    v_and_b32 v17, 48, v1
    v_add3_u32 v16, v16, v17, s84
    s_lshl_b32 s85, s6, 8
    v_add_u32 v17, s85, v16
    s_lshl_b32 s85, s6, 6
    v_add_u32 v16, s85, v16
    global_load_dwordx4 v[24:27], v17, s[26:27] offset:0 sc1
    global_load_dwordx4 v[28:31], v17, s[26:27] offset:640 sc1
    global_load_dwordx4 v[32:35], v17, s[26:27] offset:64 sc1
    global_load_dwordx4 v[36:39], v17, s[26:27] offset:704 sc1
    global_load_dwordx4 v[40:43], v17, s[26:27] offset:128 sc1
    global_load_dwordx4 v[44:47], v17, s[26:27] offset:768 sc1
    global_load_dwordx4 v[48:51], v17, s[26:27] offset:192 sc1
    global_load_dwordx4 v[52:55], v17, s[26:27] offset:832 sc1
    global_load_dwordx4 v[56:59], v16, s[26:27] offset:512 sc1
    global_load_dwordx4 v[60:63], v16, s[26:27] offset:1152 sc1
    v_lshrrev_b32 v18, 4, v1
    v_and_b32 v19, 1, v18
    v_lshrrev_b32 v18, 1, v18
    v_lshlrev_b32 v18, 8, v18
    v_lshl_add_u32 v18, v19, 10, v18
    v_and_b32 v19, 15, v1
    v_lshl_add_u32 v4, v19, 4, v18
    s_mul_i32 s84, s28, 112
    s_mul_i32 s85, s29, 5
    s_add_u32 s84, s84, s85
    s_lshl_b32 s84, s84, 13
    s_lshl_b32 s85, s5, 12
    s_add_u32 s84, s84, s85
    s_add_u32 s84, s84, 0x400000
    s_and_b32 s85, s29, 1
    s_lshl1_add_u32 s86, s6, s85
    s_lshl_b32 s86, s86, 13
    s_add_u32 s72, s84, s86
    s_add_u32 s73, s72, 8192
    s_xor_b32 s85, s85, 1
    s_lshl_b32 s85, s85, 15
    s_add_u32 s84, s84, s85
    s_lshl_b32 s85, s6, 9
    s_add_u32 s74, s84, s85
    s_lshl2_add_u32 s91, s2, s4
    s_lshl_b32 s75, s91, 6
    s_lshr_b32 s92, s91, 5
    s_mul_i32 s92, s92, 7168
    s_and_b32 s91, s91, 31
    s_lshl_b32 s91, s91, 6
    s_add_u32 s92, s92, s91
    s_add_u32 s34, s92, 5120
    s_add_u32 s75, s75, 0x440000
    s_load_dword s94, s[10:11], s75 offset:0x0
    s_add_u32 s34, s34, 0x4d0000
    s_load_dword s94, s[16:17], s34 offset:0x0
    s_load_dword s94, s[18:19], s34 offset:0x0
    s_load_dword s94, s[10:11], s75 offset:0x10000
    s_barrier
    s_add_u32 m0, s79, 118784
    s_mov_b32 s78, 33024
    buffer_load_dwordx4 v20, s[36:39], s78 offen sc1 lds
    s_add_u32 m0, s79, 119808
    s_nop 0
    buffer_load_dwordx4 v21, s[36:39], s78 offen sc1 lds
    s_add_u32 m0, s81, 133120
    s_mov_b32 s78, 256
    s_mov_b64 exec, 0xffffffff
    buffer_load_dwordx4 v3, s[36:39], s78 offen sc1 lds
    s_mov_b64 exec, -1
    s_add_u32 m0, s33, 16384
    s_mov_b32 s76, 786432
    buffer_load_dwordx4 v23, s[40:43], s76 offen offset:0 lds
    s_add_u32 m0, s33, 18432
    s_nop 0
    buffer_load_dwordx4 v23, s[40:43], s76 offen offset:2048 lds
    s_add_u32 m0, s33, 24576
    s_nop 0
    buffer_load_dwordx4 v23, s[44:47], s76 offen offset:0 lds
    s_add_u32 m0, s33, 28672
    s_mov_b32 s77, 917504
    buffer_load_dwordx4 v22, s[48:51], s77 offen offset:0 lds
    s_add_u32 m0, s33, 32768
    s_nop 0
    buffer_load_dwordx4 v22, s[52:55], s77 offen offset:0 lds
    s_load_dword s94, s[10:11], s75 offset:0x20000
    s_load_dword s94, s[10:11], s75 offset:0x30000
    s_load_dword s94, s[16:17], s34 offset:0x38000
    s_load_dword s94, s[18:19], s34 offset:0x38000
    v_mov_b32 v5, 0
    global_load_dwordx2 v[6:7], v5, s[24:25] sc1
    s_barrier
    s_add_u32 m0, s79, 135168
    s_mov_b32 s78, 384
    buffer_load_dwordx4 v20, s[36:39], s78 offen sc1 lds
    s_waitcnt vmcnt(20)
    v_rcp_f32 v80, v9
    v_sub_f32 v64, 0, v8
    v_mul_f32 v67, v9, v9
    v_fma_f32 v81, -v9, v80, 1.0
    v_fma_f32 v80, v81, v80, v80
    v_mul_f32 v65, 0xc0135761, v80
    v_mul_f32 v81, v80, v80
    v_mul_f32 v81, v81, v80
    v_mul_f32 v66, 0xbdd2d3e8, v81
    v_rcp_f32 v80, v11
    v_sub_f32 v68, 0, v10
    v_mul_f32 v71, v11, v11
    v_fma_f32 v81, -v11, v80, 1.0
    v_fma_f32 v80, v81, v80, v80
    s_add_u32 m0, s79, 136192
    s_nop 0
    buffer_load_dwordx4 v21, s[36:39], s78 offen sc1 lds
    v_mul_f32 v69, 0xc0135761, v80
    v_mul_f32 v81, v80, v80
    v_mul_f32 v81, v81, v80
    v_mul_f32 v70, 0xbdd2d3e8, v81
    v_rcp_f32 v80, v13
    v_sub_f32 v72, 0, v12
    v_mul_f32 v75, v13, v13
    s_add_u32 m0, s33, 36864
    s_mov_b32 s76, 983040
    buffer_load_dwordx4 v23, s[40:43], s76 offen offset:0 lds
    v_fma_f32 v81, -v13, v80, 1.0
    v_fma_f32 v80, v81, v80, v80
    v_mul_f32 v73, 0xc0135761, v80
    v_mul_f32 v81, v80, v80
    v_mul_f32 v81, v81, v80
    v_mul_f32 v74, 0xbdd2d3e8, v81
    v_rcp_f32 v80, v15
    s_add_u32 m0, s33, 38912
    s_nop 0
    buffer_load_dwordx4 v23, s[40:43], s76 offen offset:2048 lds
    v_sub_f32 v76, 0, v14
    v_mul_f32 v79, v15, v15
    v_fma_f32 v81, -v15, v80, 1.0
    v_fma_f32 v80, v81, v80, v80
    v_mul_f32 v77, 0xc0135761, v80
    v_mul_f32 v81, v80, v80
    v_mul_f32 v81, v81, v80
    v_mul_f32 v78, 0xbdd2d3e8, v81
    s_add_u32 m0, s33, 45056
    s_nop 0
    buffer_load_dwordx4 v23, s[44:47], s76 offen offset:0 lds
    s_waitcnt vmcnt(22)
    v_add_f32_dpp v24, v24, v24 row_ror:8 row_mask:0xf bank_mask:0xf
    v_add_f32_dpp v25, v25, v25 row_ror:8 row_mask:0xf bank_mask:0xf
    v_add_f32_dpp v26, v26, v26 row_ror:8 row_mask:0xf bank_mask:0xf
    v_add_f32_dpp v27, v27, v27 row_ror:8 row_mask:0xf bank_mask:0xf
    v_add_f32_dpp v28, v28, v28 row_ror:8 row_mask:0xf bank_mask:0xf
    v_add_f32_dpp v29, v29, v29 row_ror:8 row_mask:0xf bank_mask:0xf
    v_add_f32_dpp v30, v30, v30 row_ror:8 row_mask:0xf bank_mask:0xf
    v_add_f32_dpp v31, v31, v31 row_ror:8 row_mask:0xf bank_mask:0xf
    s_add_u32 m0, s33, 49152
    s_mov_b32 s77, 1146880
    buffer_load_dwordx4 v22, s[48:51], s77 offen offset:0 lds
    v_add_f32_dpp v24, v24, v24 row_ror:4 row_mask:0xf bank_mask:0xf
    v_add_f32_dpp v25, v25, v25 row_ror:4 row_mask:0xf bank_mask:0xf
    v_add_f32_dpp v26, v26, v26 row_ror:4 row_mask:0xf bank_mask:0xf
    v_add_f32_dpp v27, v27, v27 row_ror:4 row_mask:0xf bank_mask:0xf
    v_add_f32_dpp v28, v28, v28 row_ror:4 row_mask:0xf bank_mask:0xf
    v_add_f32_dpp v29, v29, v29 row_ror:4 row_mask:0xf bank_mask:0xf
    v_add_f32_dpp v30, v30, v30 row_ror:4 row_mask:0xf bank_mask:0xf
    v_add_f32_dpp v31, v31, v31 row_ror:4 row_mask:0xf bank_mask:0xf
    s_add_u32 m0, s33, 53248
    s_nop 0
    buffer_load_dwordx4 v22, s[52:55], s77 offen offset:0 lds
    v_add_f32_dpp v24, v24, v24 row_ror:2 row_mask:0xf bank_mask:0xf
    v_add_f32_dpp v25, v25, v25 row_ror:2 row_mask:0xf bank_mask:0xf
    v_add_f32_dpp v26, v26, v26 row_ror:2 row_mask:0xf bank_mask:0xf
    v_add_f32_dpp v27, v27, v27 row_ror:2 row_mask:0xf bank_mask:0xf
    v_add_f32_dpp v28, v28, v28 row_ror:2 row_mask:0xf bank_mask:0xf
    v_add_f32_dpp v29, v29, v29 row_ror:2 row_mask:0xf bank_mask:0xf
    v_add_f32_dpp v30, v30, v30 row_ror:2 row_mask:0xf bank_mask:0xf
    v_add_f32_dpp v31, v31, v31 row_ror:2 row_mask:0xf bank_mask:0xf
    s_load_dword s94, s[10:11], s75 offset:0x40000
    s_load_dword s94, s[10:11], s75 offset:0x50000
    s_load_dword s94, s[10:11], s75 offset:0x60000
    s_load_dword s94, s[16:17], s34 offset:0x70000
    s_waitcnt vmcnt(30)
    s_barrier
    s_add_u32 m0, s79, 137216
    s_mov_b32 s78, 33152
    buffer_load_dwordx4 v20, s[36:39], s78 offen sc1 lds
    v_add_f32_dpp v24, v24, v24 row_ror:1 row_mask:0xf bank_mask:0xf
    v_add_f32_dpp v25, v25, v25 row_ror:1 row_mask:0xf bank_mask:0xf
    v_add_f32_dpp v26, v26, v26 row_ror:1 row_mask:0xf bank_mask:0xf
    v_add_f32_dpp v27, v27, v27 row_ror:1 row_mask:0xf bank_mask:0xf
    v_add_f32_dpp v28, v28, v28 row_ror:1 row_mask:0xf bank_mask:0xf
    v_add_f32_dpp v29, v29, v29 row_ror:1 row_mask:0xf bank_mask:0xf
    v_add_f32_dpp v30, v30, v30 row_ror:1 row_mask:0xf bank_mask:0xf
    v_add_f32_dpp v31, v31, v31 row_ror:1 row_mask:0xf bank_mask:0xf
    s_add_u32 m0, s79, 138240
    s_nop 0
    buffer_load_dwordx4 v21, s[36:39], s78 offen sc1 lds
    v_fmac_f32 v88, v24, v64
    v_fmac_f32 v89, v25, v64
    v_fmac_f32 v90, v26, v64
    v_fmac_f32 v91, v27, v64
    v_fmac_f32 v104, v28, v64
    v_fmac_f32 v105, v29, v64
    v_fmac_f32 v106, v30, v64
    v_fmac_f32 v107, v31, v64
    s_add_u32 m0, s81, 151552
    s_mov_b32 s78, 384
    s_mov_b64 exec, 0xffffffff
    buffer_load_dwordx4 v3, s[36:39], s78 offen sc1 lds
    s_mov_b64 exec, -1
    v_mul_f32 v80, v88, v88
    v_mul_f32 v81, v89, v89
    v_mul_f32 v82, v90, v90
    v_mul_f32 v83, v91, v91
    v_fma_f32 v80, v80, v66, v65
    v_fma_f32 v81, v81, v66, v65
    v_fma_f32 v82, v82, v66, v65
    v_fma_f32 v83, v83, v66, v65
    s_add_u32 m0, s33, 57344
    s_mov_b32 s76, 1179648
    buffer_load_dwordx4 v23, s[40:43], s76 offen offset:0 lds
    v_mul_f32 v80, v80, v88
    v_mul_f32 v81, v81, v89
    v_mul_f32 v82, v82, v90
    v_mul_f32 v83, v83, v91
    v_exp_f32 v80, v80
    v_mul_f32 v88, v88, v104
    v_exp_f32 v81, v81
    s_add_u32 m0, s33, 59392
    s_nop 0
    buffer_load_dwordx4 v23, s[40:43], s76 offen offset:2048 lds
    v_mul_f32 v89, v89, v105
    v_exp_f32 v82, v82
    v_mul_f32 v90, v90, v106
    v_exp_f32 v83, v83
    v_mul_f32 v91, v91, v107
    v_fma_f32 v80, v80, v67, v67
    s_add_u32 m0, s33, 65536
    s_nop 0
    buffer_load_dwordx4 v23, s[44:47], s76 offen offset:0 lds
    v_fma_f32 v81, v81, v67, v67
    v_fma_f32 v82, v82, v67, v67
    v_fma_f32 v83, v83, v67, v67
    v_rcp_f32 v80, v80
    v_rcp_f32 v81, v81
    v_rcp_f32 v82, v82
    s_add_u32 m0, s33, 69632
    s_mov_b32 s77, 1376256
    buffer_load_dwordx4 v22, s[48:51], s77 offen offset:0 lds
    v_rcp_f32 v83, v83
    s_nop 0
    v_mul_f32 v88, v88, v80
    v_mul_f32 v89, v89, v81
    v_mul_f32 v90, v90, v82
    v_mul_f32 v91, v91, v83
    v_cvt_pk_bf16_f32 v88, v88, v89
    v_cvt_pk_bf16_f32 v89, v90, v91
    s_add_u32 m0, s33, 73728
    s_nop 0
    buffer_load_dwordx4 v22, s[52:55], s77 offen offset:0 lds
    v_fmac_f32 v92, v24, v68
    v_fmac_f32 v93, v25, v68
    v_fmac_f32 v94, v26, v68
    v_fmac_f32 v95, v27, v68
    v_fmac_f32 v108, v28, v68
    v_fmac_f32 v109, v29, v68
    v_fmac_f32 v110, v30, v68
    v_fmac_f32 v111, v31, v68
    s_load_dword s94, s[18:19], s34 offset:0x70000
    s_load_dword s94, s[10:11], s75 offset:0x70000
    s_load_dword s94, s[10:11], s75 offset:0x80000
    s_load_dword s94, s[10:11], s75 offset:0x90000
    s_waitcnt vmcnt(16)
    s_barrier
    s_add_u32 m0, s79, 98304
    s_mov_b32 s78, 512
    buffer_load_dwordx4 v20, s[36:39], s78 offen sc1 lds
    v_mul_f32 v80, v92, v92
    v_mul_f32 v81, v93, v93
    v_mul_f32 v82, v94, v94
    v_mul_f32 v83, v95, v95
    v_fma_f32 v80, v80, v70, v69
    v_fma_f32 v81, v81, v70, v69
    v_fma_f32 v82, v82, v70, v69
    v_fma_f32 v83, v83, v70, v69
    v_mul_f32 v80, v80, v92
    v_mul_f32 v81, v81, v93
    v_mul_f32 v82, v82, v94
    v_mul_f32 v83, v83, v95
    v_exp_f32 v80, v80
    v_mul_f32 v92, v92, v108
    v_exp_f32 v81, v81
    s_add_u32 m0, s79, 99328
    s_nop 0
    buffer_load_dwordx4 v21, s[36:39], s78 offen sc1 lds
    v_mul_f32 v93, v93, v109
    v_exp_f32 v82, v82
    v_mul_f32 v94, v94, v110
    v_exp_f32 v83, v83
    v_mul_f32 v95, v95, v111
    v_fma_f32 v80, v80, v71, v71
    s_add_u32 m0, s33, 77824
    s_mov_b32 s76, 1376256
    buffer_load_dwordx4 v23, s[40:43], s76 offen offset:0 lds
    v_fma_f32 v81, v81, v71, v71
    v_fma_f32 v82, v82, v71, v71
    v_fma_f32 v83, v83, v71, v71
    v_rcp_f32 v80, v80
    v_rcp_f32 v81, v81
    v_rcp_f32 v82, v82
    s_add_u32 m0, s33, 79872
    s_nop 0
    buffer_load_dwordx4 v23, s[40:43], s76 offen offset:2048 lds
    v_rcp_f32 v83, v83
    s_nop 0
    v_mul_f32 v92, v92, v80
    v_mul_f32 v93, v93, v81
    v_mul_f32 v94, v94, v82
    v_mul_f32 v95, v95, v83
    v_cvt_pk_bf16_f32 v90, v92, v93
    v_cvt_pk_bf16_f32 v91, v94, v95
    s_add_u32 m0, s33, 86016
    s_nop 0
    buffer_load_dwordx4 v23, s[44:47], s76 offen offset:0 lds
    s_nop 1
    v_permlane16_swap_b32 v88, v90
    v_permlane16_swap_b32 v89, v91
    s_add_u32 m0, s33, 90112
    s_mov_b32 s77, 1605632
    buffer_load_dwordx4 v22, s[48:51], s77 offen offset:0 lds
    buffer_store_dwordx4 v[88:91], v4, s[68:71], s72 offen offset:0 sc1
    v_fmac_f32 v96, v24, v72
    v_fmac_f32 v97, v25, v72
    v_fmac_f32 v98, v26, v72
    v_fmac_f32 v99, v27, v72
    v_fmac_f32 v112, v28, v72
    v_fmac_f32 v113, v29, v72
    v_fmac_f32 v114, v30, v72
    v_fmac_f32 v115, v31, v72
    s_add_u32 m0, s33, 94208
    s_nop 0
    buffer_load_dwordx4 v22, s[52:55], s77 offen offset:0 lds
    v_mul_f32 v80, v96, v96
    v_mul_f32 v81, v97, v97
    v_mul_f32 v82, v98, v98
    v_mul_f32 v83, v99, v99
    v_fma_f32 v80, v80, v74, v73
    v_fma_f32 v81, v81, v74, v73
    v_fma_f32 v82, v82, v74, v73
    v_fma_f32 v83, v83, v74, v73
    s_load_dword s94, s[16:17], s34 offset:0xa8000
    s_load_dword s94, s[18:19], s34 offset:0xa8000
    s_load_dword s94, s[10:11], s75 offset:0xa0000
    s_load_dword s94, s[10:11], s75 offset:0xb0000
    s_waitcnt vmcnt(16)
    s_barrier
    s_add_u32 m0, s79, 100352
    s_mov_b32 s78, 33280
    buffer_load_dwordx4 v20, s[36:39], s78 offen sc1 lds
    v_mul_f32 v80, v80, v96
    v_mul_f32 v81, v81, v97
    v_mul_f32 v82, v82, v98
    v_mul_f32 v83, v83, v99
    v_exp_f32 v80, v80
    v_mul_f32 v96, v96, v112
    v_exp_f32 v81, v81
    s_add_u32 m0, s79, 101376
    s_nop 0
    buffer_load_dwordx4 v21, s[36:39], s78 offen sc1 lds
    v_mul_f32 v97, v97, v113
    v_exp_f32 v82, v82
    v_mul_f32 v98, v98, v114
    v_exp_f32 v83, v83
    v_mul_f32 v99, v99, v115
    v_fma_f32 v80, v80, v75, v75
    s_add_u32 m0, s81, 114688
    s_mov_b32 s78, 512
    s_mov_b64 exec, 0xffffffff
    buffer_load_dwordx4 v3, s[36:39], s78 offen sc1 lds
    s_mov_b64 exec, -1
    v_fma_f32 v81, v81, v75, v75
    v_fma_f32 v82, v82, v75, v75
    v_fma_f32 v83, v83, v75, v75
    v_rcp_f32 v80, v80
    v_rcp_f32 v81, v81
    v_rcp_f32 v82, v82
    s_add_u32 m0, s33, 16384
    s_mov_b32 s76, 1572864
    buffer_load_dwordx4 v23, s[40:43], s76 offen offset:0 lds
    v_rcp_f32 v83, v83
    s_nop 0
    v_mul_f32 v96, v96, v80
    v_mul_f32 v97, v97, v81
    v_mul_f32 v98, v98, v82
    v_mul_f32 v99, v99, v83
    v_cvt_pk_bf16_f32 v96, v96, v97
    v_cvt_pk_bf16_f32 v97, v98, v99
    s_add_u32 m0, s33, 18432
    s_nop 0
    buffer_load_dwordx4 v23, s[40:43], s76 offen offset:2048 lds
    v_fmac_f32 v100, v24, v76
    v_fmac_f32 v101, v25, v76
    v_fmac_f32 v102, v26, v76
    v_fmac_f32 v103, v27, v76
    v_fmac_f32 v116, v28, v76
    v_fmac_f32 v117, v29, v76
    v_fmac_f32 v118, v30, v76
    v_fmac_f32 v119, v31, v76
    s_add_u32 m0, s33, 24576
    s_nop 0
    buffer_load_dwordx4 v23, s[44:47], s76 offen offset:0 lds
    v_mul_f32 v80, v100, v100
    v_mul_f32 v81, v101, v101
    v_mul_f32 v82, v102, v102
    v_mul_f32 v83, v103, v103
    v_fma_f32 v80, v80, v78, v77
    v_fma_f32 v81, v81, v78, v77
    v_fma_f32 v82, v82, v78, v77
    v_fma_f32 v83, v83, v78, v77
    s_add_u32 m0, s33, 28672
    s_mov_b32 s77, 1835008
    buffer_load_dwordx4 v22, s[48:51], s77 offen offset:0 lds
    v_mul_f32 v80, v80, v100
    v_mul_f32 v81, v81, v101
    v_mul_f32 v82, v82, v102
    v_mul_f32 v83, v83, v103
    v_exp_f32 v80, v80
    v_mul_f32 v100, v100, v116
    v_exp_f32 v81, v81
    s_add_u32 m0, s33, 32768
    s_nop 0
    buffer_load_dwordx4 v22, s[52:55], s77 offen offset:0 lds
    v_mul_f32 v101, v101, v117
    v_exp_f32 v82, v82
    v_mul_f32 v102, v102, v118
    v_exp_f32 v83, v83
    v_mul_f32 v103, v103, v119
    v_fma_f32 v80, v80, v79, v79
    s_load_dword s94, s[10:11], s75 offset:0xc0000
    s_load_dword s94, s[16:17], s34 offset:0xe0000
    s_load_dword s94, s[18:19], s34 offset:0xe0000
    s_load_dword s94, s[10:11], s75 offset:0xd0000
    s_waitcnt vmcnt(16)
    s_barrier
    s_add_u32 m0, s79, 116736
    s_mov_b32 s78, 640
    buffer_load_dwordx4 v20, s[36:39], s78 offen sc1 lds
    v_fma_f32 v81, v81, v79, v79
    v_fma_f32 v82, v82, v79, v79
    v_fma_f32 v83, v83, v79, v79
    v_rcp_f32 v80, v80
    v_rcp_f32 v81, v81
    v_rcp_f32 v82, v82
    s_add_u32 m0, s79, 117760
    s_nop 0
    buffer_load_dwordx4 v21, s[36:39], s78 offen sc1 lds
    v_rcp_f32 v83, v83
    s_nop 0
    v_mul_f32 v100, v100, v80
    v_mul_f32 v101, v101, v81
    v_mul_f32 v102, v102, v82
    v_mul_f32 v103, v103, v83
    v_cvt_pk_bf16_f32 v98, v100, v101
    v_cvt_pk_bf16_f32 v99, v102, v103
    s_nop 1
    v_permlane16_swap_b32 v96, v98
    v_permlane16_swap_b32 v97, v99
    s_add_u32 m0, s33, 36864
    s_mov_b32 s76, 1769472
    buffer_load_dwordx4 v23, s[40:43], s76 offen offset:0 lds
    buffer_store_dwordx4 v[96:99], v4, s[68:71], s72 offen offset:2048 sc1
    s_waitcnt vmcnt(50)
    v_add_f32_dpp v32, v32, v32 row_ror:8 row_mask:0xf bank_mask:0xf
    v_add_f32_dpp v33, v33, v33 row_ror:8 row_mask:0xf bank_mask:0xf
    v_add_f32_dpp v34, v34, v34 row_ror:8 row_mask:0xf bank_mask:0xf
    v_add_f32_dpp v35, v35, v35 row_ror:8 row_mask:0xf bank_mask:0xf
    v_add_f32_dpp v36, v36, v36 row_ror:8 row_mask:0xf bank_mask:0xf
    v_add_f32_dpp v37, v37, v37 row_ror:8 row_mask:0xf bank_mask:0xf
    v_add_f32_dpp v38, v38, v38 row_ror:8 row_mask:0xf bank_mask:0xf
    v_add_f32_dpp v39, v39, v39 row_ror:8 row_mask:0xf bank_mask:0xf
    s_add_u32 m0, s33, 38912
    s_nop 0
    buffer_load_dwordx4 v23, s[40:43], s76 offen offset:2048 lds
    v_add_f32_dpp v32, v32, v32 row_ror:4 row_mask:0xf bank_mask:0xf
    v_add_f32_dpp v33, v33, v33 row_ror:4 row_mask:0xf bank_mask:0xf
    v_add_f32_dpp v34, v34, v34 row_ror:4 row_mask:0xf bank_mask:0xf
    v_add_f32_dpp v35, v35, v35 row_ror:4 row_mask:0xf bank_mask:0xf
    v_add_f32_dpp v36, v36, v36 row_ror:4 row_mask:0xf bank_mask:0xf
    v_add_f32_dpp v37, v37, v37 row_ror:4 row_mask:0xf bank_mask:0xf
    v_add_f32_dpp v38, v38, v38 row_ror:4 row_mask:0xf bank_mask:0xf
    v_add_f32_dpp v39, v39, v39 row_ror:4 row_mask:0xf bank_mask:0xf
    s_add_u32 m0, s33, 45056
    s_nop 0
    buffer_load_dwordx4 v23, s[44:47], s76 offen offset:0 lds
    v_add_f32_dpp v32, v32, v32 row_ror:2 row_mask:0xf bank_mask:0xf
    v_add_f32_dpp v33, v33, v33 row_ror:2 row_mask:0xf bank_mask:0xf
    v_add_f32_dpp v34, v34, v34 row_ror:2 row_mask:0xf bank_mask:0xf
    v_add_f32_dpp v35, v35, v35 row_ror:2 row_mask:0xf bank_mask:0xf
    v_add_f32_dpp v36, v36, v36 row_ror:2 row_mask:0xf bank_mask:0xf
    v_add_f32_dpp v37, v37, v37 row_ror:2 row_mask:0xf bank_mask:0xf
    v_add_f32_dpp v38, v38, v38 row_ror:2 row_mask:0xf bank_mask:0xf
    v_add_f32_dpp v39, v39, v39 row_ror:2 row_mask:0xf bank_mask:0xf
    s_add_u32 m0, s33, 49152
    s_mov_b32 s77, 2064384
    buffer_load_dwordx4 v22, s[48:51], s77 offen offset:0 lds
    v_add_f32_dpp v32, v32, v32 row_ror:1 row_mask:0xf bank_mask:0xf
    v_add_f32_dpp v33, v33, v33 row_ror:1 row_mask:0xf bank_mask:0xf
    v_add_f32_dpp v34, v34, v34 row_ror:1 row_mask:0xf bank_mask:0xf
    v_add_f32_dpp v35, v35, v35 row_ror:1 row_mask:0xf bank_mask:0xf
    v_add_f32_dpp v36, v36, v36 row_ror:1 row_mask:0xf bank_mask:0xf
    v_add_f32_dpp v37, v37, v37 row_ror:1 row_mask:0xf bank_mask:0xf
    v_add_f32_dpp v38, v38, v38 row_ror:1 row_mask:0xf bank_mask:0xf
    v_add_f32_dpp v39, v39, v39 row_ror:1 row_mask:0xf bank_mask:0xf
    s_add_u32 m0, s33, 53248
    s_nop 0
    buffer_load_dwordx4 v22, s[52:55], s77 offen offset:0 lds
    v_fmac_f32 v120, v32, v64
    v_fmac_f32 v121, v33, v64
    v_fmac_f32 v122, v34, v64
    v_fmac_f32 v123, v35, v64
    v_fmac_f32 v136, v36, v64
    v_fmac_f32 v137, v37, v64
    v_fmac_f32 v138, v38, v64
    v_fmac_f32 v139, v39, v64
    v_mul_f32 v80, v120, v120
    v_mul_f32 v81, v121, v121
    v_mul_f32 v82, v122, v122
    v_mul_f32 v83, v123, v123
    v_fma_f32 v80, v80, v66, v65
    v_fma_f32 v81, v81, v66, v65
    v_fma_f32 v82, v82, v66, v65
    v_fma_f32 v83, v83, v66, v65
    s_load_dword s94, s[10:11], s75 offset:0xe0000
    s_load_dword s94, s[10:11], s75 offset:0xf0000
    s_add_u32 s34, s34, 0x118000
    s_load_dword s94, s[16:17], s34 offset:0x0
    s_load_dword s94, s[18:19], s34 offset:0x0
    s_waitcnt vmcnt(16)
    s_barrier
    s_add_u32 m0, s79, 118784
    s_mov_b32 s78, 33408
    buffer_load_dwordx4 v20, s[36:39], s78 offen sc1 lds
    v_mul_f32 v80, v80, v120
    v_mul_f32 v81, v81, v121
    v_mul_f32 v82, v82, v122
    v_mul_f32 v83, v83, v123
    v_exp_f32 v80, v80
    v_mul_f32 v120, v120, v136
    v_exp_f32 v81, v81
    s_add_u32 m0, s79, 119808
    s_nop 0
    buffer_load_dwordx4 v21, s[36:39], s78 offen sc1 lds
    v_mul_f32 v121, v121, v137
    v_exp_f32 v82, v82
    v_mul_f32 v122, v122, v138
    v_exp_f32 v83, v83
    v_mul_f32 v123, v123, v139
    v_fma_f32 v80, v80, v67, v67
    s_add_u32 m0, s81, 133120
    s_mov_b32 s78, 640
    s_mov_b64 exec, 0xffffffff
    buffer_load_dwordx4 v3, s[36:39], s78 offen sc1 lds
    s_mov_b64 exec, -1
    v_fma_f32 v81, v81, v67, v67
    v_fma_f32 v82, v82, v67, v67
    v_fma_f32 v83, v83, v67, v67
    v_rcp_f32 v80, v80
    v_rcp_f32 v81, v81
    v_rcp_f32 v82, v82
    s_add_u32 m0, s33, 57344
    s_mov_b32 s76, 1966080
    buffer_load_dwordx4 v23, s[40:43], s76 offen offset:0 lds
    v_rcp_f32 v83, v83
    s_nop 0
    v_mul_f32 v120, v120, v80
    v_mul_f32 v121, v121, v81
    v_mul_f32 v122, v122, v82
    v_mul_f32 v123, v123, v83
    v_cvt_pk_bf16_f32 v120, v120, v121
    v_cvt_pk_bf16_f32 v121, v122, v123
    s_add_u32 m0, s33, 59392
    s_nop 0
    buffer_load_dwordx4 v23, s[40:43], s76 offen offset:2048 lds
    v_fmac_f32 v124, v32, v68
    v_fmac_f32 v125, v33, v68
    v_fmac_f32 v126, v34, v68
    v_fmac_f32 v127, v35, v68
    v_fmac_f32 v140, v36, v68
    v_fmac_f32 v141, v37, v68
    v_fmac_f32 v142, v38, v68
    v_fmac_f32 v143, v39, v68
    s_add_u32 m0, s33, 65536
    s_nop 0
    buffer_load_dwordx4 v23, s[44:47], s76 offen offset:0 lds
    v_mul_f32 v80, v124, v124
    v_mul_f32 v81, v125, v125
    v_mul_f32 v82, v126, v126
    v_mul_f32 v83, v127, v127
    v_fma_f32 v80, v80, v70, v69
    v_fma_f32 v81, v81, v70, v69
    v_fma_f32 v82, v82, v70, v69
    v_fma_f32 v83, v83, v70, v69
    s_add_u32 m0, s33, 69632
    s_mov_b32 s77, 2293760
    buffer_load_dwordx4 v22, s[48:51], s77 offen offset:0 lds
    v_mul_f32 v80, v80, v124
    v_mul_f32 v81, v81, v125
    v_mul_f32 v82, v82, v126
    v_mul_f32 v83, v83, v127
    v_exp_f32 v80, v80
    v_mul_f32 v124, v124, v140
    v_exp_f32 v81, v81
    s_add_u32 m0, s33, 73728
    s_nop 0
    buffer_load_dwordx4 v22, s[52:55], s77 offen offset:0 lds
    v_mul_f32 v125, v125, v141
    v_exp_f32 v82, v82
    v_mul_f32 v126, v126, v142
    v_exp_f32 v83, v83
    v_mul_f32 v127, v127, v143
    v_fma_f32 v80, v80, v71, v71
    s_add_u32 s75, s75, 0x100000
    s_load_dword s94, s[10:11], s75 offset:0x0
    s_load_dword s94, s[10:11], s75 offset:0x10000
    s_load_dword s94, s[10:11], s75 offset:0x20000
    s_load_dword s94, s[16:17], s34 offset:0x38000
    s_waitcnt vmcnt(16)
    s_barrier
    s_add_u32 m0, s79, 135168
    s_mov_b32 s78, 768
    buffer_load_dwordx4 v20, s[36:39], s78 offen sc1 lds
    v_fma_f32 v81, v81, v71, v71
    v_fma_f32 v82, v82, v71, v71
    v_fma_f32 v83, v83, v71, v71
    v_rcp_f32 v80, v80
    v_rcp_f32 v81, v81
    v_rcp_f32 v82, v82
    s_add_u32 m0, s79, 136192
    s_nop 0
    buffer_load_dwordx4 v21, s[36:39], s78 offen sc1 lds
    v_rcp_f32 v83, v83
    s_nop 0
    v_mul_f32 v124, v124, v80
    v_mul_f32 v125, v125, v81
    v_mul_f32 v126, v126, v82
    v_mul_f32 v127, v127, v83
    v_cvt_pk_bf16_f32 v122, v124, v125
    v_cvt_pk_bf16_f32 v123, v126, v127
    s_nop 1
    v_permlane16_swap_b32 v120, v122
    v_permlane16_swap_b32 v121, v123
    s_add_u32 m0, s33, 77824
    s_mov_b32 s76, 2162688
    buffer_load_dwordx4 v23, s[40:43], s76 offen offset:0 lds
    buffer_store_dwordx4 v[120:123], v4, s[68:71], s72 offen offset:512 sc1
    v_fmac_f32 v128, v32, v72
    v_fmac_f32 v129, v33, v72
    v_fmac_f32 v130, v34, v72
    v_fmac_f32 v131, v35, v72
    v_fmac_f32 v144, v36, v72
    v_fmac_f32 v145, v37, v72
    v_fmac_f32 v146, v38, v72
    v_fmac_f32 v147, v39, v72
    s_add_u32 m0, s33, 79872
    s_nop 0
    buffer_load_dwordx4 v23, s[40:43], s76 offen offset:2048 lds
    v_mul_f32 v80, v128, v128
    v_mul_f32 v81, v129, v129
    v_mul_f32 v82, v130, v130
    v_mul_f32 v83, v131, v131
    v_fma_f32 v80, v80, v74, v73
    v_fma_f32 v81, v81, v74, v73
    v_fma_f32 v82, v82, v74, v73
    v_fma_f32 v83, v83, v74, v73
    s_add_u32 m0, s33, 86016
    s_nop 0
    buffer_load_dwordx4 v23, s[44:47], s76 offen offset:0 lds
    v_mul_f32 v80, v80, v128
    v_mul_f32 v81, v81, v129
    v_mul_f32 v82, v82, v130
    v_mul_f32 v83, v83, v131
    v_exp_f32 v80, v80
    v_mul_f32 v128, v128, v144
    v_exp_f32 v81, v81
    s_add_u32 m0, s33, 90112
    s_mov_b32 s77, 2523136
    buffer_load_dwordx4 v22, s[48:51], s77 offen offset:0 lds
    v_mul_f32 v129, v129, v145
    v_exp_f32 v82, v82
    v_mul_f32 v130, v130, v146
    v_exp_f32 v83, v83
    v_mul_f32 v131, v131, v147
    v_fma_f32 v80, v80, v75, v75
    s_add_u32 m0, s33, 94208
    s_nop 0
    buffer_load_dwordx4 v22, s[52:55], s77 offen offset:0 lds
    v_fma_f32 v81, v81, v75, v75
    v_fma_f32 v82, v82, v75, v75
    v_fma_f32 v83, v83, v75, v75
    v_rcp_f32 v80, v80
    v_rcp_f32 v81, v81
    v_rcp_f32 v82, v82
    s_load_dword s94, s[18:19], s34 offset:0x38000
    s_load_dword s94, s[10:11], s75 offset:0x30000
    s_load_dword s94, s[10:11], s75 offset:0x40000
    s_load_dword s94, s[10:11], s75 offset:0x50000
    s_waitcnt vmcnt(55)
    s_movk_i32 s98, 0x4000
L_tokA_chk:
    v_readfirstlane_b32 s100, v6
    v_readfirstlane_b32 s101, v7
    s_nop 1
    s_cmp_lg_u32 s100, 0
    s_cbranch_scc1 L_tokA_ok
    s_sub_u32 s98, s98, 1
    s_cbranch_scc1 L_tokA_ok
    s_sleep 1
    global_load_dwordx2 v[6:7], v5, s[24:25] sc1
    s_waitcnt vmcnt(0)
    s_branch L_tokA_chk
L_tokA_ok:
    s_waitcnt vmcnt(16)
    s_barrier
    s_add_u32 m0, s79, 137216
    s_mov_b32 s78, 33536
    buffer_load_dwordx4 v20, s[36:39], s78 offen sc1 lds
    v_rcp_f32 v83, v83
    s_nop 0
    v_mul_f32 v128, v128, v80
    v_mul_f32 v129, v129, v81
    v_mul_f32 v130, v130, v82
    v_mul_f32 v131, v131, v83
    v_cvt_pk_bf16_f32 v128, v128, v129
    v_cvt_pk_bf16_f32 v129, v130, v131
    s_add_u32 m0, s79, 138240
    s_nop 0
    buffer_load_dwordx4 v21, s[36:39], s78 offen sc1 lds
    v_fmac_f32 v132, v32, v76
    v_fmac_f32 v133, v33, v76
    v_fmac_f32 v134, v34, v76
    v_fmac_f32 v135, v35, v76
    v_fmac_f32 v148, v36, v76
    v_fmac_f32 v149, v37, v76
    v_fmac_f32 v150, v38, v76
    v_fmac_f32 v151, v39, v76
    s_add_u32 m0, s81, 151552
    s_mov_b32 s78, 768
    s_mov_b64 exec, 0xffffffff
    buffer_load_dwordx4 v3, s[36:39], s78 offen sc1 lds
    s_mov_b64 exec, -1
    v_mul_f32 v80, v132, v132
    v_mul_f32 v81, v133, v133
    v_mul_f32 v82, v134, v134
    v_mul_f32 v83, v135, v135
    v_fma_f32 v80, v80, v78, v77
    v_fma_f32 v81, v81, v78, v77
    v_fma_f32 v82, v82, v78, v77
    v_fma_f32 v83, v83, v78, v77
    s_add_u32 m0, s33, 16384
    s_mov_b32 s76, 2359296
    buffer_load_dwordx4 v23, s[40:43], s76 offen offset:0 lds
    v_mul_f32 v80, v80, v132
    v_mul_f32 v81, v81, v133
    v_mul_f32 v82, v82, v134
    v_mul_f32 v83, v83, v135
    v_exp_f32 v80, v80
    v_mul_f32 v132, v132, v148
    v_exp_f32 v81, v81
    s_add_u32 m0, s33, 18432
    s_nop 0
    buffer_load_dwordx4 v23, s[40:43], s76 offen offset:2048 lds
    v_mul_f32 v133, v133, v149
    v_exp_f32 v82, v82
    v_mul_f32 v134, v134, v150
    v_exp_f32 v83, v83
    v_mul_f32 v135, v135, v151
    v_fma_f32 v80, v80, v79, v79
    s_add_u32 m0, s33, 24576
    s_nop 0
    buffer_load_dwordx4 v23, s[44:47], s76 offen offset:0 lds
    v_fma_f32 v81, v81, v79, v79
    v_fma_f32 v82, v82, v79, v79
    v_fma_f32 v83, v83, v79, v79
    v_rcp_f32 v80, v80
    v_rcp_f32 v81, v81
    v_rcp_f32 v82, v82
    s_add_u32 m0, s33, 28672
    s_mov_b32 s77, 2752512
    buffer_load_dwordx4 v22, s[48:51], s77 offen offset:0 lds
    v_rcp_f32 v83, v83
    s_nop 0
    v_mul_f32 v132, v132, v80
    v_mul_f32 v133, v133, v81
    v_mul_f32 v134, v134, v82
    v_mul_f32 v135, v135, v83
    v_cvt_pk_bf16_f32 v130, v132, v133
    v_cvt_pk_bf16_f32 v131, v134, v135
    s_add_u32 m0, s33, 32768
    s_nop 0
    buffer_load_dwordx4 v22, s[52:55], s77 offen offset:0 lds
    s_nop 1
    v_permlane16_swap_b32 v128, v130
    v_permlane16_swap_b32 v129, v131
    s_load_dword s94, s[16:17], s34 offset:0x70000
    s_load_dword s94, s[18:19], s34 offset:0x70000
    s_load_dword s94, s[10:11], s75 offset:0x60000
    s_load_dword s94, s[10:11], s75 offset:0x70000
    s_waitcnt vmcnt(16)
    s_barrier
    s_add_u32 m0, s79, 98304
    s_mov_b32 s78, 896
    buffer_load_dwordx4 v20, s[36:39], s78 offen sc1 lds
    buffer_store_dwordx4 v[128:131], v4, s[68:71], s72 offen offset:2560 sc1
    s_waitcnt vmcnt(63)
    v_add_f32_dpp v40, v40, v40 row_ror:8 row_mask:0xf bank_mask:0xf
    v_add_f32_dpp v41, v41, v41 row_ror:8 row_mask:0xf bank_mask:0xf
    v_add_f32_dpp v42, v42, v42 row_ror:8 row_mask:0xf bank_mask:0xf
    v_add_f32_dpp v43, v43, v43 row_ror:8 row_mask:0xf bank_mask:0xf
    v_add_f32_dpp v44, v44, v44 row_ror:8 row_mask:0xf bank_mask:0xf
    v_add_f32_dpp v45, v45, v45 row_ror:8 row_mask:0xf bank_mask:0xf
    v_add_f32_dpp v46, v46, v46 row_ror:8 row_mask:0xf bank_mask:0xf
    v_add_f32_dpp v47, v47, v47 row_ror:8 row_mask:0xf bank_mask:0xf
    s_add_u32 m0, s79, 99328
    s_nop 0
    buffer_load_dwordx4 v21, s[36:39], s78 offen sc1 lds
    v_add_f32_dpp v40, v40, v40 row_ror:4 row_mask:0xf bank_mask:0xf
    v_add_f32_dpp v41, v41, v41 row_ror:4 row_mask:0xf bank_mask:0xf
    v_add_f32_dpp v42, v42, v42 row_ror:4 row_mask:0xf bank_mask:0xf
    v_add_f32_dpp v43, v43, v43 row_ror:4 row_mask:0xf bank_mask:0xf
    v_add_f32_dpp v44, v44, v44 row_ror:4 row_mask:0xf bank_mask:0xf
    v_add_f32_dpp v45, v45, v45 row_ror:4 row_mask:0xf bank_mask:0xf
    v_add_f32_dpp v46, v46, v46 row_ror:4 row_mask:0xf bank_mask:0xf
    v_add_f32_dpp v47, v47, v47 row_ror:4 row_mask:0xf bank_mask:0xf
    v_add_f32_dpp v40, v40, v40 row_ror:2 row_mask:0xf bank_mask:0xf
    v_add_f32_dpp v41, v41, v41 row_ror:2 row_mask:0xf bank_mask:0xf
    v_add_f32_dpp v42, v42, v42 row_ror:2 row_mask:0xf bank_mask:0xf
    v_add_f32_dpp v43, v43, v43 row_ror:2 row_mask:0xf bank_mask:0xf
    v_add_f32_dpp v44, v44, v44 row_ror:2 row_mask:0xf bank_mask:0xf
    v_add_f32_dpp v45, v45, v45 row_ror:2 row_mask:0xf bank_mask:0xf
    v_add_f32_dpp v46, v46, v46 row_ror:2 row_mask:0xf bank_mask:0xf
    v_add_f32_dpp v47, v47, v47 row_ror:2 row_mask:0xf bank_mask:0xf
    s_add_u32 m0, s33, 36864
    s_mov_b32 s76, 2555904
    buffer_load_dwordx4 v23, s[40:43], s76 offen offset:0 lds
    v_add_f32_dpp v40, v40, v40 row_ror:1 row_mask:0xf bank_mask:0xf
    v_add_f32_dpp v41, v41, v41 row_ror:1 row_mask:0xf bank_mask:0xf
    v_add_f32_dpp v42, v42, v42 row_ror:1 row_mask:0xf bank_mask:0xf
    v_add_f32_dpp v43, v43, v43 row_ror:1 row_mask:0xf bank_mask:0xf
    v_add_f32_dpp v44, v44, v44 row_ror:1 row_mask:0xf bank_mask:0xf
    v_add_f32_dpp v45, v45, v45 row_ror:1 row_mask:0xf bank_mask:0xf
    v_add_f32_dpp v46, v46, v46 row_ror:1 row_mask:0xf bank_mask:0xf
    v_add_f32_dpp v47, v47, v47 row_ror:1 row_mask:0xf bank_mask:0xf
    s_add_u32 m0, s33, 38912
    s_nop 0
    buffer_load_dwordx4 v23, s[40:43], s76 offen offset:2048 lds
    v_fmac_f32 v152, v40, v64
    v_fmac_f32 v153, v41, v64
    v_fmac_f32 v154, v42, v64
    v_fmac_f32 v155, v43, v64
    v_fmac_f32 v168, v44, v64
    v_fmac_f32 v169, v45, v64
    v_fmac_f32 v170, v46, v64
    v_fmac_f32 v171, v47, v64
    s_add_u32 m0, s33, 45056
    s_nop 0
    buffer_load_dwordx4 v23, s[44:47], s76 offen offset:0 lds
    v_mul_f32 v80, v152, v152
    v_mul_f32 v81, v153, v153
    v_mul_f32 v82, v154, v154
    v_mul_f32 v83, v155, v155
    v_fma_f32 v80, v80, v66, v65
    v_fma_f32 v81, v81, v66, v65
    v_fma_f32 v82, v82, v66, v65
    v_fma_f32 v83, v83, v66, v65
    s_add_u32 m0, s33, 49152
    s_mov_b32 s77, 2981888
    buffer_load_dwordx4 v22, s[48:51], s77 offen offset:0 lds
    v_mul_f32 v80, v80, v152
    v_mul_f32 v81, v81, v153
    v_mul_f32 v82, v82, v154
    v_mul_f32 v83, v83, v155
    v_exp_f32 v80, v80
    v_mul_f32 v152, v152, v168
    v_exp_f32 v81, v81
    s_add_u32 m0, s33, 53248
    s_nop 0
    buffer_load_dwordx4 v22, s[52:55], s77 offen offset:0 lds
    v_mul_f32 v153, v153, v169
    v_exp_f32 v82, v82
    v_mul_f32 v154, v154, v170
    v_exp_f32 v83, v83
    v_mul_f32 v155, v155, v171
    v_fma_f32 v80, v80, v67, v67
    s_load_dword s94, s[10:11], s75 offset:0x80000
    s_load_dword s94, s[16:17], s34 offset:0xa8000
    s_load_dword s94, s[18:19], s34 offset:0xa8000
    s_load_dword s94, s[10:11], s75 offset:0x90000
    s_waitcnt vmcnt(16)
    s_barrier
    s_add_u32 m0, s79, 100352
    s_mov_b32 s78, 33664
    buffer_load_dwordx4 v20, s[36:39], s78 offen sc1 lds
    v_fma_f32 v81, v81, v67, v67
    v_fma_f32 v82, v82, v67, v67
    v_fma_f32 v83, v83, v67, v67
    v_rcp_f32 v80, v80
    v_rcp_f32 v81, v81
    v_rcp_f32 v82, v82
    s_add_u32 m0, s79, 101376
    s_nop 0
    buffer_load_dwordx4 v21, s[36:39], s78 offen sc1 lds
    v_rcp_f32 v83, v83
    s_nop 0
    v_mul_f32 v152, v152, v80
    v_mul_f32 v153, v153, v81
    v_mul_f32 v154, v154, v82
    v_mul_f32 v155, v155, v83
    v_cvt_pk_bf16_f32 v152, v152, v153
    v_cvt_pk_bf16_f32 v153, v154, v155
    s_add_u32 m0, s81, 114688
    s_mov_b32 s78, 896
    s_mov_b64 exec, 0xffffffff
    buffer_load_dwordx4 v3, s[36:39], s78 offen sc1 lds
    s_mov_b64 exec, -1
    v_fmac_f32 v156, v40, v68
    v_fmac_f32 v157, v41, v68
    v_fmac_f32 v158, v42, v68
    v_fmac_f32 v159, v43, v68
    v_fmac_f32 v172, v44, v68
    v_fmac_f32 v173, v45, v68
    v_fmac_f32 v174, v46, v68
    v_fmac_f32 v175, v47, v68
    s_add_u32 m0, s33, 57344
    s_mov_b32 s76, 2752512
    buffer_load_dwordx4 v23, s[40:43], s76 offen offset:0 lds
    v_mul_f32 v80, v156, v156
    v_mul_f32 v81, v157, v157
    v_mul_f32 v82, v158, v158
    v_mul_f32 v83, v159, v159
    v_fma_f32 v80, v80, v70, v69
    v_fma_f32 v81, v81, v70, v69
    v_fma_f32 v82, v82, v70, v69
    v_fma_f32 v83, v83, v70, v69
    s_add_u32 m0, s33, 59392
    s_nop 0
    buffer_load_dwordx4 v23, s[40:43], s76 offen offset:2048 lds
    v_mul_f32 v80, v80, v156
    v_mul_f32 v81, v81, v157
    v_mul_f32 v82, v82, v158
    v_mul_f32 v83, v83, v159
    v_exp_f32 v80, v80
    v_mul_f32 v156, v156, v172
    v_exp_f32 v81, v81
    s_add_u32 m0, s33, 65536
    s_nop 0
    buffer_load_dwordx4 v23, s[44:47], s76 offen offset:0 lds
    v_mul_f32 v157, v157, v173
    v_exp_f32 v82, v82
    v_mul_f32 v158, v158, v174
    v_exp_f32 v83, v83
    v_mul_f32 v159, v159, v175
    v_fma_f32 v80, v80, v71, v71
    s_add_u32 m0, s33, 69632
    s_mov_b32 s77, 3211264
    buffer_load_dwordx4 v22, s[48:51], s77 offen offset:0 lds
    v_fma_f32 v81, v81, v71, v71
    v_fma_f32 v82, v82, v71, v71
    v_fma_f32 v83, v83, v71, v71
    v_rcp_f32 v80, v80
    v_rcp_f32 v81, v81
    v_rcp_f32 v82, v82
    s_add_u32 m0, s33, 73728
    s_nop 0
    buffer_load_dwordx4 v22, s[52:55], s77 offen offset:0 lds
    v_rcp_f32 v83, v83
    s_nop 0
    v_mul_f32 v156, v156, v80
    v_mul_f32 v157, v157, v81
    v_mul_f32 v158, v158, v82
    v_mul_f32 v159, v159, v83
    v_cvt_pk_bf16_f32 v154, v156, v157
    v_cvt_pk_bf16_f32 v155, v158, v159
    s_load_dword s94, s[10:11], s75 offset:0xa0000
    s_load_dword s94, s[10:11], s75 offset:0xb0000
    s_load_dword s94, s[16:17], s34 offset:0xe0000
    s_load_dword s94, s[18:19], s34 offset:0xe0000
    s_waitcnt vmcnt(16)
    s_barrier
    s_add_u32 m0, s79, 116736
    s_mov_b32 s78, 1024
    buffer_load_dwordx4 v20, s[36:39], s78 offen sc1 lds
    s_nop 1
    v_permlane16_swap_b32 v152, v154
    v_permlane16_swap_b32 v153, v155
    buffer_store_dwordx4 v[152:155], v4, s[68:71], s73 offen offset:0 sc1
    v_fmac_f32 v160, v40, v72
    v_fmac_f32 v161, v41, v72
    v_fmac_f32 v162, v42, v72
    v_fmac_f32 v163, v43, v72
    v_fmac_f32 v176, v44, v72
    v_fmac_f32 v177, v45, v72
    v_fmac_f32 v178, v46, v72
    v_fmac_f32 v179, v47, v72
    s_add_u32 m0, s79, 117760
    s_nop 0
    buffer_load_dwordx4 v21, s[36:39], s78 offen sc1 lds
    v_mul_f32 v80, v160, v160
    v_mul_f32 v81, v161, v161
    v_mul_f32 v82, v162, v162
    v_mul_f32 v83, v163, v163
    v_fma_f32 v80, v80, v74, v73
    v_fma_f32 v81, v81, v74, v73
    v_fma_f32 v82, v82, v74, v73
    v_fma_f32 v83, v83, v74, v73
    s_add_u32 m0, s33, 77824
    s_mov_b32 s76, 2949120
    buffer_load_dwordx4 v23, s[40:43], s76 offen offset:0 lds
    v_mul_f32 v80, v80, v160
    v_mul_f32 v81, v81, v161
    v_mul_f32 v82, v82, v162
    v_mul_f32 v83, v83, v163
    v_exp_f32 v80, v80
    v_mul_f32 v160, v160, v176
    v_exp_f32 v81, v81
    s_add_u32 m0, s33, 79872
    s_nop 0
    buffer_load_dwordx4 v23, s[40:43], s76 offen offset:2048 lds
    v_mul_f32 v161, v161, v177
    v_exp_f32 v82, v82
    v_mul_f32 v162, v162, v178
    v_exp_f32 v83, v83
    v_mul_f32 v163, v163, v179
    v_fma_f32 v80, v80, v75, v75
    s_add_u32 m0, s33, 86016
    s_nop 0
    buffer_load_dwordx4 v23, s[44:47], s76 offen offset:0 lds
    v_fma_f32 v81, v81, v75, v75
    v_fma_f32 v82, v82, v75, v75
    v_fma_f32 v83, v83, v75, v75
    v_rcp_f32 v80, v80
    v_rcp_f32 v81, v81
    v_rcp_f32 v82, v82
    s_add_u32 m0, s33, 90112
    s_mov_b32 s77, 3440640
    buffer_load_dwordx4 v22, s[48:51], s77 offen offset:0 lds
    v_rcp_f32 v83, v83
    s_nop 0
    v_mul_f32 v160, v160, v80
    v_mul_f32 v161, v161, v81
    v_mul_f32 v162, v162, v82
    v_mul_f32 v163, v163, v83
    v_cvt_pk_bf16_f32 v160, v160, v161
    v_cvt_pk_bf16_f32 v161, v162, v163
    s_add_u32 m0, s33, 94208
    s_nop 0
    buffer_load_dwordx4 v22, s[52:55], s77 offen offset:0 lds
    v_fmac_f32 v164, v40, v76
    v_fmac_f32 v165, v41, v76
    v_fmac_f32 v166, v42, v76
    v_fmac_f32 v167, v43, v76
    v_fmac_f32 v180, v44, v76
    v_fmac_f32 v181, v45, v76
    v_fmac_f32 v182, v46, v76
    v_fmac_f32 v183, v47, v76
    s_add_u32 s75, s75, 0xffac0000
    s_load_dword s94, s[20:21], s75 offset:0x0
    s_add_u32 s75, s75, 0x280000
    s_load_dword s94, s[20:21], s75 offset:0x0
    s_add_u32 s75, s75, 0xffd90000
    s_load_dword s94, s[20:21], s75 offset:0x0
    s_add_u32 s75, s75, 0x280000
    s_load_dword s94, s[20:21], s75 offset:0x0
    s_waitcnt vmcnt(16)
    s_barrier
    s_add_u32 m0, s79, 118784
    s_mov_b32 s78, 33792
    buffer_load_dwordx4 v20, s[36:39], s78 offen sc1 lds
    v_mul_f32 v80, v164, v164
    v_mul_f32 v81, v165, v165
    v_mul_f32 v82, v166, v166
    v_mul_f32 v83, v167, v167
    v_fma_f32 v80, v80, v78, v77
    v_fma_f32 v81, v81, v78, v77
    v_fma_f32 v82, v82, v78, v77
    v_fma_f32 v83, v83, v78, v77
    s_add_u32 m0, s79, 119808
    s_nop 0
    buffer_load_dwordx4 v21, s[36:39], s78 offen sc1 lds
    v_mul_f32 v80, v80, v164
    v_mul_f32 v81, v81, v165
    v_mul_f32 v82, v82, v166
    v_mul_f32 v83, v83, v167
    v_exp_f32 v80, v80
    v_mul_f32 v164, v164, v180
    v_exp_f32 v81, v81
    s_add_u32 m0, s81, 133120
    s_mov_b32 s78, 1024
    s_mov_b64 exec, 0xffffffff
    buffer_load_dwordx4 v3, s[36:39], s78 offen sc1 lds
    s_mov_b64 exec, -1
    v_mul_f32 v165, v165, v181
    v_exp_f32 v82, v82
    v_mul_f32 v166, v166, v182
    v_exp_f32 v83, v83
    v_mul_f32 v167, v167, v183
    v_fma_f32 v80, v80, v79, v79
    s_add_u32 m0, s33, 16384
    s_mov_b32 s76, 3145728
    buffer_load_dwordx4 v23, s[40:43], s76 offen offset:0 lds
    v_fma_f32 v81, v81, v79, v79
    v_fma_f32 v82, v82, v79, v79
    v_fma_f32 v83, v83, v79, v79
    v_rcp_f32 v80, v80
    v_rcp_f32 v81, v81
    v_rcp_f32 v82, v82
    s_add_u32 m0, s33, 18432
    s_nop 0
    buffer_load_dwordx4 v23, s[40:43], s76 offen offset:2048 lds
    v_rcp_f32 v83, v83
    s_nop 0
    v_mul_f32 v164, v164, v80
    v_mul_f32 v165, v165, v81
    v_mul_f32 v166, v166, v82
    v_mul_f32 v167, v167, v83
    v_cvt_pk_bf16_f32 v162, v164, v165
    v_cvt_pk_bf16_f32 v163, v166, v167
    s_add_u32 m0, s33, 24576
    s_nop 0
    buffer_load_dwordx4 v23, s[44:47], s76 offen offset:0 lds
    s_nop 1
    v_permlane16_swap_b32 v160, v162
    v_permlane16_swap_b32 v161, v163
    buffer_store_dwordx4 v[160:163], v4, s[68:71], s73 offen offset:2048 sc1
    s_add_u32 m0, s33, 28672
    s_mov_b32 s77, 3670016
    buffer_load_dwordx4 v22, s[48:51], s77 offen offset:0 lds
    s_waitcnt vmcnt(63)
    v_add_f32_dpp v48, v48, v48 row_ror:8 row_mask:0xf bank_mask:0xf
    v_add_f32_dpp v49, v49, v49 row_ror:8 row_mask:0xf bank_mask:0xf
    v_add_f32_dpp v50, v50, v50 row_ror:8 row_mask:0xf bank_mask:0xf
    v_add_f32_dpp v51, v51, v51 row_ror:8 row_mask:0xf bank_mask:0xf
    v_add_f32_dpp v52, v52, v52 row_ror:8 row_mask:0xf bank_mask:0xf
    v_add_f32_dpp v53, v53, v53 row_ror:8 row_mask:0xf bank_mask:0xf
    v_add_f32_dpp v54, v54, v54 row_ror:8 row_mask:0xf bank_mask:0xf
    v_add_f32_dpp v55, v55, v55 row_ror:8 row_mask:0xf bank_mask:0xf
    s_add_u32 m0, s33, 32768
    s_nop 0
    buffer_load_dwordx4 v22, s[52:55], s77 offen offset:0 lds
    v_add_f32_dpp v48, v48, v48 row_ror:4 row_mask:0xf bank_mask:0xf
    v_add_f32_dpp v49, v49, v49 row_ror:4 row_mask:0xf bank_mask:0xf
    v_add_f32_dpp v50, v50, v50 row_ror:4 row_mask:0xf bank_mask:0xf
    v_add_f32_dpp v51, v51, v51 row_ror:4 row_mask:0xf bank_mask:0xf
    v_add_f32_dpp v52, v52, v52 row_ror:4 row_mask:0xf bank_mask:0xf
    v_add_f32_dpp v53, v53, v53 row_ror:4 row_mask:0xf bank_mask:0xf
    v_add_f32_dpp v54, v54, v54 row_ror:4 row_mask:0xf bank_mask:0xf
    v_add_f32_dpp v55, v55, v55 row_ror:4 row_mask:0xf bank_mask:0xf
    s_add_u32 s75, s75, 0xffd90000
    s_load_dword s94, s[20:21], s75 offset:0x0
    s_add_u32 s75, s75, 0x280000
    s_load_dword s94, s[20:21], s75 offset:0x0
    s_add_u32 s75, s75, 0xffd90000
    s_load_dword s94, s[20:21], s75 offset:0x0
    s_add_u32 s75, s75, 0x280000
    s_load_dword s94, s[20:21], s75 offset:0x0
    s_waitcnt vmcnt(17)
    s_barrier
    s_add_u32 m0, s79, 135168
    s_mov_b32 s78, 1152
    buffer_load_dwordx4 v20, s[36:39], s78 offen sc1 lds
    v_add_f32_dpp v48, v48, v48 row_ror:2 row_mask:0xf bank_mask:0xf
    v_add_f32_dpp v49, v49, v49 row_ror:2 row_mask:0xf bank_mask:0xf
    v_add_f32_dpp v50, v50, v50 row_ror:2 row_mask:0xf bank_mask:0xf
    v_add_f32_dpp v51, v51, v51 row_ror:2 row_mask:0xf bank_mask:0xf
    v_add_f32_dpp v52, v52, v52 row_ror:2 row_mask:0xf bank_mask:0xf
    v_add_f32_dpp v53, v53, v53 row_ror:2 row_mask:0xf bank_mask:0xf
    v_add_f32_dpp v54, v54, v54 row_ror:2 row_mask:0xf bank_mask:0xf
    v_add_f32_dpp v55, v55, v55 row_ror:2 row_mask:0xf bank_mask:0xf
    v_add_f32_dpp v48, v48, v48 row_ror:1 row_mask:0xf bank_mask:0xf
    v_add_f32_dpp v49, v49, v49 row_ror:1 row_mask:0xf bank_mask:0xf
    v_add_f32_dpp v50, v50, v50 row_ror:1 row_mask:0xf bank_mask:0xf
    v_add_f32_dpp v51, v51, v51 row_ror:1 row_mask:0xf bank_mask:0xf
    v_add_f32_dpp v52, v52, v52 row_ror:1 row_mask:0xf bank_mask:0xf
    v_add_f32_dpp v53, v53, v53 row_ror:1 row_mask:0xf bank_mask:0xf
    v_add_f32_dpp v54, v54, v54 row_ror:1 row_mask:0xf bank_mask:0xf
    v_add_f32_dpp v55, v55, v55 row_ror:1 row_mask:0xf bank_mask:0xf
    s_add_u32 m0, s79, 136192
    s_nop 0
    buffer_load_dwordx4 v21, s[36:39], s78 offen sc1 lds
    v_fmac_f32 v184, v48, v64
    v_fmac_f32 v185, v49, v64
    v_fmac_f32 v186, v50, v64
    v_fmac_f32 v187, v51, v64
    v_fmac_f32 v200, v52, v64
    v_fmac_f32 v201, v53, v64
    v_fmac_f32 v202, v54, v64
    v_fmac_f32 v203, v55, v64
    s_add_u32 m0, s33, 36864
    s_mov_b32 s76, 3342336
    buffer_load_dwordx4 v23, s[40:43], s76 offen offset:0 lds
    v_mul_f32 v80, v184, v184
    v_mul_f32 v81, v185, v185
    v_mul_f32 v82, v186, v186
    v_mul_f32 v83, v187, v187
    v_fma_f32 v80, v80, v66, v65
    v_fma_f32 v81, v81, v66, v65
    v_fma_f32 v82, v82, v66, v65
    v_fma_f32 v83, v83, v66, v65
    s_add_u32 m0, s33, 38912
    s_nop 0
    buffer_load_dwordx4 v23, s[40:43], s76 offen offset:2048 lds
    v_mul_f32 v80, v80, v184
    v_mul_f32 v81, v81, v185
    v_mul_f32 v82, v82, v186
    v_mul_f32 v83, v83, v187
    v_exp_f32 v80, v80
    v_mul_f32 v184, v184, v200
    v_exp_f32 v81, v81
    s_add_u32 m0, s33, 45056
    s_nop 0
    buffer_load_dwordx4 v23, s[44:47], s76 offen offset:0 lds
    v_mul_f32 v185, v185, v201
    v_exp_f32 v82, v82
    v_mul_f32 v186, v186, v202
    v_exp_f32 v83, v83
    v_mul_f32 v187, v187, v203
    v_fma_f32 v80, v80, v67, v67
    s_add_u32 m0, s33, 49152
    s_mov_b32 s77, 3899392
    buffer_load_dwordx4 v22, s[48:51], s77 offen offset:0 lds
    v_fma_f32 v81, v81, v67, v67
    v_fma_f32 v82, v82, v67, v67
    v_fma_f32 v83, v83, v67, v67
    v_rcp_f32 v80, v80
    v_rcp_f32 v81, v81
    v_rcp_f32 v82, v82
    s_add_u32 m0, s33, 53248
    s_nop 0
    buffer_load_dwordx4 v22, s[52:55], s77 offen offset:0 lds
    v_rcp_f32 v83, v83
    s_nop 0
    v_mul_f32 v184, v184, v80
    v_mul_f32 v185, v185, v81
    v_mul_f32 v186, v186, v82
    v_mul_f32 v187, v187, v83
    v_cvt_pk_bf16_f32 v184, v184, v185
    v_cvt_pk_bf16_f32 v185, v186, v187
    s_add_u32 s75, s75, 0xffd90000
    s_load_dword s94, s[20:21], s75 offset:0x0
    s_add_u32 s75, s75, 0x280000
    s_load_dword s94, s[20:21], s75 offset:0x0
    s_add_u32 s75, s75, 0xffd90000
    s_load_dword s94, s[20:21], s75 offset:0x0
    s_add_u32 s75, s75, 0x280000
    s_load_dword s94, s[20:21], s75 offset:0x0
    s_waitcnt vmcnt(16)
    s_barrier
    s_add_u32 m0, s79, 137216
    s_mov_b32 s78, 33920
    buffer_load_dwordx4 v20, s[36:39], s78 offen sc1 lds
    v_fmac_f32 v188, v48, v68
    v_fmac_f32 v189, v49, v68
    v_fmac_f32 v190, v50, v68
    v_fmac_f32 v191, v51, v68
    v_fmac_f32 v204, v52, v68
    v_fmac_f32 v205, v53, v68
    v_fmac_f32 v206, v54, v68
    v_fmac_f32 v207, v55, v68
    s_add_u32 m0, s79, 138240
    s_nop 0
    buffer_load_dwordx4 v21, s[36:39], s78 offen sc1 lds
    v_mul_f32 v80, v188, v188
    v_mul_f32 v81, v189, v189
    v_mul_f32 v82, v190, v190
    v_mul_f32 v83, v191, v191
    v_fma_f32 v80, v80, v70, v69
    v_fma_f32 v81, v81, v70, v69
    v_fma_f32 v82, v82, v70, v69
    v_fma_f32 v83, v83, v70, v69
    s_add_u32 m0, s81, 151552
    s_mov_b32 s78, 1152
    s_mov_b64 exec, 0xffffffff
    buffer_load_dwordx4 v3, s[36:39], s78 offen sc1 lds
    s_mov_b64 exec, -1
    v_mul_f32 v80, v80, v188
    v_mul_f32 v81, v81, v189
    v_mul_f32 v82, v82, v190
    v_mul_f32 v83, v83, v191
    v_exp_f32 v80, v80
    v_mul_f32 v188, v188, v204
    v_exp_f32 v81, v81
    s_add_u32 m0, s33, 57344
    s_mov_b32 s76, 3538944
    buffer_load_dwordx4 v23, s[40:43], s76 offen offset:0 lds
    v_mul_f32 v189, v189, v205
    v_exp_f32 v82, v82
    v_mul_f32 v190, v190, v206
    v_exp_f32 v83, v83
    v_mul_f32 v191, v191, v207
    v_fma_f32 v80, v80, v71, v71
    s_add_u32 m0, s33, 59392
    s_nop 0
    buffer_load_dwordx4 v23, s[40:43], s76 offen offset:2048 lds
    v_fma_f32 v81, v81, v71, v71
    v_fma_f32 v82, v82, v71, v71
    v_fma_f32 v83, v83, v71, v71
    v_rcp_f32 v80, v80
    v_rcp_f32 v81, v81
    v_rcp_f32 v82, v82
    s_add_u32 m0, s33, 65536
    s_nop 0
    buffer_load_dwordx4 v23, s[44:47], s76 offen offset:0 lds
    v_rcp_f32 v83, v83
    s_nop 0
    v_mul_f32 v188, v188, v80
    v_mul_f32 v189, v189, v81
    v_mul_f32 v190, v190, v82
    v_mul_f32 v191, v191, v83
    v_cvt_pk_bf16_f32 v186, v188, v189
    v_cvt_pk_bf16_f32 v187, v190, v191
    s_add_u32 m0, s33, 69632
    s_mov_b32 s77, 4128768
    buffer_load_dwordx4 v22, s[48:51], s77 offen offset:0 lds
    s_nop 1
    v_permlane16_swap_b32 v184, v186
    v_permlane16_swap_b32 v185, v187
    buffer_store_dwordx4 v[184:187], v4, s[68:71], s73 offen offset:512 sc1
    s_add_u32 m0, s33, 73728
    s_nop 0
    buffer_load_dwordx4 v22, s[52:55], s77 offen offset:0 lds
    v_fmac_f32 v192, v48, v72
    v_fmac_f32 v193, v49, v72
    v_fmac_f32 v194, v50, v72
    v_fmac_f32 v195, v51, v72
    v_fmac_f32 v208, v52, v72
    v_fmac_f32 v209, v53, v72
    v_fmac_f32 v210, v54, v72
    v_fmac_f32 v211, v55, v72
    s_add_u32 s75, s75, 0xffd90000
    s_load_dword s94, s[20:21], s75 offset:0x0
    s_add_u32 s75, s75, 0x280000
    s_load_dword s94, s[20:21], s75 offset:0x0
    s_add_u32 s75, s75, 0xffd90000
    s_load_dword s94, s[20:21], s75 offset:0x0
    s_add_u32 s75, s75, 0x280000
    s_load_dword s94, s[20:21], s75 offset:0x0
    s_waitcnt vmcnt(16)
    s_barrier
    s_add_u32 m0, s79, 98304
    s_mov_b32 s78, 1280
    buffer_load_dwordx4 v20, s[36:39], s78 offen sc1 lds
    v_mul_f32 v80, v192, v192
    v_mul_f32 v81, v193, v193
    v_mul_f32 v82, v194, v194
    v_mul_f32 v83, v195, v195
    v_fma_f32 v80, v80, v74, v73
    v_fma_f32 v81, v81, v74, v73
    v_fma_f32 v82, v82, v74, v73
    v_fma_f32 v83, v83, v74, v73
    v_mul_f32 v80, v80, v192
    v_mul_f32 v81, v81, v193
    v_mul_f32 v82, v82, v194
    v_mul_f32 v83, v83, v195
    v_exp_f32 v80, v80
    v_mul_f32 v192, v192, v208
    v_exp_f32 v81, v81
    s_add_u32 m0, s79, 99328
    s_nop 0
    buffer_load_dwordx4 v21, s[36:39], s78 offen sc1 lds
    v_mul_f32 v193, v193, v209
    v_exp_f32 v82, v82
    v_mul_f32 v194, v194, v210
    v_exp_f32 v83, v83
    v_mul_f32 v195, v195, v211
    v_fma_f32 v80, v80, v75, v75
    s_add_u32 m0, s33, 77824
    s_mov_b32 s76, 3735552
    buffer_load_dwordx4 v23, s[40:43], s76 offen offset:0 lds
    v_fma_f32 v81, v81, v75, v75
    v_fma_f32 v82, v82, v75, v75
    v_fma_f32 v83, v83, v75, v75
    v_rcp_f32 v80, v80
    v_rcp_f32 v81, v81
    v_rcp_f32 v82, v82
    s_add_u32 m0, s33, 79872
    s_nop 0
    buffer_load_dwordx4 v23, s[40:43], s76 offen offset:2048 lds
    v_rcp_f32 v83, v83
    s_nop 0
    v_mul_f32 v192, v192, v80
    v_mul_f32 v193, v193, v81
    v_mul_f32 v194, v194, v82
    v_mul_f32 v195, v195, v83
    v_cvt_pk_bf16_f32 v192, v192, v193
    v_cvt_pk_bf16_f32 v193, v194, v195
    s_add_u32 m0, s33, 86016
    s_nop 0
    buffer_load_dwordx4 v23, s[44:47], s76 offen offset:0 lds
    v_fmac_f32 v196, v48, v76
    v_fmac_f32 v197, v49, v76
    v_fmac_f32 v198, v50, v76
    v_fmac_f32 v199, v51, v76
    v_fmac_f32 v212, v52, v76
    v_fmac_f32 v213, v53, v76
    v_fmac_f32 v214, v54, v76
    v_fmac_f32 v215, v55, v76
    s_add_u32 m0, s33, 90112
    s_mov_b32 s77, 4358144
    buffer_load_dwordx4 v22, s[48:51], s77 offen offset:0 lds
    v_mul_f32 v80, v196, v196
    v_mul_f32 v81, v197, v197
    v_mul_f32 v82, v198, v198
    v_mul_f32 v83, v199, v199
    v_fma_f32 v80, v80, v78, v77
    v_fma_f32 v81, v81, v78, v77
    v_fma_f32 v82, v82, v78, v77
    v_fma_f32 v83, v83, v78, v77
    s_add_u32 m0, s33, 94208
    s_nop 0
    buffer_load_dwordx4 v22, s[52:55], s77 offen offset:0 lds
    v_mul_f32 v80, v80, v196
    v_mul_f32 v81, v81, v197
    v_mul_f32 v82, v82, v198
    v_mul_f32 v83, v83, v199
    v_exp_f32 v80, v80
    v_mul_f32 v196, v196, v212
    v_exp_f32 v81, v81
    s_add_u32 s75, s75, 0xffd90000
    s_load_dword s94, s[20:21], s75 offset:0x0
    s_add_u32 s75, s75, 0x280000
    s_load_dword s94, s[20:21], s75 offset:0x0
    s_add_u32 s75, s75, 0xffd90000
    s_load_dword s94, s[20:21], s75 offset:0x0
    s_add_u32 s75, s75, 0x280000
    s_load_dword s94, s[20:21], s75 offset:0x0
    s_waitcnt vmcnt(16)
    s_barrier
    s_add_u32 m0, s79, 100352
    s_mov_b32 s78, 34048
    buffer_load_dwordx4 v20, s[36:39], s78 offen sc1 lds
    v_mul_f32 v197, v197, v213
    v_exp_f32 v82, v82
    v_mul_f32 v198, v198, v214
    v_exp_f32 v83, v83
    v_mul_f32 v199, v199, v215
    v_fma_f32 v80, v80, v79, v79
    s_add_u32 m0, s79, 101376
    s_nop 0
    buffer_load_dwordx4 v21, s[36:39], s78 offen sc1 lds
    v_fma_f32 v81, v81, v79, v79
    v_fma_f32 v82, v82, v79, v79
    v_fma_f32 v83, v83, v79, v79
    v_rcp_f32 v80, v80
    v_rcp_f32 v81, v81
    v_rcp_f32 v82, v82
    s_add_u32 m0, s81, 114688
    s_mov_b32 s78, 1280
    s_mov_b64 exec, 0xffffffff
    buffer_load_dwordx4 v3, s[36:39], s78 offen sc1 lds
    s_mov_b64 exec, -1
    v_rcp_f32 v83, v83
    s_nop 0
    v_mul_f32 v196, v196, v80
    v_mul_f32 v197, v197, v81
    v_mul_f32 v198, v198, v82
    v_mul_f32 v199, v199, v83
    v_cvt_pk_bf16_f32 v194, v196, v197
    v_cvt_pk_bf16_f32 v195, v198, v199
    s_add_u32 m0, s33, 16384
    s_mov_b32 s76, 3932160
    buffer_load_dwordx4 v23, s[40:43], s76 offen offset:0 lds
    s_nop 1
    v_permlane16_swap_b32 v192, v194
    v_permlane16_swap_b32 v193, v195
    buffer_store_dwordx4 v[192:195], v4, s[68:71], s73 offen offset:2560 sc1
    s_waitcnt vmcnt(63)
    v_add_f32_dpp v56, v56, v56 row_ror:8 row_mask:0xf bank_mask:0xf
    v_add_f32_dpp v57, v57, v57 row_ror:8 row_mask:0xf bank_mask:0xf
    v_add_f32_dpp v58, v58, v58 row_ror:8 row_mask:0xf bank_mask:0xf
    v_add_f32_dpp v59, v59, v59 row_ror:8 row_mask:0xf bank_mask:0xf
    v_add_f32_dpp v60, v60, v60 row_ror:8 row_mask:0xf bank_mask:0xf
    v_add_f32_dpp v61, v61, v61 row_ror:8 row_mask:0xf bank_mask:0xf
    v_add_f32_dpp v62, v62, v62 row_ror:8 row_mask:0xf bank_mask:0xf
    v_add_f32_dpp v63, v63, v63 row_ror:8 row_mask:0xf bank_mask:0xf
    s_add_u32 m0, s33, 18432
    s_nop 0
    buffer_load_dwordx4 v23, s[40:43], s76 offen offset:2048 lds
    v_add_f32_dpp v56, v56, v56 row_ror:4 row_mask:0xf bank_mask:0xf
    v_add_f32_dpp v57, v57, v57 row_ror:4 row_mask:0xf bank_mask:0xf
    v_add_f32_dpp v58, v58, v58 row_ror:4 row_mask:0xf bank_mask:0xf
    v_add_f32_dpp v59, v59, v59 row_ror:4 row_mask:0xf bank_mask:0xf
    v_add_f32_dpp v60, v60, v60 row_ror:4 row_mask:0xf bank_mask:0xf
    v_add_f32_dpp v61, v61, v61 row_ror:4 row_mask:0xf bank_mask:0xf
    v_add_f32_dpp v62, v62, v62 row_ror:4 row_mask:0xf bank_mask:0xf
    v_add_f32_dpp v63, v63, v63 row_ror:4 row_mask:0xf bank_mask:0xf
    s_add_u32 m0, s33, 24576
    s_nop 0
    buffer_load_dwordx4 v23, s[44:47], s76 offen offset:0 lds
    v_add_f32_dpp v56, v56, v56 row_ror:2 row_mask:0xf bank_mask:0xf
    v_add_f32_dpp v57, v57, v57 row_ror:2 row_mask:0xf bank_mask:0xf
    v_add_f32_dpp v58, v58, v58 row_ror:2 row_mask:0xf bank_mask:0xf
    v_add_f32_dpp v59, v59, v59 row_ror:2 row_mask:0xf bank_mask:0xf
    v_add_f32_dpp v60, v60, v60 row_ror:2 row_mask:0xf bank_mask:0xf
    v_add_f32_dpp v61, v61, v61 row_ror:2 row_mask:0xf bank_mask:0xf
    v_add_f32_dpp v62, v62, v62 row_ror:2 row_mask:0xf bank_mask:0xf
    v_add_f32_dpp v63, v63, v63 row_ror:2 row_mask:0xf bank_mask:0xf
    s_add_u32 m0, s33, 28672
    s_mov_b32 s77, 4587520
    buffer_load_dwordx4 v22, s[48:51], s77 offen offset:0 lds
    v_add_f32_dpp v56, v56, v56 row_ror:1 row_mask:0xf bank_mask:0xf
    v_add_f32_dpp v57, v57, v57 row_ror:1 row_mask:0xf bank_mask:0xf
    v_add_f32_dpp v58, v58, v58 row_ror:1 row_mask:0xf bank_mask:0xf
    v_add_f32_dpp v59, v59, v59 row_ror:1 row_mask:0xf bank_mask:0xf
    v_add_f32_dpp v60, v60, v60 row_ror:1 row_mask:0xf bank_mask:0xf
    v_add_f32_dpp v61, v61, v61 row_ror:1 row_mask:0xf bank_mask:0xf
    v_add_f32_dpp v62, v62, v62 row_ror:1 row_mask:0xf bank_mask:0xf
    v_add_f32_dpp v63, v63, v63 row_ror:1 row_mask:0xf bank_mask:0xf
    s_add_u32 m0, s33, 32768
    s_nop 0
    buffer_load_dwordx4 v22, s[52:55], s77 offen offset:0 lds
    v_fmac_f32 v216, v56, v64
    v_fmac_f32 v217, v57, v64
    v_fmac_f32 v218, v58, v64
    v_fmac_f32 v219, v59, v64
    v_fmac_f32 v232, v60, v64
    v_fmac_f32 v233, v61, v64
    v_fmac_f32 v234, v62, v64
    v_fmac_f32 v235, v63, v64
    s_add_u32 s75, s75, 0xffd90000
    s_load_dword s94, s[20:21], s75 offset:0x0
    s_add_u32 s75, s75, 0x280000
    s_load_dword s94, s[20:21], s75 offset:0x0
    s_add_u32 s75, s75, 0xffd90000
    s_load_dword s94, s[20:21], s75 offset:0x0
    s_add_u32 s75, s75, 0x280000
    s_load_dword s94, s[20:21], s75 offset:0x0
    s_waitcnt vmcnt(16)
    s_barrier
    s_add_u32 m0, s79, 116736
    s_mov_b32 s78, 1408
    buffer_load_dwordx4 v20, s[36:39], s78 offen sc1 lds
    v_mul_f32 v80, v216, v216
    v_mul_f32 v81, v217, v217
    v_mul_f32 v82, v218, v218
    v_mul_f32 v83, v219, v219
    v_fma_f32 v80, v80, v66, v65
    v_fma_f32 v81, v81, v66, v65
    v_fma_f32 v82, v82, v66, v65
    v_fma_f32 v83, v83, v66, v65
    v_mul_f32 v80, v80, v216
    v_mul_f32 v81, v81, v217
    v_mul_f32 v82, v82, v218
    v_mul_f32 v83, v83, v219
    v_exp_f32 v80, v80
    v_mul_f32 v216, v216, v232
    v_exp_f32 v81, v81
    s_add_u32 m0, s79, 117760
    s_nop 0
    buffer_load_dwordx4 v21, s[36:39], s78 offen sc1 lds
    v_mul_f32 v217, v217, v233
    v_exp_f32 v82, v82
    v_mul_f32 v218, v218, v234
    v_exp_f32 v83, v83
    v_mul_f32 v219, v219, v235
    v_fma_f32 v80, v80, v67, v67
    s_add_u32 m0, s33, 36864
    s_mov_b32 s76, 4128768
    buffer_load_dwordx4 v23, s[40:43], s76 offen offset:0 lds
    v_fma_f32 v81, v81, v67, v67
    v_fma_f32 v82, v82, v67, v67
    v_fma_f32 v83, v83, v67, v67
    v_rcp_f32 v80, v80
    v_rcp_f32 v81, v81
    v_rcp_f32 v82, v82
    s_add_u32 m0, s33, 38912
    s_nop 0
    buffer_load_dwordx4 v23, s[40:43], s76 offen offset:2048 lds
    v_rcp_f32 v83, v83
    s_nop 0
    v_mul_f32 v216, v216, v80
    v_mul_f32 v217, v217, v81
    v_mul_f32 v218, v218, v82
    v_mul_f32 v219, v219, v83
    v_cvt_pk_bf16_f32 v216, v216, v217
    v_cvt_pk_bf16_f32 v217, v218, v219
    s_add_u32 m0, s33, 45056
    s_nop 0
    buffer_load_dwordx4 v23, s[44:47], s76 offen offset:0 lds
    v_fmac_f32 v220, v56, v68
    v_fmac_f32 v221, v57, v68
    v_fmac_f32 v222, v58, v68
    v_fmac_f32 v223, v59, v68
    v_fmac_f32 v236, v60, v68
    v_fmac_f32 v237, v61, v68
    v_fmac_f32 v238, v62, v68
    v_fmac_f32 v239, v63, v68
    s_add_u32 m0, s33, 49152
    s_mov_b32 s77, 4816896
    buffer_load_dwordx4 v22, s[48:51], s77 offen offset:0 lds
    v_mul_f32 v80, v220, v220
    v_mul_f32 v81, v221, v221
    v_mul_f32 v82, v222, v222
    v_mul_f32 v83, v223, v223
    v_fma_f32 v80, v80, v70, v69
    v_fma_f32 v81, v81, v70, v69
    v_fma_f32 v82, v82, v70, v69
    v_fma_f32 v83, v83, v70, v69
    s_add_u32 m0, s33, 53248
    s_nop 0
    buffer_load_dwordx4 v22, s[52:55], s77 offen offset:0 lds
    v_mul_f32 v80, v80, v220
    v_mul_f32 v81, v81, v221
    v_mul_f32 v82, v82, v222
    v_mul_f32 v83, v83, v223
    v_exp_f32 v80, v80
    v_mul_f32 v220, v220, v236
    v_exp_f32 v81, v81
    s_add_u32 s75, s75, 0xffd90000
    s_load_dword s94, s[20:21], s75 offset:0x0
    s_add_u32 s75, s75, 0x280000
    s_load_dword s94, s[20:21], s75 offset:0x0
    s_add_u32 s75, s75, 0xffd90000
    s_load_dword s94, s[20:21], s75 offset:0x0
    s_add_u32 s75, s75, 0x280000
    s_load_dword s94, s[20:21], s75 offset:0x0
    s_waitcnt vmcnt(16)
    s_barrier
    s_add_u32 m0, s79, 118784
    s_mov_b32 s78, 34176
    buffer_load_dwordx4 v20, s[36:39], s78 offen sc1 lds
    v_mul_f32 v221, v221, v237
    v_exp_f32 v82, v82
    v_mul_f32 v222, v222, v238
    v_exp_f32 v83, v83
    v_mul_f32 v223, v223, v239
    v_fma_f32 v80, v80, v71, v71
    s_add_u32 m0, s79, 119808
    s_nop 0
    buffer_load_dwordx4 v21, s[36:39], s78 offen sc1 lds
    v_fma_f32 v81, v81, v71, v71
    v_fma_f32 v82, v82, v71, v71
    v_fma_f32 v83, v83, v71, v71
    v_rcp_f32 v80, v80
    v_rcp_f32 v81, v81
    v_rcp_f32 v82, v82
    s_add_u32 m0, s81, 133120
    s_mov_b32 s78, 1408
    s_mov_b64 exec, 0xffffffff
    buffer_load_dwordx4 v3, s[36:39], s78 offen sc1 lds
    s_mov_b64 exec, -1
    v_rcp_f32 v83, v83
    s_nop 0
    v_mul_f32 v220, v220, v80
    v_mul_f32 v221, v221, v81
    v_mul_f32 v222, v222, v82
    v_mul_f32 v223, v223, v83
    v_cvt_pk_bf16_f32 v218, v220, v221
    v_cvt_pk_bf16_f32 v219, v222, v223
    s_add_u32 m0, s33, 57344
    s_mov_b32 s76, 4325376
    buffer_load_dwordx4 v23, s[40:43], s76 offen offset:0 lds
    s_nop 1
    v_permlane16_swap_b32 v216, v218
    v_permlane16_swap_b32 v217, v219
    buffer_store_dwordx4 v[216:219], v4, s[68:71], s74 offen offset:0 sc1
    v_fmac_f32 v224, v56, v72
    v_fmac_f32 v225, v57, v72
    v_fmac_f32 v226, v58, v72
    v_fmac_f32 v227, v59, v72
    v_fmac_f32 v240, v60, v72
    v_fmac_f32 v241, v61, v72
    v_fmac_f32 v242, v62, v72
    v_fmac_f32 v243, v63, v72
    s_add_u32 m0, s33, 59392
    s_nop 0
    buffer_load_dwordx4 v23, s[40:43], s76 offen offset:2048 lds
    v_mul_f32 v80, v224, v224
    v_mul_f32 v81, v225, v225
    v_mul_f32 v82, v226, v226
    v_mul_f32 v83, v227, v227
    v_fma_f32 v80, v80, v74, v73
    v_fma_f32 v81, v81, v74, v73
    v_fma_f32 v82, v82, v74, v73
    v_fma_f32 v83, v83, v74, v73
    s_add_u32 m0, s33, 65536
    s_nop 0
    buffer_load_dwordx4 v23, s[44:47], s76 offen offset:0 lds
    v_mul_f32 v80, v80, v224
    v_mul_f32 v81, v81, v225
    v_mul_f32 v82, v82, v226
    v_mul_f32 v83, v83, v227
    v_exp_f32 v80, v80
    v_mul_f32 v224, v224, v240
    v_exp_f32 v81, v81
    s_add_u32 m0, s33, 69632
    s_mov_b32 s77, 5046272
    buffer_load_dwordx4 v22, s[48:51], s77 offen offset:0 lds
    s_add_u32 m0, s33, 73728
    s_nop 0
    buffer_load_dwordx4 v22, s[52:55], s77 offen offset:0 lds
    v_mul_f32 v225, v225, v241
    v_exp_f32 v82, v82
    v_mul_f32 v226, v226, v242
    v_exp_f32 v83, v83
    v_mul_f32 v227, v227, v243
    v_fma_f32 v80, v80, v75, v75
    s_add_u32 s75, s75, 0xffd90000
    s_load_dword s94, s[20:21], s75 offset:0x0
    s_add_u32 s75, s75, 0x280000
    s_load_dword s94, s[20:21], s75 offset:0x0
    s_add_u32 s75, s75, 0xffd90000
    s_load_dword s94, s[20:21], s75 offset:0x0
    s_add_u32 s75, s75, 0x280000
    s_load_dword s94, s[20:21], s75 offset:0x0
    s_waitcnt vmcnt(16)
    s_barrier
    s_add_u32 m0, s79, 135168
    s_mov_b32 s78, 1536
    buffer_load_dwordx4 v20, s[36:39], s78 offen sc1 lds
    v_fma_f32 v81, v81, v75, v75
    v_fma_f32 v82, v82, v75, v75
    v_fma_f32 v83, v83, v75, v75
    v_rcp_f32 v80, v80
    v_rcp_f32 v81, v81
    v_rcp_f32 v82, v82
    s_add_u32 m0, s79, 136192
    s_nop 0
    buffer_load_dwordx4 v21, s[36:39], s78 offen sc1 lds
    v_rcp_f32 v83, v83
    s_nop 0
    v_mul_f32 v224, v224, v80
    v_mul_f32 v225, v225, v81
    v_mul_f32 v226, v226, v82
    v_mul_f32 v227, v227, v83
    v_cvt_pk_bf16_f32 v224, v224, v225
    v_cvt_pk_bf16_f32 v225, v226, v227
    v_fmac_f32 v228, v56, v76
    v_fmac_f32 v229, v57, v76
    v_fmac_f32 v230, v58, v76
    v_fmac_f32 v231, v59, v76
    v_fmac_f32 v244, v60, v76
    v_fmac_f32 v245, v61, v76
    v_fmac_f32 v246, v62, v76
    v_fmac_f32 v247, v63, v76
    s_add_u32 m0, s33, 77824
    s_mov_b32 s76, 4521984
    buffer_load_dwordx4 v23, s[40:43], s76 offen offset:0 lds
    v_mul_f32 v80, v228, v228
    v_mul_f32 v81, v229, v229
    v_mul_f32 v82, v230, v230
    v_mul_f32 v83, v231, v231
    v_fma_f32 v80, v80, v78, v77
    v_fma_f32 v81, v81, v78, v77
    v_fma_f32 v82, v82, v78, v77
    v_fma_f32 v83, v83, v78, v77
    s_add_u32 m0, s33, 79872
    s_nop 0
    buffer_load_dwordx4 v23, s[40:43], s76 offen offset:2048 lds
    v_mul_f32 v80, v80, v228
    v_mul_f32 v81, v81, v229
    v_mul_f32 v82, v82, v230
    v_mul_f32 v83, v83, v231
    v_exp_f32 v80, v80
    v_mul_f32 v228, v228, v244
    v_exp_f32 v81, v81
    s_add_u32 m0, s33, 86016
    s_nop 0
    buffer_load_dwordx4 v23, s[44:47], s76 offen offset:0 lds
    v_mul_f32 v229, v229, v245
    v_exp_f32 v82, v82
    v_mul_f32 v230, v230, v246
    v_exp_f32 v83, v83
    v_mul_f32 v231, v231, v247
    v_fma_f32 v80, v80, v79, v79
    s_add_u32 m0, s33, 90112
    s_mov_b32 s77, 5275648
    buffer_load_dwordx4 v22, s[48:51], s77 offen offset:0 lds
    v_fma_f32 v81, v81, v79, v79
    v_fma_f32 v82, v82, v79, v79
    v_fma_f32 v83, v83, v79, v79
    v_rcp_f32 v80, v80
    v_rcp_f32 v81, v81
    v_rcp_f32 v82, v82
    s_add_u32 m0, s33, 94208
    s_nop 0
    buffer_load_dwordx4 v22, s[52:55], s77 offen offset:0 lds
    v_rcp_f32 v83, v83
    s_nop 0
    v_mul_f32 v228, v228, v80
    v_mul_f32 v229, v229, v81
    v_mul_f32 v230, v230, v82
    v_mul_f32 v231, v231, v83
    v_cvt_pk_bf16_f32 v226, v228, v229
    v_cvt_pk_bf16_f32 v227, v230, v231
    s_add_u32 s75, s75, 0xffd90000
    s_load_dword s94, s[20:21], s75 offset:0x0
    s_add_u32 s75, s75, 0x280000
    s_load_dword s94, s[20:21], s75 offset:0x0
    s_add_u32 s75, s75, 0xffd90000
    s_load_dword s94, s[20:21], s75 offset:0x0
    s_add_u32 s75, s75, 0x280000
    s_load_dword s94, s[20:21], s75 offset:0x0
    s_waitcnt vmcnt(16)
    s_barrier
    s_add_u32 m0, s79, 137216
    s_mov_b32 s78, 34304
    buffer_load_dwordx4 v20, s[36:39], s78 offen sc1 lds
    s_nop 1
    v_permlane16_swap_b32 v224, v226
    v_permlane16_swap_b32 v225, v227
    buffer_store_dwordx4 v[224:227], v4, s[68:71], s74 offen offset:2048 sc1
    v_lshrrev_b32 v64, 4, v1
    v_bfe_u32 v65, v1, 2, 2
    v_and_b32 v66, 3, v1
    v_and_b32 v67, 15, v1
    v_lshrrev_b32 v68, 3, v1
    v_and_b32 v69, 7, v1
    s_lshl_b32 s85, s6, 2
    v_lshl_add_u32 v70, v64, 3, v65
    v_lshlrev_b32 v70, 7, v70
    s_add_u32 m0, s79, 138240
    s_nop 0
    buffer_load_dwordx4 v21, s[36:39], s78 offen sc1 lds
    v_and_b32 v71, 1, v66
    v_lshl_add_u32 v70, v71, 3, v70
    v_add_u32 v70, 0, v70
    v_and_b32 v71, 2, v65
    v_and_b32 v72, 1, v64
    v_lshl_add_u32 v71, v72, 2, v71
    v_lshrrev_b32 v72, 1, v66
    v_xor_b32 v71, v71, v72
    s_add_u32 m0, s81, 151552
    s_mov_b32 s78, 1536
    s_mov_b64 exec, 0xffffffff
    buffer_load_dwordx4 v3, s[36:39], s78 offen sc1 lds
    s_mov_b64 exec, -1
    v_xor_b32 v71, s85, v71
    v_xor_b32 v72, 0, v71
    v_lshl_add_u32 v6, v72, 4, v70
    v_add_u32 v8, 65536, v6
    v_xor_b32 v72, 2, v71
    v_lshl_add_u32 v7, v72, 4, v70
    v_add_u32 v9, 65536, v7
    s_lshl_b32 s85, s5, 12
    v_lshl_add_u32 v4, v1, 4, s85
    s_add_u32 m0, s33, 16384
    s_mov_b32 s76, 4718592
    buffer_load_dwordx4 v23, s[40:43], s76 offen offset:0 lds
    v_add_u32 v5, 65536, v4
    s_lshl_b32 s85, s4, 12
    v_lshl_add_u32 v10, v1, 4, s85
    s_lshl_b32 s85, s4, 4
    v_and_b32 v70, 2, v68
    v_xor_b32 v70, v70, v69
    v_xor_b32 v70, 0, v70
    v_add_u32 v71, s85, v68
    v_mul_u32_u24 v71, 2048, v71
    v_lshl_add_u32 v11, v70, 4, v71
    s_add_u32 m0, s33, 18432
    s_nop 0
    buffer_load_dwordx4 v23, s[40:43], s76 offen offset:2048 lds
    s_add_u32 s85, s85, 8
    v_and_b32 v70, 2, v68
    v_xor_b32 v70, v70, v69
    v_xor_b32 v70, 4, v70
    v_add_u32 v71, s85, v68
    v_mul_u32_u24 v71, 2048, v71
    v_lshl_add_u32 v12, v70, 4, v71
    s_lshl_b32 s85, s31, 8
    s_lshl_b32 s86, s32, 7
    s_add_u32 s86, s85, s86
    s_xor_b32 s87, s86, 128
    s_add_u32 s60, s20, s86
    s_addc_u32 s61, s21, 0
    s_add_u32 m0, s33, 24576
    s_nop 0
    buffer_load_dwordx4 v23, s[44:47], s76 offen offset:0 lds
    s_sub_u32 s62, 7340032, s86
    s_mov_b32 s63, 0x20000
    s_add_u32 s64, s20, s87
    s_addc_u32 s65, s21, 0
    s_sub_u32 s66, 7340032, s87
    s_mov_b32 s67, 0x20000
    s_add_u32 s56, s26, 0x400000
    s_addc_u32 s57, s27, 0
    s_mov_b32 s58, 0xe00000
    s_mov_b32 s59, 0x20000
    s_mul_i32 s82, s30, 917504
    s_mul_i32 s85, s32, 327680
    s_add_u32 s82, s82, s85
    s_mul_i32 s83, s32, 2621440
    s_mul_i32 s85, s32, 24
    s_sub_u32 s85, 40, s85
    s_lshl_b32 s14, s85, 13
    s_lshl_b32 s35, s85, 16
    v_mov_b32 v88, 0
    v_mov_b32 v89, 0
    v_mov_b32 v90, 0
    s_add_u32 m0, s33, 28672
    s_mov_b32 s77, 5505024
    buffer_load_dwordx4 v22, s[48:51], s77 offen offset:0 lds
    v_mov_b32 v91, 0
    v_mov_b32 v92, 0
    v_mov_b32 v93, 0
    v_mov_b32 v94, 0
    v_mov_b32 v95, 0
    v_mov_b32 v96, 0
    v_mov_b32 v97, 0
    v_mov_b32 v98, 0
    s_add_u32 m0, s33, 32768
    s_nop 0
    buffer_load_dwordx4 v22, s[52:55], s77 offen offset:0 lds
    v_mov_b32 v99, 0
    v_mov_b32 v100, 0
    v_mov_b32 v101, 0
    v_mov_b32 v102, 0
    v_mov_b32 v103, 0
    v_mov_b32 v104, 0
    v_mov_b32 v105, 0
    v_mov_b32 v106, 0
    s_add_u32 s75, s75, 0xffd90000
    s_load_dword s94, s[20:21], s75 offset:0x0
    s_add_u32 s75, s75, 0x280000
    s_load_dword s94, s[20:21], s75 offset:0x0
    s_add_u32 s75, s75, 0xffd90000
    s_load_dword s94, s[20:21], s75 offset:0x0
    s_add_u32 s75, s75, 0x280000
    s_load_dword s94, s[20:21], s75 offset:0x0
    s_waitcnt vmcnt(16)
    s_barrier
    s_add_u32 m0, s79, 98304
    s_mov_b32 s78, 1664
    buffer_load_dwordx4 v20, s[36:39], s78 offen sc1 lds
    v_mov_b32 v107, 0
    v_mov_b32 v108, 0
    v_mov_b32 v109, 0
    v_mov_b32 v110, 0
    v_mov_b32 v111, 0
    v_mov_b32 v112, 0
    v_mov_b32 v113, 0
    v_mov_b32 v114, 0
    v_mov_b32 v115, 0
    v_mov_b32 v116, 0
    v_mov_b32 v117, 0
    v_mov_b32 v118, 0
    v_mov_b32 v119, 0
    v_mov_b32 v120, 0
    v_mov_b32 v121, 0
    v_mov_b32 v122, 0
    s_add_u32 m0, s79, 99328
    s_nop 0
    buffer_load_dwordx4 v21, s[36:39], s78 offen sc1 lds
    v_mov_b32 v123, 0
    v_mov_b32 v124, 0
    v_mov_b32 v125, 0
    v_mov_b32 v126, 0
    v_mov_b32 v127, 0
    v_mov_b32 v128, 0
    v_mov_b32 v129, 0
    v_mov_b32 v130, 0
    s_add_u32 m0, s33, 36864
    s_mov_b32 s76, 4915200
    buffer_load_dwordx4 v23, s[40:43], s76 offen offset:0 lds
    v_mov_b32 v131, 0
    v_mov_b32 v132, 0
    v_mov_b32 v133, 0
    v_mov_b32 v134, 0
    v_mov_b32 v135, 0
    v_mov_b32 v136, 0
    v_mov_b32 v137, 0
    v_mov_b32 v138, 0
    s_add_u32 m0, s33, 38912
    s_nop 0
    buffer_load_dwordx4 v23, s[40:43], s76 offen offset:2048 lds
    v_mov_b32 v139, 0
    v_mov_b32 v140, 0
    v_mov_b32 v141, 0
    v_mov_b32 v142, 0
    v_mov_b32 v143, 0
    v_mov_b32 v144, 0
    v_mov_b32 v145, 0
    v_mov_b32 v146, 0
    s_add_u32 m0, s33, 45056
    s_nop 0
    buffer_load_dwordx4 v23, s[44:47], s76 offen offset:0 lds
    v_mov_b32 v147, 0
    v_mov_b32 v148, 0
    v_mov_b32 v149, 0
    v_mov_b32 v150, 0
    v_mov_b32 v151, 0
    s_add_u32 m0, s33, 49152
    s_mov_b32 s77, 5734400
    buffer_load_dwordx4 v22, s[48:51], s77 offen offset:0 lds
    s_add_u32 m0, s33, 53248
    s_nop 0
    buffer_load_dwordx4 v22, s[52:55], s77 offen offset:0 lds
    s_add_u32 s75, s75, 0xffd90000
    s_load_dword s94, s[20:21], s75 offset:0x0
    s_add_u32 s75, s75, 0x280000
    s_load_dword s94, s[20:21], s75 offset:0x0
    s_add_u32 s75, s75, 0xffd90000
    s_load_dword s94, s[20:21], s75 offset:0x0
    s_add_u32 s75, s75, 0x280000
    s_load_dword s94, s[20:21], s75 offset:0x0
    s_waitcnt vmcnt(16)
    s_barrier
    s_add_u32 m0, s79, 100352
    s_mov_b32 s78, 34432
    buffer_load_dwordx4 v20, s[36:39], s78 offen sc1 lds
    s_add_u32 m0, s79, 101376
    s_nop 0
    buffer_load_dwordx4 v21, s[36:39], s78 offen sc1 lds
    s_add_u32 m0, s81, 114688
    s_mov_b32 s78, 1664
    s_mov_b64 exec, 0xffffffff
    buffer_load_dwordx4 v3, s[36:39], s78 offen sc1 lds
    s_mov_b64 exec, -1
    s_add_u32 m0, s33, 57344
    s_mov_b32 s76, 5111808
    buffer_load_dwordx4 v23, s[40:43], s76 offen offset:0 lds
    s_add_u32 m0, s33, 59392
    s_nop 0
    buffer_load_dwordx4 v23, s[40:43], s76 offen offset:2048 lds
    s_add_u32 m0, s33, 65536
    s_nop 0
    buffer_load_dwordx4 v23, s[44:47], s76 offen offset:0 lds
    s_add_u32 m0, s33, 69632
    s_mov_b32 s77, 5963776
    buffer_load_dwordx4 v22, s[48:51], s77 offen offset:0 lds
    s_add_u32 m0, s33, 73728
    s_nop 0
    buffer_load_dwordx4 v22, s[52:55], s77 offen offset:0 lds
    s_add_u32 s75, s75, 0xffd90000
    s_load_dword s94, s[20:21], s75 offset:0x0
    s_add_u32 s75, s75, 0x280000
    s_load_dword s94, s[20:21], s75 offset:0x0
    s_add_u32 s75, s75, 0xffd90000
    s_load_dword s94, s[20:21], s75 offset:0x0
    s_add_u32 s75, s75, 0x280000
    s_load_dword s94, s[20:21], s75 offset:0x0
    s_waitcnt vmcnt(22)
    s_waitcnt vmcnt(15)
    s_barrier
    s_add_u32 m0, s79, 116736
    s_mov_b32 s78, 1792
    buffer_load_dwordx4 v20, s[36:39], s78 offen sc1 lds
    s_add_u32 m0, s79, 117760
    s_nop 0
    buffer_load_dwordx4 v21, s[36:39], s78 offen sc1 lds
    s_add_u32 m0, s33, 77824
    s_mov_b32 s76, 5308416
    buffer_load_dwordx4 v23, s[40:43], s76 offen offset:0 lds
    s_add_u32 m0, s33, 79872
    s_nop 0
    buffer_load_dwordx4 v23, s[40:43], s76 offen offset:2048 lds
    s_add_u32 m0, s33, 86016
    s_nop 0
    buffer_load_dwordx4 v23, s[44:47], s76 offen offset:0 lds
    s_add_u32 m0, s33, 90112
    s_mov_b32 s77, 6193152
    buffer_load_dwordx4 v22, s[48:51], s77 offen offset:0 lds
    s_add_u32 m0, s33, 94208
    s_nop 0
    buffer_load_dwordx4 v22, s[52:55], s77 offen offset:0 lds
    s_add_u32 s75, s75, 0xffd90000
    s_load_dword s94, s[20:21], s75 offset:0x0
    s_add_u32 s75, s75, 0x280000
    s_load_dword s94, s[20:21], s75 offset:0x0
    s_add_u32 s75, s75, 0xffd90000
    s_load_dword s94, s[20:21], s75 offset:0x0
    s_add_u32 s75, s75, 0x280000
    s_load_dword s94, s[20:21], s75 offset:0x0
    s_cmp_lg_u32 s4, 0
    s_cbranch_scc1 L_fH1
    s_lshl_b32 s91, s28, 4
    s_add_u32 s91, s91, s29
    s_lshl_b32 s91, s91, 7
    s_add_u32 s91, s91, 0x1e88000
    v_mov_b32 v16, s91
    v_mov_b32 v18, s100
    v_mov_b32 v19, s101
    s_mov_b64 exec, 1
    global_store_dwordx2 v16, v[18:19], s[26:27] sc1
    s_mov_b64 exec, -1
L_fH1:
    s_waitcnt vmcnt(15)
    s_barrier
    s_add_u32 m0, s79, 118784
    s_mov_b32 s78, 34560
    buffer_load_dwordx4 v20, s[36:39], s78 offen sc1 lds
    s_add_u32 m0, s79, 119808
    s_nop 0
    buffer_load_dwordx4 v21, s[36:39], s78 offen sc1 lds
    s_add_u32 m0, s81, 133120
    s_mov_b32 s78, 1792
    s_mov_b64 exec, 0xffffffff
    buffer_load_dwordx4 v3, s[36:39], s78 offen sc1 lds
    s_mov_b64 exec, -1
    s_add_u32 m0, s33, 16384
    s_mov_b32 s76, 5505024
    buffer_load_dwordx4 v23, s[40:43], s76 offen offset:0 lds
    s_add_u32 m0, s33, 18432
    s_nop 0
    buffer_load_dwordx4 v23, s[40:43], s76 offen offset:2048 lds
    s_add_u32 m0, s33, 24576
    s_nop 0
    buffer_load_dwordx4 v23, s[44:47], s76 offen offset:0 lds
    s_add_u32 m0, s33, 28672
    s_mov_b32 s77, 6422528
    buffer_load_dwordx4 v22, s[48:51], s77 offen offset:0 lds
    s_add_u32 m0, s33, 32768
    s_nop 0
    buffer_load_dwordx4 v22, s[52:55], s77 offen offset:0 lds
    s_add_u32 s75, s75, 0xffd90000
    s_load_dword s94, s[20:21], s75 offset:0x0
    s_add_u32 s75, s75, 0x280000
    s_load_dword s94, s[20:21], s75 offset:0x0
    s_add_u32 s75, s75, 0xffd90000
    s_load_dword s94, s[20:21], s75 offset:0x0
    s_add_u32 s75, s75, 0x280000
    s_load_dword s94, s[20:21], s75 offset:0x0
    s_waitcnt vmcnt(15)
    s_barrier
    s_add_u32 m0, s79, 135168
    s_mov_b32 s78, 1920
    buffer_load_dwordx4 v20, s[36:39], s78 offen sc1 lds
    s_add_u32 m0, s79, 136192
    s_nop 0
    buffer_load_dwordx4 v21, s[36:39], s78 offen sc1 lds
    s_add_u32 m0, s33, 36864
    s_mov_b32 s76, 5701632
    buffer_load_dwordx4 v23, s[40:43], s76 offen offset:0 lds
    s_add_u32 m0, s33, 38912
    s_nop 0
    buffer_load_dwordx4 v23, s[40:43], s76 offen offset:2048 lds
    s_add_u32 m0, s33, 45056
    s_nop 0
    buffer_load_dwordx4 v23, s[44:47], s76 offen offset:0 lds
    s_add_u32 m0, s33, 49152
    s_mov_b32 s77, 6651904
    buffer_load_dwordx4 v22, s[48:51], s77 offen offset:0 lds
    s_add_u32 m0, s33, 53248
    s_nop 0
    buffer_load_dwordx4 v22, s[52:55], s77 offen offset:0 lds
    s_add_u32 s75, s75, 0xffd90000
    s_load_dword s94, s[20:21], s75 offset:0x0
    s_add_u32 s75, s75, 0x280000
    s_load_dword s94, s[20:21], s75 offset:0x0
    s_add_u32 s75, s75, 0xffd90000
    s_load_dword s94, s[20:21], s75 offset:0x0
    s_add_u32 s75, s75, 0x280000
    s_load_dword s94, s[20:21], s75 offset:0x0
    v_and_b32 v13, 15, v1
    s_lshl_b32 s91, s30, 11
    s_add_u32 s91, s91, 0x1e88000
    v_lshl_add_u32 v13, v13, 7, s91
    global_load_dwordx2 v[14:15], v13, s[26:27] sc1
    s_waitcnt vmcnt(16)
    s_barrier
    s_add_u32 m0, s79, 137216
    s_mov_b32 s78, 34688
    buffer_load_dwordx4 v20, s[36:39], s78 offen sc1 lds
    s_add_u32 m0, s79, 138240
    s_nop 0
    buffer_load_dwordx4 v21, s[36:39], s78 offen sc1 lds
    s_add_u32 m0, s81, 151552
    s_mov_b32 s78, 1920
    s_mov_b64 exec, 0xffffffff
    buffer_load_dwordx4 v3, s[36:39], s78 offen sc1 lds
    s_mov_b64 exec, -1
    s_add_u32 m0, s33, 57344
    s_mov_b32 s76, 5898240
    buffer_load_dwordx4 v23, s[40:43], s76 offen offset:0 lds
    s_add_u32 m0, s33, 59392
    s_nop 0
    buffer_load_dwordx4 v23, s[40:43], s76 offen offset:2048 lds
    s_add_u32 m0, s33, 65536
    s_nop 0
    buffer_load_dwordx4 v23, s[44:47], s76 offen offset:0 lds
    s_add_u32 m0, s33, 69632
    s_mov_b32 s77, 6881280
    buffer_load_dwordx4 v22, s[48:51], s77 offen offset:0 lds
    s_add_u32 m0, s33, 73728
    s_nop 0
    buffer_load_dwordx4 v22, s[52:55], s77 offen offset:0 lds
    s_add_u32 s75, s75, 0xffd90000
    s_load_dword s94, s[20:21], s75 offset:0x0
    s_add_u32 s75, s75, 0x280000
    s_load_dword s94, s[20:21], s75 offset:0x0
    s_add_u32 s75, s75, 0xffd90000
    s_load_dword s94, s[20:21], s75 offset:0x0
    s_add_u32 s75, s75, 0x280000
    s_load_dword s94, s[20:21], s75 offset:0x0
    s_waitcnt vmcnt(16)
    s_barrier
    s_add_u32 m0, s33, 77824
    s_mov_b32 s76, 6094848
    buffer_load_dwordx4 v23, s[40:43], s76 offen offset:0 lds
    s_add_u32 m0, s33, 79872
    s_nop 0
    buffer_load_dwordx4 v23, s[40:43], s76 offen offset:2048 lds
    s_add_u32 m0, s33, 86016
    s_nop 0
    buffer_load_dwordx4 v23, s[44:47], s76 offen offset:0 lds
    s_add_u32 m0, s33, 90112
    s_mov_b32 s77, 7110656
    buffer_load_dwordx4 v22, s[48:51], s77 offen offset:0 lds
    s_add_u32 m0, s33, 94208
    s_nop 0
    buffer_load_dwordx4 v22, s[52:55], s77 offen offset:0 lds
    s_add_u32 s75, s75, 0xffd90000
    s_load_dword s94, s[20:21], s75 offset:0x0
    s_add_u32 s75, s75, 0x280000
    s_load_dword s94, s[20:21], s75 offset:0x0
    s_add_u32 s75, s75, 0xffd90000
    s_load_dword s94, s[20:21], s75 offset:0x0
    s_add_u32 s75, s75, 0x280000
    s_load_dword s94, s[20:21], s75 offset:0x0
    s_waitcnt vmcnt(13)
    s_movk_i32 s98, 0x4000
L_pH1_chk:
    v_cmp_ne_u64 vcc, s[100:101], v[14:15]
    s_nop 1
    s_cmp_eq_u64 vcc, 0
    s_cbranch_scc1 L_pH1_ok
    s_sub_u32 s98, s98, 1
    s_cbranch_scc1 L_pH1_ok
    s_sleep 1
    global_load_dwordx2 v[14:15], v13, s[26:27] sc1
    s_waitcnt vmcnt(0)
    s_branch L_pH1_chk
L_pH1_ok:
    s_waitcnt vmcnt(14)
    s_barrier
    s_lshl_b32 m0, s33, 2
    s_nop 0
    buffer_load_dwordx4 v10, s[56:59], s82 offen offset:0 sc1 lds
    buffer_load_dwordx4 v10, s[56:59], s82 offen offset:1024 sc1 lds
    buffer_load_dwordx4 v10, s[56:59], s82 offen offset:2048 sc1 lds
    buffer_load_dwordx4 v10, s[56:59], s82 offen offset:3072 sc1 lds
    s_add_u32 s82, s82, 16384
    s_lshl1_add_u32 m0, s33, 16384
    s_nop 0
    buffer_load_dwordx4 v11, s[60:63], s83 offen lds
    s_lshl1_add_u32 m0, s33, 17408
    s_nop 0
    buffer_load_dwordx4 v12, s[60:63], s83 offen lds
    s_lshl1_add_u32 m0, s33, 24576
    s_nop 0
    buffer_load_dwordx4 v11, s[64:67], s83 offen lds
    s_lshl1_add_u32 m0, s33, 25600
    s_nop 0
    buffer_load_dwordx4 v12, s[64:67], s83 offen lds
    s_add_u32 s83, s83, 131072
    s_add_u32 s75, s75, 0xffd90000
    s_load_dword s94, s[20:21], s75 offset:0x0
    s_add_u32 s75, s75, 0x280000
    s_load_dword s94, s[20:21], s75 offset:0x0
    s_add_u32 s75, s75, 0xffd90000
    s_load_dword s94, s[20:21], s75 offset:0x0
    s_add_u32 s75, s75, 0x280000
    s_load_dword s94, s[20:21], s75 offset:0x0
    s_waitcnt vmcnt(13)
    s_barrier
    s_lshl2_add_u32 m0, s33, 98304
    s_nop 0
    buffer_load_dwordx4 v10, s[56:59], s82 offen offset:0 sc1 lds
    buffer_load_dwordx4 v10, s[56:59], s82 offen offset:1024 sc1 lds
    buffer_load_dwordx4 v10, s[56:59], s82 offen offset:2048 sc1 lds
    buffer_load_dwordx4 v10, s[56:59], s82 offen offset:3072 sc1 lds
    s_add_u32 s82, s82, 16384
    s_lshl1_add_u32 m0, s33, 114688
    s_nop 0
    buffer_load_dwordx4 v11, s[60:63], s83 offen lds
    s_lshl1_add_u32 m0, s33, 115712
    s_nop 0
    buffer_load_dwordx4 v12, s[60:63], s83 offen lds
    s_lshl1_add_u32 m0, s33, 122880
    s_nop 0
    buffer_load_dwordx4 v11, s[64:67], s83 offen lds
    s_lshl1_add_u32 m0, s33, 123904
    s_nop 0
    buffer_load_dwordx4 v12, s[64:67], s83 offen lds
    s_add_u32 s83, s83, 131072
    s_waitcnt vmcnt(16)
    s_barrier
    s_lshl2_add_u32 m0, s33, 32768
    s_nop 0
    buffer_load_dwordx4 v10, s[56:59], s82 offen offset:0 sc1 lds
    buffer_load_dwordx4 v10, s[56:59], s82 offen offset:1024 sc1 lds
    buffer_load_dwordx4 v10, s[56:59], s82 offen offset:2048 sc1 lds
    buffer_load_dwordx4 v10, s[56:59], s82 offen offset:3072 sc1 lds
    s_add_u32 s82, s82, 16384
    s_lshl1_add_u32 m0, s33, 49152
    s_nop 0
    buffer_load_dwordx4 v11, s[60:63], s83 offen lds
    s_lshl1_add_u32 m0, s33, 50176
    s_nop 0
    buffer_load_dwordx4 v12, s[60:63], s83 offen lds
    s_lshl1_add_u32 m0, s33, 57344
    s_nop 0
    buffer_load_dwordx4 v11, s[64:67], s83 offen lds
    s_lshl1_add_u32 m0, s33, 58368
    s_nop 0
    buffer_load_dwordx4 v12, s[64:67], s83 offen lds
    s_add_u32 s83, s83, 131072
    s_lshl_b32 s85, s31, 8
    s_lshl_b32 s86, s32, 7
    s_add_u32 s86, s85, s86
    s_xor_b32 s87, s86, 128
    s_add_u32 s60, s12, s86
    s_addc_u32 s61, s13, 0
    s_sub_u32 s62, 2097152, s86
    s_mov_b32 s63, 0x20000
    s_add_u32 s56, s26, 0x1200000
    s_addc_u32 s57, s27, 0
    s_mov_b32 s58, 0x400000
    s_mov_b32 s59, 0x20000
    s_lshl_b32 s82, s30, 18
    s_mov_b32 s83, 393216
    s_add_u32 s82, s82, 49152
    s_waitcnt vmcnt(16)
    s_barrier
    s_setprio 1
    ds_read_b64_tr_b16 v[40:41], v6 offset:16384
    ds_read_b64_tr_b16 v[42:43], v6 offset:16896
    ds_read_b128 v[24:27], v4 offset:0
    ds_read_b128 v[28:31], v4 offset:1024
    ds_read_b128 v[32:35], v4 offset:2048
    ds_read_b128 v[36:39], v4 offset:3072
    ds_read_b64_tr_b16 v[44:45], v7 offset:16384
    ds_read_b64_tr_b16 v[46:47], v7 offset:16896
    ds_read_b64_tr_b16 v[48:49], v6 offset:24576
    ds_read_b64_tr_b16 v[50:51], v6 offset:25088
    ds_read_b64_tr_b16 v[52:53], v7 offset:24576
    ds_read_b64_tr_b16 v[54:55], v7 offset:25088
    s_mov_b32 s34, 6
.p2align 6
L_d:
    s_waitcnt lgkmcnt(9)
    v_mfma_f32_16x16x32_bf16 v[88:91], v[40:43], v[24:27], v[88:91]
    ds_read_b64_tr_b16 v[72:73], v6 offset:20480
    ds_read_b64_tr_b16 v[74:75], v6 offset:20992
    s_waitcnt lgkmcnt(10)
    v_mfma_f32_16x16x32_bf16 v[92:95], v[40:43], v[28:31], v[92:95]
    ds_read_b128 v[56:59], v4 offset:8192
    s_waitcnt lgkmcnt(10)
    v_mfma_f32_16x16x32_bf16 v[96:99], v[40:43], v[32:35], v[96:99]
    ds_read_b128 v[60:63], v4 offset:9216
    ds_read_b128 v[64:67], v4 offset:10240
    s_waitcnt lgkmcnt(11)
    v_mfma_f32_16x16x32_bf16 v[100:103], v[40:43], v[36:39], v[100:103]
    ds_read_b128 v[68:71], v4 offset:11264
    s_waitcnt lgkmcnt(10)
    v_mfma_f32_16x16x32_bf16 v[104:107], v[44:47], v[24:27], v[104:107]
    ds_read_b64_tr_b16 v[76:77], v7 offset:20480
    ds_read_b64_tr_b16 v[78:79], v7 offset:20992
    v_mfma_f32_16x16x32_bf16 v[108:111], v[44:47], v[28:31], v[108:111]
    ds_read_b64_tr_b16 v[80:81], v6 offset:28672
    v_mfma_f32_16x16x32_bf16 v[112:115], v[44:47], v[32:35], v[112:115]
    ds_read_b64_tr_b16 v[82:83], v6 offset:29184
    ds_read_b64_tr_b16 v[84:85], v7 offset:28672
    v_mfma_f32_16x16x32_bf16 v[116:119], v[44:47], v[36:39], v[116:119]
    ds_read_b64_tr_b16 v[86:87], v7 offset:29184
    s_waitcnt lgkmcnt(14)
    v_mfma_f32_16x16x32_bf16 v[120:123], v[48:51], v[24:27], v[120:123]
    v_mfma_f32_16x16x32_bf16 v[124:127], v[48:51], v[28:31], v[124:127]
    v_mfma_f32_16x16x32_bf16 v[128:131], v[48:51], v[32:35], v[128:131]
    v_mfma_f32_16x16x32_bf16 v[132:135], v[48:51], v[36:39], v[132:135]
    s_waitcnt lgkmcnt(12)
    v_mfma_f32_16x16x32_bf16 v[136:139], v[52:55], v[24:27], v[136:139]
    v_mfma_f32_16x16x32_bf16 v[140:143], v[52:55], v[28:31], v[140:143]
    v_mfma_f32_16x16x32_bf16 v[144:147], v[52:55], v[32:35], v[144:147]
    v_mfma_f32_16x16x32_bf16 v[148:151], v[52:55], v[36:39], v[148:151]
    s_waitcnt vmcnt(8) lgkmcnt(0)
    s_barrier
    v_mfma_f32_16x16x32_bf16 v[88:91], v[72:75], v[56:59], v[88:91]
    ds_read_b64_tr_b16 v[40:41], v8 offset:49152
    ds_read_b64_tr_b16 v[42:43], v8 offset:49664
    v_mfma_f32_16x16x32_bf16 v[92:95], v[72:75], v[60:63], v[92:95]
    ds_read_b128 v[24:27], v5 offset:32768
    v_mfma_f32_16x16x32_bf16 v[96:99], v[72:75], v[64:67], v[96:99]
    ds_read_b128 v[28:31], v5 offset:33792
    v_mfma_f32_16x16x32_bf16 v[100:103], v[72:75], v[68:71], v[100:103]
    ds_read_b128 v[32:35], v5 offset:34816
    v_mfma_f32_16x16x32_bf16 v[104:107], v[76:79], v[56:59], v[104:107]
    ds_read_b128 v[36:39], v5 offset:35840
    v_mfma_f32_16x16x32_bf16 v[108:111], v[76:79], v[60:63], v[108:111]
    ds_read_b64_tr_b16 v[44:45], v9 offset:49152
    ds_read_b64_tr_b16 v[46:47], v9 offset:49664
    v_mfma_f32_16x16x32_bf16 v[112:115], v[76:79], v[64:67], v[112:115]
    ds_read_b64_tr_b16 v[48:49], v8 offset:57344
    v_mfma_f32_16x16x32_bf16 v[116:119], v[76:79], v[68:71], v[116:119]
    ds_read_b64_tr_b16 v[50:51], v8 offset:57856
    v_mfma_f32_16x16x32_bf16 v[120:123], v[80:83], v[56:59], v[120:123]
    ds_read_b64_tr_b16 v[52:53], v9 offset:57344
    v_mfma_f32_16x16x32_bf16 v[124:127], v[80:83], v[60:63], v[124:127]
    ds_read_b64_tr_b16 v[54:55], v9 offset:57856
    v_mfma_f32_16x16x32_bf16 v[128:131], v[80:83], v[64:67], v[128:131]
    v_mfma_f32_16x16x32_bf16 v[132:135], v[80:83], v[68:71], v[132:135]
    v_mfma_f32_16x16x32_bf16 v[136:139], v[84:87], v[56:59], v[136:139]
    v_mfma_f32_16x16x32_bf16 v[140:143], v[84:87], v[60:63], v[140:143]
    v_mfma_f32_16x16x32_bf16 v[144:147], v[84:87], v[64:67], v[144:147]
    v_mfma_f32_16x16x32_bf16 v[148:151], v[84:87], v[68:71], v[148:151]
    s_waitcnt lgkmcnt(9)
    v_mfma_f32_16x16x32_bf16 v[88:91], v[40:43], v[24:27], v[88:91]
    ds_read_b64_tr_b16 v[72:73], v8 offset:53248
    ds_read_b64_tr_b16 v[74:75], v8 offset:53760
    s_waitcnt lgkmcnt(10)
    v_mfma_f32_16x16x32_bf16 v[92:95], v[40:43], v[28:31], v[92:95]
    ds_read_b128 v[56:59], v5 offset:40960
    s_waitcnt lgkmcnt(10)
    v_mfma_f32_16x16x32_bf16 v[96:99], v[40:43], v[32:35], v[96:99]
    ds_read_b128 v[60:63], v5 offset:41984
    ds_read_b128 v[64:67], v5 offset:43008
    s_waitcnt lgkmcnt(11)
    v_mfma_f32_16x16x32_bf16 v[100:103], v[40:43], v[36:39], v[100:103]
    ds_read_b128 v[68:71], v5 offset:44032
    s_waitcnt lgkmcnt(10)
    v_mfma_f32_16x16x32_bf16 v[104:107], v[44:47], v[24:27], v[104:107]
    ds_read_b64_tr_b16 v[76:77], v9 offset:53248
    ds_read_b64_tr_b16 v[78:79], v9 offset:53760
    v_mfma_f32_16x16x32_bf16 v[108:111], v[44:47], v[28:31], v[108:111]
    ds_read_b64_tr_b16 v[80:81], v8 offset:61440
    v_mfma_f32_16x16x32_bf16 v[112:115], v[44:47], v[32:35], v[112:115]
    ds_read_b64_tr_b16 v[82:83], v8 offset:61952
    ds_read_b64_tr_b16 v[84:85], v9 offset:61440
    v_mfma_f32_16x16x32_bf16 v[116:119], v[44:47], v[36:39], v[116:119]
    ds_read_b64_tr_b16 v[86:87], v9 offset:61952
    s_waitcnt lgkmcnt(14)
    v_mfma_f32_16x16x32_bf16 v[120:123], v[48:51], v[24:27], v[120:123]
    v_mfma_f32_16x16x32_bf16 v[124:127], v[48:51], v[28:31], v[124:127]
    v_mfma_f32_16x16x32_bf16 v[128:131], v[48:51], v[32:35], v[128:131]
    v_mfma_f32_16x16x32_bf16 v[132:135], v[48:51], v[36:39], v[132:135]
    s_waitcnt lgkmcnt(12)
    v_mfma_f32_16x16x32_bf16 v[136:139], v[52:55], v[24:27], v[136:139]
    v_mfma_f32_16x16x32_bf16 v[140:143], v[52:55], v[28:31], v[140:143]
    v_mfma_f32_16x16x32_bf16 v[144:147], v[52:55], v[32:35], v[144:147]
    v_mfma_f32_16x16x32_bf16 v[148:151], v[52:55], v[36:39], v[148:151]
    s_waitcnt vmcnt(0) lgkmcnt(0)
    s_barrier
    v_mfma_f32_16x16x32_bf16 v[88:91], v[72:75], v[56:59], v[88:91]
    ds_read_b64_tr_b16 v[40:41], v6 offset:49152
    ds_read_b64_tr_b16 v[42:43], v6 offset:49664
    v_mfma_f32_16x16x32_bf16 v[92:95], v[72:75], v[60:63], v[92:95]
    ds_read_b128 v[24:27], v4 offset:32768
    v_mfma_f32_16x16x32_bf16 v[96:99], v[72:75], v[64:67], v[96:99]
    ds_read_b128 v[28:31], v4 offset:33792
    v_mfma_f32_16x16x32_bf16 v[100:103], v[72:75], v[68:71], v[100:103]
    ds_read_b128 v[32:35], v4 offset:34816
    v_mfma_f32_16x16x32_bf16 v[104:107], v[76:79], v[56:59], v[104:107]
    ds_read_b128 v[36:39], v4 offset:35840
    v_mfma_f32_16x16x32_bf16 v[108:111], v[76:79], v[60:63], v[108:111]
    ds_read_b64_tr_b16 v[44:45], v7 offset:49152
    ds_read_b64_tr_b16 v[46:47], v7 offset:49664
    v_mfma_f32_16x16x32_bf16 v[112:115], v[76:79], v[64:67], v[112:115]
    ds_read_b64_tr_b16 v[48:49], v6 offset:57344
    v_mfma_f32_16x16x32_bf16 v[116:119], v[76:79], v[68:71], v[116:119]
    ds_read_b64_tr_b16 v[50:51], v6 offset:57856
    v_mfma_f32_16x16x32_bf16 v[120:123], v[80:83], v[56:59], v[120:123]
    ds_read_b64_tr_b16 v[52:53], v7 offset:57344
    v_mfma_f32_16x16x32_bf16 v[124:127], v[80:83], v[60:63], v[124:127]
    ds_read_b64_tr_b16 v[54:55], v7 offset:57856
    v_mfma_f32_16x16x32_bf16 v[128:131], v[80:83], v[64:67], v[128:131]
    v_mfma_f32_16x16x32_bf16 v[132:135], v[80:83], v[68:71], v[132:135]
    v_mfma_f32_16x16x32_bf16 v[136:139], v[84:87], v[56:59], v[136:139]
    v_mfma_f32_16x16x32_bf16 v[140:143], v[84:87], v[60:63], v[140:143]
    v_mfma_f32_16x16x32_bf16 v[144:147], v[84:87], v[64:67], v[144:147]
    v_mfma_f32_16x16x32_bf16 v[148:151], v[84:87], v[68:71], v[148:151]
    s_waitcnt lgkmcnt(9)
    v_mfma_f32_16x16x32_bf16 v[88:91], v[40:43], v[24:27], v[88:91]
    ds_read_b64_tr_b16 v[72:73], v6 offset:53248
    ds_read_b64_tr_b16 v[74:75], v6 offset:53760
    s_waitcnt lgkmcnt(10)
    v_mfma_f32_16x16x32_bf16 v[92:95], v[40:43], v[28:31], v[92:95]
    ds_read_b128 v[56:59], v4 offset:40960
    s_waitcnt lgkmcnt(10)
    v_mfma_f32_16x16x32_bf16 v[96:99], v[40:43], v[32:35], v[96:99]
    ds_read_b128 v[60:63], v4 offset:41984
    ds_read_b128 v[64:67], v4 offset:43008
    s_waitcnt lgkmcnt(11)
    v_mfma_f32_16x16x32_bf16 v[100:103], v[40:43], v[36:39], v[100:103]
    ds_read_b128 v[68:71], v4 offset:44032
    s_waitcnt lgkmcnt(10)
    v_mfma_f32_16x16x32_bf16 v[104:107], v[44:47], v[24:27], v[104:107]
    ds_read_b64_tr_b16 v[76:77], v7 offset:53248
    ds_read_b64_tr_b16 v[78:79], v7 offset:53760
    v_mfma_f32_16x16x32_bf16 v[108:111], v[44:47], v[28:31], v[108:111]
    ds_read_b64_tr_b16 v[80:81], v6 offset:61440
    v_mfma_f32_16x16x32_bf16 v[112:115], v[44:47], v[32:35], v[112:115]
    ds_read_b64_tr_b16 v[82:83], v6 offset:61952
    ds_read_b64_tr_b16 v[84:85], v7 offset:61440
    v_mfma_f32_16x16x32_bf16 v[116:119], v[44:47], v[36:39], v[116:119]
    ds_read_b64_tr_b16 v[86:87], v7 offset:61952
    s_waitcnt lgkmcnt(14)
    v_mfma_f32_16x16x32_bf16 v[120:123], v[48:51], v[24:27], v[120:123]
    v_mfma_f32_16x16x32_bf16 v[124:127], v[48:51], v[28:31], v[124:127]
    v_mfma_f32_16x16x32_bf16 v[128:131], v[48:51], v[32:35], v[128:131]
    v_mfma_f32_16x16x32_bf16 v[132:135], v[48:51], v[36:39], v[132:135]
    s_waitcnt lgkmcnt(12)
    v_mfma_f32_16x16x32_bf16 v[136:139], v[52:55], v[24:27], v[136:139]
    v_mfma_f32_16x16x32_bf16 v[140:143], v[52:55], v[28:31], v[140:143]
    v_mfma_f32_16x16x32_bf16 v[144:147], v[52:55], v[32:35], v[144:147]
    v_mfma_f32_16x16x32_bf16 v[148:151], v[52:55], v[36:39], v[148:151]
    s_waitcnt lgkmcnt(0)
    s_barrier
    v_mfma_f32_16x16x32_bf16 v[88:91], v[72:75], v[56:59], v[88:91]
    ds_read_b64_tr_b16 v[40:41], v8 offset:16384
    ds_read_b64_tr_b16 v[42:43], v8 offset:16896
    v_mfma_f32_16x16x32_bf16 v[92:95], v[72:75], v[60:63], v[92:95]
    ds_read_b128 v[24:27], v5 offset:0
    v_mfma_f32_16x16x32_bf16 v[96:99], v[72:75], v[64:67], v[96:99]
    ds_read_b128 v[28:31], v5 offset:1024
    v_mfma_f32_16x16x32_bf16 v[100:103], v[72:75], v[68:71], v[100:103]
    ds_read_b128 v[32:35], v5 offset:2048
    v_mfma_f32_16x16x32_bf16 v[104:107], v[76:79], v[56:59], v[104:107]
    ds_read_b128 v[36:39], v5 offset:3072
    v_mfma_f32_16x16x32_bf16 v[108:111], v[76:79], v[60:63], v[108:111]
    ds_read_b64_tr_b16 v[44:45], v9 offset:16384
    ds_read_b64_tr_b16 v[46:47], v9 offset:16896
    v_mfma_f32_16x16x32_bf16 v[112:115], v[76:79], v[64:67], v[112:115]
    ds_read_b64_tr_b16 v[48:49], v8 offset:24576
    v_mfma_f32_16x16x32_bf16 v[116:119], v[76:79], v[68:71], v[116:119]
    ds_read_b64_tr_b16 v[50:51], v8 offset:25088
    v_mfma_f32_16x16x32_bf16 v[120:123], v[80:83], v[56:59], v[120:123]
    ds_read_b64_tr_b16 v[52:53], v9 offset:24576
    v_mfma_f32_16x16x32_bf16 v[124:127], v[80:83], v[60:63], v[124:127]
    ds_read_b64_tr_b16 v[54:55], v9 offset:25088
    v_mfma_f32_16x16x32_bf16 v[128:131], v[80:83], v[64:67], v[128:131]
    v_mfma_f32_16x16x32_bf16 v[132:135], v[80:83], v[68:71], v[132:135]
    v_mfma_f32_16x16x32_bf16 v[136:139], v[84:87], v[56:59], v[136:139]
    v_mfma_f32_16x16x32_bf16 v[140:143], v[84:87], v[60:63], v[140:143]
    v_mfma_f32_16x16x32_bf16 v[144:147], v[84:87], v[64:67], v[144:147]
    v_mfma_f32_16x16x32_bf16 v[148:151], v[84:87], v[68:71], v[148:151]
    s_waitcnt lgkmcnt(9)
    v_mfma_f32_16x16x32_bf16 v[88:91], v[40:43], v[24:27], v[88:91]
    ds_read_b64_tr_b16 v[72:73], v8 offset:20480
    ds_read_b64_tr_b16 v[74:75], v8 offset:20992
    s_waitcnt lgkmcnt(10)
    v_mfma_f32_16x16x32_bf16 v[92:95], v[40:43], v[28:31], v[92:95]
    ds_read_b128 v[56:59], v5 offset:8192
    s_waitcnt lgkmcnt(10)
    v_mfma_f32_16x16x32_bf16 v[96:99], v[40:43], v[32:35], v[96:99]
    ds_read_b128 v[60:63], v5 offset:9216
    ds_read_b128 v[64:67], v5 offset:10240
    s_waitcnt lgkmcnt(11)
    v_mfma_f32_16x16x32_bf16 v[100:103], v[40:43], v[36:39], v[100:103]
    ds_read_b128 v[68:71], v5 offset:11264
    s_waitcnt lgkmcnt(10)
    v_mfma_f32_16x16x32_bf16 v[104:107], v[44:47], v[24:27], v[104:107]
    ds_read_b64_tr_b16 v[76:77], v9 offset:20480
    ds_read_b64_tr_b16 v[78:79], v9 offset:20992
    v_mfma_f32_16x16x32_bf16 v[108:111], v[44:47], v[28:31], v[108:111]
    ds_read_b64_tr_b16 v[80:81], v8 offset:28672
    v_mfma_f32_16x16x32_bf16 v[112:115], v[44:47], v[32:35], v[112:115]
    ds_read_b64_tr_b16 v[82:83], v8 offset:29184
    ds_read_b64_tr_b16 v[84:85], v9 offset:28672
    v_mfma_f32_16x16x32_bf16 v[116:119], v[44:47], v[36:39], v[116:119]
    ds_read_b64_tr_b16 v[86:87], v9 offset:29184
    s_waitcnt lgkmcnt(14)
    v_mfma_f32_16x16x32_bf16 v[120:123], v[48:51], v[24:27], v[120:123]
    v_mfma_f32_16x16x32_bf16 v[124:127], v[48:51], v[28:31], v[124:127]
    v_mfma_f32_16x16x32_bf16 v[128:131], v[48:51], v[32:35], v[128:131]
    v_mfma_f32_16x16x32_bf16 v[132:135], v[48:51], v[36:39], v[132:135]
    s_waitcnt lgkmcnt(12)
    v_mfma_f32_16x16x32_bf16 v[136:139], v[52:55], v[24:27], v[136:139]
    v_mfma_f32_16x16x32_bf16 v[140:143], v[52:55], v[28:31], v[140:143]
    v_mfma_f32_16x16x32_bf16 v[144:147], v[52:55], v[32:35], v[144:147]
    v_mfma_f32_16x16x32_bf16 v[148:151], v[52:55], v[36:39], v[148:151]
    s_waitcnt lgkmcnt(0)
    s_barrier
    v_mfma_f32_16x16x32_bf16 v[88:91], v[72:75], v[56:59], v[88:91]
    ds_read_b64_tr_b16 v[40:41], v6 offset:16384
    ds_read_b64_tr_b16 v[42:43], v6 offset:16896
    v_mfma_f32_16x16x32_bf16 v[92:95], v[72:75], v[60:63], v[92:95]
    ds_read_b128 v[24:27], v4 offset:0
    v_mfma_f32_16x16x32_bf16 v[96:99], v[72:75], v[64:67], v[96:99]
    ds_read_b128 v[28:31], v4 offset:1024
    v_mfma_f32_16x16x32_bf16 v[100:103], v[72:75], v[68:71], v[100:103]
    ds_read_b128 v[32:35], v4 offset:2048
    v_mfma_f32_16x16x32_bf16 v[104:107], v[76:79], v[56:59], v[104:107]
    ds_read_b128 v[36:39], v4 offset:3072
    v_mfma_f32_16x16x32_bf16 v[108:111], v[76:79], v[60:63], v[108:111]
    ds_read_b64_tr_b16 v[44:45], v7 offset:16384
    ds_read_b64_tr_b16 v[46:47], v7 offset:16896
    v_mfma_f32_16x16x32_bf16 v[112:115], v[76:79], v[64:67], v[112:115]
    ds_read_b64_tr_b16 v[48:49], v6 offset:24576
    v_mfma_f32_16x16x32_bf16 v[116:119], v[76:79], v[68:71], v[116:119]
    ds_read_b64_tr_b16 v[50:51], v6 offset:25088
    v_mfma_f32_16x16x32_bf16 v[120:123], v[80:83], v[56:59], v[120:123]
    ds_read_b64_tr_b16 v[52:53], v7 offset:24576
    v_mfma_f32_16x16x32_bf16 v[124:127], v[80:83], v[60:63], v[124:127]
    ds_read_b64_tr_b16 v[54:55], v7 offset:25088
    v_mfma_f32_16x16x32_bf16 v[128:131], v[80:83], v[64:67], v[128:131]
    v_mfma_f32_16x16x32_bf16 v[132:135], v[80:83], v[68:71], v[132:135]
    v_mfma_f32_16x16x32_bf16 v[136:139], v[84:87], v[56:59], v[136:139]
    v_mfma_f32_16x16x32_bf16 v[140:143], v[84:87], v[60:63], v[140:143]
    v_mfma_f32_16x16x32_bf16 v[144:147], v[84:87], v[64:67], v[144:147]
    v_mfma_f32_16x16x32_bf16 v[148:151], v[84:87], v[68:71], v[148:151]
    s_sub_u32 s34, s34, 1
    s_cmp_lg_u32 s34, 0
    s_cbranch_scc1 L_d
    s_waitcnt lgkmcnt(9)
    v_mfma_f32_16x16x32_bf16 v[88:91], v[40:43], v[24:27], v[88:91]
    ds_read_b64_tr_b16 v[72:73], v6 offset:20480
    ds_read_b64_tr_b16 v[74:75], v6 offset:20992
    s_waitcnt lgkmcnt(10)
    v_mfma_f32_16x16x32_bf16 v[92:95], v[40:43], v[28:31], v[92:95]
    ds_read_b128 v[56:59], v4 offset:8192
    s_waitcnt lgkmcnt(10)
    v_mfma_f32_16x16x32_bf16 v[96:99], v[40:43], v[32:35], v[96:99]
    ds_read_b128 v[60:63], v4 offset:9216
    ds_read_b128 v[64:67], v4 offset:10240
    s_waitcnt lgkmcnt(11)
    v_mfma_f32_16x16x32_bf16 v[100:103], v[40:43], v[36:39], v[100:103]
    ds_read_b128 v[68:71], v4 offset:11264
    s_waitcnt lgkmcnt(10)
    v_mfma_f32_16x16x32_bf16 v[104:107], v[44:47], v[24:27], v[104:107]
    ds_read_b64_tr_b16 v[76:77], v7 offset:20480
    ds_read_b64_tr_b16 v[78:79], v7 offset:20992
    v_mfma_f32_16x16x32_bf16 v[108:111], v[44:47], v[28:31], v[108:111]
    ds_read_b64_tr_b16 v[80:81], v6 offset:28672
    v_mfma_f32_16x16x32_bf16 v[112:115], v[44:47], v[32:35], v[112:115]
    ds_read_b64_tr_b16 v[82:83], v6 offset:29184
    ds_read_b64_tr_b16 v[84:85], v7 offset:28672
    v_mfma_f32_16x16x32_bf16 v[116:119], v[44:47], v[36:39], v[116:119]
    ds_read_b64_tr_b16 v[86:87], v7 offset:29184
    s_waitcnt lgkmcnt(14)
    v_mfma_f32_16x16x32_bf16 v[120:123], v[48:51], v[24:27], v[120:123]
    v_mfma_f32_16x16x32_bf16 v[124:127], v[48:51], v[28:31], v[124:127]
    v_mfma_f32_16x16x32_bf16 v[128:131], v[48:51], v[32:35], v[128:131]
    v_mfma_f32_16x16x32_bf16 v[132:135], v[48:51], v[36:39], v[132:135]
    s_waitcnt lgkmcnt(12)
    v_mfma_f32_16x16x32_bf16 v[136:139], v[52:55], v[24:27], v[136:139]
    v_mfma_f32_16x16x32_bf16 v[140:143], v[52:55], v[28:31], v[140:143]
    v_mfma_f32_16x16x32_bf16 v[144:147], v[52:55], v[32:35], v[144:147]
    v_mfma_f32_16x16x32_bf16 v[148:151], v[52:55], v[36:39], v[148:151]
    s_waitcnt lgkmcnt(0)
    s_barrier
    v_mfma_f32_16x16x32_bf16 v[88:91], v[72:75], v[56:59], v[88:91]
    ds_read_b64_tr_b16 v[40:41], v8 offset:49152
    ds_read_b64_tr_b16 v[42:43], v8 offset:49664
    v_mfma_f32_16x16x32_bf16 v[92:95], v[72:75], v[60:63], v[92:95]
    ds_read_b128 v[24:27], v5 offset:32768
    v_mfma_f32_16x16x32_bf16 v[96:99], v[72:75], v[64:67], v[96:99]
    ds_read_b128 v[28:31], v5 offset:33792
    v_mfma_f32_16x16x32_bf16 v[100:103], v[72:75], v[68:71], v[100:103]
    ds_read_b128 v[32:35], v5 offset:34816
    v_mfma_f32_16x16x32_bf16 v[104:107], v[76:79], v[56:59], v[104:107]
    ds_read_b128 v[36:39], v5 offset:35840
    v_mfma_f32_16x16x32_bf16 v[108:111], v[76:79], v[60:63], v[108:111]
    ds_read_b64_tr_b16 v[44:45], v9 offset:49152
    ds_read_b64_tr_b16 v[46:47], v9 offset:49664
    v_mfma_f32_16x16x32_bf16 v[112:115], v[76:79], v[64:67], v[112:115]
    ds_read_b64_tr_b16 v[48:49], v8 offset:57344
    v_mfma_f32_16x16x32_bf16 v[116:119], v[76:79], v[68:71], v[116:119]
    ds_read_b64_tr_b16 v[50:51], v8 offset:57856
    v_mfma_f32_16x16x32_bf16 v[120:123], v[80:83], v[56:59], v[120:123]
    ds_read_b64_tr_b16 v[52:53], v9 offset:57344
    v_mfma_f32_16x16x32_bf16 v[124:127], v[80:83], v[60:63], v[124:127]
    ds_read_b64_tr_b16 v[54:55], v9 offset:57856
    v_mfma_f32_16x16x32_bf16 v[128:131], v[80:83], v[64:67], v[128:131]
    v_mfma_f32_16x16x32_bf16 v[132:135], v[80:83], v[68:71], v[132:135]
    v_mfma_f32_16x16x32_bf16 v[136:139], v[84:87], v[56:59], v[136:139]
    v_mfma_f32_16x16x32_bf16 v[140:143], v[84:87], v[60:63], v[140:143]
    v_mfma_f32_16x16x32_bf16 v[144:147], v[84:87], v[64:67], v[144:147]
    v_mfma_f32_16x16x32_bf16 v[148:151], v[84:87], v[68:71], v[148:151]
    s_waitcnt lgkmcnt(9)
    v_mfma_f32_16x16x32_bf16 v[88:91], v[40:43], v[24:27], v[88:91]
    ds_read_b64_tr_b16 v[72:73], v8 offset:53248
    ds_read_b64_tr_b16 v[74:75], v8 offset:53760
    s_waitcnt lgkmcnt(10)
    v_mfma_f32_16x16x32_bf16 v[92:95], v[40:43], v[28:31], v[92:95]
    ds_read_b128 v[56:59], v5 offset:40960
    s_waitcnt lgkmcnt(10)
    v_mfma_f32_16x16x32_bf16 v[96:99], v[40:43], v[32:35], v[96:99]
    ds_read_b128 v[60:63], v5 offset:41984
    ds_read_b128 v[64:67], v5 offset:43008
    s_waitcnt lgkmcnt(11)
    v_mfma_f32_16x16x32_bf16 v[100:103], v[40:43], v[36:39], v[100:103]
    ds_read_b128 v[68:71], v5 offset:44032
    s_waitcnt lgkmcnt(10)
    v_mfma_f32_16x16x32_bf16 v[104:107], v[44:47], v[24:27], v[104:107]
    ds_read_b64_tr_b16 v[76:77], v9 offset:53248
    ds_read_b64_tr_b16 v[78:79], v9 offset:53760
    v_mfma_f32_16x16x32_bf16 v[108:111], v[44:47], v[28:31], v[108:111]
    ds_read_b64_tr_b16 v[80:81], v8 offset:61440
    v_mfma_f32_16x16x32_bf16 v[112:115], v[44:47], v[32:35], v[112:115]
    ds_read_b64_tr_b16 v[82:83], v8 offset:61952
    ds_read_b64_tr_b16 v[84:85], v9 offset:61440
    v_mfma_f32_16x16x32_bf16 v[116:119], v[44:47], v[36:39], v[116:119]
    ds_read_b64_tr_b16 v[86:87], v9 offset:61952
    s_waitcnt lgkmcnt(14)
    v_mfma_f32_16x16x32_bf16 v[120:123], v[48:51], v[24:27], v[120:123]
    v_mfma_f32_16x16x32_bf16 v[124:127], v[48:51], v[28:31], v[124:127]
    v_mfma_f32_16x16x32_bf16 v[128:131], v[48:51], v[32:35], v[128:131]
    v_mfma_f32_16x16x32_bf16 v[132:135], v[48:51], v[36:39], v[132:135]
    s_waitcnt lgkmcnt(12)
    v_mfma_f32_16x16x32_bf16 v[136:139], v[52:55], v[24:27], v[136:139]
    v_mfma_f32_16x16x32_bf16 v[140:143], v[52:55], v[28:31], v[140:143]
    v_mfma_f32_16x16x32_bf16 v[144:147], v[52:55], v[32:35], v[144:147]
    v_mfma_f32_16x16x32_bf16 v[148:151], v[52:55], v[36:39], v[148:151]
    s_waitcnt lgkmcnt(0)
    s_barrier
    v_mfma_f32_16x16x32_bf16 v[88:91], v[72:75], v[56:59], v[88:91]
    ds_read_b64_tr_b16 v[40:41], v6 offset:49152
    ds_read_b64_tr_b16 v[42:43], v6 offset:49664
    v_mfma_f32_16x16x32_bf16 v[92:95], v[72:75], v[60:63], v[92:95]
    ds_read_b128 v[24:27], v4 offset:32768
    v_mfma_f32_16x16x32_bf16 v[96:99], v[72:75], v[64:67], v[96:99]
    ds_read_b128 v[28:31], v4 offset:33792
    v_mfma_f32_16x16x32_bf16 v[100:103], v[72:75], v[68:71], v[100:103]
    ds_read_b128 v[32:35], v4 offset:34816
    v_mfma_f32_16x16x32_bf16 v[104:107], v[76:79], v[56:59], v[104:107]
    ds_read_b128 v[36:39], v4 offset:35840
    v_mfma_f32_16x16x32_bf16 v[108:111], v[76:79], v[60:63], v[108:111]
    ds_read_b64_tr_b16 v[44:45], v7 offset:49152
    ds_read_b64_tr_b16 v[46:47], v7 offset:49664
    v_mfma_f32_16x16x32_bf16 v[112:115], v[76:79], v[64:67], v[112:115]
    ds_read_b64_tr_b16 v[48:49], v6 offset:57344
    v_mfma_f32_16x16x32_bf16 v[116:119], v[76:79], v[68:71], v[116:119]
    ds_read_b64_tr_b16 v[50:51], v6 offset:57856
    v_mfma_f32_16x16x32_bf16 v[120:123], v[80:83], v[56:59], v[120:123]
    ds_read_b64_tr_b16 v[52:53], v7 offset:57344
    v_mfma_f32_16x16x32_bf16 v[124:127], v[80:83], v[60:63], v[124:127]
    ds_read_b64_tr_b16 v[54:55], v7 offset:57856
    v_mfma_f32_16x16x32_bf16 v[128:131], v[80:83], v[64:67], v[128:131]
    v_mfma_f32_16x16x32_bf16 v[132:135], v[80:83], v[68:71], v[132:135]
    v_mfma_f32_16x16x32_bf16 v[136:139], v[84:87], v[56:59], v[136:139]
    v_mfma_f32_16x16x32_bf16 v[140:143], v[84:87], v[60:63], v[140:143]
    v_mfma_f32_16x16x32_bf16 v[144:147], v[84:87], v[64:67], v[144:147]
    v_mfma_f32_16x16x32_bf16 v[148:151], v[84:87], v[68:71], v[148:151]
    s_waitcnt lgkmcnt(9)
    v_mfma_f32_16x16x32_bf16 v[88:91], v[40:43], v[24:27], v[88:91]
    ds_read_b64_tr_b16 v[72:73], v6 offset:53248
    ds_read_b64_tr_b16 v[74:75], v6 offset:53760
    s_waitcnt lgkmcnt(10)
    v_mfma_f32_16x16x32_bf16 v[92:95], v[40:43], v[28:31], v[92:95]
    ds_read_b128 v[56:59], v4 offset:40960
    s_waitcnt lgkmcnt(10)
    v_mfma_f32_16x16x32_bf16 v[96:99], v[40:43], v[32:35], v[96:99]
    ds_read_b128 v[60:63], v4 offset:41984
    ds_read_b128 v[64:67], v4 offset:43008
    s_waitcnt lgkmcnt(11)
    v_mfma_f32_16x16x32_bf16 v[100:103], v[40:43], v[36:39], v[100:103]
    ds_read_b128 v[68:71], v4 offset:44032
    s_waitcnt lgkmcnt(10)
    v_mfma_f32_16x16x32_bf16 v[104:107], v[44:47], v[24:27], v[104:107]
    ds_read_b64_tr_b16 v[76:77], v7 offset:53248
    ds_read_b64_tr_b16 v[78:79], v7 offset:53760
    v_mfma_f32_16x16x32_bf16 v[108:111], v[44:47], v[28:31], v[108:111]
    ds_read_b64_tr_b16 v[80:81], v6 offset:61440
    v_mfma_f32_16x16x32_bf16 v[112:115], v[44:47], v[32:35], v[112:115]
    ds_read_b64_tr_b16 v[82:83], v6 offset:61952
    ds_read_b64_tr_b16 v[84:85], v7 offset:61440
    v_mfma_f32_16x16x32_bf16 v[116:119], v[44:47], v[36:39], v[116:119]
    ds_read_b64_tr_b16 v[86:87], v7 offset:61952
    s_waitcnt lgkmcnt(14)
    v_mfma_f32_16x16x32_bf16 v[120:123], v[48:51], v[24:27], v[120:123]
    v_mfma_f32_16x16x32_bf16 v[124:127], v[48:51], v[28:31], v[124:127]
    v_mfma_f32_16x16x32_bf16 v[128:131], v[48:51], v[32:35], v[128:131]
    v_mfma_f32_16x16x32_bf16 v[132:135], v[48:51], v[36:39], v[132:135]
    s_waitcnt lgkmcnt(12)
    v_mfma_f32_16x16x32_bf16 v[136:139], v[52:55], v[24:27], v[136:139]
    v_mfma_f32_16x16x32_bf16 v[140:143], v[52:55], v[28:31], v[140:143]
    v_mfma_f32_16x16x32_bf16 v[144:147], v[52:55], v[32:35], v[144:147]
    v_mfma_f32_16x16x32_bf16 v[148:151], v[52:55], v[36:39], v[148:151]
    s_waitcnt lgkmcnt(0)
    s_barrier
    v_mfma_f32_16x16x32_bf16 v[88:91], v[72:75], v[56:59], v[88:91]
    ds_read_b64_tr_b16 v[40:41], v8 offset:16384
    ds_read_b64_tr_b16 v[42:43], v8 offset:16896
    v_mfma_f32_16x16x32_bf16 v[92:95], v[72:75], v[60:63], v[92:95]
    ds_read_b128 v[24:27], v5 offset:0
    v_mfma_f32_16x16x32_bf16 v[96:99], v[72:75], v[64:67], v[96:99]
    ds_read_b128 v[28:31], v5 offset:1024
    v_mfma_f32_16x16x32_bf16 v[100:103], v[72:75], v[68:71], v[100:103]
    ds_read_b128 v[32:35], v5 offset:2048
    v_mfma_f32_16x16x32_bf16 v[104:107], v[76:79], v[56:59], v[104:107]
    ds_read_b128 v[36:39], v5 offset:3072
    v_mfma_f32_16x16x32_bf16 v[108:111], v[76:79], v[60:63], v[108:111]
    ds_read_b64_tr_b16 v[44:45], v9 offset:16384
    ds_read_b64_tr_b16 v[46:47], v9 offset:16896
    v_mfma_f32_16x16x32_bf16 v[112:115], v[76:79], v[64:67], v[112:115]
    ds_read_b64_tr_b16 v[48:49], v8 offset:24576
    v_mfma_f32_16x16x32_bf16 v[116:119], v[76:79], v[68:71], v[116:119]
    ds_read_b64_tr_b16 v[50:51], v8 offset:25088
    v_mfma_f32_16x16x32_bf16 v[120:123], v[80:83], v[56:59], v[120:123]
    ds_read_b64_tr_b16 v[52:53], v9 offset:24576
    v_mfma_f32_16x16x32_bf16 v[124:127], v[80:83], v[60:63], v[124:127]
    ds_read_b64_tr_b16 v[54:55], v9 offset:25088
    v_mfma_f32_16x16x32_bf16 v[128:131], v[80:83], v[64:67], v[128:131]
    v_mfma_f32_16x16x32_bf16 v[132:135], v[80:83], v[68:71], v[132:135]
    v_mfma_f32_16x16x32_bf16 v[136:139], v[84:87], v[56:59], v[136:139]
    v_mfma_f32_16x16x32_bf16 v[140:143], v[84:87], v[60:63], v[140:143]
    v_mfma_f32_16x16x32_bf16 v[144:147], v[84:87], v[64:67], v[144:147]
    v_mfma_f32_16x16x32_bf16 v[148:151], v[84:87], v[68:71], v[148:151]
    s_waitcnt lgkmcnt(9)
    v_mfma_f32_16x16x32_bf16 v[88:91], v[40:43], v[24:27], v[88:91]
    ds_read_b64_tr_b16 v[72:73], v8 offset:20480
    ds_read_b64_tr_b16 v[74:75], v8 offset:20992
    s_waitcnt lgkmcnt(10)
    v_mfma_f32_16x16x32_bf16 v[92:95], v[40:43], v[28:31], v[92:95]
    ds_read_b128 v[56:59], v5 offset:8192
    s_waitcnt lgkmcnt(10)
    v_mfma_f32_16x16x32_bf16 v[96:99], v[40:43], v[32:35], v[96:99]
    ds_read_b128 v[60:63], v5 offset:9216
    ds_read_b128 v[64:67], v5 offset:10240
    s_waitcnt lgkmcnt(11)
    v_mfma_f32_16x16x32_bf16 v[100:103], v[40:43], v[36:39], v[100:103]
    ds_read_b128 v[68:71], v5 offset:11264
    s_waitcnt lgkmcnt(10)
    v_mfma_f32_16x16x32_bf16 v[104:107], v[44:47], v[24:27], v[104:107]
    ds_read_b64_tr_b16 v[76:77], v9 offset:20480
    ds_read_b64_tr_b16 v[78:79], v9 offset:20992
    v_mfma_f32_16x16x32_bf16 v[108:111], v[44:47], v[28:31], v[108:111]
    ds_read_b64_tr_b16 v[80:81], v8 offset:28672
    v_mfma_f32_16x16x32_bf16 v[112:115], v[44:47], v[32:35], v[112:115]
    ds_read_b64_tr_b16 v[82:83], v8 offset:29184
    ds_read_b64_tr_b16 v[84:85], v9 offset:28672
    v_mfma_f32_16x16x32_bf16 v[116:119], v[44:47], v[36:39], v[116:119]
    ds_read_b64_tr_b16 v[86:87], v9 offset:29184
    s_waitcnt lgkmcnt(14)
    v_mfma_f32_16x16x32_bf16 v[120:123], v[48:51], v[24:27], v[120:123]
    v_mfma_f32_16x16x32_bf16 v[124:127], v[48:51], v[28:31], v[124:127]
    v_mfma_f32_16x16x32_bf16 v[128:131], v[48:51], v[32:35], v[128:131]
    v_mfma_f32_16x16x32_bf16 v[132:135], v[48:51], v[36:39], v[132:135]
    s_waitcnt lgkmcnt(12)
    v_mfma_f32_16x16x32_bf16 v[136:139], v[52:55], v[24:27], v[136:139]
    v_mfma_f32_16x16x32_bf16 v[140:143], v[52:55], v[28:31], v[140:143]
    v_mfma_f32_16x16x32_bf16 v[144:147], v[52:55], v[32:35], v[144:147]
    v_mfma_f32_16x16x32_bf16 v[148:151], v[52:55], v[36:39], v[148:151]
    s_waitcnt lgkmcnt(0)
    s_barrier
    v_mfma_f32_16x16x32_bf16 v[88:91], v[72:75], v[56:59], v[88:91]
    v_mfma_f32_16x16x32_bf16 v[92:95], v[72:75], v[60:63], v[92:95]
    v_mfma_f32_16x16x32_bf16 v[96:99], v[72:75], v[64:67], v[96:99]
    v_mfma_f32_16x16x32_bf16 v[100:103], v[72:75], v[68:71], v[100:103]
    v_mfma_f32_16x16x32_bf16 v[104:107], v[76:79], v[56:59], v[104:107]
    v_mfma_f32_16x16x32_bf16 v[108:111], v[76:79], v[60:63], v[108:111]
    v_mfma_f32_16x16x32_bf16 v[112:115], v[76:79], v[64:67], v[112:115]
    v_mfma_f32_16x16x32_bf16 v[116:119], v[76:79], v[68:71], v[116:119]
    v_mfma_f32_16x16x32_bf16 v[120:123], v[80:83], v[56:59], v[120:123]
    v_mfma_f32_16x16x32_bf16 v[124:127], v[80:83], v[60:63], v[124:127]
    v_mfma_f32_16x16x32_bf16 v[128:131], v[80:83], v[64:67], v[128:131]
    v_mfma_f32_16x16x32_bf16 v[132:135], v[80:83], v[68:71], v[132:135]
    v_mfma_f32_16x16x32_bf16 v[136:139], v[84:87], v[56:59], v[136:139]
    v_mfma_f32_16x16x32_bf16 v[140:143], v[84:87], v[60:63], v[140:143]
    v_mfma_f32_16x16x32_bf16 v[144:147], v[84:87], v[64:67], v[144:147]
    v_mfma_f32_16x16x32_bf16 v[148:151], v[84:87], v[68:71], v[148:151]
    s_setprio 0
    s_lshl_b32 s84, s2, 15
    s_lshl_b32 s85, s4, 13
    s_add_u32 s84, s84, s85
    s_add_u32 s36, s84, 0x1600000
    s_add_u32 s37, s36, 4096
    s_xor_b32 s38, s36, 32768
    s_xor_b32 s39, s37, 32768
    v_lshlrev_b32 v4, 4, v1
    s_nop 3
    buffer_store_dwordx4 v[120:123], v4, s[68:71], s36 offen offset:0 sc1
    buffer_store_dwordx4 v[124:127], v4, s[68:71], s36 offen offset:1024 sc1
    buffer_store_dwordx4 v[128:131], v4, s[68:71], s36 offen offset:2048 sc1
    buffer_store_dwordx4 v[132:135], v4, s[68:71], s36 offen offset:3072 sc1
    buffer_store_dwordx4 v[136:139], v4, s[68:71], s37 offen offset:0 sc1
    buffer_store_dwordx4 v[140:143], v4, s[68:71], s37 offen offset:1024 sc1
    buffer_store_dwordx4 v[144:147], v4, s[68:71], s37 offen offset:2048 sc1
    buffer_store_dwordx4 v[148:151], v4, s[68:71], s37 offen offset:3072 sc1
    s_lshl_b32 s84, s4, 12
    s_add_u32 s84, s84, 131072
    v_lshl_add_u32 v5, v1, 3, s84
    s_lshl2_add_u32 m0, s33, 65536
    s_nop 0
    buffer_load_dwordx4 v10, s[56:59], s82 offen offset:0 sc1 lds
    buffer_load_dwordx4 v10, s[56:59], s82 offen offset:1024 sc1 lds
    buffer_load_dwordx4 v10, s[56:59], s82 offen offset:2048 sc1 lds
    buffer_load_dwordx4 v10, s[56:59], s82 offen offset:3072 sc1 lds
    s_add_u32 s82, s82, 16384
    s_lshl1_add_u32 m0, s33, 81920
    s_nop 0
    buffer_load_dwordx4 v11, s[60:63], s83 offen lds
    s_lshl1_add_u32 m0, s33, 82944
    s_nop 0
    buffer_load_dwordx4 v12, s[60:63], s83 offen lds
    s_add_u32 s83, s83, 131072
    s_barrier
    s_lshl_b32 m0, s33, 2
    s_nop 0
    buffer_load_dwordx4 v10, s[56:59], s82 offen offset:0 sc1 lds
    buffer_load_dwordx4 v10, s[56:59], s82 offen offset:1024 sc1 lds
    buffer_load_dwordx4 v10, s[56:59], s82 offen offset:2048 sc1 lds
    buffer_load_dwordx4 v10, s[56:59], s82 offen offset:3072 sc1 lds
    s_add_u32 s82, s82, 16384
    s_lshl1_add_u32 m0, s33, 16384
    s_nop 0
    buffer_load_dwordx4 v11, s[60:63], s83 offen lds
    s_lshl1_add_u32 m0, s33, 17408
    s_nop 0
    buffer_load_dwordx4 v12, s[60:63], s83 offen lds
    s_add_u32 s83, s83, 131072
    s_barrier
    s_lshl2_add_u32 m0, s33, 98304
    s_nop 0
    buffer_load_dwordx4 v10, s[56:59], s82 offen offset:0 sc1 lds
    buffer_load_dwordx4 v10, s[56:59], s82 offen offset:1024 sc1 lds
    buffer_load_dwordx4 v10, s[56:59], s82 offen offset:2048 sc1 lds
    buffer_load_dwordx4 v10, s[56:59], s82 offen offset:3072 sc1 lds
    s_add_u32 s82, s82, 16384
    s_lshl1_add_u32 m0, s33, 114688
    s_nop 0
    buffer_load_dwordx4 v11, s[60:63], s83 offen lds
    s_lshl1_add_u32 m0, s33, 115712
    s_nop 0
    buffer_load_dwordx4 v12, s[60:63], s83 offen lds
    s_add_u32 s83, s83, 131072
    s_waitcnt vmcnt(12)
    s_barrier
    s_lshl2_add_u32 m0, s33, 32768
    s_nop 0
    buffer_load_dwordx4 v10, s[56:59], s82 offen offset:0 sc1 lds
    buffer_load_dwordx4 v10, s[56:59], s82 offen offset:1024 sc1 lds
    buffer_load_dwordx4 v10, s[56:59], s82 offen offset:2048 sc1 lds
    buffer_load_dwordx4 v10, s[56:59], s82 offen offset:3072 sc1 lds
    s_add_u32 s82, s82, 16384
    s_lshl1_add_u32 m0, s33, 49152
    s_nop 0
    buffer_load_dwordx4 v11, s[60:63], s83 offen lds
    s_lshl1_add_u32 m0, s33, 50176
    s_nop 0
    buffer_load_dwordx4 v12, s[60:63], s83 offen lds
    s_add_u32 s83, s83, 131072
    s_waitcnt vmcnt(12)
    s_barrier
    s_lshl2_add_u32 m0, s33, 65536
    s_nop 0
    buffer_load_dwordx4 v10, s[56:59], s82 offen offset:0 sc1 lds
    buffer_load_dwordx4 v10, s[56:59], s82 offen offset:1024 sc1 lds
    buffer_load_dwordx4 v10, s[56:59], s82 offen offset:2048 sc1 lds
    buffer_load_dwordx4 v10, s[56:59], s82 offen offset:3072 sc1 lds
    s_add_u32 s82, s82, 16384
    s_lshl1_add_u32 m0, s33, 81920
    s_nop 0
    buffer_load_dwordx4 v11, s[60:63], s83 offen lds
    s_lshl1_add_u32 m0, s33, 82944
    s_nop 0
    buffer_load_dwordx4 v12, s[60:63], s83 offen lds
    s_add_u32 s83, s83, 131072
    s_waitcnt vmcnt(30)
    s_waitcnt vmcnt(12)
    s_barrier
    s_lshl_b32 m0, s33, 2
    s_nop 0
    buffer_load_dwordx4 v10, s[56:59], s82 offen offset:0 sc1 lds
    buffer_load_dwordx4 v10, s[56:59], s82 offen offset:1024 sc1 lds
    buffer_load_dwordx4 v10, s[56:59], s82 offen offset:2048 sc1 lds
    buffer_load_dwordx4 v10, s[56:59], s82 offen offset:3072 sc1 lds
    s_add_u32 s82, s82, 16384
    s_lshl1_add_u32 m0, s33, 16384
    s_nop 0
    buffer_load_dwordx4 v11, s[60:63], s83 offen lds
    s_lshl1_add_u32 m0, s33, 17408
    s_nop 0
    buffer_load_dwordx4 v12, s[60:63], s83 offen lds
    s_add_u32 s83, s83, 131072
    s_cmp_lg_u32 s4, 0
    s_cbranch_scc1 L_fP
    s_lshl_b32 s91, s28, 4
    s_add_u32 s91, s91, s29
    s_lshl_b32 s91, s91, 7
    s_add_u32 s91, s91, 0x1ea0000
    v_mov_b32 v16, s91
    v_mov_b32 v18, s100
    v_mov_b32 v19, s101
    s_mov_b64 exec, 1
    global_store_dwordx2 v16, v[18:19], s[26:27] sc1
    s_mov_b64 exec, -1
L_fP:
    s_xor_b32 s91, s28, 8
    s_lshl_b32 s91, s91, 4
    s_add_u32 s91, s91, s29
    s_lshl_b32 s91, s91, 7
    s_add_u32 s91, s91, 0x1ea0000
    v_mov_b32 v13, s91
    s_waitcnt vmcnt(12)
    s_barrier
    s_lshl2_add_u32 m0, s33, 98304
    s_nop 0
    buffer_load_dwordx4 v10, s[56:59], s82 offen offset:0 sc1 lds
    buffer_load_dwordx4 v10, s[56:59], s82 offen offset:1024 sc1 lds
    buffer_load_dwordx4 v10, s[56:59], s82 offen offset:2048 sc1 lds
    buffer_load_dwordx4 v10, s[56:59], s82 offen offset:3072 sc1 lds
    s_add_u32 s82, s82, 16384
    s_lshl1_add_u32 m0, s33, 114688
    s_nop 0
    buffer_load_dwordx4 v11, s[60:63], s83 offen lds
    s_lshl1_add_u32 m0, s33, 115712
    s_nop 0
    buffer_load_dwordx4 v12, s[60:63], s83 offen lds
    s_add_u32 s83, s83, 131072
    s_waitcnt vmcnt(12)
    s_barrier
    s_lshl2_add_u32 m0, s33, 32768
    s_nop 0
    buffer_load_dwordx4 v10, s[56:59], s82 offen offset:0 sc1 lds
    buffer_load_dwordx4 v10, s[56:59], s82 offen offset:1024 sc1 lds
    buffer_load_dwordx4 v10, s[56:59], s82 offen offset:2048 sc1 lds
    buffer_load_dwordx4 v10, s[56:59], s82 offen offset:3072 sc1 lds
    s_add_u32 s82, s82, 16384
    s_lshl1_add_u32 m0, s33, 49152
    s_nop 0
    buffer_load_dwordx4 v11, s[60:63], s83 offen lds
    s_lshl1_add_u32 m0, s33, 50176
    s_nop 0
    buffer_load_dwordx4 v12, s[60:63], s83 offen lds
    s_add_u32 s83, s83, 131072
    global_load_dwordx2 v[14:15], v13, s[26:27] sc1
    s_waitcnt vmcnt(13)
    s_barrier
    s_lshl2_add_u32 m0, s33, 65536
    s_nop 0
    buffer_load_dwordx4 v10, s[56:59], s82 offen offset:0 sc1 lds
    buffer_load_dwordx4 v10, s[56:59], s82 offen offset:1024 sc1 lds
    buffer_load_dwordx4 v10, s[56:59], s82 offen offset:2048 sc1 lds
    buffer_load_dwordx4 v10, s[56:59], s82 offen offset:3072 sc1 lds
    s_add_u32 s82, s82, 16384
    s_lshl1_add_u32 m0, s33, 81920
    s_nop 0
    buffer_load_dwordx4 v11, s[60:63], s83 offen lds
    s_lshl1_add_u32 m0, s33, 82944
    s_nop 0
    buffer_load_dwordx4 v12, s[60:63], s83 offen lds
    s_add_u32 s83, s83, 131072
    s_waitcnt vmcnt(6)
    s_movk_i32 s98, 0x4000
L_pP_chk:
    v_cmp_ne_u64 vcc, s[100:101], v[14:15]
    s_nop 1
    s_cmp_eq_u64 vcc, 0
    s_cbranch_scc1 L_pP_ok
    s_sub_u32 s98, s98, 1
    s_cbranch_scc1 L_pP_ok
    s_sleep 1
    global_load_dwordx2 v[14:15], v13, s[26:27] sc1
    s_waitcnt vmcnt(0)
    s_branch L_pP_chk
L_pP_ok:
    buffer_load_dwordx4 v[152:155], v4, s[68:71], s38 offen offset:0 sc1
    buffer_load_dwordx4 v[156:159], v4, s[68:71], s38 offen offset:1024 sc1
    buffer_load_dwordx4 v[160:163], v4, s[68:71], s38 offen offset:2048 sc1
    buffer_load_dwordx4 v[164:167], v4, s[68:71], s38 offen offset:3072 sc1
    buffer_load_dwordx4 v[168:171], v4, s[68:71], s39 offen offset:0 sc1
    buffer_load_dwordx4 v[172:175], v4, s[68:71], s39 offen offset:1024 sc1
    buffer_load_dwordx4 v[176:179], v4, s[68:71], s39 offen offset:2048 sc1
    buffer_load_dwordx4 v[180:183], v4, s[68:71], s39 offen offset:3072 sc1
    s_waitcnt vmcnt(21)
    s_barrier
    s_lshl_b32 m0, s33, 2
    s_nop 0
    buffer_load_dwordx4 v10, s[56:59], s82 offen offset:0 sc1 lds
    buffer_load_dwordx4 v10, s[56:59], s82 offen offset:1024 sc1 lds
    buffer_load_dwordx4 v10, s[56:59], s82 offen offset:2048 sc1 lds
    buffer_load_dwordx4 v10, s[56:59], s82 offen offset:3072 sc1 lds
    s_add_u32 s82, s82, 16384
    s_lshl1_add_u32 m0, s33, 16384
    s_nop 0
    buffer_load_dwordx4 v11, s[60:63], s83 offen lds
    s_lshl1_add_u32 m0, s33, 17408
    s_nop 0
    buffer_load_dwordx4 v12, s[60:63], s83 offen lds
    s_add_u32 s83, s83, 131072
    s_waitcnt vmcnt(21)
    s_barrier
    s_lshl2_add_u32 m0, s33, 98304
    s_nop 0
    buffer_load_dwordx4 v10, s[56:59], s82 offen offset:0 sc1 lds
    buffer_load_dwordx4 v10, s[56:59], s82 offen offset:1024 sc1 lds
    buffer_load_dwordx4 v10, s[56:59], s82 offen offset:2048 sc1 lds
    buffer_load_dwordx4 v10, s[56:59], s82 offen offset:3072 sc1 lds
    s_add_u32 s82, s82, 16384
    s_lshl1_add_u32 m0, s33, 114688
    s_nop 0
    buffer_load_dwordx4 v11, s[60:63], s83 offen lds
    s_lshl1_add_u32 m0, s33, 115712
    s_nop 0
    buffer_load_dwordx4 v12, s[60:63], s83 offen lds
    s_add_u32 s83, s83, 131072
    s_waitcnt vmcnt(20)
    s_barrier
    s_lshl2_add_u32 m0, s33, 32768
    s_nop 0
    buffer_load_dwordx4 v10, s[56:59], s82 offen offset:0 sc1 lds
    s_waitcnt vmcnt(20)
    v_add_f32 v88, v88, v152
    v_add_f32 v89, v89, v153
    v_add_f32 v90, v90, v154
    v_add_f32 v91, v91, v155
    v_cvt_pk_bf16_f32 v28, v88, v89
    v_cvt_pk_bf16_f32 v29, v90, v91
    v_lshlrev_b32 v88, 16, v28
    v_and_b32 v89, 0xffff0000, v28
    v_lshlrev_b32 v90, 16, v29
    v_and_b32 v91, 0xffff0000, v29
    v_mul_f32 v24, 0xbfb8aa3b, v88
    v_mul_f32 v25, 0xbfb8aa3b, v89
    v_mul_f32 v26, 0xbfb8aa3b, v90
    v_mul_f32 v27, 0xbfb8aa3b, v91
    v_exp_f32 v24, v24
    buffer_load_dwordx4 v10, s[56:59], s82 offen offset:1024 sc1 lds
    v_exp_f32 v25, v25
    v_exp_f32 v26, v26
    v_exp_f32 v27, v27
    s_nop 0
    v_add_f32 v24, 1.0, v24
    v_add_f32 v25, 1.0, v25
    v_add_f32 v26, 1.0, v26
    v_add_f32 v27, 1.0, v27
    v_rcp_f32 v24, v24
    v_rcp_f32 v25, v25
    v_rcp_f32 v26, v26
    buffer_load_dwordx4 v10, s[56:59], s82 offen offset:2048 sc1 lds
    v_rcp_f32 v27, v27
    s_nop 0
    v_mul_f32 v24, v24, v88
    v_mul_f32 v25, v25, v89
    v_mul_f32 v26, v26, v90
    v_mul_f32 v27, v27, v91
    v_cvt_pk_bf16_f32 v88, v24, v25
    v_cvt_pk_bf16_f32 v89, v26, v27
    buffer_load_dwordx4 v10, s[56:59], s82 offen offset:3072 sc1 lds
    s_add_u32 s82, s82, 16384
    ds_write_b64 v5, v[88:89] offset:0
    s_waitcnt vmcnt(22)
    v_add_f32 v92, v92, v156
    v_add_f32 v93, v93, v157
    v_add_f32 v94, v94, v158
    v_add_f32 v95, v95, v159
    v_cvt_pk_bf16_f32 v28, v92, v93
    v_cvt_pk_bf16_f32 v29, v94, v95
    v_lshlrev_b32 v92, 16, v28
    v_and_b32 v93, 0xffff0000, v28
    v_lshlrev_b32 v94, 16, v29
    v_and_b32 v95, 0xffff0000, v29
    v_mul_f32 v24, 0xbfb8aa3b, v92
    v_mul_f32 v25, 0xbfb8aa3b, v93
    v_mul_f32 v26, 0xbfb8aa3b, v94
    v_mul_f32 v27, 0xbfb8aa3b, v95
    v_exp_f32 v24, v24
    s_lshl1_add_u32 m0, s33, 49152
    s_nop 0
    buffer_load_dwordx4 v11, s[60:63], s83 offen lds
    v_exp_f32 v25, v25
    v_exp_f32 v26, v26
    v_exp_f32 v27, v27
    s_nop 0
    v_add_f32 v24, 1.0, v24
    v_add_f32 v25, 1.0, v25
    v_add_f32 v26, 1.0, v26
    v_add_f32 v27, 1.0, v27
    v_rcp_f32 v24, v24
    v_rcp_f32 v25, v25
    v_rcp_f32 v26, v26
    s_lshl1_add_u32 m0, s33, 50176
    s_nop 0
    buffer_load_dwordx4 v12, s[60:63], s83 offen lds
    s_add_u32 s83, s83, 131072
    v_rcp_f32 v27, v27
    s_nop 0
    v_mul_f32 v24, v24, v92
    v_mul_f32 v25, v25, v93
    v_mul_f32 v26, v26, v94
    v_mul_f32 v27, v27, v95
    v_cvt_pk_bf16_f32 v92, v24, v25
    v_cvt_pk_bf16_f32 v93, v26, v27
    s_waitcnt vmcnt(12)
    s_barrier
    s_lshl2_add_u32 m0, s33, 65536
    s_nop 0
    buffer_load_dwordx4 v10, s[56:59], s82 offen offset:0 sc1 lds
    ds_write_b64 v5, v[92:93] offset:512
    s_waitcnt vmcnt(24)
    v_add_f32 v96, v96, v160
    v_add_f32 v97, v97, v161
    v_add_f32 v98, v98, v162
    v_add_f32 v99, v99, v163
    v_cvt_pk_bf16_f32 v28, v96, v97
    v_cvt_pk_bf16_f32 v29, v98, v99
    v_lshlrev_b32 v96, 16, v28
    v_and_b32 v97, 0xffff0000, v28
    v_lshlrev_b32 v98, 16, v29
    v_and_b32 v99, 0xffff0000, v29
    v_mul_f32 v24, 0xbfb8aa3b, v96
    v_mul_f32 v25, 0xbfb8aa3b, v97
    v_mul_f32 v26, 0xbfb8aa3b, v98
    v_mul_f32 v27, 0xbfb8aa3b, v99
    v_exp_f32 v24, v24
    buffer_load_dwordx4 v10, s[56:59], s82 offen offset:1024 sc1 lds
    v_exp_f32 v25, v25
    v_exp_f32 v26, v26
    v_exp_f32 v27, v27
    s_nop 0
    v_add_f32 v24, 1.0, v24
    v_add_f32 v25, 1.0, v25
    v_add_f32 v26, 1.0, v26
    v_add_f32 v27, 1.0, v27
    v_rcp_f32 v24, v24
    v_rcp_f32 v25, v25
    v_rcp_f32 v26, v26
    buffer_load_dwordx4 v10, s[56:59], s82 offen offset:2048 sc1 lds
    v_rcp_f32 v27, v27
    s_nop 0
    v_mul_f32 v24, v24, v96
    v_mul_f32 v25, v25, v97
    v_mul_f32 v26, v26, v98
    v_mul_f32 v27, v27, v99
    v_cvt_pk_bf16_f32 v96, v24, v25
    v_cvt_pk_bf16_f32 v97, v26, v27
    buffer_load_dwordx4 v10, s[56:59], s82 offen offset:3072 sc1 lds
    s_add_u32 s82, s82, 16384
    ds_write_b64 v5, v[96:97] offset:1024
    s_waitcnt vmcnt(26)
    v_add_f32 v100, v100, v164
    v_add_f32 v101, v101, v165
    v_add_f32 v102, v102, v166
    v_add_f32 v103, v103, v167
    v_cvt_pk_bf16_f32 v28, v100, v101
    v_cvt_pk_bf16_f32 v29, v102, v103
    v_lshlrev_b32 v100, 16, v28
    v_and_b32 v101, 0xffff0000, v28
    v_lshlrev_b32 v102, 16, v29
    v_and_b32 v103, 0xffff0000, v29
    v_mul_f32 v24, 0xbfb8aa3b, v100
    v_mul_f32 v25, 0xbfb8aa3b, v101
    v_mul_f32 v26, 0xbfb8aa3b, v102
    v_mul_f32 v27, 0xbfb8aa3b, v103
    v_exp_f32 v24, v24
    s_lshl1_add_u32 m0, s33, 81920
    s_nop 0
    buffer_load_dwordx4 v11, s[60:63], s83 offen lds
    v_exp_f32 v25, v25
    v_exp_f32 v26, v26
    v_exp_f32 v27, v27
    s_nop 0
    v_add_f32 v24, 1.0, v24
    v_add_f32 v25, 1.0, v25
    v_add_f32 v26, 1.0, v26
    v_add_f32 v27, 1.0, v27
    v_rcp_f32 v24, v24
    v_rcp_f32 v25, v25
    v_rcp_f32 v26, v26
    s_lshl1_add_u32 m0, s33, 82944
    s_nop 0
    buffer_load_dwordx4 v12, s[60:63], s83 offen lds
    s_add_u32 s83, s83, 131072
    v_rcp_f32 v27, v27
    s_nop 0
    v_mul_f32 v24, v24, v100
    v_mul_f32 v25, v25, v101
    v_mul_f32 v26, v26, v102
    v_mul_f32 v27, v27, v103
    v_cvt_pk_bf16_f32 v100, v24, v25
    v_cvt_pk_bf16_f32 v101, v26, v27
    s_waitcnt vmcnt(12)
    s_barrier
    ds_write_b64 v5, v[100:101] offset:1536
    s_waitcnt vmcnt(27)
    v_add_f32 v104, v104, v168
    v_add_f32 v105, v105, v169
    v_add_f32 v106, v106, v170
    v_add_f32 v107, v107, v171
    v_cvt_pk_bf16_f32 v28, v104, v105
    v_cvt_pk_bf16_f32 v29, v106, v107
    v_lshlrev_b32 v104, 16, v28
    v_and_b32 v105, 0xffff0000, v28
    v_lshlrev_b32 v106, 16, v29
    v_and_b32 v107, 0xffff0000, v29
    v_mul_f32 v24, 0xbfb8aa3b, v104
    v_mul_f32 v25, 0xbfb8aa3b, v105
    v_mul_f32 v26, 0xbfb8aa3b, v106
    v_mul_f32 v27, 0xbfb8aa3b, v107
    v_exp_f32 v24, v24
    v_exp_f32 v25, v25
    v_exp_f32 v26, v26
    v_exp_f32 v27, v27
    s_nop 0
    v_add_f32 v24, 1.0, v24
    v_add_f32 v25, 1.0, v25
    v_add_f32 v26, 1.0, v26
    v_add_f32 v27, 1.0, v27
    v_rcp_f32 v24, v24
    v_rcp_f32 v25, v25
    v_rcp_f32 v26, v26
    v_rcp_f32 v27, v27
    s_nop 0
    v_mul_f32 v24, v24, v104
    v_mul_f32 v25, v25, v105
    v_mul_f32 v26, v26, v106
    v_mul_f32 v27, v27, v107
    v_cvt_pk_bf16_f32 v104, v24, v25
    v_cvt_pk_bf16_f32 v105, v26, v27
    ds_write_b64 v5, v[104:105] offset:2048
    s_waitcnt vmcnt(26)
    v_add_f32 v108, v108, v172
    v_add_f32 v109, v109, v173
    v_add_f32 v110, v110, v174
    v_add_f32 v111, v111, v175
    v_cvt_pk_bf16_f32 v28, v108, v109
    v_cvt_pk_bf16_f32 v29, v110, v111
    v_lshlrev_b32 v108, 16, v28
    v_and_b32 v109, 0xffff0000, v28
    v_lshlrev_b32 v110, 16, v29
    v_and_b32 v111, 0xffff0000, v29
    v_mul_f32 v24, 0xbfb8aa3b, v108
    v_mul_f32 v25, 0xbfb8aa3b, v109
    v_mul_f32 v26, 0xbfb8aa3b, v110
    v_mul_f32 v27, 0xbfb8aa3b, v111
    v_exp_f32 v24, v24
    v_exp_f32 v25, v25
    v_exp_f32 v26, v26
    v_exp_f32 v27, v27
    s_nop 0
    v_add_f32 v24, 1.0, v24
    v_add_f32 v25, 1.0, v25
    v_add_f32 v26, 1.0, v26
    v_add_f32 v27, 1.0, v27
    v_rcp_f32 v24, v24
    v_rcp_f32 v25, v25
    v_rcp_f32 v26, v26
    v_rcp_f32 v27, v27
    s_nop 0
    v_mul_f32 v24, v24, v108
    v_mul_f32 v25, v25, v109
    v_mul_f32 v26, v26, v110
    v_mul_f32 v27, v27, v111
    v_cvt_pk_bf16_f32 v108, v24, v25
    v_cvt_pk_bf16_f32 v109, v26, v27
    s_waitcnt vmcnt(6)
    s_barrier
    ds_write_b64 v5, v[108:109] offset:2560
    s_waitcnt vmcnt(25)
    v_add_f32 v112, v112, v176
    v_add_f32 v113, v113, v177
    v_add_f32 v114, v114, v178
    v_add_f32 v115, v115, v179
    v_cvt_pk_bf16_f32 v28, v112, v113
    v_cvt_pk_bf16_f32 v29, v114, v115
    v_lshlrev_b32 v112, 16, v28
    v_and_b32 v113, 0xffff0000, v28
    v_lshlrev_b32 v114, 16, v29
    v_and_b32 v115, 0xffff0000, v29
    v_mul_f32 v24, 0xbfb8aa3b, v112
    v_mul_f32 v25, 0xbfb8aa3b, v113
    v_mul_f32 v26, 0xbfb8aa3b, v114
    v_mul_f32 v27, 0xbfb8aa3b, v115
    v_exp_f32 v24, v24
    v_exp_f32 v25, v25
    v_exp_f32 v26, v26
    v_exp_f32 v27, v27
    s_nop 0
    v_add_f32 v24, 1.0, v24
    v_add_f32 v25, 1.0, v25
    v_add_f32 v26, 1.0, v26
    v_add_f32 v27, 1.0, v27
    v_rcp_f32 v24, v24
    v_rcp_f32 v25, v25
    v_rcp_f32 v26, v26
    v_rcp_f32 v27, v27
    s_nop 0
    v_mul_f32 v24, v24, v112
    v_mul_f32 v25, v25, v113
    v_mul_f32 v26, v26, v114
    v_mul_f32 v27, v27, v115
    v_cvt_pk_bf16_f32 v112, v24, v25
    v_cvt_pk_bf16_f32 v113, v26, v27
    ds_write_b64 v5, v[112:113] offset:3072
    s_waitcnt vmcnt(24)
    v_add_f32 v116, v116, v180
    v_add_f32 v117, v117, v181
    v_add_f32 v118, v118, v182
    v_add_f32 v119, v119, v183
    v_cvt_pk_bf16_f32 v28, v116, v117
    v_cvt_pk_bf16_f32 v29, v118, v119
    v_lshlrev_b32 v116, 16, v28
    v_and_b32 v117, 0xffff0000, v28
    v_lshlrev_b32 v118, 16, v29
    v_and_b32 v119, 0xffff0000, v29
    v_mul_f32 v24, 0xbfb8aa3b, v116
    v_mul_f32 v25, 0xbfb8aa3b, v117
    v_mul_f32 v26, 0xbfb8aa3b, v118
    v_mul_f32 v27, 0xbfb8aa3b, v119
    v_exp_f32 v24, v24
    v_exp_f32 v25, v25
    v_exp_f32 v26, v26
    v_exp_f32 v27, v27
    s_nop 0
    v_add_f32 v24, 1.0, v24
    v_add_f32 v25, 1.0, v25
    v_add_f32 v26, 1.0, v26
    v_add_f32 v27, 1.0, v27
    v_rcp_f32 v24, v24
    v_rcp_f32 v25, v25
    v_rcp_f32 v26, v26
    v_rcp_f32 v27, v27
    s_nop 0
    v_mul_f32 v24, v24, v116
    v_mul_f32 v25, v25, v117
    v_mul_f32 v26, v26, v118
    v_mul_f32 v27, v27, v119
    v_cvt_pk_bf16_f32 v116, v24, v25
    v_cvt_pk_bf16_f32 v117, v26, v27
    s_waitcnt vmcnt(0)
    s_barrier
    ds_write_b64 v5, v[116:117] offset:3584
    s_waitcnt lgkmcnt(0)
    s_barrier
    s_branch L_fin
L_teamB:
    s_setprio 0
    v_lshrrev_b32 v64, 4, v1
    v_bfe_u32 v65, v1, 2, 2
    v_and_b32 v66, 3, v1
    v_and_b32 v67, 15, v1
    v_lshrrev_b32 v68, 3, v1
    v_and_b32 v69, 7, v1
    s_lshl_b32 s85, s28, 7
    s_lshl_b32 s86, s4, 5
    s_add_u32 s86, s85, s86
    v_add_u32 v71, s86, v68
    v_xor_b32 v70, v69, v64
    v_lshlrev_b32 v70, 4, v70
    v_lshl_add_u32 v20, v71, 11, v70
    v_xor_b32 v21, 64, v20
    v_add_u32 v21, 16384, v21
    s_lshl_b32 s79, s4, 12
    s_mov_b32 s36, s8
    s_mov_b32 s37, s9
    s_mov_b32 s38, 0x400000
    s_mov_b32 s39, 0x20000
    s_add_u32 m0, s79, 116736
    s_mov_b32 s78, 0
    buffer_load_dwordx4 v20, s[36:39], s78 offen lds
    s_add_u32 m0, s79, 117760
    s_nop 0
    buffer_load_dwordx4 v21, s[36:39], s78 offen lds
    s_add_u32 m0, s79, 118784
    s_mov_b32 s78, 32768
    buffer_load_dwordx4 v20, s[36:39], s78 offen lds
    s_add_u32 m0, s79, 119808
    s_nop 0
    buffer_load_dwordx4 v21, s[36:39], s78 offen lds
    s_lshl_b32 s85, s4, 3
    s_and_b32 s86, s4, 1
    s_lshl_b32 s86, s86, 2
    v_and_b32 v70, 2, v68
    v_xor_b32 v70, v70, v69
    v_xor_b32 v70, s86, v70
    v_add_u32 v71, s85, v68
    v_mul_u32_u24 v71, 7168, v71
    v_lshl_add_u32 v22, v70, 4, v71
    v_lshrrev_b32 v71, 2, v1
    s_lshl_b32 s86, s86, 2
    v_add_u32 v71, s86, v71
    v_mul_u32_u24 v71, 7168, v71
    v_and_b32 v70, 2, v64
    v_xor_b32 v70, v70, v66
    v_lshl_add_u32 v9, v70, 4, v71
    s_mul_i32 s85, s29, 320
    s_and_b32 s86, s29, 1
    s_lshl_b32 s87, s86, 6
    s_add_u32 s87, s87, s85
    s_add_u32 s40, s16, s87
    s_addc_u32 s41, s17, 0
    s_sub_u32 s42, 7340032, s87
    s_mov_b32 s43, 0x20000
    s_add_u32 s44, s18, s87
    s_addc_u32 s45, s19, 0
    s_sub_u32 s46, 7340032, s87
    s_mov_b32 s47, 0x20000
    s_xor_b32 s86, s86, 1
    s_lshl_b32 s86, s86, 8
    s_add_u32 s87, s86, s85
    s_cmp_lt_u32 s4, 2
    s_cselect_b32 s88, s16, s18
    s_cselect_b32 s89, s17, s19
    s_add_u32 s48, s88, s87
    s_addc_u32 s49, s89, 0
    s_sub_u32 s50, 7340032, s87
    s_mov_b32 s51, 0x20000
    s_add_u32 m0, s33, 16384
    s_mov_b32 s77, 0
    buffer_load_dwordx4 v22, s[40:43], s77 offen offset:0 lds
    s_add_u32 m0, s33, 20352
    s_nop 0
    buffer_load_dwordx4 v22, s[40:43], s77 offen offset:128 lds
    s_add_u32 m0, s33, 24576
    s_nop 0
    buffer_load_dwordx4 v22, s[44:47], s77 offen offset:0 lds
    s_add_u32 m0, s33, 28544
    s_nop 0
    buffer_load_dwordx4 v22, s[44:47], s77 offen offset:128 lds
    s_add_u32 m0, s33, 32768
    s_nop 0
    buffer_load_dwordx4 v9, s[48:51], s77 offen lds
    s_add_u32 m0, s79, 135168
    s_mov_b32 s78, 128
    buffer_load_dwordx4 v20, s[36:39], s78 offen lds
    s_add_u32 m0, s79, 136192
    s_nop 0
    buffer_load_dwordx4 v21, s[36:39], s78 offen lds
    s_add_u32 m0, s33, 36864
    s_mov_b32 s77, 229376
    buffer_load_dwordx4 v22, s[40:43], s77 offen offset:0 lds
    s_add_u32 m0, s33, 40832
    s_nop 0
    buffer_load_dwordx4 v22, s[40:43], s77 offen offset:128 lds
    s_add_u32 m0, s33, 45056
    s_nop 0
    buffer_load_dwordx4 v22, s[44:47], s77 offen offset:0 lds
    s_add_u32 m0, s33, 49024
    s_nop 0
    buffer_load_dwordx4 v22, s[44:47], s77 offen offset:128 lds
    s_add_u32 m0, s33, 53248
    s_nop 0
    buffer_load_dwordx4 v9, s[48:51], s77 offen lds
    s_lshl_b32 s84, s28, 7
    s_lshl_b32 s85, s29, 3
    s_add_u32 s84, s84, s85
    s_lshl1_add_u32 s84, s4, s84
    s_lshl_b32 s90, s84, 3
    s_lshl_b32 s84, s84, 11
    v_lshl_add_u32 v4, v1, 4, s84
    s_cmp_lt_u32 s4, 2
    s_cselect_b32 s72, s16, s18
    s_cselect_b32 s73, s17, s19
    s_mov_b32 s74, 7340032
    s_mov_b32 s75, 0x20000
    s_mul_i32 s84, s29, 320
    s_and_b32 s85, s29, 1
    s_lshl_b32 s86, s85, 6
    s_add_u32 s86, s86, s84
    s_lshl_b32 s87, s6, 7
    s_add_u32 s86, s86, s87
    s_xor_b32 s85, s85, 1
    s_lshl_b32 s85, s85, 8
    s_add_u32 s85, s85, s84
    s_lshl_b32 s87, s6, 5
    s_add_u32 s85, s85, s87
    s_mul_i32 s87, s28, 458752
    s_add_u32 s86, s86, s87
    s_add_u32 s85, s85, s87
    v_lshrrev_b32 v64, 3, v1
    v_and_b32 v65, 7, v1
    v_mul_u32_u24 v64, 7168, v64
    v_lshl_add_u32 v64, v65, 4, v64
    v_add_u32 v5, s86, v64
    v_lshrrev_b32 v64, 1, v1
    v_and_b32 v65, 1, v1
    v_mul_u32_u24 v64, 7168, v64
    v_lshl_add_u32 v64, v65, 4, v64
    v_add_u32 v6, s85, v64
    s_lshl2_add_u32 s91, s2, s4
    s_lshl_b32 s52, s91, 6
    s_lshr_b32 s92, s91, 5
    s_mul_i32 s92, s92, 7168
    s_and_b32 s91, s91, 31
    s_lshl_b32 s91, s91, 6
    s_add_u32 s92, s92, s91
    s_add_u32 s53, s92, 5120
    s_waitcnt vmcnt(7)
    s_barrier
    s_add_u32 m0, s79, 137216
    s_mov_b32 s78, 32896
    buffer_load_dwordx4 v20, s[36:39], s78 offen lds
    s_add_u32 m0, s79, 138240
    s_nop 0
    buffer_load_dwordx4 v21, s[36:39], s78 offen lds
    s_add_u32 m0, s33, 57344
    s_mov_b32 s77, 458752
    buffer_load_dwordx4 v22, s[40:43], s77 offen offset:0 lds
    s_add_u32 m0, s33, 61312
    s_nop 0
    buffer_load_dwordx4 v22, s[40:43], s77 offen offset:128 lds
    s_add_u32 m0, s33, 65536
    s_nop 0
    buffer_load_dwordx4 v22, s[44:47], s77 offen offset:0 lds
    s_add_u32 m0, s33, 69504
    s_nop 0
    buffer_load_dwordx4 v22, s[44:47], s77 offen offset:128 lds
    s_add_u32 m0, s33, 73728
    s_nop 0
    buffer_load_dwordx4 v9, s[48:51], s77 offen lds
    s_add_u32 m0, s79, 98304
    s_mov_b32 s78, 256
    buffer_load_dwordx4 v20, s[36:39], s78 offen lds
    s_add_u32 m0, s79, 99328
    s_nop 0
    buffer_load_dwordx4 v21, s[36:39], s78 offen lds
    s_add_u32 m0, s33, 77824
    s_mov_b32 s77, 688128
    buffer_load_dwordx4 v22, s[40:43], s77 offen offset:0 lds
    s_load_dword s94, s[10:11], s52 offset:0x0
    s_load_dword s94, s[10:11], s52 offset:0x10000
    s_load_dword s94, s[10:11], s52 offset:0x20000
    s_load_dword s94, s[16:17], s53 offset:0x0
    global_load_dwordx4 v[24:27], v4, s[8:9] offset:0
    s_lshr_b32 s92, s28, 2
    s_cmp_lg_u32 s92, 0
    s_cbranch_scc1 L_cs0_0
    s_mov_b32 s91, 0
    buffer_load_dwordx4 v[88:91], v5, s[72:75], s91 offen
    s_mov_b32 s91, 57344
    buffer_load_dwordx4 v[92:95], v5, s[72:75], s91 offen
    s_mov_b32 s91, 114688
    buffer_load_dwordx4 v[96:99], v5, s[72:75], s91 offen
    s_mov_b32 s91, 172032
    buffer_load_dwordx4 v[100:103], v5, s[72:75], s91 offen
    s_mov_b32 s91, 229376
    buffer_load_dwordx4 v[104:107], v5, s[72:75], s91 offen
L_cs0_0:
    s_lshr_b32 s92, s28, 2
    s_cmp_lg_u32 s92, 1
    s_cbranch_scc1 L_cs1_0
    s_mov_b32 s91, 0
    buffer_load_dwordx4 v[88:91], v5, s[72:75], s91 offen
    s_mov_b32 s91, 57344
    buffer_load_dwordx4 v[92:95], v5, s[72:75], s91 offen
L_cs1_0:
    s_waitcnt vmcnt(11)
    s_barrier
    s_add_u32 m0, s33, 81792
    s_nop 0
    buffer_load_dwordx4 v22, s[40:43], s77 offen offset:128 lds
    s_add_u32 m0, s33, 86016
    s_nop 0
    buffer_load_dwordx4 v22, s[44:47], s77 offen offset:0 lds
    s_add_u32 m0, s33, 89984
    s_nop 0
    buffer_load_dwordx4 v22, s[44:47], s77 offen offset:128 lds
    s_add_u32 m0, s33, 94208
    s_nop 0
    buffer_load_dwordx4 v9, s[48:51], s77 offen lds
    s_add_u32 m0, s79, 100352
    s_mov_b32 s78, 33024
    buffer_load_dwordx4 v20, s[36:39], s78 offen lds
    s_add_u32 m0, s79, 101376
    s_nop 0
    buffer_load_dwordx4 v21, s[36:39], s78 offen lds
    s_add_u32 m0, s33, 16384
    s_mov_b32 s77, 917504
    buffer_load_dwordx4 v22, s[40:43], s77 offen offset:0 lds
    s_add_u32 m0, s33, 20352
    s_nop 0
    buffer_load_dwordx4 v22, s[40:43], s77 offen offset:128 lds
    s_add_u32 m0, s33, 24576
    s_nop 0
    buffer_load_dwordx4 v22, s[44:47], s77 offen offset:0 lds
    s_add_u32 m0, s33, 28544
    s_nop 0
    buffer_load_dwordx4 v22, s[44:47], s77 offen offset:128 lds
    s_load_dword s94, s[18:19], s53 offset:0x0
    s_load_dword s94, s[10:11], s52 offset:0x30000
    s_load_dword s94, s[10:11], s52 offset:0x40000
    s_load_dword s94, s[10:11], s52 offset:0x50000
    global_load_dwordx4 v[32:35], v4, s[8:9] offset:2048
    s_lshr_b32 s92, s28, 2
    s_cmp_lg_u32 s92, 0
    s_cbranch_scc1 L_cs0_5
    s_mov_b32 s91, 286720
    buffer_load_dwordx4 v[108:111], v5, s[72:75], s91 offen
    s_mov_b32 s91, 344064
    buffer_load_dwordx4 v[112:115], v5, s[72:75], s91 offen
    s_mov_b32 s91, 401408
    buffer_load_dwordx4 v[116:119], v5, s[72:75], s91 offen
    s_mov_b32 s91, 0
    buffer_load_dwordx4 v[120:123], v6, s[72:75], s91 offen
    s_mov_b32 s91, 229376
    buffer_load_dwordx4 v[124:127], v6, s[72:75], s91 offen
L_cs0_5:
    s_lshr_b32 s92, s28, 2
    s_cmp_lg_u32 s92, 1
    s_cbranch_scc1 L_cs1_2
    s_mov_b32 s91, 114688
    buffer_load_dwordx4 v[96:99], v5, s[72:75], s91 offen
    s_mov_b32 s91, 172032
    buffer_load_dwordx4 v[100:103], v5, s[72:75], s91 offen
L_cs1_2:
    s_waitcnt vmcnt(15)
    s_barrier
    s_add_u32 m0, s33, 32768
    s_nop 0
    buffer_load_dwordx4 v9, s[48:51], s77 offen lds
    s_add_u32 m0, s79, 116736
    s_mov_b32 s78, 384
    buffer_load_dwordx4 v20, s[36:39], s78 offen lds
    s_add_u32 m0, s79, 117760
    s_nop 0
    buffer_load_dwordx4 v21, s[36:39], s78 offen lds
    s_add_u32 m0, s33, 36864
    s_mov_b32 s77, 1146880
    buffer_load_dwordx4 v22, s[40:43], s77 offen offset:0 lds
    s_add_u32 m0, s33, 40832
    s_nop 0
    buffer_load_dwordx4 v22, s[40:43], s77 offen offset:128 lds
    s_add_u32 m0, s33, 45056
    s_nop 0
    buffer_load_dwordx4 v22, s[44:47], s77 offen offset:0 lds
    s_add_u32 m0, s33, 49024
    s_nop 0
    buffer_load_dwordx4 v22, s[44:47], s77 offen offset:128 lds
    s_add_u32 m0, s33, 53248
    s_nop 0
    buffer_load_dwordx4 v9, s[48:51], s77 offen lds
    s_load_dword s94, s[16:17], s53 offset:0x38000
    s_load_dword s94, s[18:19], s53 offset:0x38000
    s_load_dword s94, s[10:11], s52 offset:0x60000
    s_load_dword s94, s[10:11], s52 offset:0x70000
    global_load_dwordx4 v[28:31], v4, s[8:9] offset:1024
    s_lshr_b32 s92, s28, 2
    s_cmp_lg_u32 s92, 1
    s_cbranch_scc1 L_cs1_4
    s_mov_b32 s91, 229376
    buffer_load_dwordx4 v[104:107], v5, s[72:75], s91 offen
    s_mov_b32 s91, 286720
    buffer_load_dwordx4 v[108:111], v5, s[72:75], s91 offen
L_cs1_4:
    s_waitcnt vmcnt(16)
    s_barrier
    s_add_u32 m0, s79, 118784
    s_mov_b32 s78, 33152
    buffer_load_dwordx4 v20, s[36:39], s78 offen lds
    s_add_u32 m0, s79, 119808
    s_nop 0
    buffer_load_dwordx4 v21, s[36:39], s78 offen lds
    s_add_u32 m0, s33, 57344
    s_mov_b32 s77, 1376256
    buffer_load_dwordx4 v22, s[40:43], s77 offen offset:0 lds
    s_add_u32 m0, s33, 61312
    s_nop 0
    buffer_load_dwordx4 v22, s[40:43], s77 offen offset:128 lds
    s_add_u32 m0, s33, 65536
    s_nop 0
    buffer_load_dwordx4 v22, s[44:47], s77 offen offset:0 lds
    s_add_u32 m0, s33, 69504
    s_nop 0
    buffer_load_dwordx4 v22, s[44:47], s77 offen offset:128 lds
    s_add_u32 m0, s33, 73728
    s_nop 0
    buffer_load_dwordx4 v9, s[48:51], s77 offen lds
    s_load_dword s94, s[10:11], s52 offset:0x80000
    s_load_dword s94, s[16:17], s53 offset:0x70000
    s_load_dword s94, s[18:19], s53 offset:0x70000
    s_load_dword s94, s[10:11], s52 offset:0x90000
    global_load_dwordx4 v[36:39], v4, s[8:9] offset:3072
    s_lshr_b32 s92, s28, 2
    s_cmp_lg_u32 s92, 1
    s_cbranch_scc1 L_cs1_6
    s_mov_b32 s91, 344064
    buffer_load_dwordx4 v[112:115], v5, s[72:75], s91 offen
    s_mov_b32 s91, 401408
    buffer_load_dwordx4 v[116:119], v5, s[72:75], s91 offen
L_cs1_6:
    s_lshr_b32 s92, s28, 2
    s_cmp_lg_u32 s92, 2
    s_cbranch_scc1 L_cs2_0
    s_mov_b32 s91, 0
    buffer_load_dwordx4 v[88:91], v5, s[72:75], s91 offen
    s_mov_b32 s91, 57344
    buffer_load_dwordx4 v[92:95], v5, s[72:75], s91 offen
L_cs2_0:
    s_waitcnt vmcnt(16)
    s_barrier
    s_add_u32 m0, s79, 135168
    s_mov_b32 s78, 512
    buffer_load_dwordx4 v20, s[36:39], s78 offen lds
    s_add_u32 m0, s79, 136192
    s_nop 0
    buffer_load_dwordx4 v21, s[36:39], s78 offen lds
    s_add_u32 m0, s33, 77824
    s_mov_b32 s77, 1605632
    buffer_load_dwordx4 v22, s[40:43], s77 offen offset:0 lds
    s_add_u32 m0, s33, 81792
    s_nop 0
    buffer_load_dwordx4 v22, s[40:43], s77 offen offset:128 lds
    s_add_u32 m0, s33, 86016
    s_nop 0
    buffer_load_dwordx4 v22, s[44:47], s77 offen offset:0 lds
    s_add_u32 m0, s33, 89984
    s_nop 0
    buffer_load_dwordx4 v22, s[44:47], s77 offen offset:128 lds
    s_add_u32 m0, s33, 94208
    s_nop 0
    buffer_load_dwordx4 v9, s[48:51], s77 offen lds
    s_load_dword s94, s[10:11], s52 offset:0xa0000
    s_load_dword s94, s[10:11], s52 offset:0xb0000
    s_load_dword s94, s[16:17], s53 offset:0xa8000
    s_load_dword s94, s[18:19], s53 offset:0xa8000
    s_lshr_b32 s92, s28, 2
    s_cmp_lg_u32 s92, 1
    s_cbranch_scc1 L_cs1_8
    s_mov_b32 s91, 0
    buffer_load_dwordx4 v[120:123], v6, s[72:75], s91 offen
    s_mov_b32 s91, 229376
    buffer_load_dwordx4 v[124:127], v6, s[72:75], s91 offen
L_cs1_8:
    s_lshr_b32 s92, s28, 2
    s_cmp_lg_u32 s92, 2
    s_cbranch_scc1 L_cs2_2
    s_mov_b32 s91, 114688
    buffer_load_dwordx4 v[96:99], v5, s[72:75], s91 offen
    s_mov_b32 s91, 172032
    buffer_load_dwordx4 v[100:103], v5, s[72:75], s91 offen
L_cs2_2:
    s_waitcnt vmcnt(16)
    s_barrier
    s_add_u32 m0, s79, 137216
    s_mov_b32 s78, 33280
    buffer_load_dwordx4 v20, s[36:39], s78 offen lds
    s_add_u32 m0, s79, 138240
    s_nop 0
    buffer_load_dwordx4 v21, s[36:39], s78 offen lds
    s_add_u32 m0, s33, 16384
    s_mov_b32 s77, 1835008
    buffer_load_dwordx4 v22, s[40:43], s77 offen offset:0 lds
    s_add_u32 m0, s33, 20352
    s_nop 0
    buffer_load_dwordx4 v22, s[40:43], s77 offen offset:128 lds
    s_add_u32 m0, s33, 24576
    s_nop 0
    buffer_load_dwordx4 v22, s[44:47], s77 offen offset:0 lds
    s_add_u32 m0, s33, 28544
    s_nop 0
    buffer_load_dwordx4 v22, s[44:47], s77 offen offset:128 lds
    s_add_u32 m0, s33, 32768
    s_nop 0
    buffer_load_dwordx4 v9, s[48:51], s77 offen lds
    s_load_dword s94, s[10:11], s52 offset:0xc0000
    s_load_dword s94, s[10:11], s52 offset:0xd0000
    s_load_dword s94, s[10:11], s52 offset:0xe0000
    s_load_dword s94, s[16:17], s53 offset:0xe0000
    s_lshr_b32 s92, s28, 2
    s_cmp_lg_u32 s92, 2
    s_cbranch_scc1 L_cs2_4
    s_mov_b32 s91, 229376
    buffer_load_dwordx4 v[104:107], v5, s[72:75], s91 offen
    s_mov_b32 s91, 286720
    buffer_load_dwordx4 v[108:111], v5, s[72:75], s91 offen
L_cs2_4:
    s_waitcnt vmcnt(15)
    s_barrier
    s_add_u32 m0, s79, 98304
    s_mov_b32 s78, 640
    buffer_load_dwordx4 v20, s[36:39], s78 offen lds
    s_waitcnt vmcnt(15)
    v_lshlrev_b32 v40, 16, v24
    v_and_b32 v41, 0xffff0000, v24
    v_lshlrev_b32 v42, 16, v25
    v_and_b32 v43, 0xffff0000, v25
    v_lshlrev_b32 v44, 16, v26
    v_and_b32 v45, 0xffff0000, v26
    v_lshlrev_b32 v46, 16, v27
    v_and_b32 v47, 0xffff0000, v27
    v_lshlrev_b32 v48, 16, v28
    v_and_b32 v49, 0xffff0000, v28
    v_lshlrev_b32 v50, 16, v29
    v_and_b32 v51, 0xffff0000, v29
    v_lshlrev_b32 v52, 16, v30
    v_and_b32 v53, 0xffff0000, v30
    v_lshlrev_b32 v54, 16, v31
    v_and_b32 v55, 0xffff0000, v31
    s_add_u32 m0, s79, 99328
    s_nop 0
    buffer_load_dwordx4 v21, s[36:39], s78 offen lds
    v_lshlrev_b32 v56, 16, v32
    v_and_b32 v57, 0xffff0000, v32
    v_lshlrev_b32 v58, 16, v33
    v_and_b32 v59, 0xffff0000, v33
    v_lshlrev_b32 v60, 16, v34
    v_and_b32 v61, 0xffff0000, v34
    v_lshlrev_b32 v62, 16, v35
    v_and_b32 v63, 0xffff0000, v35
    s_add_u32 m0, s33, 36864
    s_mov_b32 s77, 2064384
    buffer_load_dwordx4 v22, s[40:43], s77 offen offset:0 lds
    v_lshlrev_b32 v64, 16, v36
    v_and_b32 v65, 0xffff0000, v36
    v_lshlrev_b32 v66, 16, v37
    v_and_b32 v67, 0xffff0000, v37
    v_lshlrev_b32 v68, 16, v38
    v_and_b32 v69, 0xffff0000, v38
    v_lshlrev_b32 v70, 16, v39
    v_and_b32 v71, 0xffff0000, v39
    s_add_u32 m0, s33, 40832
    s_nop 0
    buffer_load_dwordx4 v22, s[40:43], s77 offen offset:128 lds
    v_add_f32 v72, v40, v41
    v_add_f32 v74, v56, v57
    v_add_f32 v72, v72, v42
    v_add_f32 v74, v74, v58
    v_add_f32 v72, v72, v43
    v_add_f32 v74, v74, v59
    v_add_f32 v72, v72, v44
    v_add_f32 v74, v74, v60
    s_add_u32 m0, s33, 45056
    s_nop 0
    buffer_load_dwordx4 v22, s[44:47], s77 offen offset:0 lds
    v_add_f32 v72, v72, v45
    v_add_f32 v74, v74, v61
    v_add_f32 v72, v72, v46
    v_add_f32 v74, v74, v62
    v_add_f32 v72, v72, v47
    v_add_f32 v74, v74, v63
    v_add_f32 v72, v72, v48
    v_add_f32 v74, v74, v64
    s_add_u32 m0, s33, 49024
    s_nop 0
    buffer_load_dwordx4 v22, s[44:47], s77 offen offset:128 lds
    v_add_f32 v72, v72, v49
    v_add_f32 v74, v74, v65
    v_add_f32 v72, v72, v50
    v_add_f32 v74, v74, v66
    v_add_f32 v72, v72, v51
    v_add_f32 v74, v74, v67
    v_add_f32 v72, v72, v52
    v_add_f32 v74, v74, v68
    s_add_u32 m0, s33, 53248
    s_nop 0
    buffer_load_dwordx4 v9, s[48:51], s77 offen lds
    v_add_f32 v72, v72, v53
    v_add_f32 v74, v74, v69
    v_add_f32 v72, v72, v54
    v_add_f32 v74, v74, v70
    v_add_f32 v72, v72, v55
    v_add_f32 v74, v74, v71
    s_nop 0
    v_add_f32_dpp v72, v72, v72 quad_perm:[1,0,3,2] row_mask:0xf bank_mask:0xf
    v_add_f32_dpp v74, v74, v74 quad_perm:[1,0,3,2] row_mask:0xf bank_mask:0xf
    s_load_dword s94, s[18:19], s53 offset:0xe0000
    s_load_dword s94, s[10:11], s52 offset:0xf0000
    s_add_u32 s52, s52, 0x100000
    s_load_dword s94, s[10:11], s52 offset:0x0
    s_load_dword s94, s[10:11], s52 offset:0x10000
    s_lshr_b32 s92, s28, 2
    s_cmp_lg_u32 s92, 2
    s_cbranch_scc1 L_cs2_6
    s_mov_b32 s91, 344064
    buffer_load_dwordx4 v[112:115], v5, s[72:75], s91 offen
    s_mov_b32 s91, 401408
    buffer_load_dwordx4 v[116:119], v5, s[72:75], s91 offen
L_cs2_6:
    s_lshr_b32 s92, s28, 2
    s_cmp_lg_u32 s92, 3
    s_cbranch_scc1 L_cs3_0
    s_mov_b32 s91, 0
    buffer_load_dwordx4 v[88:91], v5, s[72:75], s91 offen
    s_mov_b32 s91, 57344
    buffer_load_dwordx4 v[92:95], v5, s[72:75], s91 offen
L_cs3_0:
    s_waitcnt vmcnt(14)
    s_barrier
    s_add_u32 m0, s79, 100352
    s_mov_b32 s78, 33408
    buffer_load_dwordx4 v20, s[36:39], s78 offen lds
    s_nop 0
    v_add_f32_dpp v72, v72, v72 quad_perm:[2,3,0,1] row_mask:0xf bank_mask:0xf
    v_add_f32_dpp v74, v74, v74 quad_perm:[2,3,0,1] row_mask:0xf bank_mask:0xf
    s_nop 0
    v_add_f32_dpp v72, v72, v72 row_half_mirror row_mask:0xf bank_mask:0xf
    v_add_f32_dpp v74, v74, v74 row_half_mirror row_mask:0xf bank_mask:0xf
    s_nop 0
    v_add_f32_dpp v72, v72, v72 row_mirror row_mask:0xf bank_mask:0xf
    v_add_f32_dpp v74, v74, v74 row_mirror row_mask:0xf bank_mask:0xf
    v_mov_b32 v78, v72
    v_mov_b32 v79, v74
    s_nop 0
    v_permlane16_swap_b32 v72, v78
    v_permlane16_swap_b32 v74, v79
    v_add_f32 v72, v72, v78
    v_add_f32 v74, v74, v79
    v_mov_b32 v78, v72
    v_mov_b32 v79, v74
    s_nop 0
    v_permlane32_swap_b32 v72, v78
    s_add_u32 m0, s79, 101376
    s_nop 0
    buffer_load_dwordx4 v21, s[36:39], s78 offen lds
    s_add_u32 m0, s33, 57344
    s_mov_b32 s77, 2293760
    buffer_load_dwordx4 v22, s[40:43], s77 offen offset:0 lds
    v_permlane32_swap_b32 v74, v79
    v_add_f32 v72, v72, v78
    v_add_f32 v74, v74, v79
    v_mul_f32 v72, 0x3a800000, v72
    v_mul_f32 v74, 0x3a800000, v74
    v_sub_f32 v78, v40, v72
    v_sub_f32 v79, v56, v74
    v_mul_f32 v73, v78, v78
    v_mul_f32 v75, v79, v79
    v_sub_f32 v78, v41, v72
    v_sub_f32 v79, v57, v74
    v_fmac_f32 v73, v78, v78
    v_fmac_f32 v75, v79, v79
    v_sub_f32 v78, v42, v72
    v_sub_f32 v79, v58, v74
    v_fmac_f32 v73, v78, v78
    s_add_u32 m0, s33, 61312
    s_nop 0
    buffer_load_dwordx4 v22, s[40:43], s77 offen offset:128 lds
    v_fmac_f32 v75, v79, v79
    v_sub_f32 v78, v43, v72
    v_sub_f32 v79, v59, v74
    v_fmac_f32 v73, v78, v78
    v_fmac_f32 v75, v79, v79
    v_sub_f32 v78, v44, v72
    v_sub_f32 v79, v60, v74
    v_fmac_f32 v73, v78, v78
    s_add_u32 m0, s33, 65536
    s_nop 0
    buffer_load_dwordx4 v22, s[44:47], s77 offen offset:0 lds
    v_fmac_f32 v75, v79, v79
    v_sub_f32 v78, v45, v72
    v_sub_f32 v79, v61, v74
    v_fmac_f32 v73, v78, v78
    v_fmac_f32 v75, v79, v79
    v_sub_f32 v78, v46, v72
    v_sub_f32 v79, v62, v74
    v_fmac_f32 v73, v78, v78
    s_add_u32 m0, s33, 69504
    s_nop 0
    buffer_load_dwordx4 v22, s[44:47], s77 offen offset:128 lds
    v_fmac_f32 v75, v79, v79
    v_sub_f32 v78, v47, v72
    v_sub_f32 v79, v63, v74
    v_fmac_f32 v73, v78, v78
    v_fmac_f32 v75, v79, v79
    v_sub_f32 v78, v48, v72
    v_sub_f32 v79, v64, v74
    v_fmac_f32 v73, v78, v78
    s_add_u32 m0, s33, 73728
    s_nop 0
    buffer_load_dwordx4 v9, s[48:51], s77 offen lds
    v_fmac_f32 v75, v79, v79
    v_sub_f32 v78, v49, v72
    v_sub_f32 v79, v65, v74
    v_fmac_f32 v73, v78, v78
    v_fmac_f32 v75, v79, v79
    v_sub_f32 v78, v50, v72
    v_sub_f32 v79, v66, v74
    v_fmac_f32 v73, v78, v78
    s_add_u32 s53, s53, 0x118000
    s_load_dword s94, s[16:17], s53 offset:0x0
    s_load_dword s94, s[18:19], s53 offset:0x0
    s_load_dword s94, s[10:11], s52 offset:0x20000
    s_load_dword s94, s[10:11], s52 offset:0x30000
    s_lshr_b32 s92, s28, 2
    s_cmp_lg_u32 s92, 2
    s_cbranch_scc1 L_cs2_8
    s_mov_b32 s91, 0
    buffer_load_dwordx4 v[120:123], v6, s[72:75], s91 offen
    s_mov_b32 s91, 229376
    buffer_load_dwordx4 v[124:127], v6, s[72:75], s91 offen
L_cs2_8:
    s_lshr_b32 s92, s28, 2
    s_cmp_lg_u32 s92, 3
    s_cbranch_scc1 L_cs3_2
    s_mov_b32 s91, 114688
    buffer_load_dwordx4 v[96:99], v5, s[72:75], s91 offen
    s_mov_b32 s91, 172032
    buffer_load_dwordx4 v[100:103], v5, s[72:75], s91 offen
L_cs3_2:
    s_waitcnt vmcnt(14)
    s_barrier
    s_add_u32 m0, s79, 116736
    s_mov_b32 s78, 768
    buffer_load_dwordx4 v20, s[36:39], s78 offen lds
    v_fmac_f32 v75, v79, v79
    v_sub_f32 v78, v51, v72
    v_sub_f32 v79, v67, v74
    v_fmac_f32 v73, v78, v78
    v_fmac_f32 v75, v79, v79
    v_sub_f32 v78, v52, v72
    v_sub_f32 v79, v68, v74
    v_fmac_f32 v73, v78, v78
    v_fmac_f32 v75, v79, v79
    v_sub_f32 v78, v53, v72
    v_sub_f32 v79, v69, v74
    v_fmac_f32 v73, v78, v78
    v_fmac_f32 v75, v79, v79
    v_sub_f32 v78, v54, v72
    v_sub_f32 v79, v70, v74
    v_fmac_f32 v73, v78, v78
    s_add_u32 m0, s79, 117760
    s_nop 0
    buffer_load_dwordx4 v21, s[36:39], s78 offen lds
    v_fmac_f32 v75, v79, v79
    v_sub_f32 v78, v55, v72
    v_sub_f32 v79, v71, v74
    v_fmac_f32 v73, v78, v78
    v_fmac_f32 v75, v79, v79
    s_nop 0
    v_add_f32_dpp v73, v73, v73 quad_perm:[1,0,3,2] row_mask:0xf bank_mask:0xf
    v_add_f32_dpp v75, v75, v75 quad_perm:[1,0,3,2] row_mask:0xf bank_mask:0xf
    s_nop 0
    v_add_f32_dpp v73, v73, v73 quad_perm:[2,3,0,1] row_mask:0xf bank_mask:0xf
    s_add_u32 m0, s33, 77824
    s_mov_b32 s77, 2523136
    buffer_load_dwordx4 v22, s[40:43], s77 offen offset:0 lds
    v_add_f32_dpp v75, v75, v75 quad_perm:[2,3,0,1] row_mask:0xf bank_mask:0xf
    s_nop 0
    v_add_f32_dpp v73, v73, v73 row_half_mirror row_mask:0xf bank_mask:0xf
    v_add_f32_dpp v75, v75, v75 row_half_mirror row_mask:0xf bank_mask:0xf
    s_nop 0
    v_add_f32_dpp v73, v73, v73 row_mirror row_mask:0xf bank_mask:0xf
    v_add_f32_dpp v75, v75, v75 row_mirror row_mask:0xf bank_mask:0xf
    v_mov_b32 v78, v73
    v_mov_b32 v79, v75
    s_add_u32 m0, s33, 81792
    s_nop 0
    buffer_load_dwordx4 v22, s[40:43], s77 offen offset:128 lds
    s_nop 0
    v_permlane16_swap_b32 v73, v78
    v_permlane16_swap_b32 v75, v79
    v_add_f32 v73, v73, v78
    v_add_f32 v75, v75, v79
    v_mov_b32 v78, v73
    v_mov_b32 v79, v75
    s_nop 0
    v_permlane32_swap_b32 v73, v78
    s_add_u32 m0, s33, 86016
    s_nop 0
    buffer_load_dwordx4 v22, s[44:47], s77 offen offset:0 lds
    v_permlane32_swap_b32 v75, v79
    v_add_f32 v73, v73, v78
    v_add_f32 v75, v75, v79
    v_mul_f32 v73, 0x3a800000, v73
    v_mul_f32 v75, 0x3a800000, v75
    v_cvt_pk_bf16_f32 v72, v72, v72
    v_lshlrev_b32 v72, 16, v72
    v_cvt_pk_bf16_f32 v73, v73, v73
    s_add_u32 m0, s33, 89984
    s_nop 0
    buffer_load_dwordx4 v22, s[44:47], s77 offen offset:128 lds
    v_lshlrev_b32 v73, 16, v73
    v_add_f32 v73, 0x3727c5ac, v73
    v_cvt_pk_bf16_f32 v73, v73, v73
    v_lshlrev_b32 v73, 16, v73
    v_sqrt_f32 v73, v73
    v_cvt_pk_bf16_f32 v74, v74, v74
    v_lshlrev_b32 v74, 16, v74
    s_add_u32 m0, s33, 94208
    s_nop 0
    buffer_load_dwordx4 v9, s[48:51], s77 offen lds
    v_cvt_pk_bf16_f32 v75, v75, v75
    v_lshlrev_b32 v75, 16, v75
    v_add_f32 v75, 0x3727c5ac, v75
    v_cvt_pk_bf16_f32 v75, v75, v75
    v_lshlrev_b32 v75, 16, v75
    v_sqrt_f32 v75, v75
    s_nop 0
    v_cvt_pk_bf16_f32 v73, v73, v73
    s_load_dword s94, s[10:11], s52 offset:0x40000
    s_load_dword s94, s[16:17], s53 offset:0x38000
    s_load_dword s94, s[18:19], s53 offset:0x38000
    s_load_dword s94, s[10:11], s52 offset:0x50000
    s_lshr_b32 s92, s28, 2
    s_cmp_lg_u32 s92, 3
    s_cbranch_scc1 L_cs3_4
    s_mov_b32 s91, 229376
    buffer_load_dwordx4 v[104:107], v5, s[72:75], s91 offen
    s_mov_b32 s91, 286720
    buffer_load_dwordx4 v[108:111], v5, s[72:75], s91 offen
L_cs3_4:
    s_waitcnt vmcnt(14)
    s_barrier
    s_add_u32 m0, s79, 118784
    s_mov_b32 s78, 33536
    buffer_load_dwordx4 v20, s[36:39], s78 offen lds
    v_lshlrev_b32 v73, 16, v73
    v_rcp_f32 v76, v73
    s_nop 0
    v_cvt_pk_bf16_f32 v75, v75, v75
    v_lshlrev_b32 v75, 16, v75
    v_rcp_f32 v77, v75
    s_nop 0
    v_fma_f32 v78, -v73, v76, 1.0
    s_add_u32 m0, s79, 119808
    s_nop 0
    buffer_load_dwordx4 v21, s[36:39], s78 offen lds
    v_fma_f32 v76, v78, v76, v76
    s_nop 0
    v_fma_f32 v79, -v75, v77, 1.0
    v_fma_f32 v77, v79, v77, v77
    v_sub_f32 v80, v40, v72
    v_sub_f32 v81, v41, v72
    v_cvt_pk_bf16_f32 v80, v80, v81
    v_and_b32 v81, 0xffff0000, v80
    v_lshlrev_b32 v80, 16, v80
    s_add_u32 m0, s33, 16384
    s_mov_b32 s77, 2752512
    buffer_load_dwordx4 v22, s[40:43], s77 offen offset:0 lds
    v_mul_f32 v80, v80, v76
    v_mul_f32 v81, v81, v76
    v_cvt_pk_bf16_f32 v24, v80, v81
    v_sub_f32 v80, v42, v72
    v_sub_f32 v81, v43, v72
    v_cvt_pk_bf16_f32 v80, v80, v81
    v_and_b32 v81, 0xffff0000, v80
    v_lshlrev_b32 v80, 16, v80
    v_mul_f32 v80, v80, v76
    v_mul_f32 v81, v81, v76
    v_cvt_pk_bf16_f32 v25, v80, v81
    v_sub_f32 v80, v44, v72
    v_sub_f32 v81, v45, v72
    v_cvt_pk_bf16_f32 v80, v80, v81
    v_and_b32 v81, 0xffff0000, v80
    v_lshlrev_b32 v80, 16, v80
    s_add_u32 m0, s33, 20352
    s_nop 0
    buffer_load_dwordx4 v22, s[40:43], s77 offen offset:128 lds
    v_mul_f32 v80, v80, v76
    v_mul_f32 v81, v81, v76
    v_cvt_pk_bf16_f32 v26, v80, v81
    v_sub_f32 v80, v46, v72
    v_sub_f32 v81, v47, v72
    v_cvt_pk_bf16_f32 v80, v80, v81
    v_and_b32 v81, 0xffff0000, v80
    v_lshlrev_b32 v80, 16, v80
    s_add_u32 m0, s33, 24576
    s_nop 0
    buffer_load_dwordx4 v22, s[44:47], s77 offen offset:0 lds
    v_mul_f32 v80, v80, v76
    v_mul_f32 v81, v81, v76
    v_cvt_pk_bf16_f32 v27, v80, v81
    v_sub_f32 v80, v48, v72
    v_sub_f32 v81, v49, v72
    v_cvt_pk_bf16_f32 v80, v80, v81
    v_and_b32 v81, 0xffff0000, v80
    v_lshlrev_b32 v80, 16, v80
    s_add_u32 m0, s33, 28544
    s_nop 0
    buffer_load_dwordx4 v22, s[44:47], s77 offen offset:128 lds
    v_mul_f32 v80, v80, v76
    v_mul_f32 v81, v81, v76
    v_cvt_pk_bf16_f32 v28, v80, v81
    v_sub_f32 v80, v50, v72
    v_sub_f32 v81, v51, v72
    v_cvt_pk_bf16_f32 v80, v80, v81
    v_and_b32 v81, 0xffff0000, v80
    v_lshlrev_b32 v80, 16, v80
    s_add_u32 m0, s33, 32768
    s_nop 0
    buffer_load_dwordx4 v9, s[48:51], s77 offen lds
    v_mul_f32 v80, v80, v76
    v_mul_f32 v81, v81, v76
    v_cvt_pk_bf16_f32 v29, v80, v81
    v_sub_f32 v80, v52, v72
    v_sub_f32 v81, v53, v72
    v_cvt_pk_bf16_f32 v80, v80, v81
    v_and_b32 v81, 0xffff0000, v80
    v_lshlrev_b32 v80, 16, v80
    s_load_dword s94, s[10:11], s52 offset:0x60000
    s_load_dword s94, s[10:11], s52 offset:0x70000
    s_load_dword s94, s[16:17], s53 offset:0x70000
    s_load_dword s94, s[18:19], s53 offset:0x70000
    s_lshr_b32 s92, s28, 2
    s_cmp_lg_u32 s92, 3
    s_cbranch_scc1 L_cs3_6
    s_mov_b32 s91, 344064
    buffer_load_dwordx4 v[112:115], v5, s[72:75], s91 offen
    s_mov_b32 s91, 401408
    buffer_load_dwordx4 v[116:119], v5, s[72:75], s91 offen
L_cs3_6:
    s_waitcnt vmcnt(14)
    s_barrier
    s_add_u32 m0, s79, 135168
    s_mov_b32 s78, 896
    buffer_load_dwordx4 v20, s[36:39], s78 offen lds
    v_mul_f32 v80, v80, v76
    v_mul_f32 v81, v81, v76
    v_cvt_pk_bf16_f32 v30, v80, v81
    v_sub_f32 v80, v54, v72
    v_sub_f32 v81, v55, v72
    v_cvt_pk_bf16_f32 v80, v80, v81
    v_and_b32 v81, 0xffff0000, v80
    v_lshlrev_b32 v80, 16, v80
    v_mul_f32 v80, v80, v76
    v_mul_f32 v81, v81, v76
    v_cvt_pk_bf16_f32 v31, v80, v81
    v_sub_f32 v80, v56, v74
    v_sub_f32 v81, v57, v74
    v_cvt_pk_bf16_f32 v80, v80, v81
    v_and_b32 v81, 0xffff0000, v80
    v_lshlrev_b32 v80, 16, v80
    s_add_u32 m0, s79, 136192
    s_nop 0
    buffer_load_dwordx4 v21, s[36:39], s78 offen lds
    v_mul_f32 v80, v80, v77
    v_mul_f32 v81, v81, v77
    v_cvt_pk_bf16_f32 v32, v80, v81
    v_sub_f32 v80, v58, v74
    v_sub_f32 v81, v59, v74
    v_cvt_pk_bf16_f32 v80, v80, v81
    v_and_b32 v81, 0xffff0000, v80
    v_lshlrev_b32 v80, 16, v80
    s_add_u32 m0, s33, 36864
    s_mov_b32 s77, 2981888
    buffer_load_dwordx4 v22, s[40:43], s77 offen offset:0 lds
    v_mul_f32 v80, v80, v77
    v_mul_f32 v81, v81, v77
    v_cvt_pk_bf16_f32 v33, v80, v81
    v_sub_f32 v80, v60, v74
    v_sub_f32 v81, v61, v74
    v_cvt_pk_bf16_f32 v80, v80, v81
    v_and_b32 v81, 0xffff0000, v80
    v_lshlrev_b32 v80, 16, v80
    s_add_u32 m0, s33, 40832
    s_nop 0
    buffer_load_dwordx4 v22, s[40:43], s77 offen offset:128 lds
    v_mul_f32 v80, v80, v77
    v_mul_f32 v81, v81, v77
    v_cvt_pk_bf16_f32 v34, v80, v81
    v_sub_f32 v80, v62, v74
    v_sub_f32 v81, v63, v74
    v_cvt_pk_bf16_f32 v80, v80, v81
    v_and_b32 v81, 0xffff0000, v80
    v_lshlrev_b32 v80, 16, v80
    s_add_u32 m0, s33, 45056
    s_nop 0
    buffer_load_dwordx4 v22, s[44:47], s77 offen offset:0 lds
    v_mul_f32 v80, v80, v77
    v_mul_f32 v81, v81, v77
    v_cvt_pk_bf16_f32 v35, v80, v81
    v_sub_f32 v80, v64, v74
    v_sub_f32 v81, v65, v74
    v_cvt_pk_bf16_f32 v80, v80, v81
    v_and_b32 v81, 0xffff0000, v80
    v_lshlrev_b32 v80, 16, v80
    s_add_u32 m0, s33, 49024
    s_nop 0
    buffer_load_dwordx4 v22, s[44:47], s77 offen offset:128 lds
    v_mul_f32 v80, v80, v77
    v_mul_f32 v81, v81, v77
    v_cvt_pk_bf16_f32 v36, v80, v81
    v_sub_f32 v80, v66, v74
    v_sub_f32 v81, v67, v74
    v_cvt_pk_bf16_f32 v80, v80, v81
    v_and_b32 v81, 0xffff0000, v80
    v_lshlrev_b32 v80, 16, v80
    s_add_u32 m0, s33, 53248
    s_nop 0
    buffer_load_dwordx4 v9, s[48:51], s77 offen lds
    v_mul_f32 v80, v80, v77
    v_mul_f32 v81, v81, v77
    v_cvt_pk_bf16_f32 v37, v80, v81
    v_sub_f32 v80, v68, v74
    v_sub_f32 v81, v69, v74
    v_cvt_pk_bf16_f32 v80, v80, v81
    v_and_b32 v81, 0xffff0000, v80
    v_lshlrev_b32 v80, 16, v80
    s_load_dword s94, s[10:11], s52 offset:0x80000
    s_load_dword s94, s[10:11], s52 offset:0x90000
    s_load_dword s94, s[10:11], s52 offset:0xa0000
    s_load_dword s94, s[16:17], s53 offset:0xa8000
    s_lshr_b32 s92, s28, 2
    s_cmp_lg_u32 s92, 3
    s_cbranch_scc1 L_cs3_8
    s_mov_b32 s91, 0
    buffer_load_dwordx4 v[120:123], v6, s[72:75], s91 offen
    s_mov_b32 s91, 229376
    buffer_load_dwordx4 v[124:127], v6, s[72:75], s91 offen
L_cs3_8:
    s_waitcnt vmcnt(14)
    s_barrier
    s_add_u32 m0, s79, 137216
    s_mov_b32 s78, 33664
    buffer_load_dwordx4 v20, s[36:39], s78 offen lds
    v_mul_f32 v80, v80, v77
    v_mul_f32 v81, v81, v77
    v_cvt_pk_bf16_f32 v38, v80, v81
    v_sub_f32 v80, v70, v74
    v_sub_f32 v81, v71, v74
    v_cvt_pk_bf16_f32 v80, v80, v81
    v_and_b32 v81, 0xffff0000, v80
    v_lshlrev_b32 v80, 16, v80
    v_mul_f32 v80, v80, v77
    v_mul_f32 v81, v81, v77
    v_cvt_pk_bf16_f32 v39, v80, v81
    s_add_u32 m0, s79, 138240
    s_nop 0
    buffer_load_dwordx4 v21, s[36:39], s78 offen lds
    global_store_dwordx4 v4, v[24:27], s[26:27] offset:0 sc1
    global_store_dwordx4 v4, v[28:31], s[26:27] offset:1024 sc1
    global_store_dwordx4 v4, v[32:35], s[26:27] offset:2048 sc1
    global_store_dwordx4 v4, v[36:39], s[26:27] offset:3072 sc1
    s_add_u32 s90, s90, 0x1e00000
    v_mov_b32 v7, s90
    s_mov_b64 exec, 1
    global_store_dwordx4 v7, v[72:75], s[26:27] sc1
    s_mov_b64 exec, -1
    s_add_u32 m0, s33, 57344
    s_mov_b32 s77, 3211264
    buffer_load_dwordx4 v22, s[40:43], s77 offen offset:0 lds
    s_add_u32 m0, s33, 61312
    s_nop 0
    buffer_load_dwordx4 v22, s[40:43], s77 offen offset:128 lds
    s_add_u32 m0, s33, 65536
    s_nop 0
    buffer_load_dwordx4 v22, s[44:47], s77 offen offset:0 lds
    s_add_u32 m0, s33, 69504
    s_nop 0
    buffer_load_dwordx4 v22, s[44:47], s77 offen offset:128 lds
    s_add_u32 m0, s33, 73728
    s_nop 0
    buffer_load_dwordx4 v9, s[48:51], s77 offen lds
    s_load_dword s94, s[18:19], s53 offset:0xa8000
    s_load_dword s94, s[10:11], s52 offset:0xb0000
    s_load_dword s94, s[10:11], s52 offset:0xc0000
    s_load_dword s94, s[10:11], s52 offset:0xd0000
    s_waitcnt vmcnt(19)
    s_barrier
    s_add_u32 m0, s79, 98304
    s_mov_b32 s78, 1024
    buffer_load_dwordx4 v20, s[36:39], s78 offen lds
    s_add_u32 m0, s79, 99328
    s_nop 0
    buffer_load_dwordx4 v21, s[36:39], s78 offen lds
    s_add_u32 m0, s33, 77824
    s_mov_b32 s77, 3440640
    buffer_load_dwordx4 v22, s[40:43], s77 offen offset:0 lds
    s_add_u32 m0, s33, 81792
    s_nop 0
    buffer_load_dwordx4 v22, s[40:43], s77 offen offset:128 lds
    s_add_u32 m0, s33, 86016
    s_nop 0
    buffer_load_dwordx4 v22, s[44:47], s77 offen offset:0 lds
    s_add_u32 m0, s33, 89984
    s_nop 0
    buffer_load_dwordx4 v22, s[44:47], s77 offen offset:128 lds
    s_add_u32 m0, s33, 94208
    s_nop 0
    buffer_load_dwordx4 v9, s[48:51], s77 offen lds
    s_load_dword s94, s[16:17], s53 offset:0xe0000
    s_load_dword s94, s[18:19], s53 offset:0xe0000
    s_load_dword s94, s[10:11], s52 offset:0xe0000
    s_load_dword s94, s[10:11], s52 offset:0xf0000
    s_waitcnt vmcnt(19)
    s_barrier
    s_add_u32 m0, s79, 100352
    s_mov_b32 s78, 33792
    buffer_load_dwordx4 v20, s[36:39], s78 offen lds
    s_waitcnt vmcnt(20)
    v_lshlrev_b32 v128, 16, v88
    v_and_b32 v129, 0xffff0000, v88
    v_lshlrev_b32 v130, 16, v89
    v_and_b32 v131, 0xffff0000, v89
    v_lshlrev_b32 v132, 16, v90
    v_and_b32 v133, 0xffff0000, v90
    v_lshlrev_b32 v134, 16, v91
    v_and_b32 v135, 0xffff0000, v91
    v_lshlrev_b32 v76, 16, v92
    v_and_b32 v92, 0xffff0000, v92
    v_add_f32 v128, v128, v76
    v_add_f32 v129, v129, v92
    v_lshlrev_b32 v76, 16, v93
    v_and_b32 v93, 0xffff0000, v93
    v_add_f32 v130, v130, v76
    v_add_f32 v131, v131, v93
    s_add_u32 m0, s79, 101376
    s_nop 0
    buffer_load_dwordx4 v21, s[36:39], s78 offen lds
    v_lshlrev_b32 v76, 16, v94
    v_and_b32 v94, 0xffff0000, v94
    v_add_f32 v132, v132, v76
    v_add_f32 v133, v133, v94
    v_lshlrev_b32 v76, 16, v95
    v_and_b32 v95, 0xffff0000, v95
    v_add_f32 v134, v134, v76
    v_add_f32 v135, v135, v95
    s_add_u32 m0, s33, 16384
    s_mov_b32 s77, 3670016
    buffer_load_dwordx4 v22, s[40:43], s77 offen offset:0 lds
    v_lshlrev_b32 v76, 16, v96
    v_and_b32 v96, 0xffff0000, v96
    v_add_f32 v128, v128, v76
    v_add_f32 v129, v129, v96
    v_lshlrev_b32 v76, 16, v97
    v_and_b32 v97, 0xffff0000, v97
    v_add_f32 v130, v130, v76
    v_add_f32 v131, v131, v97
    s_add_u32 m0, s33, 20352
    s_nop 0
    buffer_load_dwordx4 v22, s[40:43], s77 offen offset:128 lds
    v_lshlrev_b32 v76, 16, v98
    v_and_b32 v98, 0xffff0000, v98
    v_add_f32 v132, v132, v76
    v_add_f32 v133, v133, v98
    v_lshlrev_b32 v76, 16, v99
    v_and_b32 v99, 0xffff0000, v99
    v_add_f32 v134, v134, v76
    v_add_f32 v135, v135, v99
    s_add_u32 m0, s33, 24576
    s_nop 0
    buffer_load_dwordx4 v22, s[44:47], s77 offen offset:0 lds
    v_lshlrev_b32 v76, 16, v100
    v_and_b32 v100, 0xffff0000, v100
    v_add_f32 v128, v128, v76
    v_add_f32 v129, v129, v100
    v_lshlrev_b32 v76, 16, v101
    v_and_b32 v101, 0xffff0000, v101
    v_add_f32 v130, v130, v76
    v_add_f32 v131, v131, v101
    s_add_u32 m0, s33, 28544
    s_nop 0
    buffer_load_dwordx4 v22, s[44:47], s77 offen offset:128 lds
    v_lshlrev_b32 v76, 16, v102
    v_and_b32 v102, 0xffff0000, v102
    v_add_f32 v132, v132, v76
    v_add_f32 v133, v133, v102
    v_lshlrev_b32 v76, 16, v103
    v_and_b32 v103, 0xffff0000, v103
    v_add_f32 v134, v134, v76
    v_add_f32 v135, v135, v103
    s_add_u32 m0, s33, 32768
    s_nop 0
    buffer_load_dwordx4 v9, s[48:51], s77 offen lds
    v_lshlrev_b32 v76, 16, v104
    v_and_b32 v104, 0xffff0000, v104
    v_add_f32 v128, v128, v76
    v_add_f32 v129, v129, v104
    v_lshlrev_b32 v76, 16, v105
    v_and_b32 v105, 0xffff0000, v105
    v_add_f32 v130, v130, v76
    v_add_f32 v131, v131, v105
    s_add_u32 s52, s52, 0x100000
    s_load_dword s94, s[10:11], s52 offset:0x0
    s_add_u32 s53, s53, 0x118000
    s_load_dword s94, s[16:17], s53 offset:0x0
    s_load_dword s94, s[18:19], s53 offset:0x0
    s_load_dword s94, s[10:11], s52 offset:0x10000
    s_waitcnt vmcnt(14)
    s_barrier
    s_add_u32 m0, s79, 116736
    s_mov_b32 s78, 1152
    buffer_load_dwordx4 v20, s[36:39], s78 offen lds
    v_lshlrev_b32 v76, 16, v106
    v_and_b32 v106, 0xffff0000, v106
    v_add_f32 v132, v132, v76
    v_add_f32 v133, v133, v106
    v_lshlrev_b32 v76, 16, v107
    v_and_b32 v107, 0xffff0000, v107
    v_add_f32 v134, v134, v76
    v_add_f32 v135, v135, v107
    v_lshlrev_b32 v76, 16, v108
    v_and_b32 v108, 0xffff0000, v108
    v_add_f32 v128, v128, v76
    v_add_f32 v129, v129, v108
    v_lshlrev_b32 v76, 16, v109
    v_and_b32 v109, 0xffff0000, v109
    v_add_f32 v130, v130, v76
    v_add_f32 v131, v131, v109
    s_add_u32 m0, s79, 117760
    s_nop 0
    buffer_load_dwordx4 v21, s[36:39], s78 offen lds
    v_lshlrev_b32 v76, 16, v110
    v_and_b32 v110, 0xffff0000, v110
    v_add_f32 v132, v132, v76
    v_add_f32 v133, v133, v110
    v_lshlrev_b32 v76, 16, v111
    v_and_b32 v111, 0xffff0000, v111
    v_add_f32 v134, v134, v76
    v_add_f32 v135, v135, v111
    s_add_u32 m0, s33, 36864
    s_mov_b32 s77, 3899392
    buffer_load_dwordx4 v22, s[40:43], s77 offen offset:0 lds
    v_lshlrev_b32 v76, 16, v112
    v_and_b32 v112, 0xffff0000, v112
    v_add_f32 v128, v128, v76
    v_add_f32 v129, v129, v112
    v_lshlrev_b32 v76, 16, v113
    v_and_b32 v113, 0xffff0000, v113
    v_add_f32 v130, v130, v76
    v_add_f32 v131, v131, v113
    s_add_u32 m0, s33, 40832
    s_nop 0
    buffer_load_dwordx4 v22, s[40:43], s77 offen offset:128 lds
    v_lshlrev_b32 v76, 16, v114
    v_and_b32 v114, 0xffff0000, v114
    v_add_f32 v132, v132, v76
    v_add_f32 v133, v133, v114
    v_lshlrev_b32 v76, 16, v115
    v_and_b32 v115, 0xffff0000, v115
    v_add_f32 v134, v134, v76
    v_add_f32 v135, v135, v115
    s_add_u32 m0, s33, 45056
    s_nop 0
    buffer_load_dwordx4 v22, s[44:47], s77 offen offset:0 lds
    v_lshlrev_b32 v76, 16, v116
    v_and_b32 v116, 0xffff0000, v116
    v_add_f32 v128, v128, v76
    v_add_f32 v129, v129, v116
    v_lshlrev_b32 v76, 16, v117
    v_and_b32 v117, 0xffff0000, v117
    v_add_f32 v130, v130, v76
    v_add_f32 v131, v131, v117
    s_add_u32 m0, s33, 49024
    s_nop 0
    buffer_load_dwordx4 v22, s[44:47], s77 offen offset:128 lds
    v_lshlrev_b32 v76, 16, v118
    v_and_b32 v118, 0xffff0000, v118
    v_add_f32 v132, v132, v76
    v_add_f32 v133, v133, v118
    v_lshlrev_b32 v76, 16, v119
    v_and_b32 v119, 0xffff0000, v119
    v_add_f32 v134, v134, v76
    v_add_f32 v135, v135, v119
    s_add_u32 m0, s33, 53248
    s_nop 0
    buffer_load_dwordx4 v9, s[48:51], s77 offen lds
    v_lshlrev_b32 v136, 16, v120
    v_and_b32 v137, 0xffff0000, v120
    v_lshlrev_b32 v138, 16, v121
    v_and_b32 v139, 0xffff0000, v121
    v_lshlrev_b32 v140, 16, v122
    v_and_b32 v141, 0xffff0000, v122
    v_lshlrev_b32 v142, 16, v123
    v_and_b32 v143, 0xffff0000, v123
    s_load_dword s94, s[10:11], s52 offset:0x20000
    s_load_dword s94, s[10:11], s52 offset:0x30000
    s_load_dword s94, s[16:17], s53 offset:0x38000
    s_load_dword s94, s[18:19], s53 offset:0x38000
    s_waitcnt vmcnt(14)
    s_barrier
    s_add_u32 m0, s79, 118784
    s_mov_b32 s78, 33920
    buffer_load_dwordx4 v20, s[36:39], s78 offen lds
    v_lshlrev_b32 v76, 16, v124
    v_and_b32 v124, 0xffff0000, v124
    v_add_f32 v136, v136, v76
    v_add_f32 v137, v137, v124
    v_lshlrev_b32 v76, 16, v125
    v_and_b32 v125, 0xffff0000, v125
    v_add_f32 v138, v138, v76
    v_add_f32 v139, v139, v125
    v_lshlrev_b32 v76, 16, v126
    v_and_b32 v126, 0xffff0000, v126
    v_add_f32 v140, v140, v76
    v_add_f32 v141, v141, v126
    v_lshlrev_b32 v76, 16, v127
    v_and_b32 v127, 0xffff0000, v127
    v_add_f32 v142, v142, v76
    v_add_f32 v143, v143, v127
    s_add_u32 m0, s79, 119808
    s_nop 0
    buffer_load_dwordx4 v21, s[36:39], s78 offen lds
    s_nop 1
    v_permlane16_swap_b32 v128, v132
    v_permlane16_swap_b32 v129, v133
    v_permlane16_swap_b32 v130, v134
    v_permlane16_swap_b32 v131, v135
    v_permlane16_swap_b32 v136, v140
    v_permlane16_swap_b32 v137, v141
    v_permlane16_swap_b32 v138, v142
    s_add_u32 m0, s33, 57344
    s_mov_b32 s77, 4128768
    buffer_load_dwordx4 v22, s[40:43], s77 offen offset:0 lds
    v_permlane16_swap_b32 v139, v143
    v_add_f32 v128, v128, v132
    v_add_f32 v129, v129, v133
    v_add_f32 v130, v130, v134
    v_add_f32 v131, v131, v135
    v_add_f32 v136, v136, v140
    v_add_f32 v137, v137, v141
    v_add_f32 v138, v138, v142
    s_add_u32 m0, s33, 61312
    s_nop 0
    buffer_load_dwordx4 v22, s[40:43], s77 offen offset:128 lds
    v_add_f32 v139, v139, v143
    s_nop 1
    v_permlane32_swap_b32 v128, v130
    v_permlane32_swap_b32 v129, v131
    v_permlane32_swap_b32 v136, v138
    v_permlane32_swap_b32 v137, v139
    v_add_f32 v128, v128, v130
    v_add_f32 v129, v129, v131
    s_add_u32 m0, s33, 65536
    s_nop 0
    buffer_load_dwordx4 v22, s[44:47], s77 offen offset:0 lds
    v_add_f32 v136, v136, v138
    v_add_f32 v137, v137, v139
    s_nop 1
    v_add_f32_dpp v128, v128, v128 row_ror:8 row_mask:0xf bank_mask:0xf
    v_add_f32_dpp v129, v129, v129 row_ror:8 row_mask:0xf bank_mask:0xf
    v_add_f32_dpp v136, v136, v136 row_ror:8 row_mask:0xf bank_mask:0xf
    v_add_f32_dpp v137, v137, v137 row_ror:8 row_mask:0xf bank_mask:0xf
    s_nop 1
    v_add_f32_dpp v136, v136, v136 row_ror:4 row_mask:0xf bank_mask:0xf
    s_add_u32 m0, s33, 69504
    s_nop 0
    buffer_load_dwordx4 v22, s[44:47], s77 offen offset:128 lds
    v_add_f32_dpp v137, v137, v137 row_ror:4 row_mask:0xf bank_mask:0xf
    s_nop 1
    v_add_f32_dpp v136, v136, v136 row_ror:2 row_mask:0xf bank_mask:0xf
    v_add_f32_dpp v137, v137, v137 row_ror:2 row_mask:0xf bank_mask:0xf
    s_add_u32 m0, s33, 73728
    s_nop 0
    buffer_load_dwordx4 v9, s[48:51], s77 offen lds
    v_lshrrev_b32 v76, 4, v1
    v_and_b32 v77, 1, v76
    v_and_b32 v76, 2, v76
    v_lshlrev_b32 v76, 2, v76
    v_lshl_add_u32 v76, v77, 4, v76
    s_lshl_b32 s84, s29, 4
    s_add_u32 s84, s84, s28
    s_mul_i32 s84, s84, 1280
    s_mul_i32 s85, s5, 640
    s_add_u32 s84, s84, s85
    s_add_u32 s84, s84, 0x1e10000
    s_lshl_b32 s85, s6, 8
    s_add_u32 s85, s85, s84
    v_and_b32 v77, 7, v1
    v_lshl_add_u32 v77, v77, 5, v76
    v_add_u32 v77, s85, v77
    s_lshl_b32 s85, s6, 6
    s_add_u32 s85, s85, s84
    s_add_u32 s85, s85, 512
    v_and_b32 v78, 1, v1
    v_lshl_add_u32 v78, v78, 5, v76
    v_add_u32 v78, s85, v78
    global_store_dwordx2 v77, v[128:129], s[26:27] sc1
    global_store_dwordx2 v78, v[136:137], s[26:27] sc1
    s_load_dword s94, s[10:11], s52 offset:0x40000
    s_load_dword s94, s[10:11], s52 offset:0x50000
    s_load_dword s94, s[10:11], s52 offset:0x60000
    s_load_dword s94, s[16:17], s53 offset:0x70000
    s_waitcnt vmcnt(16)
    s_barrier
    s_add_u32 m0, s79, 135168
    s_mov_b32 s78, 1280
    buffer_load_dwordx4 v20, s[36:39], s78 offen lds
    s_add_u32 m0, s79, 136192
    s_nop 0
    buffer_load_dwordx4 v21, s[36:39], s78 offen lds
    s_add_u32 m0, s33, 77824
    s_mov_b32 s77, 4358144
    buffer_load_dwordx4 v22, s[40:43], s77 offen offset:0 lds
    s_add_u32 m0, s33, 81792
    s_nop 0
    buffer_load_dwordx4 v22, s[40:43], s77 offen offset:128 lds
    s_add_u32 m0, s33, 86016
    s_nop 0
    buffer_load_dwordx4 v22, s[44:47], s77 offen offset:0 lds
    s_add_u32 m0, s33, 89984
    s_nop 0
    buffer_load_dwordx4 v22, s[44:47], s77 offen offset:128 lds
    s_add_u32 m0, s33, 94208
    s_nop 0
    buffer_load_dwordx4 v9, s[48:51], s77 offen lds
    s_load_dword s94, s[18:19], s53 offset:0x70000
    s_load_dword s94, s[10:11], s52 offset:0x70000
    s_load_dword s94, s[10:11], s52 offset:0x80000
    s_load_dword s94, s[10:11], s52 offset:0x90000
    v_mov_b32 v8, 0
    global_load_dwordx2 v[18:19], v8, s[24:25] sc1
    s_waitcnt vmcnt(17)
    s_barrier
    s_add_u32 m0, s79, 137216
    s_mov_b32 s78, 34048
    buffer_load_dwordx4 v20, s[36:39], s78 offen lds
    v_lshrrev_b32 v64, 4, v1
    v_bfe_u32 v65, v1, 2, 2
    v_and_b32 v66, 3, v1
    v_and_b32 v67, 15, v1
    v_lshrrev_b32 v68, 3, v1
    v_and_b32 v69, 7, v1
    s_lshl_b32 s85, s6, 2
    s_lshl_b32 s86, s5, 1
    s_or_b32 s85, s85, s86
    v_lshl_add_u32 v70, v64, 3, v65
    v_lshlrev_b32 v70, 7, v70
    s_add_u32 m0, s79, 138240
    s_nop 0
    buffer_load_dwordx4 v21, s[36:39], s78 offen lds
    v_and_b32 v71, 1, v66
    v_lshl_add_u32 v70, v71, 3, v70
    v_add_u32 v70, 16384, v70
    v_and_b32 v71, 2, v65
    v_and_b32 v72, 1, v64
    v_lshl_add_u32 v71, v72, 2, v71
    v_lshrrev_b32 v72, 1, v66
    v_xor_b32 v71, v71, v72
    v_xor_b32 v71, s85, v71
    v_xor_b32 v72, 0, v71
    v_lshl_add_u32 v4, v72, 4, v70
    v_add_u32 v6, 40960, v4
    v_xor_b32 v72, 2, v71
    v_lshl_add_u32 v5, v72, 4, v70
    v_add_u32 v7, 40960, v5
    v_lshrrev_b32 v70, 1, v67
    s_add_u32 m0, s33, 16384
    s_mov_b32 s77, 4587520
    buffer_load_dwordx4 v22, s[40:43], s77 offen offset:0 lds
    v_xor_b32 v70, v70, v64
    v_lshlrev_b32 v70, 4, v70
    v_lshl_add_u32 v70, v67, 7, v70
    s_lshl_b32 s85, s5, 13
    v_add_u32 v16, s85, v70
    v_xor_b32 v17, 64, v16
    s_sub_u32 s95, 16384, s85
    s_mov_b32 s80, 135168
    s_lshl_b32 s86, s28, 7
    s_sub_u32 s86, s86, 16
    s_max_i32 s86, s86, 0
    s_lshl_b32 s87, s4, 2
    v_add_u32 v71, s87, v68
    s_add_u32 m0, s33, 20352
    s_nop 0
    buffer_load_dwordx4 v22, s[40:43], s77 offen offset:128 lds
    v_lshrrev_b32 v70, 1, v71
    v_and_b32 v70, 7, v70
    v_xor_b32 v70, v70, v69
    v_lshlrev_b32 v70, 4, v70
    v_add_u32 v71, s86, v71
    v_lshl_add_u32 v3, v71, 11, v70
    s_lshl_b32 s81, s4, 9
    s_lshl_b32 s85, s4, 3
    s_and_b32 s86, s4, 1
    s_lshl_b32 s86, s86, 2
    v_and_b32 v70, 2, v68
    s_add_u32 m0, s33, 24576
    s_nop 0
    buffer_load_dwordx4 v22, s[44:47], s77 offen offset:0 lds
    v_xor_b32 v70, v70, v69
    v_xor_b32 v70, s86, v70
    v_add_u32 v71, s85, v68
    v_mul_u32_u24 v71, 6144, v71
    v_lshl_add_u32 v23, v70, 4, v71
    s_lshl_b32 s85, s4, 12
    v_lshl_add_u32 v10, v1, 4, s85
    s_lshl_b32 s85, s4, 4
    v_and_b32 v70, 2, v68
    v_xor_b32 v70, v70, v69
    s_add_u32 m0, s33, 28544
    s_nop 0
    buffer_load_dwordx4 v22, s[44:47], s77 offen offset:128 lds
    v_xor_b32 v70, 0, v70
    v_add_u32 v71, s85, v68
    v_mul_u32_u24 v71, 2048, v71
    v_lshl_add_u32 v11, v70, 4, v71
    s_add_u32 s85, s85, 8
    v_and_b32 v70, 2, v68
    v_xor_b32 v70, v70, v69
    v_xor_b32 v70, 4, v70
    v_add_u32 v71, s85, v68
    s_add_u32 m0, s33, 32768
    s_nop 0
    buffer_load_dwordx4 v9, s[48:51], s77 offen lds
    v_mul_u32_u24 v71, 2048, v71
    v_lshl_add_u32 v12, v70, 4, v71
    s_lshl_b32 s85, s31, 8
    s_lshl_b32 s86, s32, 7
    s_add_u32 s86, s85, s86
    s_xor_b32 s87, s86, 128
    s_add_u32 s60, s20, s86
    s_addc_u32 s61, s21, 0
    s_sub_u32 s62, 7340032, s86
    s_mov_b32 s63, 0x20000
    s_add_u32 s64, s20, s87
    s_addc_u32 s65, s21, 0
    s_sub_u32 s66, 7340032, s87
    s_mov_b32 s67, 0x20000
    s_add_u32 s56, s26, 0x400000
    s_addc_u32 s57, s27, 0
    s_mov_b32 s58, 0xe00000
    s_mov_b32 s59, 0x20000
    s_mul_i32 s82, s30, 917504
    s_mul_i32 s85, s32, 327680
    s_add_u32 s82, s82, s85
    s_mul_i32 s83, s32, 2621440
    s_mul_i32 s85, s32, 24
    s_load_dword s94, s[16:17], s53 offset:0xa8000
    s_load_dword s94, s[18:19], s53 offset:0xa8000
    s_load_dword s94, s[10:11], s52 offset:0xa0000
    s_load_dword s94, s[10:11], s52 offset:0xb0000
    s_waitcnt vmcnt(17)
    s_barrier
    s_add_u32 m0, s79, 98304
    s_mov_b32 s78, 1408
    buffer_load_dwordx4 v20, s[36:39], s78 offen lds
    s_sub_u32 s85, 40, s85
    s_lshl_b32 s14, s85, 13
    s_lshl_b32 s35, s85, 16
    s_add_u32 s83, s83, 393216
    s_add_u32 s82, s82, 49152
    v_mov_b32 v88, 0
    v_mov_b32 v89, 0
    v_mov_b32 v90, 0
    v_mov_b32 v91, 0
    v_mov_b32 v92, 0
    v_mov_b32 v93, 0
    v_mov_b32 v94, 0
    v_mov_b32 v95, 0
    v_mov_b32 v96, 0
    v_mov_b32 v97, 0
    v_mov_b32 v98, 0
    v_mov_b32 v99, 0
    v_mov_b32 v100, 0
    v_mov_b32 v101, 0
    v_mov_b32 v102, 0
    s_add_u32 m0, s79, 99328
    s_nop 0
    buffer_load_dwordx4 v21, s[36:39], s78 offen lds
    v_mov_b32 v103, 0
    v_mov_b32 v104, 0
    v_mov_b32 v105, 0
    v_mov_b32 v106, 0
    v_mov_b32 v107, 0
    v_mov_b32 v108, 0
    v_mov_b32 v109, 0
    v_mov_b32 v110, 0
    s_add_u32 m0, s33, 36864
    s_mov_b32 s77, 4816896
    buffer_load_dwordx4 v22, s[40:43], s77 offen offset:0 lds
    v_mov_b32 v111, 0
    v_mov_b32 v112, 0
    v_mov_b32 v113, 0
    v_mov_b32 v114, 0
    v_mov_b32 v115, 0
    v_mov_b32 v116, 0
    v_mov_b32 v117, 0
    v_mov_b32 v118, 0
    s_add_u32 m0, s33, 40832
    s_nop 0
    buffer_load_dwordx4 v22, s[40:43], s77 offen offset:128 lds
    v_mov_b32 v119, 0
    v_mov_b32 v120, 0
    v_mov_b32 v121, 0
    v_mov_b32 v122, 0
    v_mov_b32 v123, 0
    v_mov_b32 v124, 0
    v_mov_b32 v125, 0
    v_mov_b32 v126, 0
    s_add_u32 m0, s33, 45056
    s_nop 0
    buffer_load_dwordx4 v22, s[44:47], s77 offen offset:0 lds
    v_mov_b32 v127, 0
    v_mov_b32 v128, 0
    v_mov_b32 v129, 0
    v_mov_b32 v130, 0
    v_mov_b32 v131, 0
    v_mov_b32 v132, 0
    v_mov_b32 v133, 0
    v_mov_b32 v134, 0
    s_add_u32 m0, s33, 49024
    s_nop 0
    buffer_load_dwordx4 v22, s[44:47], s77 offen offset:128 lds
    v_mov_b32 v135, 0
    v_mov_b32 v136, 0
    v_mov_b32 v137, 0
    v_mov_b32 v138, 0
    v_mov_b32 v139, 0
    v_mov_b32 v140, 0
    v_mov_b32 v141, 0
    v_mov_b32 v142, 0
    s_add_u32 m0, s33, 53248
    s_nop 0
    buffer_load_dwordx4 v9, s[48:51], s77 offen lds
    v_mov_b32 v143, 0
    v_mov_b32 v144, 0
    v_mov_b32 v145, 0
    v_mov_b32 v146, 0
    v_mov_b32 v147, 0
    v_mov_b32 v148, 0
    v_mov_b32 v149, 0
    v_mov_b32 v150, 0
    s_load_dword s94, s[10:11], s52 offset:0xc0000
    s_load_dword s94, s[16:17], s53 offset:0xe0000
    s_load_dword s94, s[18:19], s53 offset:0xe0000
    s_load_dword s94, s[10:11], s52 offset:0xd0000
    s_waitcnt vmcnt(15)
    s_barrier
    s_add_u32 m0, s79, 100352
    s_mov_b32 s78, 34176
    buffer_load_dwordx4 v20, s[36:39], s78 offen lds
    v_mov_b32 v151, 0
    v_mov_b32 v152, 0
    v_mov_b32 v153, 0
    v_mov_b32 v154, 0
    v_mov_b32 v155, 0
    v_mov_b32 v156, 0
    v_mov_b32 v157, 0
    v_mov_b32 v158, 0
    v_mov_b32 v159, 0
    v_mov_b32 v160, 0
    v_mov_b32 v161, 0
    v_mov_b32 v162, 0
    v_mov_b32 v163, 0
    v_mov_b32 v164, 0
    v_mov_b32 v165, 0
    v_mov_b32 v166, 0
    s_add_u32 m0, s79, 101376
    s_nop 0
    buffer_load_dwordx4 v21, s[36:39], s78 offen lds
    v_mov_b32 v167, 0
    v_mov_b32 v168, 0
    v_mov_b32 v169, 0
    v_mov_b32 v170, 0
    v_mov_b32 v171, 0
    v_mov_b32 v172, 0
    v_mov_b32 v173, 0
    v_mov_b32 v174, 0
    s_add_u32 m0, s33, 57344
    s_mov_b32 s77, 5046272
    buffer_load_dwordx4 v22, s[40:43], s77 offen offset:0 lds
    v_mov_b32 v175, 0
    v_mov_b32 v176, 0
    v_mov_b32 v177, 0
    v_mov_b32 v178, 0
    v_mov_b32 v179, 0
    v_mov_b32 v180, 0
    v_mov_b32 v181, 0
    v_mov_b32 v182, 0
    s_add_u32 m0, s33, 61312
    s_nop 0
    buffer_load_dwordx4 v22, s[40:43], s77 offen offset:128 lds
    v_mov_b32 v183, 0
    v_mov_b32 v184, 0
    v_mov_b32 v185, 0
    v_mov_b32 v186, 0
    v_mov_b32 v187, 0
    v_mov_b32 v188, 0
    v_mov_b32 v189, 0
    v_mov_b32 v190, 0
    s_add_u32 m0, s33, 65536
    s_nop 0
    buffer_load_dwordx4 v22, s[44:47], s77 offen offset:0 lds
    v_mov_b32 v191, 0
    v_mov_b32 v192, 0
    v_mov_b32 v193, 0
    v_mov_b32 v194, 0
    v_mov_b32 v195, 0
    v_mov_b32 v196, 0
    v_mov_b32 v197, 0
    v_mov_b32 v198, 0
    s_add_u32 m0, s33, 69504
    s_nop 0
    buffer_load_dwordx4 v22, s[44:47], s77 offen offset:128 lds
    v_mov_b32 v199, 0
    v_mov_b32 v200, 0
    v_mov_b32 v201, 0
    v_mov_b32 v202, 0
    v_mov_b32 v203, 0
    v_mov_b32 v204, 0
    v_mov_b32 v205, 0
    v_mov_b32 v206, 0
    s_add_u32 m0, s33, 73728
    s_nop 0
    buffer_load_dwordx4 v9, s[48:51], s77 offen lds
    v_mov_b32 v207, 0
    v_mov_b32 v208, 0
    v_mov_b32 v209, 0
    v_mov_b32 v210, 0
    v_mov_b32 v211, 0
    v_mov_b32 v212, 0
    v_mov_b32 v213, 0
    v_mov_b32 v214, 0
    s_load_dword s94, s[10:11], s52 offset:0xe0000
    s_load_dword s94, s[10:11], s52 offset:0xf0000
    s_add_u32 s53, s53, 0x118000
    s_load_dword s94, s[16:17], s53 offset:0x0
    s_load_dword s94, s[18:19], s53 offset:0x0
    s_waitcnt vmcnt(14)
    s_barrier
    s_add_u32 m0, s79, 116736
    s_mov_b32 s78, 1536
    buffer_load_dwordx4 v20, s[36:39], s78 offen lds
    v_mov_b32 v215, 0
    v_mov_b32 v216, 0
    v_mov_b32 v217, 0
    v_mov_b32 v218, 0
    v_mov_b32 v219, 0
    v_mov_b32 v220, 0
    v_mov_b32 v221, 0
    v_mov_b32 v222, 0
    v_mov_b32 v223, 0
    v_mov_b32 v224, 0
    v_mov_b32 v225, 0
    v_mov_b32 v226, 0
    v_mov_b32 v227, 0
    v_mov_b32 v228, 0
    v_mov_b32 v229, 0
    v_mov_b32 v230, 0
    s_add_u32 m0, s79, 117760
    s_nop 0
    buffer_load_dwordx4 v21, s[36:39], s78 offen lds
    v_mov_b32 v231, 0
    v_mov_b32 v232, 0
    v_mov_b32 v233, 0
    v_mov_b32 v234, 0
    v_mov_b32 v235, 0
    v_mov_b32 v236, 0
    v_mov_b32 v237, 0
    v_mov_b32 v238, 0
    s_add_u32 m0, s33, 77824
    s_mov_b32 s77, 5275648
    buffer_load_dwordx4 v22, s[40:43], s77 offen offset:0 lds
    v_mov_b32 v239, 0
    v_mov_b32 v240, 0
    v_mov_b32 v241, 0
    v_mov_b32 v242, 0
    v_mov_b32 v243, 0
    v_mov_b32 v244, 0
    v_mov_b32 v245, 0
    v_mov_b32 v246, 0
    s_add_u32 m0, s33, 81792
    s_nop 0
    buffer_load_dwordx4 v22, s[40:43], s77 offen offset:128 lds
    v_mov_b32 v247, 0
    v_mov_b32 v248, 0
    v_mov_b32 v249, 0
    v_mov_b32 v250, 0
    v_mov_b32 v251, 0
    v_mov_b32 v252, 0
    v_mov_b32 v253, 0
    v_mov_b32 v254, 0
    s_add_u32 m0, s33, 86016
    s_nop 0
    buffer_load_dwordx4 v22, s[44:47], s77 offen offset:0 lds
    v_mov_b32 v255, 0
    s_add_u32 m0, s33, 89984
    s_nop 0
    buffer_load_dwordx4 v22, s[44:47], s77 offen offset:128 lds
    s_add_u32 m0, s33, 94208
    s_nop 0
    buffer_load_dwordx4 v9, s[48:51], s77 offen lds
    s_add_u32 s52, s52, 0x100000
    s_load_dword s94, s[10:11], s52 offset:0x0
    s_load_dword s94, s[10:11], s52 offset:0x10000
    s_load_dword s94, s[10:11], s52 offset:0x20000
    s_load_dword s94, s[16:17], s53 offset:0x38000
    s_waitcnt vmcnt(28)
    s_movk_i32 s98, 0x4000
L_tokB_chk:
    v_readfirstlane_b32 s100, v18
    v_readfirstlane_b32 s101, v19
    s_nop 1
    s_cmp_lg_u32 s100, 0
    s_cbranch_scc1 L_tokB_ok
    s_sub_u32 s98, s98, 1
    s_cbranch_scc1 L_tokB_ok
    s_sleep 1
    global_load_dwordx2 v[18:19], v8, s[24:25] sc1
    s_waitcnt vmcnt(0)
    s_branch L_tokB_chk
L_tokB_ok:
    s_waitcnt vmcnt(36)
    s_waitcnt vmcnt(14)
    s_barrier
    s_add_u32 m0, s79, 118784
    s_mov_b32 s78, 34304
    buffer_load_dwordx4 v20, s[36:39], s78 offen lds
    s_add_u32 m0, s79, 119808
    s_nop 0
    buffer_load_dwordx4 v21, s[36:39], s78 offen lds
    s_add_u32 m0, s33, 16384
    s_mov_b32 s77, 5505024
    buffer_load_dwordx4 v22, s[40:43], s77 offen offset:0 lds
    s_add_u32 m0, s33, 20352
    s_nop 0
    buffer_load_dwordx4 v22, s[40:43], s77 offen offset:128 lds
    s_add_u32 m0, s33, 24576
    s_nop 0
    buffer_load_dwordx4 v22, s[44:47], s77 offen offset:0 lds
    s_add_u32 m0, s33, 28544
    s_nop 0
    buffer_load_dwordx4 v22, s[44:47], s77 offen offset:128 lds
    s_add_u32 m0, s33, 32768
    s_nop 0
    buffer_load_dwordx4 v9, s[48:51], s77 offen lds
    s_load_dword s94, s[18:19], s53 offset:0x38000
    s_load_dword s94, s[10:11], s52 offset:0x30000
    s_load_dword s94, s[10:11], s52 offset:0x40000
    s_load_dword s94, s[10:11], s52 offset:0x50000
    s_cmp_lg_u32 s4, 0
    s_cbranch_scc1 L_fLN
    s_lshl_b32 s91, s28, 4
    s_add_u32 s91, s91, s29
    s_lshl_b32 s91, s91, 7
    s_add_u32 s91, s91, 0x1e80000
    v_mov_b32 v24, s91
    v_mov_b32 v26, s100
    v_mov_b32 v27, s101
    s_mov_b64 exec, 1
    global_store_dwordx2 v24, v[26:27], s[26:27] sc1
    s_mov_b64 exec, -1
L_fLN:
    s_waitcnt vmcnt(14)
    s_barrier
    s_add_u32 m0, s79, 135168
    s_mov_b32 s78, 1664
    buffer_load_dwordx4 v20, s[36:39], s78 offen lds
    s_add_u32 m0, s79, 136192
    s_nop 0
    buffer_load_dwordx4 v21, s[36:39], s78 offen lds
    s_add_u32 m0, s33, 36864
    s_mov_b32 s77, 5734400
    buffer_load_dwordx4 v22, s[40:43], s77 offen offset:0 lds
    s_add_u32 m0, s33, 40832
    s_nop 0
    buffer_load_dwordx4 v22, s[40:43], s77 offen offset:128 lds
    s_add_u32 m0, s33, 45056
    s_nop 0
    buffer_load_dwordx4 v22, s[44:47], s77 offen offset:0 lds
    s_add_u32 m0, s33, 49024
    s_nop 0
    buffer_load_dwordx4 v22, s[44:47], s77 offen offset:128 lds
    s_add_u32 m0, s33, 53248
    s_nop 0
    buffer_load_dwordx4 v9, s[48:51], s77 offen lds
    s_load_dword s94, s[16:17], s53 offset:0x70000
    s_load_dword s94, s[18:19], s53 offset:0x70000
    s_load_dword s94, s[10:11], s52 offset:0x60000
    s_load_dword s94, s[10:11], s52 offset:0x70000
    s_waitcnt vmcnt(14)
    s_barrier
    s_add_u32 m0, s79, 137216
    s_mov_b32 s78, 34432
    buffer_load_dwordx4 v20, s[36:39], s78 offen lds
    s_add_u32 m0, s79, 138240
    s_nop 0
    buffer_load_dwordx4 v21, s[36:39], s78 offen lds
    s_add_u32 m0, s33, 57344
    s_mov_b32 s77, 5963776
    buffer_load_dwordx4 v22, s[40:43], s77 offen offset:0 lds
    s_add_u32 m0, s33, 61312
    s_nop 0
    buffer_load_dwordx4 v22, s[40:43], s77 offen offset:128 lds
    s_add_u32 m0, s33, 65536
    s_nop 0
    buffer_load_dwordx4 v22, s[44:47], s77 offen offset:0 lds
    s_add_u32 m0, s33, 69504
    s_nop 0
    buffer_load_dwordx4 v22, s[44:47], s77 offen offset:128 lds
    s_add_u32 m0, s33, 73728
    s_nop 0
    buffer_load_dwordx4 v9, s[48:51], s77 offen lds
    s_load_dword s94, s[10:11], s52 offset:0x80000
    s_load_dword s94, s[16:17], s53 offset:0xa8000
    s_load_dword s94, s[18:19], s53 offset:0xa8000
    s_load_dword s94, s[10:11], s52 offset:0x90000
    s_waitcnt vmcnt(14)
    s_barrier
    s_add_u32 m0, s79, 98304
    s_mov_b32 s78, 1792
    buffer_load_dwordx4 v20, s[36:39], s78 offen lds
    s_add_u32 m0, s79, 99328
    s_nop 0
    buffer_load_dwordx4 v21, s[36:39], s78 offen lds
    s_add_u32 m0, s33, 77824
    s_mov_b32 s77, 6193152
    buffer_load_dwordx4 v22, s[40:43], s77 offen offset:0 lds
    s_add_u32 m0, s33, 81792
    s_nop 0
    buffer_load_dwordx4 v22, s[40:43], s77 offen offset:128 lds
    s_add_u32 m0, s33, 86016
    s_nop 0
    buffer_load_dwordx4 v22, s[44:47], s77 offen offset:0 lds
    s_add_u32 m0, s33, 89984
    s_nop 0
    buffer_load_dwordx4 v22, s[44:47], s77 offen offset:128 lds
    s_add_u32 m0, s33, 94208
    s_nop 0
    buffer_load_dwordx4 v9, s[48:51], s77 offen lds
    s_load_dword s94, s[10:11], s52 offset:0xa0000
    s_load_dword s94, s[10:11], s52 offset:0xb0000
    s_load_dword s94, s[16:17], s53 offset:0xe0000
    s_load_dword s94, s[18:19], s53 offset:0xe0000
    v_and_b32 v24, 15, v1
    s_lshl_b32 s91, s28, 4
    s_sub_u32 s92, s91, 16
    s_max_i32 s92, s92, 0
    v_add_u32 v8, s91, v24
    v_add_u32 v25, s92, v24
    v_cmp_lt_u32 vcc, 15, v1
    v_lshl_add_u32 v24, v24, 4, s29
    s_nop 0
    v_cndmask_b32 v8, v8, v25, vcc
    v_cmp_lt_u32 vcc, 31, v1
    s_mov_b32 s91, 0x1e80000
    s_nop 0
    v_cndmask_b32 v8, v8, v24, vcc
    v_lshl_add_u32 v8, v8, 7, s91
    global_load_dwordx2 v[18:19], v8, s[26:27] sc1
    s_waitcnt vmcnt(15)
    s_barrier
    s_add_u32 m0, s79, 100352
    s_mov_b32 s78, 34560
    buffer_load_dwordx4 v20, s[36:39], s78 offen lds
    s_add_u32 m0, s79, 101376
    s_nop 0
    buffer_load_dwordx4 v21, s[36:39], s78 offen lds
    s_add_u32 m0, s33, 16384
    s_mov_b32 s77, 6422528
    buffer_load_dwordx4 v22, s[40:43], s77 offen offset:0 lds
    s_add_u32 m0, s33, 20352
    s_nop 0
    buffer_load_dwordx4 v22, s[40:43], s77 offen offset:128 lds
    s_add_u32 m0, s33, 24576
    s_nop 0
    buffer_load_dwordx4 v22, s[44:47], s77 offen offset:0 lds
    s_add_u32 m0, s33, 28544
    s_nop 0
    buffer_load_dwordx4 v22, s[44:47], s77 offen offset:128 lds
    s_add_u32 m0, s33, 32768
    s_nop 0
    buffer_load_dwordx4 v9, s[48:51], s77 offen lds
    s_load_dword s94, s[10:11], s52 offset:0xc0000
    s_load_dword s94, s[10:11], s52 offset:0xd0000
    s_load_dword s94, s[10:11], s52 offset:0xe0000
    s_add_u32 s53, s53, 0x118000
    s_load_dword s94, s[16:17], s53 offset:0x0
    s_waitcnt vmcnt(15)
    s_barrier
    s_add_u32 m0, s79, 116736
    s_mov_b32 s78, 1920
    buffer_load_dwordx4 v20, s[36:39], s78 offen lds
    s_add_u32 m0, s79, 117760
    s_nop 0
    buffer_load_dwordx4 v21, s[36:39], s78 offen lds
    s_add_u32 m0, s33, 36864
    s_mov_b32 s77, 6651904
    buffer_load_dwordx4 v22, s[40:43], s77 offen offset:0 lds
    s_add_u32 m0, s33, 40832
    s_nop 0
    buffer_load_dwordx4 v22, s[40:43], s77 offen offset:128 lds
    s_add_u32 m0, s33, 45056
    s_nop 0
    buffer_load_dwordx4 v22, s[44:47], s77 offen offset:0 lds
    s_add_u32 m0, s33, 49024
    s_nop 0
    buffer_load_dwordx4 v22, s[44:47], s77 offen offset:128 lds
    s_add_u32 m0, s33, 53248
    s_nop 0
    buffer_load_dwordx4 v9, s[48:51], s77 offen lds
    s_load_dword s94, s[18:19], s53 offset:0x0
    s_load_dword s94, s[10:11], s52 offset:0xf0000
    s_add_u32 s52, s52, 0x100000
    s_load_dword s94, s[10:11], s52 offset:0x0
    s_load_dword s94, s[10:11], s52 offset:0x10000
    s_waitcnt vmcnt(15)
    s_barrier
    s_add_u32 m0, s79, 118784
    s_mov_b32 s78, 34688
    buffer_load_dwordx4 v20, s[36:39], s78 offen lds
    s_add_u32 m0, s79, 119808
    s_nop 0
    buffer_load_dwordx4 v21, s[36:39], s78 offen lds
    s_add_u32 m0, s33, 57344
    s_mov_b32 s77, 6881280
    buffer_load_dwordx4 v22, s[40:43], s77 offen offset:0 lds
    s_add_u32 m0, s33, 61312
    s_nop 0
    buffer_load_dwordx4 v22, s[40:43], s77 offen offset:128 lds
    s_add_u32 m0, s33, 65536
    s_nop 0
    buffer_load_dwordx4 v22, s[44:47], s77 offen offset:0 lds
    s_add_u32 m0, s33, 69504
    s_nop 0
    buffer_load_dwordx4 v22, s[44:47], s77 offen offset:128 lds
    s_add_u32 m0, s33, 73728
    s_nop 0
    buffer_load_dwordx4 v9, s[48:51], s77 offen lds
    s_load_dword s94, s[16:17], s53 offset:0x38000
    s_load_dword s94, s[18:19], s53 offset:0x38000
    s_load_dword s94, s[10:11], s52 offset:0x20000
    s_load_dword s94, s[10:11], s52 offset:0x30000
    s_waitcnt vmcnt(21)
    s_movk_i32 s98, 0x4000
L_pLN_chk:
    v_cmp_ne_u64 vcc, s[100:101], v[18:19]
    s_nop 1
    s_cmp_eq_u64 vcc, 0
    s_cbranch_scc1 L_pLN_ok
    s_sub_u32 s98, s98, 1
    s_cbranch_scc1 L_pLN_ok
    s_sleep 1
    global_load_dwordx2 v[18:19], v8, s[26:27] sc1
    s_waitcnt vmcnt(0)
    s_branch L_pLN_chk
L_pLN_ok:
    s_waitcnt vmcnt(14)
    s_barrier
    s_mov_b32 s36, s26
    s_mov_b32 s37, s27
    s_mov_b32 s38, 0x400000
    s_mov_b32 s39, 0x20000
    s_add_u32 m0, s33, 77824
    s_mov_b32 s77, 7110656
    buffer_load_dwordx4 v22, s[40:43], s77 offen offset:0 lds
    s_add_u32 m0, s33, 81792
    s_nop 0
    buffer_load_dwordx4 v22, s[40:43], s77 offen offset:128 lds
    s_add_u32 m0, s33, 86016
    s_nop 0
    buffer_load_dwordx4 v22, s[44:47], s77 offen offset:0 lds
    s_add_u32 m0, s33, 89984
    s_nop 0
    buffer_load_dwordx4 v22, s[44:47], s77 offen offset:128 lds
    s_add_u32 m0, s33, 94208
    s_nop 0
    buffer_load_dwordx4 v9, s[48:51], s77 offen lds
    s_add_u32 m0, s79, 135168
    s_mov_b32 s78, 0
    buffer_load_dwordx4 v20, s[36:39], s78 offen sc1 lds
    s_add_u32 m0, s79, 136192
    s_nop 0
    buffer_load_dwordx4 v21, s[36:39], s78 offen sc1 lds
    s_waitcnt vmcnt(14)
    s_barrier
    s_lshl_b32 s85, s29, 7
    s_add_u32 s40, s10, s85
    s_addc_u32 s41, s11, 0
    s_sub_u32 s42, 6291456, s85
    s_mov_b32 s43, 0x20000
    s_add_u32 s86, s85, 4096
    s_add_u32 s44, s10, s86
    s_addc_u32 s45, s11, 0
    s_sub_u32 s46, 6291456, s86
    s_mov_b32 s47, 0x20000
    s_add_u32 s86, s85, 5120
    s_add_u32 s48, s16, s86
    s_addc_u32 s49, s17, 0
    s_sub_u32 s50, 7340032, s86
    s_mov_b32 s51, 0x20000
    s_add_u32 s52, s18, s86
    s_addc_u32 s53, s19, 0
    s_sub_u32 s54, 7340032, s86
    s_mov_b32 s55, 0x20000
    s_add_u32 m0, s79, 137216
    s_mov_b32 s78, 32768
    buffer_load_dwordx4 v20, s[36:39], s78 offen sc1 lds
    s_add_u32 m0, s79, 138240
    s_nop 0
    buffer_load_dwordx4 v21, s[36:39], s78 offen sc1 lds
    s_add_u32 m0, s81, 151552
    s_mov_b32 s78, 0
    s_mov_b64 exec, 0xffffffff
    buffer_load_dwordx4 v3, s[36:39], s78 offen sc1 lds
    s_mov_b64 exec, -1
    s_add_u32 m0, s33, 16384
    s_mov_b32 s76, 0
    buffer_load_dwordx4 v23, s[40:43], s76 offen offset:0 lds
    s_add_u32 m0, s33, 18432
    s_nop 0
    buffer_load_dwordx4 v23, s[40:43], s76 offen offset:2048 lds
    s_add_u32 m0, s33, 24576
    s_nop 0
    buffer_load_dwordx4 v23, s[44:47], s76 offen offset:0 lds
    s_add_u32 m0, s33, 28672
    s_mov_b32 s77, 0
    buffer_load_dwordx4 v22, s[48:51], s77 offen offset:0 lds
    s_add_u32 m0, s33, 32768
    s_nop 0
    buffer_load_dwordx4 v22, s[52:55], s77 offen offset:0 lds
    s_waitcnt vmcnt(15)
    s_barrier
    s_add_u32 m0, s79, 98304
    s_mov_b32 s78, 128
    buffer_load_dwordx4 v20, s[36:39], s78 offen sc1 lds
    s_add_u32 m0, s79, 99328
    s_nop 0
    buffer_load_dwordx4 v21, s[36:39], s78 offen sc1 lds
    s_add_u32 m0, s33, 36864
    s_mov_b32 s76, 196608
    buffer_load_dwordx4 v23, s[40:43], s76 offen offset:0 lds
    s_add_u32 m0, s33, 38912
    s_nop 0
    buffer_load_dwordx4 v23, s[40:43], s76 offen offset:2048 lds
    s_add_u32 m0, s33, 45056
    s_nop 0
    buffer_load_dwordx4 v23, s[44:47], s76 offen offset:0 lds
    s_add_u32 m0, s33, 49152
    s_mov_b32 s77, 229376
    buffer_load_dwordx4 v22, s[48:51], s77 offen offset:0 lds
    s_add_u32 m0, s33, 53248
    s_nop 0
    buffer_load_dwordx4 v22, s[52:55], s77 offen offset:0 lds
    s_waitcnt vmcnt(17)
    s_barrier
    s_add_u32 m0, s79, 100352
    s_mov_b32 s78, 32896
    buffer_load_dwordx4 v20, s[36:39], s78 offen sc1 lds
    s_add_u32 m0, s79, 101376
    s_nop 0
    buffer_load_dwordx4 v21, s[36:39], s78 offen sc1 lds
    s_add_u32 m0, s81, 114688
    s_mov_b32 s78, 128
    s_mov_b64 exec, 0xffffffff
    buffer_load_dwordx4 v3, s[36:39], s78 offen sc1 lds
    s_mov_b64 exec, -1
    s_add_u32 m0, s33, 57344
    s_mov_b32 s76, 393216
    buffer_load_dwordx4 v23, s[40:43], s76 offen offset:0 lds
    s_add_u32 m0, s33, 59392
    s_nop 0
    buffer_load_dwordx4 v23, s[40:43], s76 offen offset:2048 lds
    s_add_u32 m0, s33, 65536
    s_nop 0
    buffer_load_dwordx4 v23, s[44:47], s76 offen offset:0 lds
    s_add_u32 m0, s33, 69632
    s_mov_b32 s77, 458752
    buffer_load_dwordx4 v22, s[48:51], s77 offen offset:0 lds
    s_add_u32 m0, s33, 73728
    s_nop 0
    buffer_load_dwordx4 v22, s[52:55], s77 offen offset:0 lds
    s_waitcnt vmcnt(15)
    s_barrier
    s_setprio 1
    v_add_u32 v14, s80, v16
    v_add_u32 v15, s80, v17
    s_add_u32 s84, s80, s95
    v_add_u32 v18, s84, v16
    v_add_u32 v19, s84, v17
    s_add_u32 s80, s80, 18432
    s_cmp_ge_u32 s80, 153600
    s_cselect_b32 s84, 55296, 0
    s_sub_u32 s80, s80, s84
    ds_read_b64_tr_b16 v[64:65], v4 offset:4096
    ds_read_b64_tr_b16 v[66:67], v4 offset:4608
    ds_read_b128 v[24:27], v14 offset:0
    ds_read_b128 v[28:31], v14 offset:2048
    ds_read_b128 v[32:35], v14 offset:4096
    ds_read_b128 v[36:39], v14 offset:6144
    ds_read_b64_tr_b16 v[68:69], v5 offset:4096
    ds_read_b64_tr_b16 v[70:71], v5 offset:4608
    ds_read_b64_tr_b16 v[72:73], v4 offset:8192
    ds_read_b64_tr_b16 v[74:75], v4 offset:8704
    ds_read_b128 v[56:59], v18
    s_mov_b32 s34, 7
.p2align 6
L_p2:
    s_waitcnt lgkmcnt(8)
    v_mfma_f32_16x16x32_bf16 v[88:91], v[64:67], v[24:27], v[88:91]
    ds_read_b64_tr_b16 v[76:77], v5 offset:8192
    s_waitcnt lgkmcnt(8)
    v_mfma_f32_16x16x32_bf16 v[92:95], v[64:67], v[28:31], v[92:95]
    ds_read_b64_tr_b16 v[78:79], v5 offset:8704
    s_waitcnt lgkmcnt(8)
    v_mfma_f32_16x16x32_bf16 v[96:99], v[64:67], v[32:35], v[96:99]
    ds_read_b64_tr_b16 v[80:81], v4 offset:0
    s_waitcnt lgkmcnt(8)
    v_mfma_f32_16x16x32_bf16 v[100:103], v[64:67], v[36:39], v[100:103]
    ds_read_b64_tr_b16 v[82:83], v4 offset:512
    s_waitcnt lgkmcnt(4)
    v_mfma_f32_16x16x32_bf16 v[248:251], v[64:67], v[56:59], v[248:251]
    v_mfma_f32_16x16x32_bf16 v[104:107], v[68:71], v[24:27], v[104:107]
    ds_read_b64_tr_b16 v[64:65], v5 offset:0
    v_mfma_f32_16x16x32_bf16 v[108:111], v[68:71], v[28:31], v[108:111]
    v_mfma_f32_16x16x32_bf16 v[112:115], v[68:71], v[32:35], v[112:115]
    ds_read_b64_tr_b16 v[66:67], v5 offset:512
    v_mfma_f32_16x16x32_bf16 v[116:119], v[68:71], v[36:39], v[116:119]
    v_mfma_f32_16x16x32_bf16 v[120:123], v[24:27], v[72:75], v[120:123]
    ds_read_b64_tr_b16 v[68:69], v4 offset:12288
    v_mfma_f32_16x16x32_bf16 v[124:127], v[28:31], v[72:75], v[124:127]
    v_mfma_f32_16x16x32_bf16 v[128:131], v[32:35], v[72:75], v[128:131]
    ds_read_b64_tr_b16 v[70:71], v4 offset:12800
    v_mfma_f32_16x16x32_bf16 v[132:135], v[36:39], v[72:75], v[132:135]
    v_mfma_f32_16x16x32_bf16 v[252:255], v[56:59], v[72:75], v[252:255]
    s_waitcnt lgkmcnt(6)
    v_mfma_f32_16x16x32_bf16 v[136:139], v[24:27], v[76:79], v[136:139]
    ds_read_b64_tr_b16 v[72:73], v4 offset:16384
    v_mfma_f32_16x16x32_bf16 v[140:143], v[28:31], v[76:79], v[140:143]
    v_mfma_f32_16x16x32_bf16 v[144:147], v[32:35], v[76:79], v[144:147]
    ds_read_b64_tr_b16 v[74:75], v4 offset:16896
    v_mfma_f32_16x16x32_bf16 v[148:151], v[36:39], v[76:79], v[148:151]
    s_waitcnt lgkmcnt(6)
    v_mfma_f32_16x16x32_bf16 v[152:155], v[80:83], v[24:27], v[152:155]
    ds_read_b64_tr_b16 v[76:77], v5 offset:12288
    v_mfma_f32_16x16x32_bf16 v[156:159], v[80:83], v[28:31], v[156:159]
    v_mfma_f32_16x16x32_bf16 v[160:163], v[80:83], v[32:35], v[160:163]
    ds_read_b64_tr_b16 v[78:79], v5 offset:12800
    v_mfma_f32_16x16x32_bf16 v[164:167], v[80:83], v[36:39], v[164:167]
    s_waitcnt lgkmcnt(6)
    v_mfma_f32_16x16x32_bf16 v[168:171], v[64:67], v[24:27], v[168:171]
    ds_read_b64_tr_b16 v[80:81], v5 offset:16384
    v_mfma_f32_16x16x32_bf16 v[172:175], v[64:67], v[28:31], v[172:175]
    v_mfma_f32_16x16x32_bf16 v[176:179], v[64:67], v[32:35], v[176:179]
    ds_read_b64_tr_b16 v[82:83], v5 offset:16896
    v_mfma_f32_16x16x32_bf16 v[180:183], v[64:67], v[36:39], v[180:183]
    s_waitcnt lgkmcnt(6)
    v_mfma_f32_16x16x32_bf16 v[184:187], v[68:71], v[24:27], v[184:187]
    v_mfma_f32_16x16x32_bf16 v[188:191], v[68:71], v[28:31], v[188:191]
    v_mfma_f32_16x16x32_bf16 v[192:195], v[68:71], v[32:35], v[192:195]
    v_mfma_f32_16x16x32_bf16 v[196:199], v[68:71], v[36:39], v[196:199]
    s_waitcnt vmcnt(8) lgkmcnt(0)
    s_barrier
    v_mfma_f32_16x16x32_bf16 v[200:203], v[72:75], v[24:27], v[200:203]
    ds_read_b64_tr_b16 v[64:65], v4 offset:24576
    v_mfma_f32_16x16x32_bf16 v[204:207], v[72:75], v[28:31], v[204:207]
    ds_read_b64_tr_b16 v[66:67], v4 offset:25088
    v_mfma_f32_16x16x32_bf16 v[208:211], v[72:75], v[32:35], v[208:211]
    ds_read_b128 v[40:43], v15 offset:0
    v_mfma_f32_16x16x32_bf16 v[212:215], v[72:75], v[36:39], v[212:215]
    ds_read_b128 v[44:47], v15 offset:2048
    v_mfma_f32_16x16x32_bf16 v[216:219], v[76:79], v[24:27], v[216:219]
    ds_read_b128 v[48:51], v15 offset:4096
    v_mfma_f32_16x16x32_bf16 v[220:223], v[76:79], v[28:31], v[220:223]
    ds_read_b128 v[52:55], v15 offset:6144
    v_mfma_f32_16x16x32_bf16 v[224:227], v[76:79], v[32:35], v[224:227]
    ds_read_b64_tr_b16 v[68:69], v5 offset:24576
    v_mfma_f32_16x16x32_bf16 v[228:231], v[76:79], v[36:39], v[228:231]
    ds_read_b64_tr_b16 v[70:71], v5 offset:25088
    v_mfma_f32_16x16x32_bf16 v[232:235], v[80:83], v[24:27], v[232:235]
    ds_read_b64_tr_b16 v[72:73], v4 offset:28672
    v_mfma_f32_16x16x32_bf16 v[236:239], v[80:83], v[28:31], v[236:239]
    ds_read_b64_tr_b16 v[74:75], v4 offset:29184
    v_mfma_f32_16x16x32_bf16 v[240:243], v[80:83], v[32:35], v[240:243]
    ds_read_b128 v[60:63], v19
    v_mfma_f32_16x16x32_bf16 v[244:247], v[80:83], v[36:39], v[244:247]
    s_waitcnt lgkmcnt(8)
    v_mfma_f32_16x16x32_bf16 v[88:91], v[64:67], v[40:43], v[88:91]
    ds_read_b64_tr_b16 v[76:77], v5 offset:28672
    s_waitcnt lgkmcnt(8)
    v_mfma_f32_16x16x32_bf16 v[92:95], v[64:67], v[44:47], v[92:95]
    ds_read_b64_tr_b16 v[78:79], v5 offset:29184
    s_waitcnt lgkmcnt(8)
    v_mfma_f32_16x16x32_bf16 v[96:99], v[64:67], v[48:51], v[96:99]
    ds_read_b64_tr_b16 v[80:81], v4 offset:20480
    s_waitcnt lgkmcnt(8)
    v_mfma_f32_16x16x32_bf16 v[100:103], v[64:67], v[52:55], v[100:103]
    ds_read_b64_tr_b16 v[82:83], v4 offset:20992
    s_waitcnt lgkmcnt(4)
    v_mfma_f32_16x16x32_bf16 v[248:251], v[64:67], v[60:63], v[248:251]
    v_mfma_f32_16x16x32_bf16 v[104:107], v[68:71], v[40:43], v[104:107]
    ds_read_b64_tr_b16 v[64:65], v5 offset:20480
    v_mfma_f32_16x16x32_bf16 v[108:111], v[68:71], v[44:47], v[108:111]
    v_add_u32 v14, s80, v16
    v_mfma_f32_16x16x32_bf16 v[112:115], v[68:71], v[48:51], v[112:115]
    ds_read_b64_tr_b16 v[66:67], v5 offset:20992
    v_mfma_f32_16x16x32_bf16 v[116:119], v[68:71], v[52:55], v[116:119]
    v_add_u32 v15, s80, v17
    v_mfma_f32_16x16x32_bf16 v[120:123], v[40:43], v[72:75], v[120:123]
    ds_read_b64_tr_b16 v[68:69], v4 offset:32768
    v_mfma_f32_16x16x32_bf16 v[124:127], v[44:47], v[72:75], v[124:127]
    s_add_u32 s84, s80, s95
    v_mfma_f32_16x16x32_bf16 v[128:131], v[48:51], v[72:75], v[128:131]
    ds_read_b64_tr_b16 v[70:71], v4 offset:33280
    v_mfma_f32_16x16x32_bf16 v[132:135], v[52:55], v[72:75], v[132:135]
    v_add_u32 v18, s84, v16
    v_mfma_f32_16x16x32_bf16 v[252:255], v[60:63], v[72:75], v[252:255]
    s_waitcnt lgkmcnt(6)
    v_mfma_f32_16x16x32_bf16 v[136:139], v[40:43], v[76:79], v[136:139]
    ds_read_b64_tr_b16 v[72:73], v4 offset:36864
    v_mfma_f32_16x16x32_bf16 v[140:143], v[44:47], v[76:79], v[140:143]
    v_add_u32 v19, s84, v17
    v_mfma_f32_16x16x32_bf16 v[144:147], v[48:51], v[76:79], v[144:147]
    ds_read_b64_tr_b16 v[74:75], v4 offset:37376
    v_mfma_f32_16x16x32_bf16 v[148:151], v[52:55], v[76:79], v[148:151]
    s_add_u32 s80, s80, 18432
    s_waitcnt lgkmcnt(6)
    v_mfma_f32_16x16x32_bf16 v[152:155], v[80:83], v[40:43], v[152:155]
    ds_read_b64_tr_b16 v[76:77], v5 offset:32768
    v_mfma_f32_16x16x32_bf16 v[156:159], v[80:83], v[44:47], v[156:159]
    s_cmp_ge_u32 s80, 153600
    s_cselect_b32 s84, 55296, 0
    v_mfma_f32_16x16x32_bf16 v[160:163], v[80:83], v[48:51], v[160:163]
    ds_read_b64_tr_b16 v[78:79], v5 offset:33280
    v_mfma_f32_16x16x32_bf16 v[164:167], v[80:83], v[52:55], v[164:167]
    s_sub_u32 s80, s80, s84
    s_waitcnt lgkmcnt(6)
    v_mfma_f32_16x16x32_bf16 v[168:171], v[64:67], v[40:43], v[168:171]
    ds_read_b64_tr_b16 v[80:81], v5 offset:36864
    v_mfma_f32_16x16x32_bf16 v[172:175], v[64:67], v[44:47], v[172:175]
    v_mfma_f32_16x16x32_bf16 v[176:179], v[64:67], v[48:51], v[176:179]
    ds_read_b64_tr_b16 v[82:83], v5 offset:37376
    v_mfma_f32_16x16x32_bf16 v[180:183], v[64:67], v[52:55], v[180:183]
    s_waitcnt lgkmcnt(6)
    v_mfma_f32_16x16x32_bf16 v[184:187], v[68:71], v[40:43], v[184:187]
    v_mfma_f32_16x16x32_bf16 v[188:191], v[68:71], v[44:47], v[188:191]
    v_mfma_f32_16x16x32_bf16 v[192:195], v[68:71], v[48:51], v[192:195]
    v_mfma_f32_16x16x32_bf16 v[196:199], v[68:71], v[52:55], v[196:199]
    s_waitcnt vmcnt(0) lgkmcnt(0)
    s_barrier
    v_mfma_f32_16x16x32_bf16 v[200:203], v[72:75], v[40:43], v[200:203]
    ds_read_b64_tr_b16 v[64:65], v6 offset:4096
    v_mfma_f32_16x16x32_bf16 v[204:207], v[72:75], v[44:47], v[204:207]
    ds_read_b64_tr_b16 v[66:67], v6 offset:4608
    v_mfma_f32_16x16x32_bf16 v[208:211], v[72:75], v[48:51], v[208:211]
    ds_read_b128 v[24:27], v14 offset:0
    v_mfma_f32_16x16x32_bf16 v[212:215], v[72:75], v[52:55], v[212:215]
    ds_read_b128 v[28:31], v14 offset:2048
    v_mfma_f32_16x16x32_bf16 v[216:219], v[76:79], v[40:43], v[216:219]
    ds_read_b128 v[32:35], v14 offset:4096
    v_mfma_f32_16x16x32_bf16 v[220:223], v[76:79], v[44:47], v[220:223]
    ds_read_b128 v[36:39], v14 offset:6144
    v_mfma_f32_16x16x32_bf16 v[224:227], v[76:79], v[48:51], v[224:227]
    ds_read_b64_tr_b16 v[68:69], v7 offset:4096
    v_mfma_f32_16x16x32_bf16 v[228:231], v[76:79], v[52:55], v[228:231]
    ds_read_b64_tr_b16 v[70:71], v7 offset:4608
    v_mfma_f32_16x16x32_bf16 v[232:235], v[80:83], v[40:43], v[232:235]
    ds_read_b64_tr_b16 v[72:73], v6 offset:8192
    v_mfma_f32_16x16x32_bf16 v[236:239], v[80:83], v[44:47], v[236:239]
    ds_read_b64_tr_b16 v[74:75], v6 offset:8704
    v_mfma_f32_16x16x32_bf16 v[240:243], v[80:83], v[48:51], v[240:243]
    ds_read_b128 v[56:59], v18
    v_mfma_f32_16x16x32_bf16 v[244:247], v[80:83], v[52:55], v[244:247]
    s_waitcnt lgkmcnt(8)
    v_mfma_f32_16x16x32_bf16 v[88:91], v[64:67], v[24:27], v[88:91]
    ds_read_b64_tr_b16 v[76:77], v7 offset:8192
    s_waitcnt lgkmcnt(8)
    v_mfma_f32_16x16x32_bf16 v[92:95], v[64:67], v[28:31], v[92:95]
    ds_read_b64_tr_b16 v[78:79], v7 offset:8704
    s_waitcnt lgkmcnt(8)
    v_mfma_f32_16x16x32_bf16 v[96:99], v[64:67], v[32:35], v[96:99]
    ds_read_b64_tr_b16 v[80:81], v6 offset:0
    s_waitcnt lgkmcnt(8)
    v_mfma_f32_16x16x32_bf16 v[100:103], v[64:67], v[36:39], v[100:103]
    ds_read_b64_tr_b16 v[82:83], v6 offset:512
    s_waitcnt lgkmcnt(4)
    v_mfma_f32_16x16x32_bf16 v[248:251], v[64:67], v[56:59], v[248:251]
    v_mfma_f32_16x16x32_bf16 v[104:107], v[68:71], v[24:27], v[104:107]
    ds_read_b64_tr_b16 v[64:65], v7 offset:0
    v_mfma_f32_16x16x32_bf16 v[108:111], v[68:71], v[28:31], v[108:111]
    v_mfma_f32_16x16x32_bf16 v[112:115], v[68:71], v[32:35], v[112:115]
    ds_read_b64_tr_b16 v[66:67], v7 offset:512
    v_mfma_f32_16x16x32_bf16 v[116:119], v[68:71], v[36:39], v[116:119]
    v_mfma_f32_16x16x32_bf16 v[120:123], v[24:27], v[72:75], v[120:123]
    ds_read_b64_tr_b16 v[68:69], v6 offset:12288
    v_mfma_f32_16x16x32_bf16 v[124:127], v[28:31], v[72:75], v[124:127]
    v_mfma_f32_16x16x32_bf16 v[128:131], v[32:35], v[72:75], v[128:131]
    ds_read_b64_tr_b16 v[70:71], v6 offset:12800
    v_mfma_f32_16x16x32_bf16 v[132:135], v[36:39], v[72:75], v[132:135]
    v_mfma_f32_16x16x32_bf16 v[252:255], v[56:59], v[72:75], v[252:255]
    s_waitcnt lgkmcnt(6)
    v_mfma_f32_16x16x32_bf16 v[136:139], v[24:27], v[76:79], v[136:139]
    ds_read_b64_tr_b16 v[72:73], v6 offset:16384
    v_mfma_f32_16x16x32_bf16 v[140:143], v[28:31], v[76:79], v[140:143]
    v_mfma_f32_16x16x32_bf16 v[144:147], v[32:35], v[76:79], v[144:147]
    ds_read_b64_tr_b16 v[74:75], v6 offset:16896
    v_mfma_f32_16x16x32_bf16 v[148:151], v[36:39], v[76:79], v[148:151]
    s_waitcnt lgkmcnt(6)
    v_mfma_f32_16x16x32_bf16 v[152:155], v[80:83], v[24:27], v[152:155]
    ds_read_b64_tr_b16 v[76:77], v7 offset:12288
    v_mfma_f32_16x16x32_bf16 v[156:159], v[80:83], v[28:31], v[156:159]
    v_mfma_f32_16x16x32_bf16 v[160:163], v[80:83], v[32:35], v[160:163]
    ds_read_b64_tr_b16 v[78:79], v7 offset:12800
    v_mfma_f32_16x16x32_bf16 v[164:167], v[80:83], v[36:39], v[164:167]
    s_waitcnt lgkmcnt(6)
    v_mfma_f32_16x16x32_bf16 v[168:171], v[64:67], v[24:27], v[168:171]
    ds_read_b64_tr_b16 v[80:81], v7 offset:16384
    v_mfma_f32_16x16x32_bf16 v[172:175], v[64:67], v[28:31], v[172:175]
    v_mfma_f32_16x16x32_bf16 v[176:179], v[64:67], v[32:35], v[176:179]
    ds_read_b64_tr_b16 v[82:83], v7 offset:16896
    v_mfma_f32_16x16x32_bf16 v[180:183], v[64:67], v[36:39], v[180:183]
    s_waitcnt lgkmcnt(6)
    v_mfma_f32_16x16x32_bf16 v[184:187], v[68:71], v[24:27], v[184:187]
    v_mfma_f32_16x16x32_bf16 v[188:191], v[68:71], v[28:31], v[188:191]
    v_mfma_f32_16x16x32_bf16 v[192:195], v[68:71], v[32:35], v[192:195]
    v_mfma_f32_16x16x32_bf16 v[196:199], v[68:71], v[36:39], v[196:199]
    s_waitcnt lgkmcnt(0)
    s_barrier
    v_mfma_f32_16x16x32_bf16 v[200:203], v[72:75], v[24:27], v[200:203]
    ds_read_b64_tr_b16 v[64:65], v6 offset:24576
    v_mfma_f32_16x16x32_bf16 v[204:207], v[72:75], v[28:31], v[204:207]
    ds_read_b64_tr_b16 v[66:67], v6 offset:25088
    v_mfma_f32_16x16x32_bf16 v[208:211], v[72:75], v[32:35], v[208:211]
    ds_read_b128 v[40:43], v15 offset:0
    v_mfma_f32_16x16x32_bf16 v[212:215], v[72:75], v[36:39], v[212:215]
    ds_read_b128 v[44:47], v15 offset:2048
    v_mfma_f32_16x16x32_bf16 v[216:219], v[76:79], v[24:27], v[216:219]
    ds_read_b128 v[48:51], v15 offset:4096
    v_mfma_f32_16x16x32_bf16 v[220:223], v[76:79], v[28:31], v[220:223]
    ds_read_b128 v[52:55], v15 offset:6144
    v_mfma_f32_16x16x32_bf16 v[224:227], v[76:79], v[32:35], v[224:227]
    ds_read_b64_tr_b16 v[68:69], v7 offset:24576
    v_mfma_f32_16x16x32_bf16 v[228:231], v[76:79], v[36:39], v[228:231]
    ds_read_b64_tr_b16 v[70:71], v7 offset:25088
    v_mfma_f32_16x16x32_bf16 v[232:235], v[80:83], v[24:27], v[232:235]
    ds_read_b64_tr_b16 v[72:73], v6 offset:28672
    v_mfma_f32_16x16x32_bf16 v[236:239], v[80:83], v[28:31], v[236:239]
    ds_read_b64_tr_b16 v[74:75], v6 offset:29184
    v_mfma_f32_16x16x32_bf16 v[240:243], v[80:83], v[32:35], v[240:243]
    ds_read_b128 v[60:63], v19
    v_mfma_f32_16x16x32_bf16 v[244:247], v[80:83], v[36:39], v[244:247]
    s_waitcnt lgkmcnt(8)
    v_mfma_f32_16x16x32_bf16 v[88:91], v[64:67], v[40:43], v[88:91]
    ds_read_b64_tr_b16 v[76:77], v7 offset:28672
    s_waitcnt lgkmcnt(8)
    v_mfma_f32_16x16x32_bf16 v[92:95], v[64:67], v[44:47], v[92:95]
    ds_read_b64_tr_b16 v[78:79], v7 offset:29184
    s_waitcnt lgkmcnt(8)
    v_mfma_f32_16x16x32_bf16 v[96:99], v[64:67], v[48:51], v[96:99]
    ds_read_b64_tr_b16 v[80:81], v6 offset:20480
    s_waitcnt lgkmcnt(8)
    v_mfma_f32_16x16x32_bf16 v[100:103], v[64:67], v[52:55], v[100:103]
    ds_read_b64_tr_b16 v[82:83], v6 offset:20992
    s_waitcnt lgkmcnt(4)
    v_mfma_f32_16x16x32_bf16 v[248:251], v[64:67], v[60:63], v[248:251]
    v_mfma_f32_16x16x32_bf16 v[104:107], v[68:71], v[40:43], v[104:107]
    ds_read_b64_tr_b16 v[64:65], v7 offset:20480
    v_mfma_f32_16x16x32_bf16 v[108:111], v[68:71], v[44:47], v[108:111]
    v_add_u32 v14, s80, v16
    v_mfma_f32_16x16x32_bf16 v[112:115], v[68:71], v[48:51], v[112:115]
    ds_read_b64_tr_b16 v[66:67], v7 offset:20992
    v_mfma_f32_16x16x32_bf16 v[116:119], v[68:71], v[52:55], v[116:119]
    v_add_u32 v15, s80, v17
    v_mfma_f32_16x16x32_bf16 v[120:123], v[40:43], v[72:75], v[120:123]
    ds_read_b64_tr_b16 v[68:69], v6 offset:32768
    v_mfma_f32_16x16x32_bf16 v[124:127], v[44:47], v[72:75], v[124:127]
    s_add_u32 s84, s80, s95
    v_mfma_f32_16x16x32_bf16 v[128:131], v[48:51], v[72:75], v[128:131]
    ds_read_b64_tr_b16 v[70:71], v6 offset:33280
    v_mfma_f32_16x16x32_bf16 v[132:135], v[52:55], v[72:75], v[132:135]
    v_add_u32 v18, s84, v16
    v_mfma_f32_16x16x32_bf16 v[252:255], v[60:63], v[72:75], v[252:255]
    s_waitcnt lgkmcnt(6)
    v_mfma_f32_16x16x32_bf16 v[136:139], v[40:43], v[76:79], v[136:139]
    ds_read_b64_tr_b16 v[72:73], v6 offset:36864
    v_mfma_f32_16x16x32_bf16 v[140:143], v[44:47], v[76:79], v[140:143]
    v_add_u32 v19, s84, v17
    v_mfma_f32_16x16x32_bf16 v[144:147], v[48:51], v[76:79], v[144:147]
    ds_read_b64_tr_b16 v[74:75], v6 offset:37376
    v_mfma_f32_16x16x32_bf16 v[148:151], v[52:55], v[76:79], v[148:151]
    s_add_u32 s80, s80, 18432
    s_waitcnt lgkmcnt(6)
    v_mfma_f32_16x16x32_bf16 v[152:155], v[80:83], v[40:43], v[152:155]
    ds_read_b64_tr_b16 v[76:77], v7 offset:32768
    v_mfma_f32_16x16x32_bf16 v[156:159], v[80:83], v[44:47], v[156:159]
    s_cmp_ge_u32 s80, 153600
    s_cselect_b32 s84, 55296, 0
    v_mfma_f32_16x16x32_bf16 v[160:163], v[80:83], v[48:51], v[160:163]
    ds_read_b64_tr_b16 v[78:79], v7 offset:33280
    v_mfma_f32_16x16x32_bf16 v[164:167], v[80:83], v[52:55], v[164:167]
    s_sub_u32 s80, s80, s84
    s_waitcnt lgkmcnt(6)
    v_mfma_f32_16x16x32_bf16 v[168:171], v[64:67], v[40:43], v[168:171]
    ds_read_b64_tr_b16 v[80:81], v7 offset:36864
    v_mfma_f32_16x16x32_bf16 v[172:175], v[64:67], v[44:47], v[172:175]
    v_mfma_f32_16x16x32_bf16 v[176:179], v[64:67], v[48:51], v[176:179]
    ds_read_b64_tr_b16 v[82:83], v7 offset:37376
    v_mfma_f32_16x16x32_bf16 v[180:183], v[64:67], v[52:55], v[180:183]
    s_waitcnt lgkmcnt(6)
    v_mfma_f32_16x16x32_bf16 v[184:187], v[68:71], v[40:43], v[184:187]
    v_mfma_f32_16x16x32_bf16 v[188:191], v[68:71], v[44:47], v[188:191]
    v_mfma_f32_16x16x32_bf16 v[192:195], v[68:71], v[48:51], v[192:195]
    v_mfma_f32_16x16x32_bf16 v[196:199], v[68:71], v[52:55], v[196:199]
    s_waitcnt lgkmcnt(0)
    s_barrier
    v_mfma_f32_16x16x32_bf16 v[200:203], v[72:75], v[40:43], v[200:203]
    ds_read_b64_tr_b16 v[64:65], v4 offset:4096
    v_mfma_f32_16x16x32_bf16 v[204:207], v[72:75], v[44:47], v[204:207]
    ds_read_b64_tr_b16 v[66:67], v4 offset:4608
    v_mfma_f32_16x16x32_bf16 v[208:211], v[72:75], v[48:51], v[208:211]
    ds_read_b128 v[24:27], v14 offset:0
    v_mfma_f32_16x16x32_bf16 v[212:215], v[72:75], v[52:55], v[212:215]
    ds_read_b128 v[28:31], v14 offset:2048
    v_mfma_f32_16x16x32_bf16 v[216:219], v[76:79], v[40:43], v[216:219]
    ds_read_b128 v[32:35], v14 offset:4096
    v_mfma_f32_16x16x32_bf16 v[220:223], v[76:79], v[44:47], v[220:223]
    ds_read_b128 v[36:39], v14 offset:6144
    v_mfma_f32_16x16x32_bf16 v[224:227], v[76:79], v[48:51], v[224:227]
    ds_read_b64_tr_b16 v[68:69], v5 offset:4096
    v_mfma_f32_16x16x32_bf16 v[228:231], v[76:79], v[52:55], v[228:231]
    ds_read_b64_tr_b16 v[70:71], v5 offset:4608
    v_mfma_f32_16x16x32_bf16 v[232:235], v[80:83], v[40:43], v[232:235]
    ds_read_b64_tr_b16 v[72:73], v4 offset:8192
    v_mfma_f32_16x16x32_bf16 v[236:239], v[80:83], v[44:47], v[236:239]
    ds_read_b64_tr_b16 v[74:75], v4 offset:8704
    v_mfma_f32_16x16x32_bf16 v[240:243], v[80:83], v[48:51], v[240:243]
    ds_read_b128 v[56:59], v18
    v_mfma_f32_16x16x32_bf16 v[244:247], v[80:83], v[52:55], v[244:247]
    s_sub_u32 s34, s34, 1
    s_cmp_lg_u32 s34, 0
    s_cbranch_scc1 L_p2
    s_waitcnt lgkmcnt(8)
    v_mfma_f32_16x16x32_bf16 v[88:91], v[64:67], v[24:27], v[88:91]
    ds_read_b64_tr_b16 v[76:77], v5 offset:8192
    s_waitcnt lgkmcnt(8)
    v_mfma_f32_16x16x32_bf16 v[92:95], v[64:67], v[28:31], v[92:95]
    ds_read_b64_tr_b16 v[78:79], v5 offset:8704
    s_waitcnt lgkmcnt(8)
    v_mfma_f32_16x16x32_bf16 v[96:99], v[64:67], v[32:35], v[96:99]
    ds_read_b64_tr_b16 v[80:81], v4 offset:0
    s_waitcnt lgkmcnt(8)
    v_mfma_f32_16x16x32_bf16 v[100:103], v[64:67], v[36:39], v[100:103]
    ds_read_b64_tr_b16 v[82:83], v4 offset:512
    s_waitcnt lgkmcnt(4)
    v_mfma_f32_16x16x32_bf16 v[248:251], v[64:67], v[56:59], v[248:251]
    v_mfma_f32_16x16x32_bf16 v[104:107], v[68:71], v[24:27], v[104:107]
    ds_read_b64_tr_b16 v[64:65], v5 offset:0
    v_mfma_f32_16x16x32_bf16 v[108:111], v[68:71], v[28:31], v[108:111]
    v_mfma_f32_16x16x32_bf16 v[112:115], v[68:71], v[32:35], v[112:115]
    ds_read_b64_tr_b16 v[66:67], v5 offset:512
    v_mfma_f32_16x16x32_bf16 v[116:119], v[68:71], v[36:39], v[116:119]
    v_mfma_f32_16x16x32_bf16 v[120:123], v[24:27], v[72:75], v[120:123]
    ds_read_b64_tr_b16 v[68:69], v4 offset:12288
    v_mfma_f32_16x16x32_bf16 v[124:127], v[28:31], v[72:75], v[124:127]
    v_mfma_f32_16x16x32_bf16 v[128:131], v[32:35], v[72:75], v[128:131]
    ds_read_b64_tr_b16 v[70:71], v4 offset:12800
    v_mfma_f32_16x16x32_bf16 v[132:135], v[36:39], v[72:75], v[132:135]
    v_mfma_f32_16x16x32_bf16 v[252:255], v[56:59], v[72:75], v[252:255]
    s_waitcnt lgkmcnt(6)
    v_mfma_f32_16x16x32_bf16 v[136:139], v[24:27], v[76:79], v[136:139]
    ds_read_b64_tr_b16 v[72:73], v4 offset:16384
    v_mfma_f32_16x16x32_bf16 v[140:143], v[28:31], v[76:79], v[140:143]
    v_mfma_f32_16x16x32_bf16 v[144:147], v[32:35], v[76:79], v[144:147]
    ds_read_b64_tr_b16 v[74:75], v4 offset:16896
    v_mfma_f32_16x16x32_bf16 v[148:151], v[36:39], v[76:79], v[148:151]
    s_waitcnt lgkmcnt(6)
    v_mfma_f32_16x16x32_bf16 v[152:155], v[80:83], v[24:27], v[152:155]
    ds_read_b64_tr_b16 v[76:77], v5 offset:12288
    v_mfma_f32_16x16x32_bf16 v[156:159], v[80:83], v[28:31], v[156:159]
    v_mfma_f32_16x16x32_bf16 v[160:163], v[80:83], v[32:35], v[160:163]
    ds_read_b64_tr_b16 v[78:79], v5 offset:12800
    v_mfma_f32_16x16x32_bf16 v[164:167], v[80:83], v[36:39], v[164:167]
    s_waitcnt lgkmcnt(6)
    v_mfma_f32_16x16x32_bf16 v[168:171], v[64:67], v[24:27], v[168:171]
    ds_read_b64_tr_b16 v[80:81], v5 offset:16384
    v_mfma_f32_16x16x32_bf16 v[172:175], v[64:67], v[28:31], v[172:175]
    v_mfma_f32_16x16x32_bf16 v[176:179], v[64:67], v[32:35], v[176:179]
    ds_read_b64_tr_b16 v[82:83], v5 offset:16896
    v_mfma_f32_16x16x32_bf16 v[180:183], v[64:67], v[36:39], v[180:183]
    s_waitcnt lgkmcnt(6)
    v_mfma_f32_16x16x32_bf16 v[184:187], v[68:71], v[24:27], v[184:187]
    v_mfma_f32_16x16x32_bf16 v[188:191], v[68:71], v[28:31], v[188:191]
    v_mfma_f32_16x16x32_bf16 v[192:195], v[68:71], v[32:35], v[192:195]
    v_mfma_f32_16x16x32_bf16 v[196:199], v[68:71], v[36:39], v[196:199]
    s_waitcnt lgkmcnt(0)
    s_barrier
    v_mfma_f32_16x16x32_bf16 v[200:203], v[72:75], v[24:27], v[200:203]
    ds_read_b64_tr_b16 v[64:65], v4 offset:24576
    v_mfma_f32_16x16x32_bf16 v[204:207], v[72:75], v[28:31], v[204:207]
    ds_read_b64_tr_b16 v[66:67], v4 offset:25088
    v_mfma_f32_16x16x32_bf16 v[208:211], v[72:75], v[32:35], v[208:211]
    ds_read_b128 v[40:43], v15 offset:0
    v_mfma_f32_16x16x32_bf16 v[212:215], v[72:75], v[36:39], v[212:215]
    ds_read_b128 v[44:47], v15 offset:2048
    v_mfma_f32_16x16x32_bf16 v[216:219], v[76:79], v[24:27], v[216:219]
    ds_read_b128 v[48:51], v15 offset:4096
    v_mfma_f32_16x16x32_bf16 v[220:223], v[76:79], v[28:31], v[220:223]
    ds_read_b128 v[52:55], v15 offset:6144
    v_mfma_f32_16x16x32_bf16 v[224:227], v[76:79], v[32:35], v[224:227]
    ds_read_b64_tr_b16 v[68:69], v5 offset:24576
    v_mfma_f32_16x16x32_bf16 v[228:231], v[76:79], v[36:39], v[228:231]
    ds_read_b64_tr_b16 v[70:71], v5 offset:25088
    v_mfma_f32_16x16x32_bf16 v[232:235], v[80:83], v[24:27], v[232:235]
    ds_read_b64_tr_b16 v[72:73], v4 offset:28672
    v_mfma_f32_16x16x32_bf16 v[236:239], v[80:83], v[28:31], v[236:239]
    ds_read_b64_tr_b16 v[74:75], v4 offset:29184
    v_mfma_f32_16x16x32_bf16 v[240:243], v[80:83], v[32:35], v[240:243]
    ds_read_b128 v[60:63], v19
    v_mfma_f32_16x16x32_bf16 v[244:247], v[80:83], v[36:39], v[244:247]
    s_waitcnt lgkmcnt(8)
    v_mfma_f32_16x16x32_bf16 v[88:91], v[64:67], v[40:43], v[88:91]
    ds_read_b64_tr_b16 v[76:77], v5 offset:28672
    s_waitcnt lgkmcnt(8)
    v_mfma_f32_16x16x32_bf16 v[92:95], v[64:67], v[44:47], v[92:95]
    ds_read_b64_tr_b16 v[78:79], v5 offset:29184
    s_waitcnt lgkmcnt(8)
    v_mfma_f32_16x16x32_bf16 v[96:99], v[64:67], v[48:51], v[96:99]
    ds_read_b64_tr_b16 v[80:81], v4 offset:20480
    s_waitcnt lgkmcnt(8)
    v_mfma_f32_16x16x32_bf16 v[100:103], v[64:67], v[52:55], v[100:103]
    ds_read_b64_tr_b16 v[82:83], v4 offset:20992
    s_waitcnt lgkmcnt(4)
    v_mfma_f32_16x16x32_bf16 v[248:251], v[64:67], v[60:63], v[248:251]
    v_mfma_f32_16x16x32_bf16 v[104:107], v[68:71], v[40:43], v[104:107]
    ds_read_b64_tr_b16 v[64:65], v5 offset:20480
    v_mfma_f32_16x16x32_bf16 v[108:111], v[68:71], v[44:47], v[108:111]
    v_add_u32 v14, s80, v16
    v_mfma_f32_16x16x32_bf16 v[112:115], v[68:71], v[48:51], v[112:115]
    ds_read_b64_tr_b16 v[66:67], v5 offset:20992
    v_mfma_f32_16x16x32_bf16 v[116:119], v[68:71], v[52:55], v[116:119]
    v_add_u32 v15, s80, v17
    v_mfma_f32_16x16x32_bf16 v[120:123], v[40:43], v[72:75], v[120:123]
    ds_read_b64_tr_b16 v[68:69], v4 offset:32768
    v_mfma_f32_16x16x32_bf16 v[124:127], v[44:47], v[72:75], v[124:127]
    s_add_u32 s84, s80, s95
    v_mfma_f32_16x16x32_bf16 v[128:131], v[48:51], v[72:75], v[128:131]
    ds_read_b64_tr_b16 v[70:71], v4 offset:33280
    v_mfma_f32_16x16x32_bf16 v[132:135], v[52:55], v[72:75], v[132:135]
    v_add_u32 v18, s84, v16
    v_mfma_f32_16x16x32_bf16 v[252:255], v[60:63], v[72:75], v[252:255]
    s_waitcnt lgkmcnt(6)
    v_mfma_f32_16x16x32_bf16 v[136:139], v[40:43], v[76:79], v[136:139]
    ds_read_b64_tr_b16 v[72:73], v4 offset:36864
    v_mfma_f32_16x16x32_bf16 v[140:143], v[44:47], v[76:79], v[140:143]
    v_add_u32 v19, s84, v17
    v_mfma_f32_16x16x32_bf16 v[144:147], v[48:51], v[76:79], v[144:147]
    ds_read_b64_tr_b16 v[74:75], v4 offset:37376
    v_mfma_f32_16x16x32_bf16 v[148:151], v[52:55], v[76:79], v[148:151]
    s_add_u32 s80, s80, 18432
    s_waitcnt lgkmcnt(6)
    v_mfma_f32_16x16x32_bf16 v[152:155], v[80:83], v[40:43], v[152:155]
    ds_read_b64_tr_b16 v[76:77], v5 offset:32768
    v_mfma_f32_16x16x32_bf16 v[156:159], v[80:83], v[44:47], v[156:159]
    s_cmp_ge_u32 s80, 153600
    s_cselect_b32 s84, 55296, 0
    v_mfma_f32_16x16x32_bf16 v[160:163], v[80:83], v[48:51], v[160:163]
    ds_read_b64_tr_b16 v[78:79], v5 offset:33280
    v_mfma_f32_16x16x32_bf16 v[164:167], v[80:83], v[52:55], v[164:167]
    s_sub_u32 s80, s80, s84
    s_waitcnt lgkmcnt(6)
    v_mfma_f32_16x16x32_bf16 v[168:171], v[64:67], v[40:43], v[168:171]
    ds_read_b64_tr_b16 v[80:81], v5 offset:36864
    v_mfma_f32_16x16x32_bf16 v[172:175], v[64:67], v[44:47], v[172:175]
    v_mfma_f32_16x16x32_bf16 v[176:179], v[64:67], v[48:51], v[176:179]
    ds_read_b64_tr_b16 v[82:83], v5 offset:37376
    v_mfma_f32_16x16x32_bf16 v[180:183], v[64:67], v[52:55], v[180:183]
    s_waitcnt lgkmcnt(6)
    v_mfma_f32_16x16x32_bf16 v[184:187], v[68:71], v[40:43], v[184:187]
    v_mfma_f32_16x16x32_bf16 v[188:191], v[68:71], v[44:47], v[188:191]
    v_mfma_f32_16x16x32_bf16 v[192:195], v[68:71], v[48:51], v[192:195]
    v_mfma_f32_16x16x32_bf16 v[196:199], v[68:71], v[52:55], v[196:199]
    s_waitcnt lgkmcnt(0)
    s_barrier
    v_mfma_f32_16x16x32_bf16 v[200:203], v[72:75], v[40:43], v[200:203]
    ds_read_b64_tr_b16 v[64:65], v6 offset:4096
    v_mfma_f32_16x16x32_bf16 v[204:207], v[72:75], v[44:47], v[204:207]
    ds_read_b64_tr_b16 v[66:67], v6 offset:4608
    v_mfma_f32_16x16x32_bf16 v[208:211], v[72:75], v[48:51], v[208:211]
    ds_read_b128 v[24:27], v14 offset:0
    v_mfma_f32_16x16x32_bf16 v[212:215], v[72:75], v[52:55], v[212:215]
    ds_read_b128 v[28:31], v14 offset:2048
    v_mfma_f32_16x16x32_bf16 v[216:219], v[76:79], v[40:43], v[216:219]
    ds_read_b128 v[32:35], v14 offset:4096
    v_mfma_f32_16x16x32_bf16 v[220:223], v[76:79], v[44:47], v[220:223]
    ds_read_b128 v[36:39], v14 offset:6144
    v_mfma_f32_16x16x32_bf16 v[224:227], v[76:79], v[48:51], v[224:227]
    ds_read_b64_tr_b16 v[68:69], v7 offset:4096
    v_mfma_f32_16x16x32_bf16 v[228:231], v[76:79], v[52:55], v[228:231]
    ds_read_b64_tr_b16 v[70:71], v7 offset:4608
    v_mfma_f32_16x16x32_bf16 v[232:235], v[80:83], v[40:43], v[232:235]
    ds_read_b64_tr_b16 v[72:73], v6 offset:8192
    v_mfma_f32_16x16x32_bf16 v[236:239], v[80:83], v[44:47], v[236:239]
    ds_read_b64_tr_b16 v[74:75], v6 offset:8704
    v_mfma_f32_16x16x32_bf16 v[240:243], v[80:83], v[48:51], v[240:243]
    ds_read_b128 v[56:59], v18
    v_mfma_f32_16x16x32_bf16 v[244:247], v[80:83], v[52:55], v[244:247]
    s_waitcnt lgkmcnt(8)
    v_mfma_f32_16x16x32_bf16 v[88:91], v[64:67], v[24:27], v[88:91]
    ds_read_b64_tr_b16 v[76:77], v7 offset:8192
    s_waitcnt lgkmcnt(8)
    v_mfma_f32_16x16x32_bf16 v[92:95], v[64:67], v[28:31], v[92:95]
    ds_read_b64_tr_b16 v[78:79], v7 offset:8704
    s_waitcnt lgkmcnt(8)
    v_mfma_f32_16x16x32_bf16 v[96:99], v[64:67], v[32:35], v[96:99]
    ds_read_b64_tr_b16 v[80:81], v6 offset:0
    s_waitcnt lgkmcnt(8)
    v_mfma_f32_16x16x32_bf16 v[100:103], v[64:67], v[36:39], v[100:103]
    ds_read_b64_tr_b16 v[82:83], v6 offset:512
    s_waitcnt lgkmcnt(4)
    v_mfma_f32_16x16x32_bf16 v[248:251], v[64:67], v[56:59], v[248:251]
    v_mfma_f32_16x16x32_bf16 v[104:107], v[68:71], v[24:27], v[104:107]
    ds_read_b64_tr_b16 v[64:65], v7 offset:0
    v_mfma_f32_16x16x32_bf16 v[108:111], v[68:71], v[28:31], v[108:111]
    v_mfma_f32_16x16x32_bf16 v[112:115], v[68:71], v[32:35], v[112:115]
    ds_read_b64_tr_b16 v[66:67], v7 offset:512
    v_mfma_f32_16x16x32_bf16 v[116:119], v[68:71], v[36:39], v[116:119]
    v_mfma_f32_16x16x32_bf16 v[120:123], v[24:27], v[72:75], v[120:123]
    ds_read_b64_tr_b16 v[68:69], v6 offset:12288
    v_mfma_f32_16x16x32_bf16 v[124:127], v[28:31], v[72:75], v[124:127]
    v_mfma_f32_16x16x32_bf16 v[128:131], v[32:35], v[72:75], v[128:131]
    ds_read_b64_tr_b16 v[70:71], v6 offset:12800
    v_mfma_f32_16x16x32_bf16 v[132:135], v[36:39], v[72:75], v[132:135]
    v_mfma_f32_16x16x32_bf16 v[252:255], v[56:59], v[72:75], v[252:255]
    s_waitcnt lgkmcnt(6)
    v_mfma_f32_16x16x32_bf16 v[136:139], v[24:27], v[76:79], v[136:139]
    ds_read_b64_tr_b16 v[72:73], v6 offset:16384
    v_mfma_f32_16x16x32_bf16 v[140:143], v[28:31], v[76:79], v[140:143]
    v_mfma_f32_16x16x32_bf16 v[144:147], v[32:35], v[76:79], v[144:147]
    ds_read_b64_tr_b16 v[74:75], v6 offset:16896
    v_mfma_f32_16x16x32_bf16 v[148:151], v[36:39], v[76:79], v[148:151]
    s_waitcnt lgkmcnt(6)
    v_mfma_f32_16x16x32_bf16 v[152:155], v[80:83], v[24:27], v[152:155]
    ds_read_b64_tr_b16 v[76:77], v7 offset:12288
    v_mfma_f32_16x16x32_bf16 v[156:159], v[80:83], v[28:31], v[156:159]
    v_mfma_f32_16x16x32_bf16 v[160:163], v[80:83], v[32:35], v[160:163]
    ds_read_b64_tr_b16 v[78:79], v7 offset:12800
    v_mfma_f32_16x16x32_bf16 v[164:167], v[80:83], v[36:39], v[164:167]
    s_waitcnt lgkmcnt(6)
    v_mfma_f32_16x16x32_bf16 v[168:171], v[64:67], v[24:27], v[168:171]
    ds_read_b64_tr_b16 v[80:81], v7 offset:16384
    v_mfma_f32_16x16x32_bf16 v[172:175], v[64:67], v[28:31], v[172:175]
    v_mfma_f32_16x16x32_bf16 v[176:179], v[64:67], v[32:35], v[176:179]
    ds_read_b64_tr_b16 v[82:83], v7 offset:16896
    v_mfma_f32_16x16x32_bf16 v[180:183], v[64:67], v[36:39], v[180:183]
    s_waitcnt lgkmcnt(6)
    v_mfma_f32_16x16x32_bf16 v[184:187], v[68:71], v[24:27], v[184:187]
    v_mfma_f32_16x16x32_bf16 v[188:191], v[68:71], v[28:31], v[188:191]
    v_mfma_f32_16x16x32_bf16 v[192:195], v[68:71], v[32:35], v[192:195]
    v_mfma_f32_16x16x32_bf16 v[196:199], v[68:71], v[36:39], v[196:199]
    s_waitcnt lgkmcnt(0)
    s_barrier
    v_mfma_f32_16x16x32_bf16 v[200:203], v[72:75], v[24:27], v[200:203]
    ds_read_b64_tr_b16 v[64:65], v6 offset:24576
    v_mfma_f32_16x16x32_bf16 v[204:207], v[72:75], v[28:31], v[204:207]
    ds_read_b64_tr_b16 v[66:67], v6 offset:25088
    v_mfma_f32_16x16x32_bf16 v[208:211], v[72:75], v[32:35], v[208:211]
    ds_read_b128 v[40:43], v15 offset:0
    v_mfma_f32_16x16x32_bf16 v[212:215], v[72:75], v[36:39], v[212:215]
    ds_read_b128 v[44:47], v15 offset:2048
    v_mfma_f32_16x16x32_bf16 v[216:219], v[76:79], v[24:27], v[216:219]
    ds_read_b128 v[48:51], v15 offset:4096
    v_mfma_f32_16x16x32_bf16 v[220:223], v[76:79], v[28:31], v[220:223]
    ds_read_b128 v[52:55], v15 offset:6144
    v_mfma_f32_16x16x32_bf16 v[224:227], v[76:79], v[32:35], v[224:227]
    ds_read_b64_tr_b16 v[68:69], v7 offset:24576
    v_mfma_f32_16x16x32_bf16 v[228:231], v[76:79], v[36:39], v[228:231]
    ds_read_b64_tr_b16 v[70:71], v7 offset:25088
    v_mfma_f32_16x16x32_bf16 v[232:235], v[80:83], v[24:27], v[232:235]
    ds_read_b64_tr_b16 v[72:73], v6 offset:28672
    v_mfma_f32_16x16x32_bf16 v[236:239], v[80:83], v[28:31], v[236:239]
    ds_read_b64_tr_b16 v[74:75], v6 offset:29184
    v_mfma_f32_16x16x32_bf16 v[240:243], v[80:83], v[32:35], v[240:243]
    ds_read_b128 v[60:63], v19
    v_mfma_f32_16x16x32_bf16 v[244:247], v[80:83], v[36:39], v[244:247]
    s_waitcnt lgkmcnt(8)
    v_mfma_f32_16x16x32_bf16 v[88:91], v[64:67], v[40:43], v[88:91]
    ds_read_b64_tr_b16 v[76:77], v7 offset:28672
    s_waitcnt lgkmcnt(8)
    v_mfma_f32_16x16x32_bf16 v[92:95], v[64:67], v[44:47], v[92:95]
    ds_read_b64_tr_b16 v[78:79], v7 offset:29184
    s_waitcnt lgkmcnt(8)
    v_mfma_f32_16x16x32_bf16 v[96:99], v[64:67], v[48:51], v[96:99]
    ds_read_b64_tr_b16 v[80:81], v6 offset:20480
    s_waitcnt lgkmcnt(8)
    v_mfma_f32_16x16x32_bf16 v[100:103], v[64:67], v[52:55], v[100:103]
    ds_read_b64_tr_b16 v[82:83], v6 offset:20992
    s_waitcnt lgkmcnt(4)
    v_mfma_f32_16x16x32_bf16 v[248:251], v[64:67], v[60:63], v[248:251]
    v_mfma_f32_16x16x32_bf16 v[104:107], v[68:71], v[40:43], v[104:107]
    ds_read_b64_tr_b16 v[64:65], v7 offset:20480
    v_mfma_f32_16x16x32_bf16 v[108:111], v[68:71], v[44:47], v[108:111]
    v_mfma_f32_16x16x32_bf16 v[112:115], v[68:71], v[48:51], v[112:115]
    ds_read_b64_tr_b16 v[66:67], v7 offset:20992
    v_mfma_f32_16x16x32_bf16 v[116:119], v[68:71], v[52:55], v[116:119]
    v_mfma_f32_16x16x32_bf16 v[120:123], v[40:43], v[72:75], v[120:123]
    ds_read_b64_tr_b16 v[68:69], v6 offset:32768
    v_mfma_f32_16x16x32_bf16 v[124:127], v[44:47], v[72:75], v[124:127]
    v_mfma_f32_16x16x32_bf16 v[128:131], v[48:51], v[72:75], v[128:131]
    ds_read_b64_tr_b16 v[70:71], v6 offset:33280
    v_mfma_f32_16x16x32_bf16 v[132:135], v[52:55], v[72:75], v[132:135]
    v_mfma_f32_16x16x32_bf16 v[252:255], v[60:63], v[72:75], v[252:255]
    s_waitcnt lgkmcnt(6)
    v_mfma_f32_16x16x32_bf16 v[136:139], v[40:43], v[76:79], v[136:139]
    ds_read_b64_tr_b16 v[72:73], v6 offset:36864
    v_mfma_f32_16x16x32_bf16 v[140:143], v[44:47], v[76:79], v[140:143]
    v_mfma_f32_16x16x32_bf16 v[144:147], v[48:51], v[76:79], v[144:147]
    ds_read_b64_tr_b16 v[74:75], v6 offset:37376
    v_mfma_f32_16x16x32_bf16 v[148:151], v[52:55], v[76:79], v[148:151]
    s_waitcnt lgkmcnt(6)
    v_mfma_f32_16x16x32_bf16 v[152:155], v[80:83], v[40:43], v[152:155]
    ds_read_b64_tr_b16 v[76:77], v7 offset:32768
    v_mfma_f32_16x16x32_bf16 v[156:159], v[80:83], v[44:47], v[156:159]
    v_mfma_f32_16x16x32_bf16 v[160:163], v[80:83], v[48:51], v[160:163]
    ds_read_b64_tr_b16 v[78:79], v7 offset:33280
    v_mfma_f32_16x16x32_bf16 v[164:167], v[80:83], v[52:55], v[164:167]
    s_waitcnt lgkmcnt(6)
    v_mfma_f32_16x16x32_bf16 v[168:171], v[64:67], v[40:43], v[168:171]
    ds_read_b64_tr_b16 v[80:81], v7 offset:36864
    v_mfma_f32_16x16x32_bf16 v[172:175], v[64:67], v[44:47], v[172:175]
    v_mfma_f32_16x16x32_bf16 v[176:179], v[64:67], v[48:51], v[176:179]
    ds_read_b64_tr_b16 v[82:83], v7 offset:37376
    v_mfma_f32_16x16x32_bf16 v[180:183], v[64:67], v[52:55], v[180:183]
    s_waitcnt lgkmcnt(6)
    v_mfma_f32_16x16x32_bf16 v[184:187], v[68:71], v[40:43], v[184:187]
    v_mfma_f32_16x16x32_bf16 v[188:191], v[68:71], v[44:47], v[188:191]
    v_mfma_f32_16x16x32_bf16 v[192:195], v[68:71], v[48:51], v[192:195]
    v_mfma_f32_16x16x32_bf16 v[196:199], v[68:71], v[52:55], v[196:199]
    s_waitcnt lgkmcnt(0)
    s_barrier
    v_mfma_f32_16x16x32_bf16 v[200:203], v[72:75], v[40:43], v[200:203]
    v_mfma_f32_16x16x32_bf16 v[204:207], v[72:75], v[44:47], v[204:207]
    v_mfma_f32_16x16x32_bf16 v[208:211], v[72:75], v[48:51], v[208:211]
    v_mfma_f32_16x16x32_bf16 v[212:215], v[72:75], v[52:55], v[212:215]
    v_mfma_f32_16x16x32_bf16 v[216:219], v[76:79], v[40:43], v[216:219]
    v_mfma_f32_16x16x32_bf16 v[220:223], v[76:79], v[44:47], v[220:223]
    v_mfma_f32_16x16x32_bf16 v[224:227], v[76:79], v[48:51], v[224:227]
    v_mfma_f32_16x16x32_bf16 v[228:231], v[76:79], v[52:55], v[228:231]
    v_mfma_f32_16x16x32_bf16 v[232:235], v[80:83], v[40:43], v[232:235]
    v_mfma_f32_16x16x32_bf16 v[236:239], v[80:83], v[44:47], v[236:239]
    v_mfma_f32_16x16x32_bf16 v[240:243], v[80:83], v[48:51], v[240:243]
    v_mfma_f32_16x16x32_bf16 v[244:247], v[80:83], v[52:55], v[244:247]
    s_setprio 0
    s_nop 7
    s_mul_i32 s84, s6, 3072
    s_add_u32 s84, s84, 153600
    v_lshl_add_u32 v6, v1, 3, s84
    v_cvt_pk_bf16_f32 v100, v100, v101
    v_cvt_pk_bf16_f32 v101, v102, v103
    v_cvt_pk_bf16_f32 v102, v116, v117
    v_cvt_pk_bf16_f32 v103, v118, v119
    v_cvt_pk_bf16_f32 v32, v132, v133
    v_cvt_pk_bf16_f32 v33, v134, v135
    v_cvt_pk_bf16_f32 v42, v148, v149
    v_cvt_pk_bf16_f32 v43, v150, v151
    v_cvt_pk_bf16_f32 v44, v248, v249
    v_cvt_pk_bf16_f32 v45, v250, v251
    v_cvt_pk_bf16_f32 v24, v252, v253
    v_cvt_pk_bf16_f32 v25, v254, v255
    s_cmp_lg_u32 s5, 0
    s_cbranch_scc1 L_hx1
    ds_write_b64 v6, v[100:101]
    ds_write_b64 v6, v[102:103] offset:512
    ds_write_b64 v6, v[32:33] offset:1024
    ds_write_b64 v6, v[42:43] offset:1536
    s_branch L_hx2
L_hx1:
    ds_write_b64 v6, v[44:45] offset:2048
    ds_write_b64 v6, v[24:25] offset:2560
L_hx2:
    v_lshrrev_b32 v16, 4, v1
    v_and_b32 v17, 1, v16
    v_lshrrev_b32 v16, 1, v16
    v_lshlrev_b32 v16, 8, v16
    v_lshl_add_u32 v16, v17, 10, v16
    v_and_b32 v17, 15, v1
    v_lshl_add_u32 v4, v17, 4, v16
    s_mul_i32 s84, s28, 112
    s_lshl1_add_u32 s85, s29, s6
    s_add_u32 s84, s84, s85
    s_add_u32 s84, s84, 80
    s_lshl_b32 s84, s84, 13
    s_lshl_b32 s86, s5, 12
    s_add_u32 s84, s84, s86
    s_add_u32 s84, s84, 0x400000
    s_lshl_b32 s87, s5, 9
    s_add_u32 s36, s84, s87
    s_xor_b32 s87, s87, 512
    s_add_u32 s37, s84, s87
    s_lshl_b32 s84, s28, 5
    s_add_u32 s84, s84, s85
    s_lshl_b32 s84, s84, 13
    s_add_u32 s84, s84, s86
    s_add_u32 s38, s84, 0x1200000
    s_mov_b32 s76, 0xbdd2d3e8
    v_mov_b32 v73, 0xc0135761
    s_waitcnt lgkmcnt(0)
    s_lshl2_add_u32 m0, s33, 65536
    s_nop 0
    buffer_load_dwordx4 v10, s[56:59], s82 offen offset:0 sc1 lds
    v_mul_f32 v80, v184, v184
    v_mul_f32 v81, v185, v185
    v_mul_f32 v82, v186, v186
    v_mul_f32 v83, v187, v187
    v_fma_f32 v80, v80, s76, v73
    v_fma_f32 v81, v81, s76, v73
    v_fma_f32 v82, v82, s76, v73
    v_fma_f32 v83, v83, s76, v73
    buffer_load_dwordx4 v10, s[56:59], s82 offen offset:1024 sc1 lds
    v_mul_f32 v80, v80, v184
    v_mul_f32 v81, v81, v185
    v_mul_f32 v82, v82, v186
    v_mul_f32 v83, v83, v187
    v_exp_f32 v80, v80
    v_mul_f32 v184, v184, v200
    v_exp_f32 v81, v81
    buffer_load_dwordx4 v10, s[56:59], s82 offen offset:2048 sc1 lds
    v_mul_f32 v185, v185, v201
    v_exp_f32 v82, v82
    v_mul_f32 v186, v186, v202
    v_exp_f32 v83, v83
    v_mul_f32 v187, v187, v203
    v_add_f32 v80, 1.0, v80
    buffer_load_dwordx4 v10, s[56:59], s82 offen offset:3072 sc1 lds
    s_add_u32 s82, s82, 16384
    v_add_f32 v81, 1.0, v81
    v_add_f32 v82, 1.0, v82
    v_add_f32 v83, 1.0, v83
    v_rcp_f32 v80, v80
    v_rcp_f32 v81, v81
    v_rcp_f32 v82, v82
    s_lshl1_add_u32 m0, s33, 81920
    s_nop 0
    buffer_load_dwordx4 v11, s[60:63], s83 offen lds
    v_rcp_f32 v83, v83
    s_nop 0
    v_mul_f32 v184, v184, v80
    v_mul_f32 v185, v185, v81
    v_mul_f32 v186, v186, v82
    v_mul_f32 v187, v187, v83
    v_cvt_pk_bf16_f32 v184, v184, v185
    v_cvt_pk_bf16_f32 v185, v186, v187
    s_lshl1_add_u32 m0, s33, 82944
    s_nop 0
    buffer_load_dwordx4 v12, s[60:63], s83 offen lds
    v_mul_f32 v80, v188, v188
    v_mul_f32 v81, v189, v189
    v_mul_f32 v82, v190, v190
    v_mul_f32 v83, v191, v191
    v_fma_f32 v80, v80, s76, v73
    v_fma_f32 v81, v81, s76, v73
    v_fma_f32 v82, v82, s76, v73
    v_fma_f32 v83, v83, s76, v73
    s_lshl1_add_u32 m0, s33, 90112
    s_nop 0
    buffer_load_dwordx4 v11, s[64:67], s83 offen lds
    v_mul_f32 v80, v80, v188
    v_mul_f32 v81, v81, v189
    v_mul_f32 v82, v82, v190
    v_mul_f32 v83, v83, v191
    v_exp_f32 v80, v80
    v_mul_f32 v188, v188, v204
    v_exp_f32 v81, v81
    s_lshl1_add_u32 m0, s33, 91136
    s_nop 0
    buffer_load_dwordx4 v12, s[64:67], s83 offen lds
    s_add_u32 s83, s83, 131072
    v_mul_f32 v189, v189, v205
    v_exp_f32 v82, v82
    v_mul_f32 v190, v190, v206
    v_exp_f32 v83, v83
    v_mul_f32 v191, v191, v207
    v_add_f32 v80, 1.0, v80
    s_barrier
    s_cmp_lg_u32 s5, 0
    s_cbranch_scc1 L_hx3
    ds_read_b64 v[46:47], v6 offset:2048
    ds_read_b64 v[34:35], v6 offset:2560
    s_branch L_hx4
L_hx3:
    ds_read_b64 v[44:45], v6 offset:512
    ds_read_b64 v[46:47], v6
    ds_read_b64 v[24:25], v6 offset:1536
    ds_read_b64 v[34:35], v6 offset:1024
L_hx4:
    s_lshl_b32 m0, s33, 2
    s_nop 0
    buffer_load_dwordx4 v10, s[56:59], s82 offen offset:0 sc1 lds
    v_add_f32 v81, 1.0, v81
    v_add_f32 v82, 1.0, v82
    v_add_f32 v83, 1.0, v83
    v_rcp_f32 v80, v80
    v_rcp_f32 v81, v81
    v_rcp_f32 v82, v82
    buffer_load_dwordx4 v10, s[56:59], s82 offen offset:1024 sc1 lds
    v_rcp_f32 v83, v83
    s_nop 0
    v_mul_f32 v188, v188, v80
    v_mul_f32 v189, v189, v81
    v_mul_f32 v190, v190, v82
    v_mul_f32 v191, v191, v83
    v_cvt_pk_bf16_f32 v186, v188, v189
    v_cvt_pk_bf16_f32 v187, v190, v191
    buffer_load_dwordx4 v10, s[56:59], s82 offen offset:2048 sc1 lds
    s_nop 1
    v_permlane16_swap_b32 v184, v186
    v_permlane16_swap_b32 v185, v187
    buffer_store_dwordx4 v[184:187], v4, s[68:71], s36 offen offset:0 sc1
    v_mul_f32 v80, v192, v192
    v_mul_f32 v81, v193, v193
    v_mul_f32 v82, v194, v194
    v_mul_f32 v83, v195, v195
    v_fma_f32 v80, v80, s76, v73
    v_fma_f32 v81, v81, s76, v73
    v_fma_f32 v82, v82, s76, v73
    v_fma_f32 v83, v83, s76, v73
    buffer_load_dwordx4 v10, s[56:59], s82 offen offset:3072 sc1 lds
    s_add_u32 s82, s82, 16384
    v_mul_f32 v80, v80, v192
    v_mul_f32 v81, v81, v193
    v_mul_f32 v82, v82, v194
    v_mul_f32 v83, v83, v195
    v_exp_f32 v80, v80
    v_mul_f32 v192, v192, v208
    v_exp_f32 v81, v81
    s_lshl1_add_u32 m0, s33, 16384
    s_nop 0
    buffer_load_dwordx4 v11, s[60:63], s83 offen lds
    v_mul_f32 v193, v193, v209
    v_exp_f32 v82, v82
    v_mul_f32 v194, v194, v210
    v_exp_f32 v83, v83
    v_mul_f32 v195, v195, v211
    v_add_f32 v80, 1.0, v80
    s_lshl1_add_u32 m0, s33, 17408
    s_nop 0
    buffer_load_dwordx4 v12, s[60:63], s83 offen lds
    v_add_f32 v81, 1.0, v81
    v_add_f32 v82, 1.0, v82
    v_add_f32 v83, 1.0, v83
    v_rcp_f32 v80, v80
    v_rcp_f32 v81, v81
    v_rcp_f32 v82, v82
    s_lshl1_add_u32 m0, s33, 24576
    s_nop 0
    buffer_load_dwordx4 v11, s[64:67], s83 offen lds
    v_rcp_f32 v83, v83
    s_nop 0
    v_mul_f32 v192, v192, v80
    v_mul_f32 v193, v193, v81
    v_mul_f32 v194, v194, v82
    v_mul_f32 v195, v195, v83
    v_cvt_pk_bf16_f32 v192, v192, v193
    v_cvt_pk_bf16_f32 v193, v194, v195
    s_lshl1_add_u32 m0, s33, 25600
    s_nop 0
    buffer_load_dwordx4 v12, s[64:67], s83 offen lds
    s_add_u32 s83, s83, 131072
    s_barrier
    s_waitcnt lgkmcnt(0)
    s_lshl2_add_u32 m0, s33, 98304
    s_nop 0
    buffer_load_dwordx4 v10, s[56:59], s82 offen offset:0 sc1 lds
    v_mul_f32 v80, v196, v196
    v_mul_f32 v81, v197, v197
    v_mul_f32 v82, v198, v198
    v_mul_f32 v83, v199, v199
    v_fma_f32 v80, v80, s76, v73
    v_fma_f32 v81, v81, s76, v73
    v_fma_f32 v82, v82, s76, v73
    v_fma_f32 v83, v83, s76, v73
    buffer_load_dwordx4 v10, s[56:59], s82 offen offset:1024 sc1 lds
    v_mul_f32 v80, v80, v196
    v_mul_f32 v81, v81, v197
    v_mul_f32 v82, v82, v198
    v_mul_f32 v83, v83, v199
    v_exp_f32 v80, v80
    v_mul_f32 v196, v196, v212
    v_exp_f32 v81, v81
    buffer_load_dwordx4 v10, s[56:59], s82 offen offset:2048 sc1 lds
    v_mul_f32 v197, v197, v213
    v_exp_f32 v82, v82
    v_mul_f32 v198, v198, v214
    v_exp_f32 v83, v83
    v_mul_f32 v199, v199, v215
    v_add_f32 v80, 1.0, v80
    buffer_load_dwordx4 v10, s[56:59], s82 offen offset:3072 sc1 lds
    s_add_u32 s82, s82, 16384
    v_add_f32 v81, 1.0, v81
    v_add_f32 v82, 1.0, v82
    v_add_f32 v83, 1.0, v83
    v_rcp_f32 v80, v80
    v_rcp_f32 v81, v81
    v_rcp_f32 v82, v82
    s_lshl1_add_u32 m0, s33, 114688
    s_nop 0
    buffer_load_dwordx4 v11, s[60:63], s83 offen lds
    v_rcp_f32 v83, v83
    s_nop 0
    v_mul_f32 v196, v196, v80
    v_mul_f32 v197, v197, v81
    v_mul_f32 v198, v198, v82
    v_mul_f32 v199, v199, v83
    v_cvt_pk_bf16_f32 v194, v196, v197
    v_cvt_pk_bf16_f32 v195, v198, v199
    s_lshl1_add_u32 m0, s33, 115712
    s_nop 0
    buffer_load_dwordx4 v12, s[60:63], s83 offen lds
    s_nop 1
    v_permlane16_swap_b32 v192, v194
    v_permlane16_swap_b32 v193, v195
    buffer_store_dwordx4 v[192:195], v4, s[68:71], s36 offen offset:2048 sc1
    v_mul_f32 v80, v216, v216
    v_mul_f32 v81, v217, v217
    v_mul_f32 v82, v218, v218
    v_mul_f32 v83, v219, v219
    v_fma_f32 v80, v80, s76, v73
    v_fma_f32 v81, v81, s76, v73
    v_fma_f32 v82, v82, s76, v73
    v_fma_f32 v83, v83, s76, v73
    s_lshl1_add_u32 m0, s33, 122880
    s_nop 0
    buffer_load_dwordx4 v11, s[64:67], s83 offen lds
    v_mul_f32 v80, v80, v216
    v_mul_f32 v81, v81, v217
    v_mul_f32 v82, v82, v218
    v_mul_f32 v83, v83, v219
    v_exp_f32 v80, v80
    v_mul_f32 v216, v216, v232
    v_exp_f32 v81, v81
    s_lshl1_add_u32 m0, s33, 123904
    s_nop 0
    buffer_load_dwordx4 v12, s[64:67], s83 offen lds
    s_add_u32 s83, s83, 131072
    v_mul_f32 v217, v217, v233
    v_exp_f32 v82, v82
    v_mul_f32 v218, v218, v234
    v_exp_f32 v83, v83
    v_mul_f32 v219, v219, v235
    v_add_f32 v80, 1.0, v80
    s_lshl2_add_u32 s91, s2, s4
    s_lshl_b32 s39, s91, 6
    s_lshr_b32 s92, s91, 5
    s_mul_i32 s92, s92, 7168
    s_and_b32 s91, s91, 31
    s_lshl_b32 s91, s91, 6
    s_add_u32 s92, s92, s91
    s_add_u32 s34, s92, 5120
    s_add_u32 s39, s39, 0x240000
    s_load_dword s94, s[20:21], s39 offset:0x0
    s_add_u32 s39, s39, 0x280000
    s_load_dword s94, s[20:21], s39 offset:0x0
    s_add_u32 s39, s39, 0xffd90000
    s_load_dword s94, s[20:21], s39 offset:0x0
    s_add_u32 s39, s39, 0x280000
    s_load_dword s94, s[20:21], s39 offset:0x0
    s_waitcnt vmcnt(18)
    s_barrier
    s_lshl2_add_u32 m0, s33, 32768
    s_nop 0
    buffer_load_dwordx4 v10, s[56:59], s82 offen offset:0 sc1 lds
    v_add_f32 v81, 1.0, v81
    v_add_f32 v82, 1.0, v82
    v_add_f32 v83, 1.0, v83
    v_rcp_f32 v80, v80
    v_rcp_f32 v81, v81
    v_rcp_f32 v82, v82
    buffer_load_dwordx4 v10, s[56:59], s82 offen offset:1024 sc1 lds
    v_rcp_f32 v83, v83
    s_nop 0
    v_mul_f32 v216, v216, v80
    v_mul_f32 v217, v217, v81
    v_mul_f32 v218, v218, v82
    v_mul_f32 v219, v219, v83
    v_cvt_pk_bf16_f32 v216, v216, v217
    v_cvt_pk_bf16_f32 v217, v218, v219
    buffer_load_dwordx4 v10, s[56:59], s82 offen offset:2048 sc1 lds
    v_mul_f32 v80, v220, v220
    v_mul_f32 v81, v221, v221
    v_mul_f32 v82, v222, v222
    v_mul_f32 v83, v223, v223
    v_fma_f32 v80, v80, s76, v73
    v_fma_f32 v81, v81, s76, v73
    v_fma_f32 v82, v82, s76, v73
    v_fma_f32 v83, v83, s76, v73
    buffer_load_dwordx4 v10, s[56:59], s82 offen offset:3072 sc1 lds
    s_add_u32 s82, s82, 16384
    v_mul_f32 v80, v80, v220
    v_mul_f32 v81, v81, v221
    v_mul_f32 v82, v82, v222
    v_mul_f32 v83, v83, v223
    v_exp_f32 v80, v80
    v_mul_f32 v220, v220, v236
    v_exp_f32 v81, v81
    s_lshl1_add_u32 m0, s33, 49152
    s_nop 0
    buffer_load_dwordx4 v11, s[60:63], s83 offen lds
    v_mul_f32 v221, v221, v237
    v_exp_f32 v82, v82
    v_mul_f32 v222, v222, v238
    v_exp_f32 v83, v83
    v_mul_f32 v223, v223, v239
    v_add_f32 v80, 1.0, v80
    s_lshl1_add_u32 m0, s33, 50176
    s_nop 0
    buffer_load_dwordx4 v12, s[60:63], s83 offen lds
    v_add_f32 v81, 1.0, v81
    v_add_f32 v82, 1.0, v82
    v_add_f32 v83, 1.0, v83
    v_rcp_f32 v80, v80
    v_rcp_f32 v81, v81
    v_rcp_f32 v82, v82
    s_lshl1_add_u32 m0, s33, 57344
    s_nop 0
    buffer_load_dwordx4 v11, s[64:67], s83 offen lds
    v_rcp_f32 v83, v83
    s_nop 0
    v_mul_f32 v220, v220, v80
    v_mul_f32 v221, v221, v81
    v_mul_f32 v222, v222, v82
    v_mul_f32 v223, v223, v83
    v_cvt_pk_bf16_f32 v218, v220, v221
    v_cvt_pk_bf16_f32 v219, v222, v223
    s_lshl1_add_u32 m0, s33, 58368
    s_nop 0
    buffer_load_dwordx4 v12, s[64:67], s83 offen lds
    s_add_u32 s83, s83, 131072
    s_nop 1
    v_permlane16_swap_b32 v216, v218
    v_permlane16_swap_b32 v217, v219
    buffer_store_dwordx4 v[216:219], v4, s[68:71], s37 offen offset:0 sc1
    s_add_u32 s39, s39, 0xffd90000
    s_load_dword s94, s[20:21], s39 offset:0x0
    s_add_u32 s39, s39, 0x280000
    s_load_dword s94, s[20:21], s39 offset:0x0
    s_add_u32 s39, s39, 0xffd90000
    s_load_dword s94, s[20:21], s39 offset:0x0
    s_add_u32 s39, s39, 0x280000
    s_load_dword s94, s[20:21], s39 offset:0x0
    s_waitcnt vmcnt(18)
    s_barrier
    s_lshl2_add_u32 m0, s33, 65536
    s_nop 0
    buffer_load_dwordx4 v10, s[56:59], s82 offen offset:0 sc1 lds
    v_mul_f32 v80, v224, v224
    v_mul_f32 v81, v225, v225
    v_mul_f32 v82, v226, v226
    v_mul_f32 v83, v227, v227
    v_fma_f32 v80, v80, s76, v73
    v_fma_f32 v81, v81, s76, v73
    v_fma_f32 v82, v82, s76, v73
    v_fma_f32 v83, v83, s76, v73
    buffer_load_dwordx4 v10, s[56:59], s82 offen offset:1024 sc1 lds
    v_mul_f32 v80, v80, v224
    v_mul_f32 v81, v81, v225
    v_mul_f32 v82, v82, v226
    v_mul_f32 v83, v83, v227
    v_exp_f32 v80, v80
    v_mul_f32 v224, v224, v240
    v_exp_f32 v81, v81
    buffer_load_dwordx4 v10, s[56:59], s82 offen offset:2048 sc1 lds
    v_mul_f32 v225, v225, v241
    v_exp_f32 v82, v82
    v_mul_f32 v226, v226, v242
    v_exp_f32 v83, v83
    v_mul_f32 v227, v227, v243
    v_add_f32 v80, 1.0, v80
    buffer_load_dwordx4 v10, s[56:59], s82 offen offset:3072 sc1 lds
    s_add_u32 s82, s82, 16384
    v_add_f32 v81, 1.0, v81
    v_add_f32 v82, 1.0, v82
    v_add_f32 v83, 1.0, v83
    v_rcp_f32 v80, v80
    v_rcp_f32 v81, v81
    v_rcp_f32 v82, v82
    s_lshl1_add_u32 m0, s33, 81920
    s_nop 0
    buffer_load_dwordx4 v11, s[60:63], s83 offen lds
    v_rcp_f32 v83, v83
    s_nop 0
    v_mul_f32 v224, v224, v80
    v_mul_f32 v225, v225, v81
    v_mul_f32 v226, v226, v82
    v_mul_f32 v227, v227, v83
    v_cvt_pk_bf16_f32 v224, v224, v225
    v_cvt_pk_bf16_f32 v225, v226, v227
    s_lshl1_add_u32 m0, s33, 82944
    s_nop 0
    buffer_load_dwordx4 v12, s[60:63], s83 offen lds
    v_mul_f32 v80, v228, v228
    v_mul_f32 v81, v229, v229
    v_mul_f32 v82, v230, v230
    v_mul_f32 v83, v231, v231
    v_fma_f32 v80, v80, s76, v73
    v_fma_f32 v81, v81, s76, v73
    v_fma_f32 v82, v82, s76, v73
    v_fma_f32 v83, v83, s76, v73
    s_lshl1_add_u32 m0, s33, 90112
    s_nop 0
    buffer_load_dwordx4 v11, s[64:67], s83 offen lds
    v_mul_f32 v80, v80, v228
    v_mul_f32 v81, v81, v229
    v_mul_f32 v82, v82, v230
    v_mul_f32 v83, v83, v231
    v_exp_f32 v80, v80
    v_mul_f32 v228, v228, v244
    v_exp_f32 v81, v81
    s_lshl1_add_u32 m0, s33, 91136
    s_nop 0
    buffer_load_dwordx4 v12, s[64:67], s83 offen lds
    s_add_u32 s83, s83, 131072
    v_mul_f32 v229, v229, v245
    v_exp_f32 v82, v82
    v_mul_f32 v230, v230, v246
    v_exp_f32 v83, v83
    v_mul_f32 v231, v231, v247
    v_add_f32 v80, 1.0, v80
    s_load_dword s94, s[20:21], s39 offset:0x10000
    s_add_u32 s39, s39, 0x110000
    s_load_dword s94, s[20:21], s39 offset:0x0
    s_add_u32 s39, s39, 0xfff10000
    s_load_dword s94, s[20:21], s39 offset:0x0
    s_add_u32 s39, s39, 0x100000
    s_load_dword s94, s[20:21], s39 offset:0x0
    s_waitcnt vmcnt(17)
    s_barrier
    s_lshl_b32 m0, s33, 2
    s_nop 0
    buffer_load_dwordx4 v10, s[56:59], s82 offen offset:0 sc1 lds
    v_add_f32 v81, 1.0, v81
    v_add_f32 v82, 1.0, v82
    v_add_f32 v83, 1.0, v83
    v_rcp_f32 v80, v80
    v_rcp_f32 v81, v81
    v_rcp_f32 v82, v82
    buffer_load_dwordx4 v10, s[56:59], s82 offen offset:1024 sc1 lds
    v_rcp_f32 v83, v83
    s_nop 0
    v_mul_f32 v228, v228, v80
    v_mul_f32 v229, v229, v81
    v_mul_f32 v230, v230, v82
    v_mul_f32 v231, v231, v83
    v_cvt_pk_bf16_f32 v226, v228, v229
    v_cvt_pk_bf16_f32 v227, v230, v231
    buffer_load_dwordx4 v10, s[56:59], s82 offen offset:2048 sc1 lds
    s_nop 1
    v_permlane16_swap_b32 v224, v226
    v_permlane16_swap_b32 v225, v227
    buffer_store_dwordx4 v[224:227], v4, s[68:71], s37 offen offset:2048 sc1
    v_lshrrev_b32 v60, 4, v1
    v_and_b32 v61, 15, v1
    v_and_b32 v62, 1, v60
    v_xor_b32 v62, s5, v62
    v_lshrrev_b32 v63, 1, v60
    v_lshl_add_u32 v62, v62, 1, v63
    v_lshlrev_b32 v62, 8, v62
    v_lshl_add_u32 v5, v61, 4, v62
    v_lshlrev_b32 v60, 2, v60
    v_sub_u32 v60, v61, v60
    v_add_u32 v61, 16, v60
    v_and_b32 v61, 0xfffffff1, v61
    v_cmp_eq_u32 s[40:41], 0, v61
    v_add_u32 v61, 15, v60
    v_and_b32 v61, 0xfffffff1, v61
    v_cmp_eq_u32 s[42:43], 0, v61
    v_add_u32 v61, 14, v60
    v_and_b32 v61, 0xfffffff1, v61
    v_cmp_eq_u32 s[44:45], 0, v61
    v_add_u32 v61, 13, v60
    v_and_b32 v61, 0xfffffff1, v61
    v_cmp_eq_u32 s[46:47], 0, v61
    v_add_u32 v61, 0, v60
    v_and_b32 v61, 0xfffffff1, v61
    v_cmp_eq_u32 s[48:49], 0, v61
    v_add_u32 v61, -1, v60
    v_and_b32 v61, 0xfffffff1, v61
    v_cmp_eq_u32 s[50:51], 0, v61
    v_add_u32 v61, -2, v60
    v_and_b32 v61, 0xfffffff1, v61
    v_cmp_eq_u32 s[52:53], 0, v61
    v_add_u32 v61, -3, v60
    v_and_b32 v61, 0xfffffff1, v61
    v_cmp_eq_u32 s[54:55], 0, v61
    s_or_b32 s80, s28, s5
    s_cmp_eq_u32 s80, 0
    s_cselect_b64 s[80:81], 0, -1
    v_mov_b32 v72, 0xce6e6b28
    s_mov_b32 s77, 0x3e3504f3
    s_mov_b32 s78, 0x3fb8aa3b
    buffer_load_dwordx4 v10, s[56:59], s82 offen offset:3072 sc1 lds
    s_add_u32 s82, s82, 16384
    s_lshl1_add_u32 m0, s33, 16384
    s_nop 0
    buffer_load_dwordx4 v11, s[60:63], s83 offen lds
    s_lshl1_add_u32 m0, s33, 17408
    s_nop 0
    buffer_load_dwordx4 v12, s[60:63], s83 offen lds
    s_lshl1_add_u32 m0, s33, 24576
    s_nop 0
    buffer_load_dwordx4 v11, s[64:67], s83 offen lds
    s_lshl1_add_u32 m0, s33, 25600
    s_nop 0
    buffer_load_dwordx4 v12, s[64:67], s83 offen lds
    s_add_u32 s83, s83, 131072
    v_cvt_pk_bf16_f32 v88, v88, v89
    v_cvt_pk_bf16_f32 v89, v90, v91
    v_cvt_pk_bf16_f32 v90, v104, v105
    v_cvt_pk_bf16_f32 v91, v106, v107
    v_cvt_pk_bf16_f32 v26, v120, v121
    v_cvt_pk_bf16_f32 v27, v122, v123
    v_cvt_pk_bf16_f32 v36, v136, v137
    v_cvt_pk_bf16_f32 v37, v138, v139
    s_add_u32 s39, s39, 0xfff10000
    s_load_dword s94, s[20:21], s39 offset:0x0
    s_add_u32 s39, s39, 0x100000
    s_load_dword s94, s[20:21], s39 offset:0x0
    s_add_u32 s39, s39, 0xfff10000
    s_load_dword s94, s[20:21], s39 offset:0x0
    s_add_u32 s39, s39, 0x100000
    s_load_dword s94, s[20:21], s39 offset:0x0
    s_waitcnt vmcnt(18)
    s_barrier
    s_lshl2_add_u32 m0, s33, 98304
    s_nop 0
    buffer_load_dwordx4 v10, s[56:59], s82 offen offset:0 sc1 lds
    v_cvt_pk_bf16_f32 v152, v152, v153
    v_cvt_pk_bf16_f32 v153, v154, v155
    v_cvt_pk_bf16_f32 v154, v168, v169
    v_cvt_pk_bf16_f32 v155, v170, v171
    s_nop 1
    v_mfma_f32_16x16x32_bf16 v[48:51], v[44:47], v[152:155], 0
    buffer_load_dwordx4 v10, s[56:59], s82 offen offset:1024 sc1 lds
    v_mfma_f32_16x16x32_bf16 v[52:55], v[88:91], v[152:155], 0
    s_nop 7
    v_cvt_pk_bf16_f32 v56, v48, v49
    buffer_load_dwordx4 v10, s[56:59], s82 offen offset:2048 sc1 lds
    v_cvt_pk_bf16_f32 v57, v50, v51
    v_lshlrev_b32 v48, 16, v56
    v_and_b32 v49, 0xffff0000, v56
    v_lshlrev_b32 v50, 16, v57
    v_and_b32 v51, 0xffff0000, v57
    v_cvt_pk_bf16_f32 v56, v52, v53
    v_cvt_pk_bf16_f32 v57, v54, v55
    v_lshlrev_b32 v52, 16, v56
    buffer_load_dwordx4 v10, s[56:59], s82 offen offset:3072 sc1 lds
    s_add_u32 s82, s82, 16384
    v_and_b32 v53, 0xffff0000, v56
    v_lshlrev_b32 v54, 16, v57
    v_and_b32 v55, 0xffff0000, v57
    v_mul_f32 v48, s77, v48
    v_mul_f32 v49, s77, v49
    v_mul_f32 v50, s77, v50
    v_mul_f32 v51, s77, v51
    v_mul_f32 v52, s77, v52
    s_lshl1_add_u32 m0, s33, 114688
    s_nop 0
    buffer_load_dwordx4 v11, s[60:63], s83 offen lds
    v_mul_f32 v53, s77, v53
    v_mul_f32 v54, s77, v54
    v_mul_f32 v55, s77, v55
    v_cvt_pk_bf16_f32 v56, v48, v49
    v_cvt_pk_bf16_f32 v57, v50, v51
    v_lshlrev_b32 v48, 16, v56
    v_and_b32 v49, 0xffff0000, v56
    v_lshlrev_b32 v50, 16, v57
    s_lshl1_add_u32 m0, s33, 115712
    s_nop 0
    buffer_load_dwordx4 v12, s[60:63], s83 offen lds
    v_and_b32 v51, 0xffff0000, v57
    v_cvt_pk_bf16_f32 v56, v52, v53
    v_cvt_pk_bf16_f32 v57, v54, v55
    v_lshlrev_b32 v52, 16, v56
    v_and_b32 v53, 0xffff0000, v56
    v_lshlrev_b32 v54, 16, v57
    v_and_b32 v55, 0xffff0000, v57
    s_and_b64 vcc, s[40:41], s[80:81]
    v_cndmask_b32 v48, v72, v48, vcc
    s_lshl1_add_u32 m0, s33, 122880
    s_nop 0
    buffer_load_dwordx4 v11, s[64:67], s83 offen lds
    s_and_b64 vcc, s[42:43], s[80:81]
    v_cndmask_b32 v49, v72, v49, vcc
    s_and_b64 vcc, s[44:45], s[80:81]
    v_cndmask_b32 v50, v72, v50, vcc
    s_and_b64 vcc, s[46:47], s[80:81]
    v_cndmask_b32 v51, v72, v51, vcc
    v_cndmask_b32 v52, v72, v52, s[48:49]
    v_cndmask_b32 v53, v72, v53, s[50:51]
    v_cndmask_b32 v54, v72, v54, s[52:53]
    v_cndmask_b32 v55, v72, v55, s[54:55]
    v_max3_f32 v60, v48, v49, v50
    s_lshl1_add_u32 m0, s33, 123904
    s_nop 0
    buffer_load_dwordx4 v12, s[64:67], s83 offen lds
    s_add_u32 s83, s83, 131072
    v_max3_f32 v60, v60, v51, v52
    v_max3_f32 v60, v60, v53, v54
    v_max_f32 v60, v60, v55
    v_mov_b32 v61, v60
    s_nop 1
    v_permlane16_swap_b32 v60, v61
    v_max_f32 v60, v60, v61
    v_mov_b32 v61, v60
    s_add_u32 s39, s39, 0xfff10000
    s_load_dword s94, s[20:21], s39 offset:0x0
    s_add_u32 s39, s39, 0x100000
    s_load_dword s94, s[20:21], s39 offset:0x0
    s_add_u32 s39, s39, 0xfff10000
    s_load_dword s94, s[20:21], s39 offset:0x0
    s_add_u32 s39, s39, 0x100000
    s_load_dword s94, s[20:21], s39 offset:0x0
    s_waitcnt vmcnt(17)
    s_barrier
    s_lshl2_add_u32 m0, s33, 32768
    s_nop 0
    buffer_load_dwordx4 v10, s[56:59], s82 offen offset:0 sc1 lds
    s_nop 1
    v_permlane32_swap_b32 v60, v61
    v_max_f32 v60, v60, v61
    v_sub_f32 v48, v48, v60
    v_sub_f32 v49, v49, v60
    v_sub_f32 v50, v50, v60
    v_sub_f32 v51, v51, v60
    v_sub_f32 v52, v52, v60
    buffer_load_dwordx4 v10, s[56:59], s82 offen offset:1024 sc1 lds
    v_sub_f32 v53, v53, v60
    v_sub_f32 v54, v54, v60
    v_sub_f32 v55, v55, v60
    v_mul_f32 v48, s78, v48
    v_mul_f32 v49, s78, v49
    v_mul_f32 v50, s78, v50
    v_mul_f32 v51, s78, v51
    v_mul_f32 v52, s78, v52
    buffer_load_dwordx4 v10, s[56:59], s82 offen offset:2048 sc1 lds
    v_mul_f32 v53, s78, v53
    v_mul_f32 v54, s78, v54
    v_mul_f32 v55, s78, v55
    v_exp_f32 v48, v48
    v_exp_f32 v49, v49
    v_exp_f32 v50, v50
    buffer_load_dwordx4 v10, s[56:59], s82 offen offset:3072 sc1 lds
    s_add_u32 s82, s82, 16384
    v_exp_f32 v51, v51
    v_exp_f32 v52, v52
    v_exp_f32 v53, v53
    v_exp_f32 v54, v54
    s_lshl1_add_u32 m0, s33, 49152
    s_nop 0
    buffer_load_dwordx4 v11, s[60:63], s83 offen lds
    v_exp_f32 v55, v55
    s_nop 0
    v_add_f32 v60, v48, v49
    v_add_f32 v60, v60, v50
    v_add_f32 v60, v60, v51
    v_add_f32 v60, v60, v52
    v_add_f32 v60, v60, v53
    v_add_f32 v60, v60, v54
    s_lshl1_add_u32 m0, s33, 50176
    s_nop 0
    buffer_load_dwordx4 v12, s[60:63], s83 offen lds
    v_add_f32 v60, v60, v55
    v_mov_b32 v61, v60
    s_nop 1
    v_permlane16_swap_b32 v60, v61
    v_add_f32 v60, v60, v61
    v_mov_b32 v61, v60
    s_nop 1
    v_permlane32_swap_b32 v60, v61
    s_lshl1_add_u32 m0, s33, 57344
    s_nop 0
    buffer_load_dwordx4 v11, s[64:67], s83 offen lds
    v_add_f32 v60, v60, v61
    v_rcp_f32 v60, v60
    s_nop 0
    v_mul_f32 v48, v48, v60
    v_mul_f32 v49, v49, v60
    v_mul_f32 v50, v50, v60
    v_mul_f32 v51, v51, v60
    v_mul_f32 v52, v52, v60
    s_lshl1_add_u32 m0, s33, 58368
    s_nop 0
    buffer_load_dwordx4 v12, s[64:67], s83 offen lds
    s_add_u32 s83, s83, 131072
    v_mul_f32 v53, v53, v60
    v_mul_f32 v54, v54, v60
    v_mul_f32 v55, v55, v60
    v_cvt_pk_bf16_f32 v56, v48, v49
    v_cvt_pk_bf16_f32 v57, v50, v51
    v_cvt_pk_bf16_f32 v58, v52, v53
    v_cvt_pk_bf16_f32 v59, v54, v55
    s_nop 1
    v_mfma_f32_16x16x32_bf16 v[48:51], v[24:27], v[56:59], 0
    s_add_u32 s39, s39, 0xfff10000
    s_load_dword s94, s[20:21], s39 offset:0x0
    s_add_u32 s39, s39, 0x100000
    s_load_dword s94, s[20:21], s39 offset:0x0
    s_add_u32 s39, s39, 0xfff10000
    s_load_dword s94, s[20:21], s39 offset:0x0
    s_add_u32 s39, s39, 0x100000
    s_load_dword s94, s[20:21], s39 offset:0x0
    s_waitcnt vmcnt(16)
    s_barrier
    s_lshl2_add_u32 m0, s33, 65536
    s_nop 0
    buffer_load_dwordx4 v10, s[56:59], s82 offen offset:0 sc1 lds
    v_mfma_f32_16x16x32_bf16 v[52:55], v[34:37], v[56:59], 0
    s_nop 7
    v_cvt_pk_bf16_f32 v64, v48, v49
    buffer_load_dwordx4 v10, s[56:59], s82 offen offset:1024 sc1 lds
    v_cvt_pk_bf16_f32 v65, v50, v51
    v_cvt_pk_bf16_f32 v66, v52, v53
    v_cvt_pk_bf16_f32 v67, v54, v55
    s_nop 1
    v_permlane16_swap_b32 v64, v66
    v_permlane16_swap_b32 v65, v67
    buffer_store_dwordx4 v[64:67], v5, s[68:71], s38 offen offset:0 sc1
    buffer_load_dwordx4 v10, s[56:59], s82 offen offset:2048 sc1 lds
    v_cvt_pk_bf16_f32 v92, v92, v93
    v_cvt_pk_bf16_f32 v93, v94, v95
    v_cvt_pk_bf16_f32 v94, v108, v109
    v_cvt_pk_bf16_f32 v95, v110, v111
    v_cvt_pk_bf16_f32 v28, v124, v125
    v_cvt_pk_bf16_f32 v29, v126, v127
    v_cvt_pk_bf16_f32 v38, v140, v141
    v_cvt_pk_bf16_f32 v39, v142, v143
    buffer_load_dwordx4 v10, s[56:59], s82 offen offset:3072 sc1 lds
    s_add_u32 s82, s82, 16384
    v_cvt_pk_bf16_f32 v156, v156, v157
    v_cvt_pk_bf16_f32 v157, v158, v159
    v_cvt_pk_bf16_f32 v158, v172, v173
    v_cvt_pk_bf16_f32 v159, v174, v175
    s_nop 1
    v_mfma_f32_16x16x32_bf16 v[48:51], v[88:91], v[156:159], 0
    s_lshl1_add_u32 m0, s33, 81920
    s_nop 0
    buffer_load_dwordx4 v11, s[60:63], s83 offen lds
    v_mfma_f32_16x16x32_bf16 v[52:55], v[92:95], v[156:159], 0
    s_nop 7
    v_cvt_pk_bf16_f32 v56, v48, v49
    s_lshl1_add_u32 m0, s33, 82944
    s_nop 0
    buffer_load_dwordx4 v12, s[60:63], s83 offen lds
    v_cvt_pk_bf16_f32 v57, v50, v51
    v_lshlrev_b32 v48, 16, v56
    v_and_b32 v49, 0xffff0000, v56
    v_lshlrev_b32 v50, 16, v57
    v_and_b32 v51, 0xffff0000, v57
    v_cvt_pk_bf16_f32 v56, v52, v53
    v_cvt_pk_bf16_f32 v57, v54, v55
    v_lshlrev_b32 v52, 16, v56
    s_lshl1_add_u32 m0, s33, 90112
    s_nop 0
    buffer_load_dwordx4 v11, s[64:67], s83 offen lds
    v_and_b32 v53, 0xffff0000, v56
    v_lshlrev_b32 v54, 16, v57
    v_and_b32 v55, 0xffff0000, v57
    v_mul_f32 v48, s77, v48
    v_mul_f32 v49, s77, v49
    v_mul_f32 v50, s77, v50
    v_mul_f32 v51, s77, v51
    v_mul_f32 v52, s77, v52
    s_lshl1_add_u32 m0, s33, 91136
    s_nop 0
    buffer_load_dwordx4 v12, s[64:67], s83 offen lds
    s_add_u32 s83, s83, 131072
    v_mul_f32 v53, s77, v53
    v_mul_f32 v54, s77, v54
    v_mul_f32 v55, s77, v55
    v_cvt_pk_bf16_f32 v56, v48, v49
    v_cvt_pk_bf16_f32 v57, v50, v51
    v_lshlrev_b32 v48, 16, v56
    v_and_b32 v49, 0xffff0000, v56
    v_lshlrev_b32 v50, 16, v57
    s_add_u32 s39, s39, 0xfff10000
    s_load_dword s94, s[20:21], s39 offset:0x0
    s_add_u32 s39, s39, 0x100000
    s_load_dword s94, s[20:21], s39 offset:0x0
    s_add_u32 s39, s39, 0xfff10000
    s_load_dword s94, s[20:21], s39 offset:0x0
    s_add_u32 s39, s39, 0x100000
    s_load_dword s94, s[20:21], s39 offset:0x0
    s_waitcnt vmcnt(17)
    s_barrier
    s_lshl_b32 m0, s33, 2
    s_nop 0
    buffer_load_dwordx4 v10, s[56:59], s82 offen offset:0 sc1 lds
    v_and_b32 v51, 0xffff0000, v57
    v_cvt_pk_bf16_f32 v56, v52, v53
    v_cvt_pk_bf16_f32 v57, v54, v55
    v_lshlrev_b32 v52, 16, v56
    v_and_b32 v53, 0xffff0000, v56
    v_lshlrev_b32 v54, 16, v57
    v_and_b32 v55, 0xffff0000, v57
    v_cndmask_b32 v48, v72, v48, s[40:41]
    buffer_load_dwordx4 v10, s[56:59], s82 offen offset:1024 sc1 lds
    v_cndmask_b32 v49, v72, v49, s[42:43]
    v_cndmask_b32 v50, v72, v50, s[44:45]
    v_cndmask_b32 v51, v72, v51, s[46:47]
    v_cndmask_b32 v52, v72, v52, s[48:49]
    v_cndmask_b32 v53, v72, v53, s[50:51]
    v_cndmask_b32 v54, v72, v54, s[52:53]
    v_cndmask_b32 v55, v72, v55, s[54:55]
    v_max3_f32 v60, v48, v49, v50
    buffer_load_dwordx4 v10, s[56:59], s82 offen offset:2048 sc1 lds
    v_max3_f32 v60, v60, v51, v52
    v_max3_f32 v60, v60, v53, v54
    v_max_f32 v60, v60, v55
    v_mov_b32 v61, v60
    s_nop 1
    v_permlane16_swap_b32 v60, v61
    v_max_f32 v60, v60, v61
    v_mov_b32 v61, v60
    buffer_load_dwordx4 v10, s[56:59], s82 offen offset:3072 sc1 lds
    s_add_u32 s82, s82, 16384
    s_nop 1
    v_permlane32_swap_b32 v60, v61
    v_max_f32 v60, v60, v61
    v_sub_f32 v48, v48, v60
    v_sub_f32 v49, v49, v60
    v_sub_f32 v50, v50, v60
    v_sub_f32 v51, v51, v60
    v_sub_f32 v52, v52, v60
    s_lshl1_add_u32 m0, s33, 16384
    s_nop 0
    buffer_load_dwordx4 v11, s[60:63], s83 offen lds
    v_sub_f32 v53, v53, v60
    v_sub_f32 v54, v54, v60
    v_sub_f32 v55, v55, v60
    v_mul_f32 v48, s78, v48
    v_mul_f32 v49, s78, v49
    v_mul_f32 v50, s78, v50
    v_mul_f32 v51, s78, v51
    v_mul_f32 v52, s78, v52
    s_lshl1_add_u32 m0, s33, 17408
    s_nop 0
    buffer_load_dwordx4 v12, s[60:63], s83 offen lds
    v_mul_f32 v53, s78, v53
    v_mul_f32 v54, s78, v54
    v_mul_f32 v55, s78, v55
    v_exp_f32 v48, v48
    v_exp_f32 v49, v49
    v_exp_f32 v50, v50
    s_lshl1_add_u32 m0, s33, 24576
    s_nop 0
    buffer_load_dwordx4 v11, s[64:67], s83 offen lds
    v_exp_f32 v51, v51
    v_exp_f32 v52, v52
    v_exp_f32 v53, v53
    v_exp_f32 v54, v54
    s_lshl1_add_u32 m0, s33, 25600
    s_nop 0
    buffer_load_dwordx4 v12, s[64:67], s83 offen lds
    s_add_u32 s83, s83, 131072
    v_exp_f32 v55, v55
    s_nop 0
    v_add_f32 v60, v48, v49
    v_add_f32 v60, v60, v50
    v_add_f32 v60, v60, v51
    v_add_f32 v60, v60, v52
    v_add_f32 v60, v60, v53
    v_add_f32 v60, v60, v54
    s_add_u32 s39, s39, 0xfff10000
    s_load_dword s94, s[20:21], s39 offset:0x0
    s_add_u32 s39, s39, 0x100000
    s_load_dword s94, s[20:21], s39 offset:0x0
    s_add_u32 s39, s39, 0xfff10000
    s_load_dword s94, s[20:21], s39 offset:0x0
    s_add_u32 s39, s39, 0x100000
    s_load_dword s94, s[20:21], s39 offset:0x0
    s_waitcnt vmcnt(38)
    s_waitcnt vmcnt(17)
    s_barrier
    s_lshl2_add_u32 m0, s33, 98304
    s_nop 0
    buffer_load_dwordx4 v10, s[56:59], s82 offen offset:0 sc1 lds
    v_add_f32 v60, v60, v55
    v_mov_b32 v61, v60
    s_nop 1
    v_permlane16_swap_b32 v60, v61
    v_add_f32 v60, v60, v61
    v_mov_b32 v61, v60
    s_nop 1
    v_permlane32_swap_b32 v60, v61
    buffer_load_dwordx4 v10, s[56:59], s82 offen offset:1024 sc1 lds
    v_add_f32 v60, v60, v61
    v_rcp_f32 v60, v60
    s_nop 0
    v_mul_f32 v48, v48, v60
    v_mul_f32 v49, v49, v60
    v_mul_f32 v50, v50, v60
    v_mul_f32 v51, v51, v60
    v_mul_f32 v52, v52, v60
    buffer_load_dwordx4 v10, s[56:59], s82 offen offset:2048 sc1 lds
    v_mul_f32 v53, v53, v60
    v_mul_f32 v54, v54, v60
    v_mul_f32 v55, v55, v60
    v_cvt_pk_bf16_f32 v56, v48, v49
    v_cvt_pk_bf16_f32 v57, v50, v51
    v_cvt_pk_bf16_f32 v58, v52, v53
    v_cvt_pk_bf16_f32 v59, v54, v55
    s_nop 1
    v_mfma_f32_16x16x32_bf16 v[48:51], v[26:29], v[56:59], 0
    buffer_load_dwordx4 v10, s[56:59], s82 offen offset:3072 sc1 lds
    s_add_u32 s82, s82, 16384
    v_mfma_f32_16x16x32_bf16 v[52:55], v[36:39], v[56:59], 0
    s_nop 7
    v_cvt_pk_bf16_f32 v68, v48, v49
    s_lshl1_add_u32 m0, s33, 114688
    s_nop 0
    buffer_load_dwordx4 v11, s[60:63], s83 offen lds
    v_cvt_pk_bf16_f32 v69, v50, v51
    v_cvt_pk_bf16_f32 v70, v52, v53
    v_cvt_pk_bf16_f32 v71, v54, v55
    s_nop 1
    v_permlane16_swap_b32 v68, v70
    v_permlane16_swap_b32 v69, v71
    s_lshl1_add_u32 m0, s33, 115712
    s_nop 0
    buffer_load_dwordx4 v12, s[60:63], s83 offen lds
    buffer_store_dwordx4 v[68:71], v5, s[68:71], s38 offen offset:1024 sc1
    v_cvt_pk_bf16_f32 v96, v96, v97
    v_cvt_pk_bf16_f32 v97, v98, v99
    v_cvt_pk_bf16_f32 v98, v112, v113
    v_cvt_pk_bf16_f32 v99, v114, v115
    v_cvt_pk_bf16_f32 v30, v128, v129
    v_cvt_pk_bf16_f32 v31, v130, v131
    v_cvt_pk_bf16_f32 v40, v144, v145
    v_cvt_pk_bf16_f32 v41, v146, v147
    s_lshl1_add_u32 m0, s33, 122880
    s_nop 0
    buffer_load_dwordx4 v11, s[64:67], s83 offen lds
    v_cvt_pk_bf16_f32 v160, v160, v161
    v_cvt_pk_bf16_f32 v161, v162, v163
    v_cvt_pk_bf16_f32 v162, v176, v177
    v_cvt_pk_bf16_f32 v163, v178, v179
    s_nop 1
    v_mfma_f32_16x16x32_bf16 v[48:51], v[92:95], v[160:163], 0
    s_lshl1_add_u32 m0, s33, 123904
    s_nop 0
    buffer_load_dwordx4 v12, s[64:67], s83 offen lds
    s_add_u32 s83, s83, 131072
    v_mfma_f32_16x16x32_bf16 v[52:55], v[96:99], v[160:163], 0
    s_nop 7
    v_cvt_pk_bf16_f32 v56, v48, v49
    s_add_u32 s39, s39, 0xfff10000
    s_load_dword s94, s[20:21], s39 offset:0x0
    s_add_u32 s39, s39, 0x100000
    s_load_dword s94, s[20:21], s39 offset:0x0
    s_add_u32 s39, s39, 0xfff10000
    s_load_dword s94, s[20:21], s39 offset:0x0
    s_add_u32 s39, s39, 0x100000
    s_load_dword s94, s[20:21], s39 offset:0x0
    s_cmp_lg_u32 s4, 0
    s_cbranch_scc1 L_fH2
    s_lshl_b32 s91, s28, 4
    s_add_u32 s91, s91, s29
    s_lshl_b32 s91, s91, 7
    s_add_u32 s91, s91, 0x1e90000
    v_mov_b32 v16, s91
    v_mov_b32 v18, s100
    v_mov_b32 v19, s101
    s_mov_b64 exec, 1
    global_store_dwordx2 v16, v[18:19], s[26:27] sc1
    s_mov_b64 exec, -1
L_fH2:
    s_waitcnt vmcnt(17)
    s_barrier
    s_lshl2_add_u32 m0, s33, 32768
    s_nop 0
    buffer_load_dwordx4 v10, s[56:59], s82 offen offset:0 sc1 lds
    v_cvt_pk_bf16_f32 v57, v50, v51
    v_lshlrev_b32 v48, 16, v56
    v_and_b32 v49, 0xffff0000, v56
    v_lshlrev_b32 v50, 16, v57
    v_and_b32 v51, 0xffff0000, v57
    v_cvt_pk_bf16_f32 v56, v52, v53
    v_cvt_pk_bf16_f32 v57, v54, v55
    v_lshlrev_b32 v52, 16, v56
    buffer_load_dwordx4 v10, s[56:59], s82 offen offset:1024 sc1 lds
    v_and_b32 v53, 0xffff0000, v56
    v_lshlrev_b32 v54, 16, v57
    v_and_b32 v55, 0xffff0000, v57
    v_mul_f32 v48, s77, v48
    v_mul_f32 v49, s77, v49
    v_mul_f32 v50, s77, v50
    v_mul_f32 v51, s77, v51
    v_mul_f32 v52, s77, v52
    buffer_load_dwordx4 v10, s[56:59], s82 offen offset:2048 sc1 lds
    v_mul_f32 v53, s77, v53
    v_mul_f32 v54, s77, v54
    v_mul_f32 v55, s77, v55
    v_cvt_pk_bf16_f32 v56, v48, v49
    v_cvt_pk_bf16_f32 v57, v50, v51
    v_lshlrev_b32 v48, 16, v56
    v_and_b32 v49, 0xffff0000, v56
    v_lshlrev_b32 v50, 16, v57
    buffer_load_dwordx4 v10, s[56:59], s82 offen offset:3072 sc1 lds
    s_add_u32 s82, s82, 16384
    v_and_b32 v51, 0xffff0000, v57
    v_cvt_pk_bf16_f32 v56, v52, v53
    v_cvt_pk_bf16_f32 v57, v54, v55
    v_lshlrev_b32 v52, 16, v56
    v_and_b32 v53, 0xffff0000, v56
    v_lshlrev_b32 v54, 16, v57
    v_and_b32 v55, 0xffff0000, v57
    v_cndmask_b32 v48, v72, v48, s[40:41]
    s_lshl1_add_u32 m0, s33, 49152
    s_nop 0
    buffer_load_dwordx4 v11, s[60:63], s83 offen lds
    v_cndmask_b32 v49, v72, v49, s[42:43]
    v_cndmask_b32 v50, v72, v50, s[44:45]
    v_cndmask_b32 v51, v72, v51, s[46:47]
    v_cndmask_b32 v52, v72, v52, s[48:49]
    v_cndmask_b32 v53, v72, v53, s[50:51]
    v_cndmask_b32 v54, v72, v54, s[52:53]
    v_cndmask_b32 v55, v72, v55, s[54:55]
    v_max3_f32 v60, v48, v49, v50
    s_lshl1_add_u32 m0, s33, 50176
    s_nop 0
    buffer_load_dwordx4 v12, s[60:63], s83 offen lds
    v_max3_f32 v60, v60, v51, v52
    v_max3_f32 v60, v60, v53, v54
    v_max_f32 v60, v60, v55
    v_mov_b32 v61, v60
    s_nop 1
    v_permlane16_swap_b32 v60, v61
    v_max_f32 v60, v60, v61
    v_mov_b32 v61, v60
    s_lshl1_add_u32 m0, s33, 57344
    s_nop 0
    buffer_load_dwordx4 v11, s[64:67], s83 offen lds
    s_nop 1
    v_permlane32_swap_b32 v60, v61
    v_max_f32 v60, v60, v61
    v_sub_f32 v48, v48, v60
    v_sub_f32 v49, v49, v60
    v_sub_f32 v50, v50, v60
    v_sub_f32 v51, v51, v60
    v_sub_f32 v52, v52, v60
    s_lshl1_add_u32 m0, s33, 58368
    s_nop 0
    buffer_load_dwordx4 v12, s[64:67], s83 offen lds
    s_add_u32 s83, s83, 131072
    v_sub_f32 v53, v53, v60
    v_sub_f32 v54, v54, v60
    v_sub_f32 v55, v55, v60
    v_mul_f32 v48, s78, v48
    v_mul_f32 v49, s78, v49
    v_mul_f32 v50, s78, v50
    v_mul_f32 v51, s78, v51
    v_mul_f32 v52, s78, v52
    s_add_u32 s39, s39, 0xfff10000
    s_load_dword s94, s[20:21], s39 offset:0x0
    s_add_u32 s39, s39, 0x100000
    s_load_dword s94, s[20:21], s39 offset:0x0
    s_add_u32 s39, s39, 0xfff10000
    s_load_dword s94, s[20:21], s39 offset:0x0
    s_add_u32 s39, s39, 0x100000
    s_load_dword s94, s[20:21], s39 offset:0x0
    s_waitcnt vmcnt(17)
    s_barrier
    s_lshl2_add_u32 m0, s33, 65536
    s_nop 0
    buffer_load_dwordx4 v10, s[56:59], s82 offen offset:0 sc1 lds
    v_mul_f32 v53, s78, v53
    v_mul_f32 v54, s78, v54
    v_mul_f32 v55, s78, v55
    v_exp_f32 v48, v48
    v_exp_f32 v49, v49
    v_exp_f32 v50, v50
    buffer_load_dwordx4 v10, s[56:59], s82 offen offset:1024 sc1 lds
    v_exp_f32 v51, v51
    v_exp_f32 v52, v52
    v_exp_f32 v53, v53
    v_exp_f32 v54, v54
    buffer_load_dwordx4 v10, s[56:59], s82 offen offset:2048 sc1 lds
    v_exp_f32 v55, v55
    s_nop 0
    v_add_f32 v60, v48, v49
    v_add_f32 v60, v60, v50
    v_add_f32 v60, v60, v51
    v_add_f32 v60, v60, v52
    v_add_f32 v60, v60, v53
    v_add_f32 v60, v60, v54
    buffer_load_dwordx4 v10, s[56:59], s82 offen offset:3072 sc1 lds
    s_add_u32 s82, s82, 16384
    v_add_f32 v60, v60, v55
    v_mov_b32 v61, v60
    s_nop 1
    v_permlane16_swap_b32 v60, v61
    v_add_f32 v60, v60, v61
    v_mov_b32 v61, v60
    s_nop 1
    v_permlane32_swap_b32 v60, v61
    s_lshl1_add_u32 m0, s33, 81920
    s_nop 0
    buffer_load_dwordx4 v11, s[60:63], s83 offen lds
    v_add_f32 v60, v60, v61
    v_rcp_f32 v60, v60
    s_nop 0
    v_mul_f32 v48, v48, v60
    v_mul_f32 v49, v49, v60
    v_mul_f32 v50, v50, v60
    v_mul_f32 v51, v51, v60
    v_mul_f32 v52, v52, v60
    s_lshl1_add_u32 m0, s33, 82944
    s_nop 0
    buffer_load_dwordx4 v12, s[60:63], s83 offen lds
    v_mul_f32 v53, v53, v60
    v_mul_f32 v54, v54, v60
    v_mul_f32 v55, v55, v60
    v_cvt_pk_bf16_f32 v56, v48, v49
    v_cvt_pk_bf16_f32 v57, v50, v51
    v_cvt_pk_bf16_f32 v58, v52, v53
    v_cvt_pk_bf16_f32 v59, v54, v55
    s_nop 1
    v_mfma_f32_16x16x32_bf16 v[48:51], v[28:31], v[56:59], 0
    s_lshl1_add_u32 m0, s33, 90112
    s_nop 0
    buffer_load_dwordx4 v11, s[64:67], s83 offen lds
    v_mfma_f32_16x16x32_bf16 v[52:55], v[38:41], v[56:59], 0
    s_nop 7
    v_cvt_pk_bf16_f32 v64, v48, v49
    s_lshl1_add_u32 m0, s33, 91136
    s_nop 0
    buffer_load_dwordx4 v12, s[64:67], s83 offen lds
    s_add_u32 s83, s83, 131072
    v_cvt_pk_bf16_f32 v65, v50, v51
    v_cvt_pk_bf16_f32 v66, v52, v53
    v_cvt_pk_bf16_f32 v67, v54, v55
    s_nop 1
    v_permlane16_swap_b32 v64, v66
    v_permlane16_swap_b32 v65, v67
    s_add_u32 s39, s39, 0xff910000
    s_load_dword s94, s[12:13], s39 offset:0x0
    s_load_dword s94, s[12:13], s39 offset:0x10000
    s_load_dword s94, s[12:13], s39 offset:0x20000
    s_load_dword s94, s[12:13], s39 offset:0x30000
    s_waitcnt vmcnt(16)
    s_barrier
    s_lshl_b32 m0, s33, 2
    s_nop 0
    buffer_load_dwordx4 v10, s[56:59], s82 offen offset:0 sc1 lds
    buffer_store_dwordx4 v[64:67], v5, s[68:71], s38 offen offset:2048 sc1
    v_cvt_pk_bf16_f32 v164, v164, v165
    v_cvt_pk_bf16_f32 v165, v166, v167
    v_cvt_pk_bf16_f32 v166, v180, v181
    v_cvt_pk_bf16_f32 v167, v182, v183
    s_nop 1
    v_mfma_f32_16x16x32_bf16 v[48:51], v[96:99], v[164:167], 0
    buffer_load_dwordx4 v10, s[56:59], s82 offen offset:1024 sc1 lds
    v_mfma_f32_16x16x32_bf16 v[52:55], v[100:103], v[164:167], 0
    s_nop 7
    v_cvt_pk_bf16_f32 v56, v48, v49
    buffer_load_dwordx4 v10, s[56:59], s82 offen offset:2048 sc1 lds
    v_cvt_pk_bf16_f32 v57, v50, v51
    v_lshlrev_b32 v48, 16, v56
    v_and_b32 v49, 0xffff0000, v56
    v_lshlrev_b32 v50, 16, v57
    v_and_b32 v51, 0xffff0000, v57
    v_cvt_pk_bf16_f32 v56, v52, v53
    v_cvt_pk_bf16_f32 v57, v54, v55
    v_lshlrev_b32 v52, 16, v56
    buffer_load_dwordx4 v10, s[56:59], s82 offen offset:3072 sc1 lds
    s_add_u32 s82, s82, 16384
    v_and_b32 v53, 0xffff0000, v56
    v_lshlrev_b32 v54, 16, v57
    v_and_b32 v55, 0xffff0000, v57
    v_mul_f32 v48, s77, v48
    v_mul_f32 v49, s77, v49
    v_mul_f32 v50, s77, v50
    v_mul_f32 v51, s77, v51
    v_mul_f32 v52, s77, v52
    s_lshl1_add_u32 m0, s33, 16384
    s_nop 0
    buffer_load_dwordx4 v11, s[60:63], s83 offen lds
    v_mul_f32 v53, s77, v53
    v_mul_f32 v54, s77, v54
    v_mul_f32 v55, s77, v55
    v_cvt_pk_bf16_f32 v56, v48, v49
    v_cvt_pk_bf16_f32 v57, v50, v51
    v_lshlrev_b32 v48, 16, v56
    v_and_b32 v49, 0xffff0000, v56
    v_lshlrev_b32 v50, 16, v57
    s_lshl1_add_u32 m0, s33, 17408
    s_nop 0
    buffer_load_dwordx4 v12, s[60:63], s83 offen lds
    v_and_b32 v51, 0xffff0000, v57
    v_cvt_pk_bf16_f32 v56, v52, v53
    v_cvt_pk_bf16_f32 v57, v54, v55
    v_lshlrev_b32 v52, 16, v56
    v_and_b32 v53, 0xffff0000, v56
    v_lshlrev_b32 v54, 16, v57
    v_and_b32 v55, 0xffff0000, v57
    v_cndmask_b32 v48, v72, v48, s[40:41]
    s_lshl1_add_u32 m0, s33, 24576
    s_nop 0
    buffer_load_dwordx4 v11, s[64:67], s83 offen lds
    v_cndmask_b32 v49, v72, v49, s[42:43]
    v_cndmask_b32 v50, v72, v50, s[44:45]
    v_cndmask_b32 v51, v72, v51, s[46:47]
    v_cndmask_b32 v52, v72, v52, s[48:49]
    v_cndmask_b32 v53, v72, v53, s[50:51]
    v_cndmask_b32 v54, v72, v54, s[52:53]
    v_cndmask_b32 v55, v72, v55, s[54:55]
    v_max3_f32 v60, v48, v49, v50
    s_lshl1_add_u32 m0, s33, 25600
    s_nop 0
    buffer_load_dwordx4 v12, s[64:67], s83 offen lds
    s_add_u32 s83, s83, 131072
    v_max3_f32 v60, v60, v51, v52
    v_max3_f32 v60, v60, v53, v54
    v_max_f32 v60, v60, v55
    v_mov_b32 v61, v60
    s_nop 1
    v_permlane16_swap_b32 v60, v61
    v_max_f32 v60, v60, v61
    v_mov_b32 v61, v60
    s_load_dword s94, s[12:13], s39 offset:0x40000
    s_load_dword s94, s[12:13], s39 offset:0x50000
    s_load_dword s94, s[12:13], s39 offset:0x60000
    s_load_dword s94, s[12:13], s39 offset:0x70000
    s_waitcnt vmcnt(17)
    s_barrier
    s_lshl2_add_u32 m0, s33, 98304
    s_nop 0
    buffer_load_dwordx4 v10, s[56:59], s82 offen offset:0 sc1 lds
    s_nop 1
    v_permlane32_swap_b32 v60, v61
    v_max_f32 v60, v60, v61
    v_sub_f32 v48, v48, v60
    v_sub_f32 v49, v49, v60
    v_sub_f32 v50, v50, v60
    v_sub_f32 v51, v51, v60
    v_sub_f32 v52, v52, v60
    buffer_load_dwordx4 v10, s[56:59], s82 offen offset:1024 sc1 lds
    v_sub_f32 v53, v53, v60
    v_sub_f32 v54, v54, v60
    v_sub_f32 v55, v55, v60
    v_mul_f32 v48, s78, v48
    v_mul_f32 v49, s78, v49
    v_mul_f32 v50, s78, v50
    v_mul_f32 v51, s78, v51
    v_mul_f32 v52, s78, v52
    buffer_load_dwordx4 v10, s[56:59], s82 offen offset:2048 sc1 lds
    v_mul_f32 v53, s78, v53
    v_mul_f32 v54, s78, v54
    v_mul_f32 v55, s78, v55
    v_exp_f32 v48, v48
    v_exp_f32 v49, v49
    v_exp_f32 v50, v50
    buffer_load_dwordx4 v10, s[56:59], s82 offen offset:3072 sc1 lds
    s_add_u32 s82, s82, 16384
    v_exp_f32 v51, v51
    v_exp_f32 v52, v52
    v_exp_f32 v53, v53
    v_exp_f32 v54, v54
    s_lshl1_add_u32 m0, s33, 114688
    s_nop 0
    buffer_load_dwordx4 v11, s[60:63], s83 offen lds
    v_exp_f32 v55, v55
    s_nop 0
    v_add_f32 v60, v48, v49
    v_add_f32 v60, v60, v50
    v_add_f32 v60, v60, v51
    v_add_f32 v60, v60, v52
    v_add_f32 v60, v60, v53
    v_add_f32 v60, v60, v54
    s_lshl1_add_u32 m0, s33, 115712
    s_nop 0
    buffer_load_dwordx4 v12, s[60:63], s83 offen lds
    v_add_f32 v60, v60, v55
    v_mov_b32 v61, v60
    s_nop 1
    v_permlane16_swap_b32 v60, v61
    v_add_f32 v60, v60, v61
    v_mov_b32 v61, v60
    s_nop 1
    v_permlane32_swap_b32 v60, v61
    s_lshl1_add_u32 m0, s33, 122880
    s_nop 0
    buffer_load_dwordx4 v11, s[64:67], s83 offen lds
    v_add_f32 v60, v60, v61
    v_rcp_f32 v60, v60
    s_nop 0
    v_mul_f32 v48, v48, v60
    v_mul_f32 v49, v49, v60
    v_mul_f32 v50, v50, v60
    v_mul_f32 v51, v51, v60
    v_mul_f32 v52, v52, v60
    s_lshl1_add_u32 m0, s33, 123904
    s_nop 0
    buffer_load_dwordx4 v12, s[64:67], s83 offen lds
    s_add_u32 s83, s83, 131072
    v_mul_f32 v53, v53, v60
    v_mul_f32 v54, v54, v60
    v_mul_f32 v55, v55, v60
    v_cvt_pk_bf16_f32 v56, v48, v49
    v_cvt_pk_bf16_f32 v57, v50, v51
    v_cvt_pk_bf16_f32 v58, v52, v53
    v_cvt_pk_bf16_f32 v59, v54, v55
    s_nop 1
    v_mfma_f32_16x16x32_bf16 v[48:51], v[30:33], v[56:59], 0
    s_load_dword s94, s[12:13], s39 offset:0x80000
    s_load_dword s94, s[12:13], s39 offset:0x90000
    s_load_dword s94, s[12:13], s39 offset:0xa0000
    s_load_dword s94, s[12:13], s39 offset:0xb0000
    v_and_b32 v20, 15, v1
    s_lshl_b32 s91, s30, 11
    s_add_u32 s91, s91, 0x1e90000
    v_lshl_add_u32 v20, v20, 7, s91
    global_load_dwordx2 v[22:23], v20, s[26:27] sc1
    s_waitcnt vmcnt(18)
    s_barrier
    s_lshl2_add_u32 m0, s33, 32768
    s_nop 0
    buffer_load_dwordx4 v10, s[56:59], s82 offen offset:0 sc1 lds
    v_mfma_f32_16x16x32_bf16 v[52:55], v[40:43], v[56:59], 0
    s_nop 7
    v_cvt_pk_bf16_f32 v68, v48, v49
    buffer_load_dwordx4 v10, s[56:59], s82 offen offset:1024 sc1 lds
    v_cvt_pk_bf16_f32 v69, v50, v51
    v_cvt_pk_bf16_f32 v70, v52, v53
    v_cvt_pk_bf16_f32 v71, v54, v55
    s_nop 1
    v_permlane16_swap_b32 v68, v70
    v_permlane16_swap_b32 v69, v71
    buffer_store_dwordx4 v[68:71], v5, s[68:71], s38 offen offset:3072 sc1
    buffer_load_dwordx4 v10, s[56:59], s82 offen offset:2048 sc1 lds
    v_lshrrev_b32 v64, 4, v1
    v_bfe_u32 v65, v1, 2, 2
    v_and_b32 v66, 3, v1
    v_and_b32 v67, 15, v1
    v_lshrrev_b32 v68, 3, v1
    v_and_b32 v69, 7, v1
    s_lshl_b32 s85, s6, 2
    v_lshl_add_u32 v70, v64, 3, v65
    v_lshlrev_b32 v70, 7, v70
    buffer_load_dwordx4 v10, s[56:59], s82 offen offset:3072 sc1 lds
    s_add_u32 s82, s82, 16384
    v_and_b32 v71, 1, v66
    v_lshl_add_u32 v70, v71, 3, v70
    v_add_u32 v70, 0, v70
    v_and_b32 v71, 2, v65
    v_and_b32 v72, 1, v64
    v_lshl_add_u32 v71, v72, 2, v71
    v_lshrrev_b32 v72, 1, v66
    v_xor_b32 v71, v71, v72
    s_lshl1_add_u32 m0, s33, 49152
    s_nop 0
    buffer_load_dwordx4 v11, s[60:63], s83 offen lds
    v_xor_b32 v71, s85, v71
    v_xor_b32 v72, 0, v71
    v_lshl_add_u32 v6, v72, 4, v70
    v_add_u32 v8, 65536, v6
    v_xor_b32 v72, 2, v71
    v_lshl_add_u32 v7, v72, 4, v70
    v_add_u32 v9, 65536, v7
    s_lshl_b32 s85, s5, 12
    v_lshl_add_u32 v4, v1, 4, s85
    s_lshl1_add_u32 m0, s33, 50176
    s_nop 0
    buffer_load_dwordx4 v12, s[60:63], s83 offen lds
    v_add_u32 v5, 65536, v4
    v_mov_b32 v88, 0
    v_mov_b32 v89, 0
    v_mov_b32 v90, 0
    v_mov_b32 v91, 0
    v_mov_b32 v92, 0
    v_mov_b32 v93, 0
    v_mov_b32 v94, 0
    s_lshl1_add_u32 m0, s33, 57344
    s_nop 0
    buffer_load_dwordx4 v11, s[64:67], s83 offen lds
    v_mov_b32 v95, 0
    v_mov_b32 v96, 0
    v_mov_b32 v97, 0
    v_mov_b32 v98, 0
    v_mov_b32 v99, 0
    v_mov_b32 v100, 0
    v_mov_b32 v101, 0
    v_mov_b32 v102, 0
    s_lshl1_add_u32 m0, s33, 58368
    s_nop 0
    buffer_load_dwordx4 v12, s[64:67], s83 offen lds
    s_add_u32 s83, s83, 131072
    v_mov_b32 v103, 0
    v_mov_b32 v104, 0
    v_mov_b32 v105, 0
    v_mov_b32 v106, 0
    v_mov_b32 v107, 0
    v_mov_b32 v108, 0
    v_mov_b32 v109, 0
    v_mov_b32 v110, 0
    s_load_dword s94, s[12:13], s39 offset:0xc0000
    s_load_dword s94, s[12:13], s39 offset:0xd0000
    s_load_dword s94, s[12:13], s39 offset:0xe0000
    s_load_dword s94, s[12:13], s39 offset:0xf0000
    s_waitcnt vmcnt(18)
    s_barrier
    s_lshl2_add_u32 m0, s33, 65536
    s_nop 0
    buffer_load_dwordx4 v10, s[56:59], s82 offen offset:0 sc1 lds
    v_mov_b32 v111, 0
    v_mov_b32 v112, 0
    v_mov_b32 v113, 0
    v_mov_b32 v114, 0
    v_mov_b32 v115, 0
    v_mov_b32 v116, 0
    v_mov_b32 v117, 0
    v_mov_b32 v118, 0
    buffer_load_dwordx4 v10, s[56:59], s82 offen offset:1024 sc1 lds
    v_mov_b32 v119, 0
    s_lshl_b32 s84, s30, 7
    s_lshl_b32 s85, s5, 6
    s_add_u32 s84, s84, s85
    s_lshl_b32 s84, s84, 11
    s_lshl_b32 s85, s31, 8
    s_add_u32 s84, s84, s85
    s_lshl_b32 s85, s32, 7
    s_add_u32 s84, s84, s85
    s_lshl_b32 s85, s6, 6
    s_add_u32 s84, s84, s85
    v_and_b32 v70, 1, v64
    v_lshlrev_b32 v70, 5, v70
    v_lshrrev_b32 v71, 1, v64
    v_lshl_add_u32 v70, v71, 4, v70
    v_lshl_add_u32 v70, v67, 11, v70
    buffer_load_dwordx4 v10, s[56:59], s82 offen offset:2048 sc1 lds
    v_add_u32 v13, s84, v70
    s_mov_b32 s72, s8
    s_mov_b32 s73, s9
    s_mov_b32 s74, 0x400000
    s_mov_b32 s75, 0x20000
    buffer_load_dwordx4 v10, s[56:59], s82 offen offset:3072 sc1 lds
    s_add_u32 s82, s82, 16384
    s_lshl1_add_u32 m0, s33, 81920
    s_nop 0
    buffer_load_dwordx4 v11, s[60:63], s83 offen lds
    s_lshl1_add_u32 m0, s33, 82944
    s_nop 0
    buffer_load_dwordx4 v12, s[60:63], s83 offen lds
    s_lshl1_add_u32 m0, s33, 90112
    s_nop 0
    buffer_load_dwordx4 v11, s[64:67], s83 offen lds
    s_lshl1_add_u32 m0, s33, 91136
    s_nop 0
    buffer_load_dwordx4 v12, s[64:67], s83 offen lds
    s_add_u32 s83, s83, 131072
    s_add_u32 s39, s39, 0x100000
    s_load_dword s94, s[12:13], s39 offset:0x0
    s_load_dword s94, s[12:13], s39 offset:0x10000
    s_load_dword s94, s[12:13], s39 offset:0x20000
    s_load_dword s94, s[12:13], s39 offset:0x30000
    s_waitcnt vmcnt(17)
    s_movk_i32 s98, 0x4000
L_pH2_chk:
    v_cmp_ne_u64 vcc, s[100:101], v[22:23]
    s_nop 1
    s_cmp_eq_u64 vcc, 0
    s_cbranch_scc1 L_pH2_ok
    s_sub_u32 s98, s98, 1
    s_cbranch_scc1 L_pH2_ok
    s_sleep 1
    global_load_dwordx2 v[22:23], v20, s[26:27] sc1
    s_waitcnt vmcnt(0)
    s_branch L_pH2_chk
L_pH2_ok:
    s_waitcnt vmcnt(18)
    s_barrier
    s_add_u32 s82, s82, s14
    s_add_u32 s83, s83, s35
    s_lshl_b32 m0, s33, 2
    s_nop 0
    buffer_load_dwordx4 v10, s[56:59], s82 offen offset:0 sc1 lds
    buffer_load_dwordx4 v10, s[56:59], s82 offen offset:1024 sc1 lds
    buffer_load_dwordx4 v10, s[56:59], s82 offen offset:2048 sc1 lds
    buffer_load_dwordx4 v10, s[56:59], s82 offen offset:3072 sc1 lds
    s_add_u32 s82, s82, 16384
    s_lshl1_add_u32 m0, s33, 16384
    s_nop 0
    buffer_load_dwordx4 v11, s[60:63], s83 offen lds
    s_lshl1_add_u32 m0, s33, 17408
    s_nop 0
    buffer_load_dwordx4 v12, s[60:63], s83 offen lds
    s_lshl1_add_u32 m0, s33, 24576
    s_nop 0
    buffer_load_dwordx4 v11, s[64:67], s83 offen lds
    s_lshl1_add_u32 m0, s33, 25600
    s_nop 0
    buffer_load_dwordx4 v12, s[64:67], s83 offen lds
    s_add_u32 s83, s83, 131072
    s_load_dword s94, s[12:13], s39 offset:0x40000
    s_load_dword s94, s[12:13], s39 offset:0x50000
    s_load_dword s94, s[12:13], s39 offset:0x60000
    s_load_dword s94, s[12:13], s39 offset:0x70000
    s_waitcnt vmcnt(16)
    s_barrier
    s_lshl2_add_u32 m0, s33, 98304
    s_nop 0
    buffer_load_dwordx4 v10, s[56:59], s82 offen offset:0 sc1 lds
    buffer_load_dwordx4 v10, s[56:59], s82 offen offset:1024 sc1 lds
    buffer_load_dwordx4 v10, s[56:59], s82 offen offset:2048 sc1 lds
    buffer_load_dwordx4 v10, s[56:59], s82 offen offset:3072 sc1 lds
    s_add_u32 s82, s82, 16384
    s_lshl1_add_u32 m0, s33, 114688
    s_nop 0
    buffer_load_dwordx4 v11, s[60:63], s83 offen lds
    s_lshl1_add_u32 m0, s33, 115712
    s_nop 0
    buffer_load_dwordx4 v12, s[60:63], s83 offen lds
    s_lshl1_add_u32 m0, s33, 122880
    s_nop 0
    buffer_load_dwordx4 v11, s[64:67], s83 offen lds
    s_lshl1_add_u32 m0, s33, 123904
    s_nop 0
    buffer_load_dwordx4 v12, s[64:67], s83 offen lds
    s_add_u32 s83, s83, 131072
    s_load_dword s94, s[12:13], s39 offset:0x80000
    s_load_dword s94, s[12:13], s39 offset:0x90000
    s_load_dword s94, s[12:13], s39 offset:0xa0000
    s_load_dword s94, s[12:13], s39 offset:0xb0000
    s_waitcnt vmcnt(30)
    s_waitcnt vmcnt(16)
    s_barrier
    s_lshl2_add_u32 m0, s33, 32768
    s_nop 0
    buffer_load_dwordx4 v10, s[56:59], s82 offen offset:0 sc1 lds
    buffer_load_dwordx4 v10, s[56:59], s82 offen offset:1024 sc1 lds
    buffer_load_dwordx4 v10, s[56:59], s82 offen offset:2048 sc1 lds
    buffer_load_dwordx4 v10, s[56:59], s82 offen offset:3072 sc1 lds
    s_add_u32 s82, s82, 16384
    s_lshl1_add_u32 m0, s33, 49152
    s_nop 0
    buffer_load_dwordx4 v11, s[60:63], s83 offen lds
    s_lshl1_add_u32 m0, s33, 50176
    s_nop 0
    buffer_load_dwordx4 v12, s[60:63], s83 offen lds
    s_lshl1_add_u32 m0, s33, 57344
    s_nop 0
    buffer_load_dwordx4 v11, s[64:67], s83 offen lds
    s_lshl1_add_u32 m0, s33, 58368
    s_nop 0
    buffer_load_dwordx4 v12, s[64:67], s83 offen lds
    s_add_u32 s83, s83, 131072
    s_load_dword s94, s[12:13], s39 offset:0xc0000
    s_load_dword s94, s[12:13], s39 offset:0xd0000
    s_load_dword s94, s[12:13], s39 offset:0xe0000
    s_load_dword s94, s[12:13], s39 offset:0xf0000
    s_cmp_lg_u32 s4, 0
    s_cbranch_scc1 L_fO
    s_lshl_b32 s91, s28, 4
    s_add_u32 s91, s91, s29
    s_lshl_b32 s91, s91, 7
    s_add_u32 s91, s91, 0x1e98000
    v_mov_b32 v16, s91
    v_mov_b32 v18, s100
    v_mov_b32 v19, s101
    s_mov_b64 exec, 1
    global_store_dwordx2 v16, v[18:19], s[26:27] sc1
    s_mov_b64 exec, -1
L_fO:
    s_waitcnt vmcnt(16)
    s_barrier
    s_lshl2_add_u32 m0, s33, 65536
    s_nop 0
    buffer_load_dwordx4 v10, s[56:59], s82 offen offset:0 sc1 lds
    s_mov_b32 s84, 0
    buffer_load_dwordx4 v[120:123], v13, s[72:75], s84 offen
    buffer_load_dwordx4 v10, s[56:59], s82 offen offset:1024 sc1 lds
    buffer_load_dwordx4 v10, s[56:59], s82 offen offset:2048 sc1 lds
    buffer_load_dwordx4 v10, s[56:59], s82 offen offset:3072 sc1 lds
    s_add_u32 s82, s82, 16384
    s_lshl1_add_u32 m0, s33, 81920
    s_nop 0
    buffer_load_dwordx4 v11, s[60:63], s83 offen lds
    s_lshl1_add_u32 m0, s33, 82944
    s_nop 0
    buffer_load_dwordx4 v12, s[60:63], s83 offen lds
    s_lshl1_add_u32 m0, s33, 90112
    s_nop 0
    buffer_load_dwordx4 v11, s[64:67], s83 offen lds
    s_lshl1_add_u32 m0, s33, 91136
    s_nop 0
    buffer_load_dwordx4 v12, s[64:67], s83 offen lds
    s_add_u32 s83, s83, 131072
    s_waitcnt vmcnt(17)
    s_barrier
    s_lshl_b32 m0, s33, 2
    s_nop 0
    buffer_load_dwordx4 v10, s[56:59], s82 offen offset:0 sc1 lds
    s_mov_b32 s84, 32768
    buffer_load_dwordx4 v[124:127], v13, s[72:75], s84 offen
    buffer_load_dwordx4 v10, s[56:59], s82 offen offset:1024 sc1 lds
    buffer_load_dwordx4 v10, s[56:59], s82 offen offset:2048 sc1 lds
    buffer_load_dwordx4 v10, s[56:59], s82 offen offset:3072 sc1 lds
    s_add_u32 s82, s82, 16384
    s_lshl1_add_u32 m0, s33, 16384
    s_nop 0
    buffer_load_dwordx4 v11, s[60:63], s83 offen lds
    s_lshl1_add_u32 m0, s33, 17408
    s_nop 0
    buffer_load_dwordx4 v12, s[60:63], s83 offen lds
    s_lshl1_add_u32 m0, s33, 24576
    s_nop 0
    buffer_load_dwordx4 v11, s[64:67], s83 offen lds
    s_lshl1_add_u32 m0, s33, 25600
    s_nop 0
    buffer_load_dwordx4 v12, s[64:67], s83 offen lds
    s_add_u32 s83, s83, 131072
    s_waitcnt vmcnt(18)
    s_barrier
    s_lshl2_add_u32 m0, s33, 98304
    s_nop 0
    buffer_load_dwordx4 v10, s[56:59], s82 offen offset:0 sc1 lds
    s_mov_b32 s84, 65536
    buffer_load_dwordx4 v[128:131], v13, s[72:75], s84 offen
    buffer_load_dwordx4 v10, s[56:59], s82 offen offset:1024 sc1 lds
    buffer_load_dwordx4 v10, s[56:59], s82 offen offset:2048 sc1 lds
    buffer_load_dwordx4 v10, s[56:59], s82 offen offset:3072 sc1 lds
    s_add_u32 s82, s82, 16384
    s_lshl1_add_u32 m0, s33, 114688
    s_nop 0
    buffer_load_dwordx4 v11, s[60:63], s83 offen lds
    s_lshl1_add_u32 m0, s33, 115712
    s_nop 0
    buffer_load_dwordx4 v12, s[60:63], s83 offen lds
    s_lshl1_add_u32 m0, s33, 122880
    s_nop 0
    buffer_load_dwordx4 v11, s[64:67], s83 offen lds
    s_lshl1_add_u32 m0, s33, 123904
    s_nop 0
    buffer_load_dwordx4 v12, s[64:67], s83 offen lds
    s_add_u32 s83, s83, 131072
    v_and_b32 v20, 15, v1
    s_lshl_b32 s91, s30, 11
    s_add_u32 s91, s91, 0x1e98000
    v_lshl_add_u32 v20, v20, 7, s91
    global_load_dwordx2 v[22:23], v20, s[26:27] sc1
    s_waitcnt vmcnt(19)
    s_barrier
    s_lshl2_add_u32 m0, s33, 32768
    s_nop 0
    buffer_load_dwordx4 v10, s[56:59], s82 offen offset:0 sc1 lds
    s_mov_b32 s84, 98304
    buffer_load_dwordx4 v[132:135], v13, s[72:75], s84 offen
    buffer_load_dwordx4 v10, s[56:59], s82 offen offset:1024 sc1 lds
    buffer_load_dwordx4 v10, s[56:59], s82 offen offset:2048 sc1 lds
    buffer_load_dwordx4 v10, s[56:59], s82 offen offset:3072 sc1 lds
    s_add_u32 s82, s82, 16384
    s_lshl1_add_u32 m0, s33, 49152
    s_nop 0
    buffer_load_dwordx4 v11, s[60:63], s83 offen lds
    s_lshl1_add_u32 m0, s33, 50176
    s_nop 0
    buffer_load_dwordx4 v12, s[60:63], s83 offen lds
    s_lshl1_add_u32 m0, s33, 57344
    s_nop 0
    buffer_load_dwordx4 v11, s[64:67], s83 offen lds
    s_lshl1_add_u32 m0, s33, 58368
    s_nop 0
    buffer_load_dwordx4 v12, s[64:67], s83 offen lds
    s_add_u32 s83, s83, 131072
    s_waitcnt vmcnt(19)
    s_barrier
    s_lshl2_add_u32 m0, s33, 65536
    s_nop 0
    buffer_load_dwordx4 v10, s[56:59], s82 offen offset:0 sc1 lds
    buffer_load_dwordx4 v10, s[56:59], s82 offen offset:1024 sc1 lds
    buffer_load_dwordx4 v10, s[56:59], s82 offen offset:2048 sc1 lds
    buffer_load_dwordx4 v10, s[56:59], s82 offen offset:3072 sc1 lds
    s_add_u32 s82, s82, 16384
    s_lshl1_add_u32 m0, s33, 81920
    s_nop 0
    buffer_load_dwordx4 v11, s[60:63], s83 offen lds
    s_lshl1_add_u32 m0, s33, 82944
    s_nop 0
    buffer_load_dwordx4 v12, s[60:63], s83 offen lds
    s_lshl1_add_u32 m0, s33, 90112
    s_nop 0
    buffer_load_dwordx4 v11, s[64:67], s83 offen lds
    s_lshl1_add_u32 m0, s33, 91136
    s_nop 0
    buffer_load_dwordx4 v12, s[64:67], s83 offen lds
    s_add_u32 s83, s83, 131072
    s_waitcnt vmcnt(17)
    s_movk_i32 s98, 0x4000
L_pO_chk:
    v_cmp_ne_u64 vcc, s[100:101], v[22:23]
    s_nop 1
    s_cmp_eq_u64 vcc, 0
    s_cbranch_scc1 L_pO_ok
    s_sub_u32 s98, s98, 1
    s_cbranch_scc1 L_pO_ok
    s_sleep 1
    global_load_dwordx2 v[22:23], v20, s[26:27] sc1
    s_waitcnt vmcnt(0)
    s_branch L_pO_chk
L_pO_ok:
    s_waitcnt vmcnt(18)
    s_barrier
    s_lshl_b32 s85, s31, 8
    s_lshl_b32 s86, s32, 7
    s_add_u32 s86, s85, s86
    s_xor_b32 s87, s86, 128
    s_add_u32 s60, s12, s86
    s_addc_u32 s61, s13, 0
    s_sub_u32 s62, 2097152, s86
    s_mov_b32 s63, 0x20000
    s_add_u32 s56, s26, 0x1200000
    s_addc_u32 s57, s27, 0
    s_mov_b32 s58, 0x400000
    s_mov_b32 s59, 0x20000
    s_lshl_b32 s82, s30, 18
    s_mov_b32 s83, 0
    s_lshl_b32 m0, s33, 2
    s_nop 0
    buffer_load_dwordx4 v10, s[56:59], s82 offen offset:0 sc1 lds
    buffer_load_dwordx4 v10, s[56:59], s82 offen offset:1024 sc1 lds
    buffer_load_dwordx4 v10, s[56:59], s82 offen offset:2048 sc1 lds
    buffer_load_dwordx4 v10, s[56:59], s82 offen offset:3072 sc1 lds
    s_add_u32 s82, s82, 16384
    s_lshl1_add_u32 m0, s33, 16384
    s_nop 0
    buffer_load_dwordx4 v11, s[60:63], s83 offen lds
    s_lshl1_add_u32 m0, s33, 17408
    s_nop 0
    buffer_load_dwordx4 v12, s[60:63], s83 offen lds
    s_add_u32 s83, s83, 131072
    s_waitcnt vmcnt(14)
    s_barrier
    s_lshl2_add_u32 m0, s33, 98304
    s_nop 0
    buffer_load_dwordx4 v10, s[56:59], s82 offen offset:0 sc1 lds
    buffer_load_dwordx4 v10, s[56:59], s82 offen offset:1024 sc1 lds
    buffer_load_dwordx4 v10, s[56:59], s82 offen offset:2048 sc1 lds
    buffer_load_dwordx4 v10, s[56:59], s82 offen offset:3072 sc1 lds
    s_add_u32 s82, s82, 16384
    s_lshl1_add_u32 m0, s33, 114688
    s_nop 0
    buffer_load_dwordx4 v11, s[60:63], s83 offen lds
    s_lshl1_add_u32 m0, s33, 115712
    s_nop 0
    buffer_load_dwordx4 v12, s[60:63], s83 offen lds
    s_add_u32 s83, s83, 131072
    s_waitcnt vmcnt(12)
    s_barrier
    s_lshl2_add_u32 m0, s33, 32768
    s_nop 0
    buffer_load_dwordx4 v10, s[56:59], s82 offen offset:0 sc1 lds
    buffer_load_dwordx4 v10, s[56:59], s82 offen offset:1024 sc1 lds
    buffer_load_dwordx4 v10, s[56:59], s82 offen offset:2048 sc1 lds
    buffer_load_dwordx4 v10, s[56:59], s82 offen offset:3072 sc1 lds
    s_add_u32 s82, s82, 16384
    s_lshl1_add_u32 m0, s33, 49152
    s_nop 0
    buffer_load_dwordx4 v11, s[60:63], s83 offen lds
    s_lshl1_add_u32 m0, s33, 50176
    s_nop 0
    buffer_load_dwordx4 v12, s[60:63], s83 offen lds
    s_add_u32 s83, s83, 131072
    s_waitcnt vmcnt(12)
    s_barrier
    s_setprio 1
    ds_read_b64_tr_b16 v[40:41], v6 offset:16384
    ds_read_b64_tr_b16 v[42:43], v6 offset:16896
    ds_read_b128 v[24:27], v4 offset:0
    ds_read_b128 v[28:31], v4 offset:1024
    ds_read_b128 v[32:35], v4 offset:2048
    ds_read_b128 v[36:39], v4 offset:3072
    ds_read_b64_tr_b16 v[44:45], v7 offset:16384
    ds_read_b64_tr_b16 v[46:47], v7 offset:16896
    s_mov_b32 s34, 3
.p2align 6
L_s:
    s_waitcnt lgkmcnt(5)
    v_mfma_f32_16x16x32_bf16 v[88:91], v[40:43], v[24:27], v[88:91]
    ds_read_b64_tr_b16 v[72:73], v6 offset:20480
    ds_read_b64_tr_b16 v[74:75], v6 offset:20992
    s_waitcnt lgkmcnt(6)
    v_mfma_f32_16x16x32_bf16 v[92:95], v[40:43], v[28:31], v[92:95]
    ds_read_b128 v[56:59], v4 offset:8192
    ds_read_b128 v[60:63], v4 offset:9216
    s_waitcnt lgkmcnt(7)
    v_mfma_f32_16x16x32_bf16 v[96:99], v[40:43], v[32:35], v[96:99]
    ds_read_b128 v[64:67], v4 offset:10240
    ds_read_b128 v[68:71], v4 offset:11264
    s_waitcnt lgkmcnt(8)
    v_mfma_f32_16x16x32_bf16 v[100:103], v[40:43], v[36:39], v[100:103]
    ds_read_b64_tr_b16 v[76:77], v7 offset:20480
    ds_read_b64_tr_b16 v[78:79], v7 offset:20992
    s_waitcnt lgkmcnt(8)
    v_mfma_f32_16x16x32_bf16 v[104:107], v[44:47], v[24:27], v[104:107]
    v_mfma_f32_16x16x32_bf16 v[108:111], v[44:47], v[28:31], v[108:111]
    v_mfma_f32_16x16x32_bf16 v[112:115], v[44:47], v[32:35], v[112:115]
    v_mfma_f32_16x16x32_bf16 v[116:119], v[44:47], v[36:39], v[116:119]
    s_waitcnt vmcnt(6) lgkmcnt(0)
    s_barrier
    v_mfma_f32_16x16x32_bf16 v[88:91], v[72:75], v[56:59], v[88:91]
    ds_read_b64_tr_b16 v[40:41], v8 offset:49152
    ds_read_b64_tr_b16 v[42:43], v8 offset:49664
    v_mfma_f32_16x16x32_bf16 v[92:95], v[72:75], v[60:63], v[92:95]
    ds_read_b128 v[24:27], v5 offset:32768
    ds_read_b128 v[28:31], v5 offset:33792
    v_mfma_f32_16x16x32_bf16 v[96:99], v[72:75], v[64:67], v[96:99]
    ds_read_b128 v[32:35], v5 offset:34816
    v_mfma_f32_16x16x32_bf16 v[100:103], v[72:75], v[68:71], v[100:103]
    ds_read_b128 v[36:39], v5 offset:35840
    ds_read_b64_tr_b16 v[44:45], v9 offset:49152
    v_mfma_f32_16x16x32_bf16 v[104:107], v[76:79], v[56:59], v[104:107]
    ds_read_b64_tr_b16 v[46:47], v9 offset:49664
    v_mfma_f32_16x16x32_bf16 v[108:111], v[76:79], v[60:63], v[108:111]
    v_mfma_f32_16x16x32_bf16 v[112:115], v[76:79], v[64:67], v[112:115]
    v_mfma_f32_16x16x32_bf16 v[116:119], v[76:79], v[68:71], v[116:119]
    s_waitcnt lgkmcnt(5)
    v_mfma_f32_16x16x32_bf16 v[88:91], v[40:43], v[24:27], v[88:91]
    ds_read_b64_tr_b16 v[72:73], v8 offset:53248
    ds_read_b64_tr_b16 v[74:75], v8 offset:53760
    s_waitcnt lgkmcnt(6)
    v_mfma_f32_16x16x32_bf16 v[92:95], v[40:43], v[28:31], v[92:95]
    ds_read_b128 v[56:59], v5 offset:40960
    ds_read_b128 v[60:63], v5 offset:41984
    s_waitcnt lgkmcnt(7)
    v_mfma_f32_16x16x32_bf16 v[96:99], v[40:43], v[32:35], v[96:99]
    ds_read_b128 v[64:67], v5 offset:43008
    ds_read_b128 v[68:71], v5 offset:44032
    s_waitcnt lgkmcnt(8)
    v_mfma_f32_16x16x32_bf16 v[100:103], v[40:43], v[36:39], v[100:103]
    ds_read_b64_tr_b16 v[76:77], v9 offset:53248
    ds_read_b64_tr_b16 v[78:79], v9 offset:53760
    s_waitcnt lgkmcnt(8)
    v_mfma_f32_16x16x32_bf16 v[104:107], v[44:47], v[24:27], v[104:107]
    v_mfma_f32_16x16x32_bf16 v[108:111], v[44:47], v[28:31], v[108:111]
    v_mfma_f32_16x16x32_bf16 v[112:115], v[44:47], v[32:35], v[112:115]
    v_mfma_f32_16x16x32_bf16 v[116:119], v[44:47], v[36:39], v[116:119]
    s_waitcnt vmcnt(0) lgkmcnt(0)
    s_barrier
    v_mfma_f32_16x16x32_bf16 v[88:91], v[72:75], v[56:59], v[88:91]
    ds_read_b64_tr_b16 v[40:41], v6 offset:49152
    ds_read_b64_tr_b16 v[42:43], v6 offset:49664
    v_mfma_f32_16x16x32_bf16 v[92:95], v[72:75], v[60:63], v[92:95]
    ds_read_b128 v[24:27], v4 offset:32768
    ds_read_b128 v[28:31], v4 offset:33792
    v_mfma_f32_16x16x32_bf16 v[96:99], v[72:75], v[64:67], v[96:99]
    ds_read_b128 v[32:35], v4 offset:34816
    v_mfma_f32_16x16x32_bf16 v[100:103], v[72:75], v[68:71], v[100:103]
    ds_read_b128 v[36:39], v4 offset:35840
    ds_read_b64_tr_b16 v[44:45], v7 offset:49152
    v_mfma_f32_16x16x32_bf16 v[104:107], v[76:79], v[56:59], v[104:107]
    ds_read_b64_tr_b16 v[46:47], v7 offset:49664
    v_mfma_f32_16x16x32_bf16 v[108:111], v[76:79], v[60:63], v[108:111]
    v_mfma_f32_16x16x32_bf16 v[112:115], v[76:79], v[64:67], v[112:115]
    v_mfma_f32_16x16x32_bf16 v[116:119], v[76:79], v[68:71], v[116:119]
    s_waitcnt lgkmcnt(5)
    v_mfma_f32_16x16x32_bf16 v[88:91], v[40:43], v[24:27], v[88:91]
    ds_read_b64_tr_b16 v[72:73], v6 offset:53248
    ds_read_b64_tr_b16 v[74:75], v6 offset:53760
    s_waitcnt lgkmcnt(6)
    v_mfma_f32_16x16x32_bf16 v[92:95], v[40:43], v[28:31], v[92:95]
    ds_read_b128 v[56:59], v4 offset:40960
    ds_read_b128 v[60:63], v4 offset:41984
    s_waitcnt lgkmcnt(7)
    v_mfma_f32_16x16x32_bf16 v[96:99], v[40:43], v[32:35], v[96:99]
    ds_read_b128 v[64:67], v4 offset:43008
    ds_read_b128 v[68:71], v4 offset:44032
    s_waitcnt lgkmcnt(8)
    v_mfma_f32_16x16x32_bf16 v[100:103], v[40:43], v[36:39], v[100:103]
    ds_read_b64_tr_b16 v[76:77], v7 offset:53248
    ds_read_b64_tr_b16 v[78:79], v7 offset:53760
    s_waitcnt lgkmcnt(8)
    v_mfma_f32_16x16x32_bf16 v[104:107], v[44:47], v[24:27], v[104:107]
    v_mfma_f32_16x16x32_bf16 v[108:111], v[44:47], v[28:31], v[108:111]
    v_mfma_f32_16x16x32_bf16 v[112:115], v[44:47], v[32:35], v[112:115]
    v_mfma_f32_16x16x32_bf16 v[116:119], v[44:47], v[36:39], v[116:119]
    s_waitcnt lgkmcnt(0)
    s_barrier
    v_mfma_f32_16x16x32_bf16 v[88:91], v[72:75], v[56:59], v[88:91]
    ds_read_b64_tr_b16 v[40:41], v8 offset:16384
    ds_read_b64_tr_b16 v[42:43], v8 offset:16896
    v_mfma_f32_16x16x32_bf16 v[92:95], v[72:75], v[60:63], v[92:95]
    ds_read_b128 v[24:27], v5 offset:0
    ds_read_b128 v[28:31], v5 offset:1024
    v_mfma_f32_16x16x32_bf16 v[96:99], v[72:75], v[64:67], v[96:99]
    ds_read_b128 v[32:35], v5 offset:2048
    v_mfma_f32_16x16x32_bf16 v[100:103], v[72:75], v[68:71], v[100:103]
    ds_read_b128 v[36:39], v5 offset:3072
    ds_read_b64_tr_b16 v[44:45], v9 offset:16384
    v_mfma_f32_16x16x32_bf16 v[104:107], v[76:79], v[56:59], v[104:107]
    ds_read_b64_tr_b16 v[46:47], v9 offset:16896
    v_mfma_f32_16x16x32_bf16 v[108:111], v[76:79], v[60:63], v[108:111]
    v_mfma_f32_16x16x32_bf16 v[112:115], v[76:79], v[64:67], v[112:115]
    v_mfma_f32_16x16x32_bf16 v[116:119], v[76:79], v[68:71], v[116:119]
    s_waitcnt lgkmcnt(5)
    v_mfma_f32_16x16x32_bf16 v[88:91], v[40:43], v[24:27], v[88:91]
    ds_read_b64_tr_b16 v[72:73], v8 offset:20480
    ds_read_b64_tr_b16 v[74:75], v8 offset:20992
    s_waitcnt lgkmcnt(6)
    v_mfma_f32_16x16x32_bf16 v[92:95], v[40:43], v[28:31], v[92:95]
    ds_read_b128 v[56:59], v5 offset:8192
    ds_read_b128 v[60:63], v5 offset:9216
    s_waitcnt lgkmcnt(7)
    v_mfma_f32_16x16x32_bf16 v[96:99], v[40:43], v[32:35], v[96:99]
    ds_read_b128 v[64:67], v5 offset:10240
    ds_read_b128 v[68:71], v5 offset:11264
    s_waitcnt lgkmcnt(8)
    v_mfma_f32_16x16x32_bf16 v[100:103], v[40:43], v[36:39], v[100:103]
    ds_read_b64_tr_b16 v[76:77], v9 offset:20480
    ds_read_b64_tr_b16 v[78:79], v9 offset:20992
    s_waitcnt lgkmcnt(8)
    v_mfma_f32_16x16x32_bf16 v[104:107], v[44:47], v[24:27], v[104:107]
    v_mfma_f32_16x16x32_bf16 v[108:111], v[44:47], v[28:31], v[108:111]
    v_mfma_f32_16x16x32_bf16 v[112:115], v[44:47], v[32:35], v[112:115]
    v_mfma_f32_16x16x32_bf16 v[116:119], v[44:47], v[36:39], v[116:119]
    s_waitcnt lgkmcnt(0)
    s_barrier
    v_mfma_f32_16x16x32_bf16 v[88:91], v[72:75], v[56:59], v[88:91]
    ds_read_b64_tr_b16 v[40:41], v6 offset:16384
    ds_read_b64_tr_b16 v[42:43], v6 offset:16896
    v_mfma_f32_16x16x32_bf16 v[92:95], v[72:75], v[60:63], v[92:95]
    ds_read_b128 v[24:27], v4 offset:0
    ds_read_b128 v[28:31], v4 offset:1024
    v_mfma_f32_16x16x32_bf16 v[96:99], v[72:75], v[64:67], v[96:99]
    ds_read_b128 v[32:35], v4 offset:2048
    v_mfma_f32_16x16x32_bf16 v[100:103], v[72:75], v[68:71], v[100:103]
    ds_read_b128 v[36:39], v4 offset:3072
    ds_read_b64_tr_b16 v[44:45], v7 offset:16384
    v_mfma_f32_16x16x32_bf16 v[104:107], v[76:79], v[56:59], v[104:107]
    ds_read_b64_tr_b16 v[46:47], v7 offset:16896
    v_mfma_f32_16x16x32_bf16 v[108:111], v[76:79], v[60:63], v[108:111]
    v_mfma_f32_16x16x32_bf16 v[112:115], v[76:79], v[64:67], v[112:115]
    v_mfma_f32_16x16x32_bf16 v[116:119], v[76:79], v[68:71], v[116:119]
    s_sub_u32 s34, s34, 1
    s_cmp_lg_u32 s34, 0
    s_cbranch_scc1 L_s
    s_waitcnt lgkmcnt(5)
    v_mfma_f32_16x16x32_bf16 v[88:91], v[40:43], v[24:27], v[88:91]
    ds_read_b64_tr_b16 v[72:73], v6 offset:20480
    ds_read_b64_tr_b16 v[74:75], v6 offset:20992
    s_waitcnt lgkmcnt(6)
    v_mfma_f32_16x16x32_bf16 v[92:95], v[40:43], v[28:31], v[92:95]
    ds_read_b128 v[56:59], v4 offset:8192
    ds_read_b128 v[60:63], v4 offset:9216
    s_waitcnt lgkmcnt(7)
    v_mfma_f32_16x16x32_bf16 v[96:99], v[40:43], v[32:35], v[96:99]
    ds_read_b128 v[64:67], v4 offset:10240
    ds_read_b128 v[68:71], v4 offset:11264
    s_waitcnt lgkmcnt(8)
    v_mfma_f32_16x16x32_bf16 v[100:103], v[40:43], v[36:39], v[100:103]
    ds_read_b64_tr_b16 v[76:77], v7 offset:20480
    ds_read_b64_tr_b16 v[78:79], v7 offset:20992
    s_waitcnt lgkmcnt(8)
    v_mfma_f32_16x16x32_bf16 v[104:107], v[44:47], v[24:27], v[104:107]
    v_mfma_f32_16x16x32_bf16 v[108:111], v[44:47], v[28:31], v[108:111]
    v_mfma_f32_16x16x32_bf16 v[112:115], v[44:47], v[32:35], v[112:115]
    v_mfma_f32_16x16x32_bf16 v[116:119], v[44:47], v[36:39], v[116:119]
    s_waitcnt lgkmcnt(0)
    s_barrier
    v_mfma_f32_16x16x32_bf16 v[88:91], v[72:75], v[56:59], v[88:91]
    ds_read_b64_tr_b16 v[40:41], v8 offset:49152
    ds_read_b64_tr_b16 v[42:43], v8 offset:49664
    v_mfma_f32_16x16x32_bf16 v[92:95], v[72:75], v[60:63], v[92:95]
    ds_read_b128 v[24:27], v5 offset:32768
    ds_read_b128 v[28:31], v5 offset:33792
    v_mfma_f32_16x16x32_bf16 v[96:99], v[72:75], v[64:67], v[96:99]
    ds_read_b128 v[32:35], v5 offset:34816
    v_mfma_f32_16x16x32_bf16 v[100:103], v[72:75], v[68:71], v[100:103]
    ds_read_b128 v[36:39], v5 offset:35840
    ds_read_b64_tr_b16 v[44:45], v9 offset:49152
    v_mfma_f32_16x16x32_bf16 v[104:107], v[76:79], v[56:59], v[104:107]
    ds_read_b64_tr_b16 v[46:47], v9 offset:49664
    v_mfma_f32_16x16x32_bf16 v[108:111], v[76:79], v[60:63], v[108:111]
    v_mfma_f32_16x16x32_bf16 v[112:115], v[76:79], v[64:67], v[112:115]
    v_mfma_f32_16x16x32_bf16 v[116:119], v[76:79], v[68:71], v[116:119]
    s_waitcnt lgkmcnt(5)
    v_mfma_f32_16x16x32_bf16 v[88:91], v[40:43], v[24:27], v[88:91]
    ds_read_b64_tr_b16 v[72:73], v8 offset:53248
    ds_read_b64_tr_b16 v[74:75], v8 offset:53760
    s_waitcnt lgkmcnt(6)
    v_mfma_f32_16x16x32_bf16 v[92:95], v[40:43], v[28:31], v[92:95]
    ds_read_b128 v[56:59], v5 offset:40960
    ds_read_b128 v[60:63], v5 offset:41984
    s_waitcnt lgkmcnt(7)
    v_mfma_f32_16x16x32_bf16 v[96:99], v[40:43], v[32:35], v[96:99]
    ds_read_b128 v[64:67], v5 offset:43008
    ds_read_b128 v[68:71], v5 offset:44032
    s_waitcnt lgkmcnt(8)
    v_mfma_f32_16x16x32_bf16 v[100:103], v[40:43], v[36:39], v[100:103]
    ds_read_b64_tr_b16 v[76:77], v9 offset:53248
    ds_read_b64_tr_b16 v[78:79], v9 offset:53760
    s_waitcnt lgkmcnt(8)
    v_mfma_f32_16x16x32_bf16 v[104:107], v[44:47], v[24:27], v[104:107]
    v_mfma_f32_16x16x32_bf16 v[108:111], v[44:47], v[28:31], v[108:111]
    v_mfma_f32_16x16x32_bf16 v[112:115], v[44:47], v[32:35], v[112:115]
    v_mfma_f32_16x16x32_bf16 v[116:119], v[44:47], v[36:39], v[116:119]
    s_waitcnt lgkmcnt(0)
    s_barrier
    v_mfma_f32_16x16x32_bf16 v[88:91], v[72:75], v[56:59], v[88:91]
    ds_read_b64_tr_b16 v[40:41], v6 offset:49152
    ds_read_b64_tr_b16 v[42:43], v6 offset:49664
    v_mfma_f32_16x16x32_bf16 v[92:95], v[72:75], v[60:63], v[92:95]
    ds_read_b128 v[24:27], v4 offset:32768
    ds_read_b128 v[28:31], v4 offset:33792
    v_mfma_f32_16x16x32_bf16 v[96:99], v[72:75], v[64:67], v[96:99]
    ds_read_b128 v[32:35], v4 offset:34816
    v_mfma_f32_16x16x32_bf16 v[100:103], v[72:75], v[68:71], v[100:103]
    ds_read_b128 v[36:39], v4 offset:35840
    ds_read_b64_tr_b16 v[44:45], v7 offset:49152
    v_mfma_f32_16x16x32_bf16 v[104:107], v[76:79], v[56:59], v[104:107]
    ds_read_b64_tr_b16 v[46:47], v7 offset:49664
    v_mfma_f32_16x16x32_bf16 v[108:111], v[76:79], v[60:63], v[108:111]
    v_mfma_f32_16x16x32_bf16 v[112:115], v[76:79], v[64:67], v[112:115]
    v_mfma_f32_16x16x32_bf16 v[116:119], v[76:79], v[68:71], v[116:119]
    s_waitcnt lgkmcnt(5)
    v_mfma_f32_16x16x32_bf16 v[88:91], v[40:43], v[24:27], v[88:91]
    ds_read_b64_tr_b16 v[72:73], v6 offset:53248
    ds_read_b64_tr_b16 v[74:75], v6 offset:53760
    s_waitcnt lgkmcnt(6)
    v_mfma_f32_16x16x32_bf16 v[92:95], v[40:43], v[28:31], v[92:95]
    ds_read_b128 v[56:59], v4 offset:40960
    ds_read_b128 v[60:63], v4 offset:41984
    s_waitcnt lgkmcnt(7)
    v_mfma_f32_16x16x32_bf16 v[96:99], v[40:43], v[32:35], v[96:99]
    ds_read_b128 v[64:67], v4 offset:43008
    ds_read_b128 v[68:71], v4 offset:44032
    s_waitcnt lgkmcnt(8)
    v_mfma_f32_16x16x32_bf16 v[100:103], v[40:43], v[36:39], v[100:103]
    ds_read_b64_tr_b16 v[76:77], v7 offset:53248
    ds_read_b64_tr_b16 v[78:79], v7 offset:53760
    s_waitcnt lgkmcnt(8)
    v_mfma_f32_16x16x32_bf16 v[104:107], v[44:47], v[24:27], v[104:107]
    v_mfma_f32_16x16x32_bf16 v[108:111], v[44:47], v[28:31], v[108:111]
    v_mfma_f32_16x16x32_bf16 v[112:115], v[44:47], v[32:35], v[112:115]
    v_mfma_f32_16x16x32_bf16 v[116:119], v[44:47], v[36:39], v[116:119]
    s_waitcnt lgkmcnt(0)
    s_barrier
    v_mfma_f32_16x16x32_bf16 v[88:91], v[72:75], v[56:59], v[88:91]
    ds_read_b64_tr_b16 v[40:41], v8 offset:16384
    ds_read_b64_tr_b16 v[42:43], v8 offset:16896
    v_mfma_f32_16x16x32_bf16 v[92:95], v[72:75], v[60:63], v[92:95]
    ds_read_b128 v[24:27], v5 offset:0
    ds_read_b128 v[28:31], v5 offset:1024
    v_mfma_f32_16x16x32_bf16 v[96:99], v[72:75], v[64:67], v[96:99]
    ds_read_b128 v[32:35], v5 offset:2048
    v_mfma_f32_16x16x32_bf16 v[100:103], v[72:75], v[68:71], v[100:103]
    ds_read_b128 v[36:39], v5 offset:3072
    ds_read_b64_tr_b16 v[44:45], v9 offset:16384
    v_mfma_f32_16x16x32_bf16 v[104:107], v[76:79], v[56:59], v[104:107]
    ds_read_b64_tr_b16 v[46:47], v9 offset:16896
    v_mfma_f32_16x16x32_bf16 v[108:111], v[76:79], v[60:63], v[108:111]
    v_mfma_f32_16x16x32_bf16 v[112:115], v[76:79], v[64:67], v[112:115]
    v_mfma_f32_16x16x32_bf16 v[116:119], v[76:79], v[68:71], v[116:119]
    s_waitcnt lgkmcnt(5)
    v_mfma_f32_16x16x32_bf16 v[88:91], v[40:43], v[24:27], v[88:91]
    ds_read_b64_tr_b16 v[72:73], v8 offset:20480
    ds_read_b64_tr_b16 v[74:75], v8 offset:20992
    s_waitcnt lgkmcnt(6)
    v_mfma_f32_16x16x32_bf16 v[92:95], v[40:43], v[28:31], v[92:95]
    ds_read_b128 v[56:59], v5 offset:8192
    ds_read_b128 v[60:63], v5 offset:9216
    s_waitcnt lgkmcnt(7)
    v_mfma_f32_16x16x32_bf16 v[96:99], v[40:43], v[32:35], v[96:99]
    ds_read_b128 v[64:67], v5 offset:10240
    ds_read_b128 v[68:71], v5 offset:11264
    s_waitcnt lgkmcnt(8)
    v_mfma_f32_16x16x32_bf16 v[100:103], v[40:43], v[36:39], v[100:103]
    ds_read_b64_tr_b16 v[76:77], v9 offset:20480
    ds_read_b64_tr_b16 v[78:79], v9 offset:20992
    s_waitcnt lgkmcnt(8)
    v_mfma_f32_16x16x32_bf16 v[104:107], v[44:47], v[24:27], v[104:107]
    v_mfma_f32_16x16x32_bf16 v[108:111], v[44:47], v[28:31], v[108:111]
    v_mfma_f32_16x16x32_bf16 v[112:115], v[44:47], v[32:35], v[112:115]
    v_mfma_f32_16x16x32_bf16 v[116:119], v[44:47], v[36:39], v[116:119]
    s_waitcnt lgkmcnt(5)
    v_mfma_f32_16x16x32_bf16 v[88:91], v[72:75], v[56:59], v[88:91]
    s_waitcnt lgkmcnt(4)
    v_mfma_f32_16x16x32_bf16 v[92:95], v[72:75], v[60:63], v[92:95]
    s_waitcnt lgkmcnt(3)
    v_mfma_f32_16x16x32_bf16 v[96:99], v[72:75], v[64:67], v[96:99]
    s_waitcnt lgkmcnt(2)
    v_mfma_f32_16x16x32_bf16 v[100:103], v[72:75], v[68:71], v[100:103]
    s_waitcnt lgkmcnt(0)
    v_mfma_f32_16x16x32_bf16 v[104:107], v[76:79], v[56:59], v[104:107]
    v_mfma_f32_16x16x32_bf16 v[108:111], v[76:79], v[60:63], v[108:111]
    v_mfma_f32_16x16x32_bf16 v[112:115], v[76:79], v[64:67], v[112:115]
    v_mfma_f32_16x16x32_bf16 v[116:119], v[76:79], v[68:71], v[116:119]
    s_barrier
    s_lshl_b32 s84, s4, 12
    s_add_u32 s84, s84, 131072
    v_lshl_add_u32 v4, v1, 3, s84
    ds_read_b64 v[24:25], v4 offset:0
    ds_read_b64 v[26:27], v4 offset:512
    ds_read_b64 v[28:29], v4 offset:1024
    ds_read_b64 v[30:31], v4 offset:1536
    ds_read_b64 v[32:33], v4 offset:2048
    ds_read_b64 v[34:35], v4 offset:2560
    ds_read_b64 v[36:37], v4 offset:3072
    ds_read_b64 v[38:39], v4 offset:3584
    s_mov_b32 s72, s22
    s_mov_b32 s73, s23
    s_mov_b32 s74, 0x400000
    s_mov_b32 s75, 0x20000
    v_cvt_pk_bf16_f32 v44, v88, v89
    v_cvt_pk_bf16_f32 v45, v90, v91
    v_lshlrev_b32 v88, 16, v44
    v_and_b32 v89, 0xffff0000, v44
    v_lshlrev_b32 v90, 16, v45
    v_and_b32 v91, 0xffff0000, v45
    v_cvt_pk_bf16_f32 v44, v92, v93
    v_cvt_pk_bf16_f32 v45, v94, v95
    v_lshlrev_b32 v92, 16, v44
    v_and_b32 v93, 0xffff0000, v44
    v_lshlrev_b32 v94, 16, v45
    v_and_b32 v95, 0xffff0000, v45
    v_cvt_pk_bf16_f32 v44, v96, v97
    v_cvt_pk_bf16_f32 v45, v98, v99
    v_lshlrev_b32 v96, 16, v44
    v_and_b32 v97, 0xffff0000, v44
    v_lshlrev_b32 v98, 16, v45
    v_and_b32 v99, 0xffff0000, v45
    v_cvt_pk_bf16_f32 v44, v100, v101
    v_cvt_pk_bf16_f32 v45, v102, v103
    v_lshlrev_b32 v100, 16, v44
    v_and_b32 v101, 0xffff0000, v44
    v_lshlrev_b32 v102, 16, v45
    v_and_b32 v103, 0xffff0000, v45
    v_cvt_pk_bf16_f32 v44, v104, v105
    v_cvt_pk_bf16_f32 v45, v106, v107
    v_lshlrev_b32 v104, 16, v44
    v_and_b32 v105, 0xffff0000, v44
    v_lshlrev_b32 v106, 16, v45
    v_and_b32 v107, 0xffff0000, v45
    v_cvt_pk_bf16_f32 v44, v108, v109
    v_cvt_pk_bf16_f32 v45, v110, v111
    v_lshlrev_b32 v108, 16, v44
    v_and_b32 v109, 0xffff0000, v44
    v_lshlrev_b32 v110, 16, v45
    v_and_b32 v111, 0xffff0000, v45
    v_cvt_pk_bf16_f32 v44, v112, v113
    v_cvt_pk_bf16_f32 v45, v114, v115
    v_lshlrev_b32 v112, 16, v44
    v_and_b32 v113, 0xffff0000, v44
    v_lshlrev_b32 v114, 16, v45
    v_and_b32 v115, 0xffff0000, v45
    v_cvt_pk_bf16_f32 v44, v116, v117
    v_cvt_pk_bf16_f32 v45, v118, v119
    v_lshlrev_b32 v116, 16, v44
    v_and_b32 v117, 0xffff0000, v44
    v_lshlrev_b32 v118, 16, v45
    v_and_b32 v119, 0xffff0000, v45
    s_waitcnt lgkmcnt(0)
    v_lshlrev_b32 v40, 16, v24
    v_and_b32 v41, 0xffff0000, v24
    v_lshlrev_b32 v42, 16, v25
    v_and_b32 v43, 0xffff0000, v25
    v_mul_f32 v40, v40, v88
    v_mul_f32 v41, v41, v89
    v_mul_f32 v42, v42, v90
    v_mul_f32 v43, v43, v91
    v_cvt_pk_bf16_f32 v48, v40, v41
    v_cvt_pk_bf16_f32 v49, v42, v43
    v_lshlrev_b32 v40, 16, v32
    v_and_b32 v41, 0xffff0000, v32
    v_lshlrev_b32 v42, 16, v33
    v_and_b32 v43, 0xffff0000, v33
    v_mul_f32 v40, v40, v104
    v_mul_f32 v41, v41, v105
    v_mul_f32 v42, v42, v106
    v_mul_f32 v43, v43, v107
    v_cvt_pk_bf16_f32 v50, v40, v41
    v_cvt_pk_bf16_f32 v51, v42, v43
    s_nop 1
    v_permlane16_swap_b32 v48, v50
    v_permlane16_swap_b32 v49, v51
    v_lshlrev_b32 v40, 16, v48
    v_and_b32 v41, 0xffff0000, v48
    v_lshlrev_b32 v42, 16, v120
    v_and_b32 v43, 0xffff0000, v120
    v_add_f32 v40, v40, v42
    v_add_f32 v41, v41, v43
    v_cvt_pk_bf16_f32 v48, v40, v41
    v_lshlrev_b32 v40, 16, v49
    v_and_b32 v41, 0xffff0000, v49
    v_lshlrev_b32 v42, 16, v121
    v_and_b32 v43, 0xffff0000, v121
    v_add_f32 v40, v40, v42
    v_add_f32 v41, v41, v43
    v_cvt_pk_bf16_f32 v49, v40, v41
    v_lshlrev_b32 v40, 16, v50
    v_and_b32 v41, 0xffff0000, v50
    v_lshlrev_b32 v42, 16, v122
    v_and_b32 v43, 0xffff0000, v122
    v_add_f32 v40, v40, v42
    v_add_f32 v41, v41, v43
    v_cvt_pk_bf16_f32 v50, v40, v41
    v_lshlrev_b32 v40, 16, v51
    v_and_b32 v41, 0xffff0000, v51
    v_lshlrev_b32 v42, 16, v123
    v_and_b32 v43, 0xffff0000, v123
    v_add_f32 v40, v40, v42
    v_add_f32 v41, v41, v43
    v_cvt_pk_bf16_f32 v51, v40, v41
    s_mov_b32 s84, 0
    buffer_store_dwordx4 v[48:51], v13, s[72:75], s84 offen
    v_lshlrev_b32 v40, 16, v26
    v_and_b32 v41, 0xffff0000, v26
    v_lshlrev_b32 v42, 16, v27
    v_and_b32 v43, 0xffff0000, v27
    v_mul_f32 v40, v40, v92
    v_mul_f32 v41, v41, v93
    v_mul_f32 v42, v42, v94
    v_mul_f32 v43, v43, v95
    v_cvt_pk_bf16_f32 v52, v40, v41
    v_cvt_pk_bf16_f32 v53, v42, v43
    v_lshlrev_b32 v40, 16, v34
    v_and_b32 v41, 0xffff0000, v34
    v_lshlrev_b32 v42, 16, v35
    v_and_b32 v43, 0xffff0000, v35
    v_mul_f32 v40, v40, v108
    v_mul_f32 v41, v41, v109
    v_mul_f32 v42, v42, v110
    v_mul_f32 v43, v43, v111
    v_cvt_pk_bf16_f32 v54, v40, v41
    v_cvt_pk_bf16_f32 v55, v42, v43
    s_nop 1
    v_permlane16_swap_b32 v52, v54
    v_permlane16_swap_b32 v53, v55
    v_lshlrev_b32 v40, 16, v52
    v_and_b32 v41, 0xffff0000, v52
    v_lshlrev_b32 v42, 16, v124
    v_and_b32 v43, 0xffff0000, v124
    v_add_f32 v40, v40, v42
    v_add_f32 v41, v41, v43
    v_cvt_pk_bf16_f32 v52, v40, v41
    v_lshlrev_b32 v40, 16, v53
    v_and_b32 v41, 0xffff0000, v53
    v_lshlrev_b32 v42, 16, v125
    v_and_b32 v43, 0xffff0000, v125
    v_add_f32 v40, v40, v42
    v_add_f32 v41, v41, v43
    v_cvt_pk_bf16_f32 v53, v40, v41
    v_lshlrev_b32 v40, 16, v54
    v_and_b32 v41, 0xffff0000, v54
    v_lshlrev_b32 v42, 16, v126
    v_and_b32 v43, 0xffff0000, v126
    v_add_f32 v40, v40, v42
    v_add_f32 v41, v41, v43
    v_cvt_pk_bf16_f32 v54, v40, v41
    v_lshlrev_b32 v40, 16, v55
    v_and_b32 v41, 0xffff0000, v55
    v_lshlrev_b32 v42, 16, v127
    v_and_b32 v43, 0xffff0000, v127
    v_add_f32 v40, v40, v42
    v_add_f32 v41, v41, v43
    v_cvt_pk_bf16_f32 v55, v40, v41
    s_mov_b32 s84, 32768
    buffer_store_dwordx4 v[52:55], v13, s[72:75], s84 offen
    v_lshlrev_b32 v40, 16, v28
    v_and_b32 v41, 0xffff0000, v28
    v_lshlrev_b32 v42, 16, v29
    v_and_b32 v43, 0xffff0000, v29
    v_mul_f32 v40, v40, v96
    v_mul_f32 v41, v41, v97
    v_mul_f32 v42, v42, v98
    v_mul_f32 v43, v43, v99
    v_cvt_pk_bf16_f32 v56, v40, v41
    v_cvt_pk_bf16_f32 v57, v42, v43
    v_lshlrev_b32 v40, 16, v36
    v_and_b32 v41, 0xffff0000, v36
    v_lshlrev_b32 v42, 16, v37
    v_and_b32 v43, 0xffff0000, v37
    v_mul_f32 v40, v40, v112
    v_mul_f32 v41, v41, v113
    v_mul_f32 v42, v42, v114
    v_mul_f32 v43, v43, v115
    v_cvt_pk_bf16_f32 v58, v40, v41
    v_cvt_pk_bf16_f32 v59, v42, v43
    s_nop 1
    v_permlane16_swap_b32 v56, v58
    v_permlane16_swap_b32 v57, v59
    v_lshlrev_b32 v40, 16, v56
    v_and_b32 v41, 0xffff0000, v56
    v_lshlrev_b32 v42, 16, v128
    v_and_b32 v43, 0xffff0000, v128
    v_add_f32 v40, v40, v42
    v_add_f32 v41, v41, v43
    v_cvt_pk_bf16_f32 v56, v40, v41
    v_lshlrev_b32 v40, 16, v57
    v_and_b32 v41, 0xffff0000, v57
    v_lshlrev_b32 v42, 16, v129
    v_and_b32 v43, 0xffff0000, v129
    v_add_f32 v40, v40, v42
    v_add_f32 v41, v41, v43
    v_cvt_pk_bf16_f32 v57, v40, v41
    v_lshlrev_b32 v40, 16, v58
    v_and_b32 v41, 0xffff0000, v58
    v_lshlrev_b32 v42, 16, v130
    v_and_b32 v43, 0xffff0000, v130
    v_add_f32 v40, v40, v42
    v_add_f32 v41, v41, v43
    v_cvt_pk_bf16_f32 v58, v40, v41
    v_lshlrev_b32 v40, 16, v59
    v_and_b32 v41, 0xffff0000, v59
    v_lshlrev_b32 v42, 16, v131
    v_and_b32 v43, 0xffff0000, v131
    v_add_f32 v40, v40, v42
    v_add_f32 v41, v41, v43
    v_cvt_pk_bf16_f32 v59, v40, v41
    s_mov_b32 s84, 65536
    buffer_store_dwordx4 v[56:59], v13, s[72:75], s84 offen
    v_lshlrev_b32 v40, 16, v30
    v_and_b32 v41, 0xffff0000, v30
    v_lshlrev_b32 v42, 16, v31
    v_and_b32 v43, 0xffff0000, v31
    v_mul_f32 v40, v40, v100
    v_mul_f32 v41, v41, v101
    v_mul_f32 v42, v42, v102
    v_mul_f32 v43, v43, v103
    v_cvt_pk_bf16_f32 v60, v40, v41
    v_cvt_pk_bf16_f32 v61, v42, v43
    v_lshlrev_b32 v40, 16, v38
    v_and_b32 v41, 0xffff0000, v38
    v_lshlrev_b32 v42, 16, v39
    v_and_b32 v43, 0xffff0000, v39
    v_mul_f32 v40, v40, v116
    v_mul_f32 v41, v41, v117
    v_mul_f32 v42, v42, v118
    v_mul_f32 v43, v43, v119
    v_cvt_pk_bf16_f32 v62, v40, v41
    v_cvt_pk_bf16_f32 v63, v42, v43
    s_nop 1
    v_permlane16_swap_b32 v60, v62
    v_permlane16_swap_b32 v61, v63
    v_lshlrev_b32 v40, 16, v60
    v_and_b32 v41, 0xffff0000, v60
    v_lshlrev_b32 v42, 16, v132
    v_and_b32 v43, 0xffff0000, v132
    v_add_f32 v40, v40, v42
    v_add_f32 v41, v41, v43
    v_cvt_pk_bf16_f32 v60, v40, v41
    v_lshlrev_b32 v40, 16, v61
    v_and_b32 v41, 0xffff0000, v61
    v_lshlrev_b32 v42, 16, v133
    v_and_b32 v43, 0xffff0000, v133
    v_add_f32 v40, v40, v42
    v_add_f32 v41, v41, v43
    v_cvt_pk_bf16_f32 v61, v40, v41
    v_lshlrev_b32 v40, 16, v62
    v_and_b32 v41, 0xffff0000, v62
    v_lshlrev_b32 v42, 16, v134
    v_and_b32 v43, 0xffff0000, v134
    v_add_f32 v40, v40, v42
    v_add_f32 v41, v41, v43
    v_cvt_pk_bf16_f32 v62, v40, v41
    v_lshlrev_b32 v40, 16, v63
    v_and_b32 v41, 0xffff0000, v63
    v_lshlrev_b32 v42, 16, v135
    v_and_b32 v43, 0xffff0000, v135
    v_add_f32 v40, v40, v42
    v_add_f32 v41, v41, v43
    v_cvt_pk_bf16_f32 v63, v40, v41
    s_mov_b32 s84, 98304
    buffer_store_dwordx4 v[60:63], v13, s[72:75], s84 offen
L_fin:
L_end:
    s_endpgm
L_code_end:
.section .rodata,"a"
.p2align 6
.amdhsa_kernel recurrent_scan__sliding_local_dilated__glu_gated_geglu__prompt_kernel
  .amdhsa_next_free_vgpr 256
  .amdhsa_next_free_sgpr 102
  .amdhsa_accum_offset 256
  .amdhsa_group_segment_fixed_size 0
  .amdhsa_kernarg_size 80
  .amdhsa_user_sgpr_count 2
  .amdhsa_user_sgpr_kernarg_segment_ptr 1
  .amdhsa_system_sgpr_workgroup_id_x 1
.end_amdhsa_kernel
```

```asm
; @launch grid=(256,1,1) block=(512,1,1) lds=163840
.amdgcn_target "amdgcn-amd-amdhsa--gfx950"
.text
.globl recurrent_scan__sliding_local_dilated__glu_gated_geglu__prompt_kernel
.p2align 8
.type recurrent_scan__sliding_local_dilated__glu_gated_geglu__prompt_kernel,@function
recurrent_scan__sliding_local_dilated__glu_gated_geglu__prompt_kernel:
    s_cmp_ge_u32 s2, 256
    s_cbranch_scc1 L_end
    s_load_dwordx4 s[8:11], s[0:1], 0
    s_load_dwordx2 s[12:13], s[0:1], 16
    s_load_dwordx4 s[16:19], s[0:1], 32
    s_load_dwordx4 s[20:23], s[0:1], 48
    s_load_dwordx4 s[24:27], s[0:1], 64
    v_lshrrev_b32 v3, 6, v0
    v_and_b32 v1, 63, v0
    v_readfirstlane_b32 s3, v3
    s_and_b32 s84, s2, 7
    s_lshr_b32 s85, s2, 3
    s_mov_b32 s15, s85
    s_and_b32 s32, s84, 1
    s_lshl_b32 s86, s32, 3
    s_and_b32 s87, s85, 7
    s_add_u32 s28, s86, s87
    s_lshr_b32 s86, s84, 1
    s_lshl_b32 s86, s86, 2
    s_lshr_b32 s87, s85, 3
    s_add_u32 s29, s86, s87
    s_and_b32 s87, s85, 3
    s_add_u32 s30, s86, s87
    s_lshr_b32 s31, s85, 2
    s_and_b32 s4, s3, 3
    s_lshr_b32 s5, s4, 1
    s_and_b32 s6, s4, 1
    s_lshr_b32 s7, s3, 2
    s_lshl_b32 s33, s4, 10
    s_waitcnt lgkmcnt(0)
    s_mov_b32 s68, s26
    s_mov_b32 s69, s27
    s_mov_b32 s70, 0x10000000
    s_mov_b32 s71, 0x20000
    s_cmp_lg_u32 s7, 0
    s_cbranch_scc1 L_teamB
    v_lshrrev_b32 v64, 4, v1
    v_bfe_u32 v65, v1, 2, 2
    v_and_b32 v66, 3, v1
    v_and_b32 v67, 15, v1
    v_lshrrev_b32 v68, 3, v1
    v_and_b32 v69, 7, v1
    s_lshl_b32 s85, s4, 3
    s_and_b32 s86, s4, 1
    s_lshl_b32 s86, s86, 2
    v_and_b32 v70, 2, v68
    v_xor_b32 v70, v70, v69
    v_xor_b32 v70, s86, v70
    v_add_u32 v71, s85, v68
    v_mul_u32_u24 v71, 7168, v71
    v_lshl_add_u32 v22, v70, 4, v71
    v_lshrrev_b32 v71, 2, v1
    s_lshl_b32 s86, s86, 2
    v_add_u32 v71, s86, v71
    v_mul_u32_u24 v71, 7168, v71
    v_and_b32 v70, 2, v64
    v_xor_b32 v70, v70, v66
    v_lshl_add_u32 v76, v70, 4, v71
    s_mul_i32 s85, s29, 320
    s_and_b32 s86, s29, 1
    s_lshl_b32 s87, s86, 6
    s_add_u32 s87, s87, s85
    s_add_u32 s40, s16, s87
    s_addc_u32 s41, s17, 0
    s_sub_u32 s42, 7340032, s87
    s_mov_b32 s43, 0x20000
    s_add_u32 s44, s18, s87
    s_addc_u32 s45, s19, 0
    s_sub_u32 s46, 7340032, s87
    s_mov_b32 s47, 0x20000
    s_xor_b32 s86, s86, 1
    s_lshl_b32 s86, s86, 8
    s_add_u32 s87, s86, s85
    s_cmp_lt_u32 s4, 2
    s_cselect_b32 s88, s16, s18
    s_cselect_b32 s89, s17, s19
    s_add_u32 s48, s88, s87
    s_addc_u32 s49, s89, 0
    s_sub_u32 s50, 7340032, s87
    s_mov_b32 s51, 0x20000
    s_and_b32 s77, s28, 3
    s_lshl2_add_u32 s77, s32, s77
    s_mul_i32 s77, s77, 917504
    s_add_u32 s77, s77, 0xfffc8000
    s_add_u32 m0, s33, 16384
    s_add_u32 s77, s77, 229376
    buffer_load_dwordx4 v22, s[40:43], s77 offen offset:0 lds
    s_add_u32 m0, s33, 20352
    s_nop 0
    buffer_load_dwordx4 v22, s[40:43], s77 offen offset:128 lds
    s_add_u32 m0, s33, 24576
    s_nop 0
    buffer_load_dwordx4 v22, s[44:47], s77 offen offset:0 lds
    s_add_u32 m0, s33, 28544
    s_nop 0
    buffer_load_dwordx4 v22, s[44:47], s77 offen offset:128 lds
    s_add_u32 m0, s33, 32768
    s_nop 0
    buffer_load_dwordx4 v76, s[48:51], s77 offen lds
    s_add_u32 m0, s33, 36864
    s_add_u32 s77, s77, 229376
    buffer_load_dwordx4 v22, s[40:43], s77 offen offset:0 lds
    s_add_u32 m0, s33, 40832
    s_nop 0
    buffer_load_dwordx4 v22, s[40:43], s77 offen offset:128 lds
    s_add_u32 m0, s33, 45056
    s_nop 0
    buffer_load_dwordx4 v22, s[44:47], s77 offen offset:0 lds
    s_add_u32 m0, s33, 49024
    s_nop 0
    buffer_load_dwordx4 v22, s[44:47], s77 offen offset:128 lds
    s_add_u32 m0, s33, 53248
    s_nop 0
    buffer_load_dwordx4 v76, s[48:51], s77 offen lds
    s_getpc_b64 s[92:93]
L_pc:
    s_lshl2_add_u32 s91, s15, s4
    s_lshl_b32 s91, s91, 9
    s_min_u32 s91, s91, L_code_end - L_pc - 512
    s_load_dword s94, s[92:93], s91 offset:0
    s_load_dword s94, s[92:93], s91 offset:64
    s_load_dword s94, s[92:93], s91 offset:128
    s_load_dword s94, s[92:93], s91 offset:192
    s_load_dword s94, s[92:93], s91 offset:256
    s_load_dword s94, s[92:93], s91 offset:320
    s_load_dword s94, s[92:93], s91 offset:384
    s_load_dword s94, s[92:93], s91 offset:448
    v_lshrrev_b32 v64, 4, v1
    v_bfe_u32 v65, v1, 2, 2
    v_and_b32 v66, 3, v1
    v_and_b32 v67, 15, v1
    v_lshrrev_b32 v68, 3, v1
    v_and_b32 v69, 7, v1
    s_lshl_b32 s85, s6, 12
    s_add_u32 s85, s85, 16384
    v_lshl_add_u32 v70, v64, 3, v65
    v_lshlrev_b32 v70, 7, v70
    v_and_b32 v71, 1, v66
    v_lshl_add_u32 v70, v71, 3, v70
    v_add_u32 v70, s85, v70
    v_and_b32 v71, 2, v65
    v_and_b32 v72, 1, v64
    v_lshl_add_u32 v71, v72, 2, v71
    v_lshrrev_b32 v72, 1, v66
    v_xor_b32 v71, v71, v72
    v_xor_b32 v72, 0, v71
    v_lshl_add_u32 v4, v72, 4, v70
    v_add_u32 v9, 40960, v4
    v_xor_b32 v72, 2, v71
    v_lshl_add_u32 v5, v72, 4, v70
    v_add_u32 v10, 40960, v5
    v_xor_b32 v72, 4, v71
    v_lshl_add_u32 v6, v72, 4, v70
    v_add_u32 v11, 40960, v6
    v_xor_b32 v72, 6, v71
    v_lshl_add_u32 v7, v72, 4, v70
    v_add_u32 v12, 40960, v7
    v_lshl_add_u32 v70, v64, 3, v65
    v_lshlrev_b32 v70, 6, v70
    v_and_b32 v71, 1, v66
    v_lshl_add_u32 v70, v71, 3, v70
    v_and_b32 v71, 1, v64
    v_xor_b32 v71, s6, v71
    v_lshl_add_u32 v70, v71, 5, v70
    v_lshrrev_b32 v71, 1, v66
    v_lshl_add_u32 v70, v71, 4, v70
    v_add_u32 v8, 16384, v70
    v_add_u32 v13, 57344, v70
    v_lshrrev_b32 v70, 1, v67
    v_xor_b32 v70, v70, v64
    v_lshlrev_b32 v70, 4, v70
    v_lshl_add_u32 v70, v67, 7, v70
    s_lshl_b32 s85, s5, 13
    v_add_u32 v16, s85, v70
    v_xor_b32 v17, 64, v16
    s_mov_b32 s80, 116736
    s_lshl_b32 s85, s28, 7
    s_lshl_b32 s86, s4, 5
    s_add_u32 s86, s85, s86
    v_add_u32 v71, s86, v68
    v_xor_b32 v70, v69, v64
    v_lshlrev_b32 v70, 4, v70
    v_lshl_add_u32 v20, v71, 11, v70
    v_xor_b32 v21, 64, v20
    v_add_u32 v21, 16384, v21
    s_lshl_b32 s79, s4, 12
    s_lshl_b32 s86, s28, 7
    s_sub_u32 s86, s86, 16
    s_max_i32 s86, s86, 0
    s_lshl_b32 s87, s4, 2
    v_add_u32 v71, s87, v68
    v_lshrrev_b32 v70, 1, v71
    v_and_b32 v70, 7, v70
    v_xor_b32 v70, v70, v69
    v_lshlrev_b32 v70, 4, v70
    v_add_u32 v71, s86, v71
    v_lshl_add_u32 v3, v71, 11, v70
    s_lshl_b32 s81, s4, 9
    s_lshl_b32 s85, s4, 3
    s_and_b32 s86, s4, 1
    s_lshl_b32 s86, s86, 2
    v_and_b32 v70, 2, v68
    v_xor_b32 v70, v70, v69
    v_xor_b32 v70, s86, v70
    v_add_u32 v71, s85, v68
    v_mul_u32_u24 v71, 6144, v71
    v_lshl_add_u32 v23, v70, 4, v71
    s_lshl_b32 s85, s6, 2
    v_lshl_add_u32 v70, v64, 3, v65
    v_lshlrev_b32 v70, 7, v70
    v_and_b32 v71, 1, v66
    v_lshl_add_u32 v70, v71, 3, v70
    v_add_u32 v70, 0, v70
    v_and_b32 v71, 2, v65
    v_and_b32 v72, 1, v64
    v_lshl_add_u32 v71, v72, 2, v71
    v_lshrrev_b32 v72, 1, v66
    v_xor_b32 v71, v71, v72
    v_xor_b32 v71, s85, v71
    v_xor_b32 v72, 0, v71
    v_lshl_add_u32 v250, v72, 4, v70
    v_add_u32 v252, 65536, v250
    v_xor_b32 v72, 2, v71
    v_lshl_add_u32 v251, v72, 4, v70
    v_add_u32 v253, 65536, v251
    s_lshl_b32 s85, s5, 12
    v_lshl_add_u32 v248, v1, 4, s85
    v_add_u32 v249, 65536, v248
    s_lshl_b32 s85, s4, 12
    v_lshl_add_u32 v18, v1, 4, s85
    s_lshl_b32 s85, s4, 4
    v_and_b32 v70, 2, v68
    v_xor_b32 v70, v70, v69
    v_xor_b32 v70, 0, v70
    v_add_u32 v71, s85, v68
    v_mul_u32_u24 v71, 2048, v71
    v_lshl_add_u32 v254, v70, 4, v71
    s_add_u32 s85, s85, 8
    v_and_b32 v70, 2, v68
    v_xor_b32 v70, v70, v69
    v_xor_b32 v70, 4, v70
    v_add_u32 v71, s85, v68
    v_mul_u32_u24 v71, 2048, v71
    v_lshl_add_u32 v255, v70, 4, v71
    s_lshl_b32 s85, s31, 8
    s_lshl_b32 s86, s32, 7
    s_add_u32 s86, s85, s86
    s_xor_b32 s87, s86, 128
    s_add_u32 s60, s20, s86
    s_addc_u32 s61, s21, 0
    s_sub_u32 s62, 7340032, s86
    s_mov_b32 s63, 0x20000
    s_add_u32 s64, s20, s87
    s_addc_u32 s65, s21, 0
    s_sub_u32 s66, 7340032, s87
    s_mov_b32 s67, 0x20000
    s_add_u32 s56, s26, 0x400000
    s_addc_u32 s57, s27, 0
    s_mov_b32 s58, 0xe00000
    s_mov_b32 s59, 0x20000
    s_mul_i32 s82, s30, 917504
    s_mul_i32 s85, s32, 327680
    s_add_u32 s82, s82, s85
    s_mul_i32 s83, s32, 2621440
    s_mul_i32 s85, s32, 24
    s_sub_u32 s85, 40, s85
    s_lshl_b32 s14, s85, 13
    s_lshl_b32 s35, s85, 16
    v_lshrrev_b32 v78, 4, v1
    v_and_b32 v79, 1, v78
    v_lshrrev_b32 v78, 1, v78
    v_lshlrev_b32 v78, 8, v78
    v_lshl_add_u32 v78, v79, 10, v78
    v_and_b32 v79, 15, v1
    v_lshl_add_u32 v19, v79, 4, v78
    s_mul_i32 s84, s28, 112
    s_mul_i32 s85, s29, 5
    s_add_u32 s84, s84, s85
    s_lshl_b32 s84, s84, 13
    s_lshl_b32 s85, s5, 12
    s_add_u32 s84, s84, s85
    s_add_u32 s84, s84, 0x400000
    s_and_b32 s85, s29, 1
    s_lshl1_add_u32 s86, s6, s85
    s_lshl_b32 s86, s86, 13
    s_add_u32 s72, s84, s86
    s_add_u32 s73, s72, 8192
    s_xor_b32 s85, s85, 1
    s_lshl_b32 s85, s85, 15
    s_add_u32 s84, s84, s85
    s_lshl_b32 s85, s6, 9
    s_add_u32 s74, s84, s85
    s_lshl2_add_u32 s91, s2, s4
    s_lshl_b32 s75, s91, 9
    s_lshr_b32 s92, s91, 2
    s_mul_i32 s92, s92, 7168
    s_and_b32 s91, s91, 3
    s_lshl_b32 s91, s91, 9
    s_add_u32 s92, s92, s91
    s_add_u32 s99, s92, 5120
    s_mov_b32 s36, s26
    s_mov_b32 s37, s27
    s_mov_b32 s38, 0x400000
    s_mov_b32 s39, 0x20000
    s_lshl_b32 s85, s29, 7
    s_add_u32 s40, s10, s85
    s_addc_u32 s41, s11, 0
    s_sub_u32 s42, 6291456, s85
    s_mov_b32 s43, 0x20000
    s_add_u32 s86, s85, 4096
    s_add_u32 s44, s10, s86
    s_addc_u32 s45, s11, 0
    s_sub_u32 s46, 6291456, s86
    s_mov_b32 s47, 0x20000
    s_add_u32 s86, s85, 5120
    s_add_u32 s48, s16, s86
    s_addc_u32 s49, s17, 0
    s_sub_u32 s50, 7340032, s86
    s_mov_b32 s51, 0x20000
    s_add_u32 s52, s18, s86
    s_addc_u32 s53, s19, 0
    s_sub_u32 s54, 7340032, s86
    s_mov_b32 s55, 0x20000
    s_setprio 1
    s_waitcnt vmcnt(5)
    s_barrier
    v_add_u32 v14, s80, v16
    v_add_u32 v15, s80, v17
    s_add_u32 s80, s80, 18432
    s_cmp_ge_u32 s80, 153600
    s_cselect_b32 s84, 55296, 0
    s_sub_u32 s80, s80, s84
    ds_read_b64_tr_b16 v[64:65], v4 offset:0
    ds_read_b64_tr_b16 v[66:67], v4 offset:512
    ds_read_b128 v[24:27], v14 offset:0
    ds_read_b128 v[28:31], v14 offset:2048
    ds_read_b128 v[32:35], v14 offset:4096
    ds_read_b128 v[36:39], v14 offset:6144
    ds_read_b64_tr_b16 v[68:69], v4 offset:8192
    ds_read_b64_tr_b16 v[70:71], v4 offset:8704
    ds_read_b64_tr_b16 v[72:73], v5 offset:0
    ds_read_b64_tr_b16 v[74:75], v5 offset:512
    s_waitcnt lgkmcnt(7)
    v_mfma_f32_16x16x32_bf16 v[88:91], v[64:67], v[24:27], 0
    ds_read_b64_tr_b16 v[76:77], v5 offset:8192
    s_waitcnt lgkmcnt(7)
    v_mfma_f32_16x16x32_bf16 v[92:95], v[64:67], v[28:31], 0
    ds_read_b64_tr_b16 v[78:79], v5 offset:8704
    s_waitcnt lgkmcnt(7)
    v_mfma_f32_16x16x32_bf16 v[96:99], v[64:67], v[32:35], 0
    ds_read_b64_tr_b16 v[80:81], v6 offset:0
    s_waitcnt lgkmcnt(7)
    v_mfma_f32_16x16x32_bf16 v[100:103], v[64:67], v[36:39], 0
    ds_read_b64_tr_b16 v[82:83], v6 offset:512
    s_waitcnt lgkmcnt(6)
    v_mfma_f32_16x16x32_bf16 v[104:107], v[68:71], v[24:27], 0
    ds_read_b64_tr_b16 v[64:65], v6 offset:8192
    v_mfma_f32_16x16x32_bf16 v[108:111], v[68:71], v[28:31], 0
    v_mfma_f32_16x16x32_bf16 v[112:115], v[68:71], v[32:35], 0
    ds_read_b64_tr_b16 v[66:67], v6 offset:8704
    v_mfma_f32_16x16x32_bf16 v[116:119], v[68:71], v[36:39], 0
    s_waitcnt lgkmcnt(6)
    v_mfma_f32_16x16x32_bf16 v[120:123], v[72:75], v[24:27], 0
    ds_read_b64_tr_b16 v[68:69], v7 offset:0
    v_mfma_f32_16x16x32_bf16 v[124:127], v[72:75], v[28:31], 0
    v_mfma_f32_16x16x32_bf16 v[128:131], v[72:75], v[32:35], 0
    ds_read_b64_tr_b16 v[70:71], v7 offset:512
    v_mfma_f32_16x16x32_bf16 v[132:135], v[72:75], v[36:39], 0
    s_waitcnt lgkmcnt(6)
    v_mfma_f32_16x16x32_bf16 v[136:139], v[76:79], v[24:27], 0
    ds_read_b64_tr_b16 v[72:73], v7 offset:8192
    v_mfma_f32_16x16x32_bf16 v[140:143], v[76:79], v[28:31], 0
    v_mfma_f32_16x16x32_bf16 v[144:147], v[76:79], v[32:35], 0
    ds_read_b64_tr_b16 v[74:75], v7 offset:8704
    v_mfma_f32_16x16x32_bf16 v[148:151], v[76:79], v[36:39], 0
    s_waitcnt lgkmcnt(6)
    v_mfma_f32_16x16x32_bf16 v[152:155], v[80:83], v[24:27], 0
    ds_read_b64_tr_b16 v[76:77], v8 offset:16384
    v_mfma_f32_16x16x32_bf16 v[156:159], v[80:83], v[28:31], 0
    v_mfma_f32_16x16x32_bf16 v[160:163], v[80:83], v[32:35], 0
    ds_read_b64_tr_b16 v[78:79], v8 offset:16640
    v_mfma_f32_16x16x32_bf16 v[164:167], v[80:83], v[36:39], 0
    s_waitcnt lgkmcnt(6)
    v_mfma_f32_16x16x32_bf16 v[168:171], v[64:67], v[24:27], 0
    ds_read_b64_tr_b16 v[80:81], v8 offset:18432
    v_mfma_f32_16x16x32_bf16 v[172:175], v[64:67], v[28:31], 0
    v_mfma_f32_16x16x32_bf16 v[176:179], v[64:67], v[32:35], 0
    ds_read_b64_tr_b16 v[82:83], v8 offset:18688
    v_mfma_f32_16x16x32_bf16 v[180:183], v[64:67], v[36:39], 0
    s_waitcnt lgkmcnt(6)
    v_mfma_f32_16x16x32_bf16 v[184:187], v[68:71], v[24:27], 0
    v_mfma_f32_16x16x32_bf16 v[188:191], v[68:71], v[28:31], 0
    v_mfma_f32_16x16x32_bf16 v[192:195], v[68:71], v[32:35], 0
    v_mfma_f32_16x16x32_bf16 v[196:199], v[68:71], v[36:39], 0
    s_waitcnt vmcnt(0) lgkmcnt(0)
    s_barrier
    v_mfma_f32_16x16x32_bf16 v[200:203], v[72:75], v[24:27], 0
    ds_read_b64_tr_b16 v[64:65], v4 offset:20480
    v_mfma_f32_16x16x32_bf16 v[204:207], v[72:75], v[28:31], 0
    ds_read_b64_tr_b16 v[66:67], v4 offset:20992
    v_mfma_f32_16x16x32_bf16 v[208:211], v[72:75], v[32:35], 0
    ds_read_b128 v[40:43], v15 offset:0
    v_mfma_f32_16x16x32_bf16 v[212:215], v[72:75], v[36:39], 0
    ds_read_b128 v[44:47], v15 offset:2048
    v_mfma_f32_16x16x32_bf16 v[216:219], v[76:79], v[24:27], 0
    ds_read_b128 v[48:51], v15 offset:4096
    v_mfma_f32_16x16x32_bf16 v[220:223], v[76:79], v[28:31], 0
    ds_read_b128 v[52:55], v15 offset:6144
    v_mfma_f32_16x16x32_bf16 v[224:227], v[76:79], v[32:35], 0
    ds_read_b64_tr_b16 v[68:69], v4 offset:28672
    v_mfma_f32_16x16x32_bf16 v[228:231], v[76:79], v[36:39], 0
    ds_read_b64_tr_b16 v[70:71], v4 offset:29184
    v_mfma_f32_16x16x32_bf16 v[232:235], v[80:83], v[24:27], 0
    ds_read_b64_tr_b16 v[72:73], v5 offset:20480
    v_mfma_f32_16x16x32_bf16 v[236:239], v[80:83], v[28:31], 0
    v_mfma_f32_16x16x32_bf16 v[240:243], v[80:83], v[32:35], 0
    ds_read_b64_tr_b16 v[74:75], v5 offset:20992
    v_mfma_f32_16x16x32_bf16 v[244:247], v[80:83], v[36:39], 0
    s_waitcnt lgkmcnt(7)
    v_mfma_f32_16x16x32_bf16 v[88:91], v[64:67], v[40:43], v[88:91]
    ds_read_b64_tr_b16 v[76:77], v5 offset:28672
    s_waitcnt lgkmcnt(7)
    v_mfma_f32_16x16x32_bf16 v[92:95], v[64:67], v[44:47], v[92:95]
    ds_read_b64_tr_b16 v[78:79], v5 offset:29184
    s_waitcnt lgkmcnt(7)
    v_mfma_f32_16x16x32_bf16 v[96:99], v[64:67], v[48:51], v[96:99]
    ds_read_b64_tr_b16 v[80:81], v6 offset:20480
    s_waitcnt lgkmcnt(7)
    v_mfma_f32_16x16x32_bf16 v[100:103], v[64:67], v[52:55], v[100:103]
    ds_read_b64_tr_b16 v[82:83], v6 offset:20992
    s_waitcnt lgkmcnt(6)
    v_mfma_f32_16x16x32_bf16 v[104:107], v[68:71], v[40:43], v[104:107]
    ds_read_b64_tr_b16 v[64:65], v6 offset:28672
    v_mfma_f32_16x16x32_bf16 v[108:111], v[68:71], v[44:47], v[108:111]
    v_add_u32 v14, s80, v16
    v_mfma_f32_16x16x32_bf16 v[112:115], v[68:71], v[48:51], v[112:115]
    ds_read_b64_tr_b16 v[66:67], v6 offset:29184
    v_mfma_f32_16x16x32_bf16 v[116:119], v[68:71], v[52:55], v[116:119]
    v_add_u32 v15, s80, v17
    s_waitcnt lgkmcnt(6)
    v_mfma_f32_16x16x32_bf16 v[120:123], v[72:75], v[40:43], v[120:123]
    ds_read_b64_tr_b16 v[68:69], v7 offset:20480
    v_mfma_f32_16x16x32_bf16 v[124:127], v[72:75], v[44:47], v[124:127]
    s_add_u32 s80, s80, 18432
    v_mfma_f32_16x16x32_bf16 v[128:131], v[72:75], v[48:51], v[128:131]
    ds_read_b64_tr_b16 v[70:71], v7 offset:20992
    v_mfma_f32_16x16x32_bf16 v[132:135], v[72:75], v[52:55], v[132:135]
    s_cmp_ge_u32 s80, 153600
    s_cselect_b32 s84, 55296, 0
    s_waitcnt lgkmcnt(6)
    v_mfma_f32_16x16x32_bf16 v[136:139], v[76:79], v[40:43], v[136:139]
    ds_read_b64_tr_b16 v[72:73], v7 offset:28672
    v_mfma_f32_16x16x32_bf16 v[140:143], v[76:79], v[44:47], v[140:143]
    s_sub_u32 s80, s80, s84
    v_mfma_f32_16x16x32_bf16 v[144:147], v[76:79], v[48:51], v[144:147]
    ds_read_b64_tr_b16 v[74:75], v7 offset:29184
    v_mfma_f32_16x16x32_bf16 v[148:151], v[76:79], v[52:55], v[148:151]
    s_waitcnt lgkmcnt(6)
    v_mfma_f32_16x16x32_bf16 v[152:155], v[80:83], v[40:43], v[152:155]
    ds_read_b64_tr_b16 v[76:77], v8 offset:36864
    v_mfma_f32_16x16x32_bf16 v[156:159], v[80:83], v[44:47], v[156:159]
    v_mfma_f32_16x16x32_bf16 v[160:163], v[80:83], v[48:51], v[160:163]
    ds_read_b64_tr_b16 v[78:79], v8 offset:37120
    v_mfma_f32_16x16x32_bf16 v[164:167], v[80:83], v[52:55], v[164:167]
    s_waitcnt lgkmcnt(6)
    v_mfma_f32_16x16x32_bf16 v[168:171], v[64:67], v[40:43], v[168:171]
    ds_read_b64_tr_b16 v[80:81], v8 offset:38912
    v_mfma_f32_16x16x32_bf16 v[172:175], v[64:67], v[44:47], v[172:175]
    v_mfma_f32_16x16x32_bf16 v[176:179], v[64:67], v[48:51], v[176:179]
    ds_read_b64_tr_b16 v[82:83], v8 offset:39168
    v_mfma_f32_16x16x32_bf16 v[180:183], v[64:67], v[52:55], v[180:183]
    s_waitcnt lgkmcnt(6)
    v_mfma_f32_16x16x32_bf16 v[184:187], v[68:71], v[40:43], v[184:187]
    v_mfma_f32_16x16x32_bf16 v[188:191], v[68:71], v[44:47], v[188:191]
    v_mfma_f32_16x16x32_bf16 v[192:195], v[68:71], v[48:51], v[192:195]
    v_mfma_f32_16x16x32_bf16 v[196:199], v[68:71], v[52:55], v[196:199]
    s_waitcnt lgkmcnt(0)
    s_barrier
    v_mfma_f32_16x16x32_bf16 v[200:203], v[72:75], v[40:43], v[200:203]
    ds_read_b64_tr_b16 v[64:65], v9 offset:0
    v_mfma_f32_16x16x32_bf16 v[204:207], v[72:75], v[44:47], v[204:207]
    ds_read_b64_tr_b16 v[66:67], v9 offset:512
    v_mfma_f32_16x16x32_bf16 v[208:211], v[72:75], v[48:51], v[208:211]
    ds_read_b128 v[24:27], v14 offset:0
    v_mfma_f32_16x16x32_bf16 v[212:215], v[72:75], v[52:55], v[212:215]
    ds_read_b128 v[28:31], v14 offset:2048
    v_mfma_f32_16x16x32_bf16 v[216:219], v[76:79], v[40:43], v[216:219]
    ds_read_b128 v[32:35], v14 offset:4096
    v_mfma_f32_16x16x32_bf16 v[220:223], v[76:79], v[44:47], v[220:223]
    ds_read_b128 v[36:39], v14 offset:6144
    v_mfma_f32_16x16x32_bf16 v[224:227], v[76:79], v[48:51], v[224:227]
    ds_read_b64_tr_b16 v[68:69], v9 offset:8192
    v_mfma_f32_16x16x32_bf16 v[228:231], v[76:79], v[52:55], v[228:231]
    ds_read_b64_tr_b16 v[70:71], v9 offset:8704
    v_mfma_f32_16x16x32_bf16 v[232:235], v[80:83], v[40:43], v[232:235]
    ds_read_b64_tr_b16 v[72:73], v10 offset:0
    v_mfma_f32_16x16x32_bf16 v[236:239], v[80:83], v[44:47], v[236:239]
    v_mfma_f32_16x16x32_bf16 v[240:243], v[80:83], v[48:51], v[240:243]
    ds_read_b64_tr_b16 v[74:75], v10 offset:512
    v_mfma_f32_16x16x32_bf16 v[244:247], v[80:83], v[52:55], v[244:247]
    s_waitcnt lgkmcnt(7)
    v_mfma_f32_16x16x32_bf16 v[88:91], v[64:67], v[24:27], v[88:91]
    ds_read_b64_tr_b16 v[76:77], v10 offset:8192
    s_waitcnt lgkmcnt(7)
    v_mfma_f32_16x16x32_bf16 v[92:95], v[64:67], v[28:31], v[92:95]
    ds_read_b64_tr_b16 v[78:79], v10 offset:8704
    s_waitcnt lgkmcnt(7)
    v_mfma_f32_16x16x32_bf16 v[96:99], v[64:67], v[32:35], v[96:99]
    ds_read_b64_tr_b16 v[80:81], v11 offset:0
    s_waitcnt lgkmcnt(7)
    v_mfma_f32_16x16x32_bf16 v[100:103], v[64:67], v[36:39], v[100:103]
    ds_read_b64_tr_b16 v[82:83], v11 offset:512
    s_waitcnt lgkmcnt(6)
    v_mfma_f32_16x16x32_bf16 v[104:107], v[68:71], v[24:27], v[104:107]
    ds_read_b64_tr_b16 v[64:65], v11 offset:8192
    v_mfma_f32_16x16x32_bf16 v[108:111], v[68:71], v[28:31], v[108:111]
    v_mfma_f32_16x16x32_bf16 v[112:115], v[68:71], v[32:35], v[112:115]
    ds_read_b64_tr_b16 v[66:67], v11 offset:8704
    v_mfma_f32_16x16x32_bf16 v[116:119], v[68:71], v[36:39], v[116:119]
    s_waitcnt lgkmcnt(6)
    v_mfma_f32_16x16x32_bf16 v[120:123], v[72:75], v[24:27], v[120:123]
    ds_read_b64_tr_b16 v[68:69], v12 offset:0
    v_mfma_f32_16x16x32_bf16 v[124:127], v[72:75], v[28:31], v[124:127]
    v_mfma_f32_16x16x32_bf16 v[128:131], v[72:75], v[32:35], v[128:131]
    ds_read_b64_tr_b16 v[70:71], v12 offset:512
    v_mfma_f32_16x16x32_bf16 v[132:135], v[72:75], v[36:39], v[132:135]
    s_waitcnt lgkmcnt(6)
    v_mfma_f32_16x16x32_bf16 v[136:139], v[76:79], v[24:27], v[136:139]
    ds_read_b64_tr_b16 v[72:73], v12 offset:8192
    v_mfma_f32_16x16x32_bf16 v[140:143], v[76:79], v[28:31], v[140:143]
    v_mfma_f32_16x16x32_bf16 v[144:147], v[76:79], v[32:35], v[144:147]
    ds_read_b64_tr_b16 v[74:75], v12 offset:8704
    v_mfma_f32_16x16x32_bf16 v[148:151], v[76:79], v[36:39], v[148:151]
    s_waitcnt lgkmcnt(6)
    v_mfma_f32_16x16x32_bf16 v[152:155], v[80:83], v[24:27], v[152:155]
    ds_read_b64_tr_b16 v[76:77], v13 offset:16384
    v_mfma_f32_16x16x32_bf16 v[156:159], v[80:83], v[28:31], v[156:159]
    v_mfma_f32_16x16x32_bf16 v[160:163], v[80:83], v[32:35], v[160:163]
    ds_read_b64_tr_b16 v[78:79], v13 offset:16640
    v_mfma_f32_16x16x32_bf16 v[164:167], v[80:83], v[36:39], v[164:167]
    s_waitcnt lgkmcnt(6)
    v_mfma_f32_16x16x32_bf16 v[168:171], v[64:67], v[24:27], v[168:171]
    ds_read_b64_tr_b16 v[80:81], v13 offset:18432
    v_mfma_f32_16x16x32_bf16 v[172:175], v[64:67], v[28:31], v[172:175]
    v_mfma_f32_16x16x32_bf16 v[176:179], v[64:67], v[32:35], v[176:179]
    ds_read_b64_tr_b16 v[82:83], v13 offset:18688
    v_mfma_f32_16x16x32_bf16 v[180:183], v[64:67], v[36:39], v[180:183]
    s_waitcnt lgkmcnt(6)
    v_mfma_f32_16x16x32_bf16 v[184:187], v[68:71], v[24:27], v[184:187]
    v_mfma_f32_16x16x32_bf16 v[188:191], v[68:71], v[28:31], v[188:191]
    v_mfma_f32_16x16x32_bf16 v[192:195], v[68:71], v[32:35], v[192:195]
    v_mfma_f32_16x16x32_bf16 v[196:199], v[68:71], v[36:39], v[196:199]
    s_waitcnt lgkmcnt(0)
    s_barrier
    v_mfma_f32_16x16x32_bf16 v[200:203], v[72:75], v[24:27], v[200:203]
    ds_read_b64_tr_b16 v[64:65], v9 offset:20480
    v_mfma_f32_16x16x32_bf16 v[204:207], v[72:75], v[28:31], v[204:207]
    ds_read_b64_tr_b16 v[66:67], v9 offset:20992
    v_mfma_f32_16x16x32_bf16 v[208:211], v[72:75], v[32:35], v[208:211]
    ds_read_b128 v[40:43], v15 offset:0
    v_mfma_f32_16x16x32_bf16 v[212:215], v[72:75], v[36:39], v[212:215]
    ds_read_b128 v[44:47], v15 offset:2048
    v_mfma_f32_16x16x32_bf16 v[216:219], v[76:79], v[24:27], v[216:219]
    ds_read_b128 v[48:51], v15 offset:4096
    v_mfma_f32_16x16x32_bf16 v[220:223], v[76:79], v[28:31], v[220:223]
    ds_read_b128 v[52:55], v15 offset:6144
    v_mfma_f32_16x16x32_bf16 v[224:227], v[76:79], v[32:35], v[224:227]
    ds_read_b64_tr_b16 v[68:69], v9 offset:28672
    v_mfma_f32_16x16x32_bf16 v[228:231], v[76:79], v[36:39], v[228:231]
    ds_read_b64_tr_b16 v[70:71], v9 offset:29184
    v_mfma_f32_16x16x32_bf16 v[232:235], v[80:83], v[24:27], v[232:235]
    ds_read_b64_tr_b16 v[72:73], v10 offset:20480
    v_mfma_f32_16x16x32_bf16 v[236:239], v[80:83], v[28:31], v[236:239]
    v_mfma_f32_16x16x32_bf16 v[240:243], v[80:83], v[32:35], v[240:243]
    ds_read_b64_tr_b16 v[74:75], v10 offset:20992
    v_mfma_f32_16x16x32_bf16 v[244:247], v[80:83], v[36:39], v[244:247]
    s_waitcnt lgkmcnt(7)
    v_mfma_f32_16x16x32_bf16 v[88:91], v[64:67], v[40:43], v[88:91]
    ds_read_b64_tr_b16 v[76:77], v10 offset:28672
    s_waitcnt lgkmcnt(7)
    v_mfma_f32_16x16x32_bf16 v[92:95], v[64:67], v[44:47], v[92:95]
    ds_read_b64_tr_b16 v[78:79], v10 offset:29184
    s_waitcnt lgkmcnt(7)
    v_mfma_f32_16x16x32_bf16 v[96:99], v[64:67], v[48:51], v[96:99]
    ds_read_b64_tr_b16 v[80:81], v11 offset:20480
    s_waitcnt lgkmcnt(7)
    v_mfma_f32_16x16x32_bf16 v[100:103], v[64:67], v[52:55], v[100:103]
    ds_read_b64_tr_b16 v[82:83], v11 offset:20992
    s_waitcnt lgkmcnt(6)
    v_mfma_f32_16x16x32_bf16 v[104:107], v[68:71], v[40:43], v[104:107]
    ds_read_b64_tr_b16 v[64:65], v11 offset:28672
    v_mfma_f32_16x16x32_bf16 v[108:111], v[68:71], v[44:47], v[108:111]
    v_add_u32 v14, s80, v16
    v_mfma_f32_16x16x32_bf16 v[112:115], v[68:71], v[48:51], v[112:115]
    ds_read_b64_tr_b16 v[66:67], v11 offset:29184
    v_mfma_f32_16x16x32_bf16 v[116:119], v[68:71], v[52:55], v[116:119]
    v_add_u32 v15, s80, v17
    s_waitcnt lgkmcnt(6)
    v_mfma_f32_16x16x32_bf16 v[120:123], v[72:75], v[40:43], v[120:123]
    ds_read_b64_tr_b16 v[68:69], v12 offset:20480
    v_mfma_f32_16x16x32_bf16 v[124:127], v[72:75], v[44:47], v[124:127]
    s_add_u32 s80, s80, 18432
    v_mfma_f32_16x16x32_bf16 v[128:131], v[72:75], v[48:51], v[128:131]
    ds_read_b64_tr_b16 v[70:71], v12 offset:20992
    v_mfma_f32_16x16x32_bf16 v[132:135], v[72:75], v[52:55], v[132:135]
    s_cmp_ge_u32 s80, 153600
    s_cselect_b32 s84, 55296, 0
    s_waitcnt lgkmcnt(6)
    v_mfma_f32_16x16x32_bf16 v[136:139], v[76:79], v[40:43], v[136:139]
    ds_read_b64_tr_b16 v[72:73], v12 offset:28672
    v_mfma_f32_16x16x32_bf16 v[140:143], v[76:79], v[44:47], v[140:143]
    s_sub_u32 s80, s80, s84
    v_mfma_f32_16x16x32_bf16 v[144:147], v[76:79], v[48:51], v[144:147]
    ds_read_b64_tr_b16 v[74:75], v12 offset:29184
    v_mfma_f32_16x16x32_bf16 v[148:151], v[76:79], v[52:55], v[148:151]
    s_waitcnt lgkmcnt(6)
    v_mfma_f32_16x16x32_bf16 v[152:155], v[80:83], v[40:43], v[152:155]
    ds_read_b64_tr_b16 v[76:77], v13 offset:36864
    v_mfma_f32_16x16x32_bf16 v[156:159], v[80:83], v[44:47], v[156:159]
    v_mfma_f32_16x16x32_bf16 v[160:163], v[80:83], v[48:51], v[160:163]
    ds_read_b64_tr_b16 v[78:79], v13 offset:37120
    v_mfma_f32_16x16x32_bf16 v[164:167], v[80:83], v[52:55], v[164:167]
    s_waitcnt lgkmcnt(6)
    v_mfma_f32_16x16x32_bf16 v[168:171], v[64:67], v[40:43], v[168:171]
    ds_read_b64_tr_b16 v[80:81], v13 offset:38912
    v_mfma_f32_16x16x32_bf16 v[172:175], v[64:67], v[44:47], v[172:175]
    v_mfma_f32_16x16x32_bf16 v[176:179], v[64:67], v[48:51], v[176:179]
    ds_read_b64_tr_b16 v[82:83], v13 offset:39168
    v_mfma_f32_16x16x32_bf16 v[180:183], v[64:67], v[52:55], v[180:183]
    s_waitcnt lgkmcnt(6)
    v_mfma_f32_16x16x32_bf16 v[184:187], v[68:71], v[40:43], v[184:187]
    v_mfma_f32_16x16x32_bf16 v[188:191], v[68:71], v[44:47], v[188:191]
    v_mfma_f32_16x16x32_bf16 v[192:195], v[68:71], v[48:51], v[192:195]
    v_mfma_f32_16x16x32_bf16 v[196:199], v[68:71], v[52:55], v[196:199]
    s_waitcnt lgkmcnt(0)
    s_barrier
    v_mfma_f32_16x16x32_bf16 v[200:203], v[72:75], v[40:43], v[200:203]
    ds_read_b64_tr_b16 v[64:65], v4 offset:0
    v_mfma_f32_16x16x32_bf16 v[204:207], v[72:75], v[44:47], v[204:207]
    ds_read_b64_tr_b16 v[66:67], v4 offset:512
    v_mfma_f32_16x16x32_bf16 v[208:211], v[72:75], v[48:51], v[208:211]
    ds_read_b128 v[24:27], v14 offset:0
    v_mfma_f32_16x16x32_bf16 v[212:215], v[72:75], v[52:55], v[212:215]
    ds_read_b128 v[28:31], v14 offset:2048
    v_mfma_f32_16x16x32_bf16 v[216:219], v[76:79], v[40:43], v[216:219]
    ds_read_b128 v[32:35], v14 offset:4096
    v_mfma_f32_16x16x32_bf16 v[220:223], v[76:79], v[44:47], v[220:223]
    ds_read_b128 v[36:39], v14 offset:6144
    v_mfma_f32_16x16x32_bf16 v[224:227], v[76:79], v[48:51], v[224:227]
    ds_read_b64_tr_b16 v[68:69], v4 offset:8192
    v_mfma_f32_16x16x32_bf16 v[228:231], v[76:79], v[52:55], v[228:231]
    ds_read_b64_tr_b16 v[70:71], v4 offset:8704
    v_mfma_f32_16x16x32_bf16 v[232:235], v[80:83], v[40:43], v[232:235]
    ds_read_b64_tr_b16 v[72:73], v5 offset:0
    v_mfma_f32_16x16x32_bf16 v[236:239], v[80:83], v[44:47], v[236:239]
    v_mfma_f32_16x16x32_bf16 v[240:243], v[80:83], v[48:51], v[240:243]
    ds_read_b64_tr_b16 v[74:75], v5 offset:512
    v_mfma_f32_16x16x32_bf16 v[244:247], v[80:83], v[52:55], v[244:247]
    s_or_b32 s91, s2, s4
    s_cbranch_scc1 L_notok
    s_memrealtime s[92:93]
    v_mov_b32 v60, 0
    s_waitcnt lgkmcnt(0)
    s_or_b32 s92, s92, 1
    v_mov_b32 v62, s92
    v_mov_b32 v63, s93
    s_mov_b64 exec, 1
    global_store_dwordx2 v60, v[62:63], s[24:25] sc1
    s_mov_b64 exec, -1
L_notok:
    s_mov_b32 s34, 6
.p2align 6
L_p1:
    s_waitcnt lgkmcnt(7)
    v_mfma_f32_16x16x32_bf16 v[88:91], v[64:67], v[24:27], v[88:91]
    ds_read_b64_tr_b16 v[76:77], v5 offset:8192
    s_waitcnt lgkmcnt(7)
    v_mfma_f32_16x16x32_bf16 v[92:95], v[64:67], v[28:31], v[92:95]
    ds_read_b64_tr_b16 v[78:79], v5 offset:8704
    s_waitcnt lgkmcnt(7)
    v_mfma_f32_16x16x32_bf16 v[96:99], v[64:67], v[32:35], v[96:99]
    ds_read_b64_tr_b16 v[80:81], v6 offset:0
    s_waitcnt lgkmcnt(7)
    v_mfma_f32_16x16x32_bf16 v[100:103], v[64:67], v[36:39], v[100:103]
    ds_read_b64_tr_b16 v[82:83], v6 offset:512
    s_waitcnt lgkmcnt(6)
    v_mfma_f32_16x16x32_bf16 v[104:107], v[68:71], v[24:27], v[104:107]
    ds_read_b64_tr_b16 v[64:65], v6 offset:8192
    v_mfma_f32_16x16x32_bf16 v[108:111], v[68:71], v[28:31], v[108:111]
    v_mfma_f32_16x16x32_bf16 v[112:115], v[68:71], v[32:35], v[112:115]
    ds_read_b64_tr_b16 v[66:67], v6 offset:8704
    v_mfma_f32_16x16x32_bf16 v[116:119], v[68:71], v[36:39], v[116:119]
    s_waitcnt lgkmcnt(6)
    v_mfma_f32_16x16x32_bf16 v[120:123], v[72:75], v[24:27], v[120:123]
    ds_read_b64_tr_b16 v[68:69], v7 offset:0
    v_mfma_f32_16x16x32_bf16 v[124:127], v[72:75], v[28:31], v[124:127]
    v_mfma_f32_16x16x32_bf16 v[128:131], v[72:75], v[32:35], v[128:131]
    ds_read_b64_tr_b16 v[70:71], v7 offset:512
    v_mfma_f32_16x16x32_bf16 v[132:135], v[72:75], v[36:39], v[132:135]
    s_waitcnt lgkmcnt(6)
    v_mfma_f32_16x16x32_bf16 v[136:139], v[76:79], v[24:27], v[136:139]
    ds_read_b64_tr_b16 v[72:73], v7 offset:8192
    v_mfma_f32_16x16x32_bf16 v[140:143], v[76:79], v[28:31], v[140:143]
    v_mfma_f32_16x16x32_bf16 v[144:147], v[76:79], v[32:35], v[144:147]
    ds_read_b64_tr_b16 v[74:75], v7 offset:8704
    v_mfma_f32_16x16x32_bf16 v[148:151], v[76:79], v[36:39], v[148:151]
    s_waitcnt lgkmcnt(6)
    v_mfma_f32_16x16x32_bf16 v[152:155], v[80:83], v[24:27], v[152:155]
    ds_read_b64_tr_b16 v[76:77], v8 offset:16384
    v_mfma_f32_16x16x32_bf16 v[156:159], v[80:83], v[28:31], v[156:159]
    v_mfma_f32_16x16x32_bf16 v[160:163], v[80:83], v[32:35], v[160:163]
    ds_read_b64_tr_b16 v[78:79], v8 offset:16640
    v_mfma_f32_16x16x32_bf16 v[164:167], v[80:83], v[36:39], v[164:167]
    s_waitcnt lgkmcnt(6)
    v_mfma_f32_16x16x32_bf16 v[168:171], v[64:67], v[24:27], v[168:171]
    ds_read_b64_tr_b16 v[80:81], v8 offset:18432
    v_mfma_f32_16x16x32_bf16 v[172:175], v[64:67], v[28:31], v[172:175]
    v_mfma_f32_16x16x32_bf16 v[176:179], v[64:67], v[32:35], v[176:179]
    ds_read_b64_tr_b16 v[82:83], v8 offset:18688
    v_mfma_f32_16x16x32_bf16 v[180:183], v[64:67], v[36:39], v[180:183]
    s_waitcnt lgkmcnt(6)
    v_mfma_f32_16x16x32_bf16 v[184:187], v[68:71], v[24:27], v[184:187]
    v_mfma_f32_16x16x32_bf16 v[188:191], v[68:71], v[28:31], v[188:191]
    v_mfma_f32_16x16x32_bf16 v[192:195], v[68:71], v[32:35], v[192:195]
    v_mfma_f32_16x16x32_bf16 v[196:199], v[68:71], v[36:39], v[196:199]
    s_waitcnt lgkmcnt(0)
    s_barrier
    v_mfma_f32_16x16x32_bf16 v[200:203], v[72:75], v[24:27], v[200:203]
    ds_read_b64_tr_b16 v[64:65], v4 offset:20480
    v_mfma_f32_16x16x32_bf16 v[204:207], v[72:75], v[28:31], v[204:207]
    ds_read_b64_tr_b16 v[66:67], v4 offset:20992
    v_mfma_f32_16x16x32_bf16 v[208:211], v[72:75], v[32:35], v[208:211]
    ds_read_b128 v[40:43], v15 offset:0
    v_mfma_f32_16x16x32_bf16 v[212:215], v[72:75], v[36:39], v[212:215]
    ds_read_b128 v[44:47], v15 offset:2048
    v_mfma_f32_16x16x32_bf16 v[216:219], v[76:79], v[24:27], v[216:219]
    ds_read_b128 v[48:51], v15 offset:4096
    v_mfma_f32_16x16x32_bf16 v[220:223], v[76:79], v[28:31], v[220:223]
    ds_read_b128 v[52:55], v15 offset:6144
    v_mfma_f32_16x16x32_bf16 v[224:227], v[76:79], v[32:35], v[224:227]
    ds_read_b64_tr_b16 v[68:69], v4 offset:28672
    v_mfma_f32_16x16x32_bf16 v[228:231], v[76:79], v[36:39], v[228:231]
    ds_read_b64_tr_b16 v[70:71], v4 offset:29184
    v_mfma_f32_16x16x32_bf16 v[232:235], v[80:83], v[24:27], v[232:235]
    ds_read_b64_tr_b16 v[72:73], v5 offset:20480
    v_mfma_f32_16x16x32_bf16 v[236:239], v[80:83], v[28:31], v[236:239]
    v_mfma_f32_16x16x32_bf16 v[240:243], v[80:83], v[32:35], v[240:243]
    ds_read_b64_tr_b16 v[74:75], v5 offset:20992
    v_mfma_f32_16x16x32_bf16 v[244:247], v[80:83], v[36:39], v[244:247]
    s_waitcnt lgkmcnt(7)
    v_mfma_f32_16x16x32_bf16 v[88:91], v[64:67], v[40:43], v[88:91]
    ds_read_b64_tr_b16 v[76:77], v5 offset:28672
    s_waitcnt lgkmcnt(7)
    v_mfma_f32_16x16x32_bf16 v[92:95], v[64:67], v[44:47], v[92:95]
    ds_read_b64_tr_b16 v[78:79], v5 offset:29184
    s_waitcnt lgkmcnt(7)
    v_mfma_f32_16x16x32_bf16 v[96:99], v[64:67], v[48:51], v[96:99]
    ds_read_b64_tr_b16 v[80:81], v6 offset:20480
    s_waitcnt lgkmcnt(7)
    v_mfma_f32_16x16x32_bf16 v[100:103], v[64:67], v[52:55], v[100:103]
    ds_read_b64_tr_b16 v[82:83], v6 offset:20992
    s_waitcnt lgkmcnt(6)
    v_mfma_f32_16x16x32_bf16 v[104:107], v[68:71], v[40:43], v[104:107]
    ds_read_b64_tr_b16 v[64:65], v6 offset:28672
    v_mfma_f32_16x16x32_bf16 v[108:111], v[68:71], v[44:47], v[108:111]
    v_add_u32 v14, s80, v16
    v_mfma_f32_16x16x32_bf16 v[112:115], v[68:71], v[48:51], v[112:115]
    ds_read_b64_tr_b16 v[66:67], v6 offset:29184
    v_mfma_f32_16x16x32_bf16 v[116:119], v[68:71], v[52:55], v[116:119]
    v_add_u32 v15, s80, v17
    s_waitcnt lgkmcnt(6)
    v_mfma_f32_16x16x32_bf16 v[120:123], v[72:75], v[40:43], v[120:123]
    ds_read_b64_tr_b16 v[68:69], v7 offset:20480
    v_mfma_f32_16x16x32_bf16 v[124:127], v[72:75], v[44:47], v[124:127]
    s_add_u32 s80, s80, 18432
    v_mfma_f32_16x16x32_bf16 v[128:131], v[72:75], v[48:51], v[128:131]
    ds_read_b64_tr_b16 v[70:71], v7 offset:20992
    v_mfma_f32_16x16x32_bf16 v[132:135], v[72:75], v[52:55], v[132:135]
    s_cmp_ge_u32 s80, 153600
    s_cselect_b32 s84, 55296, 0
    s_waitcnt lgkmcnt(6)
    v_mfma_f32_16x16x32_bf16 v[136:139], v[76:79], v[40:43], v[136:139]
    ds_read_b64_tr_b16 v[72:73], v7 offset:28672
    v_mfma_f32_16x16x32_bf16 v[140:143], v[76:79], v[44:47], v[140:143]
    s_sub_u32 s80, s80, s84
    v_mfma_f32_16x16x32_bf16 v[144:147], v[76:79], v[48:51], v[144:147]
    ds_read_b64_tr_b16 v[74:75], v7 offset:29184
    v_mfma_f32_16x16x32_bf16 v[148:151], v[76:79], v[52:55], v[148:151]
    s_waitcnt lgkmcnt(6)
    v_mfma_f32_16x16x32_bf16 v[152:155], v[80:83], v[40:43], v[152:155]
    ds_read_b64_tr_b16 v[76:77], v8 offset:36864
    v_mfma_f32_16x16x32_bf16 v[156:159], v[80:83], v[44:47], v[156:159]
    v_mfma_f32_16x16x32_bf16 v[160:163], v[80:83], v[48:51], v[160:163]
    ds_read_b64_tr_b16 v[78:79], v8 offset:37120
    v_mfma_f32_16x16x32_bf16 v[164:167], v[80:83], v[52:55], v[164:167]
    s_waitcnt lgkmcnt(6)
    v_mfma_f32_16x16x32_bf16 v[168:171], v[64:67], v[40:43], v[168:171]
    ds_read_b64_tr_b16 v[80:81], v8 offset:38912
    v_mfma_f32_16x16x32_bf16 v[172:175], v[64:67], v[44:47], v[172:175]
    v_mfma_f32_16x16x32_bf16 v[176:179], v[64:67], v[48:51], v[176:179]
    ds_read_b64_tr_b16 v[82:83], v8 offset:39168
    v_mfma_f32_16x16x32_bf16 v[180:183], v[64:67], v[52:55], v[180:183]
    s_waitcnt lgkmcnt(6)
    v_mfma_f32_16x16x32_bf16 v[184:187], v[68:71], v[40:43], v[184:187]
    v_mfma_f32_16x16x32_bf16 v[188:191], v[68:71], v[44:47], v[188:191]
    v_mfma_f32_16x16x32_bf16 v[192:195], v[68:71], v[48:51], v[192:195]
    v_mfma_f32_16x16x32_bf16 v[196:199], v[68:71], v[52:55], v[196:199]
    s_waitcnt lgkmcnt(0)
    s_barrier
    v_mfma_f32_16x16x32_bf16 v[200:203], v[72:75], v[40:43], v[200:203]
    ds_read_b64_tr_b16 v[64:65], v9 offset:0
    v_mfma_f32_16x16x32_bf16 v[204:207], v[72:75], v[44:47], v[204:207]
    ds_read_b64_tr_b16 v[66:67], v9 offset:512
    v_mfma_f32_16x16x32_bf16 v[208:211], v[72:75], v[48:51], v[208:211]
    ds_read_b128 v[24:27], v14 offset:0
    v_mfma_f32_16x16x32_bf16 v[212:215], v[72:75], v[52:55], v[212:215]
    ds_read_b128 v[28:31], v14 offset:2048
    v_mfma_f32_16x16x32_bf16 v[216:219], v[76:79], v[40:43], v[216:219]
    ds_read_b128 v[32:35], v14 offset:4096
    v_mfma_f32_16x16x32_bf16 v[220:223], v[76:79], v[44:47], v[220:223]
    ds_read_b128 v[36:39], v14 offset:6144
    v_mfma_f32_16x16x32_bf16 v[224:227], v[76:79], v[48:51], v[224:227]
    ds_read_b64_tr_b16 v[68:69], v9 offset:8192
    v_mfma_f32_16x16x32_bf16 v[228:231], v[76:79], v[52:55], v[228:231]
    ds_read_b64_tr_b16 v[70:71], v9 offset:8704
    v_mfma_f32_16x16x32_bf16 v[232:235], v[80:83], v[40:43], v[232:235]
    ds_read_b64_tr_b16 v[72:73], v10 offset:0
    v_mfma_f32_16x16x32_bf16 v[236:239], v[80:83], v[44:47], v[236:239]
    v_mfma_f32_16x16x32_bf16 v[240:243], v[80:83], v[48:51], v[240:243]
    ds_read_b64_tr_b16 v[74:75], v10 offset:512
    v_mfma_f32_16x16x32_bf16 v[244:247], v[80:83], v[52:55], v[244:247]
    s_waitcnt lgkmcnt(7)
    v_mfma_f32_16x16x32_bf16 v[88:91], v[64:67], v[24:27], v[88:91]
    ds_read_b64_tr_b16 v[76:77], v10 offset:8192
    s_waitcnt lgkmcnt(7)
    v_mfma_f32_16x16x32_bf16 v[92:95], v[64:67], v[28:31], v[92:95]
    ds_read_b64_tr_b16 v[78:79], v10 offset:8704
    s_waitcnt lgkmcnt(7)
    v_mfma_f32_16x16x32_bf16 v[96:99], v[64:67], v[32:35], v[96:99]
    ds_read_b64_tr_b16 v[80:81], v11 offset:0
    s_waitcnt lgkmcnt(7)
    v_mfma_f32_16x16x32_bf16 v[100:103], v[64:67], v[36:39], v[100:103]
    ds_read_b64_tr_b16 v[82:83], v11 offset:512
    s_waitcnt lgkmcnt(6)
    v_mfma_f32_16x16x32_bf16 v[104:107], v[68:71], v[24:27], v[104:107]
    ds_read_b64_tr_b16 v[64:65], v11 offset:8192
    v_mfma_f32_16x16x32_bf16 v[108:111], v[68:71], v[28:31], v[108:111]
    v_mfma_f32_16x16x32_bf16 v[112:115], v[68:71], v[32:35], v[112:115]
    ds_read_b64_tr_b16 v[66:67], v11 offset:8704
    v_mfma_f32_16x16x32_bf16 v[116:119], v[68:71], v[36:39], v[116:119]
    s_waitcnt lgkmcnt(6)
    v_mfma_f32_16x16x32_bf16 v[120:123], v[72:75], v[24:27], v[120:123]
    ds_read_b64_tr_b16 v[68:69], v12 offset:0
    v_mfma_f32_16x16x32_bf16 v[124:127], v[72:75], v[28:31], v[124:127]
    v_mfma_f32_16x16x32_bf16 v[128:131], v[72:75], v[32:35], v[128:131]
    ds_read_b64_tr_b16 v[70:71], v12 offset:512
    v_mfma_f32_16x16x32_bf16 v[132:135], v[72:75], v[36:39], v[132:135]
    s_waitcnt lgkmcnt(6)
    v_mfma_f32_16x16x32_bf16 v[136:139], v[76:79], v[24:27], v[136:139]
    ds_read_b64_tr_b16 v[72:73], v12 offset:8192
    v_mfma_f32_16x16x32_bf16 v[140:143], v[76:79], v[28:31], v[140:143]
    v_mfma_f32_16x16x32_bf16 v[144:147], v[76:79], v[32:35], v[144:147]
    ds_read_b64_tr_b16 v[74:75], v12 offset:8704
    v_mfma_f32_16x16x32_bf16 v[148:151], v[76:79], v[36:39], v[148:151]
    s_waitcnt lgkmcnt(6)
    v_mfma_f32_16x16x32_bf16 v[152:155], v[80:83], v[24:27], v[152:155]
    ds_read_b64_tr_b16 v[76:77], v13 offset:16384
    v_mfma_f32_16x16x32_bf16 v[156:159], v[80:83], v[28:31], v[156:159]
    v_mfma_f32_16x16x32_bf16 v[160:163], v[80:83], v[32:35], v[160:163]
    ds_read_b64_tr_b16 v[78:79], v13 offset:16640
    v_mfma_f32_16x16x32_bf16 v[164:167], v[80:83], v[36:39], v[164:167]
    s_waitcnt lgkmcnt(6)
    v_mfma_f32_16x16x32_bf16 v[168:171], v[64:67], v[24:27], v[168:171]
    ds_read_b64_tr_b16 v[80:81], v13 offset:18432
    v_mfma_f32_16x16x32_bf16 v[172:175], v[64:67], v[28:31], v[172:175]
    v_mfma_f32_16x16x32_bf16 v[176:179], v[64:67], v[32:35], v[176:179]
    ds_read_b64_tr_b16 v[82:83], v13 offset:18688
    v_mfma_f32_16x16x32_bf16 v[180:183], v[64:67], v[36:39], v[180:183]
    s_waitcnt lgkmcnt(6)
    v_mfma_f32_16x16x32_bf16 v[184:187], v[68:71], v[24:27], v[184:187]
    v_mfma_f32_16x16x32_bf16 v[188:191], v[68:71], v[28:31], v[188:191]
    v_mfma_f32_16x16x32_bf16 v[192:195], v[68:71], v[32:35], v[192:195]
    v_mfma_f32_16x16x32_bf16 v[196:199], v[68:71], v[36:39], v[196:199]
    s_waitcnt lgkmcnt(0)
    s_barrier
    v_mfma_f32_16x16x32_bf16 v[200:203], v[72:75], v[24:27], v[200:203]
    ds_read_b64_tr_b16 v[64:65], v9 offset:20480
    v_mfma_f32_16x16x32_bf16 v[204:207], v[72:75], v[28:31], v[204:207]
    ds_read_b64_tr_b16 v[66:67], v9 offset:20992
    v_mfma_f32_16x16x32_bf16 v[208:211], v[72:75], v[32:35], v[208:211]
    ds_read_b128 v[40:43], v15 offset:0
    v_mfma_f32_16x16x32_bf16 v[212:215], v[72:75], v[36:39], v[212:215]
    ds_read_b128 v[44:47], v15 offset:2048
    v_mfma_f32_16x16x32_bf16 v[216:219], v[76:79], v[24:27], v[216:219]
    ds_read_b128 v[48:51], v15 offset:4096
    v_mfma_f32_16x16x32_bf16 v[220:223], v[76:79], v[28:31], v[220:223]
    ds_read_b128 v[52:55], v15 offset:6144
    v_mfma_f32_16x16x32_bf16 v[224:227], v[76:79], v[32:35], v[224:227]
    ds_read_b64_tr_b16 v[68:69], v9 offset:28672
    v_mfma_f32_16x16x32_bf16 v[228:231], v[76:79], v[36:39], v[228:231]
    ds_read_b64_tr_b16 v[70:71], v9 offset:29184
    v_mfma_f32_16x16x32_bf16 v[232:235], v[80:83], v[24:27], v[232:235]
    ds_read_b64_tr_b16 v[72:73], v10 offset:20480
    v_mfma_f32_16x16x32_bf16 v[236:239], v[80:83], v[28:31], v[236:239]
    v_mfma_f32_16x16x32_bf16 v[240:243], v[80:83], v[32:35], v[240:243]
    ds_read_b64_tr_b16 v[74:75], v10 offset:20992
    v_mfma_f32_16x16x32_bf16 v[244:247], v[80:83], v[36:39], v[244:247]
    s_waitcnt lgkmcnt(7)
    v_mfma_f32_16x16x32_bf16 v[88:91], v[64:67], v[40:43], v[88:91]
    ds_read_b64_tr_b16 v[76:77], v10 offset:28672
    s_waitcnt lgkmcnt(7)
    v_mfma_f32_16x16x32_bf16 v[92:95], v[64:67], v[44:47], v[92:95]
    ds_read_b64_tr_b16 v[78:79], v10 offset:29184
    s_waitcnt lgkmcnt(7)
    v_mfma_f32_16x16x32_bf16 v[96:99], v[64:67], v[48:51], v[96:99]
    ds_read_b64_tr_b16 v[80:81], v11 offset:20480
    s_waitcnt lgkmcnt(7)
    v_mfma_f32_16x16x32_bf16 v[100:103], v[64:67], v[52:55], v[100:103]
    ds_read_b64_tr_b16 v[82:83], v11 offset:20992
    s_waitcnt lgkmcnt(6)
    v_mfma_f32_16x16x32_bf16 v[104:107], v[68:71], v[40:43], v[104:107]
    ds_read_b64_tr_b16 v[64:65], v11 offset:28672
    v_mfma_f32_16x16x32_bf16 v[108:111], v[68:71], v[44:47], v[108:111]
    v_add_u32 v14, s80, v16
    v_mfma_f32_16x16x32_bf16 v[112:115], v[68:71], v[48:51], v[112:115]
    ds_read_b64_tr_b16 v[66:67], v11 offset:29184
    v_mfma_f32_16x16x32_bf16 v[116:119], v[68:71], v[52:55], v[116:119]
    v_add_u32 v15, s80, v17
    s_waitcnt lgkmcnt(6)
    v_mfma_f32_16x16x32_bf16 v[120:123], v[72:75], v[40:43], v[120:123]
    ds_read_b64_tr_b16 v[68:69], v12 offset:20480
    v_mfma_f32_16x16x32_bf16 v[124:127], v[72:75], v[44:47], v[124:127]
    s_add_u32 s80, s80, 18432
    v_mfma_f32_16x16x32_bf16 v[128:131], v[72:75], v[48:51], v[128:131]
    ds_read_b64_tr_b16 v[70:71], v12 offset:20992
    v_mfma_f32_16x16x32_bf16 v[132:135], v[72:75], v[52:55], v[132:135]
    s_cmp_ge_u32 s80, 153600
    s_cselect_b32 s84, 55296, 0
    s_waitcnt lgkmcnt(6)
    v_mfma_f32_16x16x32_bf16 v[136:139], v[76:79], v[40:43], v[136:139]
    ds_read_b64_tr_b16 v[72:73], v12 offset:28672
    v_mfma_f32_16x16x32_bf16 v[140:143], v[76:79], v[44:47], v[140:143]
    s_sub_u32 s80, s80, s84
    v_mfma_f32_16x16x32_bf16 v[144:147], v[76:79], v[48:51], v[144:147]
    ds_read_b64_tr_b16 v[74:75], v12 offset:29184
    v_mfma_f32_16x16x32_bf16 v[148:151], v[76:79], v[52:55], v[148:151]
    s_waitcnt lgkmcnt(6)
    v_mfma_f32_16x16x32_bf16 v[152:155], v[80:83], v[40:43], v[152:155]
    ds_read_b64_tr_b16 v[76:77], v13 offset:36864
    v_mfma_f32_16x16x32_bf16 v[156:159], v[80:83], v[44:47], v[156:159]
    v_mfma_f32_16x16x32_bf16 v[160:163], v[80:83], v[48:51], v[160:163]
    ds_read_b64_tr_b16 v[78:79], v13 offset:37120
    v_mfma_f32_16x16x32_bf16 v[164:167], v[80:83], v[52:55], v[164:167]
    s_waitcnt lgkmcnt(6)
    v_mfma_f32_16x16x32_bf16 v[168:171], v[64:67], v[40:43], v[168:171]
    ds_read_b64_tr_b16 v[80:81], v13 offset:38912
    v_mfma_f32_16x16x32_bf16 v[172:175], v[64:67], v[44:47], v[172:175]
    v_mfma_f32_16x16x32_bf16 v[176:179], v[64:67], v[48:51], v[176:179]
    ds_read_b64_tr_b16 v[82:83], v13 offset:39168
    v_mfma_f32_16x16x32_bf16 v[180:183], v[64:67], v[52:55], v[180:183]
    s_waitcnt lgkmcnt(6)
    v_mfma_f32_16x16x32_bf16 v[184:187], v[68:71], v[40:43], v[184:187]
    v_mfma_f32_16x16x32_bf16 v[188:191], v[68:71], v[44:47], v[188:191]
    v_mfma_f32_16x16x32_bf16 v[192:195], v[68:71], v[48:51], v[192:195]
    v_mfma_f32_16x16x32_bf16 v[196:199], v[68:71], v[52:55], v[196:199]
    s_waitcnt lgkmcnt(0)
    s_barrier
    v_mfma_f32_16x16x32_bf16 v[200:203], v[72:75], v[40:43], v[200:203]
    ds_read_b64_tr_b16 v[64:65], v4 offset:0
    v_mfma_f32_16x16x32_bf16 v[204:207], v[72:75], v[44:47], v[204:207]
    ds_read_b64_tr_b16 v[66:67], v4 offset:512
    v_mfma_f32_16x16x32_bf16 v[208:211], v[72:75], v[48:51], v[208:211]
    ds_read_b128 v[24:27], v14 offset:0
    v_mfma_f32_16x16x32_bf16 v[212:215], v[72:75], v[52:55], v[212:215]
    ds_read_b128 v[28:31], v14 offset:2048
    v_mfma_f32_16x16x32_bf16 v[216:219], v[76:79], v[40:43], v[216:219]
    ds_read_b128 v[32:35], v14 offset:4096
    v_mfma_f32_16x16x32_bf16 v[220:223], v[76:79], v[44:47], v[220:223]
    ds_read_b128 v[36:39], v14 offset:6144
    v_mfma_f32_16x16x32_bf16 v[224:227], v[76:79], v[48:51], v[224:227]
    ds_read_b64_tr_b16 v[68:69], v4 offset:8192
    v_mfma_f32_16x16x32_bf16 v[228:231], v[76:79], v[52:55], v[228:231]
    ds_read_b64_tr_b16 v[70:71], v4 offset:8704
    v_mfma_f32_16x16x32_bf16 v[232:235], v[80:83], v[40:43], v[232:235]
    ds_read_b64_tr_b16 v[72:73], v5 offset:0
    v_mfma_f32_16x16x32_bf16 v[236:239], v[80:83], v[44:47], v[236:239]
    v_mfma_f32_16x16x32_bf16 v[240:243], v[80:83], v[48:51], v[240:243]
    ds_read_b64_tr_b16 v[74:75], v5 offset:512
    v_mfma_f32_16x16x32_bf16 v[244:247], v[80:83], v[52:55], v[244:247]
    s_sub_u32 s34, s34, 1
    s_cmp_lg_u32 s34, 0
    s_cbranch_scc1 L_p1
    s_waitcnt lgkmcnt(7)
    v_mfma_f32_16x16x32_bf16 v[88:91], v[64:67], v[24:27], v[88:91]
    ds_read_b64_tr_b16 v[76:77], v5 offset:8192
    s_waitcnt lgkmcnt(7)
    v_mfma_f32_16x16x32_bf16 v[92:95], v[64:67], v[28:31], v[92:95]
    ds_read_b64_tr_b16 v[78:79], v5 offset:8704
    s_waitcnt lgkmcnt(7)
    v_mfma_f32_16x16x32_bf16 v[96:99], v[64:67], v[32:35], v[96:99]
    ds_read_b64_tr_b16 v[80:81], v6 offset:0
    s_waitcnt lgkmcnt(7)
    v_mfma_f32_16x16x32_bf16 v[100:103], v[64:67], v[36:39], v[100:103]
    ds_read_b64_tr_b16 v[82:83], v6 offset:512
    s_waitcnt lgkmcnt(6)
    v_mfma_f32_16x16x32_bf16 v[104:107], v[68:71], v[24:27], v[104:107]
    ds_read_b64_tr_b16 v[64:65], v6 offset:8192
    v_mfma_f32_16x16x32_bf16 v[108:111], v[68:71], v[28:31], v[108:111]
    v_mfma_f32_16x16x32_bf16 v[112:115], v[68:71], v[32:35], v[112:115]
    ds_read_b64_tr_b16 v[66:67], v6 offset:8704
    v_mfma_f32_16x16x32_bf16 v[116:119], v[68:71], v[36:39], v[116:119]
    s_waitcnt lgkmcnt(6)
    v_mfma_f32_16x16x32_bf16 v[120:123], v[72:75], v[24:27], v[120:123]
    ds_read_b64_tr_b16 v[68:69], v7 offset:0
    v_mfma_f32_16x16x32_bf16 v[124:127], v[72:75], v[28:31], v[124:127]
    v_mfma_f32_16x16x32_bf16 v[128:131], v[72:75], v[32:35], v[128:131]
    ds_read_b64_tr_b16 v[70:71], v7 offset:512
    v_mfma_f32_16x16x32_bf16 v[132:135], v[72:75], v[36:39], v[132:135]
    s_waitcnt lgkmcnt(6)
    v_mfma_f32_16x16x32_bf16 v[136:139], v[76:79], v[24:27], v[136:139]
    ds_read_b64_tr_b16 v[72:73], v7 offset:8192
    v_mfma_f32_16x16x32_bf16 v[140:143], v[76:79], v[28:31], v[140:143]
    v_mfma_f32_16x16x32_bf16 v[144:147], v[76:79], v[32:35], v[144:147]
    ds_read_b64_tr_b16 v[74:75], v7 offset:8704
    v_mfma_f32_16x16x32_bf16 v[148:151], v[76:79], v[36:39], v[148:151]
    s_waitcnt lgkmcnt(6)
    v_mfma_f32_16x16x32_bf16 v[152:155], v[80:83], v[24:27], v[152:155]
    ds_read_b64_tr_b16 v[76:77], v8 offset:16384
    v_mfma_f32_16x16x32_bf16 v[156:159], v[80:83], v[28:31], v[156:159]
    v_mfma_f32_16x16x32_bf16 v[160:163], v[80:83], v[32:35], v[160:163]
    ds_read_b64_tr_b16 v[78:79], v8 offset:16640
    v_mfma_f32_16x16x32_bf16 v[164:167], v[80:83], v[36:39], v[164:167]
    s_waitcnt lgkmcnt(6)
    v_mfma_f32_16x16x32_bf16 v[168:171], v[64:67], v[24:27], v[168:171]
    ds_read_b64_tr_b16 v[80:81], v8 offset:18432
    v_mfma_f32_16x16x32_bf16 v[172:175], v[64:67], v[28:31], v[172:175]
    v_mfma_f32_16x16x32_bf16 v[176:179], v[64:67], v[32:35], v[176:179]
    ds_read_b64_tr_b16 v[82:83], v8 offset:18688
    v_mfma_f32_16x16x32_bf16 v[180:183], v[64:67], v[36:39], v[180:183]
    s_waitcnt lgkmcnt(6)
    v_mfma_f32_16x16x32_bf16 v[184:187], v[68:71], v[24:27], v[184:187]
    v_mfma_f32_16x16x32_bf16 v[188:191], v[68:71], v[28:31], v[188:191]
    v_mfma_f32_16x16x32_bf16 v[192:195], v[68:71], v[32:35], v[192:195]
    v_mfma_f32_16x16x32_bf16 v[196:199], v[68:71], v[36:39], v[196:199]
    s_waitcnt lgkmcnt(0)
    s_barrier
    v_mfma_f32_16x16x32_bf16 v[200:203], v[72:75], v[24:27], v[200:203]
    ds_read_b64_tr_b16 v[64:65], v4 offset:20480
    v_mfma_f32_16x16x32_bf16 v[204:207], v[72:75], v[28:31], v[204:207]
    ds_read_b64_tr_b16 v[66:67], v4 offset:20992
    v_mfma_f32_16x16x32_bf16 v[208:211], v[72:75], v[32:35], v[208:211]
    ds_read_b128 v[40:43], v15 offset:0
    v_mfma_f32_16x16x32_bf16 v[212:215], v[72:75], v[36:39], v[212:215]
    ds_read_b128 v[44:47], v15 offset:2048
    v_mfma_f32_16x16x32_bf16 v[216:219], v[76:79], v[24:27], v[216:219]
    ds_read_b128 v[48:51], v15 offset:4096
    v_mfma_f32_16x16x32_bf16 v[220:223], v[76:79], v[28:31], v[220:223]
    ds_read_b128 v[52:55], v15 offset:6144
    v_mfma_f32_16x16x32_bf16 v[224:227], v[76:79], v[32:35], v[224:227]
    ds_read_b64_tr_b16 v[68:69], v4 offset:28672
    v_mfma_f32_16x16x32_bf16 v[228:231], v[76:79], v[36:39], v[228:231]
    ds_read_b64_tr_b16 v[70:71], v4 offset:29184
    v_mfma_f32_16x16x32_bf16 v[232:235], v[80:83], v[24:27], v[232:235]
    ds_read_b64_tr_b16 v[72:73], v5 offset:20480
    v_mfma_f32_16x16x32_bf16 v[236:239], v[80:83], v[28:31], v[236:239]
    v_mfma_f32_16x16x32_bf16 v[240:243], v[80:83], v[32:35], v[240:243]
    ds_read_b64_tr_b16 v[74:75], v5 offset:20992
    v_mfma_f32_16x16x32_bf16 v[244:247], v[80:83], v[36:39], v[244:247]
    s_waitcnt lgkmcnt(7)
    v_mfma_f32_16x16x32_bf16 v[88:91], v[64:67], v[40:43], v[88:91]
    ds_read_b64_tr_b16 v[76:77], v5 offset:28672
    s_waitcnt lgkmcnt(7)
    v_mfma_f32_16x16x32_bf16 v[92:95], v[64:67], v[44:47], v[92:95]
    ds_read_b64_tr_b16 v[78:79], v5 offset:29184
    s_waitcnt lgkmcnt(7)
    v_mfma_f32_16x16x32_bf16 v[96:99], v[64:67], v[48:51], v[96:99]
    ds_read_b64_tr_b16 v[80:81], v6 offset:20480
    s_waitcnt lgkmcnt(7)
    v_mfma_f32_16x16x32_bf16 v[100:103], v[64:67], v[52:55], v[100:103]
    ds_read_b64_tr_b16 v[82:83], v6 offset:20992
    s_waitcnt lgkmcnt(6)
    v_mfma_f32_16x16x32_bf16 v[104:107], v[68:71], v[40:43], v[104:107]
    ds_read_b64_tr_b16 v[64:65], v6 offset:28672
    v_mfma_f32_16x16x32_bf16 v[108:111], v[68:71], v[44:47], v[108:111]
    v_add_u32 v14, s80, v16
    v_mfma_f32_16x16x32_bf16 v[112:115], v[68:71], v[48:51], v[112:115]
    ds_read_b64_tr_b16 v[66:67], v6 offset:29184
    v_mfma_f32_16x16x32_bf16 v[116:119], v[68:71], v[52:55], v[116:119]
    v_add_u32 v15, s80, v17
    s_waitcnt lgkmcnt(6)
    v_mfma_f32_16x16x32_bf16 v[120:123], v[72:75], v[40:43], v[120:123]
    ds_read_b64_tr_b16 v[68:69], v7 offset:20480
    v_mfma_f32_16x16x32_bf16 v[124:127], v[72:75], v[44:47], v[124:127]
    s_add_u32 s80, s80, 18432
    v_mfma_f32_16x16x32_bf16 v[128:131], v[72:75], v[48:51], v[128:131]
    ds_read_b64_tr_b16 v[70:71], v7 offset:20992
    v_mfma_f32_16x16x32_bf16 v[132:135], v[72:75], v[52:55], v[132:135]
    s_cmp_ge_u32 s80, 153600
    s_cselect_b32 s84, 55296, 0
    s_waitcnt lgkmcnt(6)
    v_mfma_f32_16x16x32_bf16 v[136:139], v[76:79], v[40:43], v[136:139]
    ds_read_b64_tr_b16 v[72:73], v7 offset:28672
    v_mfma_f32_16x16x32_bf16 v[140:143], v[76:79], v[44:47], v[140:143]
    s_sub_u32 s80, s80, s84
    v_mfma_f32_16x16x32_bf16 v[144:147], v[76:79], v[48:51], v[144:147]
    ds_read_b64_tr_b16 v[74:75], v7 offset:29184
    v_mfma_f32_16x16x32_bf16 v[148:151], v[76:79], v[52:55], v[148:151]
    s_waitcnt lgkmcnt(6)
    v_mfma_f32_16x16x32_bf16 v[152:155], v[80:83], v[40:43], v[152:155]
    ds_read_b64_tr_b16 v[76:77], v8 offset:36864
    v_mfma_f32_16x16x32_bf16 v[156:159], v[80:83], v[44:47], v[156:159]
    v_mfma_f32_16x16x32_bf16 v[160:163], v[80:83], v[48:51], v[160:163]
    ds_read_b64_tr_b16 v[78:79], v8 offset:37120
    v_mfma_f32_16x16x32_bf16 v[164:167], v[80:83], v[52:55], v[164:167]
    s_waitcnt lgkmcnt(6)
    v_mfma_f32_16x16x32_bf16 v[168:171], v[64:67], v[40:43], v[168:171]
    ds_read_b64_tr_b16 v[80:81], v8 offset:38912
    v_mfma_f32_16x16x32_bf16 v[172:175], v[64:67], v[44:47], v[172:175]
    v_mfma_f32_16x16x32_bf16 v[176:179], v[64:67], v[48:51], v[176:179]
    ds_read_b64_tr_b16 v[82:83], v8 offset:39168
    v_mfma_f32_16x16x32_bf16 v[180:183], v[64:67], v[52:55], v[180:183]
    s_waitcnt lgkmcnt(6)
    v_mfma_f32_16x16x32_bf16 v[184:187], v[68:71], v[40:43], v[184:187]
    v_mfma_f32_16x16x32_bf16 v[188:191], v[68:71], v[44:47], v[188:191]
    v_mfma_f32_16x16x32_bf16 v[192:195], v[68:71], v[48:51], v[192:195]
    v_mfma_f32_16x16x32_bf16 v[196:199], v[68:71], v[52:55], v[196:199]
    s_waitcnt lgkmcnt(0)
    s_barrier
    v_mfma_f32_16x16x32_bf16 v[200:203], v[72:75], v[40:43], v[200:203]
    ds_read_b64_tr_b16 v[64:65], v9 offset:0
    v_mfma_f32_16x16x32_bf16 v[204:207], v[72:75], v[44:47], v[204:207]
    ds_read_b64_tr_b16 v[66:67], v9 offset:512
    v_mfma_f32_16x16x32_bf16 v[208:211], v[72:75], v[48:51], v[208:211]
    ds_read_b128 v[24:27], v14 offset:0
    v_mfma_f32_16x16x32_bf16 v[212:215], v[72:75], v[52:55], v[212:215]
    ds_read_b128 v[28:31], v14 offset:2048
    v_mfma_f32_16x16x32_bf16 v[216:219], v[76:79], v[40:43], v[216:219]
    ds_read_b128 v[32:35], v14 offset:4096
    v_mfma_f32_16x16x32_bf16 v[220:223], v[76:79], v[44:47], v[220:223]
    ds_read_b128 v[36:39], v14 offset:6144
    v_mfma_f32_16x16x32_bf16 v[224:227], v[76:79], v[48:51], v[224:227]
    ds_read_b64_tr_b16 v[68:69], v9 offset:8192
    v_mfma_f32_16x16x32_bf16 v[228:231], v[76:79], v[52:55], v[228:231]
    ds_read_b64_tr_b16 v[70:71], v9 offset:8704
    v_mfma_f32_16x16x32_bf16 v[232:235], v[80:83], v[40:43], v[232:235]
    ds_read_b64_tr_b16 v[72:73], v10 offset:0
    v_mfma_f32_16x16x32_bf16 v[236:239], v[80:83], v[44:47], v[236:239]
    v_mfma_f32_16x16x32_bf16 v[240:243], v[80:83], v[48:51], v[240:243]
    ds_read_b64_tr_b16 v[74:75], v10 offset:512
    v_mfma_f32_16x16x32_bf16 v[244:247], v[80:83], v[52:55], v[244:247]
    s_waitcnt lgkmcnt(7)
    v_mfma_f32_16x16x32_bf16 v[88:91], v[64:67], v[24:27], v[88:91]
    ds_read_b64_tr_b16 v[76:77], v10 offset:8192
    s_waitcnt lgkmcnt(7)
    v_mfma_f32_16x16x32_bf16 v[92:95], v[64:67], v[28:31], v[92:95]
    ds_read_b64_tr_b16 v[78:79], v10 offset:8704
    s_waitcnt lgkmcnt(7)
    v_mfma_f32_16x16x32_bf16 v[96:99], v[64:67], v[32:35], v[96:99]
    ds_read_b64_tr_b16 v[80:81], v11 offset:0
    s_waitcnt lgkmcnt(7)
    v_mfma_f32_16x16x32_bf16 v[100:103], v[64:67], v[36:39], v[100:103]
    ds_read_b64_tr_b16 v[82:83], v11 offset:512
    s_waitcnt lgkmcnt(6)
    v_mfma_f32_16x16x32_bf16 v[104:107], v[68:71], v[24:27], v[104:107]
    ds_read_b64_tr_b16 v[64:65], v11 offset:8192
    v_mfma_f32_16x16x32_bf16 v[108:111], v[68:71], v[28:31], v[108:111]
    v_mfma_f32_16x16x32_bf16 v[112:115], v[68:71], v[32:35], v[112:115]
    ds_read_b64_tr_b16 v[66:67], v11 offset:8704
    v_mfma_f32_16x16x32_bf16 v[116:119], v[68:71], v[36:39], v[116:119]
    s_waitcnt lgkmcnt(6)
    v_mfma_f32_16x16x32_bf16 v[120:123], v[72:75], v[24:27], v[120:123]
    ds_read_b64_tr_b16 v[68:69], v12 offset:0
    v_mfma_f32_16x16x32_bf16 v[124:127], v[72:75], v[28:31], v[124:127]
    v_mfma_f32_16x16x32_bf16 v[128:131], v[72:75], v[32:35], v[128:131]
    ds_read_b64_tr_b16 v[70:71], v12 offset:512
    v_mfma_f32_16x16x32_bf16 v[132:135], v[72:75], v[36:39], v[132:135]
    s_waitcnt lgkmcnt(6)
    v_mfma_f32_16x16x32_bf16 v[136:139], v[76:79], v[24:27], v[136:139]
    ds_read_b64_tr_b16 v[72:73], v12 offset:8192
    v_mfma_f32_16x16x32_bf16 v[140:143], v[76:79], v[28:31], v[140:143]
    v_mfma_f32_16x16x32_bf16 v[144:147], v[76:79], v[32:35], v[144:147]
    ds_read_b64_tr_b16 v[74:75], v12 offset:8704
    v_mfma_f32_16x16x32_bf16 v[148:151], v[76:79], v[36:39], v[148:151]
    s_waitcnt lgkmcnt(6)
    v_mfma_f32_16x16x32_bf16 v[152:155], v[80:83], v[24:27], v[152:155]
    ds_read_b64_tr_b16 v[76:77], v13 offset:16384
    v_mfma_f32_16x16x32_bf16 v[156:159], v[80:83], v[28:31], v[156:159]
    v_mfma_f32_16x16x32_bf16 v[160:163], v[80:83], v[32:35], v[160:163]
    ds_read_b64_tr_b16 v[78:79], v13 offset:16640
    v_mfma_f32_16x16x32_bf16 v[164:167], v[80:83], v[36:39], v[164:167]
    s_waitcnt lgkmcnt(6)
    v_mfma_f32_16x16x32_bf16 v[168:171], v[64:67], v[24:27], v[168:171]
    ds_read_b64_tr_b16 v[80:81], v13 offset:18432
    v_mfma_f32_16x16x32_bf16 v[172:175], v[64:67], v[28:31], v[172:175]
    v_mfma_f32_16x16x32_bf16 v[176:179], v[64:67], v[32:35], v[176:179]
    ds_read_b64_tr_b16 v[82:83], v13 offset:18688
    v_mfma_f32_16x16x32_bf16 v[180:183], v[64:67], v[36:39], v[180:183]
    s_waitcnt lgkmcnt(6)
    v_mfma_f32_16x16x32_bf16 v[184:187], v[68:71], v[24:27], v[184:187]
    v_mfma_f32_16x16x32_bf16 v[188:191], v[68:71], v[28:31], v[188:191]
    v_mfma_f32_16x16x32_bf16 v[192:195], v[68:71], v[32:35], v[192:195]
    v_mfma_f32_16x16x32_bf16 v[196:199], v[68:71], v[36:39], v[196:199]
    s_waitcnt lgkmcnt(0)
    s_barrier
    v_mfma_f32_16x16x32_bf16 v[200:203], v[72:75], v[24:27], v[200:203]
    ds_read_b64_tr_b16 v[64:65], v9 offset:20480
    v_mfma_f32_16x16x32_bf16 v[204:207], v[72:75], v[28:31], v[204:207]
    ds_read_b64_tr_b16 v[66:67], v9 offset:20992
    v_mfma_f32_16x16x32_bf16 v[208:211], v[72:75], v[32:35], v[208:211]
    ds_read_b128 v[40:43], v15 offset:0
    v_mfma_f32_16x16x32_bf16 v[212:215], v[72:75], v[36:39], v[212:215]
    ds_read_b128 v[44:47], v15 offset:2048
    v_mfma_f32_16x16x32_bf16 v[216:219], v[76:79], v[24:27], v[216:219]
    ds_read_b128 v[48:51], v15 offset:4096
    v_mfma_f32_16x16x32_bf16 v[220:223], v[76:79], v[28:31], v[220:223]
    ds_read_b128 v[52:55], v15 offset:6144
    v_mfma_f32_16x16x32_bf16 v[224:227], v[76:79], v[32:35], v[224:227]
    ds_read_b64_tr_b16 v[68:69], v9 offset:28672
    v_mfma_f32_16x16x32_bf16 v[228:231], v[76:79], v[36:39], v[228:231]
    ds_read_b64_tr_b16 v[70:71], v9 offset:29184
    v_mfma_f32_16x16x32_bf16 v[232:235], v[80:83], v[24:27], v[232:235]
    ds_read_b64_tr_b16 v[72:73], v10 offset:20480
    v_mfma_f32_16x16x32_bf16 v[236:239], v[80:83], v[28:31], v[236:239]
    v_mfma_f32_16x16x32_bf16 v[240:243], v[80:83], v[32:35], v[240:243]
    ds_read_b64_tr_b16 v[74:75], v10 offset:20992
    v_mfma_f32_16x16x32_bf16 v[244:247], v[80:83], v[36:39], v[244:247]
    s_waitcnt lgkmcnt(7)
    v_mfma_f32_16x16x32_bf16 v[88:91], v[64:67], v[40:43], v[88:91]
    ds_read_b64_tr_b16 v[76:77], v10 offset:28672
    s_waitcnt lgkmcnt(7)
    v_mfma_f32_16x16x32_bf16 v[92:95], v[64:67], v[44:47], v[92:95]
    ds_read_b64_tr_b16 v[78:79], v10 offset:29184
    s_waitcnt lgkmcnt(7)
    v_mfma_f32_16x16x32_bf16 v[96:99], v[64:67], v[48:51], v[96:99]
    ds_read_b64_tr_b16 v[80:81], v11 offset:20480
    s_waitcnt lgkmcnt(7)
    v_mfma_f32_16x16x32_bf16 v[100:103], v[64:67], v[52:55], v[100:103]
    ds_read_b64_tr_b16 v[82:83], v11 offset:20992
    s_waitcnt lgkmcnt(6)
    v_mfma_f32_16x16x32_bf16 v[104:107], v[68:71], v[40:43], v[104:107]
    ds_read_b64_tr_b16 v[64:65], v11 offset:28672
    v_mfma_f32_16x16x32_bf16 v[108:111], v[68:71], v[44:47], v[108:111]
    v_mfma_f32_16x16x32_bf16 v[112:115], v[68:71], v[48:51], v[112:115]
    ds_read_b64_tr_b16 v[66:67], v11 offset:29184
    v_mfma_f32_16x16x32_bf16 v[116:119], v[68:71], v[52:55], v[116:119]
    s_waitcnt lgkmcnt(6)
    v_mfma_f32_16x16x32_bf16 v[120:123], v[72:75], v[40:43], v[120:123]
    ds_read_b64_tr_b16 v[68:69], v12 offset:20480
    v_mfma_f32_16x16x32_bf16 v[124:127], v[72:75], v[44:47], v[124:127]
    v_mfma_f32_16x16x32_bf16 v[128:131], v[72:75], v[48:51], v[128:131]
    ds_read_b64_tr_b16 v[70:71], v12 offset:20992
    v_mfma_f32_16x16x32_bf16 v[132:135], v[72:75], v[52:55], v[132:135]
    s_waitcnt lgkmcnt(6)
    v_mfma_f32_16x16x32_bf16 v[136:139], v[76:79], v[40:43], v[136:139]
    ds_read_b64_tr_b16 v[72:73], v12 offset:28672
    v_mfma_f32_16x16x32_bf16 v[140:143], v[76:79], v[44:47], v[140:143]
    v_mfma_f32_16x16x32_bf16 v[144:147], v[76:79], v[48:51], v[144:147]
    ds_read_b64_tr_b16 v[74:75], v12 offset:29184
    v_mfma_f32_16x16x32_bf16 v[148:151], v[76:79], v[52:55], v[148:151]
    s_waitcnt lgkmcnt(6)
    v_mfma_f32_16x16x32_bf16 v[152:155], v[80:83], v[40:43], v[152:155]
    ds_read_b64_tr_b16 v[76:77], v13 offset:36864
    v_mfma_f32_16x16x32_bf16 v[156:159], v[80:83], v[44:47], v[156:159]
    v_mfma_f32_16x16x32_bf16 v[160:163], v[80:83], v[48:51], v[160:163]
    ds_read_b64_tr_b16 v[78:79], v13 offset:37120
    v_mfma_f32_16x16x32_bf16 v[164:167], v[80:83], v[52:55], v[164:167]
    s_waitcnt lgkmcnt(6)
    v_mfma_f32_16x16x32_bf16 v[168:171], v[64:67], v[40:43], v[168:171]
    ds_read_b64_tr_b16 v[80:81], v13 offset:38912
    v_mfma_f32_16x16x32_bf16 v[172:175], v[64:67], v[44:47], v[172:175]
    v_mfma_f32_16x16x32_bf16 v[176:179], v[64:67], v[48:51], v[176:179]
    ds_read_b64_tr_b16 v[82:83], v13 offset:39168
    v_mfma_f32_16x16x32_bf16 v[180:183], v[64:67], v[52:55], v[180:183]
    s_waitcnt lgkmcnt(6)
    v_mfma_f32_16x16x32_bf16 v[184:187], v[68:71], v[40:43], v[184:187]
    v_mfma_f32_16x16x32_bf16 v[188:191], v[68:71], v[44:47], v[188:191]
    v_mfma_f32_16x16x32_bf16 v[192:195], v[68:71], v[48:51], v[192:195]
    v_mfma_f32_16x16x32_bf16 v[196:199], v[68:71], v[52:55], v[196:199]
    s_waitcnt lgkmcnt(0)
    s_barrier
    v_mfma_f32_16x16x32_bf16 v[200:203], v[72:75], v[40:43], v[200:203]
    v_mfma_f32_16x16x32_bf16 v[204:207], v[72:75], v[44:47], v[204:207]
    v_mfma_f32_16x16x32_bf16 v[208:211], v[72:75], v[48:51], v[208:211]
    v_mfma_f32_16x16x32_bf16 v[212:215], v[72:75], v[52:55], v[212:215]
    v_mfma_f32_16x16x32_bf16 v[216:219], v[76:79], v[40:43], v[216:219]
    v_mfma_f32_16x16x32_bf16 v[220:223], v[76:79], v[44:47], v[220:223]
    v_mfma_f32_16x16x32_bf16 v[224:227], v[76:79], v[48:51], v[224:227]
    v_mfma_f32_16x16x32_bf16 v[228:231], v[76:79], v[52:55], v[228:231]
    v_mfma_f32_16x16x32_bf16 v[232:235], v[80:83], v[40:43], v[232:235]
    v_mfma_f32_16x16x32_bf16 v[236:239], v[80:83], v[44:47], v[236:239]
    v_mfma_f32_16x16x32_bf16 v[240:243], v[80:83], v[48:51], v[240:243]
    v_mfma_f32_16x16x32_bf16 v[244:247], v[80:83], v[52:55], v[244:247]
    s_setprio 0
    s_lshl_b32 s84, s5, 10
    s_add_u32 s84, s84, 161024
    v_and_b32 v16, 15, v1
    v_lshl_add_u32 v16, v16, 4, s84
    ds_read_b128 v[64:67], v16 offset:0
    ds_read_b128 v[68:71], v16 offset:256
    ds_read_b128 v[72:75], v16 offset:512
    ds_read_b128 v[76:79], v16 offset:768
    v_and_b32 v17, 48, v1
    s_lshl_b32 s84, s6, 8
    s_add_u32 s84, s84, 159744
    v_add_u32 v16, s84, v17
    s_lshl_b32 s84, s6, 6
    s_add_u32 s84, s84, 159744
    v_add_u32 v17, s84, v17
    ds_read_b128 v[24:27], v16 offset:0
    ds_read_b128 v[28:31], v16 offset:640
    ds_read_b128 v[32:35], v16 offset:64
    ds_read_b128 v[36:39], v16 offset:704
    ds_read_b128 v[40:43], v16 offset:128
    ds_read_b128 v[44:47], v16 offset:768
    ds_read_b128 v[48:51], v16 offset:192
    ds_read_b128 v[52:55], v16 offset:832
    ds_read_b128 v[56:59], v17 offset:512
    ds_read_b128 v[60:63], v17 offset:1152
    s_add_u32 m0, s79, 116736
    s_mov_b32 s78, 256
    buffer_load_dwordx4 v20, s[36:39], s78 offen sc1 lds
    s_waitcnt lgkmcnt(0)
    v_fmac_f32 v88, v24, v64
    v_fmac_f32 v89, v25, v64
    v_fmac_f32 v90, v26, v64
    v_fmac_f32 v91, v27, v64
    v_fmac_f32 v104, v28, v64
    v_fmac_f32 v105, v29, v64
    v_fmac_f32 v106, v30, v64
    v_fmac_f32 v107, v31, v64
    s_add_u32 m0, s79, 117760
    s_nop 0
    buffer_load_dwordx4 v21, s[36:39], s78 offen sc1 lds
    v_mul_f32 v80, v88, v88
    v_mul_f32 v81, v89, v89
    v_mul_f32 v82, v90, v90
    v_mul_f32 v83, v91, v91
    v_fma_f32 v80, v80, v66, v65
    v_fma_f32 v81, v81, v66, v65
    v_fma_f32 v82, v82, v66, v65
    v_fma_f32 v83, v83, v66, v65
    s_add_u32 m0, s33, 77824
    s_mov_b32 s76, 589824
    buffer_load_dwordx4 v23, s[40:43], s76 offen offset:0 lds
    v_mul_f32 v80, v80, v88
    v_mul_f32 v81, v81, v89
    v_mul_f32 v82, v82, v90
    v_mul_f32 v83, v83, v91
    v_exp_f32 v80, v80
    v_mul_f32 v88, v88, v104
    v_exp_f32 v81, v81
    s_add_u32 m0, s33, 79872
    s_nop 0
    buffer_load_dwordx4 v23, s[40:43], s76 offen offset:2048 lds
    v_mul_f32 v89, v89, v105
    v_exp_f32 v82, v82
    v_mul_f32 v90, v90, v106
    v_exp_f32 v83, v83
    v_mul_f32 v91, v91, v107
    v_fma_f32 v80, v80, v67, v67
    s_add_u32 m0, s33, 86016
    s_nop 0
    buffer_load_dwordx4 v23, s[44:47], s76 offen offset:0 lds
    v_fma_f32 v81, v81, v67, v67
    v_fma_f32 v82, v82, v67, v67
    v_fma_f32 v83, v83, v67, v67
    v_rcp_f32 v80, v80
    v_rcp_f32 v81, v81
    v_rcp_f32 v82, v82
    s_add_u32 m0, s33, 90112
    s_mov_b32 s77, 688128
    buffer_load_dwordx4 v22, s[48:51], s77 offen offset:0 lds
    v_rcp_f32 v83, v83
    s_nop 0
    v_mul_f32 v88, v88, v80
    v_mul_f32 v89, v89, v81
    v_mul_f32 v90, v90, v82
    v_mul_f32 v91, v91, v83
    v_cvt_pk_bf16_f32 v88, v88, v89
    v_cvt_pk_bf16_f32 v89, v90, v91
    s_add_u32 m0, s33, 94208
    s_nop 0
    buffer_load_dwordx4 v22, s[52:55], s77 offen offset:0 lds
    s_barrier
    s_add_u32 m0, s79, 118784
    s_mov_b32 s78, 33024
    buffer_load_dwordx4 v20, s[36:39], s78 offen sc1 lds
    v_fmac_f32 v92, v24, v68
    v_fmac_f32 v93, v25, v68
    v_fmac_f32 v94, v26, v68
    v_fmac_f32 v95, v27, v68
    v_fmac_f32 v108, v28, v68
    v_fmac_f32 v109, v29, v68
    v_fmac_f32 v110, v30, v68
    v_fmac_f32 v111, v31, v68
    s_add_u32 m0, s79, 119808
    s_nop 0
    buffer_load_dwordx4 v21, s[36:39], s78 offen sc1 lds
    v_mul_f32 v80, v92, v92
    v_mul_f32 v81, v93, v93
    v_mul_f32 v82, v94, v94
    v_mul_f32 v83, v95, v95
    v_fma_f32 v80, v80, v70, v69
    v_fma_f32 v81, v81, v70, v69
    v_fma_f32 v82, v82, v70, v69
    v_fma_f32 v83, v83, v70, v69
    s_add_u32 m0, s81, 133120
    s_mov_b32 s78, 256
    s_mov_b64 exec, 0xffffffff
    buffer_load_dwordx4 v3, s[36:39], s78 offen sc1 lds
    s_mov_b64 exec, -1
    v_mul_f32 v80, v80, v92
    v_mul_f32 v81, v81, v93
    v_mul_f32 v82, v82, v94
    v_mul_f32 v83, v83, v95
    v_exp_f32 v80, v80
    v_mul_f32 v92, v92, v108
    v_exp_f32 v81, v81
    s_add_u32 m0, s33, 16384
    s_mov_b32 s76, 786432
    buffer_load_dwordx4 v23, s[40:43], s76 offen offset:0 lds
    s_add_u32 m0, s33, 18432
    s_nop 0
    buffer_load_dwordx4 v23, s[40:43], s76 offen offset:2048 lds
    v_mul_f32 v93, v93, v109
    v_exp_f32 v82, v82
    v_mul_f32 v94, v94, v110
    v_exp_f32 v83, v83
    v_mul_f32 v95, v95, v111
    v_fma_f32 v80, v80, v71, v71
    s_add_u32 m0, s33, 24576
    s_nop 0
    buffer_load_dwordx4 v23, s[44:47], s76 offen offset:0 lds
    v_fma_f32 v81, v81, v71, v71
    v_fma_f32 v82, v82, v71, v71
    v_fma_f32 v83, v83, v71, v71
    v_rcp_f32 v80, v80
    v_rcp_f32 v81, v81
    v_rcp_f32 v82, v82
    s_add_u32 m0, s33, 28672
    s_mov_b32 s77, 917504
    buffer_load_dwordx4 v22, s[48:51], s77 offen offset:0 lds
    v_rcp_f32 v83, v83
    s_nop 0
    v_mul_f32 v92, v92, v80
    v_mul_f32 v93, v93, v81
    v_mul_f32 v94, v94, v82
    v_mul_f32 v95, v95, v83
    v_cvt_pk_bf16_f32 v90, v92, v93
    v_cvt_pk_bf16_f32 v91, v94, v95
    s_add_u32 m0, s33, 32768
    s_nop 0
    buffer_load_dwordx4 v22, s[52:55], s77 offen offset:0 lds
    s_add_u32 s99, s99, 0x380100
    s_load_dword s94, s[16:17], s99 offset:0x0
    s_load_dword s94, s[16:17], s99 offset:0x40
    s_load_dword s94, s[16:17], s99 offset:0x80
    s_load_dword s94, s[16:17], s99 offset:0xc0
    v_mov_b32 v5, 0
    global_load_dwordx2 v[6:7], v5, s[24:25] sc1
    s_barrier
    s_add_u32 m0, s79, 135168
    s_mov_b32 s78, 384
    buffer_load_dwordx4 v20, s[36:39], s78 offen sc1 lds
    s_nop 1
    v_permlane16_swap_b32 v88, v90
    v_permlane16_swap_b32 v89, v91
    v_fmac_f32 v96, v24, v72
    v_fmac_f32 v97, v25, v72
    v_fmac_f32 v98, v26, v72
    v_fmac_f32 v99, v27, v72
    v_fmac_f32 v112, v28, v72
    v_fmac_f32 v113, v29, v72
    v_fmac_f32 v114, v30, v72
    v_fmac_f32 v115, v31, v72
    s_add_u32 m0, s79, 136192
    s_nop 0
    buffer_load_dwordx4 v21, s[36:39], s78 offen sc1 lds
    v_mul_f32 v80, v96, v96
    v_mul_f32 v81, v97, v97
    v_mul_f32 v82, v98, v98
    v_mul_f32 v83, v99, v99
    v_fma_f32 v80, v80, v74, v73
    v_fma_f32 v81, v81, v74, v73
    v_fma_f32 v82, v82, v74, v73
    v_fma_f32 v83, v83, v74, v73
    s_add_u32 m0, s33, 36864
    s_mov_b32 s76, 983040
    buffer_load_dwordx4 v23, s[40:43], s76 offen offset:0 lds
    v_mul_f32 v80, v80, v96
    v_mul_f32 v81, v81, v97
    v_mul_f32 v82, v82, v98
    v_mul_f32 v83, v83, v99
    v_exp_f32 v80, v80
    v_mul_f32 v96, v96, v112
    v_exp_f32 v81, v81
    s_add_u32 m0, s33, 38912
    s_nop 0
    buffer_load_dwordx4 v23, s[40:43], s76 offen offset:2048 lds
    s_add_u32 m0, s33, 45056
    s_nop 0
    buffer_load_dwordx4 v23, s[44:47], s76 offen offset:0 lds
    v_mul_f32 v97, v97, v113
    v_exp_f32 v82, v82
    v_mul_f32 v98, v98, v114
    v_exp_f32 v83, v83
    v_mul_f32 v99, v99, v115
    v_fma_f32 v80, v80, v75, v75
    s_add_u32 m0, s33, 49152
    s_mov_b32 s77, 1146880
    buffer_load_dwordx4 v22, s[48:51], s77 offen offset:0 lds
    v_fma_f32 v81, v81, v75, v75
    v_fma_f32 v82, v82, v75, v75
    v_fma_f32 v83, v83, v75, v75
    v_rcp_f32 v80, v80
    v_rcp_f32 v81, v81
    v_rcp_f32 v82, v82
    s_add_u32 m0, s33, 53248
    s_nop 0
    buffer_load_dwordx4 v22, s[52:55], s77 offen offset:0 lds
    v_rcp_f32 v83, v83
    s_nop 0
    v_mul_f32 v96, v96, v80
    v_mul_f32 v97, v97, v81
    v_mul_f32 v98, v98, v82
    v_mul_f32 v99, v99, v83
    v_cvt_pk_bf16_f32 v96, v96, v97
    v_cvt_pk_bf16_f32 v97, v98, v99
    buffer_store_dwordx4 v[88:91], v19, s[68:71], s72 offen offset:0 sc1
    s_add_u32 s99, s99, 0xffffff00
    s_load_dword s94, s[18:19], s99 offset:0x0
    s_load_dword s94, s[18:19], s99 offset:0x40
    s_load_dword s94, s[18:19], s99 offset:0x80
    s_load_dword s94, s[18:19], s99 offset:0xc0
    s_waitcnt vmcnt(17)
    s_barrier
    s_add_u32 m0, s79, 137216
    s_mov_b32 s78, 33152
    buffer_load_dwordx4 v20, s[36:39], s78 offen sc1 lds
    v_fmac_f32 v100, v24, v76
    v_fmac_f32 v101, v25, v76
    v_fmac_f32 v102, v26, v76
    v_fmac_f32 v103, v27, v76
    v_fmac_f32 v116, v28, v76
    v_fmac_f32 v117, v29, v76
    v_fmac_f32 v118, v30, v76
    v_fmac_f32 v119, v31, v76
    s_add_u32 m0, s79, 138240
    s_nop 0
    buffer_load_dwordx4 v21, s[36:39], s78 offen sc1 lds
    v_mul_f32 v80, v100, v100
    v_mul_f32 v81, v101, v101
    v_mul_f32 v82, v102, v102
    v_mul_f32 v83, v103, v103
    v_fma_f32 v80, v80, v78, v77
    v_fma_f32 v81, v81, v78, v77
    v_fma_f32 v82, v82, v78, v77
    v_fma_f32 v83, v83, v78, v77
    s_add_u32 m0, s81, 151552
    s_mov_b32 s78, 384
    s_mov_b64 exec, 0xffffffff
    buffer_load_dwordx4 v3, s[36:39], s78 offen sc1 lds
    s_mov_b64 exec, -1
    v_mul_f32 v80, v80, v100
    v_mul_f32 v81, v81, v101
    v_mul_f32 v82, v82, v102
    v_mul_f32 v83, v83, v103
    v_exp_f32 v80, v80
    v_mul_f32 v100, v100, v116
    v_exp_f32 v81, v81
    s_add_u32 m0, s33, 57344
    s_mov_b32 s76, 1179648
    buffer_load_dwordx4 v23, s[40:43], s76 offen offset:0 lds
    s_add_u32 m0, s33, 59392
    s_nop 0
    buffer_load_dwordx4 v23, s[40:43], s76 offen offset:2048 lds
    v_mul_f32 v101, v101, v117
    v_exp_f32 v82, v82
    v_mul_f32 v102, v102, v118
    v_exp_f32 v83, v83
    v_mul_f32 v103, v103, v119
    v_fma_f32 v80, v80, v79, v79
    s_add_u32 m0, s33, 65536
    s_nop 0
    buffer_load_dwordx4 v23, s[44:47], s76 offen offset:0 lds
    v_fma_f32 v81, v81, v79, v79
    v_fma_f32 v82, v82, v79, v79
    v_fma_f32 v83, v83, v79, v79
    v_rcp_f32 v80, v80
    v_rcp_f32 v81, v81
    v_rcp_f32 v82, v82
    s_add_u32 m0, s33, 69632
    s_mov_b32 s77, 1376256
    buffer_load_dwordx4 v22, s[48:51], s77 offen offset:0 lds
    v_rcp_f32 v83, v83
    s_nop 0
    v_mul_f32 v100, v100, v80
    v_mul_f32 v101, v101, v81
    v_mul_f32 v102, v102, v82
    v_mul_f32 v103, v103, v83
    v_cvt_pk_bf16_f32 v98, v100, v101
    v_cvt_pk_bf16_f32 v99, v102, v103
    s_add_u32 m0, s33, 73728
    s_nop 0
    buffer_load_dwordx4 v22, s[52:55], s77 offen offset:0 lds
    s_load_dword s94, s[18:19], s99 offset:0x100
    s_load_dword s94, s[18:19], s99 offset:0x140
    s_load_dword s94, s[18:19], s99 offset:0x180
    s_load_dword s94, s[18:19], s99 offset:0x1c0
    s_waitcnt vmcnt(17)
    s_barrier
    s_add_u32 m0, s79, 98304
    s_mov_b32 s78, 512
    buffer_load_dwordx4 v20, s[36:39], s78 offen sc1 lds
    s_nop 1
    v_permlane16_swap_b32 v96, v98
    v_permlane16_swap_b32 v97, v99
    v_fmac_f32 v120, v32, v64
    v_fmac_f32 v121, v33, v64
    v_fmac_f32 v122, v34, v64
    v_fmac_f32 v123, v35, v64
    v_fmac_f32 v136, v36, v64
    v_fmac_f32 v137, v37, v64
    v_fmac_f32 v138, v38, v64
    v_fmac_f32 v139, v39, v64
    s_add_u32 m0, s79, 99328
    s_nop 0
    buffer_load_dwordx4 v21, s[36:39], s78 offen sc1 lds
    v_mul_f32 v80, v120, v120
    v_mul_f32 v81, v121, v121
    v_mul_f32 v82, v122, v122
    v_mul_f32 v83, v123, v123
    v_fma_f32 v80, v80, v66, v65
    v_fma_f32 v81, v81, v66, v65
    v_fma_f32 v82, v82, v66, v65
    v_fma_f32 v83, v83, v66, v65
    s_add_u32 m0, s33, 77824
    s_mov_b32 s76, 1376256
    buffer_load_dwordx4 v23, s[40:43], s76 offen offset:0 lds
    v_mul_f32 v80, v80, v120
    v_mul_f32 v81, v81, v121
    v_mul_f32 v82, v82, v122
    v_mul_f32 v83, v83, v123
    v_exp_f32 v80, v80
    v_mul_f32 v120, v120, v136
    v_exp_f32 v81, v81
    s_add_u32 m0, s33, 79872
    s_nop 0
    buffer_load_dwordx4 v23, s[40:43], s76 offen offset:2048 lds
    s_add_u32 m0, s33, 86016
    s_nop 0
    buffer_load_dwordx4 v23, s[44:47], s76 offen offset:0 lds
    v_mul_f32 v121, v121, v137
    v_exp_f32 v82, v82
    v_mul_f32 v122, v122, v138
    v_exp_f32 v83, v83
    v_mul_f32 v123, v123, v139
    v_fma_f32 v80, v80, v67, v67
    s_add_u32 m0, s33, 90112
    s_mov_b32 s77, 1605632
    buffer_load_dwordx4 v22, s[48:51], s77 offen offset:0 lds
    v_fma_f32 v81, v81, v67, v67
    v_fma_f32 v82, v82, v67, v67
    v_fma_f32 v83, v83, v67, v67
    v_rcp_f32 v80, v80
    v_rcp_f32 v81, v81
    v_rcp_f32 v82, v82
    s_add_u32 m0, s33, 94208
    s_nop 0
    buffer_load_dwordx4 v22, s[52:55], s77 offen offset:0 lds
    v_rcp_f32 v83, v83
    s_nop 0
    v_mul_f32 v120, v120, v80
    v_mul_f32 v121, v121, v81
    v_mul_f32 v122, v122, v82
    v_mul_f32 v123, v123, v83
    v_cvt_pk_bf16_f32 v120, v120, v121
    v_cvt_pk_bf16_f32 v121, v122, v123
    buffer_store_dwordx4 v[96:99], v19, s[68:71], s72 offen offset:2048 sc1
    s_add_u32 s75, s75, 0x380000
    s_load_dword s94, s[10:11], s75 offset:0x0
    s_load_dword s94, s[10:11], s75 offset:0x40
    s_load_dword s94, s[10:11], s75 offset:0x80
    s_load_dword s94, s[10:11], s75 offset:0xc0
    s_waitcnt vmcnt(17)
    s_barrier
    s_add_u32 m0, s79, 100352
    s_mov_b32 s78, 33280
    buffer_load_dwordx4 v20, s[36:39], s78 offen sc1 lds
    v_fmac_f32 v124, v32, v68
    v_fmac_f32 v125, v33, v68
    v_fmac_f32 v126, v34, v68
    v_fmac_f32 v127, v35, v68
    v_fmac_f32 v140, v36, v68
    v_fmac_f32 v141, v37, v68
    v_fmac_f32 v142, v38, v68
    v_fmac_f32 v143, v39, v68
    s_add_u32 m0, s79, 101376
    s_nop 0
    buffer_load_dwordx4 v21, s[36:39], s78 offen sc1 lds
    v_mul_f32 v80, v124, v124
    v_mul_f32 v81, v125, v125
    v_mul_f32 v82, v126, v126
    v_mul_f32 v83, v127, v127
    v_fma_f32 v80, v80, v70, v69
    v_fma_f32 v81, v81, v70, v69
    v_fma_f32 v82, v82, v70, v69
    v_fma_f32 v83, v83, v70, v69
    s_add_u32 m0, s81, 114688
    s_mov_b32 s78, 512
    s_mov_b64 exec, 0xffffffff
    buffer_load_dwordx4 v3, s[36:39], s78 offen sc1 lds
    s_mov_b64 exec, -1
    v_mul_f32 v80, v80, v124
    v_mul_f32 v81, v81, v125
    v_mul_f32 v82, v82, v126
    v_mul_f32 v83, v83, v127
    v_exp_f32 v80, v80
    v_mul_f32 v124, v124, v140
    v_exp_f32 v81, v81
    s_add_u32 m0, s33, 16384
    s_mov_b32 s76, 1572864
    buffer_load_dwordx4 v23, s[40:43], s76 offen offset:0 lds
    s_add_u32 m0, s33, 18432
    s_nop 0
    buffer_load_dwordx4 v23, s[40:43], s76 offen offset:2048 lds
    v_mul_f32 v125, v125, v141
    v_exp_f32 v82, v82
    v_mul_f32 v126, v126, v142
    v_exp_f32 v83, v83
    v_mul_f32 v127, v127, v143
    v_fma_f32 v80, v80, v71, v71
    s_add_u32 m0, s33, 24576
    s_nop 0
    buffer_load_dwordx4 v23, s[44:47], s76 offen offset:0 lds
    v_fma_f32 v81, v81, v71, v71
    v_fma_f32 v82, v82, v71, v71
    v_fma_f32 v83, v83, v71, v71
    v_rcp_f32 v80, v80
    v_rcp_f32 v81, v81
    v_rcp_f32 v82, v82
    s_add_u32 m0, s33, 28672
    s_mov_b32 s77, 1835008
    buffer_load_dwordx4 v22, s[48:51], s77 offen offset:0 lds
    v_rcp_f32 v83, v83
    s_nop 0
    v_mul_f32 v124, v124, v80
    v_mul_f32 v125, v125, v81
    v_mul_f32 v126, v126, v82
    v_mul_f32 v127, v127, v83
    v_cvt_pk_bf16_f32 v122, v124, v125
    v_cvt_pk_bf16_f32 v123, v126, v127
    s_add_u32 m0, s33, 32768
    s_nop 0
    buffer_load_dwordx4 v22, s[52:55], s77 offen offset:0 lds
    s_load_dword s94, s[10:11], s75 offset:0x100
    s_load_dword s94, s[10:11], s75 offset:0x140
    s_load_dword s94, s[10:11], s75 offset:0x180
    s_load_dword s94, s[10:11], s75 offset:0x1c0
    s_waitcnt vmcnt(16)
    s_barrier
    s_add_u32 m0, s79, 116736
    s_mov_b32 s78, 640
    buffer_load_dwordx4 v20, s[36:39], s78 offen sc1 lds
    s_nop 1
    v_permlane16_swap_b32 v120, v122
    v_permlane16_swap_b32 v121, v123
    v_fmac_f32 v128, v32, v72
    v_fmac_f32 v129, v33, v72
    v_fmac_f32 v130, v34, v72
    v_fmac_f32 v131, v35, v72
    v_fmac_f32 v144, v36, v72
    v_fmac_f32 v145, v37, v72
    v_fmac_f32 v146, v38, v72
    v_fmac_f32 v147, v39, v72
    s_add_u32 m0, s79, 117760
    s_nop 0
    buffer_load_dwordx4 v21, s[36:39], s78 offen sc1 lds
    v_mul_f32 v80, v128, v128
    v_mul_f32 v81, v129, v129
    v_mul_f32 v82, v130, v130
    v_mul_f32 v83, v131, v131
    v_fma_f32 v80, v80, v74, v73
    v_fma_f32 v81, v81, v74, v73
    v_fma_f32 v82, v82, v74, v73
    v_fma_f32 v83, v83, v74, v73
    s_add_u32 m0, s33, 36864
    s_mov_b32 s76, 1769472
    buffer_load_dwordx4 v23, s[40:43], s76 offen offset:0 lds
    v_mul_f32 v80, v80, v128
    v_mul_f32 v81, v81, v129
    v_mul_f32 v82, v82, v130
    v_mul_f32 v83, v83, v131
    v_exp_f32 v80, v80
    v_mul_f32 v128, v128, v144
    v_exp_f32 v81, v81
    s_add_u32 m0, s33, 38912
    s_nop 0
    buffer_load_dwordx4 v23, s[40:43], s76 offen offset:2048 lds
    s_add_u32 m0, s33, 45056
    s_nop 0
    buffer_load_dwordx4 v23, s[44:47], s76 offen offset:0 lds
    v_mul_f32 v129, v129, v145
    v_exp_f32 v82, v82
    v_mul_f32 v130, v130, v146
    v_exp_f32 v83, v83
    v_mul_f32 v131, v131, v147
    v_fma_f32 v80, v80, v75, v75
    s_add_u32 m0, s33, 49152
    s_mov_b32 s77, 2064384
    buffer_load_dwordx4 v22, s[48:51], s77 offen offset:0 lds
    v_fma_f32 v81, v81, v75, v75
    v_fma_f32 v82, v82, v75, v75
    v_fma_f32 v83, v83, v75, v75
    v_rcp_f32 v80, v80
    v_rcp_f32 v81, v81
    v_rcp_f32 v82, v82
    s_add_u32 m0, s33, 53248
    s_nop 0
    buffer_load_dwordx4 v22, s[52:55], s77 offen offset:0 lds
    v_rcp_f32 v83, v83
    s_nop 0
    v_mul_f32 v128, v128, v80
    v_mul_f32 v129, v129, v81
    v_mul_f32 v130, v130, v82
    v_mul_f32 v131, v131, v83
    v_cvt_pk_bf16_f32 v128, v128, v129
    v_cvt_pk_bf16_f32 v129, v130, v131
    buffer_store_dwordx4 v[120:123], v19, s[68:71], s72 offen offset:512 sc1
    s_load_dword s94, s[10:11], s75 offset:0x80000
    s_load_dword s94, s[10:11], s75 offset:0x80040
    s_load_dword s94, s[10:11], s75 offset:0x80080
    s_load_dword s94, s[10:11], s75 offset:0x800c0
    s_waitcnt vmcnt(17)
    s_barrier
    s_add_u32 m0, s79, 118784
    s_mov_b32 s78, 33408
    buffer_load_dwordx4 v20, s[36:39], s78 offen sc1 lds
    v_fmac_f32 v132, v32, v76
    v_fmac_f32 v133, v33, v76
    v_fmac_f32 v134, v34, v76
    v_fmac_f32 v135, v35, v76
    v_fmac_f32 v148, v36, v76
    v_fmac_f32 v149, v37, v76
    v_fmac_f32 v150, v38, v76
    v_fmac_f32 v151, v39, v76
    s_add_u32 m0, s79, 119808
    s_nop 0
    buffer_load_dwordx4 v21, s[36:39], s78 offen sc1 lds
    v_mul_f32 v80, v132, v132
    v_mul_f32 v81, v133, v133
    v_mul_f32 v82, v134, v134
    v_mul_f32 v83, v135, v135
    v_fma_f32 v80, v80, v78, v77
    v_fma_f32 v81, v81, v78, v77
    v_fma_f32 v82, v82, v78, v77
    v_fma_f32 v83, v83, v78, v77
    s_add_u32 m0, s81, 133120
    s_mov_b32 s78, 640
    s_mov_b64 exec, 0xffffffff
    buffer_load_dwordx4 v3, s[36:39], s78 offen sc1 lds
    s_mov_b64 exec, -1
    v_mul_f32 v80, v80, v132
    v_mul_f32 v81, v81, v133
    v_mul_f32 v82, v82, v134
    v_mul_f32 v83, v83, v135
    v_exp_f32 v80, v80
    v_mul_f32 v132, v132, v148
    v_exp_f32 v81, v81
    s_add_u32 m0, s33, 57344
    s_mov_b32 s76, 1966080
    buffer_load_dwordx4 v23, s[40:43], s76 offen offset:0 lds
    s_add_u32 m0, s33, 59392
    s_nop 0
    buffer_load_dwordx4 v23, s[40:43], s76 offen offset:2048 lds
    v_mul_f32 v133, v133, v149
    v_exp_f32 v82, v82
    v_mul_f32 v134, v134, v150
    v_exp_f32 v83, v83
    v_mul_f32 v135, v135, v151
    v_fma_f32 v80, v80, v79, v79
    s_add_u32 m0, s33, 65536
    s_nop 0
    buffer_load_dwordx4 v23, s[44:47], s76 offen offset:0 lds
    v_fma_f32 v81, v81, v79, v79
    v_fma_f32 v82, v82, v79, v79
    v_fma_f32 v83, v83, v79, v79
    v_rcp_f32 v80, v80
    v_rcp_f32 v81, v81
    v_rcp_f32 v82, v82
    s_add_u32 m0, s33, 69632
    s_mov_b32 s77, 2293760
    buffer_load_dwordx4 v22, s[48:51], s77 offen offset:0 lds
    v_rcp_f32 v83, v83
    s_nop 0
    v_mul_f32 v132, v132, v80
    v_mul_f32 v133, v133, v81
    v_mul_f32 v134, v134, v82
    v_mul_f32 v135, v135, v83
    v_cvt_pk_bf16_f32 v130, v132, v133
    v_cvt_pk_bf16_f32 v131, v134, v135
    s_add_u32 m0, s33, 73728
    s_nop 0
    buffer_load_dwordx4 v22, s[52:55], s77 offen offset:0 lds
    s_load_dword s94, s[10:11], s75 offset:0x80100
    s_load_dword s94, s[10:11], s75 offset:0x80140
    s_load_dword s94, s[10:11], s75 offset:0x80180
    s_load_dword s94, s[10:11], s75 offset:0x801c0
    s_waitcnt vmcnt(16)
    s_barrier
    s_add_u32 m0, s79, 135168
    s_mov_b32 s78, 768
    buffer_load_dwordx4 v20, s[36:39], s78 offen sc1 lds
    s_nop 1
    v_permlane16_swap_b32 v128, v130
    v_permlane16_swap_b32 v129, v131
    v_fmac_f32 v152, v40, v64
    v_fmac_f32 v153, v41, v64
    v_fmac_f32 v154, v42, v64
    v_fmac_f32 v155, v43, v64
    v_fmac_f32 v168, v44, v64
    v_fmac_f32 v169, v45, v64
    v_fmac_f32 v170, v46, v64
    v_fmac_f32 v171, v47, v64
    s_add_u32 m0, s79, 136192
    s_nop 0
    buffer_load_dwordx4 v21, s[36:39], s78 offen sc1 lds
    v_mul_f32 v80, v152, v152
    v_mul_f32 v81, v153, v153
    v_mul_f32 v82, v154, v154
    v_mul_f32 v83, v155, v155
    v_fma_f32 v80, v80, v66, v65
    v_fma_f32 v81, v81, v66, v65
    v_fma_f32 v82, v82, v66, v65
    v_fma_f32 v83, v83, v66, v65
    s_add_u32 m0, s33, 77824
    s_mov_b32 s76, 2162688
    buffer_load_dwordx4 v23, s[40:43], s76 offen offset:0 lds
    v_mul_f32 v80, v80, v152
    v_mul_f32 v81, v81, v153
    v_mul_f32 v82, v82, v154
    v_mul_f32 v83, v83, v155
    v_exp_f32 v80, v80
    v_mul_f32 v152, v152, v168
    v_exp_f32 v81, v81
    s_add_u32 m0, s33, 79872
    s_nop 0
    buffer_load_dwordx4 v23, s[40:43], s76 offen offset:2048 lds
    s_add_u32 m0, s33, 86016
    s_nop 0
    buffer_load_dwordx4 v23, s[44:47], s76 offen offset:0 lds
    v_mul_f32 v153, v153, v169
    v_exp_f32 v82, v82
    v_mul_f32 v154, v154, v170
    v_exp_f32 v83, v83
    v_mul_f32 v155, v155, v171
    v_fma_f32 v80, v80, v67, v67
    s_add_u32 m0, s33, 90112
    s_mov_b32 s77, 2523136
    buffer_load_dwordx4 v22, s[48:51], s77 offen offset:0 lds
    v_fma_f32 v81, v81, v67, v67
    v_fma_f32 v82, v82, v67, v67
    v_fma_f32 v83, v83, v67, v67
    v_rcp_f32 v80, v80
    v_rcp_f32 v81, v81
    v_rcp_f32 v82, v82
    s_add_u32 m0, s33, 94208
    s_nop 0
    buffer_load_dwordx4 v22, s[52:55], s77 offen offset:0 lds
    v_rcp_f32 v83, v83
    s_nop 0
    v_mul_f32 v152, v152, v80
    v_mul_f32 v153, v153, v81
    v_mul_f32 v154, v154, v82
    v_mul_f32 v155, v155, v83
    v_cvt_pk_bf16_f32 v152, v152, v153
    v_cvt_pk_bf16_f32 v153, v154, v155
    buffer_store_dwordx4 v[128:131], v19, s[68:71], s72 offen offset:2560 sc1
    s_add_u32 s75, s75, 0x100000
    s_load_dword s94, s[10:11], s75 offset:0x0
    s_load_dword s94, s[10:11], s75 offset:0x40
    s_load_dword s94, s[10:11], s75 offset:0x80
    s_load_dword s94, s[10:11], s75 offset:0xc0
    s_waitcnt vmcnt(56)
    s_movk_i32 s98, 0x4000
L_tokA_chk:
    v_readfirstlane_b32 s100, v6
    v_readfirstlane_b32 s101, v7
    s_nop 1
    s_cmp_lg_u32 s100, 0
    s_cbranch_scc1 L_tokA_ok
    s_sub_u32 s98, s98, 1
    s_cbranch_scc1 L_tokA_ok
    s_sleep 1
    global_load_dwordx2 v[6:7], v5, s[24:25] sc1
    s_waitcnt vmcnt(0)
    s_branch L_tokA_chk
L_tokA_ok:
    s_waitcnt vmcnt(17)
    s_barrier
    s_add_u32 m0, s79, 137216
    s_mov_b32 s78, 33536
    buffer_load_dwordx4 v20, s[36:39], s78 offen sc1 lds
    v_fmac_f32 v156, v40, v68
    v_fmac_f32 v157, v41, v68
    v_fmac_f32 v158, v42, v68
    v_fmac_f32 v159, v43, v68
    v_fmac_f32 v172, v44, v68
    v_fmac_f32 v173, v45, v68
    v_fmac_f32 v174, v46, v68
    v_fmac_f32 v175, v47, v68
    s_add_u32 m0, s79, 138240
    s_nop 0
    buffer_load_dwordx4 v21, s[36:39], s78 offen sc1 lds
    v_mul_f32 v80, v156, v156
    v_mul_f32 v81, v157, v157
    v_mul_f32 v82, v158, v158
    v_mul_f32 v83, v159, v159
    v_fma_f32 v80, v80, v70, v69
    v_fma_f32 v81, v81, v70, v69
    v_fma_f32 v82, v82, v70, v69
    v_fma_f32 v83, v83, v70, v69
    s_add_u32 m0, s81, 151552
    s_mov_b32 s78, 768
    s_mov_b64 exec, 0xffffffff
    buffer_load_dwordx4 v3, s[36:39], s78 offen sc1 lds
    s_mov_b64 exec, -1
    v_mul_f32 v80, v80, v156
    v_mul_f32 v81, v81, v157
    v_mul_f32 v82, v82, v158
    v_mul_f32 v83, v83, v159
    v_exp_f32 v80, v80
    v_mul_f32 v156, v156, v172
    v_exp_f32 v81, v81
    s_add_u32 m0, s33, 16384
    s_mov_b32 s76, 2359296
    buffer_load_dwordx4 v23, s[40:43], s76 offen offset:0 lds
    s_add_u32 m0, s33, 18432
    s_nop 0
    buffer_load_dwordx4 v23, s[40:43], s76 offen offset:2048 lds
    v_mul_f32 v157, v157, v173
    v_exp_f32 v82, v82
    v_mul_f32 v158, v158, v174
    v_exp_f32 v83, v83
    v_mul_f32 v159, v159, v175
    v_fma_f32 v80, v80, v71, v71
    s_add_u32 m0, s33, 24576
    s_nop 0
    buffer_load_dwordx4 v23, s[44:47], s76 offen offset:0 lds
    v_fma_f32 v81, v81, v71, v71
    v_fma_f32 v82, v82, v71, v71
    v_fma_f32 v83, v83, v71, v71
    v_rcp_f32 v80, v80
    v_rcp_f32 v81, v81
    v_rcp_f32 v82, v82
    s_add_u32 m0, s33, 28672
    s_mov_b32 s77, 2752512
    buffer_load_dwordx4 v22, s[48:51], s77 offen offset:0 lds
    v_rcp_f32 v83, v83
    s_nop 0
    v_mul_f32 v156, v156, v80
    v_mul_f32 v157, v157, v81
    v_mul_f32 v158, v158, v82
    v_mul_f32 v159, v159, v83
    v_cvt_pk_bf16_f32 v154, v156, v157
    v_cvt_pk_bf16_f32 v155, v158, v159
    s_add_u32 m0, s33, 32768
    s_nop 0
    buffer_load_dwordx4 v22, s[52:55], s77 offen offset:0 lds
    s_load_dword s94, s[10:11], s75 offset:0x100
    s_load_dword s94, s[10:11], s75 offset:0x140
    s_load_dword s94, s[10:11], s75 offset:0x180
    s_load_dword s94, s[10:11], s75 offset:0x1c0
    s_waitcnt vmcnt(16)
    s_barrier
    s_add_u32 m0, s79, 98304
    s_mov_b32 s78, 896
    buffer_load_dwordx4 v20, s[36:39], s78 offen sc1 lds
    s_nop 1
    v_permlane16_swap_b32 v152, v154
    v_permlane16_swap_b32 v153, v155
    v_fmac_f32 v160, v40, v72
    v_fmac_f32 v161, v41, v72
    v_fmac_f32 v162, v42, v72
    v_fmac_f32 v163, v43, v72
    v_fmac_f32 v176, v44, v72
    v_fmac_f32 v177, v45, v72
    v_fmac_f32 v178, v46, v72
    v_fmac_f32 v179, v47, v72
    s_add_u32 m0, s79, 99328
    s_nop 0
    buffer_load_dwordx4 v21, s[36:39], s78 offen sc1 lds
    v_mul_f32 v80, v160, v160
    v_mul_f32 v81, v161, v161
    v_mul_f32 v82, v162, v162
    v_mul_f32 v83, v163, v163
    v_fma_f32 v80, v80, v74, v73
    v_fma_f32 v81, v81, v74, v73
    v_fma_f32 v82, v82, v74, v73
    v_fma_f32 v83, v83, v74, v73
    s_add_u32 m0, s33, 36864
    s_mov_b32 s76, 2555904
    buffer_load_dwordx4 v23, s[40:43], s76 offen offset:0 lds
    v_mul_f32 v80, v80, v160
    v_mul_f32 v81, v81, v161
    v_mul_f32 v82, v82, v162
    v_mul_f32 v83, v83, v163
    v_exp_f32 v80, v80
    v_mul_f32 v160, v160, v176
    v_exp_f32 v81, v81
    s_add_u32 m0, s33, 38912
    s_nop 0
    buffer_load_dwordx4 v23, s[40:43], s76 offen offset:2048 lds
    s_add_u32 m0, s33, 45056
    s_nop 0
    buffer_load_dwordx4 v23, s[44:47], s76 offen offset:0 lds
    v_mul_f32 v161, v161, v177
    v_exp_f32 v82, v82
    v_mul_f32 v162, v162, v178
    v_exp_f32 v83, v83
    v_mul_f32 v163, v163, v179
    v_fma_f32 v80, v80, v75, v75
    s_add_u32 m0, s33, 49152
    s_mov_b32 s77, 2981888
    buffer_load_dwordx4 v22, s[48:51], s77 offen offset:0 lds
    v_fma_f32 v81, v81, v75, v75
    v_fma_f32 v82, v82, v75, v75
    v_fma_f32 v83, v83, v75, v75
    v_rcp_f32 v80, v80
    v_rcp_f32 v81, v81
    v_rcp_f32 v82, v82
    s_add_u32 m0, s33, 53248
    s_nop 0
    buffer_load_dwordx4 v22, s[52:55], s77 offen offset:0 lds
    v_rcp_f32 v83, v83
    s_nop 0
    v_mul_f32 v160, v160, v80
    v_mul_f32 v161, v161, v81
    v_mul_f32 v162, v162, v82
    v_mul_f32 v163, v163, v83
    v_cvt_pk_bf16_f32 v160, v160, v161
    v_cvt_pk_bf16_f32 v161, v162, v163
    buffer_store_dwordx4 v[152:155], v19, s[68:71], s73 offen offset:0 sc1
    s_add_u32 s99, s99, 0x1c0000
    s_load_dword s94, s[16:17], s99 offset:0x0
    s_load_dword s94, s[16:17], s99 offset:0x40
    s_load_dword s94, s[16:17], s99 offset:0x80
    s_load_dword s94, s[16:17], s99 offset:0xc0
    s_waitcnt vmcnt(17)
    s_barrier
    s_add_u32 m0, s79, 100352
    s_mov_b32 s78, 33664
    buffer_load_dwordx4 v20, s[36:39], s78 offen sc1 lds
    v_fmac_f32 v164, v40, v76
    v_fmac_f32 v165, v41, v76
    v_fmac_f32 v166, v42, v76
    v_fmac_f32 v167, v43, v76
    v_fmac_f32 v180, v44, v76
    v_fmac_f32 v181, v45, v76
    v_fmac_f32 v182, v46, v76
    v_fmac_f32 v183, v47, v76
    s_add_u32 m0, s79, 101376
    s_nop 0
    buffer_load_dwordx4 v21, s[36:39], s78 offen sc1 lds
    v_mul_f32 v80, v164, v164
    v_mul_f32 v81, v165, v165
    v_mul_f32 v82, v166, v166
    v_mul_f32 v83, v167, v167
    v_fma_f32 v80, v80, v78, v77
    v_fma_f32 v81, v81, v78, v77
    v_fma_f32 v82, v82, v78, v77
    v_fma_f32 v83, v83, v78, v77
    s_add_u32 m0, s81, 114688
    s_mov_b32 s78, 896
    s_mov_b64 exec, 0xffffffff
    buffer_load_dwordx4 v3, s[36:39], s78 offen sc1 lds
    s_mov_b64 exec, -1
    v_mul_f32 v80, v80, v164
    v_mul_f32 v81, v81, v165
    v_mul_f32 v82, v82, v166
    v_mul_f32 v83, v83, v167
    v_exp_f32 v80, v80
    v_mul_f32 v164, v164, v180
    v_exp_f32 v81, v81
    s_add_u32 m0, s33, 57344
    s_mov_b32 s76, 2752512
    buffer_load_dwordx4 v23, s[40:43], s76 offen offset:0 lds
    s_add_u32 m0, s33, 59392
    s_nop 0
    buffer_load_dwordx4 v23, s[40:43], s76 offen offset:2048 lds
    v_mul_f32 v165, v165, v181
    v_exp_f32 v82, v82
    v_mul_f32 v166, v166, v182
    v_exp_f32 v83, v83
    v_mul_f32 v167, v167, v183
    v_fma_f32 v80, v80, v79, v79
    s_add_u32 m0, s33, 65536
    s_nop 0
    buffer_load_dwordx4 v23, s[44:47], s76 offen offset:0 lds
    v_fma_f32 v81, v81, v79, v79
    v_fma_f32 v82, v82, v79, v79
    v_fma_f32 v83, v83, v79, v79
    v_rcp_f32 v80, v80
    v_rcp_f32 v81, v81
    v_rcp_f32 v82, v82
    s_add_u32 m0, s33, 69632
    s_mov_b32 s77, 3211264
    buffer_load_dwordx4 v22, s[48:51], s77 offen offset:0 lds
    v_rcp_f32 v83, v83
    s_nop 0
    v_mul_f32 v164, v164, v80
    v_mul_f32 v165, v165, v81
    v_mul_f32 v166, v166, v82
    v_mul_f32 v167, v167, v83
    v_cvt_pk_bf16_f32 v162, v164, v165
    v_cvt_pk_bf16_f32 v163, v166, v167
    s_add_u32 m0, s33, 73728
    s_nop 0
    buffer_load_dwordx4 v22, s[52:55], s77 offen offset:0 lds
    s_load_dword s94, s[16:17], s99 offset:0x100
    s_load_dword s94, s[16:17], s99 offset:0x140
    s_load_dword s94, s[16:17], s99 offset:0x180
    s_load_dword s94, s[16:17], s99 offset:0x1c0
    s_waitcnt vmcnt(16)
    s_barrier
    s_add_u32 m0, s79, 116736
    s_mov_b32 s78, 1024
    buffer_load_dwordx4 v20, s[36:39], s78 offen sc1 lds
    s_nop 1
    v_permlane16_swap_b32 v160, v162
    v_permlane16_swap_b32 v161, v163
    v_fmac_f32 v184, v48, v64
    v_fmac_f32 v185, v49, v64
    v_fmac_f32 v186, v50, v64
    v_fmac_f32 v187, v51, v64
    v_fmac_f32 v200, v52, v64
    v_fmac_f32 v201, v53, v64
    v_fmac_f32 v202, v54, v64
    v_fmac_f32 v203, v55, v64
    s_add_u32 m0, s79, 117760
    s_nop 0
    buffer_load_dwordx4 v21, s[36:39], s78 offen sc1 lds
    v_mul_f32 v80, v184, v184
    v_mul_f32 v81, v185, v185
    v_mul_f32 v82, v186, v186
    v_mul_f32 v83, v187, v187
    v_fma_f32 v80, v80, v66, v65
    v_fma_f32 v81, v81, v66, v65
    v_fma_f32 v82, v82, v66, v65
    v_fma_f32 v83, v83, v66, v65
    s_add_u32 m0, s33, 77824
    s_mov_b32 s76, 2949120
    buffer_load_dwordx4 v23, s[40:43], s76 offen offset:0 lds
    v_mul_f32 v80, v80, v184
    v_mul_f32 v81, v81, v185
    v_mul_f32 v82, v82, v186
    v_mul_f32 v83, v83, v187
    v_exp_f32 v80, v80
    v_mul_f32 v184, v184, v200
    v_exp_f32 v81, v81
    s_add_u32 m0, s33, 79872
    s_nop 0
    buffer_load_dwordx4 v23, s[40:43], s76 offen offset:2048 lds
    s_add_u32 m0, s33, 86016
    s_nop 0
    buffer_load_dwordx4 v23, s[44:47], s76 offen offset:0 lds
    v_mul_f32 v185, v185, v201
    v_exp_f32 v82, v82
    v_mul_f32 v186, v186, v202
    v_exp_f32 v83, v83
    v_mul_f32 v187, v187, v203
    v_fma_f32 v80, v80, v67, v67
    s_add_u32 m0, s33, 90112
    s_mov_b32 s77, 3440640
    buffer_load_dwordx4 v22, s[48:51], s77 offen offset:0 lds
    v_fma_f32 v81, v81, v67, v67
    v_fma_f32 v82, v82, v67, v67
    v_fma_f32 v83, v83, v67, v67
    v_rcp_f32 v80, v80
    v_rcp_f32 v81, v81
    v_rcp_f32 v82, v82
    s_add_u32 m0, s33, 94208
    s_nop 0
    buffer_load_dwordx4 v22, s[52:55], s77 offen offset:0 lds
    v_rcp_f32 v83, v83
    s_nop 0
    v_mul_f32 v184, v184, v80
    v_mul_f32 v185, v185, v81
    v_mul_f32 v186, v186, v82
    v_mul_f32 v187, v187, v83
    v_cvt_pk_bf16_f32 v184, v184, v185
    v_cvt_pk_bf16_f32 v185, v186, v187
    buffer_store_dwordx4 v[160:163], v19, s[68:71], s73 offen offset:2048 sc1
    s_load_dword s94, s[18:19], s99 offset:0x0
    s_load_dword s94, s[18:19], s99 offset:0x40
    s_load_dword s94, s[18:19], s99 offset:0x80
    s_load_dword s94, s[18:19], s99 offset:0xc0
    s_waitcnt vmcnt(17)
    s_barrier
    s_add_u32 m0, s79, 118784
    s_mov_b32 s78, 33792
    buffer_load_dwordx4 v20, s[36:39], s78 offen sc1 lds
    v_fmac_f32 v188, v48, v68
    v_fmac_f32 v189, v49, v68
    v_fmac_f32 v190, v50, v68
    v_fmac_f32 v191, v51, v68
    v_fmac_f32 v204, v52, v68
    v_fmac_f32 v205, v53, v68
    v_fmac_f32 v206, v54, v68
    v_fmac_f32 v207, v55, v68
    s_add_u32 m0, s79, 119808
    s_nop 0
    buffer_load_dwordx4 v21, s[36:39], s78 offen sc1 lds
    v_mul_f32 v80, v188, v188
    v_mul_f32 v81, v189, v189
    v_mul_f32 v82, v190, v190
    v_mul_f32 v83, v191, v191
    v_fma_f32 v80, v80, v70, v69
    v_fma_f32 v81, v81, v70, v69
    v_fma_f32 v82, v82, v70, v69
    v_fma_f32 v83, v83, v70, v69
    s_add_u32 m0, s81, 133120
    s_mov_b32 s78, 1024
    s_mov_b64 exec, 0xffffffff
    buffer_load_dwordx4 v3, s[36:39], s78 offen sc1 lds
    s_mov_b64 exec, -1
    v_mul_f32 v80, v80, v188
    v_mul_f32 v81, v81, v189
    v_mul_f32 v82, v82, v190
    v_mul_f32 v83, v83, v191
    v_exp_f32 v80, v80
    v_mul_f32 v188, v188, v204
    v_exp_f32 v81, v81
    s_add_u32 m0, s33, 16384
    s_mov_b32 s76, 3145728
    buffer_load_dwordx4 v23, s[40:43], s76 offen offset:0 lds
    s_add_u32 m0, s33, 18432
    s_nop 0
    buffer_load_dwordx4 v23, s[40:43], s76 offen offset:2048 lds
    v_mul_f32 v189, v189, v205
    v_exp_f32 v82, v82
    v_mul_f32 v190, v190, v206
    v_exp_f32 v83, v83
    v_mul_f32 v191, v191, v207
    v_fma_f32 v80, v80, v71, v71
    s_add_u32 m0, s33, 24576
    s_nop 0
    buffer_load_dwordx4 v23, s[44:47], s76 offen offset:0 lds
    v_fma_f32 v81, v81, v71, v71
    v_fma_f32 v82, v82, v71, v71
    v_fma_f32 v83, v83, v71, v71
    v_rcp_f32 v80, v80
    v_rcp_f32 v81, v81
    v_rcp_f32 v82, v82
    s_add_u32 m0, s33, 28672
    s_mov_b32 s77, 3670016
    buffer_load_dwordx4 v22, s[48:51], s77 offen offset:0 lds
    v_rcp_f32 v83, v83
    s_nop 0
    v_mul_f32 v188, v188, v80
    v_mul_f32 v189, v189, v81
    v_mul_f32 v190, v190, v82
    v_mul_f32 v191, v191, v83
    v_cvt_pk_bf16_f32 v186, v188, v189
    v_cvt_pk_bf16_f32 v187, v190, v191
    s_add_u32 m0, s33, 32768
    s_nop 0
    buffer_load_dwordx4 v22, s[52:55], s77 offen offset:0 lds
    s_load_dword s94, s[18:19], s99 offset:0x100
    s_load_dword s94, s[18:19], s99 offset:0x140
    s_load_dword s94, s[18:19], s99 offset:0x180
    s_load_dword s94, s[18:19], s99 offset:0x1c0
    s_waitcnt vmcnt(16)
    s_barrier
    s_add_u32 m0, s79, 135168
    s_mov_b32 s78, 1152
    buffer_load_dwordx4 v20, s[36:39], s78 offen sc1 lds
    s_nop 1
    v_permlane16_swap_b32 v184, v186
    v_permlane16_swap_b32 v185, v187
    v_fmac_f32 v192, v48, v72
    v_fmac_f32 v193, v49, v72
    v_fmac_f32 v194, v50, v72
    v_fmac_f32 v195, v51, v72
    v_fmac_f32 v208, v52, v72
    v_fmac_f32 v209, v53, v72
    v_fmac_f32 v210, v54, v72
    v_fmac_f32 v211, v55, v72
    s_add_u32 m0, s79, 136192
    s_nop 0
    buffer_load_dwordx4 v21, s[36:39], s78 offen sc1 lds
    v_mul_f32 v80, v192, v192
    v_mul_f32 v81, v193, v193
    v_mul_f32 v82, v194, v194
    v_mul_f32 v83, v195, v195
    v_fma_f32 v80, v80, v74, v73
    v_fma_f32 v81, v81, v74, v73
    v_fma_f32 v82, v82, v74, v73
    v_fma_f32 v83, v83, v74, v73
    s_add_u32 m0, s33, 36864
    s_mov_b32 s76, 3342336
    buffer_load_dwordx4 v23, s[40:43], s76 offen offset:0 lds
    v_mul_f32 v80, v80, v192
    v_mul_f32 v81, v81, v193
    v_mul_f32 v82, v82, v194
    v_mul_f32 v83, v83, v195
    v_exp_f32 v80, v80
    v_mul_f32 v192, v192, v208
    v_exp_f32 v81, v81
    s_add_u32 m0, s33, 38912
    s_nop 0
    buffer_load_dwordx4 v23, s[40:43], s76 offen offset:2048 lds
    s_add_u32 m0, s33, 45056
    s_nop 0
    buffer_load_dwordx4 v23, s[44:47], s76 offen offset:0 lds
    v_mul_f32 v193, v193, v209
    v_exp_f32 v82, v82
    v_mul_f32 v194, v194, v210
    v_exp_f32 v83, v83
    v_mul_f32 v195, v195, v211
    v_fma_f32 v80, v80, v75, v75
    s_add_u32 m0, s33, 49152
    s_mov_b32 s77, 3899392
    buffer_load_dwordx4 v22, s[48:51], s77 offen offset:0 lds
    v_fma_f32 v81, v81, v75, v75
    v_fma_f32 v82, v82, v75, v75
    v_fma_f32 v83, v83, v75, v75
    v_rcp_f32 v80, v80
    v_rcp_f32 v81, v81
    v_rcp_f32 v82, v82
    s_add_u32 m0, s33, 53248
    s_nop 0
    buffer_load_dwordx4 v22, s[52:55], s77 offen offset:0 lds
    v_rcp_f32 v83, v83
    s_nop 0
    v_mul_f32 v192, v192, v80
    v_mul_f32 v193, v193, v81
    v_mul_f32 v194, v194, v82
    v_mul_f32 v195, v195, v83
    v_cvt_pk_bf16_f32 v192, v192, v193
    v_cvt_pk_bf16_f32 v193, v194, v195
    buffer_store_dwordx4 v[184:187], v19, s[68:71], s73 offen offset:512 sc1
    s_load_dword s94, s[10:11], s75 offset:0x80000
    s_load_dword s94, s[10:11], s75 offset:0x80040
    s_load_dword s94, s[10:11], s75 offset:0x80080
    s_load_dword s94, s[10:11], s75 offset:0x800c0
    s_waitcnt vmcnt(17)
    s_barrier
    s_add_u32 m0, s79, 137216
    s_mov_b32 s78, 33920
    buffer_load_dwordx4 v20, s[36:39], s78 offen sc1 lds
    v_fmac_f32 v196, v48, v76
    v_fmac_f32 v197, v49, v76
    v_fmac_f32 v198, v50, v76
    v_fmac_f32 v199, v51, v76
    v_fmac_f32 v212, v52, v76
    v_fmac_f32 v213, v53, v76
    v_fmac_f32 v214, v54, v76
    v_fmac_f32 v215, v55, v76
    s_add_u32 m0, s79, 138240
    s_nop 0
    buffer_load_dwordx4 v21, s[36:39], s78 offen sc1 lds
    v_mul_f32 v80, v196, v196
    v_mul_f32 v81, v197, v197
    v_mul_f32 v82, v198, v198
    v_mul_f32 v83, v199, v199
    v_fma_f32 v80, v80, v78, v77
    v_fma_f32 v81, v81, v78, v77
    v_fma_f32 v82, v82, v78, v77
    v_fma_f32 v83, v83, v78, v77
    s_add_u32 m0, s81, 151552
    s_mov_b32 s78, 1152
    s_mov_b64 exec, 0xffffffff
    buffer_load_dwordx4 v3, s[36:39], s78 offen sc1 lds
    s_mov_b64 exec, -1
    v_mul_f32 v80, v80, v196
    v_mul_f32 v81, v81, v197
    v_mul_f32 v82, v82, v198
    v_mul_f32 v83, v83, v199
    v_exp_f32 v80, v80
    v_mul_f32 v196, v196, v212
    v_exp_f32 v81, v81
    s_add_u32 m0, s33, 57344
    s_mov_b32 s76, 3538944
    buffer_load_dwordx4 v23, s[40:43], s76 offen offset:0 lds
    s_add_u32 m0, s33, 59392
    s_nop 0
    buffer_load_dwordx4 v23, s[40:43], s76 offen offset:2048 lds
    v_mul_f32 v197, v197, v213
    v_exp_f32 v82, v82
    v_mul_f32 v198, v198, v214
    v_exp_f32 v83, v83
    v_mul_f32 v199, v199, v215
    v_fma_f32 v80, v80, v79, v79
    s_add_u32 m0, s33, 65536
    s_nop 0
    buffer_load_dwordx4 v23, s[44:47], s76 offen offset:0 lds
    v_fma_f32 v81, v81, v79, v79
    v_fma_f32 v82, v82, v79, v79
    v_fma_f32 v83, v83, v79, v79
    v_rcp_f32 v80, v80
    v_rcp_f32 v81, v81
    v_rcp_f32 v82, v82
    s_add_u32 m0, s33, 69632
    s_mov_b32 s77, 4128768
    buffer_load_dwordx4 v22, s[48:51], s77 offen offset:0 lds
    v_rcp_f32 v83, v83
    s_nop 0
    v_mul_f32 v196, v196, v80
    v_mul_f32 v197, v197, v81
    v_mul_f32 v198, v198, v82
    v_mul_f32 v199, v199, v83
    v_cvt_pk_bf16_f32 v194, v196, v197
    v_cvt_pk_bf16_f32 v195, v198, v199
    s_add_u32 m0, s33, 73728
    s_nop 0
    buffer_load_dwordx4 v22, s[52:55], s77 offen offset:0 lds
    s_load_dword s94, s[10:11], s75 offset:0x80100
    s_load_dword s94, s[10:11], s75 offset:0x80140
    s_load_dword s94, s[10:11], s75 offset:0x80180
    s_load_dword s94, s[10:11], s75 offset:0x801c0
    s_waitcnt vmcnt(16)
    s_barrier
    s_add_u32 m0, s79, 98304
    s_mov_b32 s78, 1280
    buffer_load_dwordx4 v20, s[36:39], s78 offen sc1 lds
    s_nop 1
    v_permlane16_swap_b32 v192, v194
    v_permlane16_swap_b32 v193, v195
    v_fmac_f32 v216, v56, v64
    v_fmac_f32 v217, v57, v64
    v_fmac_f32 v218, v58, v64
    v_fmac_f32 v219, v59, v64
    v_fmac_f32 v232, v60, v64
    v_fmac_f32 v233, v61, v64
    v_fmac_f32 v234, v62, v64
    v_fmac_f32 v235, v63, v64
    s_add_u32 m0, s79, 99328
    s_nop 0
    buffer_load_dwordx4 v21, s[36:39], s78 offen sc1 lds
    v_mul_f32 v80, v216, v216
    v_mul_f32 v81, v217, v217
    v_mul_f32 v82, v218, v218
    v_mul_f32 v83, v219, v219
    v_fma_f32 v80, v80, v66, v65
    v_fma_f32 v81, v81, v66, v65
    v_fma_f32 v82, v82, v66, v65
    v_fma_f32 v83, v83, v66, v65
    s_add_u32 m0, s33, 77824
    s_mov_b32 s76, 3735552
    buffer_load_dwordx4 v23, s[40:43], s76 offen offset:0 lds
    v_mul_f32 v80, v80, v216
    v_mul_f32 v81, v81, v217
    v_mul_f32 v82, v82, v218
    v_mul_f32 v83, v83, v219
    v_exp_f32 v80, v80
    v_mul_f32 v216, v216, v232
    v_exp_f32 v81, v81
    s_add_u32 m0, s33, 79872
    s_nop 0
    buffer_load_dwordx4 v23, s[40:43], s76 offen offset:2048 lds
    s_add_u32 m0, s33, 86016
    s_nop 0
    buffer_load_dwordx4 v23, s[44:47], s76 offen offset:0 lds
    v_mul_f32 v217, v217, v233
    v_exp_f32 v82, v82
    v_mul_f32 v218, v218, v234
    v_exp_f32 v83, v83
    v_mul_f32 v219, v219, v235
    v_fma_f32 v80, v80, v67, v67
    s_add_u32 m0, s33, 90112
    s_mov_b32 s77, 4358144
    buffer_load_dwordx4 v22, s[48:51], s77 offen offset:0 lds
    v_fma_f32 v81, v81, v67, v67
    v_fma_f32 v82, v82, v67, v67
    v_fma_f32 v83, v83, v67, v67
    v_rcp_f32 v80, v80
    v_rcp_f32 v81, v81
    v_rcp_f32 v82, v82
    s_add_u32 m0, s33, 94208
    s_nop 0
    buffer_load_dwordx4 v22, s[52:55], s77 offen offset:0 lds
    v_rcp_f32 v83, v83
    s_nop 0
    v_mul_f32 v216, v216, v80
    v_mul_f32 v217, v217, v81
    v_mul_f32 v218, v218, v82
    v_mul_f32 v219, v219, v83
    v_cvt_pk_bf16_f32 v216, v216, v217
    v_cvt_pk_bf16_f32 v217, v218, v219
    buffer_store_dwordx4 v[192:195], v19, s[68:71], s73 offen offset:2560 sc1
    s_add_u32 s75, s75, 0x100000
    s_load_dword s94, s[10:11], s75 offset:0x0
    s_load_dword s94, s[10:11], s75 offset:0x40
    s_load_dword s94, s[10:11], s75 offset:0x80
    s_load_dword s94, s[10:11], s75 offset:0xc0
    s_waitcnt vmcnt(17)
    s_barrier
    s_add_u32 m0, s79, 100352
    s_mov_b32 s78, 34048
    buffer_load_dwordx4 v20, s[36:39], s78 offen sc1 lds
    v_fmac_f32 v220, v56, v68
    v_fmac_f32 v221, v57, v68
    v_fmac_f32 v222, v58, v68
    v_fmac_f32 v223, v59, v68
    v_fmac_f32 v236, v60, v68
    v_fmac_f32 v237, v61, v68
    v_fmac_f32 v238, v62, v68
    v_fmac_f32 v239, v63, v68
    s_add_u32 m0, s79, 101376
    s_nop 0
    buffer_load_dwordx4 v21, s[36:39], s78 offen sc1 lds
    v_mul_f32 v80, v220, v220
    v_mul_f32 v81, v221, v221
    v_mul_f32 v82, v222, v222
    v_mul_f32 v83, v223, v223
    v_fma_f32 v80, v80, v70, v69
    v_fma_f32 v81, v81, v70, v69
    v_fma_f32 v82, v82, v70, v69
    v_fma_f32 v83, v83, v70, v69
    s_add_u32 m0, s81, 114688
    s_mov_b32 s78, 1280
    s_mov_b64 exec, 0xffffffff
    buffer_load_dwordx4 v3, s[36:39], s78 offen sc1 lds
    s_mov_b64 exec, -1
    v_mul_f32 v80, v80, v220
    v_mul_f32 v81, v81, v221
    v_mul_f32 v82, v82, v222
    v_mul_f32 v83, v83, v223
    v_exp_f32 v80, v80
    v_mul_f32 v220, v220, v236
    v_exp_f32 v81, v81
    s_add_u32 m0, s33, 16384
    s_mov_b32 s76, 3932160
    buffer_load_dwordx4 v23, s[40:43], s76 offen offset:0 lds
    s_add_u32 m0, s33, 18432
    s_nop 0
    buffer_load_dwordx4 v23, s[40:43], s76 offen offset:2048 lds
    v_mul_f32 v221, v221, v237
    v_exp_f32 v82, v82
    v_mul_f32 v222, v222, v238
    v_exp_f32 v83, v83
    v_mul_f32 v223, v223, v239
    v_fma_f32 v80, v80, v71, v71
    s_add_u32 m0, s33, 24576
    s_nop 0
    buffer_load_dwordx4 v23, s[44:47], s76 offen offset:0 lds
    v_fma_f32 v81, v81, v71, v71
    v_fma_f32 v82, v82, v71, v71
    v_fma_f32 v83, v83, v71, v71
    v_rcp_f32 v80, v80
    v_rcp_f32 v81, v81
    v_rcp_f32 v82, v82
    s_add_u32 m0, s33, 28672
    s_mov_b32 s77, 4587520
    buffer_load_dwordx4 v22, s[48:51], s77 offen offset:0 lds
    v_rcp_f32 v83, v83
    s_nop 0
    v_mul_f32 v220, v220, v80
    v_mul_f32 v221, v221, v81
    v_mul_f32 v222, v222, v82
    v_mul_f32 v223, v223, v83
    v_cvt_pk_bf16_f32 v218, v220, v221
    v_cvt_pk_bf16_f32 v219, v222, v223
    s_add_u32 m0, s33, 32768
    s_nop 0
    buffer_load_dwordx4 v22, s[52:55], s77 offen offset:0 lds
    s_load_dword s94, s[10:11], s75 offset:0x100
    s_load_dword s94, s[10:11], s75 offset:0x140
    s_load_dword s94, s[10:11], s75 offset:0x180
    s_load_dword s94, s[10:11], s75 offset:0x1c0
    s_waitcnt vmcnt(16)
    s_barrier
    s_add_u32 m0, s79, 116736
    s_mov_b32 s78, 1408
    buffer_load_dwordx4 v20, s[36:39], s78 offen sc1 lds
    s_nop 1
    v_permlane16_swap_b32 v216, v218
    v_permlane16_swap_b32 v217, v219
    v_fmac_f32 v224, v56, v72
    v_fmac_f32 v225, v57, v72
    v_fmac_f32 v226, v58, v72
    v_fmac_f32 v227, v59, v72
    v_fmac_f32 v240, v60, v72
    v_fmac_f32 v241, v61, v72
    v_fmac_f32 v242, v62, v72
    v_fmac_f32 v243, v63, v72
    s_add_u32 m0, s79, 117760
    s_nop 0
    buffer_load_dwordx4 v21, s[36:39], s78 offen sc1 lds
    v_mul_f32 v80, v224, v224
    v_mul_f32 v81, v225, v225
    v_mul_f32 v82, v226, v226
    v_mul_f32 v83, v227, v227
    v_fma_f32 v80, v80, v74, v73
    v_fma_f32 v81, v81, v74, v73
    v_fma_f32 v82, v82, v74, v73
    v_fma_f32 v83, v83, v74, v73
    s_add_u32 m0, s33, 36864
    s_mov_b32 s76, 4128768
    buffer_load_dwordx4 v23, s[40:43], s76 offen offset:0 lds
    v_mul_f32 v80, v80, v224
    v_mul_f32 v81, v81, v225
    v_mul_f32 v82, v82, v226
    v_mul_f32 v83, v83, v227
    v_exp_f32 v80, v80
    v_mul_f32 v224, v224, v240
    v_exp_f32 v81, v81
    s_add_u32 m0, s33, 38912
    s_nop 0
    buffer_load_dwordx4 v23, s[40:43], s76 offen offset:2048 lds
    s_add_u32 m0, s33, 45056
    s_nop 0
    buffer_load_dwordx4 v23, s[44:47], s76 offen offset:0 lds
    v_mul_f32 v225, v225, v241
    v_exp_f32 v82, v82
    v_mul_f32 v226, v226, v242
    v_exp_f32 v83, v83
    v_mul_f32 v227, v227, v243
    v_fma_f32 v80, v80, v75, v75
    s_add_u32 m0, s33, 49152
    s_mov_b32 s77, 4816896
    buffer_load_dwordx4 v22, s[48:51], s77 offen offset:0 lds
    v_fma_f32 v81, v81, v75, v75
    v_fma_f32 v82, v82, v75, v75
    v_fma_f32 v83, v83, v75, v75
    v_rcp_f32 v80, v80
    v_rcp_f32 v81, v81
    v_rcp_f32 v82, v82
    s_add_u32 m0, s33, 53248
    s_nop 0
    buffer_load_dwordx4 v22, s[52:55], s77 offen offset:0 lds
    v_rcp_f32 v83, v83
    s_nop 0
    v_mul_f32 v224, v224, v80
    v_mul_f32 v225, v225, v81
    v_mul_f32 v226, v226, v82
    v_mul_f32 v227, v227, v83
    v_cvt_pk_bf16_f32 v224, v224, v225
    v_cvt_pk_bf16_f32 v225, v226, v227
    buffer_store_dwordx4 v[216:219], v19, s[68:71], s74 offen offset:0 sc1
    s_add_u32 s75, s75, 0xffa80000
    s_load_dword s94, s[20:21], s75 offset:0x0
    s_load_dword s94, s[20:21], s75 offset:0x40
    s_load_dword s94, s[20:21], s75 offset:0x80
    s_load_dword s94, s[20:21], s75 offset:0xc0
    s_waitcnt vmcnt(17)
    s_barrier
    s_add_u32 m0, s79, 118784
    s_mov_b32 s78, 34176
    buffer_load_dwordx4 v20, s[36:39], s78 offen sc1 lds
    v_fmac_f32 v228, v56, v76
    v_fmac_f32 v229, v57, v76
    v_fmac_f32 v230, v58, v76
    v_fmac_f32 v231, v59, v76
    v_fmac_f32 v244, v60, v76
    v_fmac_f32 v245, v61, v76
    v_fmac_f32 v246, v62, v76
    v_fmac_f32 v247, v63, v76
    s_add_u32 m0, s79, 119808
    s_nop 0
    buffer_load_dwordx4 v21, s[36:39], s78 offen sc1 lds
    v_mul_f32 v80, v228, v228
    v_mul_f32 v81, v229, v229
    v_mul_f32 v82, v230, v230
    v_mul_f32 v83, v231, v231
    v_fma_f32 v80, v80, v78, v77
    v_fma_f32 v81, v81, v78, v77
    v_fma_f32 v82, v82, v78, v77
    v_fma_f32 v83, v83, v78, v77
    s_add_u32 m0, s81, 133120
    s_mov_b32 s78, 1408
    s_mov_b64 exec, 0xffffffff
    buffer_load_dwordx4 v3, s[36:39], s78 offen sc1 lds
    s_mov_b64 exec, -1
    v_mul_f32 v80, v80, v228
    v_mul_f32 v81, v81, v229
    v_mul_f32 v82, v82, v230
    v_mul_f32 v83, v83, v231
    v_exp_f32 v80, v80
    v_mul_f32 v228, v228, v244
    v_exp_f32 v81, v81
    s_add_u32 m0, s33, 57344
    s_mov_b32 s76, 4325376
    buffer_load_dwordx4 v23, s[40:43], s76 offen offset:0 lds
    s_add_u32 m0, s33, 59392
    s_nop 0
    buffer_load_dwordx4 v23, s[40:43], s76 offen offset:2048 lds
    v_mul_f32 v229, v229, v245
    v_exp_f32 v82, v82
    v_mul_f32 v230, v230, v246
    v_exp_f32 v83, v83
    v_mul_f32 v231, v231, v247
    v_fma_f32 v80, v80, v79, v79
    s_add_u32 m0, s33, 65536
    s_nop 0
    buffer_load_dwordx4 v23, s[44:47], s76 offen offset:0 lds
    v_fma_f32 v81, v81, v79, v79
    v_fma_f32 v82, v82, v79, v79
    v_fma_f32 v83, v83, v79, v79
    v_rcp_f32 v80, v80
    v_rcp_f32 v81, v81
    v_rcp_f32 v82, v82
    s_add_u32 m0, s33, 69632
    s_mov_b32 s77, 5046272
    buffer_load_dwordx4 v22, s[48:51], s77 offen offset:0 lds
    v_rcp_f32 v83, v83
    s_nop 0
    v_mul_f32 v228, v228, v80
    v_mul_f32 v229, v229, v81
    v_mul_f32 v230, v230, v82
    v_mul_f32 v231, v231, v83
    v_cvt_pk_bf16_f32 v226, v228, v229
    v_cvt_pk_bf16_f32 v227, v230, v231
    s_add_u32 m0, s33, 73728
    s_nop 0
    buffer_load_dwordx4 v22, s[52:55], s77 offen offset:0 lds
    s_load_dword s94, s[20:21], s75 offset:0x100
    s_load_dword s94, s[20:21], s75 offset:0x140
    s_load_dword s94, s[20:21], s75 offset:0x180
    s_load_dword s94, s[20:21], s75 offset:0x1c0
    s_waitcnt vmcnt(16)
    s_barrier
    s_add_u32 m0, s79, 135168
    s_mov_b32 s78, 1536
    buffer_load_dwordx4 v20, s[36:39], s78 offen sc1 lds
    s_nop 1
    v_permlane16_swap_b32 v224, v226
    v_permlane16_swap_b32 v225, v227
    s_add_u32 m0, s79, 136192
    s_nop 0
    buffer_load_dwordx4 v21, s[36:39], s78 offen sc1 lds
    s_add_u32 m0, s33, 77824
    s_mov_b32 s76, 4521984
    buffer_load_dwordx4 v23, s[40:43], s76 offen offset:0 lds
    s_add_u32 m0, s33, 79872
    s_nop 0
    buffer_load_dwordx4 v23, s[40:43], s76 offen offset:2048 lds
    s_add_u32 m0, s33, 86016
    s_nop 0
    buffer_load_dwordx4 v23, s[44:47], s76 offen offset:0 lds
    s_add_u32 m0, s33, 90112
    s_mov_b32 s77, 5275648
    buffer_load_dwordx4 v22, s[48:51], s77 offen offset:0 lds
    s_add_u32 m0, s33, 94208
    s_nop 0
    buffer_load_dwordx4 v22, s[52:55], s77 offen offset:0 lds
    buffer_store_dwordx4 v[224:227], v19, s[68:71], s74 offen offset:2048 sc1
    s_add_u32 s75, s75, 0x280000
    s_load_dword s94, s[20:21], s75 offset:0x0
    s_load_dword s94, s[20:21], s75 offset:0x40
    s_load_dword s94, s[20:21], s75 offset:0x80
    s_load_dword s94, s[20:21], s75 offset:0xc0
    s_waitcnt vmcnt(17)
    s_barrier
    s_add_u32 m0, s79, 137216
    s_mov_b32 s78, 34304
    buffer_load_dwordx4 v20, s[36:39], s78 offen sc1 lds
    s_add_u32 m0, s79, 138240
    s_nop 0
    buffer_load_dwordx4 v21, s[36:39], s78 offen sc1 lds
    s_add_u32 m0, s81, 151552
    s_mov_b32 s78, 1536
    s_mov_b64 exec, 0xffffffff
    buffer_load_dwordx4 v3, s[36:39], s78 offen sc1 lds
    s_mov_b64 exec, -1
    s_add_u32 m0, s33, 16384
    s_mov_b32 s76, 4718592
    buffer_load_dwordx4 v23, s[40:43], s76 offen offset:0 lds
    s_add_u32 m0, s33, 18432
    s_nop 0
    buffer_load_dwordx4 v23, s[40:43], s76 offen offset:2048 lds
    s_add_u32 m0, s33, 24576
    s_nop 0
    buffer_load_dwordx4 v23, s[44:47], s76 offen offset:0 lds
    s_add_u32 m0, s33, 28672
    s_mov_b32 s77, 5505024
    buffer_load_dwordx4 v22, s[48:51], s77 offen offset:0 lds
    s_add_u32 m0, s33, 32768
    s_nop 0
    buffer_load_dwordx4 v22, s[52:55], s77 offen offset:0 lds
    s_load_dword s94, s[20:21], s75 offset:0x100
    s_load_dword s94, s[20:21], s75 offset:0x140
    s_load_dword s94, s[20:21], s75 offset:0x180
    s_load_dword s94, s[20:21], s75 offset:0x1c0
    s_waitcnt vmcnt(16)
    s_barrier
    s_add_u32 m0, s79, 98304
    s_mov_b32 s78, 1664
    buffer_load_dwordx4 v20, s[36:39], s78 offen sc1 lds
    s_add_u32 m0, s79, 99328
    s_nop 0
    buffer_load_dwordx4 v21, s[36:39], s78 offen sc1 lds
    s_add_u32 m0, s33, 36864
    s_mov_b32 s76, 4915200
    buffer_load_dwordx4 v23, s[40:43], s76 offen offset:0 lds
    s_add_u32 m0, s33, 38912
    s_nop 0
    buffer_load_dwordx4 v23, s[40:43], s76 offen offset:2048 lds
    s_add_u32 m0, s33, 45056
    s_nop 0
    buffer_load_dwordx4 v23, s[44:47], s76 offen offset:0 lds
    s_add_u32 m0, s33, 49152
    s_mov_b32 s77, 5734400
    buffer_load_dwordx4 v22, s[48:51], s77 offen offset:0 lds
    s_add_u32 m0, s33, 53248
    s_nop 0
    buffer_load_dwordx4 v22, s[52:55], s77 offen offset:0 lds
    s_add_u32 s75, s75, 0xffe00000
    s_load_dword s94, s[20:21], s75 offset:0x0
    s_load_dword s94, s[20:21], s75 offset:0x40
    s_load_dword s94, s[20:21], s75 offset:0x80
    s_load_dword s94, s[20:21], s75 offset:0xc0
    s_waitcnt vmcnt(16)
    s_barrier
    s_add_u32 m0, s79, 100352
    s_mov_b32 s78, 34432
    buffer_load_dwordx4 v20, s[36:39], s78 offen sc1 lds
    s_add_u32 m0, s79, 101376
    s_nop 0
    buffer_load_dwordx4 v21, s[36:39], s78 offen sc1 lds
    s_add_u32 m0, s81, 114688
    s_mov_b32 s78, 1664
    s_mov_b64 exec, 0xffffffff
    buffer_load_dwordx4 v3, s[36:39], s78 offen sc1 lds
    s_mov_b64 exec, -1
    s_add_u32 m0, s33, 57344
    s_mov_b32 s76, 5111808
    buffer_load_dwordx4 v23, s[40:43], s76 offen offset:0 lds
    s_add_u32 m0, s33, 59392
    s_nop 0
    buffer_load_dwordx4 v23, s[40:43], s76 offen offset:2048 lds
    s_add_u32 m0, s33, 65536
    s_nop 0
    buffer_load_dwordx4 v23, s[44:47], s76 offen offset:0 lds
    s_add_u32 m0, s33, 69632
    s_mov_b32 s77, 5963776
    buffer_load_dwordx4 v22, s[48:51], s77 offen offset:0 lds
    s_add_u32 m0, s33, 73728
    s_nop 0
    buffer_load_dwordx4 v22, s[52:55], s77 offen offset:0 lds
    s_load_dword s94, s[20:21], s75 offset:0x100
    s_load_dword s94, s[20:21], s75 offset:0x140
    s_load_dword s94, s[20:21], s75 offset:0x180
    s_load_dword s94, s[20:21], s75 offset:0x1c0
    s_waitcnt vmcnt(23)
    s_waitcnt vmcnt(15)
    s_barrier
    s_add_u32 m0, s79, 116736
    s_mov_b32 s78, 1792
    buffer_load_dwordx4 v20, s[36:39], s78 offen sc1 lds
    s_add_u32 m0, s79, 117760
    s_nop 0
    buffer_load_dwordx4 v21, s[36:39], s78 offen sc1 lds
    s_add_u32 m0, s33, 77824
    s_mov_b32 s76, 5308416
    buffer_load_dwordx4 v23, s[40:43], s76 offen offset:0 lds
    s_add_u32 m0, s33, 79872
    s_nop 0
    buffer_load_dwordx4 v23, s[40:43], s76 offen offset:2048 lds
    s_add_u32 m0, s33, 86016
    s_nop 0
    buffer_load_dwordx4 v23, s[44:47], s76 offen offset:0 lds
    s_add_u32 m0, s33, 90112
    s_mov_b32 s77, 6193152
    buffer_load_dwordx4 v22, s[48:51], s77 offen offset:0 lds
    s_add_u32 m0, s33, 94208
    s_nop 0
    buffer_load_dwordx4 v22, s[52:55], s77 offen offset:0 lds
    s_add_u32 s75, s75, 0x280000
    s_load_dword s94, s[20:21], s75 offset:0x0
    s_load_dword s94, s[20:21], s75 offset:0x40
    s_load_dword s94, s[20:21], s75 offset:0x80
    s_load_dword s94, s[20:21], s75 offset:0xc0
    s_cmp_lg_u32 s4, 0
    s_cbranch_scc1 L_fH1
    s_lshl_b32 s91, s28, 4
    s_add_u32 s91, s91, s29
    s_lshl_b32 s91, s91, 7
    s_add_u32 s91, s91, 0x1e88000
    v_mov_b32 v12, s91
    v_mov_b32 v14, s100
    v_mov_b32 v15, s101
    s_mov_b64 exec, 1
    global_store_dwordx2 v12, v[14:15], s[26:27] sc1
    s_mov_b64 exec, -1
L_fH1:
    s_waitcnt vmcnt(15)
    s_barrier
    s_add_u32 m0, s79, 118784
    s_mov_b32 s78, 34560
    buffer_load_dwordx4 v20, s[36:39], s78 offen sc1 lds
    s_add_u32 m0, s79, 119808
    s_nop 0
    buffer_load_dwordx4 v21, s[36:39], s78 offen sc1 lds
    s_add_u32 m0, s81, 133120
    s_mov_b32 s78, 1792
    s_mov_b64 exec, 0xffffffff
    buffer_load_dwordx4 v3, s[36:39], s78 offen sc1 lds
    s_mov_b64 exec, -1
    s_add_u32 m0, s33, 16384
    s_mov_b32 s76, 5505024
    buffer_load_dwordx4 v23, s[40:43], s76 offen offset:0 lds
    s_add_u32 m0, s33, 18432
    s_nop 0
    buffer_load_dwordx4 v23, s[40:43], s76 offen offset:2048 lds
    s_add_u32 m0, s33, 24576
    s_nop 0
    buffer_load_dwordx4 v23, s[44:47], s76 offen offset:0 lds
    s_add_u32 m0, s33, 28672
    s_mov_b32 s77, 6422528
    buffer_load_dwordx4 v22, s[48:51], s77 offen offset:0 lds
    s_add_u32 m0, s33, 32768
    s_nop 0
    buffer_load_dwordx4 v22, s[52:55], s77 offen offset:0 lds
    s_load_dword s94, s[20:21], s75 offset:0x100
    s_load_dword s94, s[20:21], s75 offset:0x140
    s_load_dword s94, s[20:21], s75 offset:0x180
    s_load_dword s94, s[20:21], s75 offset:0x1c0
    s_waitcnt vmcnt(15)
    s_barrier
    s_add_u32 m0, s79, 135168
    s_mov_b32 s78, 1920
    buffer_load_dwordx4 v20, s[36:39], s78 offen sc1 lds
    s_add_u32 m0, s79, 136192
    s_nop 0
    buffer_load_dwordx4 v21, s[36:39], s78 offen sc1 lds
    s_add_u32 m0, s33, 36864
    s_mov_b32 s76, 5701632
    buffer_load_dwordx4 v23, s[40:43], s76 offen offset:0 lds
    s_add_u32 m0, s33, 38912
    s_nop 0
    buffer_load_dwordx4 v23, s[40:43], s76 offen offset:2048 lds
    s_add_u32 m0, s33, 45056
    s_nop 0
    buffer_load_dwordx4 v23, s[44:47], s76 offen offset:0 lds
    s_add_u32 m0, s33, 49152
    s_mov_b32 s77, 6651904
    buffer_load_dwordx4 v22, s[48:51], s77 offen offset:0 lds
    s_add_u32 m0, s33, 53248
    s_nop 0
    buffer_load_dwordx4 v22, s[52:55], s77 offen offset:0 lds
    s_add_u32 s75, s75, 0xffe00000
    s_load_dword s94, s[20:21], s75 offset:0x0
    s_load_dword s94, s[20:21], s75 offset:0x40
    s_load_dword s94, s[20:21], s75 offset:0x80
    s_load_dword s94, s[20:21], s75 offset:0xc0
    v_and_b32 v13, 15, v1
    s_lshl_b32 s91, s30, 11
    s_add_u32 s91, s91, 0x1e88000
    v_lshl_add_u32 v13, v13, 7, s91
    global_load_dwordx2 v[14:15], v13, s[26:27] sc1
    s_waitcnt vmcnt(16)
    s_barrier
    s_add_u32 m0, s79, 137216
    s_mov_b32 s78, 34688
    buffer_load_dwordx4 v20, s[36:39], s78 offen sc1 lds
    s_add_u32 m0, s79, 138240
    s_nop 0
    buffer_load_dwordx4 v21, s[36:39], s78 offen sc1 lds
    s_add_u32 m0, s81, 151552
    s_mov_b32 s78, 1920
    s_mov_b64 exec, 0xffffffff
    buffer_load_dwordx4 v3, s[36:39], s78 offen sc1 lds
    s_mov_b64 exec, -1
    s_add_u32 m0, s33, 57344
    s_mov_b32 s76, 5898240
    buffer_load_dwordx4 v23, s[40:43], s76 offen offset:0 lds
    s_add_u32 m0, s33, 59392
    s_nop 0
    buffer_load_dwordx4 v23, s[40:43], s76 offen offset:2048 lds
    s_add_u32 m0, s33, 65536
    s_nop 0
    buffer_load_dwordx4 v23, s[44:47], s76 offen offset:0 lds
    s_add_u32 m0, s33, 69632
    s_mov_b32 s77, 6881280
    buffer_load_dwordx4 v22, s[48:51], s77 offen offset:0 lds
    s_add_u32 m0, s33, 73728
    s_nop 0
    buffer_load_dwordx4 v22, s[52:55], s77 offen offset:0 lds
    s_load_dword s94, s[20:21], s75 offset:0x100
    s_load_dword s94, s[20:21], s75 offset:0x140
    s_load_dword s94, s[20:21], s75 offset:0x180
    s_load_dword s94, s[20:21], s75 offset:0x1c0
    s_waitcnt vmcnt(16)
    s_barrier
    s_add_u32 m0, s33, 77824
    s_mov_b32 s76, 6094848
    buffer_load_dwordx4 v23, s[40:43], s76 offen offset:0 lds
    s_add_u32 m0, s33, 79872
    s_nop 0
    buffer_load_dwordx4 v23, s[40:43], s76 offen offset:2048 lds
    s_add_u32 m0, s33, 86016
    s_nop 0
    buffer_load_dwordx4 v23, s[44:47], s76 offen offset:0 lds
    s_add_u32 m0, s33, 90112
    s_mov_b32 s77, 7110656
    buffer_load_dwordx4 v22, s[48:51], s77 offen offset:0 lds
    s_add_u32 m0, s33, 94208
    s_nop 0
    buffer_load_dwordx4 v22, s[52:55], s77 offen offset:0 lds
    s_add_u32 s75, s75, 0x280000
    s_load_dword s94, s[20:21], s75 offset:0x0
    s_load_dword s94, s[20:21], s75 offset:0x40
    s_load_dword s94, s[20:21], s75 offset:0x80
    s_load_dword s94, s[20:21], s75 offset:0xc0
    s_waitcnt vmcnt(13)
    s_movk_i32 s98, 0x4000
L_pH1_chk:
    v_cmp_ne_u64 vcc, s[100:101], v[14:15]
    s_nop 1
    s_cmp_eq_u64 vcc, 0
    s_cbranch_scc1 L_pH1_ok
    s_sub_u32 s98, s98, 1
    s_cbranch_scc1 L_pH1_ok
    s_sleep 1
    global_load_dwordx2 v[14:15], v13, s[26:27] sc1
    s_waitcnt vmcnt(0)
    s_branch L_pH1_chk
L_pH1_ok:
    s_waitcnt vmcnt(14)
    s_barrier
    s_lshl_b32 m0, s33, 2
    s_nop 0
    buffer_load_dwordx4 v18, s[56:59], s82 offen offset:0 sc1 lds
    buffer_load_dwordx4 v18, s[56:59], s82 offen offset:1024 sc1 lds
    buffer_load_dwordx4 v18, s[56:59], s82 offen offset:2048 sc1 lds
    buffer_load_dwordx4 v18, s[56:59], s82 offen offset:3072 sc1 lds
    s_add_u32 s82, s82, 16384
    s_lshl1_add_u32 m0, s33, 16384
    s_nop 0
    buffer_load_dwordx4 v254, s[60:63], s83 offen lds
    s_lshl1_add_u32 m0, s33, 17408
    s_nop 0
    buffer_load_dwordx4 v255, s[60:63], s83 offen lds
    s_lshl1_add_u32 m0, s33, 24576
    s_nop 0
    buffer_load_dwordx4 v254, s[64:67], s83 offen lds
    s_lshl1_add_u32 m0, s33, 25600
    s_nop 0
    buffer_load_dwordx4 v255, s[64:67], s83 offen lds
    s_add_u32 s83, s83, 131072
    s_load_dword s94, s[20:21], s75 offset:0x100
    s_load_dword s94, s[20:21], s75 offset:0x140
    s_load_dword s94, s[20:21], s75 offset:0x180
    s_load_dword s94, s[20:21], s75 offset:0x1c0
    s_lshl_b32 s85, s31, 8
    s_lshl_b32 s86, s32, 7
    s_add_u32 s86, s85, s86
    s_xor_b32 s87, s86, 128
    s_add_u32 s44, s12, s86
    s_addc_u32 s45, s13, 0
    s_sub_u32 s46, 2097152, s86
    s_mov_b32 s47, 0x20000
    s_add_u32 s40, s26, 0x1200000
    s_addc_u32 s41, s27, 0
    s_mov_b32 s42, 0x400000
    s_mov_b32 s43, 0x20000
    s_lshl_b32 s76, s30, 18
    s_mov_b32 s77, 393216
    s_add_u32 s76, s76, 49152
    s_lshl_b32 s84, s2, 15
    s_lshl_b32 s85, s4, 13
    s_add_u32 s84, s84, s85
    s_add_u32 s36, s84, 0x1600000
    s_add_u32 s37, s36, 4096
    s_xor_b32 s38, s36, 32768
    s_xor_b32 s39, s37, 32768
    v_lshlrev_b32 v4, 4, v1
    s_lshl_b32 s84, s4, 12
    s_add_u32 s84, s84, 131072
    v_lshl_add_u32 v5, v1, 3, s84
    s_waitcnt vmcnt(13)
    s_barrier
    s_lshl2_add_u32 m0, s33, 98304
    s_nop 0
    buffer_load_dwordx4 v18, s[56:59], s82 offen offset:0 sc1 lds
    buffer_load_dwordx4 v18, s[56:59], s82 offen offset:1024 sc1 lds
    buffer_load_dwordx4 v18, s[56:59], s82 offen offset:2048 sc1 lds
    buffer_load_dwordx4 v18, s[56:59], s82 offen offset:3072 sc1 lds
    s_add_u32 s82, s82, 16384
    s_lshl1_add_u32 m0, s33, 114688
    s_nop 0
    buffer_load_dwordx4 v254, s[60:63], s83 offen lds
    s_lshl1_add_u32 m0, s33, 115712
    s_nop 0
    buffer_load_dwordx4 v255, s[60:63], s83 offen lds
    s_lshl1_add_u32 m0, s33, 122880
    s_nop 0
    buffer_load_dwordx4 v254, s[64:67], s83 offen lds
    s_lshl1_add_u32 m0, s33, 123904
    s_nop 0
    buffer_load_dwordx4 v255, s[64:67], s83 offen lds
    s_add_u32 s83, s83, 131072
    s_add_u32 s75, s75, 0xffe00000
    s_load_dword s94, s[20:21], s75 offset:0x0
    s_load_dword s94, s[20:21], s75 offset:0x40
    s_load_dword s94, s[20:21], s75 offset:0x80
    s_load_dword s94, s[20:21], s75 offset:0xc0
    s_waitcnt vmcnt(16)
    s_barrier
    s_lshl2_add_u32 m0, s33, 32768
    s_nop 0
    buffer_load_dwordx4 v18, s[56:59], s82 offen offset:0 sc1 lds
    buffer_load_dwordx4 v18, s[56:59], s82 offen offset:1024 sc1 lds
    buffer_load_dwordx4 v18, s[56:59], s82 offen offset:2048 sc1 lds
    buffer_load_dwordx4 v18, s[56:59], s82 offen offset:3072 sc1 lds
    s_add_u32 s82, s82, 16384
    s_lshl1_add_u32 m0, s33, 49152
    s_nop 0
    buffer_load_dwordx4 v254, s[60:63], s83 offen lds
    s_lshl1_add_u32 m0, s33, 50176
    s_nop 0
    buffer_load_dwordx4 v255, s[60:63], s83 offen lds
    s_lshl1_add_u32 m0, s33, 57344
    s_nop 0
    buffer_load_dwordx4 v254, s[64:67], s83 offen lds
    s_lshl1_add_u32 m0, s33, 58368
    s_nop 0
    buffer_load_dwordx4 v255, s[64:67], s83 offen lds
    s_add_u32 s83, s83, 131072
    s_waitcnt vmcnt(16)
    s_barrier
    s_setprio 1
    ds_read_b64_tr_b16 v[40:41], v250 offset:16384
    ds_read_b64_tr_b16 v[42:43], v250 offset:16896
    ds_read_b128 v[24:27], v248 offset:0
    ds_read_b128 v[28:31], v248 offset:1024
    ds_read_b128 v[32:35], v248 offset:2048
    ds_read_b128 v[36:39], v248 offset:3072
    ds_read_b64_tr_b16 v[44:45], v251 offset:16384
    ds_read_b64_tr_b16 v[46:47], v251 offset:16896
    ds_read_b64_tr_b16 v[48:49], v250 offset:24576
    ds_read_b64_tr_b16 v[50:51], v250 offset:25088
    ds_read_b64_tr_b16 v[52:53], v251 offset:24576
    ds_read_b64_tr_b16 v[54:55], v251 offset:25088
    s_lshl2_add_u32 m0, s33, 65536
    s_nop 0
    buffer_load_dwordx4 v18, s[56:59], s82 offen offset:0 sc1 lds
    buffer_load_dwordx4 v18, s[56:59], s82 offen offset:1024 sc1 lds
    buffer_load_dwordx4 v18, s[56:59], s82 offen offset:2048 sc1 lds
    buffer_load_dwordx4 v18, s[56:59], s82 offen offset:3072 sc1 lds
    s_add_u32 s82, s82, 16384
    s_waitcnt lgkmcnt(9)
    v_mfma_f32_16x16x32_bf16 v[88:91], v[40:43], v[24:27], 0
    ds_read_b64_tr_b16 v[72:73], v250 offset:20480
    ds_read_b64_tr_b16 v[74:75], v250 offset:20992
    s_waitcnt lgkmcnt(10)
    v_mfma_f32_16x16x32_bf16 v[92:95], v[40:43], v[28:31], 0
    ds_read_b128 v[56:59], v248 offset:8192
    s_lshl1_add_u32 m0, s33, 81920
    s_waitcnt lgkmcnt(10)
    v_mfma_f32_16x16x32_bf16 v[96:99], v[40:43], v[32:35], 0
    ds_read_b128 v[60:63], v248 offset:9216
    ds_read_b128 v[64:67], v248 offset:10240
    s_waitcnt lgkmcnt(11)
    v_mfma_f32_16x16x32_bf16 v[100:103], v[40:43], v[36:39], 0
    ds_read_b128 v[68:71], v248 offset:11264
    buffer_load_dwordx4 v254, s[60:63], s83 offen lds
    s_waitcnt lgkmcnt(10)
    v_mfma_f32_16x16x32_bf16 v[104:107], v[44:47], v[24:27], 0
    ds_read_b64_tr_b16 v[76:77], v251 offset:20480
    ds_read_b64_tr_b16 v[78:79], v251 offset:20992
    v_mfma_f32_16x16x32_bf16 v[108:111], v[44:47], v[28:31], 0
    ds_read_b64_tr_b16 v[80:81], v250 offset:28672
    s_lshl1_add_u32 m0, s33, 82944
    v_mfma_f32_16x16x32_bf16 v[112:115], v[44:47], v[32:35], 0
    ds_read_b64_tr_b16 v[82:83], v250 offset:29184
    ds_read_b64_tr_b16 v[84:85], v251 offset:28672
    v_mfma_f32_16x16x32_bf16 v[116:119], v[44:47], v[36:39], 0
    ds_read_b64_tr_b16 v[86:87], v251 offset:29184
    buffer_load_dwordx4 v255, s[60:63], s83 offen lds
    s_waitcnt lgkmcnt(14)
    v_mfma_f32_16x16x32_bf16 v[120:123], v[48:51], v[24:27], 0
    v_mfma_f32_16x16x32_bf16 v[124:127], v[48:51], v[28:31], 0
    s_lshl1_add_u32 m0, s33, 90112
    v_mfma_f32_16x16x32_bf16 v[128:131], v[48:51], v[32:35], 0
    v_mfma_f32_16x16x32_bf16 v[132:135], v[48:51], v[36:39], 0
    buffer_load_dwordx4 v254, s[64:67], s83 offen lds
    s_waitcnt lgkmcnt(12)
    v_mfma_f32_16x16x32_bf16 v[136:139], v[52:55], v[24:27], 0
    v_mfma_f32_16x16x32_bf16 v[140:143], v[52:55], v[28:31], 0
    s_lshl1_add_u32 m0, s33, 91136
    v_mfma_f32_16x16x32_bf16 v[144:147], v[52:55], v[32:35], 0
    v_mfma_f32_16x16x32_bf16 v[148:151], v[52:55], v[36:39], 0
    buffer_load_dwordx4 v255, s[64:67], s83 offen lds
    s_add_u32 s83, s83, 131072
    s_waitcnt vmcnt(16) lgkmcnt(0)
    s_barrier
    v_mfma_f32_16x16x32_bf16 v[88:91], v[72:75], v[56:59], v[88:91]
    ds_read_b64_tr_b16 v[40:41], v252 offset:49152
    ds_read_b64_tr_b16 v[42:43], v252 offset:49664
    v_mfma_f32_16x16x32_bf16 v[92:95], v[72:75], v[60:63], v[92:95]
    ds_read_b128 v[24:27], v249 offset:32768
    s_lshl_b32 m0, s33, 2
    v_mfma_f32_16x16x32_bf16 v[96:99], v[72:75], v[64:67], v[96:99]
    ds_read_b128 v[28:31], v249 offset:33792
    v_mfma_f32_16x16x32_bf16 v[100:103], v[72:75], v[68:71], v[100:103]
    ds_read_b128 v[32:35], v249 offset:34816
    buffer_load_dwordx4 v18, s[56:59], s82 offen offset:0 sc1 lds
    v_mfma_f32_16x16x32_bf16 v[104:107], v[76:79], v[56:59], v[104:107]
    ds_read_b128 v[36:39], v249 offset:35840
    v_mfma_f32_16x16x32_bf16 v[108:111], v[76:79], v[60:63], v[108:111]
    ds_read_b64_tr_b16 v[44:45], v253 offset:49152
    ds_read_b64_tr_b16 v[46:47], v253 offset:49664
    v_mfma_f32_16x16x32_bf16 v[112:115], v[76:79], v[64:67], v[112:115]
    ds_read_b64_tr_b16 v[48:49], v252 offset:57344
    v_mfma_f32_16x16x32_bf16 v[116:119], v[76:79], v[68:71], v[116:119]
    ds_read_b64_tr_b16 v[50:51], v252 offset:57856
    buffer_load_dwordx4 v18, s[56:59], s82 offen offset:1024 sc1 lds
    v_mfma_f32_16x16x32_bf16 v[120:123], v[80:83], v[56:59], v[120:123]
    ds_read_b64_tr_b16 v[52:53], v253 offset:57344
    v_mfma_f32_16x16x32_bf16 v[124:127], v[80:83], v[60:63], v[124:127]
    ds_read_b64_tr_b16 v[54:55], v253 offset:57856
    v_mfma_f32_16x16x32_bf16 v[128:131], v[80:83], v[64:67], v[128:131]
    v_mfma_f32_16x16x32_bf16 v[132:135], v[80:83], v[68:71], v[132:135]
    buffer_load_dwordx4 v18, s[56:59], s82 offen offset:2048 sc1 lds
    v_mfma_f32_16x16x32_bf16 v[136:139], v[84:87], v[56:59], v[136:139]
    v_mfma_f32_16x16x32_bf16 v[140:143], v[84:87], v[60:63], v[140:143]
    v_mfma_f32_16x16x32_bf16 v[144:147], v[84:87], v[64:67], v[144:147]
    v_mfma_f32_16x16x32_bf16 v[148:151], v[84:87], v[68:71], v[148:151]
    buffer_load_dwordx4 v18, s[56:59], s82 offen offset:3072 sc1 lds
    s_add_u32 s82, s82, 16384
    s_waitcnt lgkmcnt(9)
    v_mfma_f32_16x16x32_bf16 v[88:91], v[40:43], v[24:27], v[88:91]
    ds_read_b64_tr_b16 v[72:73], v252 offset:53248
    ds_read_b64_tr_b16 v[74:75], v252 offset:53760
    s_waitcnt lgkmcnt(10)
    v_mfma_f32_16x16x32_bf16 v[92:95], v[40:43], v[28:31], v[92:95]
    ds_read_b128 v[56:59], v249 offset:40960
    s_lshl1_add_u32 m0, s33, 16384
    s_waitcnt lgkmcnt(10)
    v_mfma_f32_16x16x32_bf16 v[96:99], v[40:43], v[32:35], v[96:99]
    ds_read_b128 v[60:63], v249 offset:41984
    ds_read_b128 v[64:67], v249 offset:43008
    s_waitcnt lgkmcnt(11)
    v_mfma_f32_16x16x32_bf16 v[100:103], v[40:43], v[36:39], v[100:103]
    ds_read_b128 v[68:71], v249 offset:44032
    buffer_load_dwordx4 v254, s[60:63], s83 offen lds
    s_waitcnt lgkmcnt(10)
    v_mfma_f32_16x16x32_bf16 v[104:107], v[44:47], v[24:27], v[104:107]
    ds_read_b64_tr_b16 v[76:77], v253 offset:53248
    ds_read_b64_tr_b16 v[78:79], v253 offset:53760
    v_mfma_f32_16x16x32_bf16 v[108:111], v[44:47], v[28:31], v[108:111]
    ds_read_b64_tr_b16 v[80:81], v252 offset:61440
    s_lshl1_add_u32 m0, s33, 17408
    v_mfma_f32_16x16x32_bf16 v[112:115], v[44:47], v[32:35], v[112:115]
    ds_read_b64_tr_b16 v[82:83], v252 offset:61952
    ds_read_b64_tr_b16 v[84:85], v253 offset:61440
    v_mfma_f32_16x16x32_bf16 v[116:119], v[44:47], v[36:39], v[116:119]
    ds_read_b64_tr_b16 v[86:87], v253 offset:61952
    buffer_load_dwordx4 v255, s[60:63], s83 offen lds
    s_waitcnt lgkmcnt(14)
    v_mfma_f32_16x16x32_bf16 v[120:123], v[48:51], v[24:27], v[120:123]
    v_mfma_f32_16x16x32_bf16 v[124:127], v[48:51], v[28:31], v[124:127]
    s_lshl1_add_u32 m0, s33, 24576
    v_mfma_f32_16x16x32_bf16 v[128:131], v[48:51], v[32:35], v[128:131]
    v_mfma_f32_16x16x32_bf16 v[132:135], v[48:51], v[36:39], v[132:135]
    buffer_load_dwordx4 v254, s[64:67], s83 offen lds
    s_waitcnt lgkmcnt(12)
    v_mfma_f32_16x16x32_bf16 v[136:139], v[52:55], v[24:27], v[136:139]
    v_mfma_f32_16x16x32_bf16 v[140:143], v[52:55], v[28:31], v[140:143]
    s_lshl1_add_u32 m0, s33, 25600
    v_mfma_f32_16x16x32_bf16 v[144:147], v[52:55], v[32:35], v[144:147]
    v_mfma_f32_16x16x32_bf16 v[148:151], v[52:55], v[36:39], v[148:151]
    buffer_load_dwordx4 v255, s[64:67], s83 offen lds
    s_add_u32 s83, s83, 131072
    s_waitcnt vmcnt(16) lgkmcnt(0)
    s_barrier
    v_mfma_f32_16x16x32_bf16 v[88:91], v[72:75], v[56:59], v[88:91]
    ds_read_b64_tr_b16 v[40:41], v250 offset:49152
    ds_read_b64_tr_b16 v[42:43], v250 offset:49664
    v_mfma_f32_16x16x32_bf16 v[92:95], v[72:75], v[60:63], v[92:95]
    ds_read_b128 v[24:27], v248 offset:32768
    s_lshl2_add_u32 m0, s33, 98304
    v_mfma_f32_16x16x32_bf16 v[96:99], v[72:75], v[64:67], v[96:99]
    ds_read_b128 v[28:31], v248 offset:33792
    v_mfma_f32_16x16x32_bf16 v[100:103], v[72:75], v[68:71], v[100:103]
    ds_read_b128 v[32:35], v248 offset:34816
    buffer_load_dwordx4 v18, s[56:59], s82 offen offset:0 sc1 lds
    v_mfma_f32_16x16x32_bf16 v[104:107], v[76:79], v[56:59], v[104:107]
    ds_read_b128 v[36:39], v248 offset:35840
    v_mfma_f32_16x16x32_bf16 v[108:111], v[76:79], v[60:63], v[108:111]
    ds_read_b64_tr_b16 v[44:45], v251 offset:49152
    ds_read_b64_tr_b16 v[46:47], v251 offset:49664
    v_mfma_f32_16x16x32_bf16 v[112:115], v[76:79], v[64:67], v[112:115]
    ds_read_b64_tr_b16 v[48:49], v250 offset:57344
    v_mfma_f32_16x16x32_bf16 v[116:119], v[76:79], v[68:71], v[116:119]
    ds_read_b64_tr_b16 v[50:51], v250 offset:57856
    buffer_load_dwordx4 v18, s[56:59], s82 offen offset:1024 sc1 lds
    v_mfma_f32_16x16x32_bf16 v[120:123], v[80:83], v[56:59], v[120:123]
    ds_read_b64_tr_b16 v[52:53], v251 offset:57344
    v_mfma_f32_16x16x32_bf16 v[124:127], v[80:83], v[60:63], v[124:127]
    ds_read_b64_tr_b16 v[54:55], v251 offset:57856
    v_mfma_f32_16x16x32_bf16 v[128:131], v[80:83], v[64:67], v[128:131]
    v_mfma_f32_16x16x32_bf16 v[132:135], v[80:83], v[68:71], v[132:135]
    buffer_load_dwordx4 v18, s[56:59], s82 offen offset:2048 sc1 lds
    v_mfma_f32_16x16x32_bf16 v[136:139], v[84:87], v[56:59], v[136:139]
    v_mfma_f32_16x16x32_bf16 v[140:143], v[84:87], v[60:63], v[140:143]
    v_mfma_f32_16x16x32_bf16 v[144:147], v[84:87], v[64:67], v[144:147]
    v_mfma_f32_16x16x32_bf16 v[148:151], v[84:87], v[68:71], v[148:151]
    buffer_load_dwordx4 v18, s[56:59], s82 offen offset:3072 sc1 lds
    s_add_u32 s82, s82, 16384
    s_waitcnt lgkmcnt(9)
    v_mfma_f32_16x16x32_bf16 v[88:91], v[40:43], v[24:27], v[88:91]
    ds_read_b64_tr_b16 v[72:73], v250 offset:53248
    ds_read_b64_tr_b16 v[74:75], v250 offset:53760
    s_waitcnt lgkmcnt(10)
    v_mfma_f32_16x16x32_bf16 v[92:95], v[40:43], v[28:31], v[92:95]
    ds_read_b128 v[56:59], v248 offset:40960
    s_lshl1_add_u32 m0, s33, 114688
    s_waitcnt lgkmcnt(10)
    v_mfma_f32_16x16x32_bf16 v[96:99], v[40:43], v[32:35], v[96:99]
    ds_read_b128 v[60:63], v248 offset:41984
    ds_read_b128 v[64:67], v248 offset:43008
    s_waitcnt lgkmcnt(11)
    v_mfma_f32_16x16x32_bf16 v[100:103], v[40:43], v[36:39], v[100:103]
    ds_read_b128 v[68:71], v248 offset:44032
    buffer_load_dwordx4 v254, s[60:63], s83 offen lds
    s_waitcnt lgkmcnt(10)
    v_mfma_f32_16x16x32_bf16 v[104:107], v[44:47], v[24:27], v[104:107]
    ds_read_b64_tr_b16 v[76:77], v251 offset:53248
    ds_read_b64_tr_b16 v[78:79], v251 offset:53760
    v_mfma_f32_16x16x32_bf16 v[108:111], v[44:47], v[28:31], v[108:111]
    ds_read_b64_tr_b16 v[80:81], v250 offset:61440
    s_lshl1_add_u32 m0, s33, 115712
    v_mfma_f32_16x16x32_bf16 v[112:115], v[44:47], v[32:35], v[112:115]
    ds_read_b64_tr_b16 v[82:83], v250 offset:61952
    ds_read_b64_tr_b16 v[84:85], v251 offset:61440
    v_mfma_f32_16x16x32_bf16 v[116:119], v[44:47], v[36:39], v[116:119]
    ds_read_b64_tr_b16 v[86:87], v251 offset:61952
    buffer_load_dwordx4 v255, s[60:63], s83 offen lds
    s_waitcnt lgkmcnt(14)
    v_mfma_f32_16x16x32_bf16 v[120:123], v[48:51], v[24:27], v[120:123]
    v_mfma_f32_16x16x32_bf16 v[124:127], v[48:51], v[28:31], v[124:127]
    s_lshl1_add_u32 m0, s33, 122880
    v_mfma_f32_16x16x32_bf16 v[128:131], v[48:51], v[32:35], v[128:131]
    v_mfma_f32_16x16x32_bf16 v[132:135], v[48:51], v[36:39], v[132:135]
    buffer_load_dwordx4 v254, s[64:67], s83 offen lds
    s_waitcnt lgkmcnt(12)
    v_mfma_f32_16x16x32_bf16 v[136:139], v[52:55], v[24:27], v[136:139]
    v_mfma_f32_16x16x32_bf16 v[140:143], v[52:55], v[28:31], v[140:143]
    s_lshl1_add_u32 m0, s33, 123904
    v_mfma_f32_16x16x32_bf16 v[144:147], v[52:55], v[32:35], v[144:147]
    v_mfma_f32_16x16x32_bf16 v[148:151], v[52:55], v[36:39], v[148:151]
    buffer_load_dwordx4 v255, s[64:67], s83 offen lds
    s_add_u32 s83, s83, 131072
    s_waitcnt vmcnt(16) lgkmcnt(0)
    s_barrier
    v_mfma_f32_16x16x32_bf16 v[88:91], v[72:75], v[56:59], v[88:91]
    ds_read_b64_tr_b16 v[40:41], v252 offset:16384
    ds_read_b64_tr_b16 v[42:43], v252 offset:16896
    v_mfma_f32_16x16x32_bf16 v[92:95], v[72:75], v[60:63], v[92:95]
    ds_read_b128 v[24:27], v249 offset:0
    s_lshl2_add_u32 m0, s33, 32768
    v_mfma_f32_16x16x32_bf16 v[96:99], v[72:75], v[64:67], v[96:99]
    ds_read_b128 v[28:31], v249 offset:1024
    v_mfma_f32_16x16x32_bf16 v[100:103], v[72:75], v[68:71], v[100:103]
    ds_read_b128 v[32:35], v249 offset:2048
    buffer_load_dwordx4 v18, s[56:59], s82 offen offset:0 sc1 lds
    v_mfma_f32_16x16x32_bf16 v[104:107], v[76:79], v[56:59], v[104:107]
    ds_read_b128 v[36:39], v249 offset:3072
    v_mfma_f32_16x16x32_bf16 v[108:111], v[76:79], v[60:63], v[108:111]
    ds_read_b64_tr_b16 v[44:45], v253 offset:16384
    ds_read_b64_tr_b16 v[46:47], v253 offset:16896
    v_mfma_f32_16x16x32_bf16 v[112:115], v[76:79], v[64:67], v[112:115]
    ds_read_b64_tr_b16 v[48:49], v252 offset:24576
    v_mfma_f32_16x16x32_bf16 v[116:119], v[76:79], v[68:71], v[116:119]
    ds_read_b64_tr_b16 v[50:51], v252 offset:25088
    buffer_load_dwordx4 v18, s[56:59], s82 offen offset:1024 sc1 lds
    v_mfma_f32_16x16x32_bf16 v[120:123], v[80:83], v[56:59], v[120:123]
    ds_read_b64_tr_b16 v[52:53], v253 offset:24576
    v_mfma_f32_16x16x32_bf16 v[124:127], v[80:83], v[60:63], v[124:127]
    ds_read_b64_tr_b16 v[54:55], v253 offset:25088
    v_mfma_f32_16x16x32_bf16 v[128:131], v[80:83], v[64:67], v[128:131]
    v_mfma_f32_16x16x32_bf16 v[132:135], v[80:83], v[68:71], v[132:135]
    buffer_load_dwordx4 v18, s[56:59], s82 offen offset:2048 sc1 lds
    v_mfma_f32_16x16x32_bf16 v[136:139], v[84:87], v[56:59], v[136:139]
    v_mfma_f32_16x16x32_bf16 v[140:143], v[84:87], v[60:63], v[140:143]
    v_mfma_f32_16x16x32_bf16 v[144:147], v[84:87], v[64:67], v[144:147]
    v_mfma_f32_16x16x32_bf16 v[148:151], v[84:87], v[68:71], v[148:151]
    buffer_load_dwordx4 v18, s[56:59], s82 offen offset:3072 sc1 lds
    s_add_u32 s82, s82, 16384
    s_waitcnt lgkmcnt(9)
    v_mfma_f32_16x16x32_bf16 v[88:91], v[40:43], v[24:27], v[88:91]
    ds_read_b64_tr_b16 v[72:73], v252 offset:20480
    ds_read_b64_tr_b16 v[74:75], v252 offset:20992
    s_waitcnt lgkmcnt(10)
    v_mfma_f32_16x16x32_bf16 v[92:95], v[40:43], v[28:31], v[92:95]
    ds_read_b128 v[56:59], v249 offset:8192
    s_lshl1_add_u32 m0, s33, 49152
    s_waitcnt lgkmcnt(10)
    v_mfma_f32_16x16x32_bf16 v[96:99], v[40:43], v[32:35], v[96:99]
    ds_read_b128 v[60:63], v249 offset:9216
    ds_read_b128 v[64:67], v249 offset:10240
    s_waitcnt lgkmcnt(11)
    v_mfma_f32_16x16x32_bf16 v[100:103], v[40:43], v[36:39], v[100:103]
    ds_read_b128 v[68:71], v249 offset:11264
    buffer_load_dwordx4 v254, s[60:63], s83 offen lds
    s_waitcnt lgkmcnt(10)
    v_mfma_f32_16x16x32_bf16 v[104:107], v[44:47], v[24:27], v[104:107]
    ds_read_b64_tr_b16 v[76:77], v253 offset:20480
    ds_read_b64_tr_b16 v[78:79], v253 offset:20992
    v_mfma_f32_16x16x32_bf16 v[108:111], v[44:47], v[28:31], v[108:111]
    ds_read_b64_tr_b16 v[80:81], v252 offset:28672
    s_lshl1_add_u32 m0, s33, 50176
    v_mfma_f32_16x16x32_bf16 v[112:115], v[44:47], v[32:35], v[112:115]
    ds_read_b64_tr_b16 v[82:83], v252 offset:29184
    ds_read_b64_tr_b16 v[84:85], v253 offset:28672
    v_mfma_f32_16x16x32_bf16 v[116:119], v[44:47], v[36:39], v[116:119]
    ds_read_b64_tr_b16 v[86:87], v253 offset:29184
    buffer_load_dwordx4 v255, s[60:63], s83 offen lds
    s_waitcnt lgkmcnt(14)
    v_mfma_f32_16x16x32_bf16 v[120:123], v[48:51], v[24:27], v[120:123]
    v_mfma_f32_16x16x32_bf16 v[124:127], v[48:51], v[28:31], v[124:127]
    s_lshl1_add_u32 m0, s33, 57344
    v_mfma_f32_16x16x32_bf16 v[128:131], v[48:51], v[32:35], v[128:131]
    v_mfma_f32_16x16x32_bf16 v[132:135], v[48:51], v[36:39], v[132:135]
    buffer_load_dwordx4 v254, s[64:67], s83 offen lds
    s_waitcnt lgkmcnt(12)
    v_mfma_f32_16x16x32_bf16 v[136:139], v[52:55], v[24:27], v[136:139]
    v_mfma_f32_16x16x32_bf16 v[140:143], v[52:55], v[28:31], v[140:143]
    s_lshl1_add_u32 m0, s33, 58368
    v_mfma_f32_16x16x32_bf16 v[144:147], v[52:55], v[32:35], v[144:147]
    v_mfma_f32_16x16x32_bf16 v[148:151], v[52:55], v[36:39], v[148:151]
    buffer_load_dwordx4 v255, s[64:67], s83 offen lds
    s_add_u32 s83, s83, 131072
    s_waitcnt vmcnt(16) lgkmcnt(0)
    s_barrier
    v_mfma_f32_16x16x32_bf16 v[88:91], v[72:75], v[56:59], v[88:91]
    ds_read_b64_tr_b16 v[40:41], v250 offset:16384
    ds_read_b64_tr_b16 v[42:43], v250 offset:16896
    v_mfma_f32_16x16x32_bf16 v[92:95], v[72:75], v[60:63], v[92:95]
    ds_read_b128 v[24:27], v248 offset:0
    s_lshl2_add_u32 m0, s33, 65536
    v_mfma_f32_16x16x32_bf16 v[96:99], v[72:75], v[64:67], v[96:99]
    ds_read_b128 v[28:31], v248 offset:1024
    v_mfma_f32_16x16x32_bf16 v[100:103], v[72:75], v[68:71], v[100:103]
    ds_read_b128 v[32:35], v248 offset:2048
    buffer_load_dwordx4 v18, s[56:59], s82 offen offset:0 sc1 lds
    v_mfma_f32_16x16x32_bf16 v[104:107], v[76:79], v[56:59], v[104:107]
    ds_read_b128 v[36:39], v248 offset:3072
    v_mfma_f32_16x16x32_bf16 v[108:111], v[76:79], v[60:63], v[108:111]
    ds_read_b64_tr_b16 v[44:45], v251 offset:16384
    ds_read_b64_tr_b16 v[46:47], v251 offset:16896
    v_mfma_f32_16x16x32_bf16 v[112:115], v[76:79], v[64:67], v[112:115]
    ds_read_b64_tr_b16 v[48:49], v250 offset:24576
    v_mfma_f32_16x16x32_bf16 v[116:119], v[76:79], v[68:71], v[116:119]
    ds_read_b64_tr_b16 v[50:51], v250 offset:25088
    buffer_load_dwordx4 v18, s[56:59], s82 offen offset:1024 sc1 lds
    v_mfma_f32_16x16x32_bf16 v[120:123], v[80:83], v[56:59], v[120:123]
    ds_read_b64_tr_b16 v[52:53], v251 offset:24576
    v_mfma_f32_16x16x32_bf16 v[124:127], v[80:83], v[60:63], v[124:127]
    ds_read_b64_tr_b16 v[54:55], v251 offset:25088
    v_mfma_f32_16x16x32_bf16 v[128:131], v[80:83], v[64:67], v[128:131]
    v_mfma_f32_16x16x32_bf16 v[132:135], v[80:83], v[68:71], v[132:135]
    buffer_load_dwordx4 v18, s[56:59], s82 offen offset:2048 sc1 lds
    v_mfma_f32_16x16x32_bf16 v[136:139], v[84:87], v[56:59], v[136:139]
    v_mfma_f32_16x16x32_bf16 v[140:143], v[84:87], v[60:63], v[140:143]
    v_mfma_f32_16x16x32_bf16 v[144:147], v[84:87], v[64:67], v[144:147]
    v_mfma_f32_16x16x32_bf16 v[148:151], v[84:87], v[68:71], v[148:151]
    buffer_load_dwordx4 v18, s[56:59], s82 offen offset:3072 sc1 lds
    s_add_u32 s82, s82, 16384
    s_mov_b32 s34, 2
.p2align 6
L_da:
    s_waitcnt lgkmcnt(9)
    v_mfma_f32_16x16x32_bf16 v[88:91], v[40:43], v[24:27], v[88:91]
    ds_read_b64_tr_b16 v[72:73], v250 offset:20480
    ds_read_b64_tr_b16 v[74:75], v250 offset:20992
    s_waitcnt lgkmcnt(10)
    v_mfma_f32_16x16x32_bf16 v[92:95], v[40:43], v[28:31], v[92:95]
    ds_read_b128 v[56:59], v248 offset:8192
    s_lshl1_add_u32 m0, s33, 81920
    s_waitcnt lgkmcnt(10)
    v_mfma_f32_16x16x32_bf16 v[96:99], v[40:43], v[32:35], v[96:99]
    ds_read_b128 v[60:63], v248 offset:9216
    ds_read_b128 v[64:67], v248 offset:10240
    s_waitcnt lgkmcnt(11)
    v_mfma_f32_16x16x32_bf16 v[100:103], v[40:43], v[36:39], v[100:103]
    ds_read_b128 v[68:71], v248 offset:11264
    buffer_load_dwordx4 v254, s[60:63], s83 offen lds
    s_waitcnt lgkmcnt(10)
    v_mfma_f32_16x16x32_bf16 v[104:107], v[44:47], v[24:27], v[104:107]
    ds_read_b64_tr_b16 v[76:77], v251 offset:20480
    ds_read_b64_tr_b16 v[78:79], v251 offset:20992
    v_mfma_f32_16x16x32_bf16 v[108:111], v[44:47], v[28:31], v[108:111]
    ds_read_b64_tr_b16 v[80:81], v250 offset:28672
    s_lshl1_add_u32 m0, s33, 82944
    v_mfma_f32_16x16x32_bf16 v[112:115], v[44:47], v[32:35], v[112:115]
    ds_read_b64_tr_b16 v[82:83], v250 offset:29184
    ds_read_b64_tr_b16 v[84:85], v251 offset:28672
    v_mfma_f32_16x16x32_bf16 v[116:119], v[44:47], v[36:39], v[116:119]
    ds_read_b64_tr_b16 v[86:87], v251 offset:29184
    buffer_load_dwordx4 v255, s[60:63], s83 offen lds
    s_waitcnt lgkmcnt(14)
    v_mfma_f32_16x16x32_bf16 v[120:123], v[48:51], v[24:27], v[120:123]
    v_mfma_f32_16x16x32_bf16 v[124:127], v[48:51], v[28:31], v[124:127]
    s_lshl1_add_u32 m0, s33, 90112
    v_mfma_f32_16x16x32_bf16 v[128:131], v[48:51], v[32:35], v[128:131]
    v_mfma_f32_16x16x32_bf16 v[132:135], v[48:51], v[36:39], v[132:135]
    buffer_load_dwordx4 v254, s[64:67], s83 offen lds
    s_waitcnt lgkmcnt(12)
    v_mfma_f32_16x16x32_bf16 v[136:139], v[52:55], v[24:27], v[136:139]
    v_mfma_f32_16x16x32_bf16 v[140:143], v[52:55], v[28:31], v[140:143]
    s_lshl1_add_u32 m0, s33, 91136
    v_mfma_f32_16x16x32_bf16 v[144:147], v[52:55], v[32:35], v[144:147]
    v_mfma_f32_16x16x32_bf16 v[148:151], v[52:55], v[36:39], v[148:151]
    buffer_load_dwordx4 v255, s[64:67], s83 offen lds
    s_add_u32 s83, s83, 131072
    s_waitcnt vmcnt(16) lgkmcnt(0)
    s_barrier
    v_mfma_f32_16x16x32_bf16 v[88:91], v[72:75], v[56:59], v[88:91]
    ds_read_b64_tr_b16 v[40:41], v252 offset:49152
    ds_read_b64_tr_b16 v[42:43], v252 offset:49664
    v_mfma_f32_16x16x32_bf16 v[92:95], v[72:75], v[60:63], v[92:95]
    ds_read_b128 v[24:27], v249 offset:32768
    s_lshl_b32 m0, s33, 2
    v_mfma_f32_16x16x32_bf16 v[96:99], v[72:75], v[64:67], v[96:99]
    ds_read_b128 v[28:31], v249 offset:33792
    v_mfma_f32_16x16x32_bf16 v[100:103], v[72:75], v[68:71], v[100:103]
    ds_read_b128 v[32:35], v249 offset:34816
    buffer_load_dwordx4 v18, s[56:59], s82 offen offset:0 sc1 lds
    v_mfma_f32_16x16x32_bf16 v[104:107], v[76:79], v[56:59], v[104:107]
    ds_read_b128 v[36:39], v249 offset:35840
    v_mfma_f32_16x16x32_bf16 v[108:111], v[76:79], v[60:63], v[108:111]
    ds_read_b64_tr_b16 v[44:45], v253 offset:49152
    ds_read_b64_tr_b16 v[46:47], v253 offset:49664
    v_mfma_f32_16x16x32_bf16 v[112:115], v[76:79], v[64:67], v[112:115]
    ds_read_b64_tr_b16 v[48:49], v252 offset:57344
    v_mfma_f32_16x16x32_bf16 v[116:119], v[76:79], v[68:71], v[116:119]
    ds_read_b64_tr_b16 v[50:51], v252 offset:57856
    buffer_load_dwordx4 v18, s[56:59], s82 offen offset:1024 sc1 lds
    v_mfma_f32_16x16x32_bf16 v[120:123], v[80:83], v[56:59], v[120:123]
    ds_read_b64_tr_b16 v[52:53], v253 offset:57344
    v_mfma_f32_16x16x32_bf16 v[124:127], v[80:83], v[60:63], v[124:127]
    ds_read_b64_tr_b16 v[54:55], v253 offset:57856
    v_mfma_f32_16x16x32_bf16 v[128:131], v[80:83], v[64:67], v[128:131]
    v_mfma_f32_16x16x32_bf16 v[132:135], v[80:83], v[68:71], v[132:135]
    buffer_load_dwordx4 v18, s[56:59], s82 offen offset:2048 sc1 lds
    v_mfma_f32_16x16x32_bf16 v[136:139], v[84:87], v[56:59], v[136:139]
    v_mfma_f32_16x16x32_bf16 v[140:143], v[84:87], v[60:63], v[140:143]
    v_mfma_f32_16x16x32_bf16 v[144:147], v[84:87], v[64:67], v[144:147]
    v_mfma_f32_16x16x32_bf16 v[148:151], v[84:87], v[68:71], v[148:151]
    buffer_load_dwordx4 v18, s[56:59], s82 offen offset:3072 sc1 lds
    s_add_u32 s82, s82, 16384
    s_waitcnt lgkmcnt(9)
    v_mfma_f32_16x16x32_bf16 v[88:91], v[40:43], v[24:27], v[88:91]
    ds_read_b64_tr_b16 v[72:73], v252 offset:53248
    ds_read_b64_tr_b16 v[74:75], v252 offset:53760
    s_waitcnt lgkmcnt(10)
    v_mfma_f32_16x16x32_bf16 v[92:95], v[40:43], v[28:31], v[92:95]
    ds_read_b128 v[56:59], v249 offset:40960
    s_lshl1_add_u32 m0, s33, 16384
    s_waitcnt lgkmcnt(10)
    v_mfma_f32_16x16x32_bf16 v[96:99], v[40:43], v[32:35], v[96:99]
    ds_read_b128 v[60:63], v249 offset:41984
    ds_read_b128 v[64:67], v249 offset:43008
    s_waitcnt lgkmcnt(11)
    v_mfma_f32_16x16x32_bf16 v[100:103], v[40:43], v[36:39], v[100:103]
    ds_read_b128 v[68:71], v249 offset:44032
    buffer_load_dwordx4 v254, s[60:63], s83 offen lds
    s_waitcnt lgkmcnt(10)
    v_mfma_f32_16x16x32_bf16 v[104:107], v[44:47], v[24:27], v[104:107]
    ds_read_b64_tr_b16 v[76:77], v253 offset:53248
    ds_read_b64_tr_b16 v[78:79], v253 offset:53760
    v_mfma_f32_16x16x32_bf16 v[108:111], v[44:47], v[28:31], v[108:111]
    ds_read_b64_tr_b16 v[80:81], v252 offset:61440
    s_lshl1_add_u32 m0, s33, 17408
    v_mfma_f32_16x16x32_bf16 v[112:115], v[44:47], v[32:35], v[112:115]
    ds_read_b64_tr_b16 v[82:83], v252 offset:61952
    ds_read_b64_tr_b16 v[84:85], v253 offset:61440
    v_mfma_f32_16x16x32_bf16 v[116:119], v[44:47], v[36:39], v[116:119]
    ds_read_b64_tr_b16 v[86:87], v253 offset:61952
    buffer_load_dwordx4 v255, s[60:63], s83 offen lds
    s_waitcnt lgkmcnt(14)
    v_mfma_f32_16x16x32_bf16 v[120:123], v[48:51], v[24:27], v[120:123]
    v_mfma_f32_16x16x32_bf16 v[124:127], v[48:51], v[28:31], v[124:127]
    s_lshl1_add_u32 m0, s33, 24576
    v_mfma_f32_16x16x32_bf16 v[128:131], v[48:51], v[32:35], v[128:131]
    v_mfma_f32_16x16x32_bf16 v[132:135], v[48:51], v[36:39], v[132:135]
    buffer_load_dwordx4 v254, s[64:67], s83 offen lds
    s_waitcnt lgkmcnt(12)
    v_mfma_f32_16x16x32_bf16 v[136:139], v[52:55], v[24:27], v[136:139]
    v_mfma_f32_16x16x32_bf16 v[140:143], v[52:55], v[28:31], v[140:143]
    s_lshl1_add_u32 m0, s33, 25600
    v_mfma_f32_16x16x32_bf16 v[144:147], v[52:55], v[32:35], v[144:147]
    v_mfma_f32_16x16x32_bf16 v[148:151], v[52:55], v[36:39], v[148:151]
    buffer_load_dwordx4 v255, s[64:67], s83 offen lds
    s_add_u32 s83, s83, 131072
    s_waitcnt vmcnt(16) lgkmcnt(0)
    s_barrier
    v_mfma_f32_16x16x32_bf16 v[88:91], v[72:75], v[56:59], v[88:91]
    ds_read_b64_tr_b16 v[40:41], v250 offset:49152
    ds_read_b64_tr_b16 v[42:43], v250 offset:49664
    v_mfma_f32_16x16x32_bf16 v[92:95], v[72:75], v[60:63], v[92:95]
    ds_read_b128 v[24:27], v248 offset:32768
    s_lshl2_add_u32 m0, s33, 98304
    v_mfma_f32_16x16x32_bf16 v[96:99], v[72:75], v[64:67], v[96:99]
    ds_read_b128 v[28:31], v248 offset:33792
    v_mfma_f32_16x16x32_bf16 v[100:103], v[72:75], v[68:71], v[100:103]
    ds_read_b128 v[32:35], v248 offset:34816
    buffer_load_dwordx4 v18, s[56:59], s82 offen offset:0 sc1 lds
    v_mfma_f32_16x16x32_bf16 v[104:107], v[76:79], v[56:59], v[104:107]
    ds_read_b128 v[36:39], v248 offset:35840
    v_mfma_f32_16x16x32_bf16 v[108:111], v[76:79], v[60:63], v[108:111]
    ds_read_b64_tr_b16 v[44:45], v251 offset:49152
    ds_read_b64_tr_b16 v[46:47], v251 offset:49664
    v_mfma_f32_16x16x32_bf16 v[112:115], v[76:79], v[64:67], v[112:115]
    ds_read_b64_tr_b16 v[48:49], v250 offset:57344
    v_mfma_f32_16x16x32_bf16 v[116:119], v[76:79], v[68:71], v[116:119]
    ds_read_b64_tr_b16 v[50:51], v250 offset:57856
    buffer_load_dwordx4 v18, s[56:59], s82 offen offset:1024 sc1 lds
    v_mfma_f32_16x16x32_bf16 v[120:123], v[80:83], v[56:59], v[120:123]
    ds_read_b64_tr_b16 v[52:53], v251 offset:57344
    v_mfma_f32_16x16x32_bf16 v[124:127], v[80:83], v[60:63], v[124:127]
    ds_read_b64_tr_b16 v[54:55], v251 offset:57856
    v_mfma_f32_16x16x32_bf16 v[128:131], v[80:83], v[64:67], v[128:131]
    v_mfma_f32_16x16x32_bf16 v[132:135], v[80:83], v[68:71], v[132:135]
    buffer_load_dwordx4 v18, s[56:59], s82 offen offset:2048 sc1 lds
    v_mfma_f32_16x16x32_bf16 v[136:139], v[84:87], v[56:59], v[136:139]
    v_mfma_f32_16x16x32_bf16 v[140:143], v[84:87], v[60:63], v[140:143]
    v_mfma_f32_16x16x32_bf16 v[144:147], v[84:87], v[64:67], v[144:147]
    v_mfma_f32_16x16x32_bf16 v[148:151], v[84:87], v[68:71], v[148:151]
    buffer_load_dwordx4 v18, s[56:59], s82 offen offset:3072 sc1 lds
    s_add_u32 s82, s82, 16384
    s_waitcnt lgkmcnt(9)
    v_mfma_f32_16x16x32_bf16 v[88:91], v[40:43], v[24:27], v[88:91]
    ds_read_b64_tr_b16 v[72:73], v250 offset:53248
    ds_read_b64_tr_b16 v[74:75], v250 offset:53760
    s_waitcnt lgkmcnt(10)
    v_mfma_f32_16x16x32_bf16 v[92:95], v[40:43], v[28:31], v[92:95]
    ds_read_b128 v[56:59], v248 offset:40960
    s_lshl1_add_u32 m0, s33, 114688
    s_waitcnt lgkmcnt(10)
    v_mfma_f32_16x16x32_bf16 v[96:99], v[40:43], v[32:35], v[96:99]
    ds_read_b128 v[60:63], v248 offset:41984
    ds_read_b128 v[64:67], v248 offset:43008
    s_waitcnt lgkmcnt(11)
    v_mfma_f32_16x16x32_bf16 v[100:103], v[40:43], v[36:39], v[100:103]
    ds_read_b128 v[68:71], v248 offset:44032
    buffer_load_dwordx4 v254, s[60:63], s83 offen lds
    s_waitcnt lgkmcnt(10)
    v_mfma_f32_16x16x32_bf16 v[104:107], v[44:47], v[24:27], v[104:107]
    ds_read_b64_tr_b16 v[76:77], v251 offset:53248
    ds_read_b64_tr_b16 v[78:79], v251 offset:53760
    v_mfma_f32_16x16x32_bf16 v[108:111], v[44:47], v[28:31], v[108:111]
    ds_read_b64_tr_b16 v[80:81], v250 offset:61440
    s_lshl1_add_u32 m0, s33, 115712
    v_mfma_f32_16x16x32_bf16 v[112:115], v[44:47], v[32:35], v[112:115]
    ds_read_b64_tr_b16 v[82:83], v250 offset:61952
    ds_read_b64_tr_b16 v[84:85], v251 offset:61440
    v_mfma_f32_16x16x32_bf16 v[116:119], v[44:47], v[36:39], v[116:119]
    ds_read_b64_tr_b16 v[86:87], v251 offset:61952
    buffer_load_dwordx4 v255, s[60:63], s83 offen lds
    s_waitcnt lgkmcnt(14)
    v_mfma_f32_16x16x32_bf16 v[120:123], v[48:51], v[24:27], v[120:123]
    v_mfma_f32_16x16x32_bf16 v[124:127], v[48:51], v[28:31], v[124:127]
    s_lshl1_add_u32 m0, s33, 122880
    v_mfma_f32_16x16x32_bf16 v[128:131], v[48:51], v[32:35], v[128:131]
    v_mfma_f32_16x16x32_bf16 v[132:135], v[48:51], v[36:39], v[132:135]
    buffer_load_dwordx4 v254, s[64:67], s83 offen lds
    s_waitcnt lgkmcnt(12)
    v_mfma_f32_16x16x32_bf16 v[136:139], v[52:55], v[24:27], v[136:139]
    v_mfma_f32_16x16x32_bf16 v[140:143], v[52:55], v[28:31], v[140:143]
    s_lshl1_add_u32 m0, s33, 123904
    v_mfma_f32_16x16x32_bf16 v[144:147], v[52:55], v[32:35], v[144:147]
    v_mfma_f32_16x16x32_bf16 v[148:151], v[52:55], v[36:39], v[148:151]
    buffer_load_dwordx4 v255, s[64:67], s83 offen lds
    s_add_u32 s83, s83, 131072
    s_waitcnt vmcnt(16) lgkmcnt(0)
    s_barrier
    v_mfma_f32_16x16x32_bf16 v[88:91], v[72:75], v[56:59], v[88:91]
    ds_read_b64_tr_b16 v[40:41], v252 offset:16384
    ds_read_b64_tr_b16 v[42:43], v252 offset:16896
    v_mfma_f32_16x16x32_bf16 v[92:95], v[72:75], v[60:63], v[92:95]
    ds_read_b128 v[24:27], v249 offset:0
    s_lshl2_add_u32 m0, s33, 32768
    v_mfma_f32_16x16x32_bf16 v[96:99], v[72:75], v[64:67], v[96:99]
    ds_read_b128 v[28:31], v249 offset:1024
    v_mfma_f32_16x16x32_bf16 v[100:103], v[72:75], v[68:71], v[100:103]
    ds_read_b128 v[32:35], v249 offset:2048
    buffer_load_dwordx4 v18, s[56:59], s82 offen offset:0 sc1 lds
    v_mfma_f32_16x16x32_bf16 v[104:107], v[76:79], v[56:59], v[104:107]
    ds_read_b128 v[36:39], v249 offset:3072
    v_mfma_f32_16x16x32_bf16 v[108:111], v[76:79], v[60:63], v[108:111]
    ds_read_b64_tr_b16 v[44:45], v253 offset:16384
    ds_read_b64_tr_b16 v[46:47], v253 offset:16896
    v_mfma_f32_16x16x32_bf16 v[112:115], v[76:79], v[64:67], v[112:115]
    ds_read_b64_tr_b16 v[48:49], v252 offset:24576
    v_mfma_f32_16x16x32_bf16 v[116:119], v[76:79], v[68:71], v[116:119]
    ds_read_b64_tr_b16 v[50:51], v252 offset:25088
    buffer_load_dwordx4 v18, s[56:59], s82 offen offset:1024 sc1 lds
    v_mfma_f32_16x16x32_bf16 v[120:123], v[80:83], v[56:59], v[120:123]
    ds_read_b64_tr_b16 v[52:53], v253 offset:24576
    v_mfma_f32_16x16x32_bf16 v[124:127], v[80:83], v[60:63], v[124:127]
    ds_read_b64_tr_b16 v[54:55], v253 offset:25088
    v_mfma_f32_16x16x32_bf16 v[128:131], v[80:83], v[64:67], v[128:131]
    v_mfma_f32_16x16x32_bf16 v[132:135], v[80:83], v[68:71], v[132:135]
    buffer_load_dwordx4 v18, s[56:59], s82 offen offset:2048 sc1 lds
    v_mfma_f32_16x16x32_bf16 v[136:139], v[84:87], v[56:59], v[136:139]
    v_mfma_f32_16x16x32_bf16 v[140:143], v[84:87], v[60:63], v[140:143]
    v_mfma_f32_16x16x32_bf16 v[144:147], v[84:87], v[64:67], v[144:147]
    v_mfma_f32_16x16x32_bf16 v[148:151], v[84:87], v[68:71], v[148:151]
    buffer_load_dwordx4 v18, s[56:59], s82 offen offset:3072 sc1 lds
    s_add_u32 s82, s82, 16384
    s_waitcnt lgkmcnt(9)
    v_mfma_f32_16x16x32_bf16 v[88:91], v[40:43], v[24:27], v[88:91]
    ds_read_b64_tr_b16 v[72:73], v252 offset:20480
    ds_read_b64_tr_b16 v[74:75], v252 offset:20992
    s_waitcnt lgkmcnt(10)
    v_mfma_f32_16x16x32_bf16 v[92:95], v[40:43], v[28:31], v[92:95]
    ds_read_b128 v[56:59], v249 offset:8192
    s_lshl1_add_u32 m0, s33, 49152
    s_waitcnt lgkmcnt(10)
    v_mfma_f32_16x16x32_bf16 v[96:99], v[40:43], v[32:35], v[96:99]
    ds_read_b128 v[60:63], v249 offset:9216
    ds_read_b128 v[64:67], v249 offset:10240
    s_waitcnt lgkmcnt(11)
    v_mfma_f32_16x16x32_bf16 v[100:103], v[40:43], v[36:39], v[100:103]
    ds_read_b128 v[68:71], v249 offset:11264
    buffer_load_dwordx4 v254, s[60:63], s83 offen lds
    s_waitcnt lgkmcnt(10)
    v_mfma_f32_16x16x32_bf16 v[104:107], v[44:47], v[24:27], v[104:107]
    ds_read_b64_tr_b16 v[76:77], v253 offset:20480
    ds_read_b64_tr_b16 v[78:79], v253 offset:20992
    v_mfma_f32_16x16x32_bf16 v[108:111], v[44:47], v[28:31], v[108:111]
    ds_read_b64_tr_b16 v[80:81], v252 offset:28672
    s_lshl1_add_u32 m0, s33, 50176
    v_mfma_f32_16x16x32_bf16 v[112:115], v[44:47], v[32:35], v[112:115]
    ds_read_b64_tr_b16 v[82:83], v252 offset:29184
    ds_read_b64_tr_b16 v[84:85], v253 offset:28672
    v_mfma_f32_16x16x32_bf16 v[116:119], v[44:47], v[36:39], v[116:119]
    ds_read_b64_tr_b16 v[86:87], v253 offset:29184
    buffer_load_dwordx4 v255, s[60:63], s83 offen lds
    s_waitcnt lgkmcnt(14)
    v_mfma_f32_16x16x32_bf16 v[120:123], v[48:51], v[24:27], v[120:123]
    v_mfma_f32_16x16x32_bf16 v[124:127], v[48:51], v[28:31], v[124:127]
    s_lshl1_add_u32 m0, s33, 57344
    v_mfma_f32_16x16x32_bf16 v[128:131], v[48:51], v[32:35], v[128:131]
    v_mfma_f32_16x16x32_bf16 v[132:135], v[48:51], v[36:39], v[132:135]
    buffer_load_dwordx4 v254, s[64:67], s83 offen lds
    s_waitcnt lgkmcnt(12)
    v_mfma_f32_16x16x32_bf16 v[136:139], v[52:55], v[24:27], v[136:139]
    v_mfma_f32_16x16x32_bf16 v[140:143], v[52:55], v[28:31], v[140:143]
    s_lshl1_add_u32 m0, s33, 58368
    v_mfma_f32_16x16x32_bf16 v[144:147], v[52:55], v[32:35], v[144:147]
    v_mfma_f32_16x16x32_bf16 v[148:151], v[52:55], v[36:39], v[148:151]
    buffer_load_dwordx4 v255, s[64:67], s83 offen lds
    s_add_u32 s83, s83, 131072
    s_waitcnt vmcnt(16) lgkmcnt(0)
    s_barrier
    v_mfma_f32_16x16x32_bf16 v[88:91], v[72:75], v[56:59], v[88:91]
    ds_read_b64_tr_b16 v[40:41], v250 offset:16384
    ds_read_b64_tr_b16 v[42:43], v250 offset:16896
    v_mfma_f32_16x16x32_bf16 v[92:95], v[72:75], v[60:63], v[92:95]
    ds_read_b128 v[24:27], v248 offset:0
    s_lshl2_add_u32 m0, s33, 65536
    v_mfma_f32_16x16x32_bf16 v[96:99], v[72:75], v[64:67], v[96:99]
    ds_read_b128 v[28:31], v248 offset:1024
    v_mfma_f32_16x16x32_bf16 v[100:103], v[72:75], v[68:71], v[100:103]
    ds_read_b128 v[32:35], v248 offset:2048
    buffer_load_dwordx4 v18, s[56:59], s82 offen offset:0 sc1 lds
    v_mfma_f32_16x16x32_bf16 v[104:107], v[76:79], v[56:59], v[104:107]
    ds_read_b128 v[36:39], v248 offset:3072
    v_mfma_f32_16x16x32_bf16 v[108:111], v[76:79], v[60:63], v[108:111]
    ds_read_b64_tr_b16 v[44:45], v251 offset:16384
    ds_read_b64_tr_b16 v[46:47], v251 offset:16896
    v_mfma_f32_16x16x32_bf16 v[112:115], v[76:79], v[64:67], v[112:115]
    ds_read_b64_tr_b16 v[48:49], v250 offset:24576
    v_mfma_f32_16x16x32_bf16 v[116:119], v[76:79], v[68:71], v[116:119]
    ds_read_b64_tr_b16 v[50:51], v250 offset:25088
    buffer_load_dwordx4 v18, s[56:59], s82 offen offset:1024 sc1 lds
    v_mfma_f32_16x16x32_bf16 v[120:123], v[80:83], v[56:59], v[120:123]
    ds_read_b64_tr_b16 v[52:53], v251 offset:24576
    v_mfma_f32_16x16x32_bf16 v[124:127], v[80:83], v[60:63], v[124:127]
    ds_read_b64_tr_b16 v[54:55], v251 offset:25088
    v_mfma_f32_16x16x32_bf16 v[128:131], v[80:83], v[64:67], v[128:131]
    v_mfma_f32_16x16x32_bf16 v[132:135], v[80:83], v[68:71], v[132:135]
    buffer_load_dwordx4 v18, s[56:59], s82 offen offset:2048 sc1 lds
    v_mfma_f32_16x16x32_bf16 v[136:139], v[84:87], v[56:59], v[136:139]
    v_mfma_f32_16x16x32_bf16 v[140:143], v[84:87], v[60:63], v[140:143]
    v_mfma_f32_16x16x32_bf16 v[144:147], v[84:87], v[64:67], v[144:147]
    v_mfma_f32_16x16x32_bf16 v[148:151], v[84:87], v[68:71], v[148:151]
    buffer_load_dwordx4 v18, s[56:59], s82 offen offset:3072 sc1 lds
    s_add_u32 s82, s82, 16384
    s_sub_u32 s34, s34, 1
    s_cmp_lg_u32 s34, 0
    s_cbranch_scc1 L_da
    s_mov_b32 s34, 3
.p2align 6
L_d:
    s_waitcnt lgkmcnt(9)
    v_mfma_f32_16x16x32_bf16 v[88:91], v[40:43], v[24:27], v[88:91]
    ds_read_b64_tr_b16 v[72:73], v250 offset:20480
    ds_read_b64_tr_b16 v[74:75], v250 offset:20992
    s_waitcnt lgkmcnt(10)
    v_mfma_f32_16x16x32_bf16 v[92:95], v[40:43], v[28:31], v[92:95]
    ds_read_b128 v[56:59], v248 offset:8192
    s_waitcnt lgkmcnt(10)
    v_mfma_f32_16x16x32_bf16 v[96:99], v[40:43], v[32:35], v[96:99]
    ds_read_b128 v[60:63], v248 offset:9216
    ds_read_b128 v[64:67], v248 offset:10240
    s_waitcnt lgkmcnt(11)
    v_mfma_f32_16x16x32_bf16 v[100:103], v[40:43], v[36:39], v[100:103]
    ds_read_b128 v[68:71], v248 offset:11264
    s_waitcnt lgkmcnt(10)
    v_mfma_f32_16x16x32_bf16 v[104:107], v[44:47], v[24:27], v[104:107]
    ds_read_b64_tr_b16 v[76:77], v251 offset:20480
    ds_read_b64_tr_b16 v[78:79], v251 offset:20992
    v_mfma_f32_16x16x32_bf16 v[108:111], v[44:47], v[28:31], v[108:111]
    ds_read_b64_tr_b16 v[80:81], v250 offset:28672
    v_mfma_f32_16x16x32_bf16 v[112:115], v[44:47], v[32:35], v[112:115]
    ds_read_b64_tr_b16 v[82:83], v250 offset:29184
    ds_read_b64_tr_b16 v[84:85], v251 offset:28672
    v_mfma_f32_16x16x32_bf16 v[116:119], v[44:47], v[36:39], v[116:119]
    ds_read_b64_tr_b16 v[86:87], v251 offset:29184
    s_waitcnt lgkmcnt(14)
    v_mfma_f32_16x16x32_bf16 v[120:123], v[48:51], v[24:27], v[120:123]
    v_mfma_f32_16x16x32_bf16 v[124:127], v[48:51], v[28:31], v[124:127]
    v_mfma_f32_16x16x32_bf16 v[128:131], v[48:51], v[32:35], v[128:131]
    v_mfma_f32_16x16x32_bf16 v[132:135], v[48:51], v[36:39], v[132:135]
    s_waitcnt lgkmcnt(12)
    v_mfma_f32_16x16x32_bf16 v[136:139], v[52:55], v[24:27], v[136:139]
    v_mfma_f32_16x16x32_bf16 v[140:143], v[52:55], v[28:31], v[140:143]
    v_mfma_f32_16x16x32_bf16 v[144:147], v[52:55], v[32:35], v[144:147]
    v_mfma_f32_16x16x32_bf16 v[148:151], v[52:55], v[36:39], v[148:151]
    s_waitcnt vmcnt(12) lgkmcnt(0)
    s_barrier
    v_mfma_f32_16x16x32_bf16 v[88:91], v[72:75], v[56:59], v[88:91]
    ds_read_b64_tr_b16 v[40:41], v252 offset:49152
    ds_read_b64_tr_b16 v[42:43], v252 offset:49664
    v_mfma_f32_16x16x32_bf16 v[92:95], v[72:75], v[60:63], v[92:95]
    ds_read_b128 v[24:27], v249 offset:32768
    v_mfma_f32_16x16x32_bf16 v[96:99], v[72:75], v[64:67], v[96:99]
    ds_read_b128 v[28:31], v249 offset:33792
    v_mfma_f32_16x16x32_bf16 v[100:103], v[72:75], v[68:71], v[100:103]
    ds_read_b128 v[32:35], v249 offset:34816
    v_mfma_f32_16x16x32_bf16 v[104:107], v[76:79], v[56:59], v[104:107]
    ds_read_b128 v[36:39], v249 offset:35840
    v_mfma_f32_16x16x32_bf16 v[108:111], v[76:79], v[60:63], v[108:111]
    ds_read_b64_tr_b16 v[44:45], v253 offset:49152
    ds_read_b64_tr_b16 v[46:47], v253 offset:49664
    v_mfma_f32_16x16x32_bf16 v[112:115], v[76:79], v[64:67], v[112:115]
    ds_read_b64_tr_b16 v[48:49], v252 offset:57344
    v_mfma_f32_16x16x32_bf16 v[116:119], v[76:79], v[68:71], v[116:119]
    ds_read_b64_tr_b16 v[50:51], v252 offset:57856
    v_mfma_f32_16x16x32_bf16 v[120:123], v[80:83], v[56:59], v[120:123]
    ds_read_b64_tr_b16 v[52:53], v253 offset:57344
    v_mfma_f32_16x16x32_bf16 v[124:127], v[80:83], v[60:63], v[124:127]
    ds_read_b64_tr_b16 v[54:55], v253 offset:57856
    v_mfma_f32_16x16x32_bf16 v[128:131], v[80:83], v[64:67], v[128:131]
    v_mfma_f32_16x16x32_bf16 v[132:135], v[80:83], v[68:71], v[132:135]
    v_mfma_f32_16x16x32_bf16 v[136:139], v[84:87], v[56:59], v[136:139]
    v_mfma_f32_16x16x32_bf16 v[140:143], v[84:87], v[60:63], v[140:143]
    v_mfma_f32_16x16x32_bf16 v[144:147], v[84:87], v[64:67], v[144:147]
    v_mfma_f32_16x16x32_bf16 v[148:151], v[84:87], v[68:71], v[148:151]
    s_waitcnt lgkmcnt(9)
    v_mfma_f32_16x16x32_bf16 v[88:91], v[40:43], v[24:27], v[88:91]
    ds_read_b64_tr_b16 v[72:73], v252 offset:53248
    ds_read_b64_tr_b16 v[74:75], v252 offset:53760
    s_waitcnt lgkmcnt(10)
    v_mfma_f32_16x16x32_bf16 v[92:95], v[40:43], v[28:31], v[92:95]
    ds_read_b128 v[56:59], v249 offset:40960
    s_waitcnt lgkmcnt(10)
    v_mfma_f32_16x16x32_bf16 v[96:99], v[40:43], v[32:35], v[96:99]
    ds_read_b128 v[60:63], v249 offset:41984
    ds_read_b128 v[64:67], v249 offset:43008
    s_waitcnt lgkmcnt(11)
    v_mfma_f32_16x16x32_bf16 v[100:103], v[40:43], v[36:39], v[100:103]
    ds_read_b128 v[68:71], v249 offset:44032
    s_waitcnt lgkmcnt(10)
    v_mfma_f32_16x16x32_bf16 v[104:107], v[44:47], v[24:27], v[104:107]
    ds_read_b64_tr_b16 v[76:77], v253 offset:53248
    ds_read_b64_tr_b16 v[78:79], v253 offset:53760
    v_mfma_f32_16x16x32_bf16 v[108:111], v[44:47], v[28:31], v[108:111]
    ds_read_b64_tr_b16 v[80:81], v252 offset:61440
    v_mfma_f32_16x16x32_bf16 v[112:115], v[44:47], v[32:35], v[112:115]
    ds_read_b64_tr_b16 v[82:83], v252 offset:61952
    ds_read_b64_tr_b16 v[84:85], v253 offset:61440
    v_mfma_f32_16x16x32_bf16 v[116:119], v[44:47], v[36:39], v[116:119]
    ds_read_b64_tr_b16 v[86:87], v253 offset:61952
    s_waitcnt lgkmcnt(14)
    v_mfma_f32_16x16x32_bf16 v[120:123], v[48:51], v[24:27], v[120:123]
    v_mfma_f32_16x16x32_bf16 v[124:127], v[48:51], v[28:31], v[124:127]
    v_mfma_f32_16x16x32_bf16 v[128:131], v[48:51], v[32:35], v[128:131]
    v_mfma_f32_16x16x32_bf16 v[132:135], v[48:51], v[36:39], v[132:135]
    s_waitcnt lgkmcnt(12)
    v_mfma_f32_16x16x32_bf16 v[136:139], v[52:55], v[24:27], v[136:139]
    v_mfma_f32_16x16x32_bf16 v[140:143], v[52:55], v[28:31], v[140:143]
    v_mfma_f32_16x16x32_bf16 v[144:147], v[52:55], v[32:35], v[144:147]
    v_mfma_f32_16x16x32_bf16 v[148:151], v[52:55], v[36:39], v[148:151]
    s_waitcnt vmcnt(4) lgkmcnt(0)
    s_barrier
    v_mfma_f32_16x16x32_bf16 v[88:91], v[72:75], v[56:59], v[88:91]
    ds_read_b64_tr_b16 v[40:41], v250 offset:49152
    ds_read_b64_tr_b16 v[42:43], v250 offset:49664
    v_mfma_f32_16x16x32_bf16 v[92:95], v[72:75], v[60:63], v[92:95]
    ds_read_b128 v[24:27], v248 offset:32768
    v_mfma_f32_16x16x32_bf16 v[96:99], v[72:75], v[64:67], v[96:99]
    ds_read_b128 v[28:31], v248 offset:33792
    v_mfma_f32_16x16x32_bf16 v[100:103], v[72:75], v[68:71], v[100:103]
    ds_read_b128 v[32:35], v248 offset:34816
    v_mfma_f32_16x16x32_bf16 v[104:107], v[76:79], v[56:59], v[104:107]
    ds_read_b128 v[36:39], v248 offset:35840
    v_mfma_f32_16x16x32_bf16 v[108:111], v[76:79], v[60:63], v[108:111]
    ds_read_b64_tr_b16 v[44:45], v251 offset:49152
    ds_read_b64_tr_b16 v[46:47], v251 offset:49664
    v_mfma_f32_16x16x32_bf16 v[112:115], v[76:79], v[64:67], v[112:115]
    ds_read_b64_tr_b16 v[48:49], v250 offset:57344
    v_mfma_f32_16x16x32_bf16 v[116:119], v[76:79], v[68:71], v[116:119]
    ds_read_b64_tr_b16 v[50:51], v250 offset:57856
    v_mfma_f32_16x16x32_bf16 v[120:123], v[80:83], v[56:59], v[120:123]
    ds_read_b64_tr_b16 v[52:53], v251 offset:57344
    v_mfma_f32_16x16x32_bf16 v[124:127], v[80:83], v[60:63], v[124:127]
    ds_read_b64_tr_b16 v[54:55], v251 offset:57856
    v_mfma_f32_16x16x32_bf16 v[128:131], v[80:83], v[64:67], v[128:131]
    v_mfma_f32_16x16x32_bf16 v[132:135], v[80:83], v[68:71], v[132:135]
    v_mfma_f32_16x16x32_bf16 v[136:139], v[84:87], v[56:59], v[136:139]
    v_mfma_f32_16x16x32_bf16 v[140:143], v[84:87], v[60:63], v[140:143]
    v_mfma_f32_16x16x32_bf16 v[144:147], v[84:87], v[64:67], v[144:147]
    v_mfma_f32_16x16x32_bf16 v[148:151], v[84:87], v[68:71], v[148:151]
    s_waitcnt lgkmcnt(9)
    v_mfma_f32_16x16x32_bf16 v[88:91], v[40:43], v[24:27], v[88:91]
    ds_read_b64_tr_b16 v[72:73], v250 offset:53248
    ds_read_b64_tr_b16 v[74:75], v250 offset:53760
    s_waitcnt lgkmcnt(10)
    v_mfma_f32_16x16x32_bf16 v[92:95], v[40:43], v[28:31], v[92:95]
    ds_read_b128 v[56:59], v248 offset:40960
    s_waitcnt lgkmcnt(10)
    v_mfma_f32_16x16x32_bf16 v[96:99], v[40:43], v[32:35], v[96:99]
    ds_read_b128 v[60:63], v248 offset:41984
    ds_read_b128 v[64:67], v248 offset:43008
    s_waitcnt lgkmcnt(11)
    v_mfma_f32_16x16x32_bf16 v[100:103], v[40:43], v[36:39], v[100:103]
    ds_read_b128 v[68:71], v248 offset:44032
    s_waitcnt lgkmcnt(10)
    v_mfma_f32_16x16x32_bf16 v[104:107], v[44:47], v[24:27], v[104:107]
    ds_read_b64_tr_b16 v[76:77], v251 offset:53248
    ds_read_b64_tr_b16 v[78:79], v251 offset:53760
    v_mfma_f32_16x16x32_bf16 v[108:111], v[44:47], v[28:31], v[108:111]
    ds_read_b64_tr_b16 v[80:81], v250 offset:61440
    v_mfma_f32_16x16x32_bf16 v[112:115], v[44:47], v[32:35], v[112:115]
    ds_read_b64_tr_b16 v[82:83], v250 offset:61952
    ds_read_b64_tr_b16 v[84:85], v251 offset:61440
    v_mfma_f32_16x16x32_bf16 v[116:119], v[44:47], v[36:39], v[116:119]
    ds_read_b64_tr_b16 v[86:87], v251 offset:61952
    s_waitcnt lgkmcnt(14)
    v_mfma_f32_16x16x32_bf16 v[120:123], v[48:51], v[24:27], v[120:123]
    v_mfma_f32_16x16x32_bf16 v[124:127], v[48:51], v[28:31], v[124:127]
    v_mfma_f32_16x16x32_bf16 v[128:131], v[48:51], v[32:35], v[128:131]
    v_mfma_f32_16x16x32_bf16 v[132:135], v[48:51], v[36:39], v[132:135]
    s_waitcnt lgkmcnt(12)
    v_mfma_f32_16x16x32_bf16 v[136:139], v[52:55], v[24:27], v[136:139]
    v_mfma_f32_16x16x32_bf16 v[140:143], v[52:55], v[28:31], v[140:143]
    v_mfma_f32_16x16x32_bf16 v[144:147], v[52:55], v[32:35], v[144:147]
    v_mfma_f32_16x16x32_bf16 v[148:151], v[52:55], v[36:39], v[148:151]
    s_waitcnt vmcnt(0) lgkmcnt(0)
    s_barrier
    v_mfma_f32_16x16x32_bf16 v[88:91], v[72:75], v[56:59], v[88:91]
    ds_read_b64_tr_b16 v[40:41], v252 offset:16384
    ds_read_b64_tr_b16 v[42:43], v252 offset:16896
    v_mfma_f32_16x16x32_bf16 v[92:95], v[72:75], v[60:63], v[92:95]
    ds_read_b128 v[24:27], v249 offset:0
    v_mfma_f32_16x16x32_bf16 v[96:99], v[72:75], v[64:67], v[96:99]
    ds_read_b128 v[28:31], v249 offset:1024
    v_mfma_f32_16x16x32_bf16 v[100:103], v[72:75], v[68:71], v[100:103]
    ds_read_b128 v[32:35], v249 offset:2048
    v_mfma_f32_16x16x32_bf16 v[104:107], v[76:79], v[56:59], v[104:107]
    ds_read_b128 v[36:39], v249 offset:3072
    v_mfma_f32_16x16x32_bf16 v[108:111], v[76:79], v[60:63], v[108:111]
    ds_read_b64_tr_b16 v[44:45], v253 offset:16384
    ds_read_b64_tr_b16 v[46:47], v253 offset:16896
    v_mfma_f32_16x16x32_bf16 v[112:115], v[76:79], v[64:67], v[112:115]
    ds_read_b64_tr_b16 v[48:49], v252 offset:24576
    v_mfma_f32_16x16x32_bf16 v[116:119], v[76:79], v[68:71], v[116:119]
    ds_read_b64_tr_b16 v[50:51], v252 offset:25088
    v_mfma_f32_16x16x32_bf16 v[120:123], v[80:83], v[56:59], v[120:123]
    ds_read_b64_tr_b16 v[52:53], v253 offset:24576
    v_mfma_f32_16x16x32_bf16 v[124:127], v[80:83], v[60:63], v[124:127]
    ds_read_b64_tr_b16 v[54:55], v253 offset:25088
    v_mfma_f32_16x16x32_bf16 v[128:131], v[80:83], v[64:67], v[128:131]
    v_mfma_f32_16x16x32_bf16 v[132:135], v[80:83], v[68:71], v[132:135]
    v_mfma_f32_16x16x32_bf16 v[136:139], v[84:87], v[56:59], v[136:139]
    v_mfma_f32_16x16x32_bf16 v[140:143], v[84:87], v[60:63], v[140:143]
    v_mfma_f32_16x16x32_bf16 v[144:147], v[84:87], v[64:67], v[144:147]
    v_mfma_f32_16x16x32_bf16 v[148:151], v[84:87], v[68:71], v[148:151]
    s_waitcnt lgkmcnt(9)
    v_mfma_f32_16x16x32_bf16 v[88:91], v[40:43], v[24:27], v[88:91]
    ds_read_b64_tr_b16 v[72:73], v252 offset:20480
    ds_read_b64_tr_b16 v[74:75], v252 offset:20992
    s_waitcnt lgkmcnt(10)
    v_mfma_f32_16x16x32_bf16 v[92:95], v[40:43], v[28:31], v[92:95]
    ds_read_b128 v[56:59], v249 offset:8192
    s_waitcnt lgkmcnt(10)
    v_mfma_f32_16x16x32_bf16 v[96:99], v[40:43], v[32:35], v[96:99]
    ds_read_b128 v[60:63], v249 offset:9216
    ds_read_b128 v[64:67], v249 offset:10240
    s_waitcnt lgkmcnt(11)
    v_mfma_f32_16x16x32_bf16 v[100:103], v[40:43], v[36:39], v[100:103]
    ds_read_b128 v[68:71], v249 offset:11264
    s_waitcnt lgkmcnt(10)
    v_mfma_f32_16x16x32_bf16 v[104:107], v[44:47], v[24:27], v[104:107]
    ds_read_b64_tr_b16 v[76:77], v253 offset:20480
    ds_read_b64_tr_b16 v[78:79], v253 offset:20992
    v_mfma_f32_16x16x32_bf16 v[108:111], v[44:47], v[28:31], v[108:111]
    ds_read_b64_tr_b16 v[80:81], v252 offset:28672
    v_mfma_f32_16x16x32_bf16 v[112:115], v[44:47], v[32:35], v[112:115]
    ds_read_b64_tr_b16 v[82:83], v252 offset:29184
    ds_read_b64_tr_b16 v[84:85], v253 offset:28672
    v_mfma_f32_16x16x32_bf16 v[116:119], v[44:47], v[36:39], v[116:119]
    ds_read_b64_tr_b16 v[86:87], v253 offset:29184
    s_waitcnt lgkmcnt(14)
    v_mfma_f32_16x16x32_bf16 v[120:123], v[48:51], v[24:27], v[120:123]
    v_mfma_f32_16x16x32_bf16 v[124:127], v[48:51], v[28:31], v[124:127]
    v_mfma_f32_16x16x32_bf16 v[128:131], v[48:51], v[32:35], v[128:131]
    v_mfma_f32_16x16x32_bf16 v[132:135], v[48:51], v[36:39], v[132:135]
    s_waitcnt lgkmcnt(12)
    v_mfma_f32_16x16x32_bf16 v[136:139], v[52:55], v[24:27], v[136:139]
    v_mfma_f32_16x16x32_bf16 v[140:143], v[52:55], v[28:31], v[140:143]
    v_mfma_f32_16x16x32_bf16 v[144:147], v[52:55], v[32:35], v[144:147]
    v_mfma_f32_16x16x32_bf16 v[148:151], v[52:55], v[36:39], v[148:151]
    s_waitcnt lgkmcnt(0)
    s_barrier
    v_mfma_f32_16x16x32_bf16 v[88:91], v[72:75], v[56:59], v[88:91]
    ds_read_b64_tr_b16 v[40:41], v250 offset:16384
    ds_read_b64_tr_b16 v[42:43], v250 offset:16896
    v_mfma_f32_16x16x32_bf16 v[92:95], v[72:75], v[60:63], v[92:95]
    ds_read_b128 v[24:27], v248 offset:0
    v_mfma_f32_16x16x32_bf16 v[96:99], v[72:75], v[64:67], v[96:99]
    ds_read_b128 v[28:31], v248 offset:1024
    v_mfma_f32_16x16x32_bf16 v[100:103], v[72:75], v[68:71], v[100:103]
    ds_read_b128 v[32:35], v248 offset:2048
    v_mfma_f32_16x16x32_bf16 v[104:107], v[76:79], v[56:59], v[104:107]
    ds_read_b128 v[36:39], v248 offset:3072
    v_mfma_f32_16x16x32_bf16 v[108:111], v[76:79], v[60:63], v[108:111]
    ds_read_b64_tr_b16 v[44:45], v251 offset:16384
    ds_read_b64_tr_b16 v[46:47], v251 offset:16896
    v_mfma_f32_16x16x32_bf16 v[112:115], v[76:79], v[64:67], v[112:115]
    ds_read_b64_tr_b16 v[48:49], v250 offset:24576
    v_mfma_f32_16x16x32_bf16 v[116:119], v[76:79], v[68:71], v[116:119]
    ds_read_b64_tr_b16 v[50:51], v250 offset:25088
    v_mfma_f32_16x16x32_bf16 v[120:123], v[80:83], v[56:59], v[120:123]
    ds_read_b64_tr_b16 v[52:53], v251 offset:24576
    v_mfma_f32_16x16x32_bf16 v[124:127], v[80:83], v[60:63], v[124:127]
    ds_read_b64_tr_b16 v[54:55], v251 offset:25088
    v_mfma_f32_16x16x32_bf16 v[128:131], v[80:83], v[64:67], v[128:131]
    v_mfma_f32_16x16x32_bf16 v[132:135], v[80:83], v[68:71], v[132:135]
    v_mfma_f32_16x16x32_bf16 v[136:139], v[84:87], v[56:59], v[136:139]
    v_mfma_f32_16x16x32_bf16 v[140:143], v[84:87], v[60:63], v[140:143]
    v_mfma_f32_16x16x32_bf16 v[144:147], v[84:87], v[64:67], v[144:147]
    v_mfma_f32_16x16x32_bf16 v[148:151], v[84:87], v[68:71], v[148:151]
    s_sub_u32 s34, s34, 1
    s_cmp_lg_u32 s34, 0
    s_cbranch_scc1 L_d
    s_waitcnt lgkmcnt(9)
    v_mfma_f32_16x16x32_bf16 v[88:91], v[40:43], v[24:27], v[88:91]
    ds_read_b64_tr_b16 v[72:73], v250 offset:20480
    ds_read_b64_tr_b16 v[74:75], v250 offset:20992
    s_waitcnt lgkmcnt(10)
    v_mfma_f32_16x16x32_bf16 v[92:95], v[40:43], v[28:31], v[92:95]
    ds_read_b128 v[56:59], v248 offset:8192
    s_waitcnt lgkmcnt(10)
    v_mfma_f32_16x16x32_bf16 v[96:99], v[40:43], v[32:35], v[96:99]
    ds_read_b128 v[60:63], v248 offset:9216
    ds_read_b128 v[64:67], v248 offset:10240
    s_waitcnt lgkmcnt(11)
    v_mfma_f32_16x16x32_bf16 v[100:103], v[40:43], v[36:39], v[100:103]
    ds_read_b128 v[68:71], v248 offset:11264
    s_waitcnt lgkmcnt(10)
    v_mfma_f32_16x16x32_bf16 v[104:107], v[44:47], v[24:27], v[104:107]
    ds_read_b64_tr_b16 v[76:77], v251 offset:20480
    ds_read_b64_tr_b16 v[78:79], v251 offset:20992
    v_mfma_f32_16x16x32_bf16 v[108:111], v[44:47], v[28:31], v[108:111]
    ds_read_b64_tr_b16 v[80:81], v250 offset:28672
    v_mfma_f32_16x16x32_bf16 v[112:115], v[44:47], v[32:35], v[112:115]
    ds_read_b64_tr_b16 v[82:83], v250 offset:29184
    ds_read_b64_tr_b16 v[84:85], v251 offset:28672
    v_mfma_f32_16x16x32_bf16 v[116:119], v[44:47], v[36:39], v[116:119]
    ds_read_b64_tr_b16 v[86:87], v251 offset:29184
    s_waitcnt lgkmcnt(14)
    v_mfma_f32_16x16x32_bf16 v[120:123], v[48:51], v[24:27], v[120:123]
    v_mfma_f32_16x16x32_bf16 v[124:127], v[48:51], v[28:31], v[124:127]
    v_mfma_f32_16x16x32_bf16 v[128:131], v[48:51], v[32:35], v[128:131]
    v_mfma_f32_16x16x32_bf16 v[132:135], v[48:51], v[36:39], v[132:135]
    s_waitcnt lgkmcnt(12)
    v_mfma_f32_16x16x32_bf16 v[136:139], v[52:55], v[24:27], v[136:139]
    v_mfma_f32_16x16x32_bf16 v[140:143], v[52:55], v[28:31], v[140:143]
    v_mfma_f32_16x16x32_bf16 v[144:147], v[52:55], v[32:35], v[144:147]
    v_mfma_f32_16x16x32_bf16 v[148:151], v[52:55], v[36:39], v[148:151]
    s_waitcnt lgkmcnt(0)
    s_barrier
    v_mfma_f32_16x16x32_bf16 v[88:91], v[72:75], v[56:59], v[88:91]
    ds_read_b64_tr_b16 v[40:41], v252 offset:49152
    ds_read_b64_tr_b16 v[42:43], v252 offset:49664
    v_mfma_f32_16x16x32_bf16 v[92:95], v[72:75], v[60:63], v[92:95]
    ds_read_b128 v[24:27], v249 offset:32768
    v_mfma_f32_16x16x32_bf16 v[96:99], v[72:75], v[64:67], v[96:99]
    ds_read_b128 v[28:31], v249 offset:33792
    v_mfma_f32_16x16x32_bf16 v[100:103], v[72:75], v[68:71], v[100:103]
    ds_read_b128 v[32:35], v249 offset:34816
    v_mfma_f32_16x16x32_bf16 v[104:107], v[76:79], v[56:59], v[104:107]
    ds_read_b128 v[36:39], v249 offset:35840
    v_mfma_f32_16x16x32_bf16 v[108:111], v[76:79], v[60:63], v[108:111]
    ds_read_b64_tr_b16 v[44:45], v253 offset:49152
    ds_read_b64_tr_b16 v[46:47], v253 offset:49664
    v_mfma_f32_16x16x32_bf16 v[112:115], v[76:79], v[64:67], v[112:115]
    ds_read_b64_tr_b16 v[48:49], v252 offset:57344
    v_mfma_f32_16x16x32_bf16 v[116:119], v[76:79], v[68:71], v[116:119]
    ds_read_b64_tr_b16 v[50:51], v252 offset:57856
    v_mfma_f32_16x16x32_bf16 v[120:123], v[80:83], v[56:59], v[120:123]
    ds_read_b64_tr_b16 v[52:53], v253 offset:57344
    v_mfma_f32_16x16x32_bf16 v[124:127], v[80:83], v[60:63], v[124:127]
    ds_read_b64_tr_b16 v[54:55], v253 offset:57856
    v_mfma_f32_16x16x32_bf16 v[128:131], v[80:83], v[64:67], v[128:131]
    v_mfma_f32_16x16x32_bf16 v[132:135], v[80:83], v[68:71], v[132:135]
    v_mfma_f32_16x16x32_bf16 v[136:139], v[84:87], v[56:59], v[136:139]
    v_mfma_f32_16x16x32_bf16 v[140:143], v[84:87], v[60:63], v[140:143]
    v_mfma_f32_16x16x32_bf16 v[144:147], v[84:87], v[64:67], v[144:147]
    v_mfma_f32_16x16x32_bf16 v[148:151], v[84:87], v[68:71], v[148:151]
    s_waitcnt lgkmcnt(9)
    v_mfma_f32_16x16x32_bf16 v[88:91], v[40:43], v[24:27], v[88:91]
    ds_read_b64_tr_b16 v[72:73], v252 offset:53248
    ds_read_b64_tr_b16 v[74:75], v252 offset:53760
    s_waitcnt lgkmcnt(10)
    v_mfma_f32_16x16x32_bf16 v[92:95], v[40:43], v[28:31], v[92:95]
    ds_read_b128 v[56:59], v249 offset:40960
    s_waitcnt lgkmcnt(10)
    v_mfma_f32_16x16x32_bf16 v[96:99], v[40:43], v[32:35], v[96:99]
    ds_read_b128 v[60:63], v249 offset:41984
    ds_read_b128 v[64:67], v249 offset:43008
    s_waitcnt lgkmcnt(11)
    v_mfma_f32_16x16x32_bf16 v[100:103], v[40:43], v[36:39], v[100:103]
    ds_read_b128 v[68:71], v249 offset:44032
    s_waitcnt lgkmcnt(10)
    v_mfma_f32_16x16x32_bf16 v[104:107], v[44:47], v[24:27], v[104:107]
    ds_read_b64_tr_b16 v[76:77], v253 offset:53248
    ds_read_b64_tr_b16 v[78:79], v253 offset:53760
    v_mfma_f32_16x16x32_bf16 v[108:111], v[44:47], v[28:31], v[108:111]
    ds_read_b64_tr_b16 v[80:81], v252 offset:61440
    v_mfma_f32_16x16x32_bf16 v[112:115], v[44:47], v[32:35], v[112:115]
    ds_read_b64_tr_b16 v[82:83], v252 offset:61952
    ds_read_b64_tr_b16 v[84:85], v253 offset:61440
    v_mfma_f32_16x16x32_bf16 v[116:119], v[44:47], v[36:39], v[116:119]
    ds_read_b64_tr_b16 v[86:87], v253 offset:61952
    s_waitcnt lgkmcnt(14)
    v_mfma_f32_16x16x32_bf16 v[120:123], v[48:51], v[24:27], v[120:123]
    v_mfma_f32_16x16x32_bf16 v[124:127], v[48:51], v[28:31], v[124:127]
    v_mfma_f32_16x16x32_bf16 v[128:131], v[48:51], v[32:35], v[128:131]
    v_mfma_f32_16x16x32_bf16 v[132:135], v[48:51], v[36:39], v[132:135]
    s_waitcnt lgkmcnt(12)
    v_mfma_f32_16x16x32_bf16 v[136:139], v[52:55], v[24:27], v[136:139]
    v_mfma_f32_16x16x32_bf16 v[140:143], v[52:55], v[28:31], v[140:143]
    v_mfma_f32_16x16x32_bf16 v[144:147], v[52:55], v[32:35], v[144:147]
    v_mfma_f32_16x16x32_bf16 v[148:151], v[52:55], v[36:39], v[148:151]
    s_waitcnt lgkmcnt(0)
    s_barrier
    v_mfma_f32_16x16x32_bf16 v[88:91], v[72:75], v[56:59], v[88:91]
    ds_read_b64_tr_b16 v[40:41], v250 offset:49152
    ds_read_b64_tr_b16 v[42:43], v250 offset:49664
    v_mfma_f32_16x16x32_bf16 v[92:95], v[72:75], v[60:63], v[92:95]
    ds_read_b128 v[24:27], v248 offset:32768
    v_mfma_f32_16x16x32_bf16 v[96:99], v[72:75], v[64:67], v[96:99]
    ds_read_b128 v[28:31], v248 offset:33792
    v_mfma_f32_16x16x32_bf16 v[100:103], v[72:75], v[68:71], v[100:103]
    ds_read_b128 v[32:35], v248 offset:34816
    v_mfma_f32_16x16x32_bf16 v[104:107], v[76:79], v[56:59], v[104:107]
    ds_read_b128 v[36:39], v248 offset:35840
    v_mfma_f32_16x16x32_bf16 v[108:111], v[76:79], v[60:63], v[108:111]
    ds_read_b64_tr_b16 v[44:45], v251 offset:49152
    ds_read_b64_tr_b16 v[46:47], v251 offset:49664
    v_mfma_f32_16x16x32_bf16 v[112:115], v[76:79], v[64:67], v[112:115]
    ds_read_b64_tr_b16 v[48:49], v250 offset:57344
    v_mfma_f32_16x16x32_bf16 v[116:119], v[76:79], v[68:71], v[116:119]
    ds_read_b64_tr_b16 v[50:51], v250 offset:57856
    v_mfma_f32_16x16x32_bf16 v[120:123], v[80:83], v[56:59], v[120:123]
    ds_read_b64_tr_b16 v[52:53], v251 offset:57344
    v_mfma_f32_16x16x32_bf16 v[124:127], v[80:83], v[60:63], v[124:127]
    ds_read_b64_tr_b16 v[54:55], v251 offset:57856
    v_mfma_f32_16x16x32_bf16 v[128:131], v[80:83], v[64:67], v[128:131]
    v_mfma_f32_16x16x32_bf16 v[132:135], v[80:83], v[68:71], v[132:135]
    v_mfma_f32_16x16x32_bf16 v[136:139], v[84:87], v[56:59], v[136:139]
    v_mfma_f32_16x16x32_bf16 v[140:143], v[84:87], v[60:63], v[140:143]
    v_mfma_f32_16x16x32_bf16 v[144:147], v[84:87], v[64:67], v[144:147]
    v_mfma_f32_16x16x32_bf16 v[148:151], v[84:87], v[68:71], v[148:151]
    s_waitcnt lgkmcnt(9)
    v_mfma_f32_16x16x32_bf16 v[88:91], v[40:43], v[24:27], v[88:91]
    ds_read_b64_tr_b16 v[72:73], v250 offset:53248
    ds_read_b64_tr_b16 v[74:75], v250 offset:53760
    s_waitcnt lgkmcnt(10)
    v_mfma_f32_16x16x32_bf16 v[92:95], v[40:43], v[28:31], v[92:95]
    ds_read_b128 v[56:59], v248 offset:40960
    s_waitcnt lgkmcnt(10)
    v_mfma_f32_16x16x32_bf16 v[96:99], v[40:43], v[32:35], v[96:99]
    ds_read_b128 v[60:63], v248 offset:41984
    ds_read_b128 v[64:67], v248 offset:43008
    s_waitcnt lgkmcnt(11)
    v_mfma_f32_16x16x32_bf16 v[100:103], v[40:43], v[36:39], v[100:103]
    ds_read_b128 v[68:71], v248 offset:44032
    s_waitcnt lgkmcnt(10)
    v_mfma_f32_16x16x32_bf16 v[104:107], v[44:47], v[24:27], v[104:107]
    ds_read_b64_tr_b16 v[76:77], v251 offset:53248
    ds_read_b64_tr_b16 v[78:79], v251 offset:53760
    v_mfma_f32_16x16x32_bf16 v[108:111], v[44:47], v[28:31], v[108:111]
    ds_read_b64_tr_b16 v[80:81], v250 offset:61440
    v_mfma_f32_16x16x32_bf16 v[112:115], v[44:47], v[32:35], v[112:115]
    ds_read_b64_tr_b16 v[82:83], v250 offset:61952
    ds_read_b64_tr_b16 v[84:85], v251 offset:61440
    v_mfma_f32_16x16x32_bf16 v[116:119], v[44:47], v[36:39], v[116:119]
    ds_read_b64_tr_b16 v[86:87], v251 offset:61952
    s_waitcnt lgkmcnt(14)
    v_mfma_f32_16x16x32_bf16 v[120:123], v[48:51], v[24:27], v[120:123]
    v_mfma_f32_16x16x32_bf16 v[124:127], v[48:51], v[28:31], v[124:127]
    v_mfma_f32_16x16x32_bf16 v[128:131], v[48:51], v[32:35], v[128:131]
    v_mfma_f32_16x16x32_bf16 v[132:135], v[48:51], v[36:39], v[132:135]
    s_waitcnt lgkmcnt(12)
    v_mfma_f32_16x16x32_bf16 v[136:139], v[52:55], v[24:27], v[136:139]
    v_mfma_f32_16x16x32_bf16 v[140:143], v[52:55], v[28:31], v[140:143]
    v_mfma_f32_16x16x32_bf16 v[144:147], v[52:55], v[32:35], v[144:147]
    v_mfma_f32_16x16x32_bf16 v[148:151], v[52:55], v[36:39], v[148:151]
    s_waitcnt lgkmcnt(0)
    s_barrier
    v_mfma_f32_16x16x32_bf16 v[88:91], v[72:75], v[56:59], v[88:91]
    ds_read_b64_tr_b16 v[40:41], v252 offset:16384
    ds_read_b64_tr_b16 v[42:43], v252 offset:16896
    v_mfma_f32_16x16x32_bf16 v[92:95], v[72:75], v[60:63], v[92:95]
    ds_read_b128 v[24:27], v249 offset:0
    v_mfma_f32_16x16x32_bf16 v[96:99], v[72:75], v[64:67], v[96:99]
    ds_read_b128 v[28:31], v249 offset:1024
    v_mfma_f32_16x16x32_bf16 v[100:103], v[72:75], v[68:71], v[100:103]
    ds_read_b128 v[32:35], v249 offset:2048
    v_mfma_f32_16x16x32_bf16 v[104:107], v[76:79], v[56:59], v[104:107]
    ds_read_b128 v[36:39], v249 offset:3072
    v_mfma_f32_16x16x32_bf16 v[108:111], v[76:79], v[60:63], v[108:111]
    ds_read_b64_tr_b16 v[44:45], v253 offset:16384
    ds_read_b64_tr_b16 v[46:47], v253 offset:16896
    v_mfma_f32_16x16x32_bf16 v[112:115], v[76:79], v[64:67], v[112:115]
    ds_read_b64_tr_b16 v[48:49], v252 offset:24576
    v_mfma_f32_16x16x32_bf16 v[116:119], v[76:79], v[68:71], v[116:119]
    ds_read_b64_tr_b16 v[50:51], v252 offset:25088
    v_mfma_f32_16x16x32_bf16 v[120:123], v[80:83], v[56:59], v[120:123]
    ds_read_b64_tr_b16 v[52:53], v253 offset:24576
    v_mfma_f32_16x16x32_bf16 v[124:127], v[80:83], v[60:63], v[124:127]
    ds_read_b64_tr_b16 v[54:55], v253 offset:25088
    v_mfma_f32_16x16x32_bf16 v[128:131], v[80:83], v[64:67], v[128:131]
    v_mfma_f32_16x16x32_bf16 v[132:135], v[80:83], v[68:71], v[132:135]
    v_mfma_f32_16x16x32_bf16 v[136:139], v[84:87], v[56:59], v[136:139]
    v_mfma_f32_16x16x32_bf16 v[140:143], v[84:87], v[60:63], v[140:143]
    v_mfma_f32_16x16x32_bf16 v[144:147], v[84:87], v[64:67], v[144:147]
    v_mfma_f32_16x16x32_bf16 v[148:151], v[84:87], v[68:71], v[148:151]
    s_waitcnt lgkmcnt(9)
    v_mfma_f32_16x16x32_bf16 v[88:91], v[40:43], v[24:27], v[88:91]
    ds_read_b64_tr_b16 v[72:73], v252 offset:20480
    ds_read_b64_tr_b16 v[74:75], v252 offset:20992
    s_waitcnt lgkmcnt(10)
    v_mfma_f32_16x16x32_bf16 v[92:95], v[40:43], v[28:31], v[92:95]
    ds_read_b128 v[56:59], v249 offset:8192
    s_waitcnt lgkmcnt(10)
    v_mfma_f32_16x16x32_bf16 v[96:99], v[40:43], v[32:35], v[96:99]
    ds_read_b128 v[60:63], v249 offset:9216
    ds_read_b128 v[64:67], v249 offset:10240
    s_waitcnt lgkmcnt(11)
    v_mfma_f32_16x16x32_bf16 v[100:103], v[40:43], v[36:39], v[100:103]
    ds_read_b128 v[68:71], v249 offset:11264
    s_waitcnt lgkmcnt(10)
    v_mfma_f32_16x16x32_bf16 v[104:107], v[44:47], v[24:27], v[104:107]
    ds_read_b64_tr_b16 v[76:77], v253 offset:20480
    ds_read_b64_tr_b16 v[78:79], v253 offset:20992
    v_mfma_f32_16x16x32_bf16 v[108:111], v[44:47], v[28:31], v[108:111]
    ds_read_b64_tr_b16 v[80:81], v252 offset:28672
    v_mfma_f32_16x16x32_bf16 v[112:115], v[44:47], v[32:35], v[112:115]
    ds_read_b64_tr_b16 v[82:83], v252 offset:29184
    ds_read_b64_tr_b16 v[84:85], v253 offset:28672
    v_mfma_f32_16x16x32_bf16 v[116:119], v[44:47], v[36:39], v[116:119]
    ds_read_b64_tr_b16 v[86:87], v253 offset:29184
    s_waitcnt lgkmcnt(14)
    v_mfma_f32_16x16x32_bf16 v[120:123], v[48:51], v[24:27], v[120:123]
    v_mfma_f32_16x16x32_bf16 v[124:127], v[48:51], v[28:31], v[124:127]
    v_mfma_f32_16x16x32_bf16 v[128:131], v[48:51], v[32:35], v[128:131]
    v_mfma_f32_16x16x32_bf16 v[132:135], v[48:51], v[36:39], v[132:135]
    s_waitcnt lgkmcnt(12)
    v_mfma_f32_16x16x32_bf16 v[136:139], v[52:55], v[24:27], v[136:139]
    v_mfma_f32_16x16x32_bf16 v[140:143], v[52:55], v[28:31], v[140:143]
    v_mfma_f32_16x16x32_bf16 v[144:147], v[52:55], v[32:35], v[144:147]
    v_mfma_f32_16x16x32_bf16 v[148:151], v[52:55], v[36:39], v[148:151]
    s_waitcnt lgkmcnt(0)
    s_barrier
    v_mfma_f32_16x16x32_bf16 v[88:91], v[72:75], v[56:59], v[88:91]
    v_mfma_f32_16x16x32_bf16 v[92:95], v[72:75], v[60:63], v[92:95]
    v_mfma_f32_16x16x32_bf16 v[96:99], v[72:75], v[64:67], v[96:99]
    v_mfma_f32_16x16x32_bf16 v[100:103], v[72:75], v[68:71], v[100:103]
    v_mfma_f32_16x16x32_bf16 v[104:107], v[76:79], v[56:59], v[104:107]
    v_mfma_f32_16x16x32_bf16 v[108:111], v[76:79], v[60:63], v[108:111]
    v_mfma_f32_16x16x32_bf16 v[112:115], v[76:79], v[64:67], v[112:115]
    v_mfma_f32_16x16x32_bf16 v[116:119], v[76:79], v[68:71], v[116:119]
    v_mfma_f32_16x16x32_bf16 v[120:123], v[80:83], v[56:59], v[120:123]
    v_mfma_f32_16x16x32_bf16 v[124:127], v[80:83], v[60:63], v[124:127]
    v_mfma_f32_16x16x32_bf16 v[128:131], v[80:83], v[64:67], v[128:131]
    v_mfma_f32_16x16x32_bf16 v[132:135], v[80:83], v[68:71], v[132:135]
    v_mfma_f32_16x16x32_bf16 v[136:139], v[84:87], v[56:59], v[136:139]
    v_mfma_f32_16x16x32_bf16 v[140:143], v[84:87], v[60:63], v[140:143]
    v_mfma_f32_16x16x32_bf16 v[144:147], v[84:87], v[64:67], v[144:147]
    v_mfma_f32_16x16x32_bf16 v[148:151], v[84:87], v[68:71], v[148:151]
    s_setprio 0
    s_nop 7
    buffer_store_dwordx4 v[120:123], v4, s[68:71], s36 offen offset:0 sc1
    buffer_store_dwordx4 v[124:127], v4, s[68:71], s36 offen offset:1024 sc1
    buffer_store_dwordx4 v[128:131], v4, s[68:71], s36 offen offset:2048 sc1
    buffer_store_dwordx4 v[132:135], v4, s[68:71], s36 offen offset:3072 sc1
    buffer_store_dwordx4 v[136:139], v4, s[68:71], s37 offen offset:0 sc1
    buffer_store_dwordx4 v[140:143], v4, s[68:71], s37 offen offset:1024 sc1
    buffer_store_dwordx4 v[144:147], v4, s[68:71], s37 offen offset:2048 sc1
    buffer_store_dwordx4 v[148:151], v4, s[68:71], s37 offen offset:3072 sc1
    s_lshl2_add_u32 m0, s33, 65536
    s_nop 0
    buffer_load_dwordx4 v18, s[40:43], s76 offen offset:0 sc1 lds
    buffer_load_dwordx4 v18, s[40:43], s76 offen offset:1024 sc1 lds
    buffer_load_dwordx4 v18, s[40:43], s76 offen offset:2048 sc1 lds
    buffer_load_dwordx4 v18, s[40:43], s76 offen offset:3072 sc1 lds
    s_add_u32 s76, s76, 16384
    s_lshl1_add_u32 m0, s33, 81920
    s_nop 0
    buffer_load_dwordx4 v254, s[44:47], s77 offen lds
    s_lshl1_add_u32 m0, s33, 82944
    s_nop 0
    buffer_load_dwordx4 v255, s[44:47], s77 offen lds
    s_add_u32 s77, s77, 131072
    s_barrier
    s_lshl_b32 m0, s33, 2
    s_nop 0
    buffer_load_dwordx4 v18, s[40:43], s76 offen offset:0 sc1 lds
    buffer_load_dwordx4 v18, s[40:43], s76 offen offset:1024 sc1 lds
    buffer_load_dwordx4 v18, s[40:43], s76 offen offset:2048 sc1 lds
    buffer_load_dwordx4 v18, s[40:43], s76 offen offset:3072 sc1 lds
    s_add_u32 s76, s76, 16384
    s_lshl1_add_u32 m0, s33, 16384
    s_nop 0
    buffer_load_dwordx4 v254, s[44:47], s77 offen lds
    s_lshl1_add_u32 m0, s33, 17408
    s_nop 0
    buffer_load_dwordx4 v255, s[44:47], s77 offen lds
    s_add_u32 s77, s77, 131072
    s_barrier
    s_lshl2_add_u32 m0, s33, 98304
    s_nop 0
    buffer_load_dwordx4 v18, s[40:43], s76 offen offset:0 sc1 lds
    buffer_load_dwordx4 v18, s[40:43], s76 offen offset:1024 sc1 lds
    buffer_load_dwordx4 v18, s[40:43], s76 offen offset:2048 sc1 lds
    buffer_load_dwordx4 v18, s[40:43], s76 offen offset:3072 sc1 lds
    s_add_u32 s76, s76, 16384
    s_lshl1_add_u32 m0, s33, 114688
    s_nop 0
    buffer_load_dwordx4 v254, s[44:47], s77 offen lds
    s_lshl1_add_u32 m0, s33, 115712
    s_nop 0
    buffer_load_dwordx4 v255, s[44:47], s77 offen lds
    s_add_u32 s77, s77, 131072
    s_waitcnt vmcnt(12)
    s_barrier
    s_lshl2_add_u32 m0, s33, 32768
    s_nop 0
    buffer_load_dwordx4 v18, s[40:43], s76 offen offset:0 sc1 lds
    buffer_load_dwordx4 v18, s[40:43], s76 offen offset:1024 sc1 lds
    buffer_load_dwordx4 v18, s[40:43], s76 offen offset:2048 sc1 lds
    buffer_load_dwordx4 v18, s[40:43], s76 offen offset:3072 sc1 lds
    s_add_u32 s76, s76, 16384
    s_lshl1_add_u32 m0, s33, 49152
    s_nop 0
    buffer_load_dwordx4 v254, s[44:47], s77 offen lds
    s_lshl1_add_u32 m0, s33, 50176
    s_nop 0
    buffer_load_dwordx4 v255, s[44:47], s77 offen lds
    s_add_u32 s77, s77, 131072
    s_waitcnt vmcnt(12)
    s_barrier
    s_lshl2_add_u32 m0, s33, 65536
    s_nop 0
    buffer_load_dwordx4 v18, s[40:43], s76 offen offset:0 sc1 lds
    buffer_load_dwordx4 v18, s[40:43], s76 offen offset:1024 sc1 lds
    buffer_load_dwordx4 v18, s[40:43], s76 offen offset:2048 sc1 lds
    buffer_load_dwordx4 v18, s[40:43], s76 offen offset:3072 sc1 lds
    s_add_u32 s76, s76, 16384
    s_lshl1_add_u32 m0, s33, 81920
    s_nop 0
    buffer_load_dwordx4 v254, s[44:47], s77 offen lds
    s_lshl1_add_u32 m0, s33, 82944
    s_nop 0
    buffer_load_dwordx4 v255, s[44:47], s77 offen lds
    s_add_u32 s77, s77, 131072
    s_waitcnt vmcnt(30)
    s_waitcnt vmcnt(12)
    s_barrier
    s_lshl_b32 m0, s33, 2
    s_nop 0
    buffer_load_dwordx4 v18, s[40:43], s76 offen offset:0 sc1 lds
    buffer_load_dwordx4 v18, s[40:43], s76 offen offset:1024 sc1 lds
    buffer_load_dwordx4 v18, s[40:43], s76 offen offset:2048 sc1 lds
    buffer_load_dwordx4 v18, s[40:43], s76 offen offset:3072 sc1 lds
    s_add_u32 s76, s76, 16384
    s_lshl1_add_u32 m0, s33, 16384
    s_nop 0
    buffer_load_dwordx4 v254, s[44:47], s77 offen lds
    s_lshl1_add_u32 m0, s33, 17408
    s_nop 0
    buffer_load_dwordx4 v255, s[44:47], s77 offen lds
    s_add_u32 s77, s77, 131072
    s_cmp_lg_u32 s4, 0
    s_cbranch_scc1 L_fP
    s_lshl_b32 s91, s28, 4
    s_add_u32 s91, s91, s29
    s_lshl_b32 s91, s91, 7
    s_add_u32 s91, s91, 0x1ea0000
    v_mov_b32 v12, s91
    v_mov_b32 v14, s100
    v_mov_b32 v15, s101
    s_mov_b64 exec, 1
    global_store_dwordx2 v12, v[14:15], s[26:27] sc1
    s_mov_b64 exec, -1
L_fP:
    s_xor_b32 s91, s28, 8
    s_lshl_b32 s91, s91, 4
    s_add_u32 s91, s91, s29
    s_lshl_b32 s91, s91, 7
    s_add_u32 s91, s91, 0x1ea0000
    v_mov_b32 v13, s91
    s_waitcnt vmcnt(12)
    s_barrier
    s_lshl2_add_u32 m0, s33, 98304
    s_nop 0
    buffer_load_dwordx4 v18, s[40:43], s76 offen offset:0 sc1 lds
    buffer_load_dwordx4 v18, s[40:43], s76 offen offset:1024 sc1 lds
    buffer_load_dwordx4 v18, s[40:43], s76 offen offset:2048 sc1 lds
    buffer_load_dwordx4 v18, s[40:43], s76 offen offset:3072 sc1 lds
    s_add_u32 s76, s76, 16384
    s_lshl1_add_u32 m0, s33, 114688
    s_nop 0
    buffer_load_dwordx4 v254, s[44:47], s77 offen lds
    s_lshl1_add_u32 m0, s33, 115712
    s_nop 0
    buffer_load_dwordx4 v255, s[44:47], s77 offen lds
    s_add_u32 s77, s77, 131072
    s_waitcnt vmcnt(12)
    s_barrier
    s_lshl2_add_u32 m0, s33, 32768
    s_nop 0
    buffer_load_dwordx4 v18, s[40:43], s76 offen offset:0 sc1 lds
    buffer_load_dwordx4 v18, s[40:43], s76 offen offset:1024 sc1 lds
    buffer_load_dwordx4 v18, s[40:43], s76 offen offset:2048 sc1 lds
    buffer_load_dwordx4 v18, s[40:43], s76 offen offset:3072 sc1 lds
    s_add_u32 s76, s76, 16384
    s_lshl1_add_u32 m0, s33, 49152
    s_nop 0
    buffer_load_dwordx4 v254, s[44:47], s77 offen lds
    s_lshl1_add_u32 m0, s33, 50176
    s_nop 0
    buffer_load_dwordx4 v255, s[44:47], s77 offen lds
    s_add_u32 s77, s77, 131072
    global_load_dwordx2 v[14:15], v13, s[26:27] sc1
    s_waitcnt vmcnt(13)
    s_barrier
    s_lshl2_add_u32 m0, s33, 65536
    s_nop 0
    buffer_load_dwordx4 v18, s[40:43], s76 offen offset:0 sc1 lds
    buffer_load_dwordx4 v18, s[40:43], s76 offen offset:1024 sc1 lds
    buffer_load_dwordx4 v18, s[40:43], s76 offen offset:2048 sc1 lds
    buffer_load_dwordx4 v18, s[40:43], s76 offen offset:3072 sc1 lds
    s_add_u32 s76, s76, 16384
    s_lshl1_add_u32 m0, s33, 81920
    s_nop 0
    buffer_load_dwordx4 v254, s[44:47], s77 offen lds
    s_lshl1_add_u32 m0, s33, 82944
    s_nop 0
    buffer_load_dwordx4 v255, s[44:47], s77 offen lds
    s_add_u32 s77, s77, 131072
    s_waitcnt vmcnt(6)
    s_movk_i32 s98, 0x4000
L_pP_chk:
    v_cmp_ne_u64 vcc, s[100:101], v[14:15]
    s_nop 1
    s_cmp_eq_u64 vcc, 0
    s_cbranch_scc1 L_pP_ok
    s_sub_u32 s98, s98, 1
    s_cbranch_scc1 L_pP_ok
    s_sleep 1
    global_load_dwordx2 v[14:15], v13, s[26:27] sc1
    s_waitcnt vmcnt(0)
    s_branch L_pP_chk
L_pP_ok:
    buffer_load_dwordx4 v[152:155], v4, s[68:71], s38 offen offset:0 sc1
    buffer_load_dwordx4 v[156:159], v4, s[68:71], s38 offen offset:1024 sc1
    buffer_load_dwordx4 v[160:163], v4, s[68:71], s38 offen offset:2048 sc1
    buffer_load_dwordx4 v[164:167], v4, s[68:71], s38 offen offset:3072 sc1
    buffer_load_dwordx4 v[168:171], v4, s[68:71], s39 offen offset:0 sc1
    buffer_load_dwordx4 v[172:175], v4, s[68:71], s39 offen offset:1024 sc1
    buffer_load_dwordx4 v[176:179], v4, s[68:71], s39 offen offset:2048 sc1
    buffer_load_dwordx4 v[180:183], v4, s[68:71], s39 offen offset:3072 sc1
    s_waitcnt vmcnt(21)
    s_barrier
    s_lshl_b32 m0, s33, 2
    s_nop 0
    buffer_load_dwordx4 v18, s[40:43], s76 offen offset:0 sc1 lds
    buffer_load_dwordx4 v18, s[40:43], s76 offen offset:1024 sc1 lds
    buffer_load_dwordx4 v18, s[40:43], s76 offen offset:2048 sc1 lds
    buffer_load_dwordx4 v18, s[40:43], s76 offen offset:3072 sc1 lds
    s_add_u32 s76, s76, 16384
    s_lshl1_add_u32 m0, s33, 16384
    s_nop 0
    buffer_load_dwordx4 v254, s[44:47], s77 offen lds
    s_lshl1_add_u32 m0, s33, 17408
    s_nop 0
    buffer_load_dwordx4 v255, s[44:47], s77 offen lds
    s_add_u32 s77, s77, 131072
    s_waitcnt vmcnt(21)
    s_barrier
    s_lshl2_add_u32 m0, s33, 98304
    s_nop 0
    buffer_load_dwordx4 v18, s[40:43], s76 offen offset:0 sc1 lds
    buffer_load_dwordx4 v18, s[40:43], s76 offen offset:1024 sc1 lds
    buffer_load_dwordx4 v18, s[40:43], s76 offen offset:2048 sc1 lds
    buffer_load_dwordx4 v18, s[40:43], s76 offen offset:3072 sc1 lds
    s_add_u32 s76, s76, 16384
    s_lshl1_add_u32 m0, s33, 114688
    s_nop 0
    buffer_load_dwordx4 v254, s[44:47], s77 offen lds
    s_lshl1_add_u32 m0, s33, 115712
    s_nop 0
    buffer_load_dwordx4 v255, s[44:47], s77 offen lds
    s_add_u32 s77, s77, 131072
    s_waitcnt vmcnt(20)
    s_barrier
    s_lshl2_add_u32 m0, s33, 32768
    s_nop 0
    buffer_load_dwordx4 v18, s[40:43], s76 offen offset:0 sc1 lds
    s_waitcnt vmcnt(20)
    v_add_f32 v88, v88, v152
    v_add_f32 v89, v89, v153
    v_add_f32 v90, v90, v154
    v_add_f32 v91, v91, v155
    v_cvt_pk_bf16_f32 v28, v88, v89
    v_cvt_pk_bf16_f32 v29, v90, v91
    v_lshlrev_b32 v88, 16, v28
    v_and_b32 v89, 0xffff0000, v28
    v_lshlrev_b32 v90, 16, v29
    v_and_b32 v91, 0xffff0000, v29
    v_mul_f32 v24, 0xbfb8aa3b, v88
    v_mul_f32 v25, 0xbfb8aa3b, v89
    v_mul_f32 v26, 0xbfb8aa3b, v90
    v_mul_f32 v27, 0xbfb8aa3b, v91
    v_exp_f32 v24, v24
    buffer_load_dwordx4 v18, s[40:43], s76 offen offset:1024 sc1 lds
    v_exp_f32 v25, v25
    v_exp_f32 v26, v26
    v_exp_f32 v27, v27
    s_nop 0
    v_add_f32 v24, 1.0, v24
    v_add_f32 v25, 1.0, v25
    v_add_f32 v26, 1.0, v26
    v_add_f32 v27, 1.0, v27
    v_rcp_f32 v24, v24
    v_rcp_f32 v25, v25
    v_rcp_f32 v26, v26
    buffer_load_dwordx4 v18, s[40:43], s76 offen offset:2048 sc1 lds
    v_rcp_f32 v27, v27
    s_nop 0
    v_mul_f32 v24, v24, v88
    v_mul_f32 v25, v25, v89
    v_mul_f32 v26, v26, v90
    v_mul_f32 v27, v27, v91
    v_cvt_pk_bf16_f32 v88, v24, v25
    v_cvt_pk_bf16_f32 v89, v26, v27
    buffer_load_dwordx4 v18, s[40:43], s76 offen offset:3072 sc1 lds
    s_add_u32 s76, s76, 16384
    ds_write_b64 v5, v[88:89] offset:0
    s_waitcnt vmcnt(22)
    v_add_f32 v92, v92, v156
    v_add_f32 v93, v93, v157
    v_add_f32 v94, v94, v158
    v_add_f32 v95, v95, v159
    v_cvt_pk_bf16_f32 v28, v92, v93
    v_cvt_pk_bf16_f32 v29, v94, v95
    v_lshlrev_b32 v92, 16, v28
    v_and_b32 v93, 0xffff0000, v28
    v_lshlrev_b32 v94, 16, v29
    v_and_b32 v95, 0xffff0000, v29
    v_mul_f32 v24, 0xbfb8aa3b, v92
    v_mul_f32 v25, 0xbfb8aa3b, v93
    v_mul_f32 v26, 0xbfb8aa3b, v94
    v_mul_f32 v27, 0xbfb8aa3b, v95
    v_exp_f32 v24, v24
    s_lshl1_add_u32 m0, s33, 49152
    s_nop 0
    buffer_load_dwordx4 v254, s[44:47], s77 offen lds
    v_exp_f32 v25, v25
    v_exp_f32 v26, v26
    v_exp_f32 v27, v27
    s_nop 0
    v_add_f32 v24, 1.0, v24
    v_add_f32 v25, 1.0, v25
    v_add_f32 v26, 1.0, v26
    v_add_f32 v27, 1.0, v27
    v_rcp_f32 v24, v24
    v_rcp_f32 v25, v25
    v_rcp_f32 v26, v26
    s_lshl1_add_u32 m0, s33, 50176
    s_nop 0
    buffer_load_dwordx4 v255, s[44:47], s77 offen lds
    s_add_u32 s77, s77, 131072
    v_rcp_f32 v27, v27
    s_nop 0
    v_mul_f32 v24, v24, v92
    v_mul_f32 v25, v25, v93
    v_mul_f32 v26, v26, v94
    v_mul_f32 v27, v27, v95
    v_cvt_pk_bf16_f32 v92, v24, v25
    v_cvt_pk_bf16_f32 v93, v26, v27
    s_waitcnt vmcnt(12)
    s_barrier
    s_lshl2_add_u32 m0, s33, 65536
    s_nop 0
    buffer_load_dwordx4 v18, s[40:43], s76 offen offset:0 sc1 lds
    ds_write_b64 v5, v[92:93] offset:512
    s_waitcnt vmcnt(24)
    v_add_f32 v96, v96, v160
    v_add_f32 v97, v97, v161
    v_add_f32 v98, v98, v162
    v_add_f32 v99, v99, v163
    v_cvt_pk_bf16_f32 v28, v96, v97
    v_cvt_pk_bf16_f32 v29, v98, v99
    v_lshlrev_b32 v96, 16, v28
    v_and_b32 v97, 0xffff0000, v28
    v_lshlrev_b32 v98, 16, v29
    v_and_b32 v99, 0xffff0000, v29
    v_mul_f32 v24, 0xbfb8aa3b, v96
    v_mul_f32 v25, 0xbfb8aa3b, v97
    v_mul_f32 v26, 0xbfb8aa3b, v98
    v_mul_f32 v27, 0xbfb8aa3b, v99
    v_exp_f32 v24, v24
    buffer_load_dwordx4 v18, s[40:43], s76 offen offset:1024 sc1 lds
    v_exp_f32 v25, v25
    v_exp_f32 v26, v26
    v_exp_f32 v27, v27
    s_nop 0
    v_add_f32 v24, 1.0, v24
    v_add_f32 v25, 1.0, v25
    v_add_f32 v26, 1.0, v26
    v_add_f32 v27, 1.0, v27
    v_rcp_f32 v24, v24
    v_rcp_f32 v25, v25
    v_rcp_f32 v26, v26
    buffer_load_dwordx4 v18, s[40:43], s76 offen offset:2048 sc1 lds
    v_rcp_f32 v27, v27
    s_nop 0
    v_mul_f32 v24, v24, v96
    v_mul_f32 v25, v25, v97
    v_mul_f32 v26, v26, v98
    v_mul_f32 v27, v27, v99
    v_cvt_pk_bf16_f32 v96, v24, v25
    v_cvt_pk_bf16_f32 v97, v26, v27
    buffer_load_dwordx4 v18, s[40:43], s76 offen offset:3072 sc1 lds
    s_add_u32 s76, s76, 16384
    ds_write_b64 v5, v[96:97] offset:1024
    s_waitcnt vmcnt(26)
    v_add_f32 v100, v100, v164
    v_add_f32 v101, v101, v165
    v_add_f32 v102, v102, v166
    v_add_f32 v103, v103, v167
    v_cvt_pk_bf16_f32 v28, v100, v101
    v_cvt_pk_bf16_f32 v29, v102, v103
    v_lshlrev_b32 v100, 16, v28
    v_and_b32 v101, 0xffff0000, v28
    v_lshlrev_b32 v102, 16, v29
    v_and_b32 v103, 0xffff0000, v29
    v_mul_f32 v24, 0xbfb8aa3b, v100
    v_mul_f32 v25, 0xbfb8aa3b, v101
    v_mul_f32 v26, 0xbfb8aa3b, v102
    v_mul_f32 v27, 0xbfb8aa3b, v103
    v_exp_f32 v24, v24
    s_lshl1_add_u32 m0, s33, 81920
    s_nop 0
    buffer_load_dwordx4 v254, s[44:47], s77 offen lds
    v_exp_f32 v25, v25
    v_exp_f32 v26, v26
    v_exp_f32 v27, v27
    s_nop 0
    v_add_f32 v24, 1.0, v24
    v_add_f32 v25, 1.0, v25
    v_add_f32 v26, 1.0, v26
    v_add_f32 v27, 1.0, v27
    v_rcp_f32 v24, v24
    v_rcp_f32 v25, v25
    v_rcp_f32 v26, v26
    s_lshl1_add_u32 m0, s33, 82944
    s_nop 0
    buffer_load_dwordx4 v255, s[44:47], s77 offen lds
    s_add_u32 s77, s77, 131072
    v_rcp_f32 v27, v27
    s_nop 0
    v_mul_f32 v24, v24, v100
    v_mul_f32 v25, v25, v101
    v_mul_f32 v26, v26, v102
    v_mul_f32 v27, v27, v103
    v_cvt_pk_bf16_f32 v100, v24, v25
    v_cvt_pk_bf16_f32 v101, v26, v27
    s_waitcnt vmcnt(12)
    s_barrier
    ds_write_b64 v5, v[100:101] offset:1536
    s_waitcnt vmcnt(27)
    v_add_f32 v104, v104, v168
    v_add_f32 v105, v105, v169
    v_add_f32 v106, v106, v170
    v_add_f32 v107, v107, v171
    v_cvt_pk_bf16_f32 v28, v104, v105
    v_cvt_pk_bf16_f32 v29, v106, v107
    v_lshlrev_b32 v104, 16, v28
    v_and_b32 v105, 0xffff0000, v28
    v_lshlrev_b32 v106, 16, v29
    v_and_b32 v107, 0xffff0000, v29
    v_mul_f32 v24, 0xbfb8aa3b, v104
    v_mul_f32 v25, 0xbfb8aa3b, v105
    v_mul_f32 v26, 0xbfb8aa3b, v106
    v_mul_f32 v27, 0xbfb8aa3b, v107
    v_exp_f32 v24, v24
    v_exp_f32 v25, v25
    v_exp_f32 v26, v26
    v_exp_f32 v27, v27
    s_nop 0
    v_add_f32 v24, 1.0, v24
    v_add_f32 v25, 1.0, v25
    v_add_f32 v26, 1.0, v26
    v_add_f32 v27, 1.0, v27
    v_rcp_f32 v24, v24
    v_rcp_f32 v25, v25
    v_rcp_f32 v26, v26
    v_rcp_f32 v27, v27
    s_nop 0
    v_mul_f32 v24, v24, v104
    v_mul_f32 v25, v25, v105
    v_mul_f32 v26, v26, v106
    v_mul_f32 v27, v27, v107
    v_cvt_pk_bf16_f32 v104, v24, v25
    v_cvt_pk_bf16_f32 v105, v26, v27
    ds_write_b64 v5, v[104:105] offset:2048
    s_waitcnt vmcnt(26)
    v_add_f32 v108, v108, v172
    v_add_f32 v109, v109, v173
    v_add_f32 v110, v110, v174
    v_add_f32 v111, v111, v175
    v_cvt_pk_bf16_f32 v28, v108, v109
    v_cvt_pk_bf16_f32 v29, v110, v111
    v_lshlrev_b32 v108, 16, v28
    v_and_b32 v109, 0xffff0000, v28
    v_lshlrev_b32 v110, 16, v29
    v_and_b32 v111, 0xffff0000, v29
    v_mul_f32 v24, 0xbfb8aa3b, v108
    v_mul_f32 v25, 0xbfb8aa3b, v109
    v_mul_f32 v26, 0xbfb8aa3b, v110
    v_mul_f32 v27, 0xbfb8aa3b, v111
    v_exp_f32 v24, v24
    v_exp_f32 v25, v25
    v_exp_f32 v26, v26
    v_exp_f32 v27, v27
    s_nop 0
    v_add_f32 v24, 1.0, v24
    v_add_f32 v25, 1.0, v25
    v_add_f32 v26, 1.0, v26
    v_add_f32 v27, 1.0, v27
    v_rcp_f32 v24, v24
    v_rcp_f32 v25, v25
    v_rcp_f32 v26, v26
    v_rcp_f32 v27, v27
    s_nop 0
    v_mul_f32 v24, v24, v108
    v_mul_f32 v25, v25, v109
    v_mul_f32 v26, v26, v110
    v_mul_f32 v27, v27, v111
    v_cvt_pk_bf16_f32 v108, v24, v25
    v_cvt_pk_bf16_f32 v109, v26, v27
    s_waitcnt vmcnt(6)
    s_barrier
    ds_write_b64 v5, v[108:109] offset:2560
    s_waitcnt vmcnt(25)
    v_add_f32 v112, v112, v176
    v_add_f32 v113, v113, v177
    v_add_f32 v114, v114, v178
    v_add_f32 v115, v115, v179
    v_cvt_pk_bf16_f32 v28, v112, v113
    v_cvt_pk_bf16_f32 v29, v114, v115
    v_lshlrev_b32 v112, 16, v28
    v_and_b32 v113, 0xffff0000, v28
    v_lshlrev_b32 v114, 16, v29
    v_and_b32 v115, 0xffff0000, v29
    v_mul_f32 v24, 0xbfb8aa3b, v112
    v_mul_f32 v25, 0xbfb8aa3b, v113
    v_mul_f32 v26, 0xbfb8aa3b, v114
    v_mul_f32 v27, 0xbfb8aa3b, v115
    v_exp_f32 v24, v24
    v_exp_f32 v25, v25
    v_exp_f32 v26, v26
    v_exp_f32 v27, v27
    s_nop 0
    v_add_f32 v24, 1.0, v24
    v_add_f32 v25, 1.0, v25
    v_add_f32 v26, 1.0, v26
    v_add_f32 v27, 1.0, v27
    v_rcp_f32 v24, v24
    v_rcp_f32 v25, v25
    v_rcp_f32 v26, v26
    v_rcp_f32 v27, v27
    s_nop 0
    v_mul_f32 v24, v24, v112
    v_mul_f32 v25, v25, v113
    v_mul_f32 v26, v26, v114
    v_mul_f32 v27, v27, v115
    v_cvt_pk_bf16_f32 v112, v24, v25
    v_cvt_pk_bf16_f32 v113, v26, v27
    ds_write_b64 v5, v[112:113] offset:3072
    s_waitcnt vmcnt(24)
    v_add_f32 v116, v116, v180
    v_add_f32 v117, v117, v181
    v_add_f32 v118, v118, v182
    v_add_f32 v119, v119, v183
    v_cvt_pk_bf16_f32 v28, v116, v117
    v_cvt_pk_bf16_f32 v29, v118, v119
    v_lshlrev_b32 v116, 16, v28
    v_and_b32 v117, 0xffff0000, v28
    v_lshlrev_b32 v118, 16, v29
    v_and_b32 v119, 0xffff0000, v29
    v_mul_f32 v24, 0xbfb8aa3b, v116
    v_mul_f32 v25, 0xbfb8aa3b, v117
    v_mul_f32 v26, 0xbfb8aa3b, v118
    v_mul_f32 v27, 0xbfb8aa3b, v119
    v_exp_f32 v24, v24
    v_exp_f32 v25, v25
    v_exp_f32 v26, v26
    v_exp_f32 v27, v27
    s_nop 0
    v_add_f32 v24, 1.0, v24
    v_add_f32 v25, 1.0, v25
    v_add_f32 v26, 1.0, v26
    v_add_f32 v27, 1.0, v27
    v_rcp_f32 v24, v24
    v_rcp_f32 v25, v25
    v_rcp_f32 v26, v26
    v_rcp_f32 v27, v27
    s_nop 0
    v_mul_f32 v24, v24, v116
    v_mul_f32 v25, v25, v117
    v_mul_f32 v26, v26, v118
    v_mul_f32 v27, v27, v119
    v_cvt_pk_bf16_f32 v116, v24, v25
    v_cvt_pk_bf16_f32 v117, v26, v27
    s_waitcnt vmcnt(0)
    s_barrier
    ds_write_b64 v5, v[116:117] offset:3584
    s_waitcnt lgkmcnt(0)
    s_barrier
    s_branch L_fin
L_teamB:
    s_setprio 3
    v_lshrrev_b32 v64, 4, v1
    v_bfe_u32 v65, v1, 2, 2
    v_and_b32 v66, 3, v1
    v_and_b32 v67, 15, v1
    v_lshrrev_b32 v68, 3, v1
    v_and_b32 v69, 7, v1
    s_lshl_b32 s85, s28, 7
    s_lshl_b32 s86, s4, 5
    s_add_u32 s86, s85, s86
    v_add_u32 v71, s86, v68
    v_xor_b32 v70, v69, v64
    v_lshlrev_b32 v70, 4, v70
    v_lshl_add_u32 v20, v71, 11, v70
    v_xor_b32 v21, 64, v20
    v_add_u32 v21, 16384, v21
    s_lshl_b32 s79, s4, 12
    s_mov_b32 s36, s8
    s_mov_b32 s37, s9
    s_mov_b32 s38, 0x400000
    s_mov_b32 s39, 0x20000
    s_and_b32 s72, s28, 3
    s_lshl2_add_u32 s72, s32, s72
    s_mul_i32 s72, s72, 256
    s_sub_u32 s72, s72, 128
    s_add_u32 m0, s79, 116736
    s_add_u32 s72, s72, 128
    s_and_b32 s78, s72, 0x7ff
    buffer_load_dwordx4 v20, s[36:39], s78 offen lds
    s_add_u32 m0, s79, 117760
    s_nop 0
    buffer_load_dwordx4 v21, s[36:39], s78 offen lds
    s_add_u32 m0, s79, 118784
    s_add_u32 s78, s78, 32768
    buffer_load_dwordx4 v20, s[36:39], s78 offen lds
    s_add_u32 m0, s79, 119808
    s_nop 0
    buffer_load_dwordx4 v21, s[36:39], s78 offen lds
    s_setprio 0
    s_lshl_b32 s85, s4, 3
    s_and_b32 s86, s4, 1
    s_lshl_b32 s86, s86, 2
    v_and_b32 v70, 2, v68
    v_xor_b32 v70, v70, v69
    v_xor_b32 v70, s86, v70
    v_add_u32 v71, s85, v68
    v_mul_u32_u24 v71, 7168, v71
    v_lshl_add_u32 v22, v70, 4, v71
    v_lshrrev_b32 v71, 2, v1
    s_lshl_b32 s86, s86, 2
    v_add_u32 v71, s86, v71
    v_mul_u32_u24 v71, 7168, v71
    v_and_b32 v70, 2, v64
    v_xor_b32 v70, v70, v66
    v_lshl_add_u32 v9, v70, 4, v71
    s_mul_i32 s85, s29, 320
    s_and_b32 s86, s29, 1
    s_lshl_b32 s87, s86, 6
    s_add_u32 s87, s87, s85
    s_add_u32 s40, s16, s87
    s_addc_u32 s41, s17, 0
    s_sub_u32 s42, 7340032, s87
    s_mov_b32 s43, 0x20000
    s_add_u32 s44, s18, s87
    s_addc_u32 s45, s19, 0
    s_sub_u32 s46, 7340032, s87
    s_mov_b32 s47, 0x20000
    s_xor_b32 s86, s86, 1
    s_lshl_b32 s86, s86, 8
    s_add_u32 s87, s86, s85
    s_cmp_lt_u32 s4, 2
    s_cselect_b32 s88, s16, s18
    s_cselect_b32 s89, s17, s19
    s_add_u32 s48, s88, s87
    s_addc_u32 s49, s89, 0
    s_sub_u32 s50, 7340032, s87
    s_mov_b32 s51, 0x20000
    s_and_b32 s77, s28, 3
    s_lshl2_add_u32 s77, s32, s77
    s_mul_i32 s77, s77, 917504
    s_add_u32 s77, s77, 0x38000
    s_add_u32 m0, s79, 135168
    s_add_u32 s72, s72, 128
    s_and_b32 s78, s72, 0x7ff
    buffer_load_dwordx4 v20, s[36:39], s78 offen lds
    s_add_u32 m0, s79, 136192
    s_nop 0
    buffer_load_dwordx4 v21, s[36:39], s78 offen lds
    s_add_u32 m0, s79, 137216
    s_add_u32 s78, s78, 32768
    buffer_load_dwordx4 v20, s[36:39], s78 offen lds
    s_add_u32 m0, s79, 138240
    s_nop 0
    buffer_load_dwordx4 v21, s[36:39], s78 offen lds
    s_add_u32 m0, s33, 57344
    s_add_u32 s77, s77, 229376
    s_cmp_eq_u32 s77, 7340032
    s_cselect_b32 s77, 0, s77
    buffer_load_dwordx4 v22, s[40:43], s77 offen offset:0 lds
    s_add_u32 m0, s33, 61312
    s_nop 0
    buffer_load_dwordx4 v22, s[40:43], s77 offen offset:128 lds
    s_add_u32 m0, s33, 65536
    s_nop 0
    buffer_load_dwordx4 v22, s[44:47], s77 offen offset:0 lds
    s_add_u32 m0, s33, 69504
    s_nop 0
    buffer_load_dwordx4 v22, s[44:47], s77 offen offset:128 lds
    s_add_u32 m0, s33, 73728
    s_nop 0
    buffer_load_dwordx4 v9, s[48:51], s77 offen lds
    s_lshl_b32 s84, s28, 7
    s_lshl_b32 s85, s29, 3
    s_add_u32 s84, s84, s85
    s_lshl1_add_u32 s84, s4, s84
    s_lshl_b32 s90, s84, 3
    s_lshl_b32 s84, s84, 11
    v_lshl_add_u32 v4, v1, 4, s84
    v_and_b32 v70, 1, v67
    v_lshlrev_b32 v70, 4, v70
    v_mov_b32 v71, 0x3f80
    v_lshlrev_b32 v70, v70, v71
    v_lshrrev_b32 v71, 1, v67
    v_cmp_eq_u32 vcc, 0, v71
    s_nop 1
    v_cndmask_b32 v144, 0, v70, vcc
    v_cmp_eq_u32 vcc, 1, v71
    s_nop 1
    v_cndmask_b32 v145, 0, v70, vcc
    v_cmp_eq_u32 vcc, 2, v71
    s_nop 1
    v_cndmask_b32 v146, 0, v70, vcc
    v_cmp_eq_u32 vcc, 3, v71
    s_nop 1
    v_cndmask_b32 v147, 0, v70, vcc
    s_lshl_b32 s91, s4, 12
    s_add_u32 s91, s91, 16384
    v_lshlrev_b32 v70, 1, v64
    v_xor_b32 v71, v69, v70
    v_lshl_add_u32 v71, v71, 4, s91
    v_and_b32 v148, 4, v70
    v_add_u32 v70, v70, v148
    v_and_b32 v148, 1, v68
    v_add_u32 v70, v70, v148
    v_lshl_add_u32 v148, v70, 7, v71
    s_lshl_b32 s91, s5, 11
    s_add_u32 s91, s91, 32768
    v_and_b32 v70, 2, v64
    v_xor_b32 v70, v66, v70
    v_lshl_add_u32 v70, v70, 4, s91
    v_lshrrev_b32 v71, 2, v1
    v_lshl_add_u32 v149, v71, 6, v70
    s_lshl2_add_u32 s91, s2, s4
    s_lshl_b32 s52, s91, 9
    s_lshr_b32 s92, s91, 2
    s_mul_i32 s92, s92, 7168
    s_and_b32 s91, s91, 3
    s_lshl_b32 s91, s91, 9
    s_add_u32 s92, s92, s91
    s_add_u32 s53, s92, 5120
    s_waitcnt vmcnt(9)
    s_barrier
    s_and_b32 s91, s28, 4
    s_cmp_eq_u32 s91, 0
    s_cbranch_scc0 L_cr0
    ds_read_b128 v[112:115], v148 offset:0
    ds_read_b128 v[116:119], v148 offset:512
    ds_read_b128 v[120:123], v148 offset:2048
    ds_read_b128 v[124:127], v148 offset:2560
    ds_read_b128 v[128:131], v149 offset:0
    ds_read_b128 v[132:135], v149 offset:1024
L_cr0:
    s_add_u32 m0, s33, 77824
    s_add_u32 s77, s77, 229376
    buffer_load_dwordx4 v22, s[40:43], s77 offen offset:0 lds
    s_add_u32 m0, s33, 81792
    s_nop 0
    buffer_load_dwordx4 v22, s[40:43], s77 offen offset:128 lds
    s_add_u32 m0, s33, 86016
    s_nop 0
    buffer_load_dwordx4 v22, s[44:47], s77 offen offset:0 lds
    s_add_u32 m0, s33, 89984
    s_nop 0
    buffer_load_dwordx4 v22, s[44:47], s77 offen offset:128 lds
    s_add_u32 m0, s33, 94208
    s_nop 0
    buffer_load_dwordx4 v9, s[48:51], s77 offen lds
    s_add_u32 m0, s79, 98304
    s_add_u32 s72, s72, 128
    s_and_b32 s78, s72, 0x7ff
    buffer_load_dwordx4 v20, s[36:39], s78 offen lds
    s_add_u32 m0, s79, 99328
    s_nop 0
    buffer_load_dwordx4 v21, s[36:39], s78 offen lds
    s_and_b32 s91, s28, 4
    s_cmp_eq_u32 s91, 0
    s_cbranch_scc0 L_cm0
    s_waitcnt lgkmcnt(0)
    s_setprio 2
    v_mfma_f32_16x16x32_bf16 v[136:139], v[144:147], v[112:115], 0
    v_mfma_f32_16x16x32_bf16 v[140:143], v[144:147], v[128:131], 0
    v_mfma_f32_16x16x32_bf16 v[136:139], v[144:147], v[116:119], v[136:139]
    v_mfma_f32_16x16x32_bf16 v[140:143], v[144:147], v[132:135], v[140:143]
    v_mfma_f32_16x16x32_bf16 v[136:139], v[144:147], v[120:123], v[136:139]
    v_mfma_f32_16x16x32_bf16 v[136:139], v[144:147], v[124:127], v[136:139]
    s_setprio 0
L_cm0:
    s_waitcnt vmcnt(16)
    s_barrier
    s_and_b32 s91, s28, 4
    s_cmp_eq_u32 s91, 0
    s_cbranch_scc0 L_cr1
    ds_read_b128 v[112:115], v148 offset:20480
    ds_read_b128 v[116:119], v148 offset:20992
    ds_read_b128 v[120:123], v148 offset:22528
    ds_read_b128 v[124:127], v148 offset:23040
    ds_read_b128 v[128:131], v149 offset:20480
    ds_read_b128 v[132:135], v149 offset:21504
L_cr1:
    s_add_u32 m0, s79, 100352
    s_add_u32 s78, s78, 32768
    buffer_load_dwordx4 v20, s[36:39], s78 offen lds
    s_add_u32 m0, s79, 101376
    s_nop 0
    buffer_load_dwordx4 v21, s[36:39], s78 offen lds
    s_add_u32 m0, s33, 16384
    s_add_u32 s77, s77, 229376
    s_cmp_eq_u32 s77, 7340032
    s_cselect_b32 s77, 0, s77
    buffer_load_dwordx4 v22, s[40:43], s77 offen offset:0 lds
    s_add_u32 m0, s33, 20352
    s_nop 0
    buffer_load_dwordx4 v22, s[40:43], s77 offen offset:128 lds
    s_add_u32 m0, s33, 24576
    s_nop 0
    buffer_load_dwordx4 v22, s[44:47], s77 offen offset:0 lds
    s_add_u32 m0, s33, 28544
    s_nop 0
    buffer_load_dwordx4 v22, s[44:47], s77 offen offset:128 lds
    s_add_u32 m0, s33, 32768
    s_nop 0
    buffer_load_dwordx4 v9, s[48:51], s77 offen lds
    s_and_b32 s91, s28, 4
    s_cmp_eq_u32 s91, 0
    s_cbranch_scc0 L_cm1
    s_waitcnt lgkmcnt(0)
    s_setprio 2
    v_mfma_f32_16x16x32_bf16 v[136:139], v[144:147], v[112:115], v[136:139]
    v_mfma_f32_16x16x32_bf16 v[140:143], v[144:147], v[128:131], v[140:143]
    v_mfma_f32_16x16x32_bf16 v[136:139], v[144:147], v[116:119], v[136:139]
    v_mfma_f32_16x16x32_bf16 v[140:143], v[144:147], v[132:135], v[140:143]
    v_mfma_f32_16x16x32_bf16 v[136:139], v[144:147], v[120:123], v[136:139]
    v_mfma_f32_16x16x32_bf16 v[136:139], v[144:147], v[124:127], v[136:139]
    s_setprio 0
L_cm1:
    s_waitcnt vmcnt(14)
    s_barrier
    s_and_b32 s91, s28, 4
    s_cmp_eq_u32 s91, 4
    s_cbranch_scc0 L_cr2
    ds_read_b128 v[112:115], v148 offset:40960
    ds_read_b128 v[116:119], v148 offset:41472
    ds_read_b128 v[120:123], v148 offset:43008
    ds_read_b128 v[124:127], v148 offset:43520
    ds_read_b128 v[128:131], v149 offset:40960
    ds_read_b128 v[132:135], v149 offset:41984
L_cr2:
    global_load_dwordx4 v[24:27], v4, s[8:9] offset:0
    global_load_dwordx4 v[32:35], v4, s[8:9] offset:2048
    global_load_dwordx4 v[28:31], v4, s[8:9] offset:1024
    global_load_dwordx4 v[36:39], v4, s[8:9] offset:3072
    s_add_u32 m0, s79, 116736
    s_add_u32 s72, s72, 128
    s_and_b32 s78, s72, 0x7ff
    buffer_load_dwordx4 v20, s[36:39], s78 offen lds
    s_add_u32 m0, s79, 117760
    s_nop 0
    buffer_load_dwordx4 v21, s[36:39], s78 offen lds
    s_add_u32 m0, s33, 36864
    s_add_u32 s77, s77, 229376
    buffer_load_dwordx4 v22, s[40:43], s77 offen offset:0 lds
    s_add_u32 m0, s33, 40832
    s_nop 0
    buffer_load_dwordx4 v22, s[40:43], s77 offen offset:128 lds
    s_add_u32 m0, s33, 45056
    s_nop 0
    buffer_load_dwordx4 v22, s[44:47], s77 offen offset:0 lds
    s_add_u32 m0, s33, 49024
    s_nop 0
    buffer_load_dwordx4 v22, s[44:47], s77 offen offset:128 lds
    s_add_u32 m0, s33, 53248
    s_nop 0
    buffer_load_dwordx4 v9, s[48:51], s77 offen lds
    s_and_b32 s91, s28, 4
    s_cmp_eq_u32 s91, 4
    s_cbranch_scc0 L_cm2
    s_waitcnt lgkmcnt(0)
    s_setprio 2
    v_mfma_f32_16x16x32_bf16 v[136:139], v[144:147], v[112:115], 0
    v_mfma_f32_16x16x32_bf16 v[140:143], v[144:147], v[128:131], 0
    v_mfma_f32_16x16x32_bf16 v[136:139], v[144:147], v[116:119], v[136:139]
    v_mfma_f32_16x16x32_bf16 v[140:143], v[144:147], v[132:135], v[140:143]
    v_mfma_f32_16x16x32_bf16 v[136:139], v[144:147], v[120:123], v[136:139]
    v_mfma_f32_16x16x32_bf16 v[136:139], v[144:147], v[124:127], v[136:139]
    s_setprio 0
L_cm2:
    s_waitcnt vmcnt(20)
    s_barrier
    s_and_b32 s91, s28, 4
    s_cmp_eq_u32 s91, 4
    s_cbranch_scc0 L_cr3
    ds_read_b128 v[112:115], v148 offset:61440
    ds_read_b128 v[116:119], v148 offset:61952
    ds_read_b128 v[120:123], v148 offset:63488
    ds_read_b128 v[124:127], v148 offset:64000
    ds_read_b128 v[128:131], v149 offset:61440
    ds_read_b128 v[132:135], v149 offset:62464
L_cr3:
    s_add_u32 m0, s79, 118784
    s_add_u32 s78, s78, 32768
    buffer_load_dwordx4 v20, s[36:39], s78 offen lds
    s_add_u32 m0, s79, 119808
    s_nop 0
    buffer_load_dwordx4 v21, s[36:39], s78 offen lds
    s_add_u32 m0, s33, 57344
    s_add_u32 s77, s77, 229376
    s_cmp_eq_u32 s77, 7340032
    s_cselect_b32 s77, 0, s77
    buffer_load_dwordx4 v22, s[40:43], s77 offen offset:0 lds
    s_add_u32 m0, s33, 61312
    s_nop 0
    buffer_load_dwordx4 v22, s[40:43], s77 offen offset:128 lds
    s_add_u32 m0, s33, 65536
    s_nop 0
    buffer_load_dwordx4 v22, s[44:47], s77 offen offset:0 lds
    s_add_u32 m0, s33, 69504
    s_nop 0
    buffer_load_dwordx4 v22, s[44:47], s77 offen offset:128 lds
    s_add_u32 m0, s33, 73728
    s_nop 0
    buffer_load_dwordx4 v9, s[48:51], s77 offen lds
    s_and_b32 s91, s28, 4
    s_cmp_eq_u32 s91, 4
    s_cbranch_scc0 L_cm3
    s_waitcnt lgkmcnt(0)
    s_setprio 2
    v_mfma_f32_16x16x32_bf16 v[136:139], v[144:147], v[112:115], v[136:139]
    v_mfma_f32_16x16x32_bf16 v[140:143], v[144:147], v[128:131], v[140:143]
    v_mfma_f32_16x16x32_bf16 v[136:139], v[144:147], v[116:119], v[136:139]
    v_mfma_f32_16x16x32_bf16 v[140:143], v[144:147], v[132:135], v[140:143]
    v_mfma_f32_16x16x32_bf16 v[136:139], v[144:147], v[120:123], v[136:139]
    v_mfma_f32_16x16x32_bf16 v[136:139], v[144:147], v[124:127], v[136:139]
    s_setprio 0
L_cm3:
    s_waitcnt vmcnt(18)
    s_barrier
    s_add_u32 m0, s79, 135168
    s_add_u32 s72, s72, 128
    s_and_b32 s78, s72, 0x7ff
    buffer_load_dwordx4 v20, s[36:39], s78 offen lds
    s_add_u32 m0, s79, 136192
    s_nop 0
    buffer_load_dwordx4 v21, s[36:39], s78 offen lds
    s_add_u32 m0, s33, 77824
    s_add_u32 s77, s77, 229376
    buffer_load_dwordx4 v22, s[40:43], s77 offen offset:0 lds
    s_add_u32 m0, s33, 81792
    s_nop 0
    buffer_load_dwordx4 v22, s[40:43], s77 offen offset:128 lds
    s_add_u32 m0, s33, 86016
    s_nop 0
    buffer_load_dwordx4 v22, s[44:47], s77 offen offset:0 lds
    s_add_u32 m0, s33, 89984
    s_nop 0
    buffer_load_dwordx4 v22, s[44:47], s77 offen offset:128 lds
    s_add_u32 m0, s33, 94208
    s_nop 0
    buffer_load_dwordx4 v9, s[48:51], s77 offen lds
    v_add_f32_dpp v136, v136, v136 row_ror:8 row_mask:0xf bank_mask:0xf
    v_add_f32_dpp v137, v137, v137 row_ror:8 row_mask:0xf bank_mask:0xf
    v_add_f32_dpp v138, v138, v138 row_ror:8 row_mask:0xf bank_mask:0xf
    v_add_f32_dpp v139, v139, v139 row_ror:8 row_mask:0xf bank_mask:0xf
    v_add_f32_dpp v140, v140, v140 row_ror:8 row_mask:0xf bank_mask:0xf
    v_add_f32_dpp v141, v141, v141 row_ror:8 row_mask:0xf bank_mask:0xf
    v_add_f32_dpp v142, v142, v142 row_ror:8 row_mask:0xf bank_mask:0xf
    v_add_f32_dpp v143, v143, v143 row_ror:8 row_mask:0xf bank_mask:0xf
    v_add_f32_dpp v140, v140, v140 row_ror:4 row_mask:0xf bank_mask:0xf
    v_add_f32_dpp v141, v141, v141 row_ror:4 row_mask:0xf bank_mask:0xf
    v_add_f32_dpp v142, v142, v142 row_ror:4 row_mask:0xf bank_mask:0xf
    v_add_f32_dpp v143, v143, v143 row_ror:4 row_mask:0xf bank_mask:0xf
    s_lshl_b32 s91, s29, 4
    s_add_u32 s91, s91, s28
    s_mul_i32 s91, s91, 1280
    s_mul_i32 s92, s5, 640
    s_add_u32 s91, s91, s92
    s_add_u32 s91, s91, 0x1e10000
    s_lshl_b32 s92, s6, 8
    v_and_b32 v112, 8, v1
    v_cmp_eq_u32 vcc, 0, v112
    v_mov_b32 v112, s92
    v_mov_b32 v113, 256
    v_cndmask_b32 v112, v113, v112, vcc
    v_cndmask_b32 v136, v140, v136, vcc
    v_cndmask_b32 v137, v141, v137, vcc
    v_cndmask_b32 v138, v142, v138, vcc
    v_cndmask_b32 v139, v143, v139, vcc
    v_and_b32 v113, 15, v1
    v_lshl_add_u32 v112, v113, 5, v112
    v_and_b32 v113, 16, v1
    v_add3_u32 v112, v112, v113, s91
    s_mov_b64 exec, 0x0fff0fff
    global_store_dwordx4 v112, v[136:139], s[26:27] sc1
    s_mov_b64 exec, -1
    s_waitcnt vmcnt(15)
    s_barrier
    s_add_u32 m0, s79, 137216
    s_add_u32 s78, s78, 32768
    buffer_load_dwordx4 v20, s[36:39], s78 offen lds
    s_waitcnt vmcnt(23)
    v_lshlrev_b32 v40, 16, v24
    v_and_b32 v41, 0xffff0000, v24
    v_lshlrev_b32 v42, 16, v25
    v_and_b32 v43, 0xffff0000, v25
    v_lshlrev_b32 v44, 16, v26
    v_and_b32 v45, 0xffff0000, v26
    v_lshlrev_b32 v46, 16, v27
    v_and_b32 v47, 0xffff0000, v27
    s_add_u32 m0, s79, 138240
    s_nop 0
    buffer_load_dwordx4 v21, s[36:39], s78 offen lds
    v_lshlrev_b32 v48, 16, v28
    v_and_b32 v49, 0xffff0000, v28
    v_lshlrev_b32 v50, 16, v29
    v_and_b32 v51, 0xffff0000, v29
    v_lshlrev_b32 v52, 16, v30
    v_and_b32 v53, 0xffff0000, v30
    v_lshlrev_b32 v54, 16, v31
    v_and_b32 v55, 0xffff0000, v31
    s_add_u32 m0, s33, 16384
    s_add_u32 s77, s77, 229376
    s_cmp_eq_u32 s77, 7340032
    s_cselect_b32 s77, 0, s77
    buffer_load_dwordx4 v22, s[40:43], s77 offen offset:0 lds
    v_lshlrev_b32 v56, 16, v32
    v_and_b32 v57, 0xffff0000, v32
    v_lshlrev_b32 v58, 16, v33
    v_and_b32 v59, 0xffff0000, v33
    v_lshlrev_b32 v60, 16, v34
    v_and_b32 v61, 0xffff0000, v34
    v_lshlrev_b32 v62, 16, v35
    v_and_b32 v63, 0xffff0000, v35
    s_add_u32 m0, s33, 20352
    s_nop 0
    buffer_load_dwordx4 v22, s[40:43], s77 offen offset:128 lds
    v_lshlrev_b32 v64, 16, v36
    v_and_b32 v65, 0xffff0000, v36
    v_lshlrev_b32 v66, 16, v37
    v_and_b32 v67, 0xffff0000, v37
    v_lshlrev_b32 v68, 16, v38
    v_and_b32 v69, 0xffff0000, v38
    v_lshlrev_b32 v70, 16, v39
    v_and_b32 v71, 0xffff0000, v39
    s_add_u32 m0, s33, 24576
    s_nop 0
    buffer_load_dwordx4 v22, s[44:47], s77 offen offset:0 lds
    v_add_f32 v72, v40, v41
    v_add_f32 v74, v56, v57
    v_add_f32 v72, v72, v42
    v_add_f32 v74, v74, v58
    v_add_f32 v72, v72, v43
    v_add_f32 v74, v74, v59
    v_add_f32 v72, v72, v44
    v_add_f32 v74, v74, v60
    s_add_u32 m0, s33, 28544
    s_nop 0
    buffer_load_dwordx4 v22, s[44:47], s77 offen offset:128 lds
    s_add_u32 m0, s33, 32768
    s_nop 0
    buffer_load_dwordx4 v9, s[48:51], s77 offen lds
    v_add_f32 v72, v72, v45
    v_add_f32 v74, v74, v61
    v_add_f32 v72, v72, v46
    v_add_f32 v74, v74, v62
    v_add_f32 v72, v72, v47
    v_add_f32 v74, v74, v63
    v_add_f32 v72, v72, v48
    v_add_f32 v74, v74, v64
    s_load_dword s94, s[10:11], s52 offset:0x0
    s_load_dword s94, s[10:11], s52 offset:0x40
    s_load_dword s94, s[10:11], s52 offset:0x80
    s_load_dword s94, s[10:11], s52 offset:0xc0
    s_waitcnt vmcnt(15)
    s_barrier
    s_add_u32 m0, s79, 98304
    s_add_u32 s72, s72, 128
    s_and_b32 s78, s72, 0x7ff
    buffer_load_dwordx4 v20, s[36:39], s78 offen lds
    v_add_f32 v72, v72, v49
    v_add_f32 v74, v74, v65
    v_add_f32 v72, v72, v50
    v_add_f32 v74, v74, v66
    v_add_f32 v72, v72, v51
    v_add_f32 v74, v74, v67
    v_add_f32 v72, v72, v52
    v_add_f32 v74, v74, v68
    s_add_u32 m0, s79, 99328
    s_nop 0
    buffer_load_dwordx4 v21, s[36:39], s78 offen lds
    v_add_f32 v72, v72, v53
    v_add_f32 v74, v74, v69
    v_add_f32 v72, v72, v54
    v_add_f32 v74, v74, v70
    v_add_f32 v72, v72, v55
    v_add_f32 v74, v74, v71
    s_nop 0
    v_add_f32_dpp v72, v72, v72 quad_perm:[1,0,3,2] row_mask:0xf bank_mask:0xf
    v_add_f32_dpp v74, v74, v74 quad_perm:[1,0,3,2] row_mask:0xf bank_mask:0xf
    s_add_u32 m0, s33, 36864
    s_add_u32 s77, s77, 229376
    buffer_load_dwordx4 v22, s[40:43], s77 offen offset:0 lds
    s_nop 0
    v_add_f32_dpp v72, v72, v72 quad_perm:[2,3,0,1] row_mask:0xf bank_mask:0xf
    v_add_f32_dpp v74, v74, v74 quad_perm:[2,3,0,1] row_mask:0xf bank_mask:0xf
    s_nop 0
    v_add_f32_dpp v72, v72, v72 row_half_mirror row_mask:0xf bank_mask:0xf
    v_add_f32_dpp v74, v74, v74 row_half_mirror row_mask:0xf bank_mask:0xf
    s_nop 0
    v_add_f32_dpp v72, v72, v72 row_mirror row_mask:0xf bank_mask:0xf
    v_add_f32_dpp v74, v74, v74 row_mirror row_mask:0xf bank_mask:0xf
    v_mov_b32 v78, v72
    s_add_u32 m0, s33, 40832
    s_nop 0
    buffer_load_dwordx4 v22, s[40:43], s77 offen offset:128 lds
    v_mov_b32 v79, v74
    s_nop 0
    v_permlane16_swap_b32 v72, v78
    v_permlane16_swap_b32 v74, v79
    v_add_f32 v72, v72, v78
    v_add_f32 v74, v74, v79
    v_mov_b32 v78, v72
    v_mov_b32 v79, v74
    s_nop 0
    v_permlane32_swap_b32 v72, v78
    s_add_u32 m0, s33, 45056
    s_nop 0
    buffer_load_dwordx4 v22, s[44:47], s77 offen offset:0 lds
    s_add_u32 m0, s33, 49024
    s_nop 0
    buffer_load_dwordx4 v22, s[44:47], s77 offen offset:128 lds
    v_permlane32_swap_b32 v74, v79
    v_add_f32 v72, v72, v78
    v_add_f32 v74, v74, v79
    v_mul_f32 v72, 0x3a800000, v72
    v_mul_f32 v74, 0x3a800000, v74
    v_sub_f32 v78, v40, v72
    v_sub_f32 v79, v56, v74
    v_mul_f32 v73, v78, v78
    s_add_u32 m0, s33, 53248
    s_nop 0
    buffer_load_dwordx4 v9, s[48:51], s77 offen lds
    v_mul_f32 v75, v79, v79
    v_sub_f32 v78, v41, v72
    v_sub_f32 v79, v57, v74
    v_fmac_f32 v73, v78, v78
    v_fmac_f32 v75, v79, v79
    v_sub_f32 v78, v42, v72
    v_sub_f32 v79, v58, v74
    v_fmac_f32 v73, v78, v78
    s_load_dword s94, s[10:11], s52 offset:0x100
    s_load_dword s94, s[10:11], s52 offset:0x140
    s_load_dword s94, s[10:11], s52 offset:0x180
    s_load_dword s94, s[10:11], s52 offset:0x1c0
    s_waitcnt vmcnt(15)
    s_barrier
    s_add_u32 m0, s79, 100352
    s_add_u32 s78, s78, 32768
    buffer_load_dwordx4 v20, s[36:39], s78 offen lds
    v_fmac_f32 v75, v79, v79
    v_sub_f32 v78, v43, v72
    v_sub_f32 v79, v59, v74
    v_fmac_f32 v73, v78, v78
    v_fmac_f32 v75, v79, v79
    v_sub_f32 v78, v44, v72
    v_sub_f32 v79, v60, v74
    v_fmac_f32 v73, v78, v78
    s_add_u32 m0, s79, 101376
    s_nop 0
    buffer_load_dwordx4 v21, s[36:39], s78 offen lds
    v_fmac_f32 v75, v79, v79
    v_sub_f32 v78, v45, v72
    v_sub_f32 v79, v61, v74
    v_fmac_f32 v73, v78, v78
    v_fmac_f32 v75, v79, v79
    v_sub_f32 v78, v46, v72
    v_sub_f32 v79, v62, v74
    v_fmac_f32 v73, v78, v78
    s_add_u32 m0, s33, 57344
    s_add_u32 s77, s77, 229376
    s_cmp_eq_u32 s77, 7340032
    s_cselect_b32 s77, 0, s77
    buffer_load_dwordx4 v22, s[40:43], s77 offen offset:0 lds
    v_fmac_f32 v75, v79, v79
    v_sub_f32 v78, v47, v72
    v_sub_f32 v79, v63, v74
    v_fmac_f32 v73, v78, v78
    v_fmac_f32 v75, v79, v79
    v_sub_f32 v78, v48, v72
    v_sub_f32 v79, v64, v74
    v_fmac_f32 v73, v78, v78
    s_add_u32 m0, s33, 61312
    s_nop 0
    buffer_load_dwordx4 v22, s[40:43], s77 offen offset:128 lds
    v_fmac_f32 v75, v79, v79
    v_sub_f32 v78, v49, v72
    v_sub_f32 v79, v65, v74
    v_fmac_f32 v73, v78, v78
    v_fmac_f32 v75, v79, v79
    v_sub_f32 v78, v50, v72
    v_sub_f32 v79, v66, v74
    v_fmac_f32 v73, v78, v78
    s_add_u32 m0, s33, 65536
    s_nop 0
    buffer_load_dwordx4 v22, s[44:47], s77 offen offset:0 lds
    v_fmac_f32 v75, v79, v79
    v_sub_f32 v78, v51, v72
    v_sub_f32 v79, v67, v74
    v_fmac_f32 v73, v78, v78
    v_fmac_f32 v75, v79, v79
    v_sub_f32 v78, v52, v72
    v_sub_f32 v79, v68, v74
    v_fmac_f32 v73, v78, v78
    s_add_u32 m0, s33, 69504
    s_nop 0
    buffer_load_dwordx4 v22, s[44:47], s77 offen offset:128 lds
    s_add_u32 m0, s33, 73728
    s_nop 0
    buffer_load_dwordx4 v9, s[48:51], s77 offen lds
    v_fmac_f32 v75, v79, v79
    v_sub_f32 v78, v53, v72
    v_sub_f32 v79, v69, v74
    v_fmac_f32 v73, v78, v78
    v_fmac_f32 v75, v79, v79
    v_sub_f32 v78, v54, v72
    v_sub_f32 v79, v70, v74
    v_fmac_f32 v73, v78, v78
    s_load_dword s94, s[16:17], s53 offset:0x0
    s_load_dword s94, s[16:17], s53 offset:0x40
    s_load_dword s94, s[16:17], s53 offset:0x80
    s_load_dword s94, s[16:17], s53 offset:0xc0
    s_waitcnt vmcnt(14)
    s_barrier
    s_add_u32 m0, s79, 116736
    s_add_u32 s72, s72, 128
    s_and_b32 s78, s72, 0x7ff
    buffer_load_dwordx4 v20, s[36:39], s78 offen lds
    v_fmac_f32 v75, v79, v79
    v_sub_f32 v78, v55, v72
    v_sub_f32 v79, v71, v74
    v_fmac_f32 v73, v78, v78
    v_fmac_f32 v75, v79, v79
    s_nop 0
    v_add_f32_dpp v73, v73, v73 quad_perm:[1,0,3,2] row_mask:0xf bank_mask:0xf
    v_add_f32_dpp v75, v75, v75 quad_perm:[1,0,3,2] row_mask:0xf bank_mask:0xf
    s_nop 0
    v_add_f32_dpp v73, v73, v73 quad_perm:[2,3,0,1] row_mask:0xf bank_mask:0xf
    s_add_u32 m0, s79, 117760
    s_nop 0
    buffer_load_dwordx4 v21, s[36:39], s78 offen lds
    v_add_f32_dpp v75, v75, v75 quad_perm:[2,3,0,1] row_mask:0xf bank_mask:0xf
    s_nop 0
    v_add_f32_dpp v73, v73, v73 row_half_mirror row_mask:0xf bank_mask:0xf
    v_add_f32_dpp v75, v75, v75 row_half_mirror row_mask:0xf bank_mask:0xf
    s_nop 0
    v_add_f32_dpp v73, v73, v73 row_mirror row_mask:0xf bank_mask:0xf
    v_add_f32_dpp v75, v75, v75 row_mirror row_mask:0xf bank_mask:0xf
    v_mov_b32 v78, v73
    v_mov_b32 v79, v75
    s_add_u32 m0, s33, 77824
    s_add_u32 s77, s77, 229376
    buffer_load_dwordx4 v22, s[40:43], s77 offen offset:0 lds
    s_nop 0
    v_permlane16_swap_b32 v73, v78
    v_permlane16_swap_b32 v75, v79
    v_add_f32 v73, v73, v78
    v_add_f32 v75, v75, v79
    v_mov_b32 v78, v73
    v_mov_b32 v79, v75
    s_nop 0
    v_permlane32_swap_b32 v73, v78
    s_add_u32 m0, s33, 81792
    s_nop 0
    buffer_load_dwordx4 v22, s[40:43], s77 offen offset:128 lds
    v_permlane32_swap_b32 v75, v79
    v_add_f32 v73, v73, v78
    v_add_f32 v75, v75, v79
    v_mul_f32 v73, 0x3a800000, v73
    v_mul_f32 v75, 0x3a800000, v75
    v_cvt_pk_bf16_f32 v72, v72, v72
    v_lshlrev_b32 v72, 16, v72
    v_cvt_pk_bf16_f32 v73, v73, v73
    s_add_u32 m0, s33, 86016
    s_nop 0
    buffer_load_dwordx4 v22, s[44:47], s77 offen offset:0 lds
    s_add_u32 m0, s33, 89984
    s_nop 0
    buffer_load_dwordx4 v22, s[44:47], s77 offen offset:128 lds
    v_lshlrev_b32 v73, 16, v73
    v_add_f32 v73, 0x3727c5ac, v73
    v_cvt_pk_bf16_f32 v73, v73, v73
    v_lshlrev_b32 v73, 16, v73
    v_sqrt_f32 v73, v73
    v_cvt_pk_bf16_f32 v74, v74, v74
    v_lshlrev_b32 v74, 16, v74
    s_add_u32 m0, s33, 94208
    s_nop 0
    buffer_load_dwordx4 v9, s[48:51], s77 offen lds
    v_cvt_pk_bf16_f32 v75, v75, v75
    v_lshlrev_b32 v75, 16, v75
    v_add_f32 v75, 0x3727c5ac, v75
    v_cvt_pk_bf16_f32 v75, v75, v75
    v_lshlrev_b32 v75, 16, v75
    v_sqrt_f32 v75, v75
    s_nop 0
    v_cvt_pk_bf16_f32 v73, v73, v73
    s_load_dword s94, s[16:17], s53 offset:0x100
    s_load_dword s94, s[16:17], s53 offset:0x140
    s_load_dword s94, s[16:17], s53 offset:0x180
    s_load_dword s94, s[16:17], s53 offset:0x1c0
    s_waitcnt vmcnt(14)
    s_barrier
    s_add_u32 m0, s79, 118784
    s_add_u32 s78, s78, 32768
    buffer_load_dwordx4 v20, s[36:39], s78 offen lds
    v_lshlrev_b32 v73, 16, v73
    v_rcp_f32 v76, v73
    s_nop 0
    v_cvt_pk_bf16_f32 v75, v75, v75
    v_lshlrev_b32 v75, 16, v75
    v_rcp_f32 v77, v75
    s_nop 0
    v_fma_f32 v78, -v73, v76, 1.0
    s_add_u32 m0, s79, 119808
    s_nop 0
    buffer_load_dwordx4 v21, s[36:39], s78 offen lds
    v_fma_f32 v76, v78, v76, v76
    s_nop 0
    v_fma_f32 v79, -v75, v77, 1.0
    v_fma_f32 v77, v79, v77, v77
    v_sub_f32 v80, v40, v72
    v_sub_f32 v81, v41, v72
    v_cvt_pk_bf16_f32 v80, v80, v81
    v_and_b32 v81, 0xffff0000, v80
    v_lshlrev_b32 v80, 16, v80
    s_add_u32 m0, s33, 16384
    s_add_u32 s77, s77, 229376
    s_cmp_eq_u32 s77, 7340032
    s_cselect_b32 s77, 0, s77
    buffer_load_dwordx4 v22, s[40:43], s77 offen offset:0 lds
    v_mul_f32 v80, v80, v76
    v_mul_f32 v81, v81, v76
    v_cvt_pk_bf16_f32 v24, v80, v81
    v_sub_f32 v80, v42, v72
    v_sub_f32 v81, v43, v72
    v_cvt_pk_bf16_f32 v80, v80, v81
    v_and_b32 v81, 0xffff0000, v80
    v_lshlrev_b32 v80, 16, v80
    s_add_u32 m0, s33, 20352
    s_nop 0
    buffer_load_dwordx4 v22, s[40:43], s77 offen offset:128 lds
    v_mul_f32 v80, v80, v76
    v_mul_f32 v81, v81, v76
    v_cvt_pk_bf16_f32 v25, v80, v81
    v_sub_f32 v80, v44, v72
    v_sub_f32 v81, v45, v72
    v_cvt_pk_bf16_f32 v80, v80, v81
    v_and_b32 v81, 0xffff0000, v80
    v_lshlrev_b32 v80, 16, v80
    s_add_u32 m0, s33, 24576
    s_nop 0
    buffer_load_dwordx4 v22, s[44:47], s77 offen offset:0 lds
    s_add_u32 m0, s33, 28544
    s_nop 0
    buffer_load_dwordx4 v22, s[44:47], s77 offen offset:128 lds
    v_mul_f32 v80, v80, v76
    v_mul_f32 v81, v81, v76
    v_cvt_pk_bf16_f32 v26, v80, v81
    v_sub_f32 v80, v46, v72
    v_sub_f32 v81, v47, v72
    v_cvt_pk_bf16_f32 v80, v80, v81
    v_and_b32 v81, 0xffff0000, v80
    v_lshlrev_b32 v80, 16, v80
    s_add_u32 m0, s33, 32768
    s_nop 0
    buffer_load_dwordx4 v9, s[48:51], s77 offen lds
    v_mul_f32 v80, v80, v76
    v_mul_f32 v81, v81, v76
    v_cvt_pk_bf16_f32 v27, v80, v81
    v_sub_f32 v80, v48, v72
    v_sub_f32 v81, v49, v72
    v_cvt_pk_bf16_f32 v80, v80, v81
    v_and_b32 v81, 0xffff0000, v80
    v_lshlrev_b32 v80, 16, v80
    s_load_dword s94, s[18:19], s53 offset:0x0
    s_load_dword s94, s[18:19], s53 offset:0x40
    s_load_dword s94, s[18:19], s53 offset:0x80
    s_load_dword s94, s[18:19], s53 offset:0xc0
    s_waitcnt vmcnt(14)
    s_barrier
    s_add_u32 m0, s79, 135168
    s_add_u32 s72, s72, 128
    s_and_b32 s78, s72, 0x7ff
    buffer_load_dwordx4 v20, s[36:39], s78 offen lds
    v_mul_f32 v80, v80, v76
    v_mul_f32 v81, v81, v76
    v_cvt_pk_bf16_f32 v28, v80, v81
    v_sub_f32 v80, v50, v72
    v_sub_f32 v81, v51, v72
    v_cvt_pk_bf16_f32 v80, v80, v81
    v_and_b32 v81, 0xffff0000, v80
    v_lshlrev_b32 v80, 16, v80
    s_add_u32 m0, s79, 136192
    s_nop 0
    buffer_load_dwordx4 v21, s[36:39], s78 offen lds
    v_mul_f32 v80, v80, v76
    v_mul_f32 v81, v81, v76
    v_cvt_pk_bf16_f32 v29, v80, v81
    v_sub_f32 v80, v52, v72
    v_sub_f32 v81, v53, v72
    v_cvt_pk_bf16_f32 v80, v80, v81
    v_and_b32 v81, 0xffff0000, v80
    v_lshlrev_b32 v80, 16, v80
    s_add_u32 m0, s33, 36864
    s_add_u32 s77, s77, 229376
    buffer_load_dwordx4 v22, s[40:43], s77 offen offset:0 lds
    v_mul_f32 v80, v80, v76
    v_mul_f32 v81, v81, v76
    v_cvt_pk_bf16_f32 v30, v80, v81
    v_sub_f32 v80, v54, v72
    v_sub_f32 v81, v55, v72
    v_cvt_pk_bf16_f32 v80, v80, v81
    v_and_b32 v81, 0xffff0000, v80
    v_lshlrev_b32 v80, 16, v80
    s_add_u32 m0, s33, 40832
    s_nop 0
    buffer_load_dwordx4 v22, s[40:43], s77 offen offset:128 lds
    v_mul_f32 v80, v80, v76
    v_mul_f32 v81, v81, v76
    v_cvt_pk_bf16_f32 v31, v80, v81
    v_sub_f32 v80, v56, v74
    v_sub_f32 v81, v57, v74
    v_cvt_pk_bf16_f32 v80, v80, v81
    v_and_b32 v81, 0xffff0000, v80
    v_lshlrev_b32 v80, 16, v80
    s_add_u32 m0, s33, 45056
    s_nop 0
    buffer_load_dwordx4 v22, s[44:47], s77 offen offset:0 lds
    v_mul_f32 v80, v80, v77
    v_mul_f32 v81, v81, v77
    v_cvt_pk_bf16_f32 v32, v80, v81
    v_sub_f32 v80, v58, v74
    v_sub_f32 v81, v59, v74
    v_cvt_pk_bf16_f32 v80, v80, v81
    v_and_b32 v81, 0xffff0000, v80
    v_lshlrev_b32 v80, 16, v80
    s_add_u32 m0, s33, 49024
    s_nop 0
    buffer_load_dwordx4 v22, s[44:47], s77 offen offset:128 lds
    s_add_u32 m0, s33, 53248
    s_nop 0
    buffer_load_dwordx4 v9, s[48:51], s77 offen lds
    v_mul_f32 v80, v80, v77
    v_mul_f32 v81, v81, v77
    v_cvt_pk_bf16_f32 v33, v80, v81
    v_sub_f32 v80, v60, v74
    v_sub_f32 v81, v61, v74
    v_cvt_pk_bf16_f32 v80, v80, v81
    v_and_b32 v81, 0xffff0000, v80
    v_lshlrev_b32 v80, 16, v80
    s_load_dword s94, s[18:19], s53 offset:0x100
    s_load_dword s94, s[18:19], s53 offset:0x140
    s_load_dword s94, s[18:19], s53 offset:0x180
    s_load_dword s94, s[18:19], s53 offset:0x1c0
    s_waitcnt vmcnt(14)
    s_barrier
    s_add_u32 m0, s79, 137216
    s_add_u32 s78, s78, 32768
    buffer_load_dwordx4 v20, s[36:39], s78 offen lds
    v_mul_f32 v80, v80, v77
    v_mul_f32 v81, v81, v77
    v_cvt_pk_bf16_f32 v34, v80, v81
    v_sub_f32 v80, v62, v74
    v_sub_f32 v81, v63, v74
    v_cvt_pk_bf16_f32 v80, v80, v81
    v_and_b32 v81, 0xffff0000, v80
    v_lshlrev_b32 v80, 16, v80
    s_add_u32 m0, s79, 138240
    s_nop 0
    buffer_load_dwordx4 v21, s[36:39], s78 offen lds
    v_mul_f32 v80, v80, v77
    v_mul_f32 v81, v81, v77
    v_cvt_pk_bf16_f32 v35, v80, v81
    v_sub_f32 v80, v64, v74
    v_sub_f32 v81, v65, v74
    v_cvt_pk_bf16_f32 v80, v80, v81
    v_and_b32 v81, 0xffff0000, v80
    v_lshlrev_b32 v80, 16, v80
    s_add_u32 m0, s33, 57344
    s_add_u32 s77, s77, 229376
    s_cmp_eq_u32 s77, 7340032
    s_cselect_b32 s77, 0, s77
    buffer_load_dwordx4 v22, s[40:43], s77 offen offset:0 lds
    v_mul_f32 v80, v80, v77
    v_mul_f32 v81, v81, v77
    v_cvt_pk_bf16_f32 v36, v80, v81
    v_sub_f32 v80, v66, v74
    v_sub_f32 v81, v67, v74
    v_cvt_pk_bf16_f32 v80, v80, v81
    v_and_b32 v81, 0xffff0000, v80
    v_lshlrev_b32 v80, 16, v80
    s_add_u32 m0, s33, 61312
    s_nop 0
    buffer_load_dwordx4 v22, s[40:43], s77 offen offset:128 lds
    v_mul_f32 v80, v80, v77
    v_mul_f32 v81, v81, v77
    v_cvt_pk_bf16_f32 v37, v80, v81
    v_sub_f32 v80, v68, v74
    v_sub_f32 v81, v69, v74
    v_cvt_pk_bf16_f32 v80, v80, v81
    v_and_b32 v81, 0xffff0000, v80
    v_lshlrev_b32 v80, 16, v80
    s_add_u32 m0, s33, 65536
    s_nop 0
    buffer_load_dwordx4 v22, s[44:47], s77 offen offset:0 lds
    v_mul_f32 v80, v80, v77
    v_mul_f32 v81, v81, v77
    v_cvt_pk_bf16_f32 v38, v80, v81
    v_sub_f32 v80, v70, v74
    v_sub_f32 v81, v71, v74
    v_cvt_pk_bf16_f32 v80, v80, v81
    v_and_b32 v81, 0xffff0000, v80
    v_lshlrev_b32 v80, 16, v80
    s_add_u32 m0, s33, 69504
    s_nop 0
    buffer_load_dwordx4 v22, s[44:47], s77 offen offset:128 lds
    s_add_u32 m0, s33, 73728
    s_nop 0
    buffer_load_dwordx4 v9, s[48:51], s77 offen lds
    v_mul_f32 v80, v80, v77
    v_mul_f32 v81, v81, v77
    v_cvt_pk_bf16_f32 v39, v80, v81
    global_store_dwordx4 v4, v[24:27], s[26:27] offset:0 sc1
    global_store_dwordx4 v4, v[28:31], s[26:27] offset:1024 sc1
    global_store_dwordx4 v4, v[32:35], s[26:27] offset:2048 sc1
    global_store_dwordx4 v4, v[36:39], s[26:27] offset:3072 sc1
    s_add_u32 s90, s90, 0x1e00000
    v_mov_b32 v7, s90
    s_mov_b64 exec, 1
    global_store_dwordx4 v7, v[72:75], s[26:27] sc1
    s_mov_b64 exec, -1
    s_load_dword s94, s[10:11], s52 offset:0x80000
    s_load_dword s94, s[10:11], s52 offset:0x80040
    s_load_dword s94, s[10:11], s52 offset:0x80080
    s_load_dword s94, s[10:11], s52 offset:0x800c0
    s_waitcnt vmcnt(19)
    s_barrier
    s_add_u32 m0, s79, 98304
    s_add_u32 s72, s72, 128
    s_and_b32 s78, s72, 0x7ff
    buffer_load_dwordx4 v20, s[36:39], s78 offen lds
    v_lshrrev_b32 v64, 4, v1
    v_bfe_u32 v65, v1, 2, 2
    v_and_b32 v66, 3, v1
    v_and_b32 v67, 15, v1
    v_lshrrev_b32 v68, 3, v1
    v_and_b32 v69, 7, v1
    s_lshl_b32 s85, s6, 2
    s_lshl_b32 s86, s5, 1
    s_or_b32 s85, s85, s86
    v_lshl_add_u32 v70, v64, 3, v65
    v_lshlrev_b32 v70, 7, v70
    s_add_u32 m0, s79, 99328
    s_nop 0
    buffer_load_dwordx4 v21, s[36:39], s78 offen lds
    v_and_b32 v71, 1, v66
    v_lshl_add_u32 v70, v71, 3, v70
    v_add_u32 v70, 16384, v70
    v_and_b32 v71, 2, v65
    v_and_b32 v72, 1, v64
    v_lshl_add_u32 v71, v72, 2, v71
    v_lshrrev_b32 v72, 1, v66
    v_xor_b32 v71, v71, v72
    s_add_u32 m0, s33, 77824
    s_add_u32 s77, s77, 229376
    buffer_load_dwordx4 v22, s[40:43], s77 offen offset:0 lds
    v_xor_b32 v71, s85, v71
    v_xor_b32 v72, 0, v71
    v_lshl_add_u32 v4, v72, 4, v70
    v_add_u32 v6, 40960, v4
    v_xor_b32 v72, 2, v71
    v_lshl_add_u32 v5, v72, 4, v70
    v_add_u32 v7, 40960, v5
    v_lshrrev_b32 v70, 1, v67
    s_add_u32 m0, s33, 81792
    s_nop 0
    buffer_load_dwordx4 v22, s[40:43], s77 offen offset:128 lds
    v_xor_b32 v70, v70, v64
    v_lshlrev_b32 v70, 4, v70
    v_lshl_add_u32 v70, v67, 7, v70
    s_lshl_b32 s85, s5, 13
    v_add_u32 v16, s85, v70
    v_xor_b32 v17, 64, v16
    s_sub_u32 s95, 16384, s85
    s_mov_b32 s80, 135168
    s_lshl_b32 s86, s28, 7
    s_sub_u32 s86, s86, 16
    s_max_i32 s86, s86, 0
    s_lshl_b32 s87, s4, 2
    v_add_u32 v71, s87, v68
    s_add_u32 m0, s33, 86016
    s_nop 0
    buffer_load_dwordx4 v22, s[44:47], s77 offen offset:0 lds
    s_add_u32 m0, s33, 89984
    s_nop 0
    buffer_load_dwordx4 v22, s[44:47], s77 offen offset:128 lds
    v_lshrrev_b32 v70, 1, v71
    v_and_b32 v70, 7, v70
    v_xor_b32 v70, v70, v69
    v_lshlrev_b32 v70, 4, v70
    v_add_u32 v71, s86, v71
    v_lshl_add_u32 v3, v71, 11, v70
    s_lshl_b32 s81, s4, 9
    s_lshl_b32 s85, s4, 3
    s_and_b32 s86, s4, 1
    s_lshl_b32 s86, s86, 2
    v_and_b32 v70, 2, v68
    s_add_u32 m0, s33, 94208
    s_nop 0
    buffer_load_dwordx4 v9, s[48:51], s77 offen lds
    v_xor_b32 v70, v70, v69
    v_xor_b32 v70, s86, v70
    v_add_u32 v71, s85, v68
    v_mul_u32_u24 v71, 6144, v71
    v_lshl_add_u32 v23, v70, 4, v71
    s_lshl_b32 s85, s4, 12
    v_lshl_add_u32 v10, v1, 4, s85
    s_lshl_b32 s85, s4, 4
    v_and_b32 v70, 2, v68
    v_xor_b32 v70, v70, v69
    s_load_dword s94, s[10:11], s52 offset:0x80100
    s_load_dword s94, s[10:11], s52 offset:0x80140
    s_load_dword s94, s[10:11], s52 offset:0x80180
    s_load_dword s94, s[10:11], s52 offset:0x801c0
    v_mov_b32 v8, 0
    global_load_dwordx2 v[18:19], v8, s[24:25] sc1
    s_waitcnt vmcnt(20)
    s_barrier
    s_add_u32 m0, s79, 100352
    s_add_u32 s78, s78, 32768
    buffer_load_dwordx4 v20, s[36:39], s78 offen lds
    v_xor_b32 v70, 0, v70
    v_add_u32 v71, s85, v68
    v_mul_u32_u24 v71, 2048, v71
    v_lshl_add_u32 v11, v70, 4, v71
    s_add_u32 s85, s85, 8
    v_and_b32 v70, 2, v68
    v_xor_b32 v70, v70, v69
    v_xor_b32 v70, 4, v70
    v_add_u32 v71, s85, v68
    s_add_u32 m0, s79, 101376
    s_nop 0
    buffer_load_dwordx4 v21, s[36:39], s78 offen lds
    v_mul_u32_u24 v71, 2048, v71
    v_lshl_add_u32 v12, v70, 4, v71
    s_lshl_b32 s85, s31, 8
    s_lshl_b32 s86, s32, 7
    s_add_u32 s86, s85, s86
    s_xor_b32 s87, s86, 128
    s_add_u32 s60, s20, s86
    s_addc_u32 s61, s21, 0
    s_sub_u32 s62, 7340032, s86
    s_mov_b32 s63, 0x20000
    s_add_u32 s64, s20, s87
    s_addc_u32 s65, s21, 0
    s_sub_u32 s66, 7340032, s87
    s_mov_b32 s67, 0x20000
    s_add_u32 s56, s26, 0x400000
    s_addc_u32 s57, s27, 0
    s_mov_b32 s58, 0xe00000
    s_mov_b32 s59, 0x20000
    s_mul_i32 s82, s30, 917504
    s_mul_i32 s85, s32, 327680
    s_add_u32 s82, s82, s85
    s_mul_i32 s83, s32, 2621440
    s_mul_i32 s85, s32, 24
    s_add_u32 m0, s33, 16384
    s_add_u32 s77, s77, 229376
    s_cmp_eq_u32 s77, 7340032
    s_cselect_b32 s77, 0, s77
    buffer_load_dwordx4 v22, s[40:43], s77 offen offset:0 lds
    s_sub_u32 s85, 40, s85
    s_lshl_b32 s14, s85, 13
    s_lshl_b32 s35, s85, 16
    s_add_u32 s83, s83, 1966080
    s_add_u32 s82, s82, 262144
    s_lshl_b32 s84, s30, 7
    s_lshl_b32 s85, s5, 6
    s_add_u32 s84, s84, s85
    s_lshl_b32 s84, s84, 11
    s_lshl_b32 s85, s31, 8
    s_add_u32 s84, s84, s85
    s_lshl_b32 s85, s32, 7
    s_add_u32 s84, s84, s85
    s_lshl_b32 s85, s6, 6
    s_add_u32 s84, s84, s85
    v_and_b32 v70, 1, v64
    v_lshlrev_b32 v70, 5, v70
    v_lshrrev_b32 v71, 1, v64
    v_lshl_add_u32 v70, v71, 4, v70
    s_add_u32 m0, s33, 20352
    s_nop 0
    buffer_load_dwordx4 v22, s[40:43], s77 offen offset:128 lds
    v_lshl_add_u32 v70, v67, 11, v70
    v_add_u32 v13, s84, v70
    s_mul_i32 s84, s6, 3072
    s_add_u32 s84, s84, 153600
    v_lshl_add_u32 v85, v1, 3, s84
    s_mul_i32 s84, s28, 112
    s_lshl1_add_u32 s85, s29, s6
    s_add_u32 s84, s84, s85
    s_add_u32 s84, s84, 80
    s_lshl_b32 s84, s84, 13
    s_lshl_b32 s86, s5, 12
    s_add_u32 s84, s84, s86
    s_add_u32 s84, s84, 0x400000
    s_lshl_b32 s87, s5, 9
    s_add_u32 s73, s84, s87
    s_xor_b32 s87, s87, 512
    s_add_u32 s74, s84, s87
    s_lshl_b32 s84, s28, 5
    s_add_u32 s84, s84, s85
    s_lshl_b32 s84, s84, 13
    s_add_u32 m0, s33, 24576
    s_nop 0
    buffer_load_dwordx4 v22, s[44:47], s77 offen offset:0 lds
    s_add_u32 m0, s33, 28544
    s_nop 0
    buffer_load_dwordx4 v22, s[44:47], s77 offen offset:128 lds
    s_add_u32 s84, s84, s86
    s_add_u32 s75, s84, 0x1200000
    v_mov_b32 v84, 0xc0135761
    v_mov_b32 v152, 0
    v_mov_b32 v153, 0
    v_mov_b32 v154, 0
    v_mov_b32 v155, 0
    v_mov_b32 v156, 0
    v_mov_b32 v157, 0
    v_mov_b32 v158, 0
    s_add_u32 m0, s33, 32768
    s_nop 0
    buffer_load_dwordx4 v9, s[48:51], s77 offen lds
    v_mov_b32 v159, 0
    v_mov_b32 v160, 0
    v_mov_b32 v161, 0
    v_mov_b32 v162, 0
    v_mov_b32 v163, 0
    v_mov_b32 v164, 0
    v_mov_b32 v165, 0
    v_mov_b32 v166, 0
    s_add_u32 s52, s52, 0x100000
    s_load_dword s94, s[10:11], s52 offset:0x0
    s_load_dword s94, s[10:11], s52 offset:0x40
    s_load_dword s94, s[10:11], s52 offset:0x80
    s_load_dword s94, s[10:11], s52 offset:0xc0
    s_waitcnt vmcnt(20)
    s_barrier
    s_add_u32 m0, s79, 116736
    s_add_u32 s72, s72, 128
    s_and_b32 s78, s72, 0x7ff
    buffer_load_dwordx4 v20, s[36:39], s78 offen lds
    v_mov_b32 v167, 0
    v_mov_b32 v168, 0
    v_mov_b32 v169, 0
    v_mov_b32 v170, 0
    v_mov_b32 v171, 0
    v_mov_b32 v172, 0
    v_mov_b32 v173, 0
    v_mov_b32 v174, 0
    s_add_u32 m0, s79, 117760
    s_nop 0
    buffer_load_dwordx4 v21, s[36:39], s78 offen lds
    v_mov_b32 v175, 0
    v_mov_b32 v176, 0
    v_mov_b32 v177, 0
    v_mov_b32 v178, 0
    v_mov_b32 v179, 0
    v_mov_b32 v180, 0
    v_mov_b32 v181, 0
    v_mov_b32 v182, 0
    s_add_u32 m0, s33, 36864
    s_add_u32 s77, s77, 229376
    buffer_load_dwordx4 v22, s[40:43], s77 offen offset:0 lds
    v_mov_b32 v183, 0
    v_mov_b32 v184, 0
    v_mov_b32 v185, 0
    v_mov_b32 v186, 0
    v_mov_b32 v187, 0
    v_mov_b32 v188, 0
    v_mov_b32 v189, 0
    v_mov_b32 v190, 0
    s_add_u32 m0, s33, 40832
    s_nop 0
    buffer_load_dwordx4 v22, s[40:43], s77 offen offset:128 lds
    v_mov_b32 v191, 0
    v_mov_b32 v192, 0
    v_mov_b32 v193, 0
    v_mov_b32 v194, 0
    v_mov_b32 v195, 0
    v_mov_b32 v196, 0
    v_mov_b32 v197, 0
    v_mov_b32 v198, 0
    s_add_u32 m0, s33, 45056
    s_nop 0
    buffer_load_dwordx4 v22, s[44:47], s77 offen offset:0 lds
    v_mov_b32 v199, 0
    v_mov_b32 v200, 0
    v_mov_b32 v201, 0
    v_mov_b32 v202, 0
    v_mov_b32 v203, 0
    v_mov_b32 v204, 0
    v_mov_b32 v205, 0
    v_mov_b32 v206, 0
    s_add_u32 m0, s33, 49024
    s_nop 0
    buffer_load_dwordx4 v22, s[44:47], s77 offen offset:128 lds
    s_add_u32 m0, s33, 53248
    s_nop 0
    buffer_load_dwordx4 v9, s[48:51], s77 offen lds
    v_mov_b32 v207, 0
    v_mov_b32 v208, 0
    v_mov_b32 v209, 0
    v_mov_b32 v210, 0
    v_mov_b32 v211, 0
    v_mov_b32 v212, 0
    v_mov_b32 v213, 0
    v_mov_b32 v214, 0
    s_load_dword s94, s[10:11], s52 offset:0x100
    s_load_dword s94, s[10:11], s52 offset:0x140
    s_load_dword s94, s[10:11], s52 offset:0x180
    s_load_dword s94, s[10:11], s52 offset:0x1c0
    s_waitcnt vmcnt(15)
    s_barrier
    s_add_u32 m0, s79, 118784
    s_add_u32 s78, s78, 32768
    buffer_load_dwordx4 v20, s[36:39], s78 offen lds
    v_mov_b32 v215, 0
    v_mov_b32 v216, 0
    v_mov_b32 v217, 0
    v_mov_b32 v218, 0
    v_mov_b32 v219, 0
    v_mov_b32 v220, 0
    v_mov_b32 v221, 0
    v_mov_b32 v222, 0
    s_add_u32 m0, s79, 119808
    s_nop 0
    buffer_load_dwordx4 v21, s[36:39], s78 offen lds
    v_mov_b32 v223, 0
    v_mov_b32 v224, 0
    v_mov_b32 v225, 0
    v_mov_b32 v226, 0
    v_mov_b32 v227, 0
    v_mov_b32 v228, 0
    v_mov_b32 v229, 0
    v_mov_b32 v230, 0
    s_add_u32 m0, s33, 57344
    s_add_u32 s77, s77, 229376
    s_cmp_eq_u32 s77, 7340032
    s_cselect_b32 s77, 0, s77
    buffer_load_dwordx4 v22, s[40:43], s77 offen offset:0 lds
    v_mov_b32 v231, 0
    v_mov_b32 v232, 0
    v_mov_b32 v233, 0
    v_mov_b32 v234, 0
    v_mov_b32 v235, 0
    v_mov_b32 v236, 0
    v_mov_b32 v237, 0
    v_mov_b32 v238, 0
    s_add_u32 m0, s33, 61312
    s_nop 0
    buffer_load_dwordx4 v22, s[40:43], s77 offen offset:128 lds
    v_mov_b32 v239, 0
    v_mov_b32 v240, 0
    v_mov_b32 v241, 0
    v_mov_b32 v242, 0
    v_mov_b32 v243, 0
    v_mov_b32 v244, 0
    v_mov_b32 v245, 0
    v_mov_b32 v246, 0
    s_add_u32 m0, s33, 65536
    s_nop 0
    buffer_load_dwordx4 v22, s[44:47], s77 offen offset:0 lds
    v_mov_b32 v247, 0
    v_mov_b32 v248, 0
    v_mov_b32 v249, 0
    v_mov_b32 v250, 0
    v_mov_b32 v251, 0
    v_mov_b32 v252, 0
    v_mov_b32 v253, 0
    v_mov_b32 v254, 0
    s_add_u32 m0, s33, 69504
    s_nop 0
    buffer_load_dwordx4 v22, s[44:47], s77 offen offset:128 lds
    s_add_u32 m0, s33, 73728
    s_nop 0
    buffer_load_dwordx4 v9, s[48:51], s77 offen lds
    v_mov_b32 v255, 0
    v_mov_b32 v112, 0
    v_mov_b32 v113, 0
    v_mov_b32 v114, 0
    v_mov_b32 v115, 0
    v_mov_b32 v116, 0
    v_mov_b32 v117, 0
    v_mov_b32 v118, 0
    v_mov_b32 v119, 0
    s_load_dword s94, s[10:11], s52 offset:0x80000
    s_load_dword s94, s[10:11], s52 offset:0x80040
    s_load_dword s94, s[10:11], s52 offset:0x80080
    s_load_dword s94, s[10:11], s52 offset:0x800c0
    s_waitcnt vmcnt(14)
    s_barrier
    s_add_u32 m0, s79, 135168
    s_add_u32 s72, s72, 128
    s_and_b32 s78, s72, 0x7ff
    buffer_load_dwordx4 v20, s[36:39], s78 offen lds
    v_mov_b32 v120, 0
    v_mov_b32 v121, 0
    v_mov_b32 v122, 0
    v_mov_b32 v123, 0
    v_mov_b32 v124, 0
    v_mov_b32 v125, 0
    v_mov_b32 v126, 0
    v_mov_b32 v127, 0
    s_add_u32 m0, s79, 136192
    s_nop 0
    buffer_load_dwordx4 v21, s[36:39], s78 offen lds
    v_mov_b32 v128, 0
    v_mov_b32 v129, 0
    v_mov_b32 v130, 0
    v_mov_b32 v131, 0
    v_mov_b32 v132, 0
    v_mov_b32 v133, 0
    v_mov_b32 v134, 0
    v_mov_b32 v135, 0
    s_add_u32 m0, s33, 77824
    s_add_u32 s77, s77, 229376
    buffer_load_dwordx4 v22, s[40:43], s77 offen offset:0 lds
    v_mov_b32 v136, 0
    v_mov_b32 v137, 0
    v_mov_b32 v138, 0
    v_mov_b32 v139, 0
    v_mov_b32 v140, 0
    v_mov_b32 v141, 0
    v_mov_b32 v142, 0
    v_mov_b32 v143, 0
    s_add_u32 m0, s33, 81792
    s_nop 0
    buffer_load_dwordx4 v22, s[40:43], s77 offen offset:128 lds
    v_mov_b32 v144, 0
    v_mov_b32 v145, 0
    v_mov_b32 v146, 0
    v_mov_b32 v147, 0
    v_mov_b32 v148, 0
    v_mov_b32 v149, 0
    v_mov_b32 v150, 0
    v_mov_b32 v151, 0
    s_add_u32 m0, s33, 86016
    s_nop 0
    buffer_load_dwordx4 v22, s[44:47], s77 offen offset:0 lds
    s_add_u32 m0, s33, 89984
    s_nop 0
    buffer_load_dwordx4 v22, s[44:47], s77 offen offset:128 lds
    s_add_u32 m0, s33, 94208
    s_nop 0
    buffer_load_dwordx4 v9, s[48:51], s77 offen lds
    s_load_dword s94, s[10:11], s52 offset:0x80100
    s_load_dword s94, s[10:11], s52 offset:0x80140
    s_load_dword s94, s[10:11], s52 offset:0x80180
    s_load_dword s94, s[10:11], s52 offset:0x801c0
    s_waitcnt vmcnt(28)
    s_movk_i32 s98, 0x4000
L_tokB_chk:
    v_readfirstlane_b32 s100, v18
    v_readfirstlane_b32 s101, v19
    s_nop 1
    s_cmp_lg_u32 s100, 0
    s_cbranch_scc1 L_tokB_ok
    s_sub_u32 s98, s98, 1
    s_cbranch_scc1 L_tokB_ok
    s_sleep 1
    global_load_dwordx2 v[18:19], v8, s[24:25] sc1
    s_waitcnt vmcnt(0)
    s_branch L_tokB_chk
L_tokB_ok:
    s_waitcnt vmcnt(36)
    s_waitcnt vmcnt(14)
    s_barrier
    s_add_u32 m0, s79, 137216
    s_add_u32 s78, s78, 32768
    buffer_load_dwordx4 v20, s[36:39], s78 offen lds
    s_add_u32 m0, s79, 138240
    s_nop 0
    buffer_load_dwordx4 v21, s[36:39], s78 offen lds
    s_add_u32 m0, s33, 16384
    s_add_u32 s77, s77, 229376
    s_cmp_eq_u32 s77, 7340032
    s_cselect_b32 s77, 0, s77
    buffer_load_dwordx4 v22, s[40:43], s77 offen offset:0 lds
    s_add_u32 m0, s33, 20352
    s_nop 0
    buffer_load_dwordx4 v22, s[40:43], s77 offen offset:128 lds
    s_add_u32 m0, s33, 24576
    s_nop 0
    buffer_load_dwordx4 v22, s[44:47], s77 offen offset:0 lds
    s_add_u32 m0, s33, 28544
    s_nop 0
    buffer_load_dwordx4 v22, s[44:47], s77 offen offset:128 lds
    s_add_u32 m0, s33, 32768
    s_nop 0
    buffer_load_dwordx4 v9, s[48:51], s77 offen lds
    s_add_u32 s53, s53, 0x1c0000
    s_load_dword s94, s[16:17], s53 offset:0x0
    s_load_dword s94, s[16:17], s53 offset:0x40
    s_load_dword s94, s[16:17], s53 offset:0x80
    s_load_dword s94, s[16:17], s53 offset:0xc0
    s_cmp_lg_u32 s4, 0
    s_cbranch_scc1 L_fLN
    s_lshl_b32 s91, s28, 4
    s_add_u32 s91, s91, s29
    s_lshl_b32 s91, s91, 7
    s_add_u32 s91, s91, 0x1e80000
    v_mov_b32 v24, s91
    v_mov_b32 v26, s100
    v_mov_b32 v27, s101
    s_mov_b64 exec, 1
    global_store_dwordx2 v24, v[26:27], s[26:27] sc1
    s_mov_b64 exec, -1
L_fLN:
    s_waitcnt vmcnt(14)
    s_barrier
    s_add_u32 m0, s79, 98304
    s_add_u32 s72, s72, 128
    s_and_b32 s78, s72, 0x7ff
    buffer_load_dwordx4 v20, s[36:39], s78 offen lds
    s_add_u32 m0, s79, 99328
    s_nop 0
    buffer_load_dwordx4 v21, s[36:39], s78 offen lds
    s_add_u32 m0, s33, 36864
    s_add_u32 s77, s77, 229376
    buffer_load_dwordx4 v22, s[40:43], s77 offen offset:0 lds
    s_add_u32 m0, s33, 40832
    s_nop 0
    buffer_load_dwordx4 v22, s[40:43], s77 offen offset:128 lds
    s_add_u32 m0, s33, 45056
    s_nop 0
    buffer_load_dwordx4 v22, s[44:47], s77 offen offset:0 lds
    s_add_u32 m0, s33, 49024
    s_nop 0
    buffer_load_dwordx4 v22, s[44:47], s77 offen offset:128 lds
    s_add_u32 m0, s33, 53248
    s_nop 0
    buffer_load_dwordx4 v9, s[48:51], s77 offen lds
    s_load_dword s94, s[16:17], s53 offset:0x100
    s_load_dword s94, s[16:17], s53 offset:0x140
    s_load_dword s94, s[16:17], s53 offset:0x180
    s_load_dword s94, s[16:17], s53 offset:0x1c0
    s_waitcnt vmcnt(14)
    s_barrier
    s_add_u32 m0, s79, 100352
    s_add_u32 s78, s78, 32768
    buffer_load_dwordx4 v20, s[36:39], s78 offen lds
    s_add_u32 m0, s79, 101376
    s_nop 0
    buffer_load_dwordx4 v21, s[36:39], s78 offen lds
    s_add_u32 m0, s33, 57344
    s_add_u32 s77, s77, 229376
    s_cmp_eq_u32 s77, 7340032
    s_cselect_b32 s77, 0, s77
    buffer_load_dwordx4 v22, s[40:43], s77 offen offset:0 lds
    s_add_u32 m0, s33, 61312
    s_nop 0
    buffer_load_dwordx4 v22, s[40:43], s77 offen offset:128 lds
    s_add_u32 m0, s33, 65536
    s_nop 0
    buffer_load_dwordx4 v22, s[44:47], s77 offen offset:0 lds
    s_add_u32 m0, s33, 69504
    s_nop 0
    buffer_load_dwordx4 v22, s[44:47], s77 offen offset:128 lds
    s_add_u32 m0, s33, 73728
    s_nop 0
    buffer_load_dwordx4 v9, s[48:51], s77 offen lds
    s_load_dword s94, s[18:19], s53 offset:0x0
    s_load_dword s94, s[18:19], s53 offset:0x40
    s_load_dword s94, s[18:19], s53 offset:0x80
    s_load_dword s94, s[18:19], s53 offset:0xc0
    s_waitcnt vmcnt(14)
    s_barrier
    s_add_u32 m0, s79, 116736
    s_add_u32 s72, s72, 128
    s_and_b32 s78, s72, 0x7ff
    buffer_load_dwordx4 v20, s[36:39], s78 offen lds
    s_add_u32 m0, s79, 117760
    s_nop 0
    buffer_load_dwordx4 v21, s[36:39], s78 offen lds
    s_add_u32 m0, s33, 77824
    s_add_u32 s77, s77, 229376
    buffer_load_dwordx4 v22, s[40:43], s77 offen offset:0 lds
    s_add_u32 m0, s33, 81792
    s_nop 0
    buffer_load_dwordx4 v22, s[40:43], s77 offen offset:128 lds
    s_add_u32 m0, s33, 86016
    s_nop 0
    buffer_load_dwordx4 v22, s[44:47], s77 offen offset:0 lds
    s_add_u32 m0, s33, 89984
    s_nop 0
    buffer_load_dwordx4 v22, s[44:47], s77 offen offset:128 lds
    s_add_u32 m0, s33, 94208
    s_nop 0
    buffer_load_dwordx4 v9, s[48:51], s77 offen lds
    s_load_dword s94, s[18:19], s53 offset:0x100
    s_load_dword s94, s[18:19], s53 offset:0x140
    s_load_dword s94, s[18:19], s53 offset:0x180
    s_load_dword s94, s[18:19], s53 offset:0x1c0
    s_waitcnt vmcnt(14)
    s_barrier
    s_add_u32 m0, s79, 118784
    s_add_u32 s78, s78, 32768
    buffer_load_dwordx4 v20, s[36:39], s78 offen lds
    s_add_u32 m0, s79, 119808
    s_nop 0
    buffer_load_dwordx4 v21, s[36:39], s78 offen lds
    s_add_u32 m0, s33, 16384
    s_add_u32 s77, s77, 229376
    s_cmp_eq_u32 s77, 7340032
    s_cselect_b32 s77, 0, s77
    buffer_load_dwordx4 v22, s[40:43], s77 offen offset:0 lds
    s_add_u32 m0, s33, 20352
    s_nop 0
    buffer_load_dwordx4 v22, s[40:43], s77 offen offset:128 lds
    s_add_u32 m0, s33, 24576
    s_nop 0
    buffer_load_dwordx4 v22, s[44:47], s77 offen offset:0 lds
    s_add_u32 m0, s33, 28544
    s_nop 0
    buffer_load_dwordx4 v22, s[44:47], s77 offen offset:128 lds
    s_add_u32 m0, s33, 32768
    s_nop 0
    buffer_load_dwordx4 v9, s[48:51], s77 offen lds
    s_add_u32 s52, s52, 0x100000
    s_load_dword s94, s[10:11], s52 offset:0x0
    s_load_dword s94, s[10:11], s52 offset:0x40
    s_load_dword s94, s[10:11], s52 offset:0x80
    s_load_dword s94, s[10:11], s52 offset:0xc0
    s_waitcnt vmcnt(14)
    s_barrier
    s_add_u32 m0, s79, 135168
    s_add_u32 s72, s72, 128
    s_and_b32 s78, s72, 0x7ff
    buffer_load_dwordx4 v20, s[36:39], s78 offen lds
    s_add_u32 m0, s79, 136192
    s_nop 0
    buffer_load_dwordx4 v21, s[36:39], s78 offen lds
    s_add_u32 m0, s33, 36864
    s_add_u32 s77, s77, 229376
    buffer_load_dwordx4 v22, s[40:43], s77 offen offset:0 lds
    s_add_u32 m0, s33, 40832
    s_nop 0
    buffer_load_dwordx4 v22, s[40:43], s77 offen offset:128 lds
    s_add_u32 m0, s33, 45056
    s_nop 0
    buffer_load_dwordx4 v22, s[44:47], s77 offen offset:0 lds
    s_add_u32 m0, s33, 49024
    s_nop 0
    buffer_load_dwordx4 v22, s[44:47], s77 offen offset:128 lds
    s_add_u32 m0, s33, 53248
    s_nop 0
    buffer_load_dwordx4 v9, s[48:51], s77 offen lds
    s_load_dword s94, s[10:11], s52 offset:0x100
    s_load_dword s94, s[10:11], s52 offset:0x140
    s_load_dword s94, s[10:11], s52 offset:0x180
    s_load_dword s94, s[10:11], s52 offset:0x1c0
    v_and_b32 v24, 15, v1
    s_lshl_b32 s91, s28, 4
    s_sub_u32 s92, s91, 16
    s_max_i32 s92, s92, 0
    v_add_u32 v8, s91, v24
    v_add_u32 v25, s92, v24
    v_cmp_lt_u32 vcc, 15, v1
    v_lshl_add_u32 v24, v24, 4, s29
    s_nop 0
    v_cndmask_b32 v8, v8, v25, vcc
    v_cmp_lt_u32 vcc, 31, v1
    s_mov_b32 s91, 0x1e80000
    s_nop 0
    v_cndmask_b32 v8, v8, v24, vcc
    v_lshl_add_u32 v8, v8, 7, s91
    global_load_dwordx2 v[18:19], v8, s[26:27] sc1
    s_waitcnt vmcnt(15)
    s_barrier
    s_add_u32 m0, s79, 137216
    s_add_u32 s78, s78, 32768
    buffer_load_dwordx4 v20, s[36:39], s78 offen lds
    s_add_u32 m0, s79, 138240
    s_nop 0
    buffer_load_dwordx4 v21, s[36:39], s78 offen lds
    s_add_u32 m0, s33, 57344
    s_add_u32 s77, s77, 229376
    s_cmp_eq_u32 s77, 7340032
    s_cselect_b32 s77, 0, s77
    buffer_load_dwordx4 v22, s[40:43], s77 offen offset:0 lds
    s_add_u32 m0, s33, 61312
    s_nop 0
    buffer_load_dwordx4 v22, s[40:43], s77 offen offset:128 lds
    s_add_u32 m0, s33, 65536
    s_nop 0
    buffer_load_dwordx4 v22, s[44:47], s77 offen offset:0 lds
    s_add_u32 m0, s33, 69504
    s_nop 0
    buffer_load_dwordx4 v22, s[44:47], s77 offen offset:128 lds
    s_add_u32 m0, s33, 73728
    s_nop 0
    buffer_load_dwordx4 v9, s[48:51], s77 offen lds
    s_load_dword s94, s[10:11], s52 offset:0x80000
    s_load_dword s94, s[10:11], s52 offset:0x80040
    s_load_dword s94, s[10:11], s52 offset:0x80080
    s_load_dword s94, s[10:11], s52 offset:0x800c0
    s_waitcnt vmcnt(15)
    s_barrier
    s_add_u32 m0, s79, 98304
    s_add_u32 s72, s72, 128
    s_and_b32 s78, s72, 0x7ff
    buffer_load_dwordx4 v20, s[36:39], s78 offen lds
    s_add_u32 m0, s79, 99328
    s_nop 0
    buffer_load_dwordx4 v21, s[36:39], s78 offen lds
    s_add_u32 m0, s33, 77824
    s_add_u32 s77, s77, 229376
    buffer_load_dwordx4 v22, s[40:43], s77 offen offset:0 lds
    s_add_u32 m0, s33, 81792
    s_nop 0
    buffer_load_dwordx4 v22, s[40:43], s77 offen offset:128 lds
    s_add_u32 m0, s33, 86016
    s_nop 0
    buffer_load_dwordx4 v22, s[44:47], s77 offen offset:0 lds
    s_add_u32 m0, s33, 89984
    s_nop 0
    buffer_load_dwordx4 v22, s[44:47], s77 offen offset:128 lds
    s_add_u32 m0, s33, 94208
    s_nop 0
    buffer_load_dwordx4 v9, s[48:51], s77 offen lds
    s_load_dword s94, s[10:11], s52 offset:0x80100
    s_load_dword s94, s[10:11], s52 offset:0x80140
    s_load_dword s94, s[10:11], s52 offset:0x80180
    s_load_dword s94, s[10:11], s52 offset:0x801c0
    s_waitcnt vmcnt(15)
    s_barrier
    s_waitcnt vmcnt(14)
    s_movk_i32 s98, 0x4000
L_pLN_chk:
    v_cmp_ne_u64 vcc, s[100:101], v[18:19]
    s_nop 1
    s_cmp_eq_u64 vcc, 0
    s_cbranch_scc1 L_pLN_ok
    s_sub_u32 s98, s98, 1
    s_cbranch_scc1 L_pLN_ok
    s_sleep 1
    global_load_dwordx2 v[18:19], v8, s[26:27] sc1
    s_waitcnt vmcnt(0)
    s_branch L_pLN_chk
L_pLN_ok:
    s_mul_i32 s91, s29, 20480
    s_mul_i32 s92, s4, 320
    s_add_u32 s91, s91, s92
    s_add_u32 s91, s91, 0x1e10000
    v_and_b32 v24, 15, v1
    v_mul_u32_u24 v24, 1280, v24
    v_and_b32 v25, 48, v1
    v_add3_u32 v24, v24, v25, s91
    global_load_dwordx4 v[88:91], v24, s[26:27] offset:0 sc1
    global_load_dwordx4 v[92:95], v24, s[26:27] offset:64 sc1
    global_load_dwordx4 v[96:99], v24, s[26:27] offset:128 sc1
    global_load_dwordx4 v[100:103], v24, s[26:27] offset:192 sc1
    global_load_dwordx4 v[104:107], v24, s[26:27] offset:256 sc1
    s_add_u32 s92, s92, 159744
    v_add_u32 v25, s92, v25
    s_lshl_b32 s91, s28, 2
    s_add_u32 s91, s91, s4
    s_lshl_b32 s91, s91, 8
    s_add_u32 s91, s91, 0x1e00000
    v_and_b32 v27, 31, v1
    v_lshl_add_u32 v26, v27, 3, s91
    global_load_dwordx2 v[28:29], v26, s[26:27] sc1
    s_lshl_b32 s91, s4, 9
    s_add_u32 s91, s91, 161024
    v_lshl_add_u32 v27, v27, 4, s91
    s_add_u32 m0, s79, 100352
    s_add_u32 s78, s78, 32768
    buffer_load_dwordx4 v20, s[36:39], s78 offen lds
    s_add_u32 m0, s79, 101376
    s_nop 0
    buffer_load_dwordx4 v21, s[36:39], s78 offen lds
    s_add_u32 m0, s33, 16384
    s_add_u32 s77, s77, 229376
    s_cmp_eq_u32 s77, 7340032
    s_cselect_b32 s77, 0, s77
    buffer_load_dwordx4 v22, s[40:43], s77 offen offset:0 lds
    s_add_u32 m0, s33, 20352
    s_nop 0
    buffer_load_dwordx4 v22, s[40:43], s77 offen offset:128 lds
    s_add_u32 m0, s33, 24576
    s_nop 0
    buffer_load_dwordx4 v22, s[44:47], s77 offen offset:0 lds
    s_add_u32 m0, s33, 28544
    s_nop 0
    buffer_load_dwordx4 v22, s[44:47], s77 offen offset:128 lds
    s_add_u32 m0, s33, 32768
    s_nop 0
    buffer_load_dwordx4 v9, s[48:51], s77 offen lds
    s_add_u32 s52, s52, 0x100000
    s_load_dword s94, s[10:11], s52 offset:0x0
    s_load_dword s94, s[10:11], s52 offset:0x40
    s_load_dword s94, s[10:11], s52 offset:0x80
    s_load_dword s94, s[10:11], s52 offset:0xc0
    s_waitcnt vmcnt(20)
    s_barrier
    s_add_u32 m0, s79, 116736
    s_add_u32 s72, s72, 128
    s_and_b32 s78, s72, 0x7ff
    buffer_load_dwordx4 v20, s[36:39], s78 offen lds
    s_add_u32 m0, s79, 117760
    s_nop 0
    buffer_load_dwordx4 v21, s[36:39], s78 offen lds
    s_add_u32 m0, s33, 36864
    s_add_u32 s77, s77, 229376
    buffer_load_dwordx4 v22, s[40:43], s77 offen offset:0 lds
    s_add_u32 m0, s33, 40832
    s_nop 0
    buffer_load_dwordx4 v22, s[40:43], s77 offen offset:128 lds
    s_add_u32 m0, s33, 45056
    s_nop 0
    buffer_load_dwordx4 v22, s[44:47], s77 offen offset:0 lds
    s_add_u32 m0, s33, 49024
    s_nop 0
    buffer_load_dwordx4 v22, s[44:47], s77 offen offset:128 lds
    s_add_u32 m0, s33, 53248
    s_nop 0
    buffer_load_dwordx4 v9, s[48:51], s77 offen lds
    s_load_dword s94, s[10:11], s52 offset:0x100
    s_load_dword s94, s[10:11], s52 offset:0x140
    s_load_dword s94, s[10:11], s52 offset:0x180
    s_load_dword s94, s[10:11], s52 offset:0x1c0
    s_waitcnt vmcnt(20)
    s_barrier
    s_add_u32 m0, s79, 118784
    s_add_u32 s78, s78, 32768
    buffer_load_dwordx4 v20, s[36:39], s78 offen lds
    s_waitcnt vmcnt(15)
    v_rcp_f32 v30, v29
    v_mul_f32 v32, -1.0, v28
    v_mul_f32 v35, v29, v29
    v_fma_f32 v31, -v29, v30, 1.0
    v_fma_f32 v30, v31, v30, v30
    v_mul_f32 v33, 0xc0135761, v30
    v_mul_f32 v31, v30, v30
    s_add_u32 m0, s79, 119808
    s_nop 0
    buffer_load_dwordx4 v21, s[36:39], s78 offen lds
    v_mul_f32 v31, v31, v30
    v_mul_f32 v34, 0xbdd2d3e8, v31
    ds_write_b128 v27, v[32:35]
    v_add_f32_dpp v88, v88, v88 row_ror:8 row_mask:0xf bank_mask:0xf
    v_add_f32_dpp v89, v89, v89 row_ror:8 row_mask:0xf bank_mask:0xf
    v_add_f32_dpp v90, v90, v90 row_ror:8 row_mask:0xf bank_mask:0xf
    v_add_f32_dpp v91, v91, v91 row_ror:8 row_mask:0xf bank_mask:0xf
    v_add_f32_dpp v92, v92, v92 row_ror:8 row_mask:0xf bank_mask:0xf
    v_add_f32_dpp v93, v93, v93 row_ror:8 row_mask:0xf bank_mask:0xf
    s_add_u32 m0, s33, 57344
    s_add_u32 s77, s77, 229376
    s_cmp_eq_u32 s77, 7340032
    s_cselect_b32 s77, 0, s77
    buffer_load_dwordx4 v22, s[40:43], s77 offen offset:0 lds
    v_add_f32_dpp v94, v94, v94 row_ror:8 row_mask:0xf bank_mask:0xf
    v_add_f32_dpp v95, v95, v95 row_ror:8 row_mask:0xf bank_mask:0xf
    v_add_f32_dpp v96, v96, v96 row_ror:8 row_mask:0xf bank_mask:0xf
    v_add_f32_dpp v97, v97, v97 row_ror:8 row_mask:0xf bank_mask:0xf
    v_add_f32_dpp v98, v98, v98 row_ror:8 row_mask:0xf bank_mask:0xf
    v_add_f32_dpp v99, v99, v99 row_ror:8 row_mask:0xf bank_mask:0xf
    v_add_f32_dpp v100, v100, v100 row_ror:8 row_mask:0xf bank_mask:0xf
    v_add_f32_dpp v101, v101, v101 row_ror:8 row_mask:0xf bank_mask:0xf
    s_add_u32 m0, s33, 61312
    s_nop 0
    buffer_load_dwordx4 v22, s[40:43], s77 offen offset:128 lds
    v_add_f32_dpp v102, v102, v102 row_ror:8 row_mask:0xf bank_mask:0xf
    v_add_f32_dpp v103, v103, v103 row_ror:8 row_mask:0xf bank_mask:0xf
    v_add_f32_dpp v104, v104, v104 row_ror:8 row_mask:0xf bank_mask:0xf
    v_add_f32_dpp v105, v105, v105 row_ror:8 row_mask:0xf bank_mask:0xf
    v_add_f32_dpp v106, v106, v106 row_ror:8 row_mask:0xf bank_mask:0xf
    v_add_f32_dpp v107, v107, v107 row_ror:8 row_mask:0xf bank_mask:0xf
    v_add_f32_dpp v88, v88, v88 row_ror:4 row_mask:0xf bank_mask:0xf
    v_add_f32_dpp v89, v89, v89 row_ror:4 row_mask:0xf bank_mask:0xf
    s_add_u32 m0, s33, 65536
    s_nop 0
    buffer_load_dwordx4 v22, s[44:47], s77 offen offset:0 lds
    v_add_f32_dpp v90, v90, v90 row_ror:4 row_mask:0xf bank_mask:0xf
    v_add_f32_dpp v91, v91, v91 row_ror:4 row_mask:0xf bank_mask:0xf
    v_add_f32_dpp v92, v92, v92 row_ror:4 row_mask:0xf bank_mask:0xf
    v_add_f32_dpp v93, v93, v93 row_ror:4 row_mask:0xf bank_mask:0xf
    v_add_f32_dpp v94, v94, v94 row_ror:4 row_mask:0xf bank_mask:0xf
    v_add_f32_dpp v95, v95, v95 row_ror:4 row_mask:0xf bank_mask:0xf
    v_add_f32_dpp v96, v96, v96 row_ror:4 row_mask:0xf bank_mask:0xf
    v_add_f32_dpp v97, v97, v97 row_ror:4 row_mask:0xf bank_mask:0xf
    s_add_u32 m0, s33, 69504
    s_nop 0
    buffer_load_dwordx4 v22, s[44:47], s77 offen offset:128 lds
    s_add_u32 m0, s33, 73728
    s_nop 0
    buffer_load_dwordx4 v9, s[48:51], s77 offen lds
    v_add_f32_dpp v98, v98, v98 row_ror:4 row_mask:0xf bank_mask:0xf
    v_add_f32_dpp v99, v99, v99 row_ror:4 row_mask:0xf bank_mask:0xf
    v_add_f32_dpp v100, v100, v100 row_ror:4 row_mask:0xf bank_mask:0xf
    v_add_f32_dpp v101, v101, v101 row_ror:4 row_mask:0xf bank_mask:0xf
    v_add_f32_dpp v102, v102, v102 row_ror:4 row_mask:0xf bank_mask:0xf
    v_add_f32_dpp v103, v103, v103 row_ror:4 row_mask:0xf bank_mask:0xf
    v_add_f32_dpp v104, v104, v104 row_ror:4 row_mask:0xf bank_mask:0xf
    v_add_f32_dpp v105, v105, v105 row_ror:4 row_mask:0xf bank_mask:0xf
    s_add_u32 s53, s53, 0x1c0000
    s_load_dword s94, s[16:17], s53 offset:0x0
    s_load_dword s94, s[16:17], s53 offset:0x40
    s_load_dword s94, s[16:17], s53 offset:0x80
    s_load_dword s94, s[16:17], s53 offset:0xc0
    s_waitcnt vmcnt(14)
    s_barrier
    s_mov_b32 s36, s26
    s_mov_b32 s37, s27
    s_mov_b32 s38, 0x400000
    s_mov_b32 s39, 0x20000
    s_add_u32 m0, s33, 77824
    s_add_u32 s77, s77, 229376
    buffer_load_dwordx4 v22, s[40:43], s77 offen offset:0 lds
    v_add_f32_dpp v106, v106, v106 row_ror:4 row_mask:0xf bank_mask:0xf
    v_add_f32_dpp v107, v107, v107 row_ror:4 row_mask:0xf bank_mask:0xf
    v_add_f32_dpp v88, v88, v88 row_ror:2 row_mask:0xf bank_mask:0xf
    v_add_f32_dpp v89, v89, v89 row_ror:2 row_mask:0xf bank_mask:0xf
    v_add_f32_dpp v90, v90, v90 row_ror:2 row_mask:0xf bank_mask:0xf
    v_add_f32_dpp v91, v91, v91 row_ror:2 row_mask:0xf bank_mask:0xf
    v_add_f32_dpp v92, v92, v92 row_ror:2 row_mask:0xf bank_mask:0xf
    v_add_f32_dpp v93, v93, v93 row_ror:2 row_mask:0xf bank_mask:0xf
    s_add_u32 m0, s33, 81792
    s_nop 0
    buffer_load_dwordx4 v22, s[40:43], s77 offen offset:128 lds
    v_add_f32_dpp v94, v94, v94 row_ror:2 row_mask:0xf bank_mask:0xf
    v_add_f32_dpp v95, v95, v95 row_ror:2 row_mask:0xf bank_mask:0xf
    v_add_f32_dpp v96, v96, v96 row_ror:2 row_mask:0xf bank_mask:0xf
    v_add_f32_dpp v97, v97, v97 row_ror:2 row_mask:0xf bank_mask:0xf
    v_add_f32_dpp v98, v98, v98 row_ror:2 row_mask:0xf bank_mask:0xf
    v_add_f32_dpp v99, v99, v99 row_ror:2 row_mask:0xf bank_mask:0xf
    v_add_f32_dpp v100, v100, v100 row_ror:2 row_mask:0xf bank_mask:0xf
    v_add_f32_dpp v101, v101, v101 row_ror:2 row_mask:0xf bank_mask:0xf
    s_add_u32 m0, s33, 86016
    s_nop 0
    buffer_load_dwordx4 v22, s[44:47], s77 offen offset:0 lds
    v_add_f32_dpp v102, v102, v102 row_ror:2 row_mask:0xf bank_mask:0xf
    v_add_f32_dpp v103, v103, v103 row_ror:2 row_mask:0xf bank_mask:0xf
    v_add_f32_dpp v104, v104, v104 row_ror:2 row_mask:0xf bank_mask:0xf
    v_add_f32_dpp v105, v105, v105 row_ror:2 row_mask:0xf bank_mask:0xf
    v_add_f32_dpp v106, v106, v106 row_ror:2 row_mask:0xf bank_mask:0xf
    v_add_f32_dpp v107, v107, v107 row_ror:2 row_mask:0xf bank_mask:0xf
    v_add_f32_dpp v88, v88, v88 row_ror:1 row_mask:0xf bank_mask:0xf
    v_add_f32_dpp v89, v89, v89 row_ror:1 row_mask:0xf bank_mask:0xf
    s_add_u32 m0, s33, 89984
    s_nop 0
    buffer_load_dwordx4 v22, s[44:47], s77 offen offset:128 lds
    v_add_f32_dpp v90, v90, v90 row_ror:1 row_mask:0xf bank_mask:0xf
    v_add_f32_dpp v91, v91, v91 row_ror:1 row_mask:0xf bank_mask:0xf
    v_add_f32_dpp v92, v92, v92 row_ror:1 row_mask:0xf bank_mask:0xf
    v_add_f32_dpp v93, v93, v93 row_ror:1 row_mask:0xf bank_mask:0xf
    v_add_f32_dpp v94, v94, v94 row_ror:1 row_mask:0xf bank_mask:0xf
    v_add_f32_dpp v95, v95, v95 row_ror:1 row_mask:0xf bank_mask:0xf
    v_add_f32_dpp v96, v96, v96 row_ror:1 row_mask:0xf bank_mask:0xf
    v_add_f32_dpp v97, v97, v97 row_ror:1 row_mask:0xf bank_mask:0xf
    s_add_u32 m0, s33, 94208
    s_nop 0
    buffer_load_dwordx4 v9, s[48:51], s77 offen lds
    v_add_f32_dpp v98, v98, v98 row_ror:1 row_mask:0xf bank_mask:0xf
    v_add_f32_dpp v99, v99, v99 row_ror:1 row_mask:0xf bank_mask:0xf
    v_add_f32_dpp v100, v100, v100 row_ror:1 row_mask:0xf bank_mask:0xf
    v_add_f32_dpp v101, v101, v101 row_ror:1 row_mask:0xf bank_mask:0xf
    v_add_f32_dpp v102, v102, v102 row_ror:1 row_mask:0xf bank_mask:0xf
    v_add_f32_dpp v103, v103, v103 row_ror:1 row_mask:0xf bank_mask:0xf
    v_add_f32_dpp v104, v104, v104 row_ror:1 row_mask:0xf bank_mask:0xf
    v_add_f32_dpp v105, v105, v105 row_ror:1 row_mask:0xf bank_mask:0xf
    s_add_u32 m0, s79, 135168
    s_mov_b32 s78, 0
    buffer_load_dwordx4 v20, s[36:39], s78 offen sc1 lds
    s_add_u32 m0, s79, 136192
    s_nop 0
    buffer_load_dwordx4 v21, s[36:39], s78 offen sc1 lds
    v_add_f32_dpp v106, v106, v106 row_ror:1 row_mask:0xf bank_mask:0xf
    v_add_f32_dpp v107, v107, v107 row_ror:1 row_mask:0xf bank_mask:0xf
    s_mov_b32 s92, 0x00010001
    s_mov_b32 s93, s92
    s_mov_b64 exec, s[92:93]
    ds_write_b128 v25, v[88:91] offset:0
    ds_write_b128 v25, v[92:95] offset:64
    ds_write_b128 v25, v[96:99] offset:128
    ds_write_b128 v25, v[100:103] offset:192
    ds_write_b128 v25, v[104:107] offset:256
    s_mov_b64 exec, -1
    s_waitcnt vmcnt(14)
    s_barrier
    s_lshl_b32 s85, s29, 7
    s_add_u32 s40, s10, s85
    s_addc_u32 s41, s11, 0
    s_sub_u32 s42, 6291456, s85
    s_mov_b32 s43, 0x20000
    s_add_u32 s86, s85, 4096
    s_add_u32 s44, s10, s86
    s_addc_u32 s45, s11, 0
    s_sub_u32 s46, 6291456, s86
    s_mov_b32 s47, 0x20000
    s_add_u32 s86, s85, 5120
    s_add_u32 s48, s16, s86
    s_addc_u32 s49, s17, 0
    s_sub_u32 s50, 7340032, s86
    s_mov_b32 s51, 0x20000
    s_add_u32 s52, s18, s86
    s_addc_u32 s53, s19, 0
    s_sub_u32 s54, 7340032, s86
    s_mov_b32 s55, 0x20000
    v_lshrrev_b32 v36, 4, v1
    v_and_b32 v37, 15, v1
    v_and_b32 v38, 1, v36
    v_xor_b32 v38, s5, v38
    v_lshrrev_b32 v39, 1, v36
    v_lshl_add_u32 v38, v38, 1, v39
    v_lshlrev_b32 v38, 8, v38
    v_lshl_add_u32 v9, v37, 4, v38
    s_add_u32 m0, s79, 137216
    s_mov_b32 s78, 32768
    buffer_load_dwordx4 v20, s[36:39], s78 offen sc1 lds
    v_mov_b32 v88, 0
    v_mov_b32 v89, 0
    v_mov_b32 v90, 0
    v_mov_b32 v91, 0
    v_mov_b32 v92, 0
    v_mov_b32 v93, 0
    v_mov_b32 v94, 0
    v_mov_b32 v95, 0
    s_add_u32 m0, s79, 138240
    s_nop 0
    buffer_load_dwordx4 v21, s[36:39], s78 offen sc1 lds
    v_mov_b32 v96, 0
    v_mov_b32 v97, 0
    v_mov_b32 v98, 0
    v_mov_b32 v99, 0
    v_mov_b32 v100, 0
    v_mov_b32 v101, 0
    v_mov_b32 v102, 0
    v_mov_b32 v103, 0
    s_add_u32 m0, s81, 151552
    s_mov_b32 s78, 0
    s_mov_b64 exec, 0xffffffff
    buffer_load_dwordx4 v3, s[36:39], s78 offen sc1 lds
    s_mov_b64 exec, -1
    v_mov_b32 v104, 0
    v_mov_b32 v105, 0
    v_mov_b32 v106, 0
    v_mov_b32 v107, 0
    v_mov_b32 v108, 0
    v_mov_b32 v109, 0
    v_mov_b32 v110, 0
    v_mov_b32 v111, 0
    s_add_u32 m0, s33, 16384
    s_mov_b32 s76, 0
    buffer_load_dwordx4 v23, s[40:43], s76 offen offset:0 lds
    s_add_u32 m0, s33, 18432
    s_nop 0
    buffer_load_dwordx4 v23, s[40:43], s76 offen offset:2048 lds
    v_lshrrev_b32 v24, 4, v1
    v_and_b32 v25, 1, v24
    v_lshrrev_b32 v24, 1, v24
    v_lshlrev_b32 v24, 8, v24
    v_lshl_add_u32 v24, v25, 10, v24
    v_and_b32 v25, 15, v1
    v_lshl_add_u32 v8, v25, 4, v24
    s_add_u32 m0, s33, 24576
    s_nop 0
    buffer_load_dwordx4 v23, s[44:47], s76 offen offset:0 lds
    s_add_u32 m0, s33, 28672
    s_mov_b32 s77, 0
    buffer_load_dwordx4 v22, s[48:51], s77 offen offset:0 lds
    s_add_u32 m0, s33, 32768
    s_nop 0
    buffer_load_dwordx4 v22, s[52:55], s77 offen offset:0 lds
    s_waitcnt vmcnt(15)
    s_barrier
    s_add_u32 m0, s79, 98304
    s_mov_b32 s78, 128
    buffer_load_dwordx4 v20, s[36:39], s78 offen sc1 lds
    s_add_u32 m0, s79, 99328
    s_nop 0
    buffer_load_dwordx4 v21, s[36:39], s78 offen sc1 lds
    s_add_u32 m0, s33, 36864
    s_mov_b32 s76, 196608
    buffer_load_dwordx4 v23, s[40:43], s76 offen offset:0 lds
    s_add_u32 m0, s33, 38912
    s_nop 0
    buffer_load_dwordx4 v23, s[40:43], s76 offen offset:2048 lds
    s_add_u32 m0, s33, 45056
    s_nop 0
    buffer_load_dwordx4 v23, s[44:47], s76 offen offset:0 lds
    s_add_u32 m0, s33, 49152
    s_mov_b32 s77, 229376
    buffer_load_dwordx4 v22, s[48:51], s77 offen offset:0 lds
    s_add_u32 m0, s33, 53248
    s_nop 0
    buffer_load_dwordx4 v22, s[52:55], s77 offen offset:0 lds
    s_waitcnt vmcnt(17)
    s_barrier
    s_add_u32 m0, s79, 100352
    s_mov_b32 s78, 32896
    buffer_load_dwordx4 v20, s[36:39], s78 offen sc1 lds
    s_add_u32 m0, s79, 101376
    s_nop 0
    buffer_load_dwordx4 v21, s[36:39], s78 offen sc1 lds
    s_add_u32 m0, s81, 114688
    s_mov_b32 s78, 128
    s_mov_b64 exec, 0xffffffff
    buffer_load_dwordx4 v3, s[36:39], s78 offen sc1 lds
    s_mov_b64 exec, -1
    s_add_u32 m0, s33, 57344
    s_mov_b32 s76, 393216
    buffer_load_dwordx4 v23, s[40:43], s76 offen offset:0 lds
    s_add_u32 m0, s33, 59392
    s_nop 0
    buffer_load_dwordx4 v23, s[40:43], s76 offen offset:2048 lds
    s_add_u32 m0, s33, 65536
    s_nop 0
    buffer_load_dwordx4 v23, s[44:47], s76 offen offset:0 lds
    s_add_u32 m0, s33, 69632
    s_mov_b32 s77, 458752
    buffer_load_dwordx4 v22, s[48:51], s77 offen offset:0 lds
    s_add_u32 m0, s33, 73728
    s_nop 0
    buffer_load_dwordx4 v22, s[52:55], s77 offen offset:0 lds
    s_waitcnt lgkmcnt(0)
    s_waitcnt vmcnt(15)
    s_barrier
    s_setprio 1
    v_add_u32 v14, s80, v16
    v_add_u32 v15, s80, v17
    s_add_u32 s84, s80, s95
    v_add_u32 v18, s84, v16
    v_add_u32 v19, s84, v17
    s_add_u32 s80, s80, 18432
    s_cmp_ge_u32 s80, 153600
    s_cselect_b32 s84, 55296, 0
    s_sub_u32 s80, s80, s84
    ds_read_b64_tr_b16 v[64:65], v4 offset:4096
    ds_read_b64_tr_b16 v[66:67], v4 offset:4608
    ds_read_b128 v[24:27], v14 offset:0
    ds_read_b128 v[28:31], v14 offset:2048
    ds_read_b128 v[32:35], v14 offset:4096
    ds_read_b128 v[36:39], v14 offset:6144
    ds_read_b64_tr_b16 v[68:69], v5 offset:4096
    ds_read_b64_tr_b16 v[70:71], v5 offset:4608
    ds_read_b64_tr_b16 v[72:73], v4 offset:8192
    ds_read_b64_tr_b16 v[74:75], v4 offset:8704
    ds_read_b128 v[56:59], v18
    s_mov_b32 s34, 7
.p2align 6
L_p2:
    s_waitcnt lgkmcnt(8)
    v_mfma_f32_16x16x32_bf16 v[88:91], v[64:67], v[24:27], v[88:91]
    ds_read_b64_tr_b16 v[76:77], v5 offset:8192
    s_waitcnt lgkmcnt(8)
    v_mfma_f32_16x16x32_bf16 v[92:95], v[64:67], v[28:31], v[92:95]
    ds_read_b64_tr_b16 v[78:79], v5 offset:8704
    s_waitcnt lgkmcnt(8)
    v_mfma_f32_16x16x32_bf16 v[96:99], v[64:67], v[32:35], v[96:99]
    ds_read_b64_tr_b16 v[80:81], v4 offset:0
    s_waitcnt lgkmcnt(8)
    v_mfma_f32_16x16x32_bf16 v[100:103], v[64:67], v[36:39], v[100:103]
    ds_read_b64_tr_b16 v[82:83], v4 offset:512
    s_waitcnt lgkmcnt(4)
    v_mfma_f32_16x16x32_bf16 v[248:251], v[64:67], v[56:59], v[248:251]
    v_mfma_f32_16x16x32_bf16 v[104:107], v[68:71], v[24:27], v[104:107]
    ds_read_b64_tr_b16 v[64:65], v5 offset:0
    v_mfma_f32_16x16x32_bf16 v[108:111], v[68:71], v[28:31], v[108:111]
    v_mfma_f32_16x16x32_bf16 v[112:115], v[68:71], v[32:35], v[112:115]
    ds_read_b64_tr_b16 v[66:67], v5 offset:512
    v_mfma_f32_16x16x32_bf16 v[116:119], v[68:71], v[36:39], v[116:119]
    v_mfma_f32_16x16x32_bf16 v[120:123], v[24:27], v[72:75], v[120:123]
    ds_read_b64_tr_b16 v[68:69], v4 offset:12288
    v_mfma_f32_16x16x32_bf16 v[124:127], v[28:31], v[72:75], v[124:127]
    v_mfma_f32_16x16x32_bf16 v[128:131], v[32:35], v[72:75], v[128:131]
    ds_read_b64_tr_b16 v[70:71], v4 offset:12800
    v_mfma_f32_16x16x32_bf16 v[132:135], v[36:39], v[72:75], v[132:135]
    v_mfma_f32_16x16x32_bf16 v[252:255], v[56:59], v[72:75], v[252:255]
    s_waitcnt lgkmcnt(6)
    v_mfma_f32_16x16x32_bf16 v[136:139], v[24:27], v[76:79], v[136:139]
    ds_read_b64_tr_b16 v[72:73], v4 offset:16384
    v_mfma_f32_16x16x32_bf16 v[140:143], v[28:31], v[76:79], v[140:143]
    v_mfma_f32_16x16x32_bf16 v[144:147], v[32:35], v[76:79], v[144:147]
    ds_read_b64_tr_b16 v[74:75], v4 offset:16896
    v_mfma_f32_16x16x32_bf16 v[148:151], v[36:39], v[76:79], v[148:151]
    s_waitcnt lgkmcnt(6)
    v_mfma_f32_16x16x32_bf16 v[152:155], v[80:83], v[24:27], v[152:155]
    ds_read_b64_tr_b16 v[76:77], v5 offset:12288
    v_mfma_f32_16x16x32_bf16 v[156:159], v[80:83], v[28:31], v[156:159]
    v_mfma_f32_16x16x32_bf16 v[160:163], v[80:83], v[32:35], v[160:163]
    ds_read_b64_tr_b16 v[78:79], v5 offset:12800
    v_mfma_f32_16x16x32_bf16 v[164:167], v[80:83], v[36:39], v[164:167]
    s_waitcnt lgkmcnt(6)
    v_mfma_f32_16x16x32_bf16 v[168:171], v[64:67], v[24:27], v[168:171]
    ds_read_b64_tr_b16 v[80:81], v5 offset:16384
    v_mfma_f32_16x16x32_bf16 v[172:175], v[64:67], v[28:31], v[172:175]
    v_mfma_f32_16x16x32_bf16 v[176:179], v[64:67], v[32:35], v[176:179]
    ds_read_b64_tr_b16 v[82:83], v5 offset:16896
    v_mfma_f32_16x16x32_bf16 v[180:183], v[64:67], v[36:39], v[180:183]
    s_waitcnt lgkmcnt(6)
    v_mfma_f32_16x16x32_bf16 v[184:187], v[68:71], v[24:27], v[184:187]
    v_mfma_f32_16x16x32_bf16 v[188:191], v[68:71], v[28:31], v[188:191]
    v_mfma_f32_16x16x32_bf16 v[192:195], v[68:71], v[32:35], v[192:195]
    v_mfma_f32_16x16x32_bf16 v[196:199], v[68:71], v[36:39], v[196:199]
    s_waitcnt vmcnt(8) lgkmcnt(0)
    s_barrier
    v_mfma_f32_16x16x32_bf16 v[200:203], v[72:75], v[24:27], v[200:203]
    ds_read_b64_tr_b16 v[64:65], v4 offset:24576
    v_mfma_f32_16x16x32_bf16 v[204:207], v[72:75], v[28:31], v[204:207]
    ds_read_b64_tr_b16 v[66:67], v4 offset:25088
    v_mfma_f32_16x16x32_bf16 v[208:211], v[72:75], v[32:35], v[208:211]
    ds_read_b128 v[40:43], v15 offset:0
    v_mfma_f32_16x16x32_bf16 v[212:215], v[72:75], v[36:39], v[212:215]
    ds_read_b128 v[44:47], v15 offset:2048
    v_mfma_f32_16x16x32_bf16 v[216:219], v[76:79], v[24:27], v[216:219]
    ds_read_b128 v[48:51], v15 offset:4096
    v_mfma_f32_16x16x32_bf16 v[220:223], v[76:79], v[28:31], v[220:223]
    ds_read_b128 v[52:55], v15 offset:6144
    v_mfma_f32_16x16x32_bf16 v[224:227], v[76:79], v[32:35], v[224:227]
    ds_read_b64_tr_b16 v[68:69], v5 offset:24576
    v_mfma_f32_16x16x32_bf16 v[228:231], v[76:79], v[36:39], v[228:231]
    ds_read_b64_tr_b16 v[70:71], v5 offset:25088
    v_mfma_f32_16x16x32_bf16 v[232:235], v[80:83], v[24:27], v[232:235]
    ds_read_b64_tr_b16 v[72:73], v4 offset:28672
    v_mfma_f32_16x16x32_bf16 v[236:239], v[80:83], v[28:31], v[236:239]
    ds_read_b64_tr_b16 v[74:75], v4 offset:29184
    v_mfma_f32_16x16x32_bf16 v[240:243], v[80:83], v[32:35], v[240:243]
    ds_read_b128 v[60:63], v19
    v_mfma_f32_16x16x32_bf16 v[244:247], v[80:83], v[36:39], v[244:247]
    s_waitcnt lgkmcnt(8)
    v_mfma_f32_16x16x32_bf16 v[88:91], v[64:67], v[40:43], v[88:91]
    ds_read_b64_tr_b16 v[76:77], v5 offset:28672
    s_waitcnt lgkmcnt(8)
    v_mfma_f32_16x16x32_bf16 v[92:95], v[64:67], v[44:47], v[92:95]
    ds_read_b64_tr_b16 v[78:79], v5 offset:29184
    s_waitcnt lgkmcnt(8)
    v_mfma_f32_16x16x32_bf16 v[96:99], v[64:67], v[48:51], v[96:99]
    ds_read_b64_tr_b16 v[80:81], v4 offset:20480
    s_waitcnt lgkmcnt(8)
    v_mfma_f32_16x16x32_bf16 v[100:103], v[64:67], v[52:55], v[100:103]
    ds_read_b64_tr_b16 v[82:83], v4 offset:20992
    s_waitcnt lgkmcnt(4)
    v_mfma_f32_16x16x32_bf16 v[248:251], v[64:67], v[60:63], v[248:251]
    v_mfma_f32_16x16x32_bf16 v[104:107], v[68:71], v[40:43], v[104:107]
    ds_read_b64_tr_b16 v[64:65], v5 offset:20480
    v_mfma_f32_16x16x32_bf16 v[108:111], v[68:71], v[44:47], v[108:111]
    v_add_u32 v14, s80, v16
    v_mfma_f32_16x16x32_bf16 v[112:115], v[68:71], v[48:51], v[112:115]
    ds_read_b64_tr_b16 v[66:67], v5 offset:20992
    v_mfma_f32_16x16x32_bf16 v[116:119], v[68:71], v[52:55], v[116:119]
    v_add_u32 v15, s80, v17
    v_mfma_f32_16x16x32_bf16 v[120:123], v[40:43], v[72:75], v[120:123]
    ds_read_b64_tr_b16 v[68:69], v4 offset:32768
    v_mfma_f32_16x16x32_bf16 v[124:127], v[44:47], v[72:75], v[124:127]
    s_add_u32 s84, s80, s95
    v_mfma_f32_16x16x32_bf16 v[128:131], v[48:51], v[72:75], v[128:131]
    ds_read_b64_tr_b16 v[70:71], v4 offset:33280
    v_mfma_f32_16x16x32_bf16 v[132:135], v[52:55], v[72:75], v[132:135]
    v_add_u32 v18, s84, v16
    v_mfma_f32_16x16x32_bf16 v[252:255], v[60:63], v[72:75], v[252:255]
    s_waitcnt lgkmcnt(6)
    v_mfma_f32_16x16x32_bf16 v[136:139], v[40:43], v[76:79], v[136:139]
    ds_read_b64_tr_b16 v[72:73], v4 offset:36864
    v_mfma_f32_16x16x32_bf16 v[140:143], v[44:47], v[76:79], v[140:143]
    v_add_u32 v19, s84, v17
    v_mfma_f32_16x16x32_bf16 v[144:147], v[48:51], v[76:79], v[144:147]
    ds_read_b64_tr_b16 v[74:75], v4 offset:37376
    v_mfma_f32_16x16x32_bf16 v[148:151], v[52:55], v[76:79], v[148:151]
    s_add_u32 s80, s80, 18432
    s_waitcnt lgkmcnt(6)
    v_mfma_f32_16x16x32_bf16 v[152:155], v[80:83], v[40:43], v[152:155]
    ds_read_b64_tr_b16 v[76:77], v5 offset:32768
    v_mfma_f32_16x16x32_bf16 v[156:159], v[80:83], v[44:47], v[156:159]
    s_cmp_ge_u32 s80, 153600
    s_cselect_b32 s84, 55296, 0
    v_mfma_f32_16x16x32_bf16 v[160:163], v[80:83], v[48:51], v[160:163]
    ds_read_b64_tr_b16 v[78:79], v5 offset:33280
    v_mfma_f32_16x16x32_bf16 v[164:167], v[80:83], v[52:55], v[164:167]
    s_sub_u32 s80, s80, s84
    s_waitcnt lgkmcnt(6)
    v_mfma_f32_16x16x32_bf16 v[168:171], v[64:67], v[40:43], v[168:171]
    ds_read_b64_tr_b16 v[80:81], v5 offset:36864
    v_mfma_f32_16x16x32_bf16 v[172:175], v[64:67], v[44:47], v[172:175]
    v_mfma_f32_16x16x32_bf16 v[176:179], v[64:67], v[48:51], v[176:179]
    ds_read_b64_tr_b16 v[82:83], v5 offset:37376
    v_mfma_f32_16x16x32_bf16 v[180:183], v[64:67], v[52:55], v[180:183]
    s_waitcnt lgkmcnt(6)
    v_mfma_f32_16x16x32_bf16 v[184:187], v[68:71], v[40:43], v[184:187]
    v_mfma_f32_16x16x32_bf16 v[188:191], v[68:71], v[44:47], v[188:191]
    v_mfma_f32_16x16x32_bf16 v[192:195], v[68:71], v[48:51], v[192:195]
    v_mfma_f32_16x16x32_bf16 v[196:199], v[68:71], v[52:55], v[196:199]
    s_waitcnt vmcnt(0) lgkmcnt(0)
    s_barrier
    v_mfma_f32_16x16x32_bf16 v[200:203], v[72:75], v[40:43], v[200:203]
    ds_read_b64_tr_b16 v[64:65], v6 offset:4096
    v_mfma_f32_16x16x32_bf16 v[204:207], v[72:75], v[44:47], v[204:207]
    ds_read_b64_tr_b16 v[66:67], v6 offset:4608
    v_mfma_f32_16x16x32_bf16 v[208:211], v[72:75], v[48:51], v[208:211]
    ds_read_b128 v[24:27], v14 offset:0
    v_mfma_f32_16x16x32_bf16 v[212:215], v[72:75], v[52:55], v[212:215]
    ds_read_b128 v[28:31], v14 offset:2048
    v_mfma_f32_16x16x32_bf16 v[216:219], v[76:79], v[40:43], v[216:219]
    ds_read_b128 v[32:35], v14 offset:4096
    v_mfma_f32_16x16x32_bf16 v[220:223], v[76:79], v[44:47], v[220:223]
    ds_read_b128 v[36:39], v14 offset:6144
    v_mfma_f32_16x16x32_bf16 v[224:227], v[76:79], v[48:51], v[224:227]
    ds_read_b64_tr_b16 v[68:69], v7 offset:4096
    v_mfma_f32_16x16x32_bf16 v[228:231], v[76:79], v[52:55], v[228:231]
    ds_read_b64_tr_b16 v[70:71], v7 offset:4608
    v_mfma_f32_16x16x32_bf16 v[232:235], v[80:83], v[40:43], v[232:235]
    ds_read_b64_tr_b16 v[72:73], v6 offset:8192
    v_mfma_f32_16x16x32_bf16 v[236:239], v[80:83], v[44:47], v[236:239]
    ds_read_b64_tr_b16 v[74:75], v6 offset:8704
    v_mfma_f32_16x16x32_bf16 v[240:243], v[80:83], v[48:51], v[240:243]
    ds_read_b128 v[56:59], v18
    v_mfma_f32_16x16x32_bf16 v[244:247], v[80:83], v[52:55], v[244:247]
    s_waitcnt lgkmcnt(8)
    v_mfma_f32_16x16x32_bf16 v[88:91], v[64:67], v[24:27], v[88:91]
    ds_read_b64_tr_b16 v[76:77], v7 offset:8192
    s_waitcnt lgkmcnt(8)
    v_mfma_f32_16x16x32_bf16 v[92:95], v[64:67], v[28:31], v[92:95]
    ds_read_b64_tr_b16 v[78:79], v7 offset:8704
    s_waitcnt lgkmcnt(8)
    v_mfma_f32_16x16x32_bf16 v[96:99], v[64:67], v[32:35], v[96:99]
    ds_read_b64_tr_b16 v[80:81], v6 offset:0
    s_waitcnt lgkmcnt(8)
    v_mfma_f32_16x16x32_bf16 v[100:103], v[64:67], v[36:39], v[100:103]
    ds_read_b64_tr_b16 v[82:83], v6 offset:512
    s_waitcnt lgkmcnt(4)
    v_mfma_f32_16x16x32_bf16 v[248:251], v[64:67], v[56:59], v[248:251]
    v_mfma_f32_16x16x32_bf16 v[104:107], v[68:71], v[24:27], v[104:107]
    ds_read_b64_tr_b16 v[64:65], v7 offset:0
    v_mfma_f32_16x16x32_bf16 v[108:111], v[68:71], v[28:31], v[108:111]
    v_mfma_f32_16x16x32_bf16 v[112:115], v[68:71], v[32:35], v[112:115]
    ds_read_b64_tr_b16 v[66:67], v7 offset:512
    v_mfma_f32_16x16x32_bf16 v[116:119], v[68:71], v[36:39], v[116:119]
    v_mfma_f32_16x16x32_bf16 v[120:123], v[24:27], v[72:75], v[120:123]
    ds_read_b64_tr_b16 v[68:69], v6 offset:12288
    v_mfma_f32_16x16x32_bf16 v[124:127], v[28:31], v[72:75], v[124:127]
    v_mfma_f32_16x16x32_bf16 v[128:131], v[32:35], v[72:75], v[128:131]
    ds_read_b64_tr_b16 v[70:71], v6 offset:12800
    v_mfma_f32_16x16x32_bf16 v[132:135], v[36:39], v[72:75], v[132:135]
    v_mfma_f32_16x16x32_bf16 v[252:255], v[56:59], v[72:75], v[252:255]
    s_waitcnt lgkmcnt(6)
    v_mfma_f32_16x16x32_bf16 v[136:139], v[24:27], v[76:79], v[136:139]
    ds_read_b64_tr_b16 v[72:73], v6 offset:16384
    v_mfma_f32_16x16x32_bf16 v[140:143], v[28:31], v[76:79], v[140:143]
    v_mfma_f32_16x16x32_bf16 v[144:147], v[32:35], v[76:79], v[144:147]
    ds_read_b64_tr_b16 v[74:75], v6 offset:16896
    v_mfma_f32_16x16x32_bf16 v[148:151], v[36:39], v[76:79], v[148:151]
    s_waitcnt lgkmcnt(6)
    v_mfma_f32_16x16x32_bf16 v[152:155], v[80:83], v[24:27], v[152:155]
    ds_read_b64_tr_b16 v[76:77], v7 offset:12288
    v_mfma_f32_16x16x32_bf16 v[156:159], v[80:83], v[28:31], v[156:159]
    v_mfma_f32_16x16x32_bf16 v[160:163], v[80:83], v[32:35], v[160:163]
    ds_read_b64_tr_b16 v[78:79], v7 offset:12800
    v_mfma_f32_16x16x32_bf16 v[164:167], v[80:83], v[36:39], v[164:167]
    s_waitcnt lgkmcnt(6)
    v_mfma_f32_16x16x32_bf16 v[168:171], v[64:67], v[24:27], v[168:171]
    ds_read_b64_tr_b16 v[80:81], v7 offset:16384
    v_mfma_f32_16x16x32_bf16 v[172:175], v[64:67], v[28:31], v[172:175]
    v_mfma_f32_16x16x32_bf16 v[176:179], v[64:67], v[32:35], v[176:179]
    ds_read_b64_tr_b16 v[82:83], v7 offset:16896
    v_mfma_f32_16x16x32_bf16 v[180:183], v[64:67], v[36:39], v[180:183]
    s_waitcnt lgkmcnt(6)
    v_mfma_f32_16x16x32_bf16 v[184:187], v[68:71], v[24:27], v[184:187]
    v_mfma_f32_16x16x32_bf16 v[188:191], v[68:71], v[28:31], v[188:191]
    v_mfma_f32_16x16x32_bf16 v[192:195], v[68:71], v[32:35], v[192:195]
    v_mfma_f32_16x16x32_bf16 v[196:199], v[68:71], v[36:39], v[196:199]
    s_waitcnt lgkmcnt(0)
    s_barrier
    v_mfma_f32_16x16x32_bf16 v[200:203], v[72:75], v[24:27], v[200:203]
    ds_read_b64_tr_b16 v[64:65], v6 offset:24576
    v_mfma_f32_16x16x32_bf16 v[204:207], v[72:75], v[28:31], v[204:207]
    ds_read_b64_tr_b16 v[66:67], v6 offset:25088
    v_mfma_f32_16x16x32_bf16 v[208:211], v[72:75], v[32:35], v[208:211]
    ds_read_b128 v[40:43], v15 offset:0
    v_mfma_f32_16x16x32_bf16 v[212:215], v[72:75], v[36:39], v[212:215]
    ds_read_b128 v[44:47], v15 offset:2048
    v_mfma_f32_16x16x32_bf16 v[216:219], v[76:79], v[24:27], v[216:219]
    ds_read_b128 v[48:51], v15 offset:4096
    v_mfma_f32_16x16x32_bf16 v[220:223], v[76:79], v[28:31], v[220:223]
    ds_read_b128 v[52:55], v15 offset:6144
    v_mfma_f32_16x16x32_bf16 v[224:227], v[76:79], v[32:35], v[224:227]
    ds_read_b64_tr_b16 v[68:69], v7 offset:24576
    v_mfma_f32_16x16x32_bf16 v[228:231], v[76:79], v[36:39], v[228:231]
    ds_read_b64_tr_b16 v[70:71], v7 offset:25088
    v_mfma_f32_16x16x32_bf16 v[232:235], v[80:83], v[24:27], v[232:235]
    ds_read_b64_tr_b16 v[72:73], v6 offset:28672
    v_mfma_f32_16x16x32_bf16 v[236:239], v[80:83], v[28:31], v[236:239]
    ds_read_b64_tr_b16 v[74:75], v6 offset:29184
    v_mfma_f32_16x16x32_bf16 v[240:243], v[80:83], v[32:35], v[240:243]
    ds_read_b128 v[60:63], v19
    v_mfma_f32_16x16x32_bf16 v[244:247], v[80:83], v[36:39], v[244:247]
    s_waitcnt lgkmcnt(8)
    v_mfma_f32_16x16x32_bf16 v[88:91], v[64:67], v[40:43], v[88:91]
    ds_read_b64_tr_b16 v[76:77], v7 offset:28672
    s_waitcnt lgkmcnt(8)
    v_mfma_f32_16x16x32_bf16 v[92:95], v[64:67], v[44:47], v[92:95]
    ds_read_b64_tr_b16 v[78:79], v7 offset:29184
    s_waitcnt lgkmcnt(8)
    v_mfma_f32_16x16x32_bf16 v[96:99], v[64:67], v[48:51], v[96:99]
    ds_read_b64_tr_b16 v[80:81], v6 offset:20480
    s_waitcnt lgkmcnt(8)
    v_mfma_f32_16x16x32_bf16 v[100:103], v[64:67], v[52:55], v[100:103]
    ds_read_b64_tr_b16 v[82:83], v6 offset:20992
    s_waitcnt lgkmcnt(4)
    v_mfma_f32_16x16x32_bf16 v[248:251], v[64:67], v[60:63], v[248:251]
    v_mfma_f32_16x16x32_bf16 v[104:107], v[68:71], v[40:43], v[104:107]
    ds_read_b64_tr_b16 v[64:65], v7 offset:20480
    v_mfma_f32_16x16x32_bf16 v[108:111], v[68:71], v[44:47], v[108:111]
    v_add_u32 v14, s80, v16
    v_mfma_f32_16x16x32_bf16 v[112:115], v[68:71], v[48:51], v[112:115]
    ds_read_b64_tr_b16 v[66:67], v7 offset:20992
    v_mfma_f32_16x16x32_bf16 v[116:119], v[68:71], v[52:55], v[116:119]
    v_add_u32 v15, s80, v17
    v_mfma_f32_16x16x32_bf16 v[120:123], v[40:43], v[72:75], v[120:123]
    ds_read_b64_tr_b16 v[68:69], v6 offset:32768
    v_mfma_f32_16x16x32_bf16 v[124:127], v[44:47], v[72:75], v[124:127]
    s_add_u32 s84, s80, s95
    v_mfma_f32_16x16x32_bf16 v[128:131], v[48:51], v[72:75], v[128:131]
    ds_read_b64_tr_b16 v[70:71], v6 offset:33280
    v_mfma_f32_16x16x32_bf16 v[132:135], v[52:55], v[72:75], v[132:135]
    v_add_u32 v18, s84, v16
    v_mfma_f32_16x16x32_bf16 v[252:255], v[60:63], v[72:75], v[252:255]
    s_waitcnt lgkmcnt(6)
    v_mfma_f32_16x16x32_bf16 v[136:139], v[40:43], v[76:79], v[136:139]
    ds_read_b64_tr_b16 v[72:73], v6 offset:36864
    v_mfma_f32_16x16x32_bf16 v[140:143], v[44:47], v[76:79], v[140:143]
    v_add_u32 v19, s84, v17
    v_mfma_f32_16x16x32_bf16 v[144:147], v[48:51], v[76:79], v[144:147]
    ds_read_b64_tr_b16 v[74:75], v6 offset:37376
    v_mfma_f32_16x16x32_bf16 v[148:151], v[52:55], v[76:79], v[148:151]
    s_add_u32 s80, s80, 18432
    s_waitcnt lgkmcnt(6)
    v_mfma_f32_16x16x32_bf16 v[152:155], v[80:83], v[40:43], v[152:155]
    ds_read_b64_tr_b16 v[76:77], v7 offset:32768
    v_mfma_f32_16x16x32_bf16 v[156:159], v[80:83], v[44:47], v[156:159]
    s_cmp_ge_u32 s80, 153600
    s_cselect_b32 s84, 55296, 0
    v_mfma_f32_16x16x32_bf16 v[160:163], v[80:83], v[48:51], v[160:163]
    ds_read_b64_tr_b16 v[78:79], v7 offset:33280
    v_mfma_f32_16x16x32_bf16 v[164:167], v[80:83], v[52:55], v[164:167]
    s_sub_u32 s80, s80, s84
    s_waitcnt lgkmcnt(6)
    v_mfma_f32_16x16x32_bf16 v[168:171], v[64:67], v[40:43], v[168:171]
    ds_read_b64_tr_b16 v[80:81], v7 offset:36864
    v_mfma_f32_16x16x32_bf16 v[172:175], v[64:67], v[44:47], v[172:175]
    v_mfma_f32_16x16x32_bf16 v[176:179], v[64:67], v[48:51], v[176:179]
    ds_read_b64_tr_b16 v[82:83], v7 offset:37376
    v_mfma_f32_16x16x32_bf16 v[180:183], v[64:67], v[52:55], v[180:183]
    s_waitcnt lgkmcnt(6)
    v_mfma_f32_16x16x32_bf16 v[184:187], v[68:71], v[40:43], v[184:187]
    v_mfma_f32_16x16x32_bf16 v[188:191], v[68:71], v[44:47], v[188:191]
    v_mfma_f32_16x16x32_bf16 v[192:195], v[68:71], v[48:51], v[192:195]
    v_mfma_f32_16x16x32_bf16 v[196:199], v[68:71], v[52:55], v[196:199]
    s_waitcnt lgkmcnt(0)
    s_barrier
    v_mfma_f32_16x16x32_bf16 v[200:203], v[72:75], v[40:43], v[200:203]
    ds_read_b64_tr_b16 v[64:65], v4 offset:4096
    v_mfma_f32_16x16x32_bf16 v[204:207], v[72:75], v[44:47], v[204:207]
    ds_read_b64_tr_b16 v[66:67], v4 offset:4608
    v_mfma_f32_16x16x32_bf16 v[208:211], v[72:75], v[48:51], v[208:211]
    ds_read_b128 v[24:27], v14 offset:0
    v_mfma_f32_16x16x32_bf16 v[212:215], v[72:75], v[52:55], v[212:215]
    ds_read_b128 v[28:31], v14 offset:2048
    v_mfma_f32_16x16x32_bf16 v[216:219], v[76:79], v[40:43], v[216:219]
    ds_read_b128 v[32:35], v14 offset:4096
    v_mfma_f32_16x16x32_bf16 v[220:223], v[76:79], v[44:47], v[220:223]
    ds_read_b128 v[36:39], v14 offset:6144
    v_mfma_f32_16x16x32_bf16 v[224:227], v[76:79], v[48:51], v[224:227]
    ds_read_b64_tr_b16 v[68:69], v5 offset:4096
    v_mfma_f32_16x16x32_bf16 v[228:231], v[76:79], v[52:55], v[228:231]
    ds_read_b64_tr_b16 v[70:71], v5 offset:4608
    v_mfma_f32_16x16x32_bf16 v[232:235], v[80:83], v[40:43], v[232:235]
    ds_read_b64_tr_b16 v[72:73], v4 offset:8192
    v_mfma_f32_16x16x32_bf16 v[236:239], v[80:83], v[44:47], v[236:239]
    ds_read_b64_tr_b16 v[74:75], v4 offset:8704
    v_mfma_f32_16x16x32_bf16 v[240:243], v[80:83], v[48:51], v[240:243]
    ds_read_b128 v[56:59], v18
    v_mfma_f32_16x16x32_bf16 v[244:247], v[80:83], v[52:55], v[244:247]
    s_sub_u32 s34, s34, 1
    s_cmp_lg_u32 s34, 0
    s_cbranch_scc1 L_p2
    s_waitcnt lgkmcnt(8)
    v_mfma_f32_16x16x32_bf16 v[88:91], v[64:67], v[24:27], v[88:91]
    ds_read_b64_tr_b16 v[76:77], v5 offset:8192
    s_waitcnt lgkmcnt(8)
    v_mfma_f32_16x16x32_bf16 v[92:95], v[64:67], v[28:31], v[92:95]
    ds_read_b64_tr_b16 v[78:79], v5 offset:8704
    s_waitcnt lgkmcnt(8)
    v_mfma_f32_16x16x32_bf16 v[96:99], v[64:67], v[32:35], v[96:99]
    ds_read_b64_tr_b16 v[80:81], v4 offset:0
    s_waitcnt lgkmcnt(8)
    v_mfma_f32_16x16x32_bf16 v[100:103], v[64:67], v[36:39], v[100:103]
    ds_read_b64_tr_b16 v[82:83], v4 offset:512
    s_waitcnt lgkmcnt(4)
    v_mfma_f32_16x16x32_bf16 v[248:251], v[64:67], v[56:59], v[248:251]
    v_mfma_f32_16x16x32_bf16 v[104:107], v[68:71], v[24:27], v[104:107]
    ds_read_b64_tr_b16 v[64:65], v5 offset:0
    v_mfma_f32_16x16x32_bf16 v[108:111], v[68:71], v[28:31], v[108:111]
    v_mfma_f32_16x16x32_bf16 v[112:115], v[68:71], v[32:35], v[112:115]
    ds_read_b64_tr_b16 v[66:67], v5 offset:512
    v_mfma_f32_16x16x32_bf16 v[116:119], v[68:71], v[36:39], v[116:119]
    v_mfma_f32_16x16x32_bf16 v[120:123], v[24:27], v[72:75], v[120:123]
    ds_read_b64_tr_b16 v[68:69], v4 offset:12288
    v_mfma_f32_16x16x32_bf16 v[124:127], v[28:31], v[72:75], v[124:127]
    v_mfma_f32_16x16x32_bf16 v[128:131], v[32:35], v[72:75], v[128:131]
    ds_read_b64_tr_b16 v[70:71], v4 offset:12800
    v_mfma_f32_16x16x32_bf16 v[132:135], v[36:39], v[72:75], v[132:135]
    v_mfma_f32_16x16x32_bf16 v[252:255], v[56:59], v[72:75], v[252:255]
    s_waitcnt lgkmcnt(6)
    v_mfma_f32_16x16x32_bf16 v[136:139], v[24:27], v[76:79], v[136:139]
    ds_read_b64_tr_b16 v[72:73], v4 offset:16384
    v_mfma_f32_16x16x32_bf16 v[140:143], v[28:31], v[76:79], v[140:143]
    v_mfma_f32_16x16x32_bf16 v[144:147], v[32:35], v[76:79], v[144:147]
    ds_read_b64_tr_b16 v[74:75], v4 offset:16896
    v_mfma_f32_16x16x32_bf16 v[148:151], v[36:39], v[76:79], v[148:151]
    s_waitcnt lgkmcnt(6)
    v_mfma_f32_16x16x32_bf16 v[152:155], v[80:83], v[24:27], v[152:155]
    ds_read_b64_tr_b16 v[76:77], v5 offset:12288
    v_mfma_f32_16x16x32_bf16 v[156:159], v[80:83], v[28:31], v[156:159]
    v_mfma_f32_16x16x32_bf16 v[160:163], v[80:83], v[32:35], v[160:163]
    ds_read_b64_tr_b16 v[78:79], v5 offset:12800
    v_mfma_f32_16x16x32_bf16 v[164:167], v[80:83], v[36:39], v[164:167]
    s_waitcnt lgkmcnt(6)
    v_mfma_f32_16x16x32_bf16 v[168:171], v[64:67], v[24:27], v[168:171]
    ds_read_b64_tr_b16 v[80:81], v5 offset:16384
    v_mfma_f32_16x16x32_bf16 v[172:175], v[64:67], v[28:31], v[172:175]
    v_mfma_f32_16x16x32_bf16 v[176:179], v[64:67], v[32:35], v[176:179]
    ds_read_b64_tr_b16 v[82:83], v5 offset:16896
    v_mfma_f32_16x16x32_bf16 v[180:183], v[64:67], v[36:39], v[180:183]
    s_waitcnt lgkmcnt(6)
    v_mfma_f32_16x16x32_bf16 v[184:187], v[68:71], v[24:27], v[184:187]
    v_mfma_f32_16x16x32_bf16 v[188:191], v[68:71], v[28:31], v[188:191]
    v_mfma_f32_16x16x32_bf16 v[192:195], v[68:71], v[32:35], v[192:195]
    v_mfma_f32_16x16x32_bf16 v[196:199], v[68:71], v[36:39], v[196:199]
    s_waitcnt lgkmcnt(0)
    s_barrier
    v_mfma_f32_16x16x32_bf16 v[200:203], v[72:75], v[24:27], v[200:203]
    ds_read_b64_tr_b16 v[64:65], v4 offset:24576
    v_mfma_f32_16x16x32_bf16 v[204:207], v[72:75], v[28:31], v[204:207]
    ds_read_b64_tr_b16 v[66:67], v4 offset:25088
    v_mfma_f32_16x16x32_bf16 v[208:211], v[72:75], v[32:35], v[208:211]
    ds_read_b128 v[40:43], v15 offset:0
    v_mfma_f32_16x16x32_bf16 v[212:215], v[72:75], v[36:39], v[212:215]
    ds_read_b128 v[44:47], v15 offset:2048
    v_mfma_f32_16x16x32_bf16 v[216:219], v[76:79], v[24:27], v[216:219]
    ds_read_b128 v[48:51], v15 offset:4096
    v_mfma_f32_16x16x32_bf16 v[220:223], v[76:79], v[28:31], v[220:223]
    ds_read_b128 v[52:55], v15 offset:6144
    v_mfma_f32_16x16x32_bf16 v[224:227], v[76:79], v[32:35], v[224:227]
    ds_read_b64_tr_b16 v[68:69], v5 offset:24576
    v_mfma_f32_16x16x32_bf16 v[228:231], v[76:79], v[36:39], v[228:231]
    ds_read_b64_tr_b16 v[70:71], v5 offset:25088
    v_mfma_f32_16x16x32_bf16 v[232:235], v[80:83], v[24:27], v[232:235]
    ds_read_b64_tr_b16 v[72:73], v4 offset:28672
    v_mfma_f32_16x16x32_bf16 v[236:239], v[80:83], v[28:31], v[236:239]
    ds_read_b64_tr_b16 v[74:75], v4 offset:29184
    v_mfma_f32_16x16x32_bf16 v[240:243], v[80:83], v[32:35], v[240:243]
    ds_read_b128 v[60:63], v19
    v_mfma_f32_16x16x32_bf16 v[244:247], v[80:83], v[36:39], v[244:247]
    s_waitcnt lgkmcnt(8)
    v_mfma_f32_16x16x32_bf16 v[88:91], v[64:67], v[40:43], v[88:91]
    ds_read_b64_tr_b16 v[76:77], v5 offset:28672
    s_waitcnt lgkmcnt(8)
    v_mfma_f32_16x16x32_bf16 v[92:95], v[64:67], v[44:47], v[92:95]
    ds_read_b64_tr_b16 v[78:79], v5 offset:29184
    s_waitcnt lgkmcnt(8)
    v_mfma_f32_16x16x32_bf16 v[96:99], v[64:67], v[48:51], v[96:99]
    ds_read_b64_tr_b16 v[80:81], v4 offset:20480
    s_waitcnt lgkmcnt(8)
    v_mfma_f32_16x16x32_bf16 v[100:103], v[64:67], v[52:55], v[100:103]
    ds_read_b64_tr_b16 v[82:83], v4 offset:20992
    s_waitcnt lgkmcnt(4)
    v_mfma_f32_16x16x32_bf16 v[248:251], v[64:67], v[60:63], v[248:251]
    v_mfma_f32_16x16x32_bf16 v[104:107], v[68:71], v[40:43], v[104:107]
    ds_read_b64_tr_b16 v[64:65], v5 offset:20480
    v_mfma_f32_16x16x32_bf16 v[108:111], v[68:71], v[44:47], v[108:111]
    v_add_u32 v14, s80, v16
    v_mfma_f32_16x16x32_bf16 v[112:115], v[68:71], v[48:51], v[112:115]
    ds_read_b64_tr_b16 v[66:67], v5 offset:20992
    v_mfma_f32_16x16x32_bf16 v[116:119], v[68:71], v[52:55], v[116:119]
    v_add_u32 v15, s80, v17
    v_mfma_f32_16x16x32_bf16 v[120:123], v[40:43], v[72:75], v[120:123]
    ds_read_b64_tr_b16 v[68:69], v4 offset:32768
    v_mfma_f32_16x16x32_bf16 v[124:127], v[44:47], v[72:75], v[124:127]
    s_add_u32 s84, s80, s95
    v_mfma_f32_16x16x32_bf16 v[128:131], v[48:51], v[72:75], v[128:131]
    ds_read_b64_tr_b16 v[70:71], v4 offset:33280
    v_mfma_f32_16x16x32_bf16 v[132:135], v[52:55], v[72:75], v[132:135]
    v_add_u32 v18, s84, v16
    v_mfma_f32_16x16x32_bf16 v[252:255], v[60:63], v[72:75], v[252:255]
    s_waitcnt lgkmcnt(6)
    v_mfma_f32_16x16x32_bf16 v[136:139], v[40:43], v[76:79], v[136:139]
    ds_read_b64_tr_b16 v[72:73], v4 offset:36864
    v_mfma_f32_16x16x32_bf16 v[140:143], v[44:47], v[76:79], v[140:143]
    v_add_u32 v19, s84, v17
    v_mfma_f32_16x16x32_bf16 v[144:147], v[48:51], v[76:79], v[144:147]
    ds_read_b64_tr_b16 v[74:75], v4 offset:37376
    v_mfma_f32_16x16x32_bf16 v[148:151], v[52:55], v[76:79], v[148:151]
    s_add_u32 s80, s80, 18432
    s_waitcnt lgkmcnt(6)
    v_mfma_f32_16x16x32_bf16 v[152:155], v[80:83], v[40:43], v[152:155]
    ds_read_b64_tr_b16 v[76:77], v5 offset:32768
    v_mfma_f32_16x16x32_bf16 v[156:159], v[80:83], v[44:47], v[156:159]
    s_cmp_ge_u32 s80, 153600
    s_cselect_b32 s84, 55296, 0
    v_mfma_f32_16x16x32_bf16 v[160:163], v[80:83], v[48:51], v[160:163]
    ds_read_b64_tr_b16 v[78:79], v5 offset:33280
    v_mfma_f32_16x16x32_bf16 v[164:167], v[80:83], v[52:55], v[164:167]
    s_sub_u32 s80, s80, s84
    s_waitcnt lgkmcnt(6)
    v_mfma_f32_16x16x32_bf16 v[168:171], v[64:67], v[40:43], v[168:171]
    ds_read_b64_tr_b16 v[80:81], v5 offset:36864
    v_mfma_f32_16x16x32_bf16 v[172:175], v[64:67], v[44:47], v[172:175]
    v_mfma_f32_16x16x32_bf16 v[176:179], v[64:67], v[48:51], v[176:179]
    ds_read_b64_tr_b16 v[82:83], v5 offset:37376
    v_mfma_f32_16x16x32_bf16 v[180:183], v[64:67], v[52:55], v[180:183]
    s_waitcnt lgkmcnt(6)
    v_mfma_f32_16x16x32_bf16 v[184:187], v[68:71], v[40:43], v[184:187]
    v_mfma_f32_16x16x32_bf16 v[188:191], v[68:71], v[44:47], v[188:191]
    v_mfma_f32_16x16x32_bf16 v[192:195], v[68:71], v[48:51], v[192:195]
    v_mfma_f32_16x16x32_bf16 v[196:199], v[68:71], v[52:55], v[196:199]
    s_waitcnt lgkmcnt(0)
    s_barrier
    v_mfma_f32_16x16x32_bf16 v[200:203], v[72:75], v[40:43], v[200:203]
    ds_read_b64_tr_b16 v[64:65], v6 offset:4096
    v_mfma_f32_16x16x32_bf16 v[204:207], v[72:75], v[44:47], v[204:207]
    ds_read_b64_tr_b16 v[66:67], v6 offset:4608
    v_mfma_f32_16x16x32_bf16 v[208:211], v[72:75], v[48:51], v[208:211]
    ds_read_b128 v[24:27], v14 offset:0
    v_mfma_f32_16x16x32_bf16 v[212:215], v[72:75], v[52:55], v[212:215]
    ds_read_b128 v[28:31], v14 offset:2048
    v_mfma_f32_16x16x32_bf16 v[216:219], v[76:79], v[40:43], v[216:219]
    ds_read_b128 v[32:35], v14 offset:4096
    v_mfma_f32_16x16x32_bf16 v[220:223], v[76:79], v[44:47], v[220:223]
    ds_read_b128 v[36:39], v14 offset:6144
    v_mfma_f32_16x16x32_bf16 v[224:227], v[76:79], v[48:51], v[224:227]
    ds_read_b64_tr_b16 v[68:69], v7 offset:4096
    v_mfma_f32_16x16x32_bf16 v[228:231], v[76:79], v[52:55], v[228:231]
    ds_read_b64_tr_b16 v[70:71], v7 offset:4608
    v_mfma_f32_16x16x32_bf16 v[232:235], v[80:83], v[40:43], v[232:235]
    ds_read_b64_tr_b16 v[72:73], v6 offset:8192
    v_mfma_f32_16x16x32_bf16 v[236:239], v[80:83], v[44:47], v[236:239]
    ds_read_b64_tr_b16 v[74:75], v6 offset:8704
    v_mfma_f32_16x16x32_bf16 v[240:243], v[80:83], v[48:51], v[240:243]
    ds_read_b128 v[56:59], v18
    v_mfma_f32_16x16x32_bf16 v[244:247], v[80:83], v[52:55], v[244:247]
    s_waitcnt lgkmcnt(8)
    v_mfma_f32_16x16x32_bf16 v[88:91], v[64:67], v[24:27], v[88:91]
    ds_read_b64_tr_b16 v[76:77], v7 offset:8192
    s_waitcnt lgkmcnt(8)
    v_mfma_f32_16x16x32_bf16 v[92:95], v[64:67], v[28:31], v[92:95]
    ds_read_b64_tr_b16 v[78:79], v7 offset:8704
    s_waitcnt lgkmcnt(8)
    v_mfma_f32_16x16x32_bf16 v[96:99], v[64:67], v[32:35], v[96:99]
    ds_read_b64_tr_b16 v[80:81], v6 offset:0
    s_waitcnt lgkmcnt(8)
    v_mfma_f32_16x16x32_bf16 v[100:103], v[64:67], v[36:39], v[100:103]
    ds_read_b64_tr_b16 v[82:83], v6 offset:512
    s_waitcnt lgkmcnt(4)
    v_mfma_f32_16x16x32_bf16 v[248:251], v[64:67], v[56:59], v[248:251]
    v_mfma_f32_16x16x32_bf16 v[104:107], v[68:71], v[24:27], v[104:107]
    ds_read_b64_tr_b16 v[64:65], v7 offset:0
    v_mfma_f32_16x16x32_bf16 v[108:111], v[68:71], v[28:31], v[108:111]
    v_mfma_f32_16x16x32_bf16 v[112:115], v[68:71], v[32:35], v[112:115]
    ds_read_b64_tr_b16 v[66:67], v7 offset:512
    v_mfma_f32_16x16x32_bf16 v[116:119], v[68:71], v[36:39], v[116:119]
    v_mfma_f32_16x16x32_bf16 v[120:123], v[24:27], v[72:75], v[120:123]
    ds_read_b64_tr_b16 v[68:69], v6 offset:12288
    v_mfma_f32_16x16x32_bf16 v[124:127], v[28:31], v[72:75], v[124:127]
    v_mfma_f32_16x16x32_bf16 v[128:131], v[32:35], v[72:75], v[128:131]
    ds_read_b64_tr_b16 v[70:71], v6 offset:12800
    v_mfma_f32_16x16x32_bf16 v[132:135], v[36:39], v[72:75], v[132:135]
    v_mfma_f32_16x16x32_bf16 v[252:255], v[56:59], v[72:75], v[252:255]
    s_waitcnt lgkmcnt(6)
    v_mfma_f32_16x16x32_bf16 v[136:139], v[24:27], v[76:79], v[136:139]
    ds_read_b64_tr_b16 v[72:73], v6 offset:16384
    v_mfma_f32_16x16x32_bf16 v[140:143], v[28:31], v[76:79], v[140:143]
    v_mfma_f32_16x16x32_bf16 v[144:147], v[32:35], v[76:79], v[144:147]
    ds_read_b64_tr_b16 v[74:75], v6 offset:16896
    v_mfma_f32_16x16x32_bf16 v[148:151], v[36:39], v[76:79], v[148:151]
    s_waitcnt lgkmcnt(6)
    v_mfma_f32_16x16x32_bf16 v[152:155], v[80:83], v[24:27], v[152:155]
    ds_read_b64_tr_b16 v[76:77], v7 offset:12288
    v_mfma_f32_16x16x32_bf16 v[156:159], v[80:83], v[28:31], v[156:159]
    v_mfma_f32_16x16x32_bf16 v[160:163], v[80:83], v[32:35], v[160:163]
    ds_read_b64_tr_b16 v[78:79], v7 offset:12800
    v_mfma_f32_16x16x32_bf16 v[164:167], v[80:83], v[36:39], v[164:167]
    s_waitcnt lgkmcnt(6)
    v_mfma_f32_16x16x32_bf16 v[168:171], v[64:67], v[24:27], v[168:171]
    ds_read_b64_tr_b16 v[80:81], v7 offset:16384
    v_mfma_f32_16x16x32_bf16 v[172:175], v[64:67], v[28:31], v[172:175]
    v_mfma_f32_16x16x32_bf16 v[176:179], v[64:67], v[32:35], v[176:179]
    ds_read_b64_tr_b16 v[82:83], v7 offset:16896
    v_mfma_f32_16x16x32_bf16 v[180:183], v[64:67], v[36:39], v[180:183]
    s_waitcnt lgkmcnt(6)
    v_mfma_f32_16x16x32_bf16 v[184:187], v[68:71], v[24:27], v[184:187]
    v_mfma_f32_16x16x32_bf16 v[188:191], v[68:71], v[28:31], v[188:191]
    v_mfma_f32_16x16x32_bf16 v[192:195], v[68:71], v[32:35], v[192:195]
    v_mfma_f32_16x16x32_bf16 v[196:199], v[68:71], v[36:39], v[196:199]
    s_waitcnt lgkmcnt(0)
    s_barrier
    v_mfma_f32_16x16x32_bf16 v[200:203], v[72:75], v[24:27], v[200:203]
    ds_read_b64_tr_b16 v[64:65], v6 offset:24576
    v_mfma_f32_16x16x32_bf16 v[204:207], v[72:75], v[28:31], v[204:207]
    ds_read_b64_tr_b16 v[66:67], v6 offset:25088
    v_mfma_f32_16x16x32_bf16 v[208:211], v[72:75], v[32:35], v[208:211]
    ds_read_b128 v[40:43], v15 offset:0
    v_mfma_f32_16x16x32_bf16 v[212:215], v[72:75], v[36:39], v[212:215]
    ds_read_b128 v[44:47], v15 offset:2048
    v_mfma_f32_16x16x32_bf16 v[216:219], v[76:79], v[24:27], v[216:219]
    ds_read_b128 v[48:51], v15 offset:4096
    v_mfma_f32_16x16x32_bf16 v[220:223], v[76:79], v[28:31], v[220:223]
    ds_read_b128 v[52:55], v15 offset:6144
    v_mfma_f32_16x16x32_bf16 v[224:227], v[76:79], v[32:35], v[224:227]
    ds_read_b64_tr_b16 v[68:69], v7 offset:24576
    v_mfma_f32_16x16x32_bf16 v[228:231], v[76:79], v[36:39], v[228:231]
    ds_read_b64_tr_b16 v[70:71], v7 offset:25088
    v_mfma_f32_16x16x32_bf16 v[232:235], v[80:83], v[24:27], v[232:235]
    ds_read_b64_tr_b16 v[72:73], v6 offset:28672
    v_mfma_f32_16x16x32_bf16 v[236:239], v[80:83], v[28:31], v[236:239]
    ds_read_b64_tr_b16 v[74:75], v6 offset:29184
    v_mfma_f32_16x16x32_bf16 v[240:243], v[80:83], v[32:35], v[240:243]
    ds_read_b128 v[60:63], v19
    v_mfma_f32_16x16x32_bf16 v[244:247], v[80:83], v[36:39], v[244:247]
    s_waitcnt lgkmcnt(8)
    v_mfma_f32_16x16x32_bf16 v[88:91], v[64:67], v[40:43], v[88:91]
    ds_read_b64_tr_b16 v[76:77], v7 offset:28672
    s_waitcnt lgkmcnt(8)
    v_mfma_f32_16x16x32_bf16 v[92:95], v[64:67], v[44:47], v[92:95]
    ds_read_b64_tr_b16 v[78:79], v7 offset:29184
    s_waitcnt lgkmcnt(8)
    v_mfma_f32_16x16x32_bf16 v[96:99], v[64:67], v[48:51], v[96:99]
    ds_read_b64_tr_b16 v[80:81], v6 offset:20480
    s_waitcnt lgkmcnt(8)
    v_mfma_f32_16x16x32_bf16 v[100:103], v[64:67], v[52:55], v[100:103]
    ds_read_b64_tr_b16 v[82:83], v6 offset:20992
    s_waitcnt lgkmcnt(4)
    v_mfma_f32_16x16x32_bf16 v[248:251], v[64:67], v[60:63], v[248:251]
    v_mfma_f32_16x16x32_bf16 v[104:107], v[68:71], v[40:43], v[104:107]
    ds_read_b64_tr_b16 v[64:65], v7 offset:20480
    v_mfma_f32_16x16x32_bf16 v[108:111], v[68:71], v[44:47], v[108:111]
    v_mfma_f32_16x16x32_bf16 v[112:115], v[68:71], v[48:51], v[112:115]
    ds_read_b64_tr_b16 v[66:67], v7 offset:20992
    v_mfma_f32_16x16x32_bf16 v[116:119], v[68:71], v[52:55], v[116:119]
    v_mfma_f32_16x16x32_bf16 v[120:123], v[40:43], v[72:75], v[120:123]
    ds_read_b64_tr_b16 v[68:69], v6 offset:32768
    v_mfma_f32_16x16x32_bf16 v[124:127], v[44:47], v[72:75], v[124:127]
    v_mfma_f32_16x16x32_bf16 v[128:131], v[48:51], v[72:75], v[128:131]
    ds_read_b64_tr_b16 v[70:71], v6 offset:33280
    v_mfma_f32_16x16x32_bf16 v[132:135], v[52:55], v[72:75], v[132:135]
    v_mfma_f32_16x16x32_bf16 v[252:255], v[60:63], v[72:75], v[252:255]
    s_waitcnt lgkmcnt(6)
    v_mfma_f32_16x16x32_bf16 v[136:139], v[40:43], v[76:79], v[136:139]
    ds_read_b64_tr_b16 v[72:73], v6 offset:36864
    v_mfma_f32_16x16x32_bf16 v[140:143], v[44:47], v[76:79], v[140:143]
    v_mfma_f32_16x16x32_bf16 v[144:147], v[48:51], v[76:79], v[144:147]
    ds_read_b64_tr_b16 v[74:75], v6 offset:37376
    v_mfma_f32_16x16x32_bf16 v[148:151], v[52:55], v[76:79], v[148:151]
    s_waitcnt lgkmcnt(6)
    v_mfma_f32_16x16x32_bf16 v[152:155], v[80:83], v[40:43], v[152:155]
    ds_read_b64_tr_b16 v[76:77], v7 offset:32768
    v_mfma_f32_16x16x32_bf16 v[156:159], v[80:83], v[44:47], v[156:159]
    v_mfma_f32_16x16x32_bf16 v[160:163], v[80:83], v[48:51], v[160:163]
    ds_read_b64_tr_b16 v[78:79], v7 offset:33280
    v_mfma_f32_16x16x32_bf16 v[164:167], v[80:83], v[52:55], v[164:167]
    s_waitcnt lgkmcnt(6)
    v_mfma_f32_16x16x32_bf16 v[168:171], v[64:67], v[40:43], v[168:171]
    ds_read_b64_tr_b16 v[80:81], v7 offset:36864
    v_mfma_f32_16x16x32_bf16 v[172:175], v[64:67], v[44:47], v[172:175]
    v_mfma_f32_16x16x32_bf16 v[176:179], v[64:67], v[48:51], v[176:179]
    ds_read_b64_tr_b16 v[82:83], v7 offset:37376
    v_mfma_f32_16x16x32_bf16 v[180:183], v[64:67], v[52:55], v[180:183]
    s_waitcnt lgkmcnt(6)
    v_mfma_f32_16x16x32_bf16 v[184:187], v[68:71], v[40:43], v[184:187]
    v_mfma_f32_16x16x32_bf16 v[188:191], v[68:71], v[44:47], v[188:191]
    v_mfma_f32_16x16x32_bf16 v[192:195], v[68:71], v[48:51], v[192:195]
    v_mfma_f32_16x16x32_bf16 v[196:199], v[68:71], v[52:55], v[196:199]
    s_waitcnt lgkmcnt(0)
    s_barrier
    v_mfma_f32_16x16x32_bf16 v[200:203], v[72:75], v[40:43], v[200:203]
    v_mfma_f32_16x16x32_bf16 v[204:207], v[72:75], v[44:47], v[204:207]
    v_mfma_f32_16x16x32_bf16 v[208:211], v[72:75], v[48:51], v[208:211]
    v_mfma_f32_16x16x32_bf16 v[212:215], v[72:75], v[52:55], v[212:215]
    v_mfma_f32_16x16x32_bf16 v[216:219], v[76:79], v[40:43], v[216:219]
    v_mfma_f32_16x16x32_bf16 v[220:223], v[76:79], v[44:47], v[220:223]
    v_mfma_f32_16x16x32_bf16 v[224:227], v[76:79], v[48:51], v[224:227]
    v_mfma_f32_16x16x32_bf16 v[228:231], v[76:79], v[52:55], v[228:231]
    v_mfma_f32_16x16x32_bf16 v[232:235], v[80:83], v[40:43], v[232:235]
    v_mfma_f32_16x16x32_bf16 v[236:239], v[80:83], v[44:47], v[236:239]
    v_mfma_f32_16x16x32_bf16 v[240:243], v[80:83], v[48:51], v[240:243]
    v_mfma_f32_16x16x32_bf16 v[244:247], v[80:83], v[52:55], v[244:247]
    s_setprio 0
    s_mov_b32 s76, 0xbdd2d3e8
    v_cvt_pk_bf16_f32 v100, v100, v101
    v_cvt_pk_bf16_f32 v101, v102, v103
    v_cvt_pk_bf16_f32 v102, v116, v117
    v_cvt_pk_bf16_f32 v103, v118, v119
    v_cvt_pk_bf16_f32 v32, v132, v133
    v_cvt_pk_bf16_f32 v33, v134, v135
    v_cvt_pk_bf16_f32 v42, v148, v149
    v_cvt_pk_bf16_f32 v43, v150, v151
    v_cvt_pk_bf16_f32 v44, v248, v249
    v_cvt_pk_bf16_f32 v45, v250, v251
    v_cvt_pk_bf16_f32 v24, v252, v253
    v_cvt_pk_bf16_f32 v25, v254, v255
    s_cmp_lg_u32 s5, 0
    s_cbranch_scc1 L_hx1
    ds_write_b64 v85, v[100:101]
    ds_write_b64 v85, v[102:103] offset:512
    ds_write_b64 v85, v[32:33] offset:1024
    ds_write_b64 v85, v[42:43] offset:1536
    s_branch L_hx2
L_hx1:
    ds_write_b64 v85, v[44:45] offset:2048
    ds_write_b64 v85, v[24:25] offset:2560
L_hx2:
    s_waitcnt lgkmcnt(0)
    v_mul_f32 v80, v184, v184
    v_mul_f32 v81, v185, v185
    v_mul_f32 v82, v186, v186
    v_mul_f32 v83, v187, v187
    v_fma_f32 v80, v80, s76, v84
    v_fma_f32 v81, v81, s76, v84
    v_fma_f32 v82, v82, s76, v84
    v_fma_f32 v83, v83, s76, v84
    v_mul_f32 v80, v80, v184
    v_mul_f32 v81, v81, v185
    v_mul_f32 v82, v82, v186
    v_mul_f32 v83, v83, v187
    v_exp_f32 v80, v80
    v_mul_f32 v184, v184, v200
    v_exp_f32 v81, v81
    v_mul_f32 v185, v185, v201
    v_exp_f32 v82, v82
    v_mul_f32 v186, v186, v202
    v_exp_f32 v83, v83
    v_mul_f32 v187, v187, v203
    v_add_f32 v80, 1.0, v80
    v_add_f32 v81, 1.0, v81
    v_add_f32 v82, 1.0, v82
    v_add_f32 v83, 1.0, v83
    v_rcp_f32 v80, v80
    v_rcp_f32 v81, v81
    v_rcp_f32 v82, v82
    v_rcp_f32 v83, v83
    s_nop 0
    v_mul_f32 v184, v184, v80
    v_mul_f32 v185, v185, v81
    v_mul_f32 v186, v186, v82
    v_mul_f32 v187, v187, v83
    v_cvt_pk_bf16_f32 v184, v184, v185
    v_cvt_pk_bf16_f32 v185, v186, v187
    v_mul_f32 v80, v188, v188
    v_mul_f32 v81, v189, v189
    v_mul_f32 v82, v190, v190
    v_mul_f32 v83, v191, v191
    v_fma_f32 v80, v80, s76, v84
    v_fma_f32 v81, v81, s76, v84
    v_fma_f32 v82, v82, s76, v84
    v_fma_f32 v83, v83, s76, v84
    v_mul_f32 v80, v80, v188
    v_mul_f32 v81, v81, v189
    v_mul_f32 v82, v82, v190
    v_mul_f32 v83, v83, v191
    v_exp_f32 v80, v80
    v_mul_f32 v188, v188, v204
    v_exp_f32 v81, v81
    v_mul_f32 v189, v189, v205
    v_exp_f32 v82, v82
    v_mul_f32 v190, v190, v206
    v_exp_f32 v83, v83
    v_mul_f32 v191, v191, v207
    v_add_f32 v80, 1.0, v80
    v_add_f32 v81, 1.0, v81
    v_add_f32 v82, 1.0, v82
    v_add_f32 v83, 1.0, v83
    v_rcp_f32 v80, v80
    v_rcp_f32 v81, v81
    v_rcp_f32 v82, v82
    s_barrier
    s_cmp_lg_u32 s5, 0
    s_cbranch_scc1 L_hx3
    ds_read_b64 v[46:47], v85 offset:2048
    ds_read_b64 v[34:35], v85 offset:2560
    s_branch L_hx4
L_hx3:
    ds_read_b64 v[44:45], v85 offset:512
    ds_read_b64 v[46:47], v85
    ds_read_b64 v[24:25], v85 offset:1536
    ds_read_b64 v[34:35], v85 offset:1024
L_hx4:
    v_rcp_f32 v83, v83
    s_nop 0
    v_mul_f32 v188, v188, v80
    v_mul_f32 v189, v189, v81
    v_mul_f32 v190, v190, v82
    v_mul_f32 v191, v191, v83
    v_cvt_pk_bf16_f32 v186, v188, v189
    v_cvt_pk_bf16_f32 v187, v190, v191
    s_nop 1
    v_permlane16_swap_b32 v184, v186
    v_permlane16_swap_b32 v185, v187
    buffer_store_dwordx4 v[184:187], v8, s[68:71], s73 offen offset:0 sc1
    v_mul_f32 v80, v192, v192
    v_mul_f32 v81, v193, v193
    v_mul_f32 v82, v194, v194
    v_mul_f32 v83, v195, v195
    v_fma_f32 v80, v80, s76, v84
    v_fma_f32 v81, v81, s76, v84
    v_fma_f32 v82, v82, s76, v84
    v_fma_f32 v83, v83, s76, v84
    v_mul_f32 v80, v80, v192
    v_mul_f32 v81, v81, v193
    v_mul_f32 v82, v82, v194
    v_mul_f32 v83, v83, v195
    v_exp_f32 v80, v80
    v_mul_f32 v192, v192, v208
    v_exp_f32 v81, v81
    v_mul_f32 v193, v193, v209
    v_exp_f32 v82, v82
    v_mul_f32 v194, v194, v210
    v_exp_f32 v83, v83
    v_mul_f32 v195, v195, v211
    v_add_f32 v80, 1.0, v80
    v_add_f32 v81, 1.0, v81
    v_add_f32 v82, 1.0, v82
    v_add_f32 v83, 1.0, v83
    v_rcp_f32 v80, v80
    v_rcp_f32 v81, v81
    v_rcp_f32 v82, v82
    v_rcp_f32 v83, v83
    s_nop 0
    v_mul_f32 v192, v192, v80
    v_mul_f32 v193, v193, v81
    v_mul_f32 v194, v194, v82
    v_mul_f32 v195, v195, v83
    v_cvt_pk_bf16_f32 v192, v192, v193
    v_cvt_pk_bf16_f32 v193, v194, v195
    v_mul_f32 v80, v196, v196
    v_mul_f32 v81, v197, v197
    v_mul_f32 v82, v198, v198
    v_mul_f32 v83, v199, v199
    v_fma_f32 v80, v80, s76, v84
    v_fma_f32 v81, v81, s76, v84
    v_fma_f32 v82, v82, s76, v84
    v_fma_f32 v83, v83, s76, v84
    v_mul_f32 v80, v80, v196
    v_mul_f32 v81, v81, v197
    v_mul_f32 v82, v82, v198
    v_mul_f32 v83, v83, v199
    v_exp_f32 v80, v80
    v_mul_f32 v196, v196, v212
    v_exp_f32 v81, v81
    v_mul_f32 v197, v197, v213
    v_exp_f32 v82, v82
    v_mul_f32 v198, v198, v214
    v_exp_f32 v83, v83
    v_mul_f32 v199, v199, v215
    v_add_f32 v80, 1.0, v80
    s_barrier
    s_waitcnt lgkmcnt(0)
    v_add_f32 v81, 1.0, v81
    v_add_f32 v82, 1.0, v82
    v_add_f32 v83, 1.0, v83
    v_rcp_f32 v80, v80
    v_rcp_f32 v81, v81
    v_rcp_f32 v82, v82
    v_rcp_f32 v83, v83
    s_nop 0
    v_mul_f32 v196, v196, v80
    v_mul_f32 v197, v197, v81
    v_mul_f32 v198, v198, v82
    v_mul_f32 v199, v199, v83
    v_cvt_pk_bf16_f32 v194, v196, v197
    v_cvt_pk_bf16_f32 v195, v198, v199
    s_nop 1
    v_permlane16_swap_b32 v192, v194
    v_permlane16_swap_b32 v193, v195
    buffer_store_dwordx4 v[192:195], v8, s[68:71], s73 offen offset:2048 sc1
    v_mul_f32 v80, v216, v216
    v_mul_f32 v81, v217, v217
    v_mul_f32 v82, v218, v218
    v_mul_f32 v83, v219, v219
    v_fma_f32 v80, v80, s76, v84
    v_fma_f32 v81, v81, s76, v84
    v_fma_f32 v82, v82, s76, v84
    v_fma_f32 v83, v83, s76, v84
    v_mul_f32 v80, v80, v216
    v_mul_f32 v81, v81, v217
    v_mul_f32 v82, v82, v218
    v_mul_f32 v83, v83, v219
    v_exp_f32 v80, v80
    v_mul_f32 v216, v216, v232
    v_exp_f32 v81, v81
    v_mul_f32 v217, v217, v233
    v_exp_f32 v82, v82
    v_mul_f32 v218, v218, v234
    v_exp_f32 v83, v83
    v_mul_f32 v219, v219, v235
    v_add_f32 v80, 1.0, v80
    v_add_f32 v81, 1.0, v81
    v_add_f32 v82, 1.0, v82
    v_add_f32 v83, 1.0, v83
    v_rcp_f32 v80, v80
    v_rcp_f32 v81, v81
    v_rcp_f32 v82, v82
    v_rcp_f32 v83, v83
    s_nop 0
    v_mul_f32 v216, v216, v80
    v_mul_f32 v217, v217, v81
    v_mul_f32 v218, v218, v82
    v_mul_f32 v219, v219, v83
    v_cvt_pk_bf16_f32 v216, v216, v217
    v_cvt_pk_bf16_f32 v217, v218, v219
    v_mul_f32 v80, v220, v220
    v_mul_f32 v81, v221, v221
    v_mul_f32 v82, v222, v222
    v_mul_f32 v83, v223, v223
    v_fma_f32 v80, v80, s76, v84
    v_fma_f32 v81, v81, s76, v84
    v_fma_f32 v82, v82, s76, v84
    v_fma_f32 v83, v83, s76, v84
    v_mul_f32 v80, v80, v220
    v_mul_f32 v81, v81, v221
    v_mul_f32 v82, v82, v222
    v_mul_f32 v83, v83, v223
    v_exp_f32 v80, v80
    v_mul_f32 v220, v220, v236
    v_exp_f32 v81, v81
    s_lshl2_add_u32 s91, s2, s4
    s_lshl_b32 s39, s91, 9
    s_lshr_b32 s92, s91, 2
    s_mul_i32 s92, s92, 7168
    s_and_b32 s91, s91, 3
    s_lshl_b32 s91, s91, 9
    s_add_u32 s92, s92, s91
    s_add_u32 s34, s92, 5120
    s_add_u32 s39, s39, 0x180100
    s_load_dword s94, s[20:21], s39 offset:0x0
    s_load_dword s94, s[20:21], s39 offset:0x40
    s_load_dword s94, s[20:21], s39 offset:0x80
    s_load_dword s94, s[20:21], s39 offset:0xc0
    s_barrier
    v_mul_f32 v221, v221, v237
    v_exp_f32 v82, v82
    v_mul_f32 v222, v222, v238
    v_exp_f32 v83, v83
    v_mul_f32 v223, v223, v239
    v_add_f32 v80, 1.0, v80
    v_add_f32 v81, 1.0, v81
    v_add_f32 v82, 1.0, v82
    v_add_f32 v83, 1.0, v83
    v_rcp_f32 v80, v80
    v_rcp_f32 v81, v81
    v_rcp_f32 v82, v82
    v_rcp_f32 v83, v83
    s_nop 0
    v_mul_f32 v220, v220, v80
    v_mul_f32 v221, v221, v81
    v_mul_f32 v222, v222, v82
    v_mul_f32 v223, v223, v83
    v_cvt_pk_bf16_f32 v218, v220, v221
    v_cvt_pk_bf16_f32 v219, v222, v223
    s_nop 1
    v_permlane16_swap_b32 v216, v218
    v_permlane16_swap_b32 v217, v219
    buffer_store_dwordx4 v[216:219], v8, s[68:71], s74 offen offset:0 sc1
    v_mul_f32 v80, v224, v224
    v_mul_f32 v81, v225, v225
    v_mul_f32 v82, v226, v226
    v_mul_f32 v83, v227, v227
    v_fma_f32 v80, v80, s76, v84
    v_fma_f32 v81, v81, s76, v84
    v_fma_f32 v82, v82, s76, v84
    v_fma_f32 v83, v83, s76, v84
    v_mul_f32 v80, v80, v224
    v_mul_f32 v81, v81, v225
    v_mul_f32 v82, v82, v226
    v_mul_f32 v83, v83, v227
    v_exp_f32 v80, v80
    v_mul_f32 v224, v224, v240
    v_exp_f32 v81, v81
    v_mul_f32 v225, v225, v241
    v_exp_f32 v82, v82
    v_mul_f32 v226, v226, v242
    v_exp_f32 v83, v83
    v_mul_f32 v227, v227, v243
    v_add_f32 v80, 1.0, v80
    v_add_f32 v81, 1.0, v81
    v_add_f32 v82, 1.0, v82
    v_add_f32 v83, 1.0, v83
    v_rcp_f32 v80, v80
    v_rcp_f32 v81, v81
    v_rcp_f32 v82, v82
    v_rcp_f32 v83, v83
    s_nop 0
    v_mul_f32 v224, v224, v80
    v_mul_f32 v225, v225, v81
    v_mul_f32 v226, v226, v82
    v_mul_f32 v227, v227, v83
    v_cvt_pk_bf16_f32 v224, v224, v225
    v_cvt_pk_bf16_f32 v225, v226, v227
    v_mul_f32 v80, v228, v228
    v_mul_f32 v81, v229, v229
    v_mul_f32 v82, v230, v230
    v_mul_f32 v83, v231, v231
    v_fma_f32 v80, v80, s76, v84
    v_fma_f32 v81, v81, s76, v84
    v_fma_f32 v82, v82, s76, v84
    v_fma_f32 v83, v83, s76, v84
    s_add_u32 s39, s39, 0x27ff00
    s_load_dword s94, s[20:21], s39 offset:0x0
    s_load_dword s94, s[20:21], s39 offset:0x40
    s_load_dword s94, s[20:21], s39 offset:0x80
    s_load_dword s94, s[20:21], s39 offset:0xc0
    s_barrier
    v_mul_f32 v80, v80, v228
    v_mul_f32 v81, v81, v229
    v_mul_f32 v82, v82, v230
    v_mul_f32 v83, v83, v231
    v_exp_f32 v80, v80
    v_mul_f32 v228, v228, v244
    v_exp_f32 v81, v81
    v_mul_f32 v229, v229, v245
    v_exp_f32 v82, v82
    v_mul_f32 v230, v230, v246
    v_exp_f32 v83, v83
    v_mul_f32 v231, v231, v247
    v_add_f32 v80, 1.0, v80
    v_add_f32 v81, 1.0, v81
    v_add_f32 v82, 1.0, v82
    v_add_f32 v83, 1.0, v83
    v_rcp_f32 v80, v80
    v_rcp_f32 v81, v81
    v_rcp_f32 v82, v82
    v_rcp_f32 v83, v83
    s_nop 0
    v_mul_f32 v228, v228, v80
    v_mul_f32 v229, v229, v81
    v_mul_f32 v230, v230, v82
    v_mul_f32 v231, v231, v83
    v_cvt_pk_bf16_f32 v226, v228, v229
    v_cvt_pk_bf16_f32 v227, v230, v231
    s_nop 1
    v_permlane16_swap_b32 v224, v226
    v_permlane16_swap_b32 v225, v227
    buffer_store_dwordx4 v[224:227], v8, s[68:71], s74 offen offset:2048 sc1
    v_lshrrev_b32 v64, 4, v1
    v_and_b32 v66, 14, v1
    v_lshlrev_b32 v64, 2, v64
    v_sub_u32 v64, v66, v64
    v_and_b32 v65, 1, v1
    v_cmp_le_i32 s[40:41], 0, v64
    v_cmp_le_i32 s[42:43], 2, v64
    v_mul_u32_u24 v66, 0x202, v65
    s_mov_b32 s80, 0x01000c0c
    v_lshl_add_u32 v66, v66, 16, s80
    v_add_u32 v67, 0x04040000, v66
    v_cndmask_b32 v76, v66, v67, s[40:41]
    v_cndmask_b32 v77, v66, v67, s[42:43]
    v_lshlrev_b32 v65, 4, v65
    v_mov_b32 v68, 0x0c0c0c0c
    v_mov_b32 v66, 0xc0c0100
    v_alignbit_b32 v66, v66, v66, v65
    v_cndmask_b32 v78, v66, v68, s[40:41]
    v_cndmask_b32 v86, v68, v66, s[40:41]
    v_mov_b32 v66, 0xc0c0302
    v_alignbit_b32 v66, v66, v66, v65
    v_cndmask_b32 v79, v66, v68, s[42:43]
    v_cndmask_b32 v87, v68, v66, s[42:43]
    s_or_b32 s80, s28, s5
    s_cmp_eq_u32 s80, 0
    s_cselect_b64 s[80:81], 0, -1
    s_or_b64 s[40:41], s[40:41], s[80:81]
    s_or_b64 s[42:43], s[42:43], s[80:81]
    v_mov_b32 v7, 0xce6e6b28
    s_mov_b32 s77, 0x3e3504f3
    s_mov_b32 s78, 0x3fb8aa3b
    v_cvt_pk_bf16_f32 v88, v88, v89
    v_cvt_pk_bf16_f32 v89, v90, v91
    v_cvt_pk_bf16_f32 v90, v104, v105
    v_cvt_pk_bf16_f32 v91, v106, v107
    v_cvt_pk_bf16_f32 v152, v152, v153
    v_cvt_pk_bf16_f32 v153, v154, v155
    v_cvt_pk_bf16_f32 v154, v168, v169
    v_cvt_pk_bf16_f32 v155, v170, v171
    v_cvt_pk_bf16_f32 v92, v92, v93
    v_cvt_pk_bf16_f32 v93, v94, v95
    v_cvt_pk_bf16_f32 v94, v108, v109
    v_cvt_pk_bf16_f32 v95, v110, v111
    v_cvt_pk_bf16_f32 v156, v156, v157
    v_cvt_pk_bf16_f32 v157, v158, v159
    v_cvt_pk_bf16_f32 v158, v172, v173
    v_cvt_pk_bf16_f32 v159, v174, v175
    s_load_dword s94, s[20:21], s39 offset:0x100
    s_load_dword s94, s[20:21], s39 offset:0x140
    s_load_dword s94, s[20:21], s39 offset:0x180
    s_load_dword s94, s[20:21], s39 offset:0x1c0
    s_barrier
    s_setprio 3
    v_mfma_f32_16x16x32_bf16 v[48:51], v[44:47], v[152:155], 0
    v_mfma_f32_16x16x32_bf16 v[52:55], v[88:91], v[152:155], 0
    s_setprio 0
    v_cvt_pk_bf16_f32 v96, v96, v97
    v_cvt_pk_bf16_f32 v97, v98, v99
    v_cvt_pk_bf16_f32 v98, v112, v113
    v_cvt_pk_bf16_f32 v99, v114, v115
    v_cvt_pk_bf16_f32 v160, v160, v161
    v_cvt_pk_bf16_f32 v161, v162, v163
    v_cvt_pk_bf16_f32 v162, v176, v177
    v_cvt_pk_bf16_f32 v163, v178, v179
    s_setprio 3
    v_mfma_f32_16x16x32_bf16 v[56:59], v[88:91], v[156:159], 0
    v_mfma_f32_16x16x32_bf16 v[60:63], v[92:95], v[156:159], 0
    s_setprio 0
    v_cvt_pk_bf16_f32 v48, v48, v49
    v_cvt_pk_bf16_f32 v49, v50, v51
    v_cvt_pk_bf16_f32 v50, v52, v53
    v_cvt_pk_bf16_f32 v51, v54, v55
    v_perm_b32 v64, v50, v48, v76
    v_perm_b32 v65, v51, v49, v77
    v_mul_f32 v64, s77, v64
    v_mul_f32 v65, s77, v65
    v_cvt_pk_bf16_f32 v65, v64, v65
    v_lshlrev_b32 v64, 16, v65
    v_and_b32 v65, 0xffff0000, v65
    v_cndmask_b32 v64, v7, v64, s[40:41]
    v_cndmask_b32 v65, v7, v65, s[42:43]
    v_max_f32 v72, v64, v65
    v_cvt_pk_bf16_f32 v164, v164, v165
    v_cvt_pk_bf16_f32 v165, v166, v167
    v_cvt_pk_bf16_f32 v166, v180, v181
    v_cvt_pk_bf16_f32 v167, v182, v183
    s_setprio 3
    v_mfma_f32_16x16x32_bf16 v[48:51], v[92:95], v[160:163], 0
    v_mfma_f32_16x16x32_bf16 v[52:55], v[96:99], v[160:163], 0
    s_setprio 0
    v_cvt_pk_bf16_f32 v56, v56, v57
    v_cvt_pk_bf16_f32 v57, v58, v59
    v_cvt_pk_bf16_f32 v58, v60, v61
    v_cvt_pk_bf16_f32 v59, v62, v63
    v_perm_b32 v66, v58, v56, v76
    v_perm_b32 v67, v59, v57, v77
    v_mul_f32 v66, s77, v66
    v_mul_f32 v67, s77, v67
    v_cvt_pk_bf16_f32 v67, v66, v67
    v_lshlrev_b32 v66, 16, v67
    v_and_b32 v67, 0xffff0000, v67
    v_max_f32 v73, v66, v67
    s_setprio 3
    v_mfma_f32_16x16x32_bf16 v[56:59], v[96:99], v[164:167], 0
    v_mfma_f32_16x16x32_bf16 v[60:63], v[100:103], v[164:167], 0
    s_setprio 0
    v_cvt_pk_bf16_f32 v26, v120, v121
    v_cvt_pk_bf16_f32 v27, v122, v123
    v_cvt_pk_bf16_f32 v36, v136, v137
    v_cvt_pk_bf16_f32 v37, v138, v139
    s_add_u32 s39, s39, 0xffe00000
    s_load_dword s94, s[20:21], s39 offset:0x0
    s_load_dword s94, s[20:21], s39 offset:0x40
    s_load_dword s94, s[20:21], s39 offset:0x80
    s_load_dword s94, s[20:21], s39 offset:0xc0
    s_barrier
    v_cvt_pk_bf16_f32 v28, v124, v125
    v_cvt_pk_bf16_f32 v29, v126, v127
    v_cvt_pk_bf16_f32 v38, v140, v141
    v_cvt_pk_bf16_f32 v39, v142, v143
    v_cvt_pk_bf16_f32 v30, v128, v129
    v_cvt_pk_bf16_f32 v31, v130, v131
    v_cvt_pk_bf16_f32 v40, v144, v145
    v_cvt_pk_bf16_f32 v41, v146, v147
    v_cvt_pk_bf16_f32 v48, v48, v49
    v_cvt_pk_bf16_f32 v49, v50, v51
    v_cvt_pk_bf16_f32 v50, v52, v53
    v_cvt_pk_bf16_f32 v51, v54, v55
    v_perm_b32 v68, v50, v48, v76
    v_perm_b32 v69, v51, v49, v77
    v_mul_f32 v68, s77, v68
    v_mul_f32 v69, s77, v69
    v_cvt_pk_bf16_f32 v69, v68, v69
    v_lshlrev_b32 v68, 16, v69
    v_and_b32 v69, 0xffff0000, v69
    v_max_f32 v74, v68, v69
    v_cvt_pk_bf16_f32 v56, v56, v57
    v_cvt_pk_bf16_f32 v57, v58, v59
    v_cvt_pk_bf16_f32 v58, v60, v61
    v_cvt_pk_bf16_f32 v59, v62, v63
    v_perm_b32 v70, v58, v56, v76
    v_perm_b32 v71, v59, v57, v77
    v_mul_f32 v70, s77, v70
    v_mul_f32 v71, s77, v71
    v_cvt_pk_bf16_f32 v71, v70, v71
    v_lshlrev_b32 v70, 16, v71
    v_and_b32 v71, 0xffff0000, v71
    v_max_f32 v75, v70, v71
    v_permlane32_swap_b32 v72, v73
    v_max_f32 v72, v72, v73
    v_permlane32_swap_b32 v74, v75
    v_max_f32 v74, v74, v75
    s_nop 1
    v_permlane16_swap_b32 v72, v74
    v_max_f32 v72, v72, v74
    v_mov_b32 v74, v72
    s_nop 1
    v_permlane16_swap_b32 v72, v74
    v_mov_b32 v73, v72
    v_mov_b32 v75, v74
    s_nop 0
    v_permlane32_swap_b32 v72, v73
    v_permlane32_swap_b32 v74, v75
    v_sub_f32 v64, v64, v72
    v_sub_f32 v65, v65, v72
    v_sub_f32 v66, v66, v73
    v_sub_f32 v67, v67, v73
    v_sub_f32 v68, v68, v74
    v_sub_f32 v69, v69, v74
    v_sub_f32 v70, v70, v75
    v_sub_f32 v71, v71, v75
    v_mul_f32 v64, s78, v64
    v_mul_f32 v65, s78, v65
    v_mul_f32 v66, s78, v66
    v_mul_f32 v67, s78, v67
    v_mul_f32 v68, s78, v68
    v_mul_f32 v69, s78, v69
    v_mul_f32 v70, s78, v70
    v_mul_f32 v71, s78, v71
    v_exp_f32 v64, v64
    v_exp_f32 v65, v65
    v_exp_f32 v66, v66
    v_exp_f32 v67, v67
    v_exp_f32 v68, v68
    v_exp_f32 v69, v69
    v_exp_f32 v70, v70
    v_exp_f32 v71, v71
    v_add_f32 v72, v64, v65
    v_add_f32 v73, v66, v67
    s_load_dword s94, s[20:21], s39 offset:0x100
    s_load_dword s94, s[20:21], s39 offset:0x140
    s_load_dword s94, s[20:21], s39 offset:0x180
    s_load_dword s94, s[20:21], s39 offset:0x1c0
    s_barrier
    v_add_f32 v74, v68, v69
    v_add_f32 v75, v70, v71
    v_permlane32_swap_b32 v72, v73
    v_add_f32 v72, v72, v73
    v_permlane32_swap_b32 v74, v75
    v_add_f32 v74, v74, v75
    s_nop 1
    v_permlane16_swap_b32 v72, v74
    v_add_f32 v72, v72, v74
    v_rcp_f32 v72, v72
    s_nop 0
    v_mov_b32 v74, v72
    s_nop 1
    v_permlane16_swap_b32 v72, v74
    v_mov_b32 v73, v72
    v_mov_b32 v75, v74
    s_nop 0
    v_permlane32_swap_b32 v72, v73
    v_permlane32_swap_b32 v74, v75
    v_mul_f32 v64, v64, v72
    v_mul_f32 v65, v65, v72
    v_mul_f32 v66, v66, v73
    v_mul_f32 v67, v67, v73
    v_mul_f32 v68, v68, v74
    v_mul_f32 v69, v69, v74
    v_mul_f32 v70, v70, v75
    v_mul_f32 v71, v71, v75
    v_cvt_pk_bf16_f32 v72, v64, v65
    v_cvt_pk_bf16_f32 v73, v66, v67
    v_cvt_pk_bf16_f32 v74, v68, v69
    v_cvt_pk_bf16_f32 v75, v70, v71
    v_perm_b32 v152, v72, v72, v78
    v_perm_b32 v153, v72, v72, v79
    v_perm_b32 v154, v72, v72, v86
    v_perm_b32 v155, v72, v72, v87
    v_perm_b32 v156, v73, v73, v78
    v_perm_b32 v157, v73, v73, v79
    v_perm_b32 v158, v73, v73, v86
    v_perm_b32 v159, v73, v73, v87
    s_setprio 3
    v_mfma_f32_16x16x32_bf16 v[48:51], v[24:27], v[152:155], 0
    v_mfma_f32_16x16x32_bf16 v[52:55], v[34:37], v[152:155], 0
    s_setprio 0
    v_perm_b32 v160, v74, v74, v78
    v_perm_b32 v161, v74, v74, v79
    v_perm_b32 v162, v74, v74, v86
    v_perm_b32 v163, v74, v74, v87
    s_setprio 3
    v_mfma_f32_16x16x32_bf16 v[56:59], v[26:29], v[156:159], 0
    v_mfma_f32_16x16x32_bf16 v[60:63], v[36:39], v[156:159], 0
    s_setprio 0
    v_perm_b32 v164, v75, v75, v78
    v_perm_b32 v165, v75, v75, v79
    v_perm_b32 v166, v75, v75, v86
    v_perm_b32 v167, v75, v75, v87
    v_cvt_pk_bf16_f32 v168, v48, v49
    v_cvt_pk_bf16_f32 v169, v50, v51
    v_cvt_pk_bf16_f32 v170, v52, v53
    v_cvt_pk_bf16_f32 v171, v54, v55
    s_setprio 3
    v_mfma_f32_16x16x32_bf16 v[48:51], v[28:31], v[160:163], 0
    v_mfma_f32_16x16x32_bf16 v[52:55], v[38:41], v[160:163], 0
    s_add_u32 s39, s39, 0x280000
    s_load_dword s94, s[20:21], s39 offset:0x0
    s_load_dword s94, s[20:21], s39 offset:0x40
    s_load_dword s94, s[20:21], s39 offset:0x80
    s_load_dword s94, s[20:21], s39 offset:0xc0
    s_barrier
    s_setprio 0
    v_cvt_pk_bf16_f32 v172, v56, v57
    v_cvt_pk_bf16_f32 v173, v58, v59
    v_cvt_pk_bf16_f32 v174, v60, v61
    v_cvt_pk_bf16_f32 v175, v62, v63
    s_setprio 3
    v_mfma_f32_16x16x32_bf16 v[56:59], v[30:33], v[164:167], 0
    v_mfma_f32_16x16x32_bf16 v[60:63], v[40:43], v[164:167], 0
    s_setprio 0
    v_permlane16_swap_b32 v168, v170
    v_permlane16_swap_b32 v169, v171
    buffer_store_dwordx4 v[168:171], v9, s[68:71], s75 offen offset:0 sc1
    v_permlane16_swap_b32 v172, v174
    v_permlane16_swap_b32 v173, v175
    buffer_store_dwordx4 v[172:175], v9, s[68:71], s75 offen offset:1024 sc1
    v_cvt_pk_bf16_f32 v176, v48, v49
    v_cvt_pk_bf16_f32 v177, v50, v51
    v_cvt_pk_bf16_f32 v178, v52, v53
    v_cvt_pk_bf16_f32 v179, v54, v55
    v_cvt_pk_bf16_f32 v180, v56, v57
    v_cvt_pk_bf16_f32 v181, v58, v59
    v_cvt_pk_bf16_f32 v182, v60, v61
    v_cvt_pk_bf16_f32 v183, v62, v63
    v_permlane16_swap_b32 v176, v178
    v_permlane16_swap_b32 v177, v179
    buffer_store_dwordx4 v[176:179], v9, s[68:71], s75 offen offset:2048 sc1
    v_permlane16_swap_b32 v180, v182
    v_permlane16_swap_b32 v181, v183
    buffer_store_dwordx4 v[180:183], v9, s[68:71], s75 offen offset:3072 sc1
    v_lshrrev_b32 v64, 4, v1
    v_bfe_u32 v65, v1, 2, 2
    v_and_b32 v66, 3, v1
    v_and_b32 v67, 15, v1
    v_lshrrev_b32 v68, 3, v1
    v_and_b32 v69, 7, v1
    s_lshl_b32 s85, s6, 2
    v_lshl_add_u32 v70, v64, 3, v65
    v_lshlrev_b32 v70, 7, v70
    v_and_b32 v71, 1, v66
    v_lshl_add_u32 v70, v71, 3, v70
    v_add_u32 v70, 0, v70
    v_and_b32 v71, 2, v65
    v_and_b32 v72, 1, v64
    v_lshl_add_u32 v71, v72, 2, v71
    v_lshrrev_b32 v72, 1, v66
    v_xor_b32 v71, v71, v72
    v_xor_b32 v71, s85, v71
    v_xor_b32 v72, 0, v71
    v_lshl_add_u32 v6, v72, 4, v70
    v_add_u32 v8, 65536, v6
    v_xor_b32 v72, 2, v71
    v_lshl_add_u32 v7, v72, 4, v70
    v_add_u32 v9, 65536, v7
    s_lshl_b32 s85, s5, 12
    v_lshl_add_u32 v4, v1, 4, s85
    v_add_u32 v5, 65536, v4
    v_mov_b32 v88, 0
    v_mov_b32 v89, 0
    v_mov_b32 v90, 0
    v_mov_b32 v91, 0
    v_mov_b32 v92, 0
    v_mov_b32 v93, 0
    v_mov_b32 v94, 0
    v_mov_b32 v95, 0
    v_mov_b32 v96, 0
    v_mov_b32 v97, 0
    v_mov_b32 v98, 0
    v_mov_b32 v99, 0
    v_mov_b32 v100, 0
    v_mov_b32 v101, 0
    v_mov_b32 v102, 0
    v_mov_b32 v103, 0
    v_mov_b32 v104, 0
    v_mov_b32 v105, 0
    v_mov_b32 v106, 0
    v_mov_b32 v107, 0
    v_mov_b32 v108, 0
    v_mov_b32 v109, 0
    v_mov_b32 v110, 0
    s_load_dword s94, s[20:21], s39 offset:0x100
    s_load_dword s94, s[20:21], s39 offset:0x140
    s_load_dword s94, s[20:21], s39 offset:0x180
    s_load_dword s94, s[20:21], s39 offset:0x1c0
    s_barrier
    v_mov_b32 v111, 0
    v_mov_b32 v112, 0
    v_mov_b32 v113, 0
    v_mov_b32 v114, 0
    v_mov_b32 v115, 0
    v_mov_b32 v116, 0
    v_mov_b32 v117, 0
    v_mov_b32 v118, 0
    v_mov_b32 v119, 0
    s_mov_b32 s72, s8
    s_mov_b32 s73, s9
    s_mov_b32 s74, 0x400000
    s_mov_b32 s75, 0x20000
    s_load_dword s94, s[20:21], s39 offset:0x80000
    s_load_dword s94, s[20:21], s39 offset:0x80040
    s_load_dword s94, s[20:21], s39 offset:0x80080
    s_load_dword s94, s[20:21], s39 offset:0x800c0
    s_waitcnt vmcnt(4)
    s_barrier
    s_load_dword s94, s[20:21], s39 offset:0x80100
    s_load_dword s94, s[20:21], s39 offset:0x80140
    s_load_dword s94, s[20:21], s39 offset:0x80180
    s_load_dword s94, s[20:21], s39 offset:0x801c0
    s_cmp_lg_u32 s4, 0
    s_cbranch_scc1 L_fH2
    s_lshl_b32 s91, s28, 4
    s_add_u32 s91, s91, s29
    s_lshl_b32 s91, s91, 7
    s_add_u32 s91, s91, 0x1e90000
    v_mov_b32 v16, s91
    v_mov_b32 v18, s100
    v_mov_b32 v19, s101
    s_mov_b64 exec, 1
    global_store_dwordx2 v16, v[18:19], s[26:27] sc1
    s_mov_b64 exec, -1
L_fH2:
    s_barrier
    s_add_u32 s39, s39, 0x180000
    s_load_dword s94, s[20:21], s39 offset:0x0
    s_load_dword s94, s[20:21], s39 offset:0x40
    s_load_dword s94, s[20:21], s39 offset:0x80
    s_load_dword s94, s[20:21], s39 offset:0xc0
    s_barrier
    s_lshl1_add_u32 m0, s33, 81920
    s_nop 0
    buffer_load_dwordx4 v11, s[60:63], s83 offen lds
    s_lshl1_add_u32 m0, s33, 82944
    s_nop 0
    buffer_load_dwordx4 v12, s[60:63], s83 offen lds
    s_lshl1_add_u32 m0, s33, 90112
    s_nop 0
    buffer_load_dwordx4 v11, s[64:67], s83 offen lds
    s_lshl1_add_u32 m0, s33, 91136
    s_nop 0
    buffer_load_dwordx4 v12, s[64:67], s83 offen lds
    s_add_u32 s83, s83, 131072
    s_load_dword s94, s[20:21], s39 offset:0x100
    s_load_dword s94, s[20:21], s39 offset:0x140
    s_load_dword s94, s[20:21], s39 offset:0x180
    s_load_dword s94, s[20:21], s39 offset:0x1c0
    s_barrier
    s_lshl_b32 m0, s33, 2
    s_nop 0
    buffer_load_dwordx4 v10, s[56:59], s82 offen offset:0 sc1 lds
    buffer_load_dwordx4 v10, s[56:59], s82 offen offset:1024 sc1 lds
    buffer_load_dwordx4 v10, s[56:59], s82 offen offset:2048 sc1 lds
    buffer_load_dwordx4 v10, s[56:59], s82 offen offset:3072 sc1 lds
    s_add_u32 s82, s82, 16384
    s_lshl1_add_u32 m0, s33, 16384
    s_nop 0
    buffer_load_dwordx4 v11, s[60:63], s83 offen lds
    s_lshl1_add_u32 m0, s33, 17408
    s_nop 0
    buffer_load_dwordx4 v12, s[60:63], s83 offen lds
    s_lshl1_add_u32 m0, s33, 24576
    s_nop 0
    buffer_load_dwordx4 v11, s[64:67], s83 offen lds
    s_lshl1_add_u32 m0, s33, 25600
    s_nop 0
    buffer_load_dwordx4 v12, s[64:67], s83 offen lds
    s_add_u32 s83, s83, 131072
    s_add_u32 s39, s39, 0xfff80000
    s_load_dword s94, s[20:21], s39 offset:0x0
    s_load_dword s94, s[20:21], s39 offset:0x40
    s_load_dword s94, s[20:21], s39 offset:0x80
    s_load_dword s94, s[20:21], s39 offset:0xc0
    s_barrier
    s_lshl2_add_u32 m0, s33, 98304
    s_nop 0
    buffer_load_dwordx4 v10, s[56:59], s82 offen offset:0 sc1 lds
    buffer_load_dwordx4 v10, s[56:59], s82 offen offset:1024 sc1 lds
    buffer_load_dwordx4 v10, s[56:59], s82 offen offset:2048 sc1 lds
    buffer_load_dwordx4 v10, s[56:59], s82 offen offset:3072 sc1 lds
    s_add_u32 s82, s82, 16384
    s_lshl1_add_u32 m0, s33, 114688
    s_nop 0
    buffer_load_dwordx4 v11, s[60:63], s83 offen lds
    s_lshl1_add_u32 m0, s33, 115712
    s_nop 0
    buffer_load_dwordx4 v12, s[60:63], s83 offen lds
    s_lshl1_add_u32 m0, s33, 122880
    s_nop 0
    buffer_load_dwordx4 v11, s[64:67], s83 offen lds
    s_lshl1_add_u32 m0, s33, 123904
    s_nop 0
    buffer_load_dwordx4 v12, s[64:67], s83 offen lds
    s_add_u32 s83, s83, 131072
    s_load_dword s94, s[20:21], s39 offset:0x100
    s_load_dword s94, s[20:21], s39 offset:0x140
    s_load_dword s94, s[20:21], s39 offset:0x180
    s_load_dword s94, s[20:21], s39 offset:0x1c0
    v_and_b32 v20, 15, v1
    s_lshl_b32 s91, s30, 11
    s_add_u32 s91, s91, 0x1e90000
    v_lshl_add_u32 v20, v20, 7, s91
    global_load_dwordx2 v[22:23], v20, s[26:27] sc1
    s_waitcnt vmcnt(17)
    s_barrier
    s_lshl2_add_u32 m0, s33, 32768
    s_nop 0
    buffer_load_dwordx4 v10, s[56:59], s82 offen offset:0 sc1 lds
    buffer_load_dwordx4 v10, s[56:59], s82 offen offset:1024 sc1 lds
    buffer_load_dwordx4 v10, s[56:59], s82 offen offset:2048 sc1 lds
    buffer_load_dwordx4 v10, s[56:59], s82 offen offset:3072 sc1 lds
    s_add_u32 s82, s82, 16384
    s_lshl1_add_u32 m0, s33, 49152
    s_nop 0
    buffer_load_dwordx4 v11, s[60:63], s83 offen lds
    s_lshl1_add_u32 m0, s33, 50176
    s_nop 0
    buffer_load_dwordx4 v12, s[60:63], s83 offen lds
    s_lshl1_add_u32 m0, s33, 57344
    s_nop 0
    buffer_load_dwordx4 v11, s[64:67], s83 offen lds
    s_lshl1_add_u32 m0, s33, 58368
    s_nop 0
    buffer_load_dwordx4 v12, s[64:67], s83 offen lds
    s_add_u32 s83, s83, 131072
    s_add_u32 s39, s39, 0x100000
    s_load_dword s94, s[20:21], s39 offset:0x0
    s_load_dword s94, s[20:21], s39 offset:0x40
    s_load_dword s94, s[20:21], s39 offset:0x80
    s_load_dword s94, s[20:21], s39 offset:0xc0
    s_waitcnt vmcnt(17)
    s_barrier
    s_lshl2_add_u32 m0, s33, 65536
    s_nop 0
    buffer_load_dwordx4 v10, s[56:59], s82 offen offset:0 sc1 lds
    buffer_load_dwordx4 v10, s[56:59], s82 offen offset:1024 sc1 lds
    buffer_load_dwordx4 v10, s[56:59], s82 offen offset:2048 sc1 lds
    buffer_load_dwordx4 v10, s[56:59], s82 offen offset:3072 sc1 lds
    s_add_u32 s82, s82, 16384
    s_lshl1_add_u32 m0, s33, 81920
    s_nop 0
    buffer_load_dwordx4 v11, s[60:63], s83 offen lds
    s_lshl1_add_u32 m0, s33, 82944
    s_nop 0
    buffer_load_dwordx4 v12, s[60:63], s83 offen lds
    s_lshl1_add_u32 m0, s33, 90112
    s_nop 0
    buffer_load_dwordx4 v11, s[64:67], s83 offen lds
    s_lshl1_add_u32 m0, s33, 91136
    s_nop 0
    buffer_load_dwordx4 v12, s[64:67], s83 offen lds
    s_add_u32 s83, s83, 131072
    s_load_dword s94, s[20:21], s39 offset:0x100
    s_load_dword s94, s[20:21], s39 offset:0x140
    s_load_dword s94, s[20:21], s39 offset:0x180
    s_load_dword s94, s[20:21], s39 offset:0x1c0
    s_waitcnt vmcnt(16)
    s_movk_i32 s98, 0x4000
L_pH2_chk:
    v_cmp_ne_u64 vcc, s[100:101], v[22:23]
    s_nop 1
    s_cmp_eq_u64 vcc, 0
    s_cbranch_scc1 L_pH2_ok
    s_sub_u32 s98, s98, 1
    s_cbranch_scc1 L_pH2_ok
    s_sleep 1
    global_load_dwordx2 v[22:23], v20, s[26:27] sc1
    s_waitcnt vmcnt(0)
    s_branch L_pH2_chk
L_pH2_ok:
    s_waitcnt vmcnt(17)
    s_barrier
    s_add_u32 s82, s82, s14
    s_add_u32 s83, s83, s35
    s_lshl_b32 m0, s33, 2
    s_nop 0
    buffer_load_dwordx4 v10, s[56:59], s82 offen offset:0 sc1 lds
    buffer_load_dwordx4 v10, s[56:59], s82 offen offset:1024 sc1 lds
    buffer_load_dwordx4 v10, s[56:59], s82 offen offset:2048 sc1 lds
    buffer_load_dwordx4 v10, s[56:59], s82 offen offset:3072 sc1 lds
    s_add_u32 s82, s82, 16384
    s_lshl1_add_u32 m0, s33, 16384
    s_nop 0
    buffer_load_dwordx4 v11, s[60:63], s83 offen lds
    s_lshl1_add_u32 m0, s33, 17408
    s_nop 0
    buffer_load_dwordx4 v12, s[60:63], s83 offen lds
    s_lshl1_add_u32 m0, s33, 24576
    s_nop 0
    buffer_load_dwordx4 v11, s[64:67], s83 offen lds
    s_lshl1_add_u32 m0, s33, 25600
    s_nop 0
    buffer_load_dwordx4 v12, s[64:67], s83 offen lds
    s_add_u32 s83, s83, 131072
    s_add_u32 s39, s39, 0xff980000
    s_load_dword s94, s[12:13], s39 offset:0x0
    s_load_dword s94, s[12:13], s39 offset:0x40
    s_load_dword s94, s[12:13], s39 offset:0x80
    s_load_dword s94, s[12:13], s39 offset:0xc0
    s_waitcnt vmcnt(16)
    s_barrier
    s_lshl2_add_u32 m0, s33, 98304
    s_nop 0
    buffer_load_dwordx4 v10, s[56:59], s82 offen offset:0 sc1 lds
    buffer_load_dwordx4 v10, s[56:59], s82 offen offset:1024 sc1 lds
    buffer_load_dwordx4 v10, s[56:59], s82 offen offset:2048 sc1 lds
    buffer_load_dwordx4 v10, s[56:59], s82 offen offset:3072 sc1 lds
    s_add_u32 s82, s82, 16384
    s_lshl1_add_u32 m0, s33, 114688
    s_nop 0
    buffer_load_dwordx4 v11, s[60:63], s83 offen lds
    s_lshl1_add_u32 m0, s33, 115712
    s_nop 0
    buffer_load_dwordx4 v12, s[60:63], s83 offen lds
    s_lshl1_add_u32 m0, s33, 122880
    s_nop 0
    buffer_load_dwordx4 v11, s[64:67], s83 offen lds
    s_lshl1_add_u32 m0, s33, 123904
    s_nop 0
    buffer_load_dwordx4 v12, s[64:67], s83 offen lds
    s_add_u32 s83, s83, 131072
    s_load_dword s94, s[12:13], s39 offset:0x100
    s_load_dword s94, s[12:13], s39 offset:0x140
    s_load_dword s94, s[12:13], s39 offset:0x180
    s_load_dword s94, s[12:13], s39 offset:0x1c0
    s_waitcnt vmcnt(53)
    s_waitcnt vmcnt(16)
    s_barrier
    s_lshl2_add_u32 m0, s33, 32768
    s_nop 0
    buffer_load_dwordx4 v10, s[56:59], s82 offen offset:0 sc1 lds
    buffer_load_dwordx4 v10, s[56:59], s82 offen offset:1024 sc1 lds
    buffer_load_dwordx4 v10, s[56:59], s82 offen offset:2048 sc1 lds
    buffer_load_dwordx4 v10, s[56:59], s82 offen offset:3072 sc1 lds
    s_add_u32 s82, s82, 16384
    s_lshl1_add_u32 m0, s33, 49152
    s_nop 0
    buffer_load_dwordx4 v11, s[60:63], s83 offen lds
    s_lshl1_add_u32 m0, s33, 50176
    s_nop 0
    buffer_load_dwordx4 v12, s[60:63], s83 offen lds
    s_lshl1_add_u32 m0, s33, 57344
    s_nop 0
    buffer_load_dwordx4 v11, s[64:67], s83 offen lds
    s_lshl1_add_u32 m0, s33, 58368
    s_nop 0
    buffer_load_dwordx4 v12, s[64:67], s83 offen lds
    s_add_u32 s83, s83, 131072
    s_load_dword s94, s[12:13], s39 offset:0x80000
    s_load_dword s94, s[12:13], s39 offset:0x80040
    s_load_dword s94, s[12:13], s39 offset:0x80080
    s_load_dword s94, s[12:13], s39 offset:0x800c0
    s_cmp_lg_u32 s4, 0
    s_cbranch_scc1 L_fO
    s_lshl_b32 s91, s28, 4
    s_add_u32 s91, s91, s29
    s_lshl_b32 s91, s91, 7
    s_add_u32 s91, s91, 0x1e98000
    v_mov_b32 v16, s91
    v_mov_b32 v18, s100
    v_mov_b32 v19, s101
    s_mov_b64 exec, 1
    global_store_dwordx2 v16, v[18:19], s[26:27] sc1
    s_mov_b64 exec, -1
L_fO:
    s_waitcnt vmcnt(16)
    s_barrier
    s_lshl2_add_u32 m0, s33, 65536
    s_nop 0
    buffer_load_dwordx4 v10, s[56:59], s82 offen offset:0 sc1 lds
    s_mov_b32 s84, 0
    buffer_load_dwordx4 v[120:123], v13, s[72:75], s84 offen
    buffer_load_dwordx4 v10, s[56:59], s82 offen offset:1024 sc1 lds
    buffer_load_dwordx4 v10, s[56:59], s82 offen offset:2048 sc1 lds
    buffer_load_dwordx4 v10, s[56:59], s82 offen offset:3072 sc1 lds
    s_add_u32 s82, s82, 16384
    s_lshl1_add_u32 m0, s33, 81920
    s_nop 0
    buffer_load_dwordx4 v11, s[60:63], s83 offen lds
    s_lshl1_add_u32 m0, s33, 82944
    s_nop 0
    buffer_load_dwordx4 v12, s[60:63], s83 offen lds
    s_lshl1_add_u32 m0, s33, 90112
    s_nop 0
    buffer_load_dwordx4 v11, s[64:67], s83 offen lds
    s_lshl1_add_u32 m0, s33, 91136
    s_nop 0
    buffer_load_dwordx4 v12, s[64:67], s83 offen lds
    s_add_u32 s83, s83, 131072
    s_load_dword s94, s[12:13], s39 offset:0x80100
    s_load_dword s94, s[12:13], s39 offset:0x80140
    s_load_dword s94, s[12:13], s39 offset:0x80180
    s_load_dword s94, s[12:13], s39 offset:0x801c0
    s_waitcnt vmcnt(17)
    s_barrier
    s_lshl_b32 m0, s33, 2
    s_nop 0
    buffer_load_dwordx4 v10, s[56:59], s82 offen offset:0 sc1 lds
    s_mov_b32 s84, 32768
    buffer_load_dwordx4 v[124:127], v13, s[72:75], s84 offen
    buffer_load_dwordx4 v10, s[56:59], s82 offen offset:1024 sc1 lds
    buffer_load_dwordx4 v10, s[56:59], s82 offen offset:2048 sc1 lds
    buffer_load_dwordx4 v10, s[56:59], s82 offen offset:3072 sc1 lds
    s_add_u32 s82, s82, 16384
    s_lshl1_add_u32 m0, s33, 16384
    s_nop 0
    buffer_load_dwordx4 v11, s[60:63], s83 offen lds
    s_lshl1_add_u32 m0, s33, 17408
    s_nop 0
    buffer_load_dwordx4 v12, s[60:63], s83 offen lds
    s_lshl1_add_u32 m0, s33, 24576
    s_nop 0
    buffer_load_dwordx4 v11, s[64:67], s83 offen lds
    s_lshl1_add_u32 m0, s33, 25600
    s_nop 0
    buffer_load_dwordx4 v12, s[64:67], s83 offen lds
    s_add_u32 s83, s83, 131072
    s_add_u32 s39, s39, 0x100000
    s_load_dword s94, s[12:13], s39 offset:0x0
    s_load_dword s94, s[12:13], s39 offset:0x40
    s_load_dword s94, s[12:13], s39 offset:0x80
    s_load_dword s94, s[12:13], s39 offset:0xc0
    s_waitcnt vmcnt(18)
    s_barrier
    s_lshl2_add_u32 m0, s33, 98304
    s_nop 0
    buffer_load_dwordx4 v10, s[56:59], s82 offen offset:0 sc1 lds
    s_mov_b32 s84, 65536
    buffer_load_dwordx4 v[128:131], v13, s[72:75], s84 offen
    buffer_load_dwordx4 v10, s[56:59], s82 offen offset:1024 sc1 lds
    buffer_load_dwordx4 v10, s[56:59], s82 offen offset:2048 sc1 lds
    buffer_load_dwordx4 v10, s[56:59], s82 offen offset:3072 sc1 lds
    s_add_u32 s82, s82, 16384
    s_lshl1_add_u32 m0, s33, 114688
    s_nop 0
    buffer_load_dwordx4 v11, s[60:63], s83 offen lds
    s_lshl1_add_u32 m0, s33, 115712
    s_nop 0
    buffer_load_dwordx4 v12, s[60:63], s83 offen lds
    s_lshl1_add_u32 m0, s33, 122880
    s_nop 0
    buffer_load_dwordx4 v11, s[64:67], s83 offen lds
    s_lshl1_add_u32 m0, s33, 123904
    s_nop 0
    buffer_load_dwordx4 v12, s[64:67], s83 offen lds
    s_add_u32 s83, s83, 131072
    s_load_dword s94, s[12:13], s39 offset:0x100
    s_load_dword s94, s[12:13], s39 offset:0x140
    s_load_dword s94, s[12:13], s39 offset:0x180
    s_load_dword s94, s[12:13], s39 offset:0x1c0
    v_and_b32 v20, 15, v1
    s_lshl_b32 s91, s30, 11
    s_add_u32 s91, s91, 0x1e98000
    v_lshl_add_u32 v20, v20, 7, s91
    global_load_dwordx2 v[22:23], v20, s[26:27] sc1
    s_waitcnt vmcnt(19)
    s_barrier
    s_lshl2_add_u32 m0, s33, 32768
    s_nop 0
    buffer_load_dwordx4 v10, s[56:59], s82 offen offset:0 sc1 lds
    s_mov_b32 s84, 98304
    buffer_load_dwordx4 v[132:135], v13, s[72:75], s84 offen
    buffer_load_dwordx4 v10, s[56:59], s82 offen offset:1024 sc1 lds
    buffer_load_dwordx4 v10, s[56:59], s82 offen offset:2048 sc1 lds
    buffer_load_dwordx4 v10, s[56:59], s82 offen offset:3072 sc1 lds
    s_add_u32 s82, s82, 16384
    s_lshl1_add_u32 m0, s33, 49152
    s_nop 0
    buffer_load_dwordx4 v11, s[60:63], s83 offen lds
    s_lshl1_add_u32 m0, s33, 50176
    s_nop 0
    buffer_load_dwordx4 v12, s[60:63], s83 offen lds
    s_lshl1_add_u32 m0, s33, 57344
    s_nop 0
    buffer_load_dwordx4 v11, s[64:67], s83 offen lds
    s_lshl1_add_u32 m0, s33, 58368
    s_nop 0
    buffer_load_dwordx4 v12, s[64:67], s83 offen lds
    s_add_u32 s83, s83, 131072
    s_load_dword s94, s[12:13], s39 offset:0x80000
    s_load_dword s94, s[12:13], s39 offset:0x80040
    s_load_dword s94, s[12:13], s39 offset:0x80080
    s_load_dword s94, s[12:13], s39 offset:0x800c0
    s_waitcnt vmcnt(19)
    s_barrier
    s_lshl2_add_u32 m0, s33, 65536
    s_nop 0
    buffer_load_dwordx4 v10, s[56:59], s82 offen offset:0 sc1 lds
    buffer_load_dwordx4 v10, s[56:59], s82 offen offset:1024 sc1 lds
    buffer_load_dwordx4 v10, s[56:59], s82 offen offset:2048 sc1 lds
    buffer_load_dwordx4 v10, s[56:59], s82 offen offset:3072 sc1 lds
    s_add_u32 s82, s82, 16384
    s_lshl1_add_u32 m0, s33, 81920
    s_nop 0
    buffer_load_dwordx4 v11, s[60:63], s83 offen lds
    s_lshl1_add_u32 m0, s33, 82944
    s_nop 0
    buffer_load_dwordx4 v12, s[60:63], s83 offen lds
    s_lshl1_add_u32 m0, s33, 90112
    s_nop 0
    buffer_load_dwordx4 v11, s[64:67], s83 offen lds
    s_lshl1_add_u32 m0, s33, 91136
    s_nop 0
    buffer_load_dwordx4 v12, s[64:67], s83 offen lds
    s_add_u32 s83, s83, 131072
    s_load_dword s94, s[12:13], s39 offset:0x80100
    s_load_dword s94, s[12:13], s39 offset:0x80140
    s_load_dword s94, s[12:13], s39 offset:0x80180
    s_load_dword s94, s[12:13], s39 offset:0x801c0
    s_waitcnt vmcnt(17)
    s_movk_i32 s98, 0x4000
L_pO_chk:
    v_cmp_ne_u64 vcc, s[100:101], v[22:23]
    s_nop 1
    s_cmp_eq_u64 vcc, 0
    s_cbranch_scc1 L_pO_ok
    s_sub_u32 s98, s98, 1
    s_cbranch_scc1 L_pO_ok
    s_sleep 1
    global_load_dwordx2 v[22:23], v20, s[26:27] sc1
    s_waitcnt vmcnt(0)
    s_branch L_pO_chk
L_pO_ok:
    s_waitcnt vmcnt(18)
    s_barrier
    s_lshl_b32 s85, s31, 8
    s_lshl_b32 s86, s32, 7
    s_add_u32 s86, s85, s86
    s_xor_b32 s87, s86, 128
    s_add_u32 s60, s12, s86
    s_addc_u32 s61, s13, 0
    s_sub_u32 s62, 2097152, s86
    s_mov_b32 s63, 0x20000
    s_add_u32 s56, s26, 0x1200000
    s_addc_u32 s57, s27, 0
    s_mov_b32 s58, 0x400000
    s_mov_b32 s59, 0x20000
    s_lshl_b32 s82, s30, 18
    s_mov_b32 s83, 0
    s_lshl_b32 m0, s33, 2
    s_nop 0
    buffer_load_dwordx4 v10, s[56:59], s82 offen offset:0 sc1 lds
    buffer_load_dwordx4 v10, s[56:59], s82 offen offset:1024 sc1 lds
    buffer_load_dwordx4 v10, s[56:59], s82 offen offset:2048 sc1 lds
    buffer_load_dwordx4 v10, s[56:59], s82 offen offset:3072 sc1 lds
    s_add_u32 s82, s82, 16384
    s_lshl1_add_u32 m0, s33, 16384
    s_nop 0
    buffer_load_dwordx4 v11, s[60:63], s83 offen lds
    s_lshl1_add_u32 m0, s33, 17408
    s_nop 0
    buffer_load_dwordx4 v12, s[60:63], s83 offen lds
    s_add_u32 s83, s83, 131072
    s_waitcnt vmcnt(14)
    s_barrier
    s_lshl2_add_u32 m0, s33, 98304
    s_nop 0
    buffer_load_dwordx4 v10, s[56:59], s82 offen offset:0 sc1 lds
    buffer_load_dwordx4 v10, s[56:59], s82 offen offset:1024 sc1 lds
    buffer_load_dwordx4 v10, s[56:59], s82 offen offset:2048 sc1 lds
    buffer_load_dwordx4 v10, s[56:59], s82 offen offset:3072 sc1 lds
    s_add_u32 s82, s82, 16384
    s_lshl1_add_u32 m0, s33, 114688
    s_nop 0
    buffer_load_dwordx4 v11, s[60:63], s83 offen lds
    s_lshl1_add_u32 m0, s33, 115712
    s_nop 0
    buffer_load_dwordx4 v12, s[60:63], s83 offen lds
    s_add_u32 s83, s83, 131072
    s_waitcnt vmcnt(12)
    s_barrier
    s_lshl2_add_u32 m0, s33, 32768
    s_nop 0
    buffer_load_dwordx4 v10, s[56:59], s82 offen offset:0 sc1 lds
    buffer_load_dwordx4 v10, s[56:59], s82 offen offset:1024 sc1 lds
    buffer_load_dwordx4 v10, s[56:59], s82 offen offset:2048 sc1 lds
    buffer_load_dwordx4 v10, s[56:59], s82 offen offset:3072 sc1 lds
    s_add_u32 s82, s82, 16384
    s_lshl1_add_u32 m0, s33, 49152
    s_nop 0
    buffer_load_dwordx4 v11, s[60:63], s83 offen lds
    s_lshl1_add_u32 m0, s33, 50176
    s_nop 0
    buffer_load_dwordx4 v12, s[60:63], s83 offen lds
    s_add_u32 s83, s83, 131072
    s_waitcnt vmcnt(12)
    s_barrier
    s_setprio 1
    ds_read_b64_tr_b16 v[40:41], v6 offset:16384
    ds_read_b64_tr_b16 v[42:43], v6 offset:16896
    ds_read_b128 v[24:27], v4 offset:0
    ds_read_b128 v[28:31], v4 offset:1024
    ds_read_b128 v[32:35], v4 offset:2048
    ds_read_b128 v[36:39], v4 offset:3072
    ds_read_b64_tr_b16 v[44:45], v7 offset:16384
    ds_read_b64_tr_b16 v[46:47], v7 offset:16896
    s_mov_b32 s34, 3
.p2align 6
L_s:
    s_waitcnt lgkmcnt(5)
    v_mfma_f32_16x16x32_bf16 v[88:91], v[40:43], v[24:27], v[88:91]
    ds_read_b64_tr_b16 v[72:73], v6 offset:20480
    ds_read_b64_tr_b16 v[74:75], v6 offset:20992
    s_waitcnt lgkmcnt(6)
    v_mfma_f32_16x16x32_bf16 v[92:95], v[40:43], v[28:31], v[92:95]
    ds_read_b128 v[56:59], v4 offset:8192
    ds_read_b128 v[60:63], v4 offset:9216
    s_waitcnt lgkmcnt(7)
    v_mfma_f32_16x16x32_bf16 v[96:99], v[40:43], v[32:35], v[96:99]
    ds_read_b128 v[64:67], v4 offset:10240
    ds_read_b128 v[68:71], v4 offset:11264
    s_waitcnt lgkmcnt(8)
    v_mfma_f32_16x16x32_bf16 v[100:103], v[40:43], v[36:39], v[100:103]
    ds_read_b64_tr_b16 v[76:77], v7 offset:20480
    ds_read_b64_tr_b16 v[78:79], v7 offset:20992
    s_waitcnt lgkmcnt(8)
    v_mfma_f32_16x16x32_bf16 v[104:107], v[44:47], v[24:27], v[104:107]
    v_mfma_f32_16x16x32_bf16 v[108:111], v[44:47], v[28:31], v[108:111]
    v_mfma_f32_16x16x32_bf16 v[112:115], v[44:47], v[32:35], v[112:115]
    v_mfma_f32_16x16x32_bf16 v[116:119], v[44:47], v[36:39], v[116:119]
    s_waitcnt vmcnt(6) lgkmcnt(0)
    s_barrier
    v_mfma_f32_16x16x32_bf16 v[88:91], v[72:75], v[56:59], v[88:91]
    ds_read_b64_tr_b16 v[40:41], v8 offset:49152
    ds_read_b64_tr_b16 v[42:43], v8 offset:49664
    v_mfma_f32_16x16x32_bf16 v[92:95], v[72:75], v[60:63], v[92:95]
    ds_read_b128 v[24:27], v5 offset:32768
    ds_read_b128 v[28:31], v5 offset:33792
    v_mfma_f32_16x16x32_bf16 v[96:99], v[72:75], v[64:67], v[96:99]
    ds_read_b128 v[32:35], v5 offset:34816
    v_mfma_f32_16x16x32_bf16 v[100:103], v[72:75], v[68:71], v[100:103]
    ds_read_b128 v[36:39], v5 offset:35840
    ds_read_b64_tr_b16 v[44:45], v9 offset:49152
    v_mfma_f32_16x16x32_bf16 v[104:107], v[76:79], v[56:59], v[104:107]
    ds_read_b64_tr_b16 v[46:47], v9 offset:49664
    v_mfma_f32_16x16x32_bf16 v[108:111], v[76:79], v[60:63], v[108:111]
    v_mfma_f32_16x16x32_bf16 v[112:115], v[76:79], v[64:67], v[112:115]
    v_mfma_f32_16x16x32_bf16 v[116:119], v[76:79], v[68:71], v[116:119]
    s_waitcnt lgkmcnt(5)
    v_mfma_f32_16x16x32_bf16 v[88:91], v[40:43], v[24:27], v[88:91]
    ds_read_b64_tr_b16 v[72:73], v8 offset:53248
    ds_read_b64_tr_b16 v[74:75], v8 offset:53760
    s_waitcnt lgkmcnt(6)
    v_mfma_f32_16x16x32_bf16 v[92:95], v[40:43], v[28:31], v[92:95]
    ds_read_b128 v[56:59], v5 offset:40960
    ds_read_b128 v[60:63], v5 offset:41984
    s_waitcnt lgkmcnt(7)
    v_mfma_f32_16x16x32_bf16 v[96:99], v[40:43], v[32:35], v[96:99]
    ds_read_b128 v[64:67], v5 offset:43008
    ds_read_b128 v[68:71], v5 offset:44032
    s_waitcnt lgkmcnt(8)
    v_mfma_f32_16x16x32_bf16 v[100:103], v[40:43], v[36:39], v[100:103]
    ds_read_b64_tr_b16 v[76:77], v9 offset:53248
    ds_read_b64_tr_b16 v[78:79], v9 offset:53760
    s_waitcnt lgkmcnt(8)
    v_mfma_f32_16x16x32_bf16 v[104:107], v[44:47], v[24:27], v[104:107]
    v_mfma_f32_16x16x32_bf16 v[108:111], v[44:47], v[28:31], v[108:111]
    v_mfma_f32_16x16x32_bf16 v[112:115], v[44:47], v[32:35], v[112:115]
    v_mfma_f32_16x16x32_bf16 v[116:119], v[44:47], v[36:39], v[116:119]
    s_waitcnt vmcnt(0) lgkmcnt(0)
    s_barrier
    v_mfma_f32_16x16x32_bf16 v[88:91], v[72:75], v[56:59], v[88:91]
    ds_read_b64_tr_b16 v[40:41], v6 offset:49152
    ds_read_b64_tr_b16 v[42:43], v6 offset:49664
    v_mfma_f32_16x16x32_bf16 v[92:95], v[72:75], v[60:63], v[92:95]
    ds_read_b128 v[24:27], v4 offset:32768
    ds_read_b128 v[28:31], v4 offset:33792
    v_mfma_f32_16x16x32_bf16 v[96:99], v[72:75], v[64:67], v[96:99]
    ds_read_b128 v[32:35], v4 offset:34816
    v_mfma_f32_16x16x32_bf16 v[100:103], v[72:75], v[68:71], v[100:103]
    ds_read_b128 v[36:39], v4 offset:35840
    ds_read_b64_tr_b16 v[44:45], v7 offset:49152
    v_mfma_f32_16x16x32_bf16 v[104:107], v[76:79], v[56:59], v[104:107]
    ds_read_b64_tr_b16 v[46:47], v7 offset:49664
    v_mfma_f32_16x16x32_bf16 v[108:111], v[76:79], v[60:63], v[108:111]
    v_mfma_f32_16x16x32_bf16 v[112:115], v[76:79], v[64:67], v[112:115]
    v_mfma_f32_16x16x32_bf16 v[116:119], v[76:79], v[68:71], v[116:119]
    s_waitcnt lgkmcnt(5)
    v_mfma_f32_16x16x32_bf16 v[88:91], v[40:43], v[24:27], v[88:91]
    ds_read_b64_tr_b16 v[72:73], v6 offset:53248
    ds_read_b64_tr_b16 v[74:75], v6 offset:53760
    s_waitcnt lgkmcnt(6)
    v_mfma_f32_16x16x32_bf16 v[92:95], v[40:43], v[28:31], v[92:95]
    ds_read_b128 v[56:59], v4 offset:40960
    ds_read_b128 v[60:63], v4 offset:41984
    s_waitcnt lgkmcnt(7)
    v_mfma_f32_16x16x32_bf16 v[96:99], v[40:43], v[32:35], v[96:99]
    ds_read_b128 v[64:67], v4 offset:43008
    ds_read_b128 v[68:71], v4 offset:44032
    s_waitcnt lgkmcnt(8)
    v_mfma_f32_16x16x32_bf16 v[100:103], v[40:43], v[36:39], v[100:103]
    ds_read_b64_tr_b16 v[76:77], v7 offset:53248
    ds_read_b64_tr_b16 v[78:79], v7 offset:53760
    s_waitcnt lgkmcnt(8)
    v_mfma_f32_16x16x32_bf16 v[104:107], v[44:47], v[24:27], v[104:107]
    v_mfma_f32_16x16x32_bf16 v[108:111], v[44:47], v[28:31], v[108:111]
    v_mfma_f32_16x16x32_bf16 v[112:115], v[44:47], v[32:35], v[112:115]
    v_mfma_f32_16x16x32_bf16 v[116:119], v[44:47], v[36:39], v[116:119]
    s_waitcnt lgkmcnt(0)
    s_barrier
    v_mfma_f32_16x16x32_bf16 v[88:91], v[72:75], v[56:59], v[88:91]
    ds_read_b64_tr_b16 v[40:41], v8 offset:16384
    ds_read_b64_tr_b16 v[42:43], v8 offset:16896
    v_mfma_f32_16x16x32_bf16 v[92:95], v[72:75], v[60:63], v[92:95]
    ds_read_b128 v[24:27], v5 offset:0
    ds_read_b128 v[28:31], v5 offset:1024
    v_mfma_f32_16x16x32_bf16 v[96:99], v[72:75], v[64:67], v[96:99]
    ds_read_b128 v[32:35], v5 offset:2048
    v_mfma_f32_16x16x32_bf16 v[100:103], v[72:75], v[68:71], v[100:103]
    ds_read_b128 v[36:39], v5 offset:3072
    ds_read_b64_tr_b16 v[44:45], v9 offset:16384
    v_mfma_f32_16x16x32_bf16 v[104:107], v[76:79], v[56:59], v[104:107]
    ds_read_b64_tr_b16 v[46:47], v9 offset:16896
    v_mfma_f32_16x16x32_bf16 v[108:111], v[76:79], v[60:63], v[108:111]
    v_mfma_f32_16x16x32_bf16 v[112:115], v[76:79], v[64:67], v[112:115]
    v_mfma_f32_16x16x32_bf16 v[116:119], v[76:79], v[68:71], v[116:119]
    s_waitcnt lgkmcnt(5)
    v_mfma_f32_16x16x32_bf16 v[88:91], v[40:43], v[24:27], v[88:91]
    ds_read_b64_tr_b16 v[72:73], v8 offset:20480
    ds_read_b64_tr_b16 v[74:75], v8 offset:20992
    s_waitcnt lgkmcnt(6)
    v_mfma_f32_16x16x32_bf16 v[92:95], v[40:43], v[28:31], v[92:95]
    ds_read_b128 v[56:59], v5 offset:8192
    ds_read_b128 v[60:63], v5 offset:9216
    s_waitcnt lgkmcnt(7)
    v_mfma_f32_16x16x32_bf16 v[96:99], v[40:43], v[32:35], v[96:99]
    ds_read_b128 v[64:67], v5 offset:10240
    ds_read_b128 v[68:71], v5 offset:11264
    s_waitcnt lgkmcnt(8)
    v_mfma_f32_16x16x32_bf16 v[100:103], v[40:43], v[36:39], v[100:103]
    ds_read_b64_tr_b16 v[76:77], v9 offset:20480
    ds_read_b64_tr_b16 v[78:79], v9 offset:20992
    s_waitcnt lgkmcnt(8)
    v_mfma_f32_16x16x32_bf16 v[104:107], v[44:47], v[24:27], v[104:107]
    v_mfma_f32_16x16x32_bf16 v[108:111], v[44:47], v[28:31], v[108:111]
    v_mfma_f32_16x16x32_bf16 v[112:115], v[44:47], v[32:35], v[112:115]
    v_mfma_f32_16x16x32_bf16 v[116:119], v[44:47], v[36:39], v[116:119]
    s_waitcnt lgkmcnt(0)
    s_barrier
    v_mfma_f32_16x16x32_bf16 v[88:91], v[72:75], v[56:59], v[88:91]
    ds_read_b64_tr_b16 v[40:41], v6 offset:16384
    ds_read_b64_tr_b16 v[42:43], v6 offset:16896
    v_mfma_f32_16x16x32_bf16 v[92:95], v[72:75], v[60:63], v[92:95]
    ds_read_b128 v[24:27], v4 offset:0
    ds_read_b128 v[28:31], v4 offset:1024
    v_mfma_f32_16x16x32_bf16 v[96:99], v[72:75], v[64:67], v[96:99]
    ds_read_b128 v[32:35], v4 offset:2048
    v_mfma_f32_16x16x32_bf16 v[100:103], v[72:75], v[68:71], v[100:103]
    ds_read_b128 v[36:39], v4 offset:3072
    ds_read_b64_tr_b16 v[44:45], v7 offset:16384
    v_mfma_f32_16x16x32_bf16 v[104:107], v[76:79], v[56:59], v[104:107]
    ds_read_b64_tr_b16 v[46:47], v7 offset:16896
    v_mfma_f32_16x16x32_bf16 v[108:111], v[76:79], v[60:63], v[108:111]
    v_mfma_f32_16x16x32_bf16 v[112:115], v[76:79], v[64:67], v[112:115]
    v_mfma_f32_16x16x32_bf16 v[116:119], v[76:79], v[68:71], v[116:119]
    s_sub_u32 s34, s34, 1
    s_cmp_lg_u32 s34, 0
    s_cbranch_scc1 L_s
    s_waitcnt lgkmcnt(5)
    v_mfma_f32_16x16x32_bf16 v[88:91], v[40:43], v[24:27], v[88:91]
    ds_read_b64_tr_b16 v[72:73], v6 offset:20480
    ds_read_b64_tr_b16 v[74:75], v6 offset:20992
    s_waitcnt lgkmcnt(6)
    v_mfma_f32_16x16x32_bf16 v[92:95], v[40:43], v[28:31], v[92:95]
    ds_read_b128 v[56:59], v4 offset:8192
    ds_read_b128 v[60:63], v4 offset:9216
    s_waitcnt lgkmcnt(7)
    v_mfma_f32_16x16x32_bf16 v[96:99], v[40:43], v[32:35], v[96:99]
    ds_read_b128 v[64:67], v4 offset:10240
    ds_read_b128 v[68:71], v4 offset:11264
    s_waitcnt lgkmcnt(8)
    v_mfma_f32_16x16x32_bf16 v[100:103], v[40:43], v[36:39], v[100:103]
    ds_read_b64_tr_b16 v[76:77], v7 offset:20480
    ds_read_b64_tr_b16 v[78:79], v7 offset:20992
    s_waitcnt lgkmcnt(8)
    v_mfma_f32_16x16x32_bf16 v[104:107], v[44:47], v[24:27], v[104:107]
    v_mfma_f32_16x16x32_bf16 v[108:111], v[44:47], v[28:31], v[108:111]
    v_mfma_f32_16x16x32_bf16 v[112:115], v[44:47], v[32:35], v[112:115]
    v_mfma_f32_16x16x32_bf16 v[116:119], v[44:47], v[36:39], v[116:119]
    s_waitcnt lgkmcnt(0)
    s_barrier
    v_mfma_f32_16x16x32_bf16 v[88:91], v[72:75], v[56:59], v[88:91]
    ds_read_b64_tr_b16 v[40:41], v8 offset:49152
    ds_read_b64_tr_b16 v[42:43], v8 offset:49664
    v_mfma_f32_16x16x32_bf16 v[92:95], v[72:75], v[60:63], v[92:95]
    ds_read_b128 v[24:27], v5 offset:32768
    ds_read_b128 v[28:31], v5 offset:33792
    v_mfma_f32_16x16x32_bf16 v[96:99], v[72:75], v[64:67], v[96:99]
    ds_read_b128 v[32:35], v5 offset:34816
    v_mfma_f32_16x16x32_bf16 v[100:103], v[72:75], v[68:71], v[100:103]
    ds_read_b128 v[36:39], v5 offset:35840
    ds_read_b64_tr_b16 v[44:45], v9 offset:49152
    v_mfma_f32_16x16x32_bf16 v[104:107], v[76:79], v[56:59], v[104:107]
    ds_read_b64_tr_b16 v[46:47], v9 offset:49664
    v_mfma_f32_16x16x32_bf16 v[108:111], v[76:79], v[60:63], v[108:111]
    v_mfma_f32_16x16x32_bf16 v[112:115], v[76:79], v[64:67], v[112:115]
    v_mfma_f32_16x16x32_bf16 v[116:119], v[76:79], v[68:71], v[116:119]
    s_waitcnt lgkmcnt(5)
    v_mfma_f32_16x16x32_bf16 v[88:91], v[40:43], v[24:27], v[88:91]
    ds_read_b64_tr_b16 v[72:73], v8 offset:53248
    ds_read_b64_tr_b16 v[74:75], v8 offset:53760
    s_waitcnt lgkmcnt(6)
    v_mfma_f32_16x16x32_bf16 v[92:95], v[40:43], v[28:31], v[92:95]
    ds_read_b128 v[56:59], v5 offset:40960
    ds_read_b128 v[60:63], v5 offset:41984
    s_waitcnt lgkmcnt(7)
    v_mfma_f32_16x16x32_bf16 v[96:99], v[40:43], v[32:35], v[96:99]
    ds_read_b128 v[64:67], v5 offset:43008
    ds_read_b128 v[68:71], v5 offset:44032
    s_waitcnt lgkmcnt(8)
    v_mfma_f32_16x16x32_bf16 v[100:103], v[40:43], v[36:39], v[100:103]
    ds_read_b64_tr_b16 v[76:77], v9 offset:53248
    ds_read_b64_tr_b16 v[78:79], v9 offset:53760
    s_waitcnt lgkmcnt(8)
    v_mfma_f32_16x16x32_bf16 v[104:107], v[44:47], v[24:27], v[104:107]
    v_mfma_f32_16x16x32_bf16 v[108:111], v[44:47], v[28:31], v[108:111]
    v_mfma_f32_16x16x32_bf16 v[112:115], v[44:47], v[32:35], v[112:115]
    v_mfma_f32_16x16x32_bf16 v[116:119], v[44:47], v[36:39], v[116:119]
    s_waitcnt lgkmcnt(0)
    s_barrier
    v_mfma_f32_16x16x32_bf16 v[88:91], v[72:75], v[56:59], v[88:91]
    ds_read_b64_tr_b16 v[40:41], v6 offset:49152
    ds_read_b64_tr_b16 v[42:43], v6 offset:49664
    v_mfma_f32_16x16x32_bf16 v[92:95], v[72:75], v[60:63], v[92:95]
    ds_read_b128 v[24:27], v4 offset:32768
    ds_read_b128 v[28:31], v4 offset:33792
    v_mfma_f32_16x16x32_bf16 v[96:99], v[72:75], v[64:67], v[96:99]
    ds_read_b128 v[32:35], v4 offset:34816
    v_mfma_f32_16x16x32_bf16 v[100:103], v[72:75], v[68:71], v[100:103]
    ds_read_b128 v[36:39], v4 offset:35840
    ds_read_b64_tr_b16 v[44:45], v7 offset:49152
    v_mfma_f32_16x16x32_bf16 v[104:107], v[76:79], v[56:59], v[104:107]
    ds_read_b64_tr_b16 v[46:47], v7 offset:49664
    v_mfma_f32_16x16x32_bf16 v[108:111], v[76:79], v[60:63], v[108:111]
    v_mfma_f32_16x16x32_bf16 v[112:115], v[76:79], v[64:67], v[112:115]
    v_mfma_f32_16x16x32_bf16 v[116:119], v[76:79], v[68:71], v[116:119]
    s_waitcnt lgkmcnt(5)
    v_mfma_f32_16x16x32_bf16 v[88:91], v[40:43], v[24:27], v[88:91]
    ds_read_b64_tr_b16 v[72:73], v6 offset:53248
    ds_read_b64_tr_b16 v[74:75], v6 offset:53760
    s_waitcnt lgkmcnt(6)
    v_mfma_f32_16x16x32_bf16 v[92:95], v[40:43], v[28:31], v[92:95]
    ds_read_b128 v[56:59], v4 offset:40960
    ds_read_b128 v[60:63], v4 offset:41984
    s_waitcnt lgkmcnt(7)
    v_mfma_f32_16x16x32_bf16 v[96:99], v[40:43], v[32:35], v[96:99]
    ds_read_b128 v[64:67], v4 offset:43008
    ds_read_b128 v[68:71], v4 offset:44032
    s_waitcnt lgkmcnt(8)
    v_mfma_f32_16x16x32_bf16 v[100:103], v[40:43], v[36:39], v[100:103]
    ds_read_b64_tr_b16 v[76:77], v7 offset:53248
    ds_read_b64_tr_b16 v[78:79], v7 offset:53760
    s_waitcnt lgkmcnt(8)
    v_mfma_f32_16x16x32_bf16 v[104:107], v[44:47], v[24:27], v[104:107]
    v_mfma_f32_16x16x32_bf16 v[108:111], v[44:47], v[28:31], v[108:111]
    v_mfma_f32_16x16x32_bf16 v[112:115], v[44:47], v[32:35], v[112:115]
    v_mfma_f32_16x16x32_bf16 v[116:119], v[44:47], v[36:39], v[116:119]
    s_waitcnt lgkmcnt(0)
    s_barrier
    v_mfma_f32_16x16x32_bf16 v[88:91], v[72:75], v[56:59], v[88:91]
    ds_read_b64_tr_b16 v[40:41], v8 offset:16384
    ds_read_b64_tr_b16 v[42:43], v8 offset:16896
    v_mfma_f32_16x16x32_bf16 v[92:95], v[72:75], v[60:63], v[92:95]
    ds_read_b128 v[24:27], v5 offset:0
    ds_read_b128 v[28:31], v5 offset:1024
    v_mfma_f32_16x16x32_bf16 v[96:99], v[72:75], v[64:67], v[96:99]
    ds_read_b128 v[32:35], v5 offset:2048
    v_mfma_f32_16x16x32_bf16 v[100:103], v[72:75], v[68:71], v[100:103]
    ds_read_b128 v[36:39], v5 offset:3072
    ds_read_b64_tr_b16 v[44:45], v9 offset:16384
    v_mfma_f32_16x16x32_bf16 v[104:107], v[76:79], v[56:59], v[104:107]
    ds_read_b64_tr_b16 v[46:47], v9 offset:16896
    v_mfma_f32_16x16x32_bf16 v[108:111], v[76:79], v[60:63], v[108:111]
    v_mfma_f32_16x16x32_bf16 v[112:115], v[76:79], v[64:67], v[112:115]
    v_mfma_f32_16x16x32_bf16 v[116:119], v[76:79], v[68:71], v[116:119]
    s_waitcnt lgkmcnt(5)
    v_mfma_f32_16x16x32_bf16 v[88:91], v[40:43], v[24:27], v[88:91]
    ds_read_b64_tr_b16 v[72:73], v8 offset:20480
    ds_read_b64_tr_b16 v[74:75], v8 offset:20992
    s_waitcnt lgkmcnt(6)
    v_mfma_f32_16x16x32_bf16 v[92:95], v[40:43], v[28:31], v[92:95]
    ds_read_b128 v[56:59], v5 offset:8192
    ds_read_b128 v[60:63], v5 offset:9216
    s_waitcnt lgkmcnt(7)
    v_mfma_f32_16x16x32_bf16 v[96:99], v[40:43], v[32:35], v[96:99]
    ds_read_b128 v[64:67], v5 offset:10240
    ds_read_b128 v[68:71], v5 offset:11264
    s_waitcnt lgkmcnt(8)
    v_mfma_f32_16x16x32_bf16 v[100:103], v[40:43], v[36:39], v[100:103]
    ds_read_b64_tr_b16 v[76:77], v9 offset:20480
    ds_read_b64_tr_b16 v[78:79], v9 offset:20992
    s_waitcnt lgkmcnt(8)
    v_mfma_f32_16x16x32_bf16 v[104:107], v[44:47], v[24:27], v[104:107]
    v_mfma_f32_16x16x32_bf16 v[108:111], v[44:47], v[28:31], v[108:111]
    v_mfma_f32_16x16x32_bf16 v[112:115], v[44:47], v[32:35], v[112:115]
    v_mfma_f32_16x16x32_bf16 v[116:119], v[44:47], v[36:39], v[116:119]
    s_waitcnt lgkmcnt(5)
    v_mfma_f32_16x16x32_bf16 v[88:91], v[72:75], v[56:59], v[88:91]
    s_waitcnt lgkmcnt(4)
    v_mfma_f32_16x16x32_bf16 v[92:95], v[72:75], v[60:63], v[92:95]
    s_waitcnt lgkmcnt(3)
    v_mfma_f32_16x16x32_bf16 v[96:99], v[72:75], v[64:67], v[96:99]
    s_waitcnt lgkmcnt(2)
    v_mfma_f32_16x16x32_bf16 v[100:103], v[72:75], v[68:71], v[100:103]
    s_waitcnt lgkmcnt(0)
    v_mfma_f32_16x16x32_bf16 v[104:107], v[76:79], v[56:59], v[104:107]
    v_mfma_f32_16x16x32_bf16 v[108:111], v[76:79], v[60:63], v[108:111]
    v_mfma_f32_16x16x32_bf16 v[112:115], v[76:79], v[64:67], v[112:115]
    v_mfma_f32_16x16x32_bf16 v[116:119], v[76:79], v[68:71], v[116:119]
    s_barrier
    s_lshl_b32 s84, s4, 12
    s_add_u32 s84, s84, 131072
    v_lshl_add_u32 v4, v1, 3, s84
    ds_read_b64 v[24:25], v4 offset:0
    ds_read_b64 v[26:27], v4 offset:512
    ds_read_b64 v[28:29], v4 offset:1024
    ds_read_b64 v[30:31], v4 offset:1536
    ds_read_b64 v[32:33], v4 offset:2048
    ds_read_b64 v[34:35], v4 offset:2560
    ds_read_b64 v[36:37], v4 offset:3072
    ds_read_b64 v[38:39], v4 offset:3584
    s_mov_b32 s72, s22
    s_mov_b32 s73, s23
    s_mov_b32 s74, 0x400000
    s_mov_b32 s75, 0x20000
    v_cvt_pk_bf16_f32 v44, v88, v89
    v_cvt_pk_bf16_f32 v45, v90, v91
    v_lshlrev_b32 v88, 16, v44
    v_and_b32 v89, 0xffff0000, v44
    v_lshlrev_b32 v90, 16, v45
    v_and_b32 v91, 0xffff0000, v45
    v_cvt_pk_bf16_f32 v44, v92, v93
    v_cvt_pk_bf16_f32 v45, v94, v95
    v_lshlrev_b32 v92, 16, v44
    v_and_b32 v93, 0xffff0000, v44
    v_lshlrev_b32 v94, 16, v45
    v_and_b32 v95, 0xffff0000, v45
    v_cvt_pk_bf16_f32 v44, v96, v97
    v_cvt_pk_bf16_f32 v45, v98, v99
    v_lshlrev_b32 v96, 16, v44
    v_and_b32 v97, 0xffff0000, v44
    v_lshlrev_b32 v98, 16, v45
    v_and_b32 v99, 0xffff0000, v45
    v_cvt_pk_bf16_f32 v44, v100, v101
    v_cvt_pk_bf16_f32 v45, v102, v103
    v_lshlrev_b32 v100, 16, v44
    v_and_b32 v101, 0xffff0000, v44
    v_lshlrev_b32 v102, 16, v45
    v_and_b32 v103, 0xffff0000, v45
    v_cvt_pk_bf16_f32 v44, v104, v105
    v_cvt_pk_bf16_f32 v45, v106, v107
    v_lshlrev_b32 v104, 16, v44
    v_and_b32 v105, 0xffff0000, v44
    v_lshlrev_b32 v106, 16, v45
    v_and_b32 v107, 0xffff0000, v45
    v_cvt_pk_bf16_f32 v44, v108, v109
    v_cvt_pk_bf16_f32 v45, v110, v111
    v_lshlrev_b32 v108, 16, v44
    v_and_b32 v109, 0xffff0000, v44
    v_lshlrev_b32 v110, 16, v45
    v_and_b32 v111, 0xffff0000, v45
    v_cvt_pk_bf16_f32 v44, v112, v113
    v_cvt_pk_bf16_f32 v45, v114, v115
    v_lshlrev_b32 v112, 16, v44
    v_and_b32 v113, 0xffff0000, v44
    v_lshlrev_b32 v114, 16, v45
    v_and_b32 v115, 0xffff0000, v45
    v_cvt_pk_bf16_f32 v44, v116, v117
    v_cvt_pk_bf16_f32 v45, v118, v119
    v_lshlrev_b32 v116, 16, v44
    v_and_b32 v117, 0xffff0000, v44
    v_lshlrev_b32 v118, 16, v45
    v_and_b32 v119, 0xffff0000, v45
    s_waitcnt lgkmcnt(0)
    v_lshlrev_b32 v40, 16, v24
    v_and_b32 v41, 0xffff0000, v24
    v_lshlrev_b32 v42, 16, v25
    v_and_b32 v43, 0xffff0000, v25
    v_mul_f32 v40, v40, v88
    v_mul_f32 v41, v41, v89
    v_mul_f32 v42, v42, v90
    v_mul_f32 v43, v43, v91
    v_cvt_pk_bf16_f32 v48, v40, v41
    v_cvt_pk_bf16_f32 v49, v42, v43
    v_lshlrev_b32 v40, 16, v32
    v_and_b32 v41, 0xffff0000, v32
    v_lshlrev_b32 v42, 16, v33
    v_and_b32 v43, 0xffff0000, v33
    v_mul_f32 v40, v40, v104
    v_mul_f32 v41, v41, v105
    v_mul_f32 v42, v42, v106
    v_mul_f32 v43, v43, v107
    v_cvt_pk_bf16_f32 v50, v40, v41
    v_cvt_pk_bf16_f32 v51, v42, v43
    s_nop 1
    v_permlane16_swap_b32 v48, v50
    v_permlane16_swap_b32 v49, v51
    v_lshlrev_b32 v40, 16, v48
    v_and_b32 v41, 0xffff0000, v48
    v_lshlrev_b32 v42, 16, v120
    v_and_b32 v43, 0xffff0000, v120
    v_add_f32 v40, v40, v42
    v_add_f32 v41, v41, v43
    v_cvt_pk_bf16_f32 v48, v40, v41
    v_lshlrev_b32 v40, 16, v49
    v_and_b32 v41, 0xffff0000, v49
    v_lshlrev_b32 v42, 16, v121
    v_and_b32 v43, 0xffff0000, v121
    v_add_f32 v40, v40, v42
    v_add_f32 v41, v41, v43
    v_cvt_pk_bf16_f32 v49, v40, v41
    v_lshlrev_b32 v40, 16, v50
    v_and_b32 v41, 0xffff0000, v50
    v_lshlrev_b32 v42, 16, v122
    v_and_b32 v43, 0xffff0000, v122
    v_add_f32 v40, v40, v42
    v_add_f32 v41, v41, v43
    v_cvt_pk_bf16_f32 v50, v40, v41
    v_lshlrev_b32 v40, 16, v51
    v_and_b32 v41, 0xffff0000, v51
    v_lshlrev_b32 v42, 16, v123
    v_and_b32 v43, 0xffff0000, v123
    v_add_f32 v40, v40, v42
    v_add_f32 v41, v41, v43
    v_cvt_pk_bf16_f32 v51, v40, v41
    s_mov_b32 s84, 0
    buffer_store_dwordx4 v[48:51], v13, s[72:75], s84 offen
    v_lshlrev_b32 v40, 16, v26
    v_and_b32 v41, 0xffff0000, v26
    v_lshlrev_b32 v42, 16, v27
    v_and_b32 v43, 0xffff0000, v27
    v_mul_f32 v40, v40, v92
    v_mul_f32 v41, v41, v93
    v_mul_f32 v42, v42, v94
    v_mul_f32 v43, v43, v95
    v_cvt_pk_bf16_f32 v52, v40, v41
    v_cvt_pk_bf16_f32 v53, v42, v43
    v_lshlrev_b32 v40, 16, v34
    v_and_b32 v41, 0xffff0000, v34
    v_lshlrev_b32 v42, 16, v35
    v_and_b32 v43, 0xffff0000, v35
    v_mul_f32 v40, v40, v108
    v_mul_f32 v41, v41, v109
    v_mul_f32 v42, v42, v110
    v_mul_f32 v43, v43, v111
    v_cvt_pk_bf16_f32 v54, v40, v41
    v_cvt_pk_bf16_f32 v55, v42, v43
    s_nop 1
    v_permlane16_swap_b32 v52, v54
    v_permlane16_swap_b32 v53, v55
    v_lshlrev_b32 v40, 16, v52
    v_and_b32 v41, 0xffff0000, v52
    v_lshlrev_b32 v42, 16, v124
    v_and_b32 v43, 0xffff0000, v124
    v_add_f32 v40, v40, v42
    v_add_f32 v41, v41, v43
    v_cvt_pk_bf16_f32 v52, v40, v41
    v_lshlrev_b32 v40, 16, v53
    v_and_b32 v41, 0xffff0000, v53
    v_lshlrev_b32 v42, 16, v125
    v_and_b32 v43, 0xffff0000, v125
    v_add_f32 v40, v40, v42
    v_add_f32 v41, v41, v43
    v_cvt_pk_bf16_f32 v53, v40, v41
    v_lshlrev_b32 v40, 16, v54
    v_and_b32 v41, 0xffff0000, v54
    v_lshlrev_b32 v42, 16, v126
    v_and_b32 v43, 0xffff0000, v126
    v_add_f32 v40, v40, v42
    v_add_f32 v41, v41, v43
    v_cvt_pk_bf16_f32 v54, v40, v41
    v_lshlrev_b32 v40, 16, v55
    v_and_b32 v41, 0xffff0000, v55
    v_lshlrev_b32 v42, 16, v127
    v_and_b32 v43, 0xffff0000, v127
    v_add_f32 v40, v40, v42
    v_add_f32 v41, v41, v43
    v_cvt_pk_bf16_f32 v55, v40, v41
    s_mov_b32 s84, 32768
    buffer_store_dwordx4 v[52:55], v13, s[72:75], s84 offen
    v_lshlrev_b32 v40, 16, v28
    v_and_b32 v41, 0xffff0000, v28
    v_lshlrev_b32 v42, 16, v29
    v_and_b32 v43, 0xffff0000, v29
    v_mul_f32 v40, v40, v96
    v_mul_f32 v41, v41, v97
    v_mul_f32 v42, v42, v98
    v_mul_f32 v43, v43, v99
    v_cvt_pk_bf16_f32 v56, v40, v41
    v_cvt_pk_bf16_f32 v57, v42, v43
    v_lshlrev_b32 v40, 16, v36
    v_and_b32 v41, 0xffff0000, v36
    v_lshlrev_b32 v42, 16, v37
    v_and_b32 v43, 0xffff0000, v37
    v_mul_f32 v40, v40, v112
    v_mul_f32 v41, v41, v113
    v_mul_f32 v42, v42, v114
    v_mul_f32 v43, v43, v115
    v_cvt_pk_bf16_f32 v58, v40, v41
    v_cvt_pk_bf16_f32 v59, v42, v43
    s_nop 1
    v_permlane16_swap_b32 v56, v58
    v_permlane16_swap_b32 v57, v59
    v_lshlrev_b32 v40, 16, v56
    v_and_b32 v41, 0xffff0000, v56
    v_lshlrev_b32 v42, 16, v128
    v_and_b32 v43, 0xffff0000, v128
    v_add_f32 v40, v40, v42
    v_add_f32 v41, v41, v43
    v_cvt_pk_bf16_f32 v56, v40, v41
    v_lshlrev_b32 v40, 16, v57
    v_and_b32 v41, 0xffff0000, v57
    v_lshlrev_b32 v42, 16, v129
    v_and_b32 v43, 0xffff0000, v129
    v_add_f32 v40, v40, v42
    v_add_f32 v41, v41, v43
    v_cvt_pk_bf16_f32 v57, v40, v41
    v_lshlrev_b32 v40, 16, v58
    v_and_b32 v41, 0xffff0000, v58
    v_lshlrev_b32 v42, 16, v130
    v_and_b32 v43, 0xffff0000, v130
    v_add_f32 v40, v40, v42
    v_add_f32 v41, v41, v43
    v_cvt_pk_bf16_f32 v58, v40, v41
    v_lshlrev_b32 v40, 16, v59
    v_and_b32 v41, 0xffff0000, v59
    v_lshlrev_b32 v42, 16, v131
    v_and_b32 v43, 0xffff0000, v131
    v_add_f32 v40, v40, v42
    v_add_f32 v41, v41, v43
    v_cvt_pk_bf16_f32 v59, v40, v41
    s_mov_b32 s84, 65536
    buffer_store_dwordx4 v[56:59], v13, s[72:75], s84 offen
    v_lshlrev_b32 v40, 16, v30
    v_and_b32 v41, 0xffff0000, v30
    v_lshlrev_b32 v42, 16, v31
    v_and_b32 v43, 0xffff0000, v31
    v_mul_f32 v40, v40, v100
    v_mul_f32 v41, v41, v101
    v_mul_f32 v42, v42, v102
    v_mul_f32 v43, v43, v103
    v_cvt_pk_bf16_f32 v60, v40, v41
    v_cvt_pk_bf16_f32 v61, v42, v43
    v_lshlrev_b32 v40, 16, v38
    v_and_b32 v41, 0xffff0000, v38
    v_lshlrev_b32 v42, 16, v39
    v_and_b32 v43, 0xffff0000, v39
    v_mul_f32 v40, v40, v116
    v_mul_f32 v41, v41, v117
    v_mul_f32 v42, v42, v118
    v_mul_f32 v43, v43, v119
    v_cvt_pk_bf16_f32 v62, v40, v41
    v_cvt_pk_bf16_f32 v63, v42, v43
    s_nop 1
    v_permlane16_swap_b32 v60, v62
    v_permlane16_swap_b32 v61, v63
    v_lshlrev_b32 v40, 16, v60
    v_and_b32 v41, 0xffff0000, v60
    v_lshlrev_b32 v42, 16, v132
    v_and_b32 v43, 0xffff0000, v132
    v_add_f32 v40, v40, v42
    v_add_f32 v41, v41, v43
    v_cvt_pk_bf16_f32 v60, v40, v41
    v_lshlrev_b32 v40, 16, v61
    v_and_b32 v41, 0xffff0000, v61
    v_lshlrev_b32 v42, 16, v133
    v_and_b32 v43, 0xffff0000, v133
    v_add_f32 v40, v40, v42
    v_add_f32 v41, v41, v43
    v_cvt_pk_bf16_f32 v61, v40, v41
    v_lshlrev_b32 v40, 16, v62
    v_and_b32 v41, 0xffff0000, v62
    v_lshlrev_b32 v42, 16, v134
    v_and_b32 v43, 0xffff0000, v134
    v_add_f32 v40, v40, v42
    v_add_f32 v41, v41, v43
    v_cvt_pk_bf16_f32 v62, v40, v41
    v_lshlrev_b32 v40, 16, v63
    v_and_b32 v41, 0xffff0000, v63
    v_lshlrev_b32 v42, 16, v135
    v_and_b32 v43, 0xffff0000, v135
    v_add_f32 v40, v40, v42
    v_add_f32 v41, v41, v43
    v_cvt_pk_bf16_f32 v63, v40, v41
    s_mov_b32 s84, 98304
    buffer_store_dwordx4 v[60:63], v13, s[72:75], s84 offen
L_fin:
L_end:
    s_endpgm
L_code_end:
.section .rodata,"a"
.p2align 6
.amdhsa_kernel recurrent_scan__sliding_local_dilated__glu_gated_geglu__prompt_kernel
  .amdhsa_next_free_vgpr 256
  .amdhsa_next_free_sgpr 102
  .amdhsa_accum_offset 256
  .amdhsa_group_segment_fixed_size 0
  .amdhsa_kernarg_size 80
  .amdhsa_user_sgpr_count 2
  .amdhsa_user_sgpr_kernarg_segment_ptr 1
  .amdhsa_system_sgpr_workgroup_id_x 1
.end_amdhsa_kernel
```

```asm
; @launch grid=(256,1,1) block=(512,1,1) lds=163840
.amdgcn_target "amdgcn-amd-amdhsa--gfx950"
.text
.globl recurrent_scan__sliding_local_dilated__glu_gated_geglu__prompt_kernel
.p2align 8
.type recurrent_scan__sliding_local_dilated__glu_gated_geglu__prompt_kernel,@function
recurrent_scan__sliding_local_dilated__glu_gated_geglu__prompt_kernel:
    s_cmp_ge_u32 s2, 256
    s_cbranch_scc1 L_end
    s_load_dwordx4 s[8:11], s[0:1], 0
    s_load_dwordx2 s[12:13], s[0:1], 16
    s_load_dwordx4 s[16:19], s[0:1], 32
    s_load_dwordx4 s[20:23], s[0:1], 48
    s_load_dwordx4 s[24:27], s[0:1], 64
    v_lshrrev_b32 v3, 6, v0
    v_and_b32 v1, 63, v0
    v_readfirstlane_b32 s3, v3
    s_and_b32 s84, s2, 7
    s_lshr_b32 s85, s2, 3
    s_mov_b32 s15, s85
    s_and_b32 s32, s84, 1
    s_lshl_b32 s86, s32, 3
    s_and_b32 s87, s85, 7
    s_add_u32 s28, s86, s87
    s_lshr_b32 s86, s84, 1
    s_lshl_b32 s86, s86, 2
    s_lshr_b32 s87, s85, 3
    s_add_u32 s29, s86, s87
    s_and_b32 s87, s85, 3
    s_add_u32 s30, s86, s87
    s_lshr_b32 s31, s85, 2
    s_and_b32 s4, s3, 3
    s_lshr_b32 s5, s4, 1
    s_and_b32 s6, s4, 1
    s_lshr_b32 s7, s3, 2
    s_lshl_b32 s33, s4, 10
    s_waitcnt lgkmcnt(0)
    s_mov_b32 s68, s26
    s_mov_b32 s69, s27
    s_mov_b32 s70, 0x10000000
    s_mov_b32 s71, 0x20000
    s_cmp_lg_u32 s7, 0
    s_cbranch_scc1 L_teamB
    v_lshrrev_b32 v64, 4, v1
    v_bfe_u32 v65, v1, 2, 2
    v_and_b32 v66, 3, v1
    v_and_b32 v67, 15, v1
    v_lshrrev_b32 v68, 3, v1
    v_and_b32 v69, 7, v1
    s_lshl_b32 s85, s4, 3
    s_and_b32 s86, s4, 1
    s_lshl_b32 s86, s86, 2
    v_and_b32 v70, 2, v68
    v_xor_b32 v70, v70, v69
    v_xor_b32 v70, s86, v70
    v_add_u32 v71, s85, v68
    v_mul_u32_u24 v71, 7168, v71
    v_lshl_add_u32 v22, v70, 4, v71
    v_lshrrev_b32 v71, 2, v1
    s_lshl_b32 s86, s86, 2
    v_add_u32 v71, s86, v71
    v_mul_u32_u24 v71, 7168, v71
    v_and_b32 v70, 2, v64
    v_xor_b32 v70, v70, v66
    v_lshl_add_u32 v76, v70, 4, v71
    s_mul_i32 s85, s29, 320
    s_and_b32 s86, s29, 1
    s_lshl_b32 s87, s86, 6
    s_add_u32 s87, s87, s85
    s_add_u32 s40, s16, s87
    s_addc_u32 s41, s17, 0
    s_sub_u32 s42, 7340032, s87
    s_mov_b32 s43, 0x20000
    s_add_u32 s44, s18, s87
    s_addc_u32 s45, s19, 0
    s_sub_u32 s46, 7340032, s87
    s_mov_b32 s47, 0x20000
    s_xor_b32 s86, s86, 1
    s_lshl_b32 s86, s86, 8
    s_add_u32 s87, s86, s85
    s_cmp_lt_u32 s4, 2
    s_cselect_b32 s88, s16, s18
    s_cselect_b32 s89, s17, s19
    s_add_u32 s48, s88, s87
    s_addc_u32 s49, s89, 0
    s_sub_u32 s50, 7340032, s87
    s_mov_b32 s51, 0x20000
    s_and_b32 s77, s28, 3
    s_bitcmp1_b32 s28, 3
    s_cselect_b32 s91, 4, 0
    s_add_u32 s77, s77, s91
    s_mul_i32 s77, s77, 917504
    s_add_u32 s77, s77, 0xfffc8000
    s_add_u32 m0, s33, 16384
    s_add_u32 s77, s77, 229376
    buffer_load_dwordx4 v22, s[40:43], s77 offen offset:0 lds
    s_add_u32 m0, s33, 20352
    s_nop 0
    buffer_load_dwordx4 v22, s[40:43], s77 offen offset:128 lds
    s_add_u32 m0, s33, 24576
    s_nop 0
    buffer_load_dwordx4 v22, s[44:47], s77 offen offset:0 lds
    s_add_u32 m0, s33, 28544
    s_nop 0
    buffer_load_dwordx4 v22, s[44:47], s77 offen offset:128 lds
    s_add_u32 m0, s33, 32768
    s_nop 0
    buffer_load_dwordx4 v76, s[48:51], s77 offen lds
    s_add_u32 m0, s33, 36864
    s_add_u32 s77, s77, 229376
    buffer_load_dwordx4 v22, s[40:43], s77 offen offset:0 lds
    s_add_u32 m0, s33, 40832
    s_nop 0
    buffer_load_dwordx4 v22, s[40:43], s77 offen offset:128 lds
    s_add_u32 m0, s33, 45056
    s_nop 0
    buffer_load_dwordx4 v22, s[44:47], s77 offen offset:0 lds
    s_add_u32 m0, s33, 49024
    s_nop 0
    buffer_load_dwordx4 v22, s[44:47], s77 offen offset:128 lds
    s_add_u32 m0, s33, 53248
    s_nop 0
    buffer_load_dwordx4 v76, s[48:51], s77 offen lds
    s_getpc_b64 s[92:93]
L_pc:
    s_lshl2_add_u32 s91, s15, s4
    s_lshl_b32 s91, s91, 9
    s_min_u32 s91, s91, L_code_end - L_pc - 512
    s_load_dword s94, s[92:93], s91 offset:0
    s_load_dword s94, s[92:93], s91 offset:64
    s_load_dword s94, s[92:93], s91 offset:128
    s_load_dword s94, s[92:93], s91 offset:192
    s_load_dword s94, s[92:93], s91 offset:256
    s_load_dword s94, s[92:93], s91 offset:320
    s_load_dword s94, s[92:93], s91 offset:384
    s_load_dword s94, s[92:93], s91 offset:448
    v_lshrrev_b32 v64, 4, v1
    v_bfe_u32 v65, v1, 2, 2
    v_and_b32 v66, 3, v1
    v_and_b32 v67, 15, v1
    v_lshrrev_b32 v68, 3, v1
    v_and_b32 v69, 7, v1
    s_lshl_b32 s85, s6, 12
    s_add_u32 s85, s85, 16384
    v_lshl_add_u32 v70, v64, 3, v65
    v_lshlrev_b32 v70, 7, v70
    v_and_b32 v71, 1, v66
    v_lshl_add_u32 v70, v71, 3, v70
    v_add_u32 v70, s85, v70
    v_and_b32 v71, 2, v65
    v_and_b32 v72, 1, v64
    v_lshl_add_u32 v71, v72, 2, v71
    v_lshrrev_b32 v72, 1, v66
    v_xor_b32 v71, v71, v72
    v_xor_b32 v72, 0, v71
    v_lshl_add_u32 v4, v72, 4, v70
    v_add_u32 v9, 40960, v4
    v_xor_b32 v72, 2, v71
    v_lshl_add_u32 v5, v72, 4, v70
    v_add_u32 v10, 40960, v5
    v_xor_b32 v72, 4, v71
    v_lshl_add_u32 v6, v72, 4, v70
    v_add_u32 v11, 40960, v6
    v_xor_b32 v72, 6, v71
    v_lshl_add_u32 v7, v72, 4, v70
    v_add_u32 v12, 40960, v7
    v_lshl_add_u32 v70, v64, 3, v65
    v_lshlrev_b32 v70, 6, v70
    v_and_b32 v71, 1, v66
    v_lshl_add_u32 v70, v71, 3, v70
    v_and_b32 v71, 1, v64
    v_xor_b32 v71, s6, v71
    v_lshl_add_u32 v70, v71, 5, v70
    v_lshrrev_b32 v71, 1, v66
    v_lshl_add_u32 v70, v71, 4, v70
    v_add_u32 v8, 16384, v70
    v_add_u32 v13, 57344, v70
    v_lshrrev_b32 v70, 1, v67
    v_xor_b32 v70, v70, v64
    v_lshlrev_b32 v70, 4, v70
    v_lshl_add_u32 v70, v67, 7, v70
    s_lshl_b32 s85, s5, 13
    v_add_u32 v16, s85, v70
    v_xor_b32 v17, 64, v16
    s_mov_b32 s80, 116736
    s_lshl_b32 s85, s28, 7
    s_lshl_b32 s86, s4, 5
    s_add_u32 s86, s85, s86
    v_add_u32 v71, s86, v68
    v_xor_b32 v70, v69, v64
    v_lshlrev_b32 v70, 4, v70
    v_lshl_add_u32 v20, v71, 11, v70
    v_xor_b32 v21, 64, v20
    v_add_u32 v21, 16384, v21
    s_lshl_b32 s79, s4, 12
    s_lshl_b32 s86, s28, 7
    s_sub_u32 s86, s86, 16
    s_max_i32 s86, s86, 0
    s_lshl_b32 s87, s4, 2
    v_add_u32 v71, s87, v68
    v_lshrrev_b32 v70, 1, v71
    v_and_b32 v70, 7, v70
    v_xor_b32 v70, v70, v69
    v_lshlrev_b32 v70, 4, v70
    v_add_u32 v71, s86, v71
    v_lshl_add_u32 v3, v71, 11, v70
    s_lshl_b32 s81, s4, 9
    s_lshl_b32 s85, s4, 3
    s_and_b32 s86, s4, 1
    s_lshl_b32 s86, s86, 2
    v_and_b32 v70, 2, v68
    v_xor_b32 v70, v70, v69
    v_xor_b32 v70, s86, v70
    v_add_u32 v71, s85, v68
    v_mul_u32_u24 v71, 6144, v71
    v_lshl_add_u32 v23, v70, 4, v71
    s_lshl_b32 s85, s6, 2
    v_lshl_add_u32 v70, v64, 3, v65
    v_lshlrev_b32 v70, 7, v70
    v_and_b32 v71, 1, v66
    v_lshl_add_u32 v70, v71, 3, v70
    v_add_u32 v70, 0, v70
    v_and_b32 v71, 2, v65
    v_and_b32 v72, 1, v64
    v_lshl_add_u32 v71, v72, 2, v71
    v_lshrrev_b32 v72, 1, v66
    v_xor_b32 v71, v71, v72
    v_xor_b32 v71, s85, v71
    v_xor_b32 v72, 0, v71
    v_lshl_add_u32 v250, v72, 4, v70
    v_add_u32 v252, 65536, v250
    v_xor_b32 v72, 2, v71
    v_lshl_add_u32 v251, v72, 4, v70
    v_add_u32 v253, 65536, v251
    s_lshl_b32 s85, s5, 12
    v_lshl_add_u32 v248, v1, 4, s85
    v_add_u32 v249, 65536, v248
    s_lshl_b32 s85, s4, 12
    v_lshl_add_u32 v18, v1, 4, s85
    s_lshl_b32 s85, s4, 4
    v_and_b32 v70, 2, v68
    v_xor_b32 v70, v70, v69
    v_xor_b32 v70, 0, v70
    v_add_u32 v71, s85, v68
    v_mul_u32_u24 v71, 2048, v71
    v_lshl_add_u32 v254, v70, 4, v71
    s_add_u32 s85, s85, 8
    v_and_b32 v70, 2, v68
    v_xor_b32 v70, v70, v69
    v_xor_b32 v70, 4, v70
    v_add_u32 v71, s85, v68
    v_mul_u32_u24 v71, 2048, v71
    v_lshl_add_u32 v255, v70, 4, v71
    s_lshl_b32 s85, s31, 8
    s_lshl_b32 s86, s32, 7
    s_add_u32 s86, s85, s86
    s_xor_b32 s87, s86, 128
    s_add_u32 s60, s20, s86
    s_addc_u32 s61, s21, 0
    s_sub_u32 s62, 7340032, s86
    s_mov_b32 s63, 0x20000
    s_add_u32 s64, s20, s87
    s_addc_u32 s65, s21, 0
    s_sub_u32 s66, 7340032, s87
    s_mov_b32 s67, 0x20000
    s_add_u32 s56, s26, 0x400000
    s_addc_u32 s57, s27, 0
    s_mov_b32 s58, 0xe00000
    s_mov_b32 s59, 0x20000
    s_mul_i32 s82, s30, 917504
    s_mul_i32 s85, s32, 327680
    s_add_u32 s82, s82, s85
    s_mul_i32 s83, s32, 2621440
    s_mul_i32 s85, s32, 24
    s_sub_u32 s85, 40, s85
    s_lshl_b32 s14, s85, 13
    s_lshl_b32 s35, s85, 16
    v_lshrrev_b32 v78, 4, v1
    v_and_b32 v79, 1, v78
    v_lshrrev_b32 v78, 1, v78
    v_lshlrev_b32 v78, 8, v78
    v_lshl_add_u32 v78, v79, 10, v78
    v_and_b32 v79, 15, v1
    v_lshl_add_u32 v19, v79, 4, v78
    s_mul_i32 s84, s28, 112
    s_mul_i32 s85, s29, 5
    s_add_u32 s84, s84, s85
    s_lshl_b32 s84, s84, 13
    s_lshl_b32 s85, s5, 12
    s_add_u32 s84, s84, s85
    s_add_u32 s84, s84, 0x400000
    s_and_b32 s85, s29, 1
    s_lshl1_add_u32 s86, s6, s85
    s_lshl_b32 s86, s86, 13
    s_add_u32 s72, s84, s86
    s_add_u32 s73, s72, 8192
    s_xor_b32 s85, s85, 1
    s_lshl_b32 s85, s85, 15
    s_add_u32 s84, s84, s85
    s_lshl_b32 s85, s6, 9
    s_add_u32 s74, s84, s85
    s_lshl2_add_u32 s91, s2, s4
    s_lshl_b32 s75, s91, 9
    s_lshr_b32 s92, s91, 2
    s_mul_i32 s92, s92, 7168
    s_and_b32 s91, s91, 3
    s_lshl_b32 s91, s91, 9
    s_add_u32 s92, s92, s91
    s_add_u32 s99, s92, 5120
    s_mov_b32 s36, s26
    s_mov_b32 s37, s27
    s_mov_b32 s38, 0x400000
    s_mov_b32 s39, 0x20000
    s_lshl_b32 s85, s29, 7
    s_add_u32 s40, s10, s85
    s_addc_u32 s41, s11, 0
    s_sub_u32 s42, 6291456, s85
    s_mov_b32 s43, 0x20000
    s_add_u32 s86, s85, 4096
    s_add_u32 s44, s10, s86
    s_addc_u32 s45, s11, 0
    s_sub_u32 s46, 6291456, s86
    s_mov_b32 s47, 0x20000
    s_add_u32 s86, s85, 5120
    s_add_u32 s48, s16, s86
    s_addc_u32 s49, s17, 0
    s_sub_u32 s50, 7340032, s86
    s_mov_b32 s51, 0x20000
    s_add_u32 s52, s18, s86
    s_addc_u32 s53, s19, 0
    s_sub_u32 s54, 7340032, s86
    s_mov_b32 s55, 0x20000
    s_setprio 1
    s_waitcnt vmcnt(5)
    s_barrier
    v_add_u32 v14, s80, v16
    v_add_u32 v15, s80, v17
    s_add_u32 s80, s80, 18432
    s_cmp_ge_u32 s80, 153600
    s_cselect_b32 s84, 55296, 0
    s_sub_u32 s80, s80, s84
    ds_read_b64_tr_b16 v[64:65], v4 offset:0
    ds_read_b64_tr_b16 v[66:67], v4 offset:512
    ds_read_b128 v[24:27], v14 offset:0
    ds_read_b128 v[28:31], v14 offset:2048
    ds_read_b128 v[32:35], v14 offset:4096
    ds_read_b128 v[36:39], v14 offset:6144
    ds_read_b64_tr_b16 v[68:69], v4 offset:8192
    ds_read_b64_tr_b16 v[70:71], v4 offset:8704
    ds_read_b64_tr_b16 v[72:73], v5 offset:0
    ds_read_b64_tr_b16 v[74:75], v5 offset:512
    s_waitcnt lgkmcnt(7)
    v_mfma_f32_16x16x32_bf16 v[88:91], v[64:67], v[24:27], 0
    ds_read_b64_tr_b16 v[76:77], v5 offset:8192
    s_waitcnt lgkmcnt(7)
    v_mfma_f32_16x16x32_bf16 v[92:95], v[64:67], v[28:31], 0
    ds_read_b64_tr_b16 v[78:79], v5 offset:8704
    s_waitcnt lgkmcnt(7)
    v_mfma_f32_16x16x32_bf16 v[96:99], v[64:67], v[32:35], 0
    ds_read_b64_tr_b16 v[80:81], v6 offset:0
    s_waitcnt lgkmcnt(7)
    v_mfma_f32_16x16x32_bf16 v[100:103], v[64:67], v[36:39], 0
    ds_read_b64_tr_b16 v[82:83], v6 offset:512
    s_waitcnt lgkmcnt(6)
    v_mfma_f32_16x16x32_bf16 v[104:107], v[68:71], v[24:27], 0
    ds_read_b64_tr_b16 v[64:65], v6 offset:8192
    v_mfma_f32_16x16x32_bf16 v[108:111], v[68:71], v[28:31], 0
    v_mfma_f32_16x16x32_bf16 v[112:115], v[68:71], v[32:35], 0
    ds_read_b64_tr_b16 v[66:67], v6 offset:8704
    v_mfma_f32_16x16x32_bf16 v[116:119], v[68:71], v[36:39], 0
    s_waitcnt lgkmcnt(6)
    v_mfma_f32_16x16x32_bf16 v[120:123], v[72:75], v[24:27], 0
    ds_read_b64_tr_b16 v[68:69], v7 offset:0
    v_mfma_f32_16x16x32_bf16 v[124:127], v[72:75], v[28:31], 0
    v_mfma_f32_16x16x32_bf16 v[128:131], v[72:75], v[32:35], 0
    ds_read_b64_tr_b16 v[70:71], v7 offset:512
    v_mfma_f32_16x16x32_bf16 v[132:135], v[72:75], v[36:39], 0
    s_waitcnt lgkmcnt(6)
    v_mfma_f32_16x16x32_bf16 v[136:139], v[76:79], v[24:27], 0
    ds_read_b64_tr_b16 v[72:73], v7 offset:8192
    v_mfma_f32_16x16x32_bf16 v[140:143], v[76:79], v[28:31], 0
    v_mfma_f32_16x16x32_bf16 v[144:147], v[76:79], v[32:35], 0
    ds_read_b64_tr_b16 v[74:75], v7 offset:8704
    v_mfma_f32_16x16x32_bf16 v[148:151], v[76:79], v[36:39], 0
    s_waitcnt lgkmcnt(6)
    v_mfma_f32_16x16x32_bf16 v[152:155], v[80:83], v[24:27], 0
    ds_read_b64_tr_b16 v[76:77], v8 offset:16384
    v_mfma_f32_16x16x32_bf16 v[156:159], v[80:83], v[28:31], 0
    v_mfma_f32_16x16x32_bf16 v[160:163], v[80:83], v[32:35], 0
    ds_read_b64_tr_b16 v[78:79], v8 offset:16640
    v_mfma_f32_16x16x32_bf16 v[164:167], v[80:83], v[36:39], 0
    s_waitcnt lgkmcnt(6)
    v_mfma_f32_16x16x32_bf16 v[168:171], v[64:67], v[24:27], 0
    ds_read_b64_tr_b16 v[80:81], v8 offset:18432
    v_mfma_f32_16x16x32_bf16 v[172:175], v[64:67], v[28:31], 0
    v_mfma_f32_16x16x32_bf16 v[176:179], v[64:67], v[32:35], 0
    ds_read_b64_tr_b16 v[82:83], v8 offset:18688
    v_mfma_f32_16x16x32_bf16 v[180:183], v[64:67], v[36:39], 0
    s_waitcnt lgkmcnt(6)
    v_mfma_f32_16x16x32_bf16 v[184:187], v[68:71], v[24:27], 0
    v_mfma_f32_16x16x32_bf16 v[188:191], v[68:71], v[28:31], 0
    v_mfma_f32_16x16x32_bf16 v[192:195], v[68:71], v[32:35], 0
    v_mfma_f32_16x16x32_bf16 v[196:199], v[68:71], v[36:39], 0
    s_waitcnt vmcnt(0) lgkmcnt(0)
    s_barrier
    v_mfma_f32_16x16x32_bf16 v[200:203], v[72:75], v[24:27], 0
    ds_read_b64_tr_b16 v[64:65], v4 offset:20480
    v_mfma_f32_16x16x32_bf16 v[204:207], v[72:75], v[28:31], 0
    ds_read_b64_tr_b16 v[66:67], v4 offset:20992
    v_mfma_f32_16x16x32_bf16 v[208:211], v[72:75], v[32:35], 0
    ds_read_b128 v[40:43], v15 offset:0
    v_mfma_f32_16x16x32_bf16 v[212:215], v[72:75], v[36:39], 0
    ds_read_b128 v[44:47], v15 offset:2048
    v_mfma_f32_16x16x32_bf16 v[216:219], v[76:79], v[24:27], 0
    ds_read_b128 v[48:51], v15 offset:4096
    v_mfma_f32_16x16x32_bf16 v[220:223], v[76:79], v[28:31], 0
    ds_read_b128 v[52:55], v15 offset:6144
    v_mfma_f32_16x16x32_bf16 v[224:227], v[76:79], v[32:35], 0
    ds_read_b64_tr_b16 v[68:69], v4 offset:28672
    v_mfma_f32_16x16x32_bf16 v[228:231], v[76:79], v[36:39], 0
    ds_read_b64_tr_b16 v[70:71], v4 offset:29184
    v_mfma_f32_16x16x32_bf16 v[232:235], v[80:83], v[24:27], 0
    ds_read_b64_tr_b16 v[72:73], v5 offset:20480
    v_mfma_f32_16x16x32_bf16 v[236:239], v[80:83], v[28:31], 0
    v_mfma_f32_16x16x32_bf16 v[240:243], v[80:83], v[32:35], 0
    ds_read_b64_tr_b16 v[74:75], v5 offset:20992
    v_mfma_f32_16x16x32_bf16 v[244:247], v[80:83], v[36:39], 0
    s_waitcnt lgkmcnt(7)
    v_mfma_f32_16x16x32_bf16 v[88:91], v[64:67], v[40:43], v[88:91]
    ds_read_b64_tr_b16 v[76:77], v5 offset:28672
    s_waitcnt lgkmcnt(7)
    v_mfma_f32_16x16x32_bf16 v[92:95], v[64:67], v[44:47], v[92:95]
    ds_read_b64_tr_b16 v[78:79], v5 offset:29184
    s_waitcnt lgkmcnt(7)
    v_mfma_f32_16x16x32_bf16 v[96:99], v[64:67], v[48:51], v[96:99]
    ds_read_b64_tr_b16 v[80:81], v6 offset:20480
    s_waitcnt lgkmcnt(7)
    v_mfma_f32_16x16x32_bf16 v[100:103], v[64:67], v[52:55], v[100:103]
    ds_read_b64_tr_b16 v[82:83], v6 offset:20992
    s_waitcnt lgkmcnt(6)
    v_mfma_f32_16x16x32_bf16 v[104:107], v[68:71], v[40:43], v[104:107]
    ds_read_b64_tr_b16 v[64:65], v6 offset:28672
    v_mfma_f32_16x16x32_bf16 v[108:111], v[68:71], v[44:47], v[108:111]
    v_add_u32 v14, s80, v16
    v_mfma_f32_16x16x32_bf16 v[112:115], v[68:71], v[48:51], v[112:115]
    ds_read_b64_tr_b16 v[66:67], v6 offset:29184
    v_mfma_f32_16x16x32_bf16 v[116:119], v[68:71], v[52:55], v[116:119]
    v_add_u32 v15, s80, v17
    s_waitcnt lgkmcnt(6)
    v_mfma_f32_16x16x32_bf16 v[120:123], v[72:75], v[40:43], v[120:123]
    ds_read_b64_tr_b16 v[68:69], v7 offset:20480
    v_mfma_f32_16x16x32_bf16 v[124:127], v[72:75], v[44:47], v[124:127]
    s_add_u32 s80, s80, 18432
    v_mfma_f32_16x16x32_bf16 v[128:131], v[72:75], v[48:51], v[128:131]
    ds_read_b64_tr_b16 v[70:71], v7 offset:20992
    v_mfma_f32_16x16x32_bf16 v[132:135], v[72:75], v[52:55], v[132:135]
    s_cmp_ge_u32 s80, 153600
    s_cselect_b32 s84, 55296, 0
    s_waitcnt lgkmcnt(6)
    v_mfma_f32_16x16x32_bf16 v[136:139], v[76:79], v[40:43], v[136:139]
    ds_read_b64_tr_b16 v[72:73], v7 offset:28672
    v_mfma_f32_16x16x32_bf16 v[140:143], v[76:79], v[44:47], v[140:143]
    s_sub_u32 s80, s80, s84
    v_mfma_f32_16x16x32_bf16 v[144:147], v[76:79], v[48:51], v[144:147]
    ds_read_b64_tr_b16 v[74:75], v7 offset:29184
    v_mfma_f32_16x16x32_bf16 v[148:151], v[76:79], v[52:55], v[148:151]
    s_waitcnt lgkmcnt(6)
    v_mfma_f32_16x16x32_bf16 v[152:155], v[80:83], v[40:43], v[152:155]
    ds_read_b64_tr_b16 v[76:77], v8 offset:36864
    v_mfma_f32_16x16x32_bf16 v[156:159], v[80:83], v[44:47], v[156:159]
    v_mfma_f32_16x16x32_bf16 v[160:163], v[80:83], v[48:51], v[160:163]
    ds_read_b64_tr_b16 v[78:79], v8 offset:37120
    v_mfma_f32_16x16x32_bf16 v[164:167], v[80:83], v[52:55], v[164:167]
    s_waitcnt lgkmcnt(6)
    v_mfma_f32_16x16x32_bf16 v[168:171], v[64:67], v[40:43], v[168:171]
    ds_read_b64_tr_b16 v[80:81], v8 offset:38912
    v_mfma_f32_16x16x32_bf16 v[172:175], v[64:67], v[44:47], v[172:175]
    v_mfma_f32_16x16x32_bf16 v[176:179], v[64:67], v[48:51], v[176:179]
    ds_read_b64_tr_b16 v[82:83], v8 offset:39168
    v_mfma_f32_16x16x32_bf16 v[180:183], v[64:67], v[52:55], v[180:183]
    s_waitcnt lgkmcnt(6)
    v_mfma_f32_16x16x32_bf16 v[184:187], v[68:71], v[40:43], v[184:187]
    v_mfma_f32_16x16x32_bf16 v[188:191], v[68:71], v[44:47], v[188:191]
    v_mfma_f32_16x16x32_bf16 v[192:195], v[68:71], v[48:51], v[192:195]
    v_mfma_f32_16x16x32_bf16 v[196:199], v[68:71], v[52:55], v[196:199]
    s_waitcnt lgkmcnt(0)
    s_barrier
    v_mfma_f32_16x16x32_bf16 v[200:203], v[72:75], v[40:43], v[200:203]
    ds_read_b64_tr_b16 v[64:65], v9 offset:0
    v_mfma_f32_16x16x32_bf16 v[204:207], v[72:75], v[44:47], v[204:207]
    ds_read_b64_tr_b16 v[66:67], v9 offset:512
    v_mfma_f32_16x16x32_bf16 v[208:211], v[72:75], v[48:51], v[208:211]
    ds_read_b128 v[24:27], v14 offset:0
    v_mfma_f32_16x16x32_bf16 v[212:215], v[72:75], v[52:55], v[212:215]
    ds_read_b128 v[28:31], v14 offset:2048
    v_mfma_f32_16x16x32_bf16 v[216:219], v[76:79], v[40:43], v[216:219]
    ds_read_b128 v[32:35], v14 offset:4096
    v_mfma_f32_16x16x32_bf16 v[220:223], v[76:79], v[44:47], v[220:223]
    ds_read_b128 v[36:39], v14 offset:6144
    v_mfma_f32_16x16x32_bf16 v[224:227], v[76:79], v[48:51], v[224:227]
    ds_read_b64_tr_b16 v[68:69], v9 offset:8192
    v_mfma_f32_16x16x32_bf16 v[228:231], v[76:79], v[52:55], v[228:231]
    ds_read_b64_tr_b16 v[70:71], v9 offset:8704
    v_mfma_f32_16x16x32_bf16 v[232:235], v[80:83], v[40:43], v[232:235]
    ds_read_b64_tr_b16 v[72:73], v10 offset:0
    v_mfma_f32_16x16x32_bf16 v[236:239], v[80:83], v[44:47], v[236:239]
    v_mfma_f32_16x16x32_bf16 v[240:243], v[80:83], v[48:51], v[240:243]
    ds_read_b64_tr_b16 v[74:75], v10 offset:512
    v_mfma_f32_16x16x32_bf16 v[244:247], v[80:83], v[52:55], v[244:247]
    s_waitcnt lgkmcnt(7)
    v_mfma_f32_16x16x32_bf16 v[88:91], v[64:67], v[24:27], v[88:91]
    ds_read_b64_tr_b16 v[76:77], v10 offset:8192
    s_waitcnt lgkmcnt(7)
    v_mfma_f32_16x16x32_bf16 v[92:95], v[64:67], v[28:31], v[92:95]
    ds_read_b64_tr_b16 v[78:79], v10 offset:8704
    s_waitcnt lgkmcnt(7)
    v_mfma_f32_16x16x32_bf16 v[96:99], v[64:67], v[32:35], v[96:99]
    ds_read_b64_tr_b16 v[80:81], v11 offset:0
    s_waitcnt lgkmcnt(7)
    v_mfma_f32_16x16x32_bf16 v[100:103], v[64:67], v[36:39], v[100:103]
    ds_read_b64_tr_b16 v[82:83], v11 offset:512
    s_waitcnt lgkmcnt(6)
    v_mfma_f32_16x16x32_bf16 v[104:107], v[68:71], v[24:27], v[104:107]
    ds_read_b64_tr_b16 v[64:65], v11 offset:8192
    v_mfma_f32_16x16x32_bf16 v[108:111], v[68:71], v[28:31], v[108:111]
    v_mfma_f32_16x16x32_bf16 v[112:115], v[68:71], v[32:35], v[112:115]
    ds_read_b64_tr_b16 v[66:67], v11 offset:8704
    v_mfma_f32_16x16x32_bf16 v[116:119], v[68:71], v[36:39], v[116:119]
    s_waitcnt lgkmcnt(6)
    v_mfma_f32_16x16x32_bf16 v[120:123], v[72:75], v[24:27], v[120:123]
    ds_read_b64_tr_b16 v[68:69], v12 offset:0
    v_mfma_f32_16x16x32_bf16 v[124:127], v[72:75], v[28:31], v[124:127]
    v_mfma_f32_16x16x32_bf16 v[128:131], v[72:75], v[32:35], v[128:131]
    ds_read_b64_tr_b16 v[70:71], v12 offset:512
    v_mfma_f32_16x16x32_bf16 v[132:135], v[72:75], v[36:39], v[132:135]
    s_waitcnt lgkmcnt(6)
    v_mfma_f32_16x16x32_bf16 v[136:139], v[76:79], v[24:27], v[136:139]
    ds_read_b64_tr_b16 v[72:73], v12 offset:8192
    v_mfma_f32_16x16x32_bf16 v[140:143], v[76:79], v[28:31], v[140:143]
    v_mfma_f32_16x16x32_bf16 v[144:147], v[76:79], v[32:35], v[144:147]
    ds_read_b64_tr_b16 v[74:75], v12 offset:8704
    v_mfma_f32_16x16x32_bf16 v[148:151], v[76:79], v[36:39], v[148:151]
    s_waitcnt lgkmcnt(6)
    v_mfma_f32_16x16x32_bf16 v[152:155], v[80:83], v[24:27], v[152:155]
    ds_read_b64_tr_b16 v[76:77], v13 offset:16384
    v_mfma_f32_16x16x32_bf16 v[156:159], v[80:83], v[28:31], v[156:159]
    v_mfma_f32_16x16x32_bf16 v[160:163], v[80:83], v[32:35], v[160:163]
    ds_read_b64_tr_b16 v[78:79], v13 offset:16640
    v_mfma_f32_16x16x32_bf16 v[164:167], v[80:83], v[36:39], v[164:167]
    s_waitcnt lgkmcnt(6)
    v_mfma_f32_16x16x32_bf16 v[168:171], v[64:67], v[24:27], v[168:171]
    ds_read_b64_tr_b16 v[80:81], v13 offset:18432
    v_mfma_f32_16x16x32_bf16 v[172:175], v[64:67], v[28:31], v[172:175]
    v_mfma_f32_16x16x32_bf16 v[176:179], v[64:67], v[32:35], v[176:179]
    ds_read_b64_tr_b16 v[82:83], v13 offset:18688
    v_mfma_f32_16x16x32_bf16 v[180:183], v[64:67], v[36:39], v[180:183]
    s_waitcnt lgkmcnt(6)
    v_mfma_f32_16x16x32_bf16 v[184:187], v[68:71], v[24:27], v[184:187]
    v_mfma_f32_16x16x32_bf16 v[188:191], v[68:71], v[28:31], v[188:191]
    v_mfma_f32_16x16x32_bf16 v[192:195], v[68:71], v[32:35], v[192:195]
    v_mfma_f32_16x16x32_bf16 v[196:199], v[68:71], v[36:39], v[196:199]
    s_waitcnt lgkmcnt(0)
    s_barrier
    v_mfma_f32_16x16x32_bf16 v[200:203], v[72:75], v[24:27], v[200:203]
    ds_read_b64_tr_b16 v[64:65], v9 offset:20480
    v_mfma_f32_16x16x32_bf16 v[204:207], v[72:75], v[28:31], v[204:207]
    ds_read_b64_tr_b16 v[66:67], v9 offset:20992
    v_mfma_f32_16x16x32_bf16 v[208:211], v[72:75], v[32:35], v[208:211]
    ds_read_b128 v[40:43], v15 offset:0
    v_mfma_f32_16x16x32_bf16 v[212:215], v[72:75], v[36:39], v[212:215]
    ds_read_b128 v[44:47], v15 offset:2048
    v_mfma_f32_16x16x32_bf16 v[216:219], v[76:79], v[24:27], v[216:219]
    ds_read_b128 v[48:51], v15 offset:4096
    v_mfma_f32_16x16x32_bf16 v[220:223], v[76:79], v[28:31], v[220:223]
    ds_read_b128 v[52:55], v15 offset:6144
    v_mfma_f32_16x16x32_bf16 v[224:227], v[76:79], v[32:35], v[224:227]
    ds_read_b64_tr_b16 v[68:69], v9 offset:28672
    v_mfma_f32_16x16x32_bf16 v[228:231], v[76:79], v[36:39], v[228:231]
    ds_read_b64_tr_b16 v[70:71], v9 offset:29184
    v_mfma_f32_16x16x32_bf16 v[232:235], v[80:83], v[24:27], v[232:235]
    ds_read_b64_tr_b16 v[72:73], v10 offset:20480
    v_mfma_f32_16x16x32_bf16 v[236:239], v[80:83], v[28:31], v[236:239]
    v_mfma_f32_16x16x32_bf16 v[240:243], v[80:83], v[32:35], v[240:243]
    ds_read_b64_tr_b16 v[74:75], v10 offset:20992
    v_mfma_f32_16x16x32_bf16 v[244:247], v[80:83], v[36:39], v[244:247]
    s_waitcnt lgkmcnt(7)
    v_mfma_f32_16x16x32_bf16 v[88:91], v[64:67], v[40:43], v[88:91]
    ds_read_b64_tr_b16 v[76:77], v10 offset:28672
    s_waitcnt lgkmcnt(7)
    v_mfma_f32_16x16x32_bf16 v[92:95], v[64:67], v[44:47], v[92:95]
    ds_read_b64_tr_b16 v[78:79], v10 offset:29184
    s_waitcnt lgkmcnt(7)
    v_mfma_f32_16x16x32_bf16 v[96:99], v[64:67], v[48:51], v[96:99]
    ds_read_b64_tr_b16 v[80:81], v11 offset:20480
    s_waitcnt lgkmcnt(7)
    v_mfma_f32_16x16x32_bf16 v[100:103], v[64:67], v[52:55], v[100:103]
    ds_read_b64_tr_b16 v[82:83], v11 offset:20992
    s_waitcnt lgkmcnt(6)
    v_mfma_f32_16x16x32_bf16 v[104:107], v[68:71], v[40:43], v[104:107]
    ds_read_b64_tr_b16 v[64:65], v11 offset:28672
    v_mfma_f32_16x16x32_bf16 v[108:111], v[68:71], v[44:47], v[108:111]
    v_add_u32 v14, s80, v16
    v_mfma_f32_16x16x32_bf16 v[112:115], v[68:71], v[48:51], v[112:115]
    ds_read_b64_tr_b16 v[66:67], v11 offset:29184
    v_mfma_f32_16x16x32_bf16 v[116:119], v[68:71], v[52:55], v[116:119]
    v_add_u32 v15, s80, v17
    s_waitcnt lgkmcnt(6)
    v_mfma_f32_16x16x32_bf16 v[120:123], v[72:75], v[40:43], v[120:123]
    ds_read_b64_tr_b16 v[68:69], v12 offset:20480
    v_mfma_f32_16x16x32_bf16 v[124:127], v[72:75], v[44:47], v[124:127]
    s_add_u32 s80, s80, 18432
    v_mfma_f32_16x16x32_bf16 v[128:131], v[72:75], v[48:51], v[128:131]
    ds_read_b64_tr_b16 v[70:71], v12 offset:20992
    v_mfma_f32_16x16x32_bf16 v[132:135], v[72:75], v[52:55], v[132:135]
    s_cmp_ge_u32 s80, 153600
    s_cselect_b32 s84, 55296, 0
    s_waitcnt lgkmcnt(6)
    v_mfma_f32_16x16x32_bf16 v[136:139], v[76:79], v[40:43], v[136:139]
    ds_read_b64_tr_b16 v[72:73], v12 offset:28672
    v_mfma_f32_16x16x32_bf16 v[140:143], v[76:79], v[44:47], v[140:143]
    s_sub_u32 s80, s80, s84
    v_mfma_f32_16x16x32_bf16 v[144:147], v[76:79], v[48:51], v[144:147]
    ds_read_b64_tr_b16 v[74:75], v12 offset:29184
    v_mfma_f32_16x16x32_bf16 v[148:151], v[76:79], v[52:55], v[148:151]
    s_waitcnt lgkmcnt(6)
    v_mfma_f32_16x16x32_bf16 v[152:155], v[80:83], v[40:43], v[152:155]
    ds_read_b64_tr_b16 v[76:77], v13 offset:36864
    v_mfma_f32_16x16x32_bf16 v[156:159], v[80:83], v[44:47], v[156:159]
    v_mfma_f32_16x16x32_bf16 v[160:163], v[80:83], v[48:51], v[160:163]
    ds_read_b64_tr_b16 v[78:79], v13 offset:37120
    v_mfma_f32_16x16x32_bf16 v[164:167], v[80:83], v[52:55], v[164:167]
    s_waitcnt lgkmcnt(6)
    v_mfma_f32_16x16x32_bf16 v[168:171], v[64:67], v[40:43], v[168:171]
    ds_read_b64_tr_b16 v[80:81], v13 offset:38912
    v_mfma_f32_16x16x32_bf16 v[172:175], v[64:67], v[44:47], v[172:175]
    v_mfma_f32_16x16x32_bf16 v[176:179], v[64:67], v[48:51], v[176:179]
    ds_read_b64_tr_b16 v[82:83], v13 offset:39168
    v_mfma_f32_16x16x32_bf16 v[180:183], v[64:67], v[52:55], v[180:183]
    s_waitcnt lgkmcnt(6)
    v_mfma_f32_16x16x32_bf16 v[184:187], v[68:71], v[40:43], v[184:187]
    v_mfma_f32_16x16x32_bf16 v[188:191], v[68:71], v[44:47], v[188:191]
    v_mfma_f32_16x16x32_bf16 v[192:195], v[68:71], v[48:51], v[192:195]
    v_mfma_f32_16x16x32_bf16 v[196:199], v[68:71], v[52:55], v[196:199]
    s_waitcnt lgkmcnt(0)
    s_barrier
    v_mfma_f32_16x16x32_bf16 v[200:203], v[72:75], v[40:43], v[200:203]
    ds_read_b64_tr_b16 v[64:65], v4 offset:0
    v_mfma_f32_16x16x32_bf16 v[204:207], v[72:75], v[44:47], v[204:207]
    ds_read_b64_tr_b16 v[66:67], v4 offset:512
    v_mfma_f32_16x16x32_bf16 v[208:211], v[72:75], v[48:51], v[208:211]
    ds_read_b128 v[24:27], v14 offset:0
    v_mfma_f32_16x16x32_bf16 v[212:215], v[72:75], v[52:55], v[212:215]
    ds_read_b128 v[28:31], v14 offset:2048
    v_mfma_f32_16x16x32_bf16 v[216:219], v[76:79], v[40:43], v[216:219]
    ds_read_b128 v[32:35], v14 offset:4096
    v_mfma_f32_16x16x32_bf16 v[220:223], v[76:79], v[44:47], v[220:223]
    ds_read_b128 v[36:39], v14 offset:6144
    v_mfma_f32_16x16x32_bf16 v[224:227], v[76:79], v[48:51], v[224:227]
    ds_read_b64_tr_b16 v[68:69], v4 offset:8192
    v_mfma_f32_16x16x32_bf16 v[228:231], v[76:79], v[52:55], v[228:231]
    ds_read_b64_tr_b16 v[70:71], v4 offset:8704
    v_mfma_f32_16x16x32_bf16 v[232:235], v[80:83], v[40:43], v[232:235]
    ds_read_b64_tr_b16 v[72:73], v5 offset:0
    v_mfma_f32_16x16x32_bf16 v[236:239], v[80:83], v[44:47], v[236:239]
    v_mfma_f32_16x16x32_bf16 v[240:243], v[80:83], v[48:51], v[240:243]
    ds_read_b64_tr_b16 v[74:75], v5 offset:512
    v_mfma_f32_16x16x32_bf16 v[244:247], v[80:83], v[52:55], v[244:247]
    s_or_b32 s91, s2, s4
    s_cbranch_scc1 L_notok
    s_memrealtime s[92:93]
    v_mov_b32 v60, 0
    s_waitcnt lgkmcnt(0)
    s_or_b32 s92, s92, 1
    v_mov_b32 v62, s92
    v_mov_b32 v63, s93
    s_mov_b64 exec, 1
    global_store_dwordx2 v60, v[62:63], s[24:25] sc1
    s_mov_b64 exec, -1
L_notok:
    s_mov_b32 s34, 6
.p2align 6
L_p1:
    s_waitcnt lgkmcnt(7)
    v_mfma_f32_16x16x32_bf16 v[88:91], v[64:67], v[24:27], v[88:91]
    ds_read_b64_tr_b16 v[76:77], v5 offset:8192
    s_waitcnt lgkmcnt(7)
    v_mfma_f32_16x16x32_bf16 v[92:95], v[64:67], v[28:31], v[92:95]
    ds_read_b64_tr_b16 v[78:79], v5 offset:8704
    s_waitcnt lgkmcnt(7)
    v_mfma_f32_16x16x32_bf16 v[96:99], v[64:67], v[32:35], v[96:99]
    ds_read_b64_tr_b16 v[80:81], v6 offset:0
    s_waitcnt lgkmcnt(7)
    v_mfma_f32_16x16x32_bf16 v[100:103], v[64:67], v[36:39], v[100:103]
    ds_read_b64_tr_b16 v[82:83], v6 offset:512
    s_waitcnt lgkmcnt(6)
    v_mfma_f32_16x16x32_bf16 v[104:107], v[68:71], v[24:27], v[104:107]
    ds_read_b64_tr_b16 v[64:65], v6 offset:8192
    v_mfma_f32_16x16x32_bf16 v[108:111], v[68:71], v[28:31], v[108:111]
    v_mfma_f32_16x16x32_bf16 v[112:115], v[68:71], v[32:35], v[112:115]
    ds_read_b64_tr_b16 v[66:67], v6 offset:8704
    v_mfma_f32_16x16x32_bf16 v[116:119], v[68:71], v[36:39], v[116:119]
    s_waitcnt lgkmcnt(6)
    v_mfma_f32_16x16x32_bf16 v[120:123], v[72:75], v[24:27], v[120:123]
    ds_read_b64_tr_b16 v[68:69], v7 offset:0
    v_mfma_f32_16x16x32_bf16 v[124:127], v[72:75], v[28:31], v[124:127]
    v_mfma_f32_16x16x32_bf16 v[128:131], v[72:75], v[32:35], v[128:131]
    ds_read_b64_tr_b16 v[70:71], v7 offset:512
    v_mfma_f32_16x16x32_bf16 v[132:135], v[72:75], v[36:39], v[132:135]
    s_waitcnt lgkmcnt(6)
    v_mfma_f32_16x16x32_bf16 v[136:139], v[76:79], v[24:27], v[136:139]
    ds_read_b64_tr_b16 v[72:73], v7 offset:8192
    v_mfma_f32_16x16x32_bf16 v[140:143], v[76:79], v[28:31], v[140:143]
    v_mfma_f32_16x16x32_bf16 v[144:147], v[76:79], v[32:35], v[144:147]
    ds_read_b64_tr_b16 v[74:75], v7 offset:8704
    v_mfma_f32_16x16x32_bf16 v[148:151], v[76:79], v[36:39], v[148:151]
    s_waitcnt lgkmcnt(6)
    v_mfma_f32_16x16x32_bf16 v[152:155], v[80:83], v[24:27], v[152:155]
    ds_read_b64_tr_b16 v[76:77], v8 offset:16384
    v_mfma_f32_16x16x32_bf16 v[156:159], v[80:83], v[28:31], v[156:159]
    v_mfma_f32_16x16x32_bf16 v[160:163], v[80:83], v[32:35], v[160:163]
    ds_read_b64_tr_b16 v[78:79], v8 offset:16640
    v_mfma_f32_16x16x32_bf16 v[164:167], v[80:83], v[36:39], v[164:167]
    s_waitcnt lgkmcnt(6)
    v_mfma_f32_16x16x32_bf16 v[168:171], v[64:67], v[24:27], v[168:171]
    ds_read_b64_tr_b16 v[80:81], v8 offset:18432
    v_mfma_f32_16x16x32_bf16 v[172:175], v[64:67], v[28:31], v[172:175]
    v_mfma_f32_16x16x32_bf16 v[176:179], v[64:67], v[32:35], v[176:179]
    ds_read_b64_tr_b16 v[82:83], v8 offset:18688
    v_mfma_f32_16x16x32_bf16 v[180:183], v[64:67], v[36:39], v[180:183]
    s_waitcnt lgkmcnt(6)
    v_mfma_f32_16x16x32_bf16 v[184:187], v[68:71], v[24:27], v[184:187]
    v_mfma_f32_16x16x32_bf16 v[188:191], v[68:71], v[28:31], v[188:191]
    v_mfma_f32_16x16x32_bf16 v[192:195], v[68:71], v[32:35], v[192:195]
    v_mfma_f32_16x16x32_bf16 v[196:199], v[68:71], v[36:39], v[196:199]
    s_waitcnt lgkmcnt(0)
    s_barrier
    v_mfma_f32_16x16x32_bf16 v[200:203], v[72:75], v[24:27], v[200:203]
    ds_read_b64_tr_b16 v[64:65], v4 offset:20480
    v_mfma_f32_16x16x32_bf16 v[204:207], v[72:75], v[28:31], v[204:207]
    ds_read_b64_tr_b16 v[66:67], v4 offset:20992
    v_mfma_f32_16x16x32_bf16 v[208:211], v[72:75], v[32:35], v[208:211]
    ds_read_b128 v[40:43], v15 offset:0
    v_mfma_f32_16x16x32_bf16 v[212:215], v[72:75], v[36:39], v[212:215]
    ds_read_b128 v[44:47], v15 offset:2048
    v_mfma_f32_16x16x32_bf16 v[216:219], v[76:79], v[24:27], v[216:219]
    ds_read_b128 v[48:51], v15 offset:4096
    v_mfma_f32_16x16x32_bf16 v[220:223], v[76:79], v[28:31], v[220:223]
    ds_read_b128 v[52:55], v15 offset:6144
    v_mfma_f32_16x16x32_bf16 v[224:227], v[76:79], v[32:35], v[224:227]
    ds_read_b64_tr_b16 v[68:69], v4 offset:28672
    v_mfma_f32_16x16x32_bf16 v[228:231], v[76:79], v[36:39], v[228:231]
    ds_read_b64_tr_b16 v[70:71], v4 offset:29184
    v_mfma_f32_16x16x32_bf16 v[232:235], v[80:83], v[24:27], v[232:235]
    ds_read_b64_tr_b16 v[72:73], v5 offset:20480
    v_mfma_f32_16x16x32_bf16 v[236:239], v[80:83], v[28:31], v[236:239]
    v_mfma_f32_16x16x32_bf16 v[240:243], v[80:83], v[32:35], v[240:243]
    ds_read_b64_tr_b16 v[74:75], v5 offset:20992
    v_mfma_f32_16x16x32_bf16 v[244:247], v[80:83], v[36:39], v[244:247]
    s_waitcnt lgkmcnt(7)
    v_mfma_f32_16x16x32_bf16 v[88:91], v[64:67], v[40:43], v[88:91]
    ds_read_b64_tr_b16 v[76:77], v5 offset:28672
    s_waitcnt lgkmcnt(7)
    v_mfma_f32_16x16x32_bf16 v[92:95], v[64:67], v[44:47], v[92:95]
    ds_read_b64_tr_b16 v[78:79], v5 offset:29184
    s_waitcnt lgkmcnt(7)
    v_mfma_f32_16x16x32_bf16 v[96:99], v[64:67], v[48:51], v[96:99]
    ds_read_b64_tr_b16 v[80:81], v6 offset:20480
    s_waitcnt lgkmcnt(7)
    v_mfma_f32_16x16x32_bf16 v[100:103], v[64:67], v[52:55], v[100:103]
    ds_read_b64_tr_b16 v[82:83], v6 offset:20992
    s_waitcnt lgkmcnt(6)
    v_mfma_f32_16x16x32_bf16 v[104:107], v[68:71], v[40:43], v[104:107]
    ds_read_b64_tr_b16 v[64:65], v6 offset:28672
    v_mfma_f32_16x16x32_bf16 v[108:111], v[68:71], v[44:47], v[108:111]
    v_add_u32 v14, s80, v16
    v_mfma_f32_16x16x32_bf16 v[112:115], v[68:71], v[48:51], v[112:115]
    ds_read_b64_tr_b16 v[66:67], v6 offset:29184
    v_mfma_f32_16x16x32_bf16 v[116:119], v[68:71], v[52:55], v[116:119]
    v_add_u32 v15, s80, v17
    s_waitcnt lgkmcnt(6)
    v_mfma_f32_16x16x32_bf16 v[120:123], v[72:75], v[40:43], v[120:123]
    ds_read_b64_tr_b16 v[68:69], v7 offset:20480
    v_mfma_f32_16x16x32_bf16 v[124:127], v[72:75], v[44:47], v[124:127]
    s_add_u32 s80, s80, 18432
    v_mfma_f32_16x16x32_bf16 v[128:131], v[72:75], v[48:51], v[128:131]
    ds_read_b64_tr_b16 v[70:71], v7 offset:20992
    v_mfma_f32_16x16x32_bf16 v[132:135], v[72:75], v[52:55], v[132:135]
    s_cmp_ge_u32 s80, 153600
    s_cselect_b32 s84, 55296, 0
    s_waitcnt lgkmcnt(6)
    v_mfma_f32_16x16x32_bf16 v[136:139], v[76:79], v[40:43], v[136:139]
    ds_read_b64_tr_b16 v[72:73], v7 offset:28672
    v_mfma_f32_16x16x32_bf16 v[140:143], v[76:79], v[44:47], v[140:143]
    s_sub_u32 s80, s80, s84
    v_mfma_f32_16x16x32_bf16 v[144:147], v[76:79], v[48:51], v[144:147]
    ds_read_b64_tr_b16 v[74:75], v7 offset:29184
    v_mfma_f32_16x16x32_bf16 v[148:151], v[76:79], v[52:55], v[148:151]
    s_waitcnt lgkmcnt(6)
    v_mfma_f32_16x16x32_bf16 v[152:155], v[80:83], v[40:43], v[152:155]
    ds_read_b64_tr_b16 v[76:77], v8 offset:36864
    v_mfma_f32_16x16x32_bf16 v[156:159], v[80:83], v[44:47], v[156:159]
    v_mfma_f32_16x16x32_bf16 v[160:163], v[80:83], v[48:51], v[160:163]
    ds_read_b64_tr_b16 v[78:79], v8 offset:37120
    v_mfma_f32_16x16x32_bf16 v[164:167], v[80:83], v[52:55], v[164:167]
    s_waitcnt lgkmcnt(6)
    v_mfma_f32_16x16x32_bf16 v[168:171], v[64:67], v[40:43], v[168:171]
    ds_read_b64_tr_b16 v[80:81], v8 offset:38912
    v_mfma_f32_16x16x32_bf16 v[172:175], v[64:67], v[44:47], v[172:175]
    v_mfma_f32_16x16x32_bf16 v[176:179], v[64:67], v[48:51], v[176:179]
    ds_read_b64_tr_b16 v[82:83], v8 offset:39168
    v_mfma_f32_16x16x32_bf16 v[180:183], v[64:67], v[52:55], v[180:183]
    s_waitcnt lgkmcnt(6)
    v_mfma_f32_16x16x32_bf16 v[184:187], v[68:71], v[40:43], v[184:187]
    v_mfma_f32_16x16x32_bf16 v[188:191], v[68:71], v[44:47], v[188:191]
    v_mfma_f32_16x16x32_bf16 v[192:195], v[68:71], v[48:51], v[192:195]
    v_mfma_f32_16x16x32_bf16 v[196:199], v[68:71], v[52:55], v[196:199]
    s_waitcnt lgkmcnt(0)
    s_barrier
    v_mfma_f32_16x16x32_bf16 v[200:203], v[72:75], v[40:43], v[200:203]
    ds_read_b64_tr_b16 v[64:65], v9 offset:0
    v_mfma_f32_16x16x32_bf16 v[204:207], v[72:75], v[44:47], v[204:207]
    ds_read_b64_tr_b16 v[66:67], v9 offset:512
    v_mfma_f32_16x16x32_bf16 v[208:211], v[72:75], v[48:51], v[208:211]
    ds_read_b128 v[24:27], v14 offset:0
    v_mfma_f32_16x16x32_bf16 v[212:215], v[72:75], v[52:55], v[212:215]
    ds_read_b128 v[28:31], v14 offset:2048
    v_mfma_f32_16x16x32_bf16 v[216:219], v[76:79], v[40:43], v[216:219]
    ds_read_b128 v[32:35], v14 offset:4096
    v_mfma_f32_16x16x32_bf16 v[220:223], v[76:79], v[44:47], v[220:223]
    ds_read_b128 v[36:39], v14 offset:6144
    v_mfma_f32_16x16x32_bf16 v[224:227], v[76:79], v[48:51], v[224:227]
    ds_read_b64_tr_b16 v[68:69], v9 offset:8192
    v_mfma_f32_16x16x32_bf16 v[228:231], v[76:79], v[52:55], v[228:231]
    ds_read_b64_tr_b16 v[70:71], v9 offset:8704
    v_mfma_f32_16x16x32_bf16 v[232:235], v[80:83], v[40:43], v[232:235]
    ds_read_b64_tr_b16 v[72:73], v10 offset:0
    v_mfma_f32_16x16x32_bf16 v[236:239], v[80:83], v[44:47], v[236:239]
    v_mfma_f32_16x16x32_bf16 v[240:243], v[80:83], v[48:51], v[240:243]
    ds_read_b64_tr_b16 v[74:75], v10 offset:512
    v_mfma_f32_16x16x32_bf16 v[244:247], v[80:83], v[52:55], v[244:247]
    s_waitcnt lgkmcnt(7)
    v_mfma_f32_16x16x32_bf16 v[88:91], v[64:67], v[24:27], v[88:91]
    ds_read_b64_tr_b16 v[76:77], v10 offset:8192
    s_waitcnt lgkmcnt(7)
    v_mfma_f32_16x16x32_bf16 v[92:95], v[64:67], v[28:31], v[92:95]
    ds_read_b64_tr_b16 v[78:79], v10 offset:8704
    s_waitcnt lgkmcnt(7)
    v_mfma_f32_16x16x32_bf16 v[96:99], v[64:67], v[32:35], v[96:99]
    ds_read_b64_tr_b16 v[80:81], v11 offset:0
    s_waitcnt lgkmcnt(7)
    v_mfma_f32_16x16x32_bf16 v[100:103], v[64:67], v[36:39], v[100:103]
    ds_read_b64_tr_b16 v[82:83], v11 offset:512
    s_waitcnt lgkmcnt(6)
    v_mfma_f32_16x16x32_bf16 v[104:107], v[68:71], v[24:27], v[104:107]
    ds_read_b64_tr_b16 v[64:65], v11 offset:8192
    v_mfma_f32_16x16x32_bf16 v[108:111], v[68:71], v[28:31], v[108:111]
    v_mfma_f32_16x16x32_bf16 v[112:115], v[68:71], v[32:35], v[112:115]
    ds_read_b64_tr_b16 v[66:67], v11 offset:8704
    v_mfma_f32_16x16x32_bf16 v[116:119], v[68:71], v[36:39], v[116:119]
    s_waitcnt lgkmcnt(6)
    v_mfma_f32_16x16x32_bf16 v[120:123], v[72:75], v[24:27], v[120:123]
    ds_read_b64_tr_b16 v[68:69], v12 offset:0
    v_mfma_f32_16x16x32_bf16 v[124:127], v[72:75], v[28:31], v[124:127]
    v_mfma_f32_16x16x32_bf16 v[128:131], v[72:75], v[32:35], v[128:131]
    ds_read_b64_tr_b16 v[70:71], v12 offset:512
    v_mfma_f32_16x16x32_bf16 v[132:135], v[72:75], v[36:39], v[132:135]
    s_waitcnt lgkmcnt(6)
    v_mfma_f32_16x16x32_bf16 v[136:139], v[76:79], v[24:27], v[136:139]
    ds_read_b64_tr_b16 v[72:73], v12 offset:8192
    v_mfma_f32_16x16x32_bf16 v[140:143], v[76:79], v[28:31], v[140:143]
    v_mfma_f32_16x16x32_bf16 v[144:147], v[76:79], v[32:35], v[144:147]
    ds_read_b64_tr_b16 v[74:75], v12 offset:8704
    v_mfma_f32_16x16x32_bf16 v[148:151], v[76:79], v[36:39], v[148:151]
    s_waitcnt lgkmcnt(6)
    v_mfma_f32_16x16x32_bf16 v[152:155], v[80:83], v[24:27], v[152:155]
    ds_read_b64_tr_b16 v[76:77], v13 offset:16384
    v_mfma_f32_16x16x32_bf16 v[156:159], v[80:83], v[28:31], v[156:159]
    v_mfma_f32_16x16x32_bf16 v[160:163], v[80:83], v[32:35], v[160:163]
    ds_read_b64_tr_b16 v[78:79], v13 offset:16640
    v_mfma_f32_16x16x32_bf16 v[164:167], v[80:83], v[36:39], v[164:167]
    s_waitcnt lgkmcnt(6)
    v_mfma_f32_16x16x32_bf16 v[168:171], v[64:67], v[24:27], v[168:171]
    ds_read_b64_tr_b16 v[80:81], v13 offset:18432
    v_mfma_f32_16x16x32_bf16 v[172:175], v[64:67], v[28:31], v[172:175]
    v_mfma_f32_16x16x32_bf16 v[176:179], v[64:67], v[32:35], v[176:179]
    ds_read_b64_tr_b16 v[82:83], v13 offset:18688
    v_mfma_f32_16x16x32_bf16 v[180:183], v[64:67], v[36:39], v[180:183]
    s_waitcnt lgkmcnt(6)
    v_mfma_f32_16x16x32_bf16 v[184:187], v[68:71], v[24:27], v[184:187]
    v_mfma_f32_16x16x32_bf16 v[188:191], v[68:71], v[28:31], v[188:191]
    v_mfma_f32_16x16x32_bf16 v[192:195], v[68:71], v[32:35], v[192:195]
    v_mfma_f32_16x16x32_bf16 v[196:199], v[68:71], v[36:39], v[196:199]
    s_waitcnt lgkmcnt(0)
    s_barrier
    v_mfma_f32_16x16x32_bf16 v[200:203], v[72:75], v[24:27], v[200:203]
    ds_read_b64_tr_b16 v[64:65], v9 offset:20480
    v_mfma_f32_16x16x32_bf16 v[204:207], v[72:75], v[28:31], v[204:207]
    ds_read_b64_tr_b16 v[66:67], v9 offset:20992
    v_mfma_f32_16x16x32_bf16 v[208:211], v[72:75], v[32:35], v[208:211]
    ds_read_b128 v[40:43], v15 offset:0
    v_mfma_f32_16x16x32_bf16 v[212:215], v[72:75], v[36:39], v[212:215]
    ds_read_b128 v[44:47], v15 offset:2048
    v_mfma_f32_16x16x32_bf16 v[216:219], v[76:79], v[24:27], v[216:219]
    ds_read_b128 v[48:51], v15 offset:4096
    v_mfma_f32_16x16x32_bf16 v[220:223], v[76:79], v[28:31], v[220:223]
    ds_read_b128 v[52:55], v15 offset:6144
    v_mfma_f32_16x16x32_bf16 v[224:227], v[76:79], v[32:35], v[224:227]
    ds_read_b64_tr_b16 v[68:69], v9 offset:28672
    v_mfma_f32_16x16x32_bf16 v[228:231], v[76:79], v[36:39], v[228:231]
    ds_read_b64_tr_b16 v[70:71], v9 offset:29184
    v_mfma_f32_16x16x32_bf16 v[232:235], v[80:83], v[24:27], v[232:235]
    ds_read_b64_tr_b16 v[72:73], v10 offset:20480
    v_mfma_f32_16x16x32_bf16 v[236:239], v[80:83], v[28:31], v[236:239]
    v_mfma_f32_16x16x32_bf16 v[240:243], v[80:83], v[32:35], v[240:243]
    ds_read_b64_tr_b16 v[74:75], v10 offset:20992
    v_mfma_f32_16x16x32_bf16 v[244:247], v[80:83], v[36:39], v[244:247]
    s_waitcnt lgkmcnt(7)
    v_mfma_f32_16x16x32_bf16 v[88:91], v[64:67], v[40:43], v[88:91]
    ds_read_b64_tr_b16 v[76:77], v10 offset:28672
    s_waitcnt lgkmcnt(7)
    v_mfma_f32_16x16x32_bf16 v[92:95], v[64:67], v[44:47], v[92:95]
    ds_read_b64_tr_b16 v[78:79], v10 offset:29184
    s_waitcnt lgkmcnt(7)
    v_mfma_f32_16x16x32_bf16 v[96:99], v[64:67], v[48:51], v[96:99]
    ds_read_b64_tr_b16 v[80:81], v11 offset:20480
    s_waitcnt lgkmcnt(7)
    v_mfma_f32_16x16x32_bf16 v[100:103], v[64:67], v[52:55], v[100:103]
    ds_read_b64_tr_b16 v[82:83], v11 offset:20992
    s_waitcnt lgkmcnt(6)
    v_mfma_f32_16x16x32_bf16 v[104:107], v[68:71], v[40:43], v[104:107]
    ds_read_b64_tr_b16 v[64:65], v11 offset:28672
    v_mfma_f32_16x16x32_bf16 v[108:111], v[68:71], v[44:47], v[108:111]
    v_add_u32 v14, s80, v16
    v_mfma_f32_16x16x32_bf16 v[112:115], v[68:71], v[48:51], v[112:115]
    ds_read_b64_tr_b16 v[66:67], v11 offset:29184
    v_mfma_f32_16x16x32_bf16 v[116:119], v[68:71], v[52:55], v[116:119]
    v_add_u32 v15, s80, v17
    s_waitcnt lgkmcnt(6)
    v_mfma_f32_16x16x32_bf16 v[120:123], v[72:75], v[40:43], v[120:123]
    ds_read_b64_tr_b16 v[68:69], v12 offset:20480
    v_mfma_f32_16x16x32_bf16 v[124:127], v[72:75], v[44:47], v[124:127]
    s_add_u32 s80, s80, 18432
    v_mfma_f32_16x16x32_bf16 v[128:131], v[72:75], v[48:51], v[128:131]
    ds_read_b64_tr_b16 v[70:71], v12 offset:20992
    v_mfma_f32_16x16x32_bf16 v[132:135], v[72:75], v[52:55], v[132:135]
    s_cmp_ge_u32 s80, 153600
    s_cselect_b32 s84, 55296, 0
    s_waitcnt lgkmcnt(6)
    v_mfma_f32_16x16x32_bf16 v[136:139], v[76:79], v[40:43], v[136:139]
    ds_read_b64_tr_b16 v[72:73], v12 offset:28672
    v_mfma_f32_16x16x32_bf16 v[140:143], v[76:79], v[44:47], v[140:143]
    s_sub_u32 s80, s80, s84
    v_mfma_f32_16x16x32_bf16 v[144:147], v[76:79], v[48:51], v[144:147]
    ds_read_b64_tr_b16 v[74:75], v12 offset:29184
    v_mfma_f32_16x16x32_bf16 v[148:151], v[76:79], v[52:55], v[148:151]
    s_waitcnt lgkmcnt(6)
    v_mfma_f32_16x16x32_bf16 v[152:155], v[80:83], v[40:43], v[152:155]
    ds_read_b64_tr_b16 v[76:77], v13 offset:36864
    v_mfma_f32_16x16x32_bf16 v[156:159], v[80:83], v[44:47], v[156:159]
    v_mfma_f32_16x16x32_bf16 v[160:163], v[80:83], v[48:51], v[160:163]
    ds_read_b64_tr_b16 v[78:79], v13 offset:37120
    v_mfma_f32_16x16x32_bf16 v[164:167], v[80:83], v[52:55], v[164:167]
    s_waitcnt lgkmcnt(6)
    v_mfma_f32_16x16x32_bf16 v[168:171], v[64:67], v[40:43], v[168:171]
    ds_read_b64_tr_b16 v[80:81], v13 offset:38912
    v_mfma_f32_16x16x32_bf16 v[172:175], v[64:67], v[44:47], v[172:175]
    v_mfma_f32_16x16x32_bf16 v[176:179], v[64:67], v[48:51], v[176:179]
    ds_read_b64_tr_b16 v[82:83], v13 offset:39168
    v_mfma_f32_16x16x32_bf16 v[180:183], v[64:67], v[52:55], v[180:183]
    s_waitcnt lgkmcnt(6)
    v_mfma_f32_16x16x32_bf16 v[184:187], v[68:71], v[40:43], v[184:187]
    v_mfma_f32_16x16x32_bf16 v[188:191], v[68:71], v[44:47], v[188:191]
    v_mfma_f32_16x16x32_bf16 v[192:195], v[68:71], v[48:51], v[192:195]
    v_mfma_f32_16x16x32_bf16 v[196:199], v[68:71], v[52:55], v[196:199]
    s_waitcnt lgkmcnt(0)
    s_barrier
    v_mfma_f32_16x16x32_bf16 v[200:203], v[72:75], v[40:43], v[200:203]
    ds_read_b64_tr_b16 v[64:65], v4 offset:0
    v_mfma_f32_16x16x32_bf16 v[204:207], v[72:75], v[44:47], v[204:207]
    ds_read_b64_tr_b16 v[66:67], v4 offset:512
    v_mfma_f32_16x16x32_bf16 v[208:211], v[72:75], v[48:51], v[208:211]
    ds_read_b128 v[24:27], v14 offset:0
    v_mfma_f32_16x16x32_bf16 v[212:215], v[72:75], v[52:55], v[212:215]
    ds_read_b128 v[28:31], v14 offset:2048
    v_mfma_f32_16x16x32_bf16 v[216:219], v[76:79], v[40:43], v[216:219]
    ds_read_b128 v[32:35], v14 offset:4096
    v_mfma_f32_16x16x32_bf16 v[220:223], v[76:79], v[44:47], v[220:223]
    ds_read_b128 v[36:39], v14 offset:6144
    v_mfma_f32_16x16x32_bf16 v[224:227], v[76:79], v[48:51], v[224:227]
    ds_read_b64_tr_b16 v[68:69], v4 offset:8192
    v_mfma_f32_16x16x32_bf16 v[228:231], v[76:79], v[52:55], v[228:231]
    ds_read_b64_tr_b16 v[70:71], v4 offset:8704
    v_mfma_f32_16x16x32_bf16 v[232:235], v[80:83], v[40:43], v[232:235]
    ds_read_b64_tr_b16 v[72:73], v5 offset:0
    v_mfma_f32_16x16x32_bf16 v[236:239], v[80:83], v[44:47], v[236:239]
    v_mfma_f32_16x16x32_bf16 v[240:243], v[80:83], v[48:51], v[240:243]
    ds_read_b64_tr_b16 v[74:75], v5 offset:512
    v_mfma_f32_16x16x32_bf16 v[244:247], v[80:83], v[52:55], v[244:247]
    s_sub_u32 s34, s34, 1
    s_cmp_lg_u32 s34, 0
    s_cbranch_scc1 L_p1
    s_waitcnt lgkmcnt(7)
    v_mfma_f32_16x16x32_bf16 v[88:91], v[64:67], v[24:27], v[88:91]
    ds_read_b64_tr_b16 v[76:77], v5 offset:8192
    s_waitcnt lgkmcnt(7)
    v_mfma_f32_16x16x32_bf16 v[92:95], v[64:67], v[28:31], v[92:95]
    ds_read_b64_tr_b16 v[78:79], v5 offset:8704
    s_waitcnt lgkmcnt(7)
    v_mfma_f32_16x16x32_bf16 v[96:99], v[64:67], v[32:35], v[96:99]
    ds_read_b64_tr_b16 v[80:81], v6 offset:0
    s_waitcnt lgkmcnt(7)
    v_mfma_f32_16x16x32_bf16 v[100:103], v[64:67], v[36:39], v[100:103]
    ds_read_b64_tr_b16 v[82:83], v6 offset:512
    s_waitcnt lgkmcnt(6)
    v_mfma_f32_16x16x32_bf16 v[104:107], v[68:71], v[24:27], v[104:107]
    ds_read_b64_tr_b16 v[64:65], v6 offset:8192
    v_mfma_f32_16x16x32_bf16 v[108:111], v[68:71], v[28:31], v[108:111]
    v_mfma_f32_16x16x32_bf16 v[112:115], v[68:71], v[32:35], v[112:115]
    ds_read_b64_tr_b16 v[66:67], v6 offset:8704
    v_mfma_f32_16x16x32_bf16 v[116:119], v[68:71], v[36:39], v[116:119]
    s_waitcnt lgkmcnt(6)
    v_mfma_f32_16x16x32_bf16 v[120:123], v[72:75], v[24:27], v[120:123]
    ds_read_b64_tr_b16 v[68:69], v7 offset:0
    v_mfma_f32_16x16x32_bf16 v[124:127], v[72:75], v[28:31], v[124:127]
    v_mfma_f32_16x16x32_bf16 v[128:131], v[72:75], v[32:35], v[128:131]
    ds_read_b64_tr_b16 v[70:71], v7 offset:512
    v_mfma_f32_16x16x32_bf16 v[132:135], v[72:75], v[36:39], v[132:135]
    s_waitcnt lgkmcnt(6)
    v_mfma_f32_16x16x32_bf16 v[136:139], v[76:79], v[24:27], v[136:139]
    ds_read_b64_tr_b16 v[72:73], v7 offset:8192
    v_mfma_f32_16x16x32_bf16 v[140:143], v[76:79], v[28:31], v[140:143]
    v_mfma_f32_16x16x32_bf16 v[144:147], v[76:79], v[32:35], v[144:147]
    ds_read_b64_tr_b16 v[74:75], v7 offset:8704
    v_mfma_f32_16x16x32_bf16 v[148:151], v[76:79], v[36:39], v[148:151]
    s_waitcnt lgkmcnt(6)
    v_mfma_f32_16x16x32_bf16 v[152:155], v[80:83], v[24:27], v[152:155]
    ds_read_b64_tr_b16 v[76:77], v8 offset:16384
    v_mfma_f32_16x16x32_bf16 v[156:159], v[80:83], v[28:31], v[156:159]
    v_mfma_f32_16x16x32_bf16 v[160:163], v[80:83], v[32:35], v[160:163]
    ds_read_b64_tr_b16 v[78:79], v8 offset:16640
    v_mfma_f32_16x16x32_bf16 v[164:167], v[80:83], v[36:39], v[164:167]
    s_waitcnt lgkmcnt(6)
    v_mfma_f32_16x16x32_bf16 v[168:171], v[64:67], v[24:27], v[168:171]
    ds_read_b64_tr_b16 v[80:81], v8 offset:18432
    v_mfma_f32_16x16x32_bf16 v[172:175], v[64:67], v[28:31], v[172:175]
    v_mfma_f32_16x16x32_bf16 v[176:179], v[64:67], v[32:35], v[176:179]
    ds_read_b64_tr_b16 v[82:83], v8 offset:18688
    v_mfma_f32_16x16x32_bf16 v[180:183], v[64:67], v[36:39], v[180:183]
    s_waitcnt lgkmcnt(6)
    v_mfma_f32_16x16x32_bf16 v[184:187], v[68:71], v[24:27], v[184:187]
    v_mfma_f32_16x16x32_bf16 v[188:191], v[68:71], v[28:31], v[188:191]
    v_mfma_f32_16x16x32_bf16 v[192:195], v[68:71], v[32:35], v[192:195]
    v_mfma_f32_16x16x32_bf16 v[196:199], v[68:71], v[36:39], v[196:199]
    s_waitcnt lgkmcnt(0)
    s_barrier
    v_mfma_f32_16x16x32_bf16 v[200:203], v[72:75], v[24:27], v[200:203]
    ds_read_b64_tr_b16 v[64:65], v4 offset:20480
    v_mfma_f32_16x16x32_bf16 v[204:207], v[72:75], v[28:31], v[204:207]
    ds_read_b64_tr_b16 v[66:67], v4 offset:20992
    v_mfma_f32_16x16x32_bf16 v[208:211], v[72:75], v[32:35], v[208:211]
    ds_read_b128 v[40:43], v15 offset:0
    v_mfma_f32_16x16x32_bf16 v[212:215], v[72:75], v[36:39], v[212:215]
    ds_read_b128 v[44:47], v15 offset:2048
    v_mfma_f32_16x16x32_bf16 v[216:219], v[76:79], v[24:27], v[216:219]
    ds_read_b128 v[48:51], v15 offset:4096
    v_mfma_f32_16x16x32_bf16 v[220:223], v[76:79], v[28:31], v[220:223]
    ds_read_b128 v[52:55], v15 offset:6144
    v_mfma_f32_16x16x32_bf16 v[224:227], v[76:79], v[32:35], v[224:227]
    ds_read_b64_tr_b16 v[68:69], v4 offset:28672
    v_mfma_f32_16x16x32_bf16 v[228:231], v[76:79], v[36:39], v[228:231]
    ds_read_b64_tr_b16 v[70:71], v4 offset:29184
    v_mfma_f32_16x16x32_bf16 v[232:235], v[80:83], v[24:27], v[232:235]
    ds_read_b64_tr_b16 v[72:73], v5 offset:20480
    v_mfma_f32_16x16x32_bf16 v[236:239], v[80:83], v[28:31], v[236:239]
    v_mfma_f32_16x16x32_bf16 v[240:243], v[80:83], v[32:35], v[240:243]
    ds_read_b64_tr_b16 v[74:75], v5 offset:20992
    v_mfma_f32_16x16x32_bf16 v[244:247], v[80:83], v[36:39], v[244:247]
    s_waitcnt lgkmcnt(7)
    v_mfma_f32_16x16x32_bf16 v[88:91], v[64:67], v[40:43], v[88:91]
    ds_read_b64_tr_b16 v[76:77], v5 offset:28672
    s_waitcnt lgkmcnt(7)
    v_mfma_f32_16x16x32_bf16 v[92:95], v[64:67], v[44:47], v[92:95]
    ds_read_b64_tr_b16 v[78:79], v5 offset:29184
    s_waitcnt lgkmcnt(7)
    v_mfma_f32_16x16x32_bf16 v[96:99], v[64:67], v[48:51], v[96:99]
    ds_read_b64_tr_b16 v[80:81], v6 offset:20480
    s_waitcnt lgkmcnt(7)
    v_mfma_f32_16x16x32_bf16 v[100:103], v[64:67], v[52:55], v[100:103]
    ds_read_b64_tr_b16 v[82:83], v6 offset:20992
    s_waitcnt lgkmcnt(6)
    v_mfma_f32_16x16x32_bf16 v[104:107], v[68:71], v[40:43], v[104:107]
    ds_read_b64_tr_b16 v[64:65], v6 offset:28672
    v_mfma_f32_16x16x32_bf16 v[108:111], v[68:71], v[44:47], v[108:111]
    v_add_u32 v14, s80, v16
    v_mfma_f32_16x16x32_bf16 v[112:115], v[68:71], v[48:51], v[112:115]
    ds_read_b64_tr_b16 v[66:67], v6 offset:29184
    v_mfma_f32_16x16x32_bf16 v[116:119], v[68:71], v[52:55], v[116:119]
    v_add_u32 v15, s80, v17
    s_waitcnt lgkmcnt(6)
    v_mfma_f32_16x16x32_bf16 v[120:123], v[72:75], v[40:43], v[120:123]
    ds_read_b64_tr_b16 v[68:69], v7 offset:20480
    v_mfma_f32_16x16x32_bf16 v[124:127], v[72:75], v[44:47], v[124:127]
    s_add_u32 s80, s80, 18432
    v_mfma_f32_16x16x32_bf16 v[128:131], v[72:75], v[48:51], v[128:131]
    ds_read_b64_tr_b16 v[70:71], v7 offset:20992
    v_mfma_f32_16x16x32_bf16 v[132:135], v[72:75], v[52:55], v[132:135]
    s_cmp_ge_u32 s80, 153600
    s_cselect_b32 s84, 55296, 0
    s_waitcnt lgkmcnt(6)
    v_mfma_f32_16x16x32_bf16 v[136:139], v[76:79], v[40:43], v[136:139]
    ds_read_b64_tr_b16 v[72:73], v7 offset:28672
    v_mfma_f32_16x16x32_bf16 v[140:143], v[76:79], v[44:47], v[140:143]
    s_sub_u32 s80, s80, s84
    v_mfma_f32_16x16x32_bf16 v[144:147], v[76:79], v[48:51], v[144:147]
    ds_read_b64_tr_b16 v[74:75], v7 offset:29184
    v_mfma_f32_16x16x32_bf16 v[148:151], v[76:79], v[52:55], v[148:151]
    s_waitcnt lgkmcnt(6)
    v_mfma_f32_16x16x32_bf16 v[152:155], v[80:83], v[40:43], v[152:155]
    ds_read_b64_tr_b16 v[76:77], v8 offset:36864
    v_mfma_f32_16x16x32_bf16 v[156:159], v[80:83], v[44:47], v[156:159]
    v_mfma_f32_16x16x32_bf16 v[160:163], v[80:83], v[48:51], v[160:163]
    ds_read_b64_tr_b16 v[78:79], v8 offset:37120
    v_mfma_f32_16x16x32_bf16 v[164:167], v[80:83], v[52:55], v[164:167]
    s_waitcnt lgkmcnt(6)
    v_mfma_f32_16x16x32_bf16 v[168:171], v[64:67], v[40:43], v[168:171]
    ds_read_b64_tr_b16 v[80:81], v8 offset:38912
    v_mfma_f32_16x16x32_bf16 v[172:175], v[64:67], v[44:47], v[172:175]
    v_mfma_f32_16x16x32_bf16 v[176:179], v[64:67], v[48:51], v[176:179]
    ds_read_b64_tr_b16 v[82:83], v8 offset:39168
    v_mfma_f32_16x16x32_bf16 v[180:183], v[64:67], v[52:55], v[180:183]
    s_waitcnt lgkmcnt(6)
    v_mfma_f32_16x16x32_bf16 v[184:187], v[68:71], v[40:43], v[184:187]
    v_mfma_f32_16x16x32_bf16 v[188:191], v[68:71], v[44:47], v[188:191]
    v_mfma_f32_16x16x32_bf16 v[192:195], v[68:71], v[48:51], v[192:195]
    v_mfma_f32_16x16x32_bf16 v[196:199], v[68:71], v[52:55], v[196:199]
    s_waitcnt lgkmcnt(0)
    s_barrier
    v_mfma_f32_16x16x32_bf16 v[200:203], v[72:75], v[40:43], v[200:203]
    ds_read_b64_tr_b16 v[64:65], v9 offset:0
    v_mfma_f32_16x16x32_bf16 v[204:207], v[72:75], v[44:47], v[204:207]
    ds_read_b64_tr_b16 v[66:67], v9 offset:512
    v_mfma_f32_16x16x32_bf16 v[208:211], v[72:75], v[48:51], v[208:211]
    ds_read_b128 v[24:27], v14 offset:0
    v_mfma_f32_16x16x32_bf16 v[212:215], v[72:75], v[52:55], v[212:215]
    ds_read_b128 v[28:31], v14 offset:2048
    v_mfma_f32_16x16x32_bf16 v[216:219], v[76:79], v[40:43], v[216:219]
    ds_read_b128 v[32:35], v14 offset:4096
    v_mfma_f32_16x16x32_bf16 v[220:223], v[76:79], v[44:47], v[220:223]
    ds_read_b128 v[36:39], v14 offset:6144
    v_mfma_f32_16x16x32_bf16 v[224:227], v[76:79], v[48:51], v[224:227]
    ds_read_b64_tr_b16 v[68:69], v9 offset:8192
    v_mfma_f32_16x16x32_bf16 v[228:231], v[76:79], v[52:55], v[228:231]
    ds_read_b64_tr_b16 v[70:71], v9 offset:8704
    v_mfma_f32_16x16x32_bf16 v[232:235], v[80:83], v[40:43], v[232:235]
    ds_read_b64_tr_b16 v[72:73], v10 offset:0
    v_mfma_f32_16x16x32_bf16 v[236:239], v[80:83], v[44:47], v[236:239]
    v_mfma_f32_16x16x32_bf16 v[240:243], v[80:83], v[48:51], v[240:243]
    ds_read_b64_tr_b16 v[74:75], v10 offset:512
    v_mfma_f32_16x16x32_bf16 v[244:247], v[80:83], v[52:55], v[244:247]
    s_waitcnt lgkmcnt(7)
    v_mfma_f32_16x16x32_bf16 v[88:91], v[64:67], v[24:27], v[88:91]
    ds_read_b64_tr_b16 v[76:77], v10 offset:8192
    s_waitcnt lgkmcnt(7)
    v_mfma_f32_16x16x32_bf16 v[92:95], v[64:67], v[28:31], v[92:95]
    ds_read_b64_tr_b16 v[78:79], v10 offset:8704
    s_waitcnt lgkmcnt(7)
    v_mfma_f32_16x16x32_bf16 v[96:99], v[64:67], v[32:35], v[96:99]
    ds_read_b64_tr_b16 v[80:81], v11 offset:0
    s_waitcnt lgkmcnt(7)
    v_mfma_f32_16x16x32_bf16 v[100:103], v[64:67], v[36:39], v[100:103]
    ds_read_b64_tr_b16 v[82:83], v11 offset:512
    s_waitcnt lgkmcnt(6)
    v_mfma_f32_16x16x32_bf16 v[104:107], v[68:71], v[24:27], v[104:107]
    ds_read_b64_tr_b16 v[64:65], v11 offset:8192
    v_mfma_f32_16x16x32_bf16 v[108:111], v[68:71], v[28:31], v[108:111]
    v_mfma_f32_16x16x32_bf16 v[112:115], v[68:71], v[32:35], v[112:115]
    ds_read_b64_tr_b16 v[66:67], v11 offset:8704
    v_mfma_f32_16x16x32_bf16 v[116:119], v[68:71], v[36:39], v[116:119]
    s_waitcnt lgkmcnt(6)
    v_mfma_f32_16x16x32_bf16 v[120:123], v[72:75], v[24:27], v[120:123]
    ds_read_b64_tr_b16 v[68:69], v12 offset:0
    v_mfma_f32_16x16x32_bf16 v[124:127], v[72:75], v[28:31], v[124:127]
    v_mfma_f32_16x16x32_bf16 v[128:131], v[72:75], v[32:35], v[128:131]
    ds_read_b64_tr_b16 v[70:71], v12 offset:512
    v_mfma_f32_16x16x32_bf16 v[132:135], v[72:75], v[36:39], v[132:135]
    s_waitcnt lgkmcnt(6)
    v_mfma_f32_16x16x32_bf16 v[136:139], v[76:79], v[24:27], v[136:139]
    ds_read_b64_tr_b16 v[72:73], v12 offset:8192
    v_mfma_f32_16x16x32_bf16 v[140:143], v[76:79], v[28:31], v[140:143]
    v_mfma_f32_16x16x32_bf16 v[144:147], v[76:79], v[32:35], v[144:147]
    ds_read_b64_tr_b16 v[74:75], v12 offset:8704
    v_mfma_f32_16x16x32_bf16 v[148:151], v[76:79], v[36:39], v[148:151]
    s_waitcnt lgkmcnt(6)
    v_mfma_f32_16x16x32_bf16 v[152:155], v[80:83], v[24:27], v[152:155]
    ds_read_b64_tr_b16 v[76:77], v13 offset:16384
    v_mfma_f32_16x16x32_bf16 v[156:159], v[80:83], v[28:31], v[156:159]
    v_mfma_f32_16x16x32_bf16 v[160:163], v[80:83], v[32:35], v[160:163]
    ds_read_b64_tr_b16 v[78:79], v13 offset:16640
    v_mfma_f32_16x16x32_bf16 v[164:167], v[80:83], v[36:39], v[164:167]
    s_waitcnt lgkmcnt(6)
    v_mfma_f32_16x16x32_bf16 v[168:171], v[64:67], v[24:27], v[168:171]
    ds_read_b64_tr_b16 v[80:81], v13 offset:18432
    v_mfma_f32_16x16x32_bf16 v[172:175], v[64:67], v[28:31], v[172:175]
    v_mfma_f32_16x16x32_bf16 v[176:179], v[64:67], v[32:35], v[176:179]
    ds_read_b64_tr_b16 v[82:83], v13 offset:18688
    v_mfma_f32_16x16x32_bf16 v[180:183], v[64:67], v[36:39], v[180:183]
    s_waitcnt lgkmcnt(6)
    v_mfma_f32_16x16x32_bf16 v[184:187], v[68:71], v[24:27], v[184:187]
    v_mfma_f32_16x16x32_bf16 v[188:191], v[68:71], v[28:31], v[188:191]
    v_mfma_f32_16x16x32_bf16 v[192:195], v[68:71], v[32:35], v[192:195]
    v_mfma_f32_16x16x32_bf16 v[196:199], v[68:71], v[36:39], v[196:199]
    s_waitcnt lgkmcnt(0)
    s_barrier
    v_mfma_f32_16x16x32_bf16 v[200:203], v[72:75], v[24:27], v[200:203]
    ds_read_b64_tr_b16 v[64:65], v9 offset:20480
    v_mfma_f32_16x16x32_bf16 v[204:207], v[72:75], v[28:31], v[204:207]
    ds_read_b64_tr_b16 v[66:67], v9 offset:20992
    v_mfma_f32_16x16x32_bf16 v[208:211], v[72:75], v[32:35], v[208:211]
    ds_read_b128 v[40:43], v15 offset:0
    v_mfma_f32_16x16x32_bf16 v[212:215], v[72:75], v[36:39], v[212:215]
    ds_read_b128 v[44:47], v15 offset:2048
    v_mfma_f32_16x16x32_bf16 v[216:219], v[76:79], v[24:27], v[216:219]
    ds_read_b128 v[48:51], v15 offset:4096
    v_mfma_f32_16x16x32_bf16 v[220:223], v[76:79], v[28:31], v[220:223]
    ds_read_b128 v[52:55], v15 offset:6144
    v_mfma_f32_16x16x32_bf16 v[224:227], v[76:79], v[32:35], v[224:227]
    ds_read_b64_tr_b16 v[68:69], v9 offset:28672
    v_mfma_f32_16x16x32_bf16 v[228:231], v[76:79], v[36:39], v[228:231]
    ds_read_b64_tr_b16 v[70:71], v9 offset:29184
    v_mfma_f32_16x16x32_bf16 v[232:235], v[80:83], v[24:27], v[232:235]
    ds_read_b64_tr_b16 v[72:73], v10 offset:20480
    v_mfma_f32_16x16x32_bf16 v[236:239], v[80:83], v[28:31], v[236:239]
    v_mfma_f32_16x16x32_bf16 v[240:243], v[80:83], v[32:35], v[240:243]
    ds_read_b64_tr_b16 v[74:75], v10 offset:20992
    v_mfma_f32_16x16x32_bf16 v[244:247], v[80:83], v[36:39], v[244:247]
    s_waitcnt lgkmcnt(7)
    v_mfma_f32_16x16x32_bf16 v[88:91], v[64:67], v[40:43], v[88:91]
    ds_read_b64_tr_b16 v[76:77], v10 offset:28672
    s_waitcnt lgkmcnt(7)
    v_mfma_f32_16x16x32_bf16 v[92:95], v[64:67], v[44:47], v[92:95]
    ds_read_b64_tr_b16 v[78:79], v10 offset:29184
    s_waitcnt lgkmcnt(7)
    v_mfma_f32_16x16x32_bf16 v[96:99], v[64:67], v[48:51], v[96:99]
    ds_read_b64_tr_b16 v[80:81], v11 offset:20480
    s_waitcnt lgkmcnt(7)
    v_mfma_f32_16x16x32_bf16 v[100:103], v[64:67], v[52:55], v[100:103]
    ds_read_b64_tr_b16 v[82:83], v11 offset:20992
    s_waitcnt lgkmcnt(6)
    v_mfma_f32_16x16x32_bf16 v[104:107], v[68:71], v[40:43], v[104:107]
    ds_read_b64_tr_b16 v[64:65], v11 offset:28672
    v_mfma_f32_16x16x32_bf16 v[108:111], v[68:71], v[44:47], v[108:111]
    v_mfma_f32_16x16x32_bf16 v[112:115], v[68:71], v[48:51], v[112:115]
    ds_read_b64_tr_b16 v[66:67], v11 offset:29184
    v_mfma_f32_16x16x32_bf16 v[116:119], v[68:71], v[52:55], v[116:119]
    s_waitcnt lgkmcnt(6)
    v_mfma_f32_16x16x32_bf16 v[120:123], v[72:75], v[40:43], v[120:123]
    ds_read_b64_tr_b16 v[68:69], v12 offset:20480
    v_mfma_f32_16x16x32_bf16 v[124:127], v[72:75], v[44:47], v[124:127]
    v_mfma_f32_16x16x32_bf16 v[128:131], v[72:75], v[48:51], v[128:131]
    ds_read_b64_tr_b16 v[70:71], v12 offset:20992
    v_mfma_f32_16x16x32_bf16 v[132:135], v[72:75], v[52:55], v[132:135]
    s_waitcnt lgkmcnt(6)
    v_mfma_f32_16x16x32_bf16 v[136:139], v[76:79], v[40:43], v[136:139]
    ds_read_b64_tr_b16 v[72:73], v12 offset:28672
    v_mfma_f32_16x16x32_bf16 v[140:143], v[76:79], v[44:47], v[140:143]
    v_mfma_f32_16x16x32_bf16 v[144:147], v[76:79], v[48:51], v[144:147]
    ds_read_b64_tr_b16 v[74:75], v12 offset:29184
    v_mfma_f32_16x16x32_bf16 v[148:151], v[76:79], v[52:55], v[148:151]
    s_waitcnt lgkmcnt(6)
    v_mfma_f32_16x16x32_bf16 v[152:155], v[80:83], v[40:43], v[152:155]
    ds_read_b64_tr_b16 v[76:77], v13 offset:36864
    v_mfma_f32_16x16x32_bf16 v[156:159], v[80:83], v[44:47], v[156:159]
    v_mfma_f32_16x16x32_bf16 v[160:163], v[80:83], v[48:51], v[160:163]
    ds_read_b64_tr_b16 v[78:79], v13 offset:37120
    v_mfma_f32_16x16x32_bf16 v[164:167], v[80:83], v[52:55], v[164:167]
    s_waitcnt lgkmcnt(6)
    v_mfma_f32_16x16x32_bf16 v[168:171], v[64:67], v[40:43], v[168:171]
    ds_read_b64_tr_b16 v[80:81], v13 offset:38912
    v_mfma_f32_16x16x32_bf16 v[172:175], v[64:67], v[44:47], v[172:175]
    v_mfma_f32_16x16x32_bf16 v[176:179], v[64:67], v[48:51], v[176:179]
    ds_read_b64_tr_b16 v[82:83], v13 offset:39168
    v_mfma_f32_16x16x32_bf16 v[180:183], v[64:67], v[52:55], v[180:183]
    s_waitcnt lgkmcnt(6)
    v_mfma_f32_16x16x32_bf16 v[184:187], v[68:71], v[40:43], v[184:187]
    v_mfma_f32_16x16x32_bf16 v[188:191], v[68:71], v[44:47], v[188:191]
    v_mfma_f32_16x16x32_bf16 v[192:195], v[68:71], v[48:51], v[192:195]
    v_mfma_f32_16x16x32_bf16 v[196:199], v[68:71], v[52:55], v[196:199]
    s_waitcnt lgkmcnt(0)
    s_barrier
    v_mfma_f32_16x16x32_bf16 v[200:203], v[72:75], v[40:43], v[200:203]
    v_mfma_f32_16x16x32_bf16 v[204:207], v[72:75], v[44:47], v[204:207]
    v_mfma_f32_16x16x32_bf16 v[208:211], v[72:75], v[48:51], v[208:211]
    v_mfma_f32_16x16x32_bf16 v[212:215], v[72:75], v[52:55], v[212:215]
    v_mfma_f32_16x16x32_bf16 v[216:219], v[76:79], v[40:43], v[216:219]
    v_mfma_f32_16x16x32_bf16 v[220:223], v[76:79], v[44:47], v[220:223]
    v_mfma_f32_16x16x32_bf16 v[224:227], v[76:79], v[48:51], v[224:227]
    v_mfma_f32_16x16x32_bf16 v[228:231], v[76:79], v[52:55], v[228:231]
    v_mfma_f32_16x16x32_bf16 v[232:235], v[80:83], v[40:43], v[232:235]
    v_mfma_f32_16x16x32_bf16 v[236:239], v[80:83], v[44:47], v[236:239]
    v_mfma_f32_16x16x32_bf16 v[240:243], v[80:83], v[48:51], v[240:243]
    v_mfma_f32_16x16x32_bf16 v[244:247], v[80:83], v[52:55], v[244:247]
    s_setprio 0
    s_lshl_b32 s84, s5, 10
    s_add_u32 s84, s84, 161024
    v_and_b32 v16, 15, v1
    v_lshl_add_u32 v16, v16, 4, s84
    ds_read_b128 v[64:67], v16 offset:0
    ds_read_b128 v[68:71], v16 offset:256
    ds_read_b128 v[72:75], v16 offset:512
    ds_read_b128 v[76:79], v16 offset:768
    v_and_b32 v17, 48, v1
    s_lshl_b32 s84, s6, 8
    s_add_u32 s84, s84, 159744
    v_add_u32 v16, s84, v17
    s_lshl_b32 s84, s6, 6
    s_add_u32 s84, s84, 159744
    v_add_u32 v17, s84, v17
    ds_read_b128 v[24:27], v16 offset:0
    ds_read_b128 v[28:31], v16 offset:640
    ds_read_b128 v[32:35], v16 offset:64
    ds_read_b128 v[36:39], v16 offset:704
    ds_read_b128 v[40:43], v16 offset:128
    ds_read_b128 v[44:47], v16 offset:768
    ds_read_b128 v[48:51], v16 offset:192
    ds_read_b128 v[52:55], v16 offset:832
    ds_read_b128 v[56:59], v17 offset:512
    ds_read_b128 v[60:63], v17 offset:1152
    s_add_u32 m0, s79, 116736
    s_mov_b32 s78, 256
    buffer_load_dwordx4 v20, s[36:39], s78 offen sc1 lds
    s_waitcnt lgkmcnt(0)
    v_fmac_f32 v88, v24, v64
    v_fmac_f32 v89, v25, v64
    v_fmac_f32 v90, v26, v64
    v_fmac_f32 v91, v27, v64
    v_fmac_f32 v104, v28, v64
    v_fmac_f32 v105, v29, v64
    v_fmac_f32 v106, v30, v64
    v_fmac_f32 v107, v31, v64
    s_add_u32 m0, s79, 117760
    s_nop 0
    buffer_load_dwordx4 v21, s[36:39], s78 offen sc1 lds
    v_mul_f32 v80, v88, v88
    v_mul_f32 v81, v89, v89
    v_mul_f32 v82, v90, v90
    v_mul_f32 v83, v91, v91
    v_fma_f32 v80, v80, v66, v65
    v_fma_f32 v81, v81, v66, v65
    v_fma_f32 v82, v82, v66, v65
    v_fma_f32 v83, v83, v66, v65
    s_add_u32 m0, s33, 77824
    s_mov_b32 s76, 589824
    buffer_load_dwordx4 v23, s[40:43], s76 offen offset:0 lds
    v_mul_f32 v80, v80, v88
    v_mul_f32 v81, v81, v89
    v_mul_f32 v82, v82, v90
    v_mul_f32 v83, v83, v91
    v_exp_f32 v80, v80
    v_mul_f32 v88, v88, v104
    v_exp_f32 v81, v81
    s_add_u32 m0, s33, 79872
    s_nop 0
    buffer_load_dwordx4 v23, s[40:43], s76 offen offset:2048 lds
    v_mul_f32 v89, v89, v105
    v_exp_f32 v82, v82
    v_mul_f32 v90, v90, v106
    v_exp_f32 v83, v83
    v_mul_f32 v91, v91, v107
    v_fma_f32 v80, v80, v67, v67
    s_add_u32 m0, s33, 86016
    s_nop 0
    buffer_load_dwordx4 v23, s[44:47], s76 offen offset:0 lds
    v_fma_f32 v81, v81, v67, v67
    v_fma_f32 v82, v82, v67, v67
    v_fma_f32 v83, v83, v67, v67
    v_rcp_f32 v80, v80
    v_rcp_f32 v81, v81
    v_rcp_f32 v82, v82
    s_add_u32 m0, s33, 90112
    s_mov_b32 s77, 688128
    buffer_load_dwordx4 v22, s[48:51], s77 offen offset:0 lds
    v_rcp_f32 v83, v83
    s_nop 0
    v_mul_f32 v88, v88, v80
    v_mul_f32 v89, v89, v81
    v_mul_f32 v90, v90, v82
    v_mul_f32 v91, v91, v83
    v_cvt_pk_bf16_f32 v88, v88, v89
    v_cvt_pk_bf16_f32 v89, v90, v91
    s_add_u32 m0, s33, 94208
    s_nop 0
    buffer_load_dwordx4 v22, s[52:55], s77 offen offset:0 lds
    s_barrier
    s_add_u32 m0, s79, 118784
    s_mov_b32 s78, 33024
    buffer_load_dwordx4 v20, s[36:39], s78 offen sc1 lds
    v_fmac_f32 v92, v24, v68
    v_fmac_f32 v93, v25, v68
    v_fmac_f32 v94, v26, v68
    v_fmac_f32 v95, v27, v68
    v_fmac_f32 v108, v28, v68
    v_fmac_f32 v109, v29, v68
    v_fmac_f32 v110, v30, v68
    v_fmac_f32 v111, v31, v68
    s_add_u32 m0, s79, 119808
    s_nop 0
    buffer_load_dwordx4 v21, s[36:39], s78 offen sc1 lds
    v_mul_f32 v80, v92, v92
    v_mul_f32 v81, v93, v93
    v_mul_f32 v82, v94, v94
    v_mul_f32 v83, v95, v95
    v_fma_f32 v80, v80, v70, v69
    v_fma_f32 v81, v81, v70, v69
    v_fma_f32 v82, v82, v70, v69
    v_fma_f32 v83, v83, v70, v69
    s_add_u32 m0, s81, 133120
    s_mov_b32 s78, 256
    s_mov_b64 exec, 0xffffffff
    buffer_load_dwordx4 v3, s[36:39], s78 offen sc1 lds
    s_mov_b64 exec, -1
    v_mul_f32 v80, v80, v92
    v_mul_f32 v81, v81, v93
    v_mul_f32 v82, v82, v94
    v_mul_f32 v83, v83, v95
    v_exp_f32 v80, v80
    v_mul_f32 v92, v92, v108
    v_exp_f32 v81, v81
    s_add_u32 m0, s33, 16384
    s_mov_b32 s76, 786432
    buffer_load_dwordx4 v23, s[40:43], s76 offen offset:0 lds
    s_add_u32 m0, s33, 18432
    s_nop 0
    buffer_load_dwordx4 v23, s[40:43], s76 offen offset:2048 lds
    v_mul_f32 v93, v93, v109
    v_exp_f32 v82, v82
    v_mul_f32 v94, v94, v110
    v_exp_f32 v83, v83
    v_mul_f32 v95, v95, v111
    v_fma_f32 v80, v80, v71, v71
    s_add_u32 m0, s33, 24576
    s_nop 0
    buffer_load_dwordx4 v23, s[44:47], s76 offen offset:0 lds
    v_fma_f32 v81, v81, v71, v71
    v_fma_f32 v82, v82, v71, v71
    v_fma_f32 v83, v83, v71, v71
    v_rcp_f32 v80, v80
    v_rcp_f32 v81, v81
    v_rcp_f32 v82, v82
    s_add_u32 m0, s33, 28672
    s_mov_b32 s77, 917504
    buffer_load_dwordx4 v22, s[48:51], s77 offen offset:0 lds
    v_rcp_f32 v83, v83
    s_nop 0
    v_mul_f32 v92, v92, v80
    v_mul_f32 v93, v93, v81
    v_mul_f32 v94, v94, v82
    v_mul_f32 v95, v95, v83
    v_cvt_pk_bf16_f32 v90, v92, v93
    v_cvt_pk_bf16_f32 v91, v94, v95
    s_add_u32 m0, s33, 32768
    s_nop 0
    buffer_load_dwordx4 v22, s[52:55], s77 offen offset:0 lds
    s_add_u32 s99, s99, 0x380100
    s_load_dword s94, s[16:17], s99 offset:0x0
    s_load_dword s94, s[16:17], s99 offset:0x40
    s_load_dword s94, s[16:17], s99 offset:0x80
    s_load_dword s94, s[16:17], s99 offset:0xc0
    v_mov_b32 v5, 0
    s_mov_b64 exec, 1
    global_load_dwordx2 v[6:7], v5, s[24:25] sc1
    s_mov_b64 exec, -1
    s_barrier
    s_add_u32 m0, s79, 135168
    s_mov_b32 s78, 384
    buffer_load_dwordx4 v20, s[36:39], s78 offen sc1 lds
    s_nop 1
    v_permlane16_swap_b32 v88, v90
    v_permlane16_swap_b32 v89, v91
    v_fmac_f32 v96, v24, v72
    v_fmac_f32 v97, v25, v72
    v_fmac_f32 v98, v26, v72
    v_fmac_f32 v99, v27, v72
    v_fmac_f32 v112, v28, v72
    v_fmac_f32 v113, v29, v72
    v_fmac_f32 v114, v30, v72
    v_fmac_f32 v115, v31, v72
    s_add_u32 m0, s79, 136192
    s_nop 0
    buffer_load_dwordx4 v21, s[36:39], s78 offen sc1 lds
    v_mul_f32 v80, v96, v96
    v_mul_f32 v81, v97, v97
    v_mul_f32 v82, v98, v98
    v_mul_f32 v83, v99, v99
    v_fma_f32 v80, v80, v74, v73
    v_fma_f32 v81, v81, v74, v73
    v_fma_f32 v82, v82, v74, v73
    v_fma_f32 v83, v83, v74, v73
    s_add_u32 m0, s33, 36864
    s_mov_b32 s76, 983040
    buffer_load_dwordx4 v23, s[40:43], s76 offen offset:0 lds
    v_mul_f32 v80, v80, v96
    v_mul_f32 v81, v81, v97
    v_mul_f32 v82, v82, v98
    v_mul_f32 v83, v83, v99
    v_exp_f32 v80, v80
    v_mul_f32 v96, v96, v112
    v_exp_f32 v81, v81
    s_add_u32 m0, s33, 38912
    s_nop 0
    buffer_load_dwordx4 v23, s[40:43], s76 offen offset:2048 lds
    s_add_u32 m0, s33, 45056
    s_nop 0
    buffer_load_dwordx4 v23, s[44:47], s76 offen offset:0 lds
    v_mul_f32 v97, v97, v113
    v_exp_f32 v82, v82
    v_mul_f32 v98, v98, v114
    v_exp_f32 v83, v83
    v_mul_f32 v99, v99, v115
    v_fma_f32 v80, v80, v75, v75
    s_add_u32 m0, s33, 49152
    s_mov_b32 s77, 1146880
    buffer_load_dwordx4 v22, s[48:51], s77 offen offset:0 lds
    v_fma_f32 v81, v81, v75, v75
    v_fma_f32 v82, v82, v75, v75
    v_fma_f32 v83, v83, v75, v75
    v_rcp_f32 v80, v80
    v_rcp_f32 v81, v81
    v_rcp_f32 v82, v82
    s_add_u32 m0, s33, 53248
    s_nop 0
    buffer_load_dwordx4 v22, s[52:55], s77 offen offset:0 lds
    v_rcp_f32 v83, v83
    s_nop 0
    v_mul_f32 v96, v96, v80
    v_mul_f32 v97, v97, v81
    v_mul_f32 v98, v98, v82
    v_mul_f32 v99, v99, v83
    v_cvt_pk_bf16_f32 v96, v96, v97
    v_cvt_pk_bf16_f32 v97, v98, v99
    buffer_store_dwordx4 v[88:91], v19, s[68:71], s72 offen offset:0 sc1
    s_add_u32 s99, s99, 0xffffff00
    s_load_dword s94, s[18:19], s99 offset:0x0
    s_load_dword s94, s[18:19], s99 offset:0x40
    s_load_dword s94, s[18:19], s99 offset:0x80
    s_load_dword s94, s[18:19], s99 offset:0xc0
    s_waitcnt vmcnt(17)
    s_barrier
    s_add_u32 m0, s79, 137216
    s_mov_b32 s78, 33152
    buffer_load_dwordx4 v20, s[36:39], s78 offen sc1 lds
    v_fmac_f32 v100, v24, v76
    v_fmac_f32 v101, v25, v76
    v_fmac_f32 v102, v26, v76
    v_fmac_f32 v103, v27, v76
    v_fmac_f32 v116, v28, v76
    v_fmac_f32 v117, v29, v76
    v_fmac_f32 v118, v30, v76
    v_fmac_f32 v119, v31, v76
    s_add_u32 m0, s79, 138240
    s_nop 0
    buffer_load_dwordx4 v21, s[36:39], s78 offen sc1 lds
    v_mul_f32 v80, v100, v100
    v_mul_f32 v81, v101, v101
    v_mul_f32 v82, v102, v102
    v_mul_f32 v83, v103, v103
    v_fma_f32 v80, v80, v78, v77
    v_fma_f32 v81, v81, v78, v77
    v_fma_f32 v82, v82, v78, v77
    v_fma_f32 v83, v83, v78, v77
    s_add_u32 m0, s81, 151552
    s_mov_b32 s78, 384
    s_mov_b64 exec, 0xffffffff
    buffer_load_dwordx4 v3, s[36:39], s78 offen sc1 lds
    s_mov_b64 exec, -1
    v_mul_f32 v80, v80, v100
    v_mul_f32 v81, v81, v101
    v_mul_f32 v82, v82, v102
    v_mul_f32 v83, v83, v103
    v_exp_f32 v80, v80
    v_mul_f32 v100, v100, v116
    v_exp_f32 v81, v81
    s_add_u32 m0, s33, 57344
    s_mov_b32 s76, 1179648
    buffer_load_dwordx4 v23, s[40:43], s76 offen offset:0 lds
    s_add_u32 m0, s33, 59392
    s_nop 0
    buffer_load_dwordx4 v23, s[40:43], s76 offen offset:2048 lds
    v_mul_f32 v101, v101, v117
    v_exp_f32 v82, v82
    v_mul_f32 v102, v102, v118
    v_exp_f32 v83, v83
    v_mul_f32 v103, v103, v119
    v_fma_f32 v80, v80, v79, v79
    s_add_u32 m0, s33, 65536
    s_nop 0
    buffer_load_dwordx4 v23, s[44:47], s76 offen offset:0 lds
    v_fma_f32 v81, v81, v79, v79
    v_fma_f32 v82, v82, v79, v79
    v_fma_f32 v83, v83, v79, v79
    v_rcp_f32 v80, v80
    v_rcp_f32 v81, v81
    v_rcp_f32 v82, v82
    s_add_u32 m0, s33, 69632
    s_mov_b32 s77, 1376256
    buffer_load_dwordx4 v22, s[48:51], s77 offen offset:0 lds
    v_rcp_f32 v83, v83
    s_nop 0
    v_mul_f32 v100, v100, v80
    v_mul_f32 v101, v101, v81
    v_mul_f32 v102, v102, v82
    v_mul_f32 v103, v103, v83
    v_cvt_pk_bf16_f32 v98, v100, v101
    v_cvt_pk_bf16_f32 v99, v102, v103
    s_add_u32 m0, s33, 73728
    s_nop 0
    buffer_load_dwordx4 v22, s[52:55], s77 offen offset:0 lds
    s_load_dword s94, s[18:19], s99 offset:0x100
    s_load_dword s94, s[18:19], s99 offset:0x140
    s_load_dword s94, s[18:19], s99 offset:0x180
    s_load_dword s94, s[18:19], s99 offset:0x1c0
    s_waitcnt vmcnt(17)
    s_barrier
    s_add_u32 m0, s79, 98304
    s_mov_b32 s78, 512
    buffer_load_dwordx4 v20, s[36:39], s78 offen sc1 lds
    s_nop 1
    v_permlane16_swap_b32 v96, v98
    v_permlane16_swap_b32 v97, v99
    v_fmac_f32 v120, v32, v64
    v_fmac_f32 v121, v33, v64
    v_fmac_f32 v122, v34, v64
    v_fmac_f32 v123, v35, v64
    v_fmac_f32 v136, v36, v64
    v_fmac_f32 v137, v37, v64
    v_fmac_f32 v138, v38, v64
    v_fmac_f32 v139, v39, v64
    s_add_u32 m0, s79, 99328
    s_nop 0
    buffer_load_dwordx4 v21, s[36:39], s78 offen sc1 lds
    v_mul_f32 v80, v120, v120
    v_mul_f32 v81, v121, v121
    v_mul_f32 v82, v122, v122
    v_mul_f32 v83, v123, v123
    v_fma_f32 v80, v80, v66, v65
    v_fma_f32 v81, v81, v66, v65
    v_fma_f32 v82, v82, v66, v65
    v_fma_f32 v83, v83, v66, v65
    s_add_u32 m0, s33, 77824
    s_mov_b32 s76, 1376256
    buffer_load_dwordx4 v23, s[40:43], s76 offen offset:0 lds
    v_mul_f32 v80, v80, v120
    v_mul_f32 v81, v81, v121
    v_mul_f32 v82, v82, v122
    v_mul_f32 v83, v83, v123
    v_exp_f32 v80, v80
    v_mul_f32 v120, v120, v136
    v_exp_f32 v81, v81
    s_add_u32 m0, s33, 79872
    s_nop 0
    buffer_load_dwordx4 v23, s[40:43], s76 offen offset:2048 lds
    s_add_u32 m0, s33, 86016
    s_nop 0
    buffer_load_dwordx4 v23, s[44:47], s76 offen offset:0 lds
    v_mul_f32 v121, v121, v137
    v_exp_f32 v82, v82
    v_mul_f32 v122, v122, v138
    v_exp_f32 v83, v83
    v_mul_f32 v123, v123, v139
    v_fma_f32 v80, v80, v67, v67
    s_add_u32 m0, s33, 90112
    s_mov_b32 s77, 1605632
    buffer_load_dwordx4 v22, s[48:51], s77 offen offset:0 lds
    v_fma_f32 v81, v81, v67, v67
    v_fma_f32 v82, v82, v67, v67
    v_fma_f32 v83, v83, v67, v67
    v_rcp_f32 v80, v80
    v_rcp_f32 v81, v81
    v_rcp_f32 v82, v82
    s_add_u32 m0, s33, 94208
    s_nop 0
    buffer_load_dwordx4 v22, s[52:55], s77 offen offset:0 lds
    v_rcp_f32 v83, v83
    s_nop 0
    v_mul_f32 v120, v120, v80
    v_mul_f32 v121, v121, v81
    v_mul_f32 v122, v122, v82
    v_mul_f32 v123, v123, v83
    v_cvt_pk_bf16_f32 v120, v120, v121
    v_cvt_pk_bf16_f32 v121, v122, v123
    buffer_store_dwordx4 v[96:99], v19, s[68:71], s72 offen offset:2048 sc1
    s_add_u32 s75, s75, 0x380000
    s_load_dword s94, s[10:11], s75 offset:0x0
    s_load_dword s94, s[10:11], s75 offset:0x40
    s_load_dword s94, s[10:11], s75 offset:0x80
    s_load_dword s94, s[10:11], s75 offset:0xc0
    s_waitcnt vmcnt(17)
    s_barrier
    s_add_u32 m0, s79, 100352
    s_mov_b32 s78, 33280
    buffer_load_dwordx4 v20, s[36:39], s78 offen sc1 lds
    v_fmac_f32 v124, v32, v68
    v_fmac_f32 v125, v33, v68
    v_fmac_f32 v126, v34, v68
    v_fmac_f32 v127, v35, v68
    v_fmac_f32 v140, v36, v68
    v_fmac_f32 v141, v37, v68
    v_fmac_f32 v142, v38, v68
    v_fmac_f32 v143, v39, v68
    s_add_u32 m0, s79, 101376
    s_nop 0
    buffer_load_dwordx4 v21, s[36:39], s78 offen sc1 lds
    v_mul_f32 v80, v124, v124
    v_mul_f32 v81, v125, v125
    v_mul_f32 v82, v126, v126
    v_mul_f32 v83, v127, v127
    v_fma_f32 v80, v80, v70, v69
    v_fma_f32 v81, v81, v70, v69
    v_fma_f32 v82, v82, v70, v69
    v_fma_f32 v83, v83, v70, v69
    s_add_u32 m0, s81, 114688
    s_mov_b32 s78, 512
    s_mov_b64 exec, 0xffffffff
    buffer_load_dwordx4 v3, s[36:39], s78 offen sc1 lds
    s_mov_b64 exec, -1
    v_mul_f32 v80, v80, v124
    v_mul_f32 v81, v81, v125
    v_mul_f32 v82, v82, v126
    v_mul_f32 v83, v83, v127
    v_exp_f32 v80, v80
    v_mul_f32 v124, v124, v140
    v_exp_f32 v81, v81
    s_add_u32 m0, s33, 16384
    s_mov_b32 s76, 1572864
    buffer_load_dwordx4 v23, s[40:43], s76 offen offset:0 lds
    s_add_u32 m0, s33, 18432
    s_nop 0
    buffer_load_dwordx4 v23, s[40:43], s76 offen offset:2048 lds
    v_mul_f32 v125, v125, v141
    v_exp_f32 v82, v82
    v_mul_f32 v126, v126, v142
    v_exp_f32 v83, v83
    v_mul_f32 v127, v127, v143
    v_fma_f32 v80, v80, v71, v71
    s_add_u32 m0, s33, 24576
    s_nop 0
    buffer_load_dwordx4 v23, s[44:47], s76 offen offset:0 lds
    v_fma_f32 v81, v81, v71, v71
    v_fma_f32 v82, v82, v71, v71
    v_fma_f32 v83, v83, v71, v71
    v_rcp_f32 v80, v80
    v_rcp_f32 v81, v81
    v_rcp_f32 v82, v82
    s_add_u32 m0, s33, 28672
    s_mov_b32 s77, 1835008
    buffer_load_dwordx4 v22, s[48:51], s77 offen offset:0 lds
    v_rcp_f32 v83, v83
    s_nop 0
    v_mul_f32 v124, v124, v80
    v_mul_f32 v125, v125, v81
    v_mul_f32 v126, v126, v82
    v_mul_f32 v127, v127, v83
    v_cvt_pk_bf16_f32 v122, v124, v125
    v_cvt_pk_bf16_f32 v123, v126, v127
    s_add_u32 m0, s33, 32768
    s_nop 0
    buffer_load_dwordx4 v22, s[52:55], s77 offen offset:0 lds
    s_load_dword s94, s[10:11], s75 offset:0x100
    s_load_dword s94, s[10:11], s75 offset:0x140
    s_load_dword s94, s[10:11], s75 offset:0x180
    s_load_dword s94, s[10:11], s75 offset:0x1c0
    s_waitcnt vmcnt(16)
    s_barrier
    s_add_u32 m0, s79, 116736
    s_mov_b32 s78, 640
    buffer_load_dwordx4 v20, s[36:39], s78 offen sc1 lds
    s_nop 1
    v_permlane16_swap_b32 v120, v122
    v_permlane16_swap_b32 v121, v123
    v_fmac_f32 v128, v32, v72
    v_fmac_f32 v129, v33, v72
    v_fmac_f32 v130, v34, v72
    v_fmac_f32 v131, v35, v72
    v_fmac_f32 v144, v36, v72
    v_fmac_f32 v145, v37, v72
    v_fmac_f32 v146, v38, v72
    v_fmac_f32 v147, v39, v72
    s_add_u32 m0, s79, 117760
    s_nop 0
    buffer_load_dwordx4 v21, s[36:39], s78 offen sc1 lds
    v_mul_f32 v80, v128, v128
    v_mul_f32 v81, v129, v129
    v_mul_f32 v82, v130, v130
    v_mul_f32 v83, v131, v131
    v_fma_f32 v80, v80, v74, v73
    v_fma_f32 v81, v81, v74, v73
    v_fma_f32 v82, v82, v74, v73
    v_fma_f32 v83, v83, v74, v73
    s_add_u32 m0, s33, 36864
    s_mov_b32 s76, 1769472
    buffer_load_dwordx4 v23, s[40:43], s76 offen offset:0 lds
    v_mul_f32 v80, v80, v128
    v_mul_f32 v81, v81, v129
    v_mul_f32 v82, v82, v130
    v_mul_f32 v83, v83, v131
    v_exp_f32 v80, v80
    v_mul_f32 v128, v128, v144
    v_exp_f32 v81, v81
    s_add_u32 m0, s33, 38912
    s_nop 0
    buffer_load_dwordx4 v23, s[40:43], s76 offen offset:2048 lds
    s_add_u32 m0, s33, 45056
    s_nop 0
    buffer_load_dwordx4 v23, s[44:47], s76 offen offset:0 lds
    v_mul_f32 v129, v129, v145
    v_exp_f32 v82, v82
    v_mul_f32 v130, v130, v146
    v_exp_f32 v83, v83
    v_mul_f32 v131, v131, v147
    v_fma_f32 v80, v80, v75, v75
    s_add_u32 m0, s33, 49152
    s_mov_b32 s77, 2064384
    buffer_load_dwordx4 v22, s[48:51], s77 offen offset:0 lds
    v_fma_f32 v81, v81, v75, v75
    v_fma_f32 v82, v82, v75, v75
    v_fma_f32 v83, v83, v75, v75
    v_rcp_f32 v80, v80
    v_rcp_f32 v81, v81
    v_rcp_f32 v82, v82
    s_add_u32 m0, s33, 53248
    s_nop 0
    buffer_load_dwordx4 v22, s[52:55], s77 offen offset:0 lds
    v_rcp_f32 v83, v83
    s_nop 0
    v_mul_f32 v128, v128, v80
    v_mul_f32 v129, v129, v81
    v_mul_f32 v130, v130, v82
    v_mul_f32 v131, v131, v83
    v_cvt_pk_bf16_f32 v128, v128, v129
    v_cvt_pk_bf16_f32 v129, v130, v131
    buffer_store_dwordx4 v[120:123], v19, s[68:71], s72 offen offset:512 sc1
    s_load_dword s94, s[10:11], s75 offset:0x80000
    s_load_dword s94, s[10:11], s75 offset:0x80040
    s_load_dword s94, s[10:11], s75 offset:0x80080
    s_load_dword s94, s[10:11], s75 offset:0x800c0
    s_waitcnt vmcnt(17)
    s_barrier
    s_add_u32 m0, s79, 118784
    s_mov_b32 s78, 33408
    buffer_load_dwordx4 v20, s[36:39], s78 offen sc1 lds
    v_fmac_f32 v132, v32, v76
    v_fmac_f32 v133, v33, v76
    v_fmac_f32 v134, v34, v76
    v_fmac_f32 v135, v35, v76
    v_fmac_f32 v148, v36, v76
    v_fmac_f32 v149, v37, v76
    v_fmac_f32 v150, v38, v76
    v_fmac_f32 v151, v39, v76
    s_add_u32 m0, s79, 119808
    s_nop 0
    buffer_load_dwordx4 v21, s[36:39], s78 offen sc1 lds
    v_mul_f32 v80, v132, v132
    v_mul_f32 v81, v133, v133
    v_mul_f32 v82, v134, v134
    v_mul_f32 v83, v135, v135
    v_fma_f32 v80, v80, v78, v77
    v_fma_f32 v81, v81, v78, v77
    v_fma_f32 v82, v82, v78, v77
    v_fma_f32 v83, v83, v78, v77
    s_add_u32 m0, s81, 133120
    s_mov_b32 s78, 640
    s_mov_b64 exec, 0xffffffff
    buffer_load_dwordx4 v3, s[36:39], s78 offen sc1 lds
    s_mov_b64 exec, -1
    v_mul_f32 v80, v80, v132
    v_mul_f32 v81, v81, v133
    v_mul_f32 v82, v82, v134
    v_mul_f32 v83, v83, v135
    v_exp_f32 v80, v80
    v_mul_f32 v132, v132, v148
    v_exp_f32 v81, v81
    s_add_u32 m0, s33, 57344
    s_mov_b32 s76, 1966080
    buffer_load_dwordx4 v23, s[40:43], s76 offen offset:0 lds
    s_add_u32 m0, s33, 59392
    s_nop 0
    buffer_load_dwordx4 v23, s[40:43], s76 offen offset:2048 lds
    v_mul_f32 v133, v133, v149
    v_exp_f32 v82, v82
    v_mul_f32 v134, v134, v150
    v_exp_f32 v83, v83
    v_mul_f32 v135, v135, v151
    v_fma_f32 v80, v80, v79, v79
    s_add_u32 m0, s33, 65536
    s_nop 0
    buffer_load_dwordx4 v23, s[44:47], s76 offen offset:0 lds
    v_fma_f32 v81, v81, v79, v79
    v_fma_f32 v82, v82, v79, v79
    v_fma_f32 v83, v83, v79, v79
    v_rcp_f32 v80, v80
    v_rcp_f32 v81, v81
    v_rcp_f32 v82, v82
    s_add_u32 m0, s33, 69632
    s_mov_b32 s77, 2293760
    buffer_load_dwordx4 v22, s[48:51], s77 offen offset:0 lds
    v_rcp_f32 v83, v83
    s_nop 0
    v_mul_f32 v132, v132, v80
    v_mul_f32 v133, v133, v81
    v_mul_f32 v134, v134, v82
    v_mul_f32 v135, v135, v83
    v_cvt_pk_bf16_f32 v130, v132, v133
    v_cvt_pk_bf16_f32 v131, v134, v135
    s_add_u32 m0, s33, 73728
    s_nop 0
    buffer_load_dwordx4 v22, s[52:55], s77 offen offset:0 lds
    s_load_dword s94, s[10:11], s75 offset:0x80100
    s_load_dword s94, s[10:11], s75 offset:0x80140
    s_load_dword s94, s[10:11], s75 offset:0x80180
    s_load_dword s94, s[10:11], s75 offset:0x801c0
    s_waitcnt vmcnt(16)
    s_barrier
    s_add_u32 m0, s79, 135168
    s_mov_b32 s78, 768
    buffer_load_dwordx4 v20, s[36:39], s78 offen sc1 lds
    s_nop 1
    v_permlane16_swap_b32 v128, v130
    v_permlane16_swap_b32 v129, v131
    v_fmac_f32 v152, v40, v64
    v_fmac_f32 v153, v41, v64
    v_fmac_f32 v154, v42, v64
    v_fmac_f32 v155, v43, v64
    v_fmac_f32 v168, v44, v64
    v_fmac_f32 v169, v45, v64
    v_fmac_f32 v170, v46, v64
    v_fmac_f32 v171, v47, v64
    s_add_u32 m0, s79, 136192
    s_nop 0
    buffer_load_dwordx4 v21, s[36:39], s78 offen sc1 lds
    v_mul_f32 v80, v152, v152
    v_mul_f32 v81, v153, v153
    v_mul_f32 v82, v154, v154
    v_mul_f32 v83, v155, v155
    v_fma_f32 v80, v80, v66, v65
    v_fma_f32 v81, v81, v66, v65
    v_fma_f32 v82, v82, v66, v65
    v_fma_f32 v83, v83, v66, v65
    s_add_u32 m0, s33, 77824
    s_mov_b32 s76, 2162688
    buffer_load_dwordx4 v23, s[40:43], s76 offen offset:0 lds
    v_mul_f32 v80, v80, v152
    v_mul_f32 v81, v81, v153
    v_mul_f32 v82, v82, v154
    v_mul_f32 v83, v83, v155
    v_exp_f32 v80, v80
    v_mul_f32 v152, v152, v168
    v_exp_f32 v81, v81
    s_add_u32 m0, s33, 79872
    s_nop 0
    buffer_load_dwordx4 v23, s[40:43], s76 offen offset:2048 lds
    s_add_u32 m0, s33, 86016
    s_nop 0
    buffer_load_dwordx4 v23, s[44:47], s76 offen offset:0 lds
    v_mul_f32 v153, v153, v169
    v_exp_f32 v82, v82
    v_mul_f32 v154, v154, v170
    v_exp_f32 v83, v83
    v_mul_f32 v155, v155, v171
    v_fma_f32 v80, v80, v67, v67
    s_add_u32 m0, s33, 90112
    s_mov_b32 s77, 2523136
    buffer_load_dwordx4 v22, s[48:51], s77 offen offset:0 lds
    v_fma_f32 v81, v81, v67, v67
    v_fma_f32 v82, v82, v67, v67
    v_fma_f32 v83, v83, v67, v67
    v_rcp_f32 v80, v80
    v_rcp_f32 v81, v81
    v_rcp_f32 v82, v82
    s_add_u32 m0, s33, 94208
    s_nop 0
    buffer_load_dwordx4 v22, s[52:55], s77 offen offset:0 lds
    v_rcp_f32 v83, v83
    s_nop 0
    v_mul_f32 v152, v152, v80
    v_mul_f32 v153, v153, v81
    v_mul_f32 v154, v154, v82
    v_mul_f32 v155, v155, v83
    v_cvt_pk_bf16_f32 v152, v152, v153
    v_cvt_pk_bf16_f32 v153, v154, v155
    buffer_store_dwordx4 v[128:131], v19, s[68:71], s72 offen offset:2560 sc1
    s_add_u32 s75, s75, 0x100000
    s_load_dword s94, s[10:11], s75 offset:0x0
    s_load_dword s94, s[10:11], s75 offset:0x40
    s_load_dword s94, s[10:11], s75 offset:0x80
    s_load_dword s94, s[10:11], s75 offset:0xc0
    s_waitcnt vmcnt(56)
    s_movk_i32 s98, 0x4000
L_tokA_chk:
    v_readfirstlane_b32 s100, v6
    v_readfirstlane_b32 s101, v7
    s_nop 1
    s_cmp_lg_u32 s100, 0
    s_cbranch_scc1 L_tokA_ok
    s_sub_u32 s98, s98, 1
    s_cbranch_scc1 L_tokA_ok
    s_sleep 1
    global_load_dwordx2 v[6:7], v5, s[24:25] sc1
    s_waitcnt vmcnt(0)
    s_branch L_tokA_chk
L_tokA_ok:
    s_waitcnt vmcnt(17)
    s_barrier
    s_add_u32 m0, s79, 137216
    s_mov_b32 s78, 33536
    buffer_load_dwordx4 v20, s[36:39], s78 offen sc1 lds
    v_fmac_f32 v156, v40, v68
    v_fmac_f32 v157, v41, v68
    v_fmac_f32 v158, v42, v68
    v_fmac_f32 v159, v43, v68
    v_fmac_f32 v172, v44, v68
    v_fmac_f32 v173, v45, v68
    v_fmac_f32 v174, v46, v68
    v_fmac_f32 v175, v47, v68
    s_add_u32 m0, s79, 138240
    s_nop 0
    buffer_load_dwordx4 v21, s[36:39], s78 offen sc1 lds
    v_mul_f32 v80, v156, v156
    v_mul_f32 v81, v157, v157
    v_mul_f32 v82, v158, v158
    v_mul_f32 v83, v159, v159
    v_fma_f32 v80, v80, v70, v69
    v_fma_f32 v81, v81, v70, v69
    v_fma_f32 v82, v82, v70, v69
    v_fma_f32 v83, v83, v70, v69
    s_add_u32 m0, s81, 151552
    s_mov_b32 s78, 768
    s_mov_b64 exec, 0xffffffff
    buffer_load_dwordx4 v3, s[36:39], s78 offen sc1 lds
    s_mov_b64 exec, -1
    v_mul_f32 v80, v80, v156
    v_mul_f32 v81, v81, v157
    v_mul_f32 v82, v82, v158
    v_mul_f32 v83, v83, v159
    v_exp_f32 v80, v80
    v_mul_f32 v156, v156, v172
    v_exp_f32 v81, v81
    s_add_u32 m0, s33, 16384
    s_mov_b32 s76, 2359296
    buffer_load_dwordx4 v23, s[40:43], s76 offen offset:0 lds
    s_add_u32 m0, s33, 18432
    s_nop 0
    buffer_load_dwordx4 v23, s[40:43], s76 offen offset:2048 lds
    v_mul_f32 v157, v157, v173
    v_exp_f32 v82, v82
    v_mul_f32 v158, v158, v174
    v_exp_f32 v83, v83
    v_mul_f32 v159, v159, v175
    v_fma_f32 v80, v80, v71, v71
    s_add_u32 m0, s33, 24576
    s_nop 0
    buffer_load_dwordx4 v23, s[44:47], s76 offen offset:0 lds
    v_fma_f32 v81, v81, v71, v71
    v_fma_f32 v82, v82, v71, v71
    v_fma_f32 v83, v83, v71, v71
    v_rcp_f32 v80, v80
    v_rcp_f32 v81, v81
    v_rcp_f32 v82, v82
    s_add_u32 m0, s33, 28672
    s_mov_b32 s77, 2752512
    buffer_load_dwordx4 v22, s[48:51], s77 offen offset:0 lds
    v_rcp_f32 v83, v83
    s_nop 0
    v_mul_f32 v156, v156, v80
    v_mul_f32 v157, v157, v81
    v_mul_f32 v158, v158, v82
    v_mul_f32 v159, v159, v83
    v_cvt_pk_bf16_f32 v154, v156, v157
    v_cvt_pk_bf16_f32 v155, v158, v159
    s_add_u32 m0, s33, 32768
    s_nop 0
    buffer_load_dwordx4 v22, s[52:55], s77 offen offset:0 lds
    s_load_dword s94, s[10:11], s75 offset:0x100
    s_load_dword s94, s[10:11], s75 offset:0x140
    s_load_dword s94, s[10:11], s75 offset:0x180
    s_load_dword s94, s[10:11], s75 offset:0x1c0
    s_waitcnt vmcnt(16)
    s_barrier
    s_add_u32 m0, s79, 98304
    s_mov_b32 s78, 896
    buffer_load_dwordx4 v20, s[36:39], s78 offen sc1 lds
    s_nop 1
    v_permlane16_swap_b32 v152, v154
    v_permlane16_swap_b32 v153, v155
    v_fmac_f32 v160, v40, v72
    v_fmac_f32 v161, v41, v72
    v_fmac_f32 v162, v42, v72
    v_fmac_f32 v163, v43, v72
    v_fmac_f32 v176, v44, v72
    v_fmac_f32 v177, v45, v72
    v_fmac_f32 v178, v46, v72
    v_fmac_f32 v179, v47, v72
    s_add_u32 m0, s79, 99328
    s_nop 0
    buffer_load_dwordx4 v21, s[36:39], s78 offen sc1 lds
    v_mul_f32 v80, v160, v160
    v_mul_f32 v81, v161, v161
    v_mul_f32 v82, v162, v162
    v_mul_f32 v83, v163, v163
    v_fma_f32 v80, v80, v74, v73
    v_fma_f32 v81, v81, v74, v73
    v_fma_f32 v82, v82, v74, v73
    v_fma_f32 v83, v83, v74, v73
    s_add_u32 m0, s33, 36864
    s_mov_b32 s76, 2555904
    buffer_load_dwordx4 v23, s[40:43], s76 offen offset:0 lds
    v_mul_f32 v80, v80, v160
    v_mul_f32 v81, v81, v161
    v_mul_f32 v82, v82, v162
    v_mul_f32 v83, v83, v163
    v_exp_f32 v80, v80
    v_mul_f32 v160, v160, v176
    v_exp_f32 v81, v81
    s_add_u32 m0, s33, 38912
    s_nop 0
    buffer_load_dwordx4 v23, s[40:43], s76 offen offset:2048 lds
    s_add_u32 m0, s33, 45056
    s_nop 0
    buffer_load_dwordx4 v23, s[44:47], s76 offen offset:0 lds
    v_mul_f32 v161, v161, v177
    v_exp_f32 v82, v82
    v_mul_f32 v162, v162, v178
    v_exp_f32 v83, v83
    v_mul_f32 v163, v163, v179
    v_fma_f32 v80, v80, v75, v75
    s_add_u32 m0, s33, 49152
    s_mov_b32 s77, 2981888
    buffer_load_dwordx4 v22, s[48:51], s77 offen offset:0 lds
    v_fma_f32 v81, v81, v75, v75
    v_fma_f32 v82, v82, v75, v75
    v_fma_f32 v83, v83, v75, v75
    v_rcp_f32 v80, v80
    v_rcp_f32 v81, v81
    v_rcp_f32 v82, v82
    s_add_u32 m0, s33, 53248
    s_nop 0
    buffer_load_dwordx4 v22, s[52:55], s77 offen offset:0 lds
    v_rcp_f32 v83, v83
    s_nop 0
    v_mul_f32 v160, v160, v80
    v_mul_f32 v161, v161, v81
    v_mul_f32 v162, v162, v82
    v_mul_f32 v163, v163, v83
    v_cvt_pk_bf16_f32 v160, v160, v161
    v_cvt_pk_bf16_f32 v161, v162, v163
    buffer_store_dwordx4 v[152:155], v19, s[68:71], s73 offen offset:0 sc1
    s_add_u32 s99, s99, 0x1c0000
    s_load_dword s94, s[16:17], s99 offset:0x0
    s_load_dword s94, s[16:17], s99 offset:0x40
    s_load_dword s94, s[16:17], s99 offset:0x80
    s_load_dword s94, s[16:17], s99 offset:0xc0
    s_waitcnt vmcnt(17)
    s_barrier
    s_add_u32 m0, s79, 100352
    s_mov_b32 s78, 33664
    buffer_load_dwordx4 v20, s[36:39], s78 offen sc1 lds
    v_fmac_f32 v164, v40, v76
    v_fmac_f32 v165, v41, v76
    v_fmac_f32 v166, v42, v76
    v_fmac_f32 v167, v43, v76
    v_fmac_f32 v180, v44, v76
    v_fmac_f32 v181, v45, v76
    v_fmac_f32 v182, v46, v76
    v_fmac_f32 v183, v47, v76
    s_add_u32 m0, s79, 101376
    s_nop 0
    buffer_load_dwordx4 v21, s[36:39], s78 offen sc1 lds
    v_mul_f32 v80, v164, v164
    v_mul_f32 v81, v165, v165
    v_mul_f32 v82, v166, v166
    v_mul_f32 v83, v167, v167
    v_fma_f32 v80, v80, v78, v77
    v_fma_f32 v81, v81, v78, v77
    v_fma_f32 v82, v82, v78, v77
    v_fma_f32 v83, v83, v78, v77
    s_add_u32 m0, s81, 114688
    s_mov_b32 s78, 896
    s_mov_b64 exec, 0xffffffff
    buffer_load_dwordx4 v3, s[36:39], s78 offen sc1 lds
    s_mov_b64 exec, -1
    v_mul_f32 v80, v80, v164
    v_mul_f32 v81, v81, v165
    v_mul_f32 v82, v82, v166
    v_mul_f32 v83, v83, v167
    v_exp_f32 v80, v80
    v_mul_f32 v164, v164, v180
    v_exp_f32 v81, v81
    s_add_u32 m0, s33, 57344
    s_mov_b32 s76, 2752512
    buffer_load_dwordx4 v23, s[40:43], s76 offen offset:0 lds
    s_add_u32 m0, s33, 59392
    s_nop 0
    buffer_load_dwordx4 v23, s[40:43], s76 offen offset:2048 lds
    v_mul_f32 v165, v165, v181
    v_exp_f32 v82, v82
    v_mul_f32 v166, v166, v182
    v_exp_f32 v83, v83
    v_mul_f32 v167, v167, v183
    v_fma_f32 v80, v80, v79, v79
    s_add_u32 m0, s33, 65536
    s_nop 0
    buffer_load_dwordx4 v23, s[44:47], s76 offen offset:0 lds
    v_fma_f32 v81, v81, v79, v79
    v_fma_f32 v82, v82, v79, v79
    v_fma_f32 v83, v83, v79, v79
    v_rcp_f32 v80, v80
    v_rcp_f32 v81, v81
    v_rcp_f32 v82, v82
    s_add_u32 m0, s33, 69632
    s_mov_b32 s77, 3211264
    buffer_load_dwordx4 v22, s[48:51], s77 offen offset:0 lds
    v_rcp_f32 v83, v83
    s_nop 0
    v_mul_f32 v164, v164, v80
    v_mul_f32 v165, v165, v81
    v_mul_f32 v166, v166, v82
    v_mul_f32 v167, v167, v83
    v_cvt_pk_bf16_f32 v162, v164, v165
    v_cvt_pk_bf16_f32 v163, v166, v167
    s_add_u32 m0, s33, 73728
    s_nop 0
    buffer_load_dwordx4 v22, s[52:55], s77 offen offset:0 lds
    s_load_dword s94, s[16:17], s99 offset:0x100
    s_load_dword s94, s[16:17], s99 offset:0x140
    s_load_dword s94, s[16:17], s99 offset:0x180
    s_load_dword s94, s[16:17], s99 offset:0x1c0
    s_waitcnt vmcnt(16)
    s_barrier
    s_add_u32 m0, s79, 116736
    s_mov_b32 s78, 1024
    buffer_load_dwordx4 v20, s[36:39], s78 offen sc1 lds
    s_nop 1
    v_permlane16_swap_b32 v160, v162
    v_permlane16_swap_b32 v161, v163
    v_fmac_f32 v184, v48, v64
    v_fmac_f32 v185, v49, v64
    v_fmac_f32 v186, v50, v64
    v_fmac_f32 v187, v51, v64
    v_fmac_f32 v200, v52, v64
    v_fmac_f32 v201, v53, v64
    v_fmac_f32 v202, v54, v64
    v_fmac_f32 v203, v55, v64
    s_add_u32 m0, s79, 117760
    s_nop 0
    buffer_load_dwordx4 v21, s[36:39], s78 offen sc1 lds
    v_mul_f32 v80, v184, v184
    v_mul_f32 v81, v185, v185
    v_mul_f32 v82, v186, v186
    v_mul_f32 v83, v187, v187
    v_fma_f32 v80, v80, v66, v65
    v_fma_f32 v81, v81, v66, v65
    v_fma_f32 v82, v82, v66, v65
    v_fma_f32 v83, v83, v66, v65
    s_add_u32 m0, s33, 77824
    s_mov_b32 s76, 2949120
    buffer_load_dwordx4 v23, s[40:43], s76 offen offset:0 lds
    v_mul_f32 v80, v80, v184
    v_mul_f32 v81, v81, v185
    v_mul_f32 v82, v82, v186
    v_mul_f32 v83, v83, v187
    v_exp_f32 v80, v80
    v_mul_f32 v184, v184, v200
    v_exp_f32 v81, v81
    s_add_u32 m0, s33, 79872
    s_nop 0
    buffer_load_dwordx4 v23, s[40:43], s76 offen offset:2048 lds
    s_add_u32 m0, s33, 86016
    s_nop 0
    buffer_load_dwordx4 v23, s[44:47], s76 offen offset:0 lds
    v_mul_f32 v185, v185, v201
    v_exp_f32 v82, v82
    v_mul_f32 v186, v186, v202
    v_exp_f32 v83, v83
    v_mul_f32 v187, v187, v203
    v_fma_f32 v80, v80, v67, v67
    s_add_u32 m0, s33, 90112
    s_mov_b32 s77, 3440640
    buffer_load_dwordx4 v22, s[48:51], s77 offen offset:0 lds
    v_fma_f32 v81, v81, v67, v67
    v_fma_f32 v82, v82, v67, v67
    v_fma_f32 v83, v83, v67, v67
    v_rcp_f32 v80, v80
    v_rcp_f32 v81, v81
    v_rcp_f32 v82, v82
    s_add_u32 m0, s33, 94208
    s_nop 0
    buffer_load_dwordx4 v22, s[52:55], s77 offen offset:0 lds
    v_rcp_f32 v83, v83
    s_nop 0
    v_mul_f32 v184, v184, v80
    v_mul_f32 v185, v185, v81
    v_mul_f32 v186, v186, v82
    v_mul_f32 v187, v187, v83
    v_cvt_pk_bf16_f32 v184, v184, v185
    v_cvt_pk_bf16_f32 v185, v186, v187
    buffer_store_dwordx4 v[160:163], v19, s[68:71], s73 offen offset:2048 sc1
    s_load_dword s94, s[18:19], s99 offset:0x0
    s_load_dword s94, s[18:19], s99 offset:0x40
    s_load_dword s94, s[18:19], s99 offset:0x80
    s_load_dword s94, s[18:19], s99 offset:0xc0
    s_waitcnt vmcnt(17)
    s_barrier
    s_add_u32 m0, s79, 118784
    s_mov_b32 s78, 33792
    buffer_load_dwordx4 v20, s[36:39], s78 offen sc1 lds
    v_fmac_f32 v188, v48, v68
    v_fmac_f32 v189, v49, v68
    v_fmac_f32 v190, v50, v68
    v_fmac_f32 v191, v51, v68
    v_fmac_f32 v204, v52, v68
    v_fmac_f32 v205, v53, v68
    v_fmac_f32 v206, v54, v68
    v_fmac_f32 v207, v55, v68
    s_add_u32 m0, s79, 119808
    s_nop 0
    buffer_load_dwordx4 v21, s[36:39], s78 offen sc1 lds
    v_mul_f32 v80, v188, v188
    v_mul_f32 v81, v189, v189
    v_mul_f32 v82, v190, v190
    v_mul_f32 v83, v191, v191
    v_fma_f32 v80, v80, v70, v69
    v_fma_f32 v81, v81, v70, v69
    v_fma_f32 v82, v82, v70, v69
    v_fma_f32 v83, v83, v70, v69
    s_add_u32 m0, s81, 133120
    s_mov_b32 s78, 1024
    s_mov_b64 exec, 0xffffffff
    buffer_load_dwordx4 v3, s[36:39], s78 offen sc1 lds
    s_mov_b64 exec, -1
    v_mul_f32 v80, v80, v188
    v_mul_f32 v81, v81, v189
    v_mul_f32 v82, v82, v190
    v_mul_f32 v83, v83, v191
    v_exp_f32 v80, v80
    v_mul_f32 v188, v188, v204
    v_exp_f32 v81, v81
    s_add_u32 m0, s33, 16384
    s_mov_b32 s76, 3145728
    buffer_load_dwordx4 v23, s[40:43], s76 offen offset:0 lds
    s_add_u32 m0, s33, 18432
    s_nop 0
    buffer_load_dwordx4 v23, s[40:43], s76 offen offset:2048 lds
    v_mul_f32 v189, v189, v205
    v_exp_f32 v82, v82
    v_mul_f32 v190, v190, v206
    v_exp_f32 v83, v83
    v_mul_f32 v191, v191, v207
    v_fma_f32 v80, v80, v71, v71
    s_add_u32 m0, s33, 24576
    s_nop 0
    buffer_load_dwordx4 v23, s[44:47], s76 offen offset:0 lds
    v_fma_f32 v81, v81, v71, v71
    v_fma_f32 v82, v82, v71, v71
    v_fma_f32 v83, v83, v71, v71
    v_rcp_f32 v80, v80
    v_rcp_f32 v81, v81
    v_rcp_f32 v82, v82
    s_add_u32 m0, s33, 28672
    s_mov_b32 s77, 3670016
    buffer_load_dwordx4 v22, s[48:51], s77 offen offset:0 lds
    v_rcp_f32 v83, v83
    s_nop 0
    v_mul_f32 v188, v188, v80
    v_mul_f32 v189, v189, v81
    v_mul_f32 v190, v190, v82
    v_mul_f32 v191, v191, v83
    v_cvt_pk_bf16_f32 v186, v188, v189
    v_cvt_pk_bf16_f32 v187, v190, v191
    s_add_u32 m0, s33, 32768
    s_nop 0
    buffer_load_dwordx4 v22, s[52:55], s77 offen offset:0 lds
    s_load_dword s94, s[18:19], s99 offset:0x100
    s_load_dword s94, s[18:19], s99 offset:0x140
    s_load_dword s94, s[18:19], s99 offset:0x180
    s_load_dword s94, s[18:19], s99 offset:0x1c0
    s_waitcnt vmcnt(16)
    s_barrier
    s_add_u32 m0, s79, 135168
    s_mov_b32 s78, 1152
    buffer_load_dwordx4 v20, s[36:39], s78 offen sc1 lds
    s_nop 1
    v_permlane16_swap_b32 v184, v186
    v_permlane16_swap_b32 v185, v187
    v_fmac_f32 v192, v48, v72
    v_fmac_f32 v193, v49, v72
    v_fmac_f32 v194, v50, v72
    v_fmac_f32 v195, v51, v72
    v_fmac_f32 v208, v52, v72
    v_fmac_f32 v209, v53, v72
    v_fmac_f32 v210, v54, v72
    v_fmac_f32 v211, v55, v72
    s_add_u32 m0, s79, 136192
    s_nop 0
    buffer_load_dwordx4 v21, s[36:39], s78 offen sc1 lds
    v_mul_f32 v80, v192, v192
    v_mul_f32 v81, v193, v193
    v_mul_f32 v82, v194, v194
    v_mul_f32 v83, v195, v195
    v_fma_f32 v80, v80, v74, v73
    v_fma_f32 v81, v81, v74, v73
    v_fma_f32 v82, v82, v74, v73
    v_fma_f32 v83, v83, v74, v73
    s_add_u32 m0, s33, 36864
    s_mov_b32 s76, 3342336
    buffer_load_dwordx4 v23, s[40:43], s76 offen offset:0 lds
    v_mul_f32 v80, v80, v192
    v_mul_f32 v81, v81, v193
    v_mul_f32 v82, v82, v194
    v_mul_f32 v83, v83, v195
    v_exp_f32 v80, v80
    v_mul_f32 v192, v192, v208
    v_exp_f32 v81, v81
    s_add_u32 m0, s33, 38912
    s_nop 0
    buffer_load_dwordx4 v23, s[40:43], s76 offen offset:2048 lds
    s_add_u32 m0, s33, 45056
    s_nop 0
    buffer_load_dwordx4 v23, s[44:47], s76 offen offset:0 lds
    v_mul_f32 v193, v193, v209
    v_exp_f32 v82, v82
    v_mul_f32 v194, v194, v210
    v_exp_f32 v83, v83
    v_mul_f32 v195, v195, v211
    v_fma_f32 v80, v80, v75, v75
    s_add_u32 m0, s33, 49152
    s_mov_b32 s77, 3899392
    buffer_load_dwordx4 v22, s[48:51], s77 offen offset:0 lds
    v_fma_f32 v81, v81, v75, v75
    v_fma_f32 v82, v82, v75, v75
    v_fma_f32 v83, v83, v75, v75
    v_rcp_f32 v80, v80
    v_rcp_f32 v81, v81
    v_rcp_f32 v82, v82
    s_add_u32 m0, s33, 53248
    s_nop 0
    buffer_load_dwordx4 v22, s[52:55], s77 offen offset:0 lds
    v_rcp_f32 v83, v83
    s_nop 0
    v_mul_f32 v192, v192, v80
    v_mul_f32 v193, v193, v81
    v_mul_f32 v194, v194, v82
    v_mul_f32 v195, v195, v83
    v_cvt_pk_bf16_f32 v192, v192, v193
    v_cvt_pk_bf16_f32 v193, v194, v195
    buffer_store_dwordx4 v[184:187], v19, s[68:71], s73 offen offset:512 sc1
    s_load_dword s94, s[10:11], s75 offset:0x80000
    s_load_dword s94, s[10:11], s75 offset:0x80040
    s_load_dword s94, s[10:11], s75 offset:0x80080
    s_load_dword s94, s[10:11], s75 offset:0x800c0
    s_waitcnt vmcnt(17)
    s_barrier
    s_add_u32 m0, s79, 137216
    s_mov_b32 s78, 33920
    buffer_load_dwordx4 v20, s[36:39], s78 offen sc1 lds
    v_fmac_f32 v196, v48, v76
    v_fmac_f32 v197, v49, v76
    v_fmac_f32 v198, v50, v76
    v_fmac_f32 v199, v51, v76
    v_fmac_f32 v212, v52, v76
    v_fmac_f32 v213, v53, v76
    v_fmac_f32 v214, v54, v76
    v_fmac_f32 v215, v55, v76
    s_add_u32 m0, s79, 138240
    s_nop 0
    buffer_load_dwordx4 v21, s[36:39], s78 offen sc1 lds
    v_mul_f32 v80, v196, v196
    v_mul_f32 v81, v197, v197
    v_mul_f32 v82, v198, v198
    v_mul_f32 v83, v199, v199
    v_fma_f32 v80, v80, v78, v77
    v_fma_f32 v81, v81, v78, v77
    v_fma_f32 v82, v82, v78, v77
    v_fma_f32 v83, v83, v78, v77
    s_add_u32 m0, s81, 151552
    s_mov_b32 s78, 1152
    s_mov_b64 exec, 0xffffffff
    buffer_load_dwordx4 v3, s[36:39], s78 offen sc1 lds
    s_mov_b64 exec, -1
    v_mul_f32 v80, v80, v196
    v_mul_f32 v81, v81, v197
    v_mul_f32 v82, v82, v198
    v_mul_f32 v83, v83, v199
    v_exp_f32 v80, v80
    v_mul_f32 v196, v196, v212
    v_exp_f32 v81, v81
    s_add_u32 m0, s33, 57344
    s_mov_b32 s76, 3538944
    buffer_load_dwordx4 v23, s[40:43], s76 offen offset:0 lds
    s_add_u32 m0, s33, 59392
    s_nop 0
    buffer_load_dwordx4 v23, s[40:43], s76 offen offset:2048 lds
    v_mul_f32 v197, v197, v213
    v_exp_f32 v82, v82
    v_mul_f32 v198, v198, v214
    v_exp_f32 v83, v83
    v_mul_f32 v199, v199, v215
    v_fma_f32 v80, v80, v79, v79
    s_add_u32 m0, s33, 65536
    s_nop 0
    buffer_load_dwordx4 v23, s[44:47], s76 offen offset:0 lds
    v_fma_f32 v81, v81, v79, v79
    v_fma_f32 v82, v82, v79, v79
    v_fma_f32 v83, v83, v79, v79
    v_rcp_f32 v80, v80
    v_rcp_f32 v81, v81
    v_rcp_f32 v82, v82
    s_add_u32 m0, s33, 69632
    s_mov_b32 s77, 4128768
    buffer_load_dwordx4 v22, s[48:51], s77 offen offset:0 lds
    v_rcp_f32 v83, v83
    s_nop 0
    v_mul_f32 v196, v196, v80
    v_mul_f32 v197, v197, v81
    v_mul_f32 v198, v198, v82
    v_mul_f32 v199, v199, v83
    v_cvt_pk_bf16_f32 v194, v196, v197
    v_cvt_pk_bf16_f32 v195, v198, v199
    s_add_u32 m0, s33, 73728
    s_nop 0
    buffer_load_dwordx4 v22, s[52:55], s77 offen offset:0 lds
    s_load_dword s94, s[10:11], s75 offset:0x80100
    s_load_dword s94, s[10:11], s75 offset:0x80140
    s_load_dword s94, s[10:11], s75 offset:0x80180
    s_load_dword s94, s[10:11], s75 offset:0x801c0
    s_waitcnt vmcnt(16)
    s_barrier
    s_add_u32 m0, s79, 98304
    s_mov_b32 s78, 1280
    buffer_load_dwordx4 v20, s[36:39], s78 offen sc1 lds
    s_nop 1
    v_permlane16_swap_b32 v192, v194
    v_permlane16_swap_b32 v193, v195
    v_fmac_f32 v216, v56, v64
    v_fmac_f32 v217, v57, v64
    v_fmac_f32 v218, v58, v64
    v_fmac_f32 v219, v59, v64
    v_fmac_f32 v232, v60, v64
    v_fmac_f32 v233, v61, v64
    v_fmac_f32 v234, v62, v64
    v_fmac_f32 v235, v63, v64
    s_add_u32 m0, s79, 99328
    s_nop 0
    buffer_load_dwordx4 v21, s[36:39], s78 offen sc1 lds
    v_mul_f32 v80, v216, v216
    v_mul_f32 v81, v217, v217
    v_mul_f32 v82, v218, v218
    v_mul_f32 v83, v219, v219
    v_fma_f32 v80, v80, v66, v65
    v_fma_f32 v81, v81, v66, v65
    v_fma_f32 v82, v82, v66, v65
    v_fma_f32 v83, v83, v66, v65
    s_add_u32 m0, s33, 77824
    s_mov_b32 s76, 3735552
    buffer_load_dwordx4 v23, s[40:43], s76 offen offset:0 lds
    v_mul_f32 v80, v80, v216
    v_mul_f32 v81, v81, v217
    v_mul_f32 v82, v82, v218
    v_mul_f32 v83, v83, v219
    v_exp_f32 v80, v80
    v_mul_f32 v216, v216, v232
    v_exp_f32 v81, v81
    s_add_u32 m0, s33, 79872
    s_nop 0
    buffer_load_dwordx4 v23, s[40:43], s76 offen offset:2048 lds
    s_add_u32 m0, s33, 86016
    s_nop 0
    buffer_load_dwordx4 v23, s[44:47], s76 offen offset:0 lds
    v_mul_f32 v217, v217, v233
    v_exp_f32 v82, v82
    v_mul_f32 v218, v218, v234
    v_exp_f32 v83, v83
    v_mul_f32 v219, v219, v235
    v_fma_f32 v80, v80, v67, v67
    s_add_u32 m0, s33, 90112
    s_mov_b32 s77, 4358144
    buffer_load_dwordx4 v22, s[48:51], s77 offen offset:0 lds
    v_fma_f32 v81, v81, v67, v67
    v_fma_f32 v82, v82, v67, v67
    v_fma_f32 v83, v83, v67, v67
    v_rcp_f32 v80, v80
    v_rcp_f32 v81, v81
    v_rcp_f32 v82, v82
    s_add_u32 m0, s33, 94208
    s_nop 0
    buffer_load_dwordx4 v22, s[52:55], s77 offen offset:0 lds
    v_rcp_f32 v83, v83
    s_nop 0
    v_mul_f32 v216, v216, v80
    v_mul_f32 v217, v217, v81
    v_mul_f32 v218, v218, v82
    v_mul_f32 v219, v219, v83
    v_cvt_pk_bf16_f32 v216, v216, v217
    v_cvt_pk_bf16_f32 v217, v218, v219
    buffer_store_dwordx4 v[192:195], v19, s[68:71], s73 offen offset:2560 sc1
    s_add_u32 s75, s75, 0x100000
    s_load_dword s94, s[10:11], s75 offset:0x0
    s_load_dword s94, s[10:11], s75 offset:0x40
    s_load_dword s94, s[10:11], s75 offset:0x80
    s_load_dword s94, s[10:11], s75 offset:0xc0
    s_waitcnt vmcnt(17)
    s_barrier
    s_add_u32 m0, s79, 100352
    s_mov_b32 s78, 34048
    buffer_load_dwordx4 v20, s[36:39], s78 offen sc1 lds
    v_fmac_f32 v220, v56, v68
    v_fmac_f32 v221, v57, v68
    v_fmac_f32 v222, v58, v68
    v_fmac_f32 v223, v59, v68
    v_fmac_f32 v236, v60, v68
    v_fmac_f32 v237, v61, v68
    v_fmac_f32 v238, v62, v68
    v_fmac_f32 v239, v63, v68
    s_add_u32 m0, s79, 101376
    s_nop 0
    buffer_load_dwordx4 v21, s[36:39], s78 offen sc1 lds
    v_mul_f32 v80, v220, v220
    v_mul_f32 v81, v221, v221
    v_mul_f32 v82, v222, v222
    v_mul_f32 v83, v223, v223
    v_fma_f32 v80, v80, v70, v69
    v_fma_f32 v81, v81, v70, v69
    v_fma_f32 v82, v82, v70, v69
    v_fma_f32 v83, v83, v70, v69
    s_add_u32 m0, s81, 114688
    s_mov_b32 s78, 1280
    s_mov_b64 exec, 0xffffffff
    buffer_load_dwordx4 v3, s[36:39], s78 offen sc1 lds
    s_mov_b64 exec, -1
    v_mul_f32 v80, v80, v220
    v_mul_f32 v81, v81, v221
    v_mul_f32 v82, v82, v222
    v_mul_f32 v83, v83, v223
    v_exp_f32 v80, v80
    v_mul_f32 v220, v220, v236
    v_exp_f32 v81, v81
    s_add_u32 m0, s33, 16384
    s_mov_b32 s76, 3932160
    buffer_load_dwordx4 v23, s[40:43], s76 offen offset:0 lds
    s_add_u32 m0, s33, 18432
    s_nop 0
    buffer_load_dwordx4 v23, s[40:43], s76 offen offset:2048 lds
    v_mul_f32 v221, v221, v237
    v_exp_f32 v82, v82
    v_mul_f32 v222, v222, v238
    v_exp_f32 v83, v83
    v_mul_f32 v223, v223, v239
    v_fma_f32 v80, v80, v71, v71
    s_add_u32 m0, s33, 24576
    s_nop 0
    buffer_load_dwordx4 v23, s[44:47], s76 offen offset:0 lds
    v_fma_f32 v81, v81, v71, v71
    v_fma_f32 v82, v82, v71, v71
    v_fma_f32 v83, v83, v71, v71
    v_rcp_f32 v80, v80
    v_rcp_f32 v81, v81
    v_rcp_f32 v82, v82
    s_add_u32 m0, s33, 28672
    s_mov_b32 s77, 4587520
    buffer_load_dwordx4 v22, s[48:51], s77 offen offset:0 lds
    v_rcp_f32 v83, v83
    s_nop 0
    v_mul_f32 v220, v220, v80
    v_mul_f32 v221, v221, v81
    v_mul_f32 v222, v222, v82
    v_mul_f32 v223, v223, v83
    v_cvt_pk_bf16_f32 v218, v220, v221
    v_cvt_pk_bf16_f32 v219, v222, v223
    s_add_u32 m0, s33, 32768
    s_nop 0
    buffer_load_dwordx4 v22, s[52:55], s77 offen offset:0 lds
    s_load_dword s94, s[10:11], s75 offset:0x100
    s_load_dword s94, s[10:11], s75 offset:0x140
    s_load_dword s94, s[10:11], s75 offset:0x180
    s_load_dword s94, s[10:11], s75 offset:0x1c0
    s_waitcnt vmcnt(16)
    s_barrier
    s_add_u32 m0, s79, 116736
    s_mov_b32 s78, 1408
    buffer_load_dwordx4 v20, s[36:39], s78 offen sc1 lds
    s_nop 1
    v_permlane16_swap_b32 v216, v218
    v_permlane16_swap_b32 v217, v219
    v_fmac_f32 v224, v56, v72
    v_fmac_f32 v225, v57, v72
    v_fmac_f32 v226, v58, v72
    v_fmac_f32 v227, v59, v72
    v_fmac_f32 v240, v60, v72
    v_fmac_f32 v241, v61, v72
    v_fmac_f32 v242, v62, v72
    v_fmac_f32 v243, v63, v72
    s_add_u32 m0, s79, 117760
    s_nop 0
    buffer_load_dwordx4 v21, s[36:39], s78 offen sc1 lds
    v_mul_f32 v80, v224, v224
    v_mul_f32 v81, v225, v225
    v_mul_f32 v82, v226, v226
    v_mul_f32 v83, v227, v227
    v_fma_f32 v80, v80, v74, v73
    v_fma_f32 v81, v81, v74, v73
    v_fma_f32 v82, v82, v74, v73
    v_fma_f32 v83, v83, v74, v73
    s_add_u32 m0, s33, 36864
    s_mov_b32 s76, 4128768
    buffer_load_dwordx4 v23, s[40:43], s76 offen offset:0 lds
    v_mul_f32 v80, v80, v224
    v_mul_f32 v81, v81, v225
    v_mul_f32 v82, v82, v226
    v_mul_f32 v83, v83, v227
    v_exp_f32 v80, v80
    v_mul_f32 v224, v224, v240
    v_exp_f32 v81, v81
    s_add_u32 m0, s33, 38912
    s_nop 0
    buffer_load_dwordx4 v23, s[40:43], s76 offen offset:2048 lds
    s_add_u32 m0, s33, 45056
    s_nop 0
    buffer_load_dwordx4 v23, s[44:47], s76 offen offset:0 lds
    v_mul_f32 v225, v225, v241
    v_exp_f32 v82, v82
    v_mul_f32 v226, v226, v242
    v_exp_f32 v83, v83
    v_mul_f32 v227, v227, v243
    v_fma_f32 v80, v80, v75, v75
    s_add_u32 m0, s33, 49152
    s_mov_b32 s77, 4816896
    buffer_load_dwordx4 v22, s[48:51], s77 offen offset:0 lds
    v_fma_f32 v81, v81, v75, v75
    v_fma_f32 v82, v82, v75, v75
    v_fma_f32 v83, v83, v75, v75
    v_rcp_f32 v80, v80
    v_rcp_f32 v81, v81
    v_rcp_f32 v82, v82
    s_add_u32 m0, s33, 53248
    s_nop 0
    buffer_load_dwordx4 v22, s[52:55], s77 offen offset:0 lds
    v_rcp_f32 v83, v83
    s_nop 0
    v_mul_f32 v224, v224, v80
    v_mul_f32 v225, v225, v81
    v_mul_f32 v226, v226, v82
    v_mul_f32 v227, v227, v83
    v_cvt_pk_bf16_f32 v224, v224, v225
    v_cvt_pk_bf16_f32 v225, v226, v227
    buffer_store_dwordx4 v[216:219], v19, s[68:71], s74 offen offset:0 sc1
    s_add_u32 s75, s75, 0xffa80000
    s_load_dword s94, s[20:21], s75 offset:0x0
    s_load_dword s94, s[20:21], s75 offset:0x40
    s_load_dword s94, s[20:21], s75 offset:0x80
    s_load_dword s94, s[20:21], s75 offset:0xc0
    s_waitcnt vmcnt(17)
    s_barrier
    s_add_u32 m0, s79, 118784
    s_mov_b32 s78, 34176
    buffer_load_dwordx4 v20, s[36:39], s78 offen sc1 lds
    v_fmac_f32 v228, v56, v76
    v_fmac_f32 v229, v57, v76
    v_fmac_f32 v230, v58, v76
    v_fmac_f32 v231, v59, v76
    v_fmac_f32 v244, v60, v76
    v_fmac_f32 v245, v61, v76
    v_fmac_f32 v246, v62, v76
    v_fmac_f32 v247, v63, v76
    s_add_u32 m0, s79, 119808
    s_nop 0
    buffer_load_dwordx4 v21, s[36:39], s78 offen sc1 lds
    v_mul_f32 v80, v228, v228
    v_mul_f32 v81, v229, v229
    v_mul_f32 v82, v230, v230
    v_mul_f32 v83, v231, v231
    v_fma_f32 v80, v80, v78, v77
    v_fma_f32 v81, v81, v78, v77
    v_fma_f32 v82, v82, v78, v77
    v_fma_f32 v83, v83, v78, v77
    s_add_u32 m0, s81, 133120
    s_mov_b32 s78, 1408
    s_mov_b64 exec, 0xffffffff
    buffer_load_dwordx4 v3, s[36:39], s78 offen sc1 lds
    s_mov_b64 exec, -1
    v_mul_f32 v80, v80, v228
    v_mul_f32 v81, v81, v229
    v_mul_f32 v82, v82, v230
    v_mul_f32 v83, v83, v231
    v_exp_f32 v80, v80
    v_mul_f32 v228, v228, v244
    v_exp_f32 v81, v81
    s_add_u32 m0, s33, 57344
    s_mov_b32 s76, 4325376
    buffer_load_dwordx4 v23, s[40:43], s76 offen offset:0 lds
    s_add_u32 m0, s33, 59392
    s_nop 0
    buffer_load_dwordx4 v23, s[40:43], s76 offen offset:2048 lds
    v_mul_f32 v229, v229, v245
    v_exp_f32 v82, v82
    v_mul_f32 v230, v230, v246
    v_exp_f32 v83, v83
    v_mul_f32 v231, v231, v247
    v_fma_f32 v80, v80, v79, v79
    s_add_u32 m0, s33, 65536
    s_nop 0
    buffer_load_dwordx4 v23, s[44:47], s76 offen offset:0 lds
    v_fma_f32 v81, v81, v79, v79
    v_fma_f32 v82, v82, v79, v79
    v_fma_f32 v83, v83, v79, v79
    v_rcp_f32 v80, v80
    v_rcp_f32 v81, v81
    v_rcp_f32 v82, v82
    s_add_u32 m0, s33, 69632
    s_mov_b32 s77, 5046272
    buffer_load_dwordx4 v22, s[48:51], s77 offen offset:0 lds
    v_rcp_f32 v83, v83
    s_nop 0
    v_mul_f32 v228, v228, v80
    v_mul_f32 v229, v229, v81
    v_mul_f32 v230, v230, v82
    v_mul_f32 v231, v231, v83
    v_cvt_pk_bf16_f32 v226, v228, v229
    v_cvt_pk_bf16_f32 v227, v230, v231
    s_add_u32 m0, s33, 73728
    s_nop 0
    buffer_load_dwordx4 v22, s[52:55], s77 offen offset:0 lds
    s_load_dword s94, s[20:21], s75 offset:0x100
    s_load_dword s94, s[20:21], s75 offset:0x140
    s_load_dword s94, s[20:21], s75 offset:0x180
    s_load_dword s94, s[20:21], s75 offset:0x1c0
    s_waitcnt vmcnt(16)
    s_barrier
    s_add_u32 m0, s79, 135168
    s_mov_b32 s78, 1536
    buffer_load_dwordx4 v20, s[36:39], s78 offen sc1 lds
    s_nop 1
    v_permlane16_swap_b32 v224, v226
    v_permlane16_swap_b32 v225, v227
    s_add_u32 m0, s79, 136192
    s_nop 0
    buffer_load_dwordx4 v21, s[36:39], s78 offen sc1 lds
    s_add_u32 m0, s33, 77824
    s_mov_b32 s76, 4521984
    buffer_load_dwordx4 v23, s[40:43], s76 offen offset:0 lds
    s_add_u32 m0, s33, 79872
    s_nop 0
    buffer_load_dwordx4 v23, s[40:43], s76 offen offset:2048 lds
    s_add_u32 m0, s33, 86016
    s_nop 0
    buffer_load_dwordx4 v23, s[44:47], s76 offen offset:0 lds
    s_add_u32 m0, s33, 90112
    s_mov_b32 s77, 5275648
    buffer_load_dwordx4 v22, s[48:51], s77 offen offset:0 lds
    s_add_u32 m0, s33, 94208
    s_nop 0
    buffer_load_dwordx4 v22, s[52:55], s77 offen offset:0 lds
    buffer_store_dwordx4 v[224:227], v19, s[68:71], s74 offen offset:2048 sc1
    s_add_u32 s75, s75, 0x280000
    s_load_dword s94, s[20:21], s75 offset:0x0
    s_load_dword s94, s[20:21], s75 offset:0x40
    s_load_dword s94, s[20:21], s75 offset:0x80
    s_load_dword s94, s[20:21], s75 offset:0xc0
    s_waitcnt vmcnt(17)
    s_barrier
    s_add_u32 m0, s79, 137216
    s_mov_b32 s78, 34304
    buffer_load_dwordx4 v20, s[36:39], s78 offen sc1 lds
    s_add_u32 m0, s79, 138240
    s_nop 0
    buffer_load_dwordx4 v21, s[36:39], s78 offen sc1 lds
    s_add_u32 m0, s81, 151552
    s_mov_b32 s78, 1536
    s_mov_b64 exec, 0xffffffff
    buffer_load_dwordx4 v3, s[36:39], s78 offen sc1 lds
    s_mov_b64 exec, -1
    s_add_u32 m0, s33, 16384
    s_mov_b32 s76, 4718592
    buffer_load_dwordx4 v23, s[40:43], s76 offen offset:0 lds
    s_add_u32 m0, s33, 18432
    s_nop 0
    buffer_load_dwordx4 v23, s[40:43], s76 offen offset:2048 lds
    s_add_u32 m0, s33, 24576
    s_nop 0
    buffer_load_dwordx4 v23, s[44:47], s76 offen offset:0 lds
    s_add_u32 m0, s33, 28672
    s_mov_b32 s77, 5505024
    buffer_load_dwordx4 v22, s[48:51], s77 offen offset:0 lds
    s_add_u32 m0, s33, 32768
    s_nop 0
    buffer_load_dwordx4 v22, s[52:55], s77 offen offset:0 lds
    s_load_dword s94, s[20:21], s75 offset:0x100
    s_load_dword s94, s[20:21], s75 offset:0x140
    s_load_dword s94, s[20:21], s75 offset:0x180
    s_load_dword s94, s[20:21], s75 offset:0x1c0
    s_waitcnt vmcnt(16)
    s_barrier
    s_add_u32 m0, s79, 98304
    s_mov_b32 s78, 1664
    buffer_load_dwordx4 v20, s[36:39], s78 offen sc1 lds
    s_add_u32 m0, s79, 99328
    s_nop 0
    buffer_load_dwordx4 v21, s[36:39], s78 offen sc1 lds
    s_add_u32 m0, s33, 36864
    s_mov_b32 s76, 4915200
    buffer_load_dwordx4 v23, s[40:43], s76 offen offset:0 lds
    s_add_u32 m0, s33, 38912
    s_nop 0
    buffer_load_dwordx4 v23, s[40:43], s76 offen offset:2048 lds
    s_add_u32 m0, s33, 45056
    s_nop 0
    buffer_load_dwordx4 v23, s[44:47], s76 offen offset:0 lds
    s_add_u32 m0, s33, 49152
    s_mov_b32 s77, 5734400
    buffer_load_dwordx4 v22, s[48:51], s77 offen offset:0 lds
    s_add_u32 m0, s33, 53248
    s_nop 0
    buffer_load_dwordx4 v22, s[52:55], s77 offen offset:0 lds
    s_add_u32 s75, s75, 0xffe00000
    s_load_dword s94, s[20:21], s75 offset:0x0
    s_load_dword s94, s[20:21], s75 offset:0x40
    s_load_dword s94, s[20:21], s75 offset:0x80
    s_load_dword s94, s[20:21], s75 offset:0xc0
    s_waitcnt vmcnt(16)
    s_barrier
    s_add_u32 m0, s79, 100352
    s_mov_b32 s78, 34432
    buffer_load_dwordx4 v20, s[36:39], s78 offen sc1 lds
    s_add_u32 m0, s79, 101376
    s_nop 0
    buffer_load_dwordx4 v21, s[36:39], s78 offen sc1 lds
    s_add_u32 m0, s81, 114688
    s_mov_b32 s78, 1664
    s_mov_b64 exec, 0xffffffff
    buffer_load_dwordx4 v3, s[36:39], s78 offen sc1 lds
    s_mov_b64 exec, -1
    s_add_u32 m0, s33, 57344
    s_mov_b32 s76, 5111808
    buffer_load_dwordx4 v23, s[40:43], s76 offen offset:0 lds
    s_add_u32 m0, s33, 59392
    s_nop 0
    buffer_load_dwordx4 v23, s[40:43], s76 offen offset:2048 lds
    s_add_u32 m0, s33, 65536
    s_nop 0
    buffer_load_dwordx4 v23, s[44:47], s76 offen offset:0 lds
    s_add_u32 m0, s33, 69632
    s_mov_b32 s77, 5963776
    buffer_load_dwordx4 v22, s[48:51], s77 offen offset:0 lds
    s_add_u32 m0, s33, 73728
    s_nop 0
    buffer_load_dwordx4 v22, s[52:55], s77 offen offset:0 lds
    s_load_dword s94, s[20:21], s75 offset:0x100
    s_load_dword s94, s[20:21], s75 offset:0x140
    s_load_dword s94, s[20:21], s75 offset:0x180
    s_load_dword s94, s[20:21], s75 offset:0x1c0
    s_waitcnt vmcnt(23)
    s_waitcnt vmcnt(15)
    s_barrier
    s_add_u32 m0, s79, 116736
    s_mov_b32 s78, 1792
    buffer_load_dwordx4 v20, s[36:39], s78 offen sc1 lds
    s_add_u32 m0, s79, 117760
    s_nop 0
    buffer_load_dwordx4 v21, s[36:39], s78 offen sc1 lds
    s_add_u32 m0, s33, 77824
    s_mov_b32 s76, 5308416
    buffer_load_dwordx4 v23, s[40:43], s76 offen offset:0 lds
    s_add_u32 m0, s33, 79872
    s_nop 0
    buffer_load_dwordx4 v23, s[40:43], s76 offen offset:2048 lds
    s_add_u32 m0, s33, 86016
    s_nop 0
    buffer_load_dwordx4 v23, s[44:47], s76 offen offset:0 lds
    s_add_u32 m0, s33, 90112
    s_mov_b32 s77, 6193152
    buffer_load_dwordx4 v22, s[48:51], s77 offen offset:0 lds
    s_add_u32 m0, s33, 94208
    s_nop 0
    buffer_load_dwordx4 v22, s[52:55], s77 offen offset:0 lds
    s_add_u32 s75, s75, 0x280000
    s_load_dword s94, s[20:21], s75 offset:0x0
    s_load_dword s94, s[20:21], s75 offset:0x40
    s_load_dword s94, s[20:21], s75 offset:0x80
    s_load_dword s94, s[20:21], s75 offset:0xc0
    s_cmp_lg_u32 s4, 0
    s_cbranch_scc1 L_fH1
    s_lshl_b32 s91, s28, 4
    s_add_u32 s91, s91, s29
    s_lshl_b32 s91, s91, 7
    s_add_u32 s91, s91, 0x1e88000
    v_mov_b32 v12, s91
    v_mov_b32 v14, s100
    v_mov_b32 v15, s101
    s_mov_b64 exec, 1
    global_store_dwordx2 v12, v[14:15], s[26:27] sc1
    s_mov_b64 exec, -1
L_fH1:
    s_waitcnt vmcnt(15)
    s_barrier
    s_add_u32 m0, s79, 118784
    s_mov_b32 s78, 34560
    buffer_load_dwordx4 v20, s[36:39], s78 offen sc1 lds
    s_add_u32 m0, s79, 119808
    s_nop 0
    buffer_load_dwordx4 v21, s[36:39], s78 offen sc1 lds
    s_add_u32 m0, s81, 133120
    s_mov_b32 s78, 1792
    s_mov_b64 exec, 0xffffffff
    buffer_load_dwordx4 v3, s[36:39], s78 offen sc1 lds
    s_mov_b64 exec, -1
    s_add_u32 m0, s33, 16384
    s_mov_b32 s76, 5505024
    buffer_load_dwordx4 v23, s[40:43], s76 offen offset:0 lds
    s_add_u32 m0, s33, 18432
    s_nop 0
    buffer_load_dwordx4 v23, s[40:43], s76 offen offset:2048 lds
    s_add_u32 m0, s33, 24576
    s_nop 0
    buffer_load_dwordx4 v23, s[44:47], s76 offen offset:0 lds
    s_add_u32 m0, s33, 28672
    s_mov_b32 s77, 6422528
    buffer_load_dwordx4 v22, s[48:51], s77 offen offset:0 lds
    s_add_u32 m0, s33, 32768
    s_nop 0
    buffer_load_dwordx4 v22, s[52:55], s77 offen offset:0 lds
    s_load_dword s94, s[20:21], s75 offset:0x100
    s_load_dword s94, s[20:21], s75 offset:0x140
    s_load_dword s94, s[20:21], s75 offset:0x180
    s_load_dword s94, s[20:21], s75 offset:0x1c0
    s_waitcnt vmcnt(15)
    s_barrier
    s_add_u32 m0, s79, 135168
    s_mov_b32 s78, 1920
    buffer_load_dwordx4 v20, s[36:39], s78 offen sc1 lds
    s_add_u32 m0, s79, 136192
    s_nop 0
    buffer_load_dwordx4 v21, s[36:39], s78 offen sc1 lds
    s_add_u32 m0, s33, 36864
    s_mov_b32 s76, 5701632
    buffer_load_dwordx4 v23, s[40:43], s76 offen offset:0 lds
    s_add_u32 m0, s33, 38912
    s_nop 0
    buffer_load_dwordx4 v23, s[40:43], s76 offen offset:2048 lds
    s_add_u32 m0, s33, 45056
    s_nop 0
    buffer_load_dwordx4 v23, s[44:47], s76 offen offset:0 lds
    s_add_u32 m0, s33, 49152
    s_mov_b32 s77, 6651904
    buffer_load_dwordx4 v22, s[48:51], s77 offen offset:0 lds
    s_add_u32 m0, s33, 53248
    s_nop 0
    buffer_load_dwordx4 v22, s[52:55], s77 offen offset:0 lds
    s_add_u32 s75, s75, 0xffe00000
    s_load_dword s94, s[20:21], s75 offset:0x0
    s_load_dword s94, s[20:21], s75 offset:0x40
    s_load_dword s94, s[20:21], s75 offset:0x80
    s_load_dword s94, s[20:21], s75 offset:0xc0
    s_waitcnt vmcnt(15)
    s_barrier
    s_add_u32 m0, s79, 137216
    s_mov_b32 s78, 34688
    buffer_load_dwordx4 v20, s[36:39], s78 offen sc1 lds
    s_add_u32 m0, s79, 138240
    s_nop 0
    buffer_load_dwordx4 v21, s[36:39], s78 offen sc1 lds
    s_add_u32 m0, s81, 151552
    s_mov_b32 s78, 1920
    s_mov_b64 exec, 0xffffffff
    buffer_load_dwordx4 v3, s[36:39], s78 offen sc1 lds
    s_mov_b64 exec, -1
    s_add_u32 m0, s33, 57344
    s_mov_b32 s76, 5898240
    buffer_load_dwordx4 v23, s[40:43], s76 offen offset:0 lds
    s_add_u32 m0, s33, 59392
    s_nop 0
    buffer_load_dwordx4 v23, s[40:43], s76 offen offset:2048 lds
    s_add_u32 m0, s33, 65536
    s_nop 0
    buffer_load_dwordx4 v23, s[44:47], s76 offen offset:0 lds
    s_add_u32 m0, s33, 69632
    s_mov_b32 s77, 6881280
    buffer_load_dwordx4 v22, s[48:51], s77 offen offset:0 lds
    s_add_u32 m0, s33, 73728
    s_nop 0
    buffer_load_dwordx4 v22, s[52:55], s77 offen offset:0 lds
    s_load_dword s94, s[20:21], s75 offset:0x100
    s_load_dword s94, s[20:21], s75 offset:0x140
    s_load_dword s94, s[20:21], s75 offset:0x180
    s_load_dword s94, s[20:21], s75 offset:0x1c0
    s_lshl2_add_u32 s91, s30, s4
    s_lshl_b32 s91, s91, 9
    s_add_u32 s91, s91, 0x1e88000
    v_lshl_add_u32 v13, v1, 7, s91
    s_mov_b64 exec, 15
    global_load_dwordx2 v[14:15], v13, s[26:27] sc1
    s_mov_b64 exec, -1
    s_waitcnt vmcnt(16)
    s_barrier
    s_add_u32 m0, s33, 77824
    s_mov_b32 s76, 6094848
    buffer_load_dwordx4 v23, s[40:43], s76 offen offset:0 lds
    s_add_u32 m0, s33, 79872
    s_nop 0
    buffer_load_dwordx4 v23, s[40:43], s76 offen offset:2048 lds
    s_add_u32 m0, s33, 86016
    s_nop 0
    buffer_load_dwordx4 v23, s[44:47], s76 offen offset:0 lds
    s_add_u32 m0, s33, 90112
    s_mov_b32 s77, 7110656
    buffer_load_dwordx4 v22, s[48:51], s77 offen offset:0 lds
    s_add_u32 m0, s33, 94208
    s_nop 0
    buffer_load_dwordx4 v22, s[52:55], s77 offen offset:0 lds
    s_add_u32 s75, s75, 0x280000
    s_load_dword s94, s[20:21], s75 offset:0x0
    s_load_dword s94, s[20:21], s75 offset:0x40
    s_load_dword s94, s[20:21], s75 offset:0x80
    s_load_dword s94, s[20:21], s75 offset:0xc0
    s_waitcnt vmcnt(5)
    s_mov_b64 exec, 15
    s_movk_i32 s98, 0x4000
L_pH1_chk:
    v_cmp_ne_u64 vcc, s[100:101], v[14:15]
    s_nop 1
    s_cmp_eq_u64 vcc, 0
    s_cbranch_scc1 L_pH1_ok
    s_sub_u32 s98, s98, 1
    s_cbranch_scc1 L_pH1_ok
    s_sleep 1
    global_load_dwordx2 v[14:15], v13, s[26:27] sc1
    s_waitcnt vmcnt(0)
    s_branch L_pH1_chk
L_pH1_ok:
    s_mov_b64 exec, -1
    s_waitcnt vmcnt(14)
    s_barrier
    s_lshl_b32 m0, s33, 2
    s_nop 0
    buffer_load_dwordx4 v18, s[56:59], s82 offen offset:0 sc1 lds
    buffer_load_dwordx4 v18, s[56:59], s82 offen offset:1024 sc1 lds
    buffer_load_dwordx4 v18, s[56:59], s82 offen offset:2048 sc1 lds
    buffer_load_dwordx4 v18, s[56:59], s82 offen offset:3072 sc1 lds
    s_add_u32 s82, s82, 16384
    s_lshl1_add_u32 m0, s33, 16384
    s_nop 0
    buffer_load_dwordx4 v254, s[60:63], s83 offen lds
    s_lshl1_add_u32 m0, s33, 17408
    s_nop 0
    buffer_load_dwordx4 v255, s[60:63], s83 offen lds
    s_lshl1_add_u32 m0, s33, 24576
    s_nop 0
    buffer_load_dwordx4 v254, s[64:67], s83 offen lds
    s_lshl1_add_u32 m0, s33, 25600
    s_nop 0
    buffer_load_dwordx4 v255, s[64:67], s83 offen lds
    s_add_u32 s83, s83, 131072
    s_load_dword s94, s[20:21], s75 offset:0x100
    s_load_dword s94, s[20:21], s75 offset:0x140
    s_load_dword s94, s[20:21], s75 offset:0x180
    s_load_dword s94, s[20:21], s75 offset:0x1c0
    s_lshl_b32 s84, s2, 15
    s_lshl_b32 s85, s4, 13
    s_add_u32 s84, s84, s85
    s_add_u32 s36, s84, 0x1600000
    s_add_u32 s37, s36, 4096
    s_xor_b32 s84, s84, 32768
    s_add_u32 s38, s84, 0x1600000
    s_add_u32 s39, s38, 4096
    v_lshlrev_b32 v4, 4, v1
    s_lshl_b32 s84, s4, 12
    s_add_u32 s84, s84, 147456
    v_lshl_add_u32 v5, v1, 3, s84
    s_waitcnt vmcnt(14)
    s_barrier
    s_lshl2_add_u32 m0, s33, 98304
    s_nop 0
    buffer_load_dwordx4 v18, s[56:59], s82 offen offset:0 sc1 lds
    buffer_load_dwordx4 v18, s[56:59], s82 offen offset:1024 sc1 lds
    buffer_load_dwordx4 v18, s[56:59], s82 offen offset:2048 sc1 lds
    buffer_load_dwordx4 v18, s[56:59], s82 offen offset:3072 sc1 lds
    s_add_u32 s82, s82, 16384
    s_lshl1_add_u32 m0, s33, 114688
    s_nop 0
    buffer_load_dwordx4 v254, s[60:63], s83 offen lds
    s_lshl1_add_u32 m0, s33, 115712
    s_nop 0
    buffer_load_dwordx4 v255, s[60:63], s83 offen lds
    s_lshl1_add_u32 m0, s33, 122880
    s_nop 0
    buffer_load_dwordx4 v254, s[64:67], s83 offen lds
    s_lshl1_add_u32 m0, s33, 123904
    s_nop 0
    buffer_load_dwordx4 v255, s[64:67], s83 offen lds
    s_add_u32 s83, s83, 131072
    s_add_u32 s75, s75, 0xffe00000
    s_load_dword s94, s[20:21], s75 offset:0x0
    s_load_dword s94, s[20:21], s75 offset:0x40
    s_load_dword s94, s[20:21], s75 offset:0x80
    s_load_dword s94, s[20:21], s75 offset:0xc0
    s_waitcnt vmcnt(16)
    s_barrier
    s_lshl2_add_u32 m0, s33, 32768
    s_nop 0
    buffer_load_dwordx4 v18, s[56:59], s82 offen offset:0 sc1 lds
    buffer_load_dwordx4 v18, s[56:59], s82 offen offset:1024 sc1 lds
    buffer_load_dwordx4 v18, s[56:59], s82 offen offset:2048 sc1 lds
    buffer_load_dwordx4 v18, s[56:59], s82 offen offset:3072 sc1 lds
    s_add_u32 s82, s82, 16384
    s_lshl1_add_u32 m0, s33, 49152
    s_nop 0
    buffer_load_dwordx4 v254, s[60:63], s83 offen lds
    s_lshl1_add_u32 m0, s33, 50176
    s_nop 0
    buffer_load_dwordx4 v255, s[60:63], s83 offen lds
    s_lshl1_add_u32 m0, s33, 57344
    s_nop 0
    buffer_load_dwordx4 v254, s[64:67], s83 offen lds
    s_lshl1_add_u32 m0, s33, 58368
    s_nop 0
    buffer_load_dwordx4 v255, s[64:67], s83 offen lds
    s_add_u32 s83, s83, 131072
    s_waitcnt vmcnt(16)
    s_barrier
    s_setprio 1
    ds_read_b64_tr_b16 v[40:41], v250 offset:16384
    ds_read_b64_tr_b16 v[42:43], v250 offset:16896
    ds_read_b128 v[24:27], v248 offset:0
    ds_read_b128 v[28:31], v248 offset:1024
    ds_read_b128 v[32:35], v248 offset:2048
    ds_read_b128 v[36:39], v248 offset:3072
    ds_read_b64_tr_b16 v[44:45], v251 offset:16384
    ds_read_b64_tr_b16 v[46:47], v251 offset:16896
    ds_read_b64_tr_b16 v[48:49], v250 offset:24576
    ds_read_b64_tr_b16 v[50:51], v250 offset:25088
    ds_read_b64_tr_b16 v[52:53], v251 offset:24576
    ds_read_b64_tr_b16 v[54:55], v251 offset:25088
    s_lshl2_add_u32 m0, s33, 65536
    s_nop 0
    buffer_load_dwordx4 v18, s[56:59], s82 offen offset:0 sc1 lds
    buffer_load_dwordx4 v18, s[56:59], s82 offen offset:1024 sc1 lds
    buffer_load_dwordx4 v18, s[56:59], s82 offen offset:2048 sc1 lds
    buffer_load_dwordx4 v18, s[56:59], s82 offen offset:3072 sc1 lds
    s_add_u32 s82, s82, 16384
    s_waitcnt lgkmcnt(9)
    v_mfma_f32_16x16x32_bf16 v[88:91], v[40:43], v[24:27], 0
    ds_read_b64_tr_b16 v[72:73], v250 offset:20480
    ds_read_b64_tr_b16 v[74:75], v250 offset:20992
    s_waitcnt lgkmcnt(10)
    v_mfma_f32_16x16x32_bf16 v[92:95], v[40:43], v[28:31], 0
    ds_read_b128 v[56:59], v248 offset:8192
    s_lshl1_add_u32 m0, s33, 81920
    s_waitcnt lgkmcnt(10)
    v_mfma_f32_16x16x32_bf16 v[96:99], v[40:43], v[32:35], 0
    ds_read_b128 v[60:63], v248 offset:9216
    ds_read_b128 v[64:67], v248 offset:10240
    s_waitcnt lgkmcnt(11)
    v_mfma_f32_16x16x32_bf16 v[100:103], v[40:43], v[36:39], 0
    ds_read_b128 v[68:71], v248 offset:11264
    buffer_load_dwordx4 v254, s[60:63], s83 offen lds
    s_waitcnt lgkmcnt(10)
    v_mfma_f32_16x16x32_bf16 v[104:107], v[44:47], v[24:27], 0
    ds_read_b64_tr_b16 v[76:77], v251 offset:20480
    ds_read_b64_tr_b16 v[78:79], v251 offset:20992
    v_mfma_f32_16x16x32_bf16 v[108:111], v[44:47], v[28:31], 0
    ds_read_b64_tr_b16 v[80:81], v250 offset:28672
    s_lshl1_add_u32 m0, s33, 82944
    v_mfma_f32_16x16x32_bf16 v[112:115], v[44:47], v[32:35], 0
    ds_read_b64_tr_b16 v[82:83], v250 offset:29184
    ds_read_b64_tr_b16 v[84:85], v251 offset:28672
    v_mfma_f32_16x16x32_bf16 v[116:119], v[44:47], v[36:39], 0
    ds_read_b64_tr_b16 v[86:87], v251 offset:29184
    buffer_load_dwordx4 v255, s[60:63], s83 offen lds
    s_waitcnt lgkmcnt(14)
    v_mfma_f32_16x16x32_bf16 v[120:123], v[48:51], v[24:27], 0
    v_mfma_f32_16x16x32_bf16 v[124:127], v[48:51], v[28:31], 0
    s_lshl1_add_u32 m0, s33, 90112
    v_mfma_f32_16x16x32_bf16 v[128:131], v[48:51], v[32:35], 0
    v_mfma_f32_16x16x32_bf16 v[132:135], v[48:51], v[36:39], 0
    buffer_load_dwordx4 v254, s[64:67], s83 offen lds
    s_waitcnt lgkmcnt(12)
    v_mfma_f32_16x16x32_bf16 v[136:139], v[52:55], v[24:27], 0
    v_mfma_f32_16x16x32_bf16 v[140:143], v[52:55], v[28:31], 0
    s_lshl1_add_u32 m0, s33, 91136
    v_mfma_f32_16x16x32_bf16 v[144:147], v[52:55], v[32:35], 0
    v_mfma_f32_16x16x32_bf16 v[148:151], v[52:55], v[36:39], 0
    buffer_load_dwordx4 v255, s[64:67], s83 offen lds
    s_add_u32 s83, s83, 131072
    s_waitcnt vmcnt(16) lgkmcnt(0)
    s_barrier
    v_mfma_f32_16x16x32_bf16 v[88:91], v[72:75], v[56:59], v[88:91]
    ds_read_b64_tr_b16 v[40:41], v252 offset:49152
    ds_read_b64_tr_b16 v[42:43], v252 offset:49664
    v_mfma_f32_16x16x32_bf16 v[92:95], v[72:75], v[60:63], v[92:95]
    ds_read_b128 v[24:27], v249 offset:32768
    s_lshl_b32 m0, s33, 2
    v_mfma_f32_16x16x32_bf16 v[96:99], v[72:75], v[64:67], v[96:99]
    ds_read_b128 v[28:31], v249 offset:33792
    v_mfma_f32_16x16x32_bf16 v[100:103], v[72:75], v[68:71], v[100:103]
    ds_read_b128 v[32:35], v249 offset:34816
    buffer_load_dwordx4 v18, s[56:59], s82 offen offset:0 sc1 lds
    v_mfma_f32_16x16x32_bf16 v[104:107], v[76:79], v[56:59], v[104:107]
    ds_read_b128 v[36:39], v249 offset:35840
    v_mfma_f32_16x16x32_bf16 v[108:111], v[76:79], v[60:63], v[108:111]
    ds_read_b64_tr_b16 v[44:45], v253 offset:49152
    ds_read_b64_tr_b16 v[46:47], v253 offset:49664
    v_mfma_f32_16x16x32_bf16 v[112:115], v[76:79], v[64:67], v[112:115]
    ds_read_b64_tr_b16 v[48:49], v252 offset:57344
    v_mfma_f32_16x16x32_bf16 v[116:119], v[76:79], v[68:71], v[116:119]
    ds_read_b64_tr_b16 v[50:51], v252 offset:57856
    buffer_load_dwordx4 v18, s[56:59], s82 offen offset:1024 sc1 lds
    v_mfma_f32_16x16x32_bf16 v[120:123], v[80:83], v[56:59], v[120:123]
    ds_read_b64_tr_b16 v[52:53], v253 offset:57344
    v_mfma_f32_16x16x32_bf16 v[124:127], v[80:83], v[60:63], v[124:127]
    ds_read_b64_tr_b16 v[54:55], v253 offset:57856
    v_mfma_f32_16x16x32_bf16 v[128:131], v[80:83], v[64:67], v[128:131]
    v_mfma_f32_16x16x32_bf16 v[132:135], v[80:83], v[68:71], v[132:135]
    buffer_load_dwordx4 v18, s[56:59], s82 offen offset:2048 sc1 lds
    v_mfma_f32_16x16x32_bf16 v[136:139], v[84:87], v[56:59], v[136:139]
    v_mfma_f32_16x16x32_bf16 v[140:143], v[84:87], v[60:63], v[140:143]
    v_mfma_f32_16x16x32_bf16 v[144:147], v[84:87], v[64:67], v[144:147]
    v_mfma_f32_16x16x32_bf16 v[148:151], v[84:87], v[68:71], v[148:151]
    buffer_load_dwordx4 v18, s[56:59], s82 offen offset:3072 sc1 lds
    s_add_u32 s82, s82, 16384
    s_waitcnt lgkmcnt(9)
    v_mfma_f32_16x16x32_bf16 v[88:91], v[40:43], v[24:27], v[88:91]
    ds_read_b64_tr_b16 v[72:73], v252 offset:53248
    ds_read_b64_tr_b16 v[74:75], v252 offset:53760
    s_waitcnt lgkmcnt(10)
    v_mfma_f32_16x16x32_bf16 v[92:95], v[40:43], v[28:31], v[92:95]
    ds_read_b128 v[56:59], v249 offset:40960
    s_lshl1_add_u32 m0, s33, 16384
    s_waitcnt lgkmcnt(10)
    v_mfma_f32_16x16x32_bf16 v[96:99], v[40:43], v[32:35], v[96:99]
    ds_read_b128 v[60:63], v249 offset:41984
    ds_read_b128 v[64:67], v249 offset:43008
    s_waitcnt lgkmcnt(11)
    v_mfma_f32_16x16x32_bf16 v[100:103], v[40:43], v[36:39], v[100:103]
    ds_read_b128 v[68:71], v249 offset:44032
    buffer_load_dwordx4 v254, s[60:63], s83 offen lds
    s_waitcnt lgkmcnt(10)
    v_mfma_f32_16x16x32_bf16 v[104:107], v[44:47], v[24:27], v[104:107]
    ds_read_b64_tr_b16 v[76:77], v253 offset:53248
    ds_read_b64_tr_b16 v[78:79], v253 offset:53760
    v_mfma_f32_16x16x32_bf16 v[108:111], v[44:47], v[28:31], v[108:111]
    ds_read_b64_tr_b16 v[80:81], v252 offset:61440
    s_lshl1_add_u32 m0, s33, 17408
    v_mfma_f32_16x16x32_bf16 v[112:115], v[44:47], v[32:35], v[112:115]
    ds_read_b64_tr_b16 v[82:83], v252 offset:61952
    ds_read_b64_tr_b16 v[84:85], v253 offset:61440
    v_mfma_f32_16x16x32_bf16 v[116:119], v[44:47], v[36:39], v[116:119]
    ds_read_b64_tr_b16 v[86:87], v253 offset:61952
    buffer_load_dwordx4 v255, s[60:63], s83 offen lds
    s_waitcnt lgkmcnt(14)
    v_mfma_f32_16x16x32_bf16 v[120:123], v[48:51], v[24:27], v[120:123]
    v_mfma_f32_16x16x32_bf16 v[124:127], v[48:51], v[28:31], v[124:127]
    s_lshl1_add_u32 m0, s33, 24576
    v_mfma_f32_16x16x32_bf16 v[128:131], v[48:51], v[32:35], v[128:131]
    v_mfma_f32_16x16x32_bf16 v[132:135], v[48:51], v[36:39], v[132:135]
    buffer_load_dwordx4 v254, s[64:67], s83 offen lds
    s_waitcnt lgkmcnt(12)
    v_mfma_f32_16x16x32_bf16 v[136:139], v[52:55], v[24:27], v[136:139]
    v_mfma_f32_16x16x32_bf16 v[140:143], v[52:55], v[28:31], v[140:143]
    s_lshl1_add_u32 m0, s33, 25600
    v_mfma_f32_16x16x32_bf16 v[144:147], v[52:55], v[32:35], v[144:147]
    v_mfma_f32_16x16x32_bf16 v[148:151], v[52:55], v[36:39], v[148:151]
    buffer_load_dwordx4 v255, s[64:67], s83 offen lds
    s_add_u32 s83, s83, 131072
    s_waitcnt vmcnt(16) lgkmcnt(0)
    s_barrier
    v_mfma_f32_16x16x32_bf16 v[88:91], v[72:75], v[56:59], v[88:91]
    ds_read_b64_tr_b16 v[40:41], v250 offset:49152
    ds_read_b64_tr_b16 v[42:43], v250 offset:49664
    v_mfma_f32_16x16x32_bf16 v[92:95], v[72:75], v[60:63], v[92:95]
    ds_read_b128 v[24:27], v248 offset:32768
    s_lshl2_add_u32 m0, s33, 98304
    v_mfma_f32_16x16x32_bf16 v[96:99], v[72:75], v[64:67], v[96:99]
    ds_read_b128 v[28:31], v248 offset:33792
    v_mfma_f32_16x16x32_bf16 v[100:103], v[72:75], v[68:71], v[100:103]
    ds_read_b128 v[32:35], v248 offset:34816
    buffer_load_dwordx4 v18, s[56:59], s82 offen offset:0 sc1 lds
    v_mfma_f32_16x16x32_bf16 v[104:107], v[76:79], v[56:59], v[104:107]
    ds_read_b128 v[36:39], v248 offset:35840
    v_mfma_f32_16x16x32_bf16 v[108:111], v[76:79], v[60:63], v[108:111]
    ds_read_b64_tr_b16 v[44:45], v251 offset:49152
    ds_read_b64_tr_b16 v[46:47], v251 offset:49664
    v_mfma_f32_16x16x32_bf16 v[112:115], v[76:79], v[64:67], v[112:115]
    ds_read_b64_tr_b16 v[48:49], v250 offset:57344
    v_mfma_f32_16x16x32_bf16 v[116:119], v[76:79], v[68:71], v[116:119]
    ds_read_b64_tr_b16 v[50:51], v250 offset:57856
    buffer_load_dwordx4 v18, s[56:59], s82 offen offset:1024 sc1 lds
    v_mfma_f32_16x16x32_bf16 v[120:123], v[80:83], v[56:59], v[120:123]
    ds_read_b64_tr_b16 v[52:53], v251 offset:57344
    v_mfma_f32_16x16x32_bf16 v[124:127], v[80:83], v[60:63], v[124:127]
    ds_read_b64_tr_b16 v[54:55], v251 offset:57856
    v_mfma_f32_16x16x32_bf16 v[128:131], v[80:83], v[64:67], v[128:131]
    v_mfma_f32_16x16x32_bf16 v[132:135], v[80:83], v[68:71], v[132:135]
    buffer_load_dwordx4 v18, s[56:59], s82 offen offset:2048 sc1 lds
    v_mfma_f32_16x16x32_bf16 v[136:139], v[84:87], v[56:59], v[136:139]
    v_mfma_f32_16x16x32_bf16 v[140:143], v[84:87], v[60:63], v[140:143]
    v_mfma_f32_16x16x32_bf16 v[144:147], v[84:87], v[64:67], v[144:147]
    v_mfma_f32_16x16x32_bf16 v[148:151], v[84:87], v[68:71], v[148:151]
    buffer_load_dwordx4 v18, s[56:59], s82 offen offset:3072 sc1 lds
    s_add_u32 s82, s82, 16384
    s_waitcnt lgkmcnt(9)
    v_mfma_f32_16x16x32_bf16 v[88:91], v[40:43], v[24:27], v[88:91]
    ds_read_b64_tr_b16 v[72:73], v250 offset:53248
    ds_read_b64_tr_b16 v[74:75], v250 offset:53760
    s_waitcnt lgkmcnt(10)
    v_mfma_f32_16x16x32_bf16 v[92:95], v[40:43], v[28:31], v[92:95]
    ds_read_b128 v[56:59], v248 offset:40960
    s_lshl1_add_u32 m0, s33, 114688
    s_waitcnt lgkmcnt(10)
    v_mfma_f32_16x16x32_bf16 v[96:99], v[40:43], v[32:35], v[96:99]
    ds_read_b128 v[60:63], v248 offset:41984
    ds_read_b128 v[64:67], v248 offset:43008
    s_waitcnt lgkmcnt(11)
    v_mfma_f32_16x16x32_bf16 v[100:103], v[40:43], v[36:39], v[100:103]
    ds_read_b128 v[68:71], v248 offset:44032
    buffer_load_dwordx4 v254, s[60:63], s83 offen lds
    s_waitcnt lgkmcnt(10)
    v_mfma_f32_16x16x32_bf16 v[104:107], v[44:47], v[24:27], v[104:107]
    ds_read_b64_tr_b16 v[76:77], v251 offset:53248
    ds_read_b64_tr_b16 v[78:79], v251 offset:53760
    v_mfma_f32_16x16x32_bf16 v[108:111], v[44:47], v[28:31], v[108:111]
    ds_read_b64_tr_b16 v[80:81], v250 offset:61440
    s_lshl1_add_u32 m0, s33, 115712
    v_mfma_f32_16x16x32_bf16 v[112:115], v[44:47], v[32:35], v[112:115]
    ds_read_b64_tr_b16 v[82:83], v250 offset:61952
    ds_read_b64_tr_b16 v[84:85], v251 offset:61440
    v_mfma_f32_16x16x32_bf16 v[116:119], v[44:47], v[36:39], v[116:119]
    ds_read_b64_tr_b16 v[86:87], v251 offset:61952
    buffer_load_dwordx4 v255, s[60:63], s83 offen lds
    s_waitcnt lgkmcnt(14)
    v_mfma_f32_16x16x32_bf16 v[120:123], v[48:51], v[24:27], v[120:123]
    v_mfma_f32_16x16x32_bf16 v[124:127], v[48:51], v[28:31], v[124:127]
    s_lshl1_add_u32 m0, s33, 122880
    v_mfma_f32_16x16x32_bf16 v[128:131], v[48:51], v[32:35], v[128:131]
    v_mfma_f32_16x16x32_bf16 v[132:135], v[48:51], v[36:39], v[132:135]
    buffer_load_dwordx4 v254, s[64:67], s83 offen lds
    s_waitcnt lgkmcnt(12)
    v_mfma_f32_16x16x32_bf16 v[136:139], v[52:55], v[24:27], v[136:139]
    v_mfma_f32_16x16x32_bf16 v[140:143], v[52:55], v[28:31], v[140:143]
    s_lshl1_add_u32 m0, s33, 123904
    v_mfma_f32_16x16x32_bf16 v[144:147], v[52:55], v[32:35], v[144:147]
    v_mfma_f32_16x16x32_bf16 v[148:151], v[52:55], v[36:39], v[148:151]
    buffer_load_dwordx4 v255, s[64:67], s83 offen lds
    s_add_u32 s83, s83, 131072
    s_waitcnt vmcnt(16) lgkmcnt(0)
    s_barrier
    v_mfma_f32_16x16x32_bf16 v[88:91], v[72:75], v[56:59], v[88:91]
    ds_read_b64_tr_b16 v[40:41], v252 offset:16384
    ds_read_b64_tr_b16 v[42:43], v252 offset:16896
    v_mfma_f32_16x16x32_bf16 v[92:95], v[72:75], v[60:63], v[92:95]
    ds_read_b128 v[24:27], v249 offset:0
    s_lshl2_add_u32 m0, s33, 32768
    v_mfma_f32_16x16x32_bf16 v[96:99], v[72:75], v[64:67], v[96:99]
    ds_read_b128 v[28:31], v249 offset:1024
    v_mfma_f32_16x16x32_bf16 v[100:103], v[72:75], v[68:71], v[100:103]
    ds_read_b128 v[32:35], v249 offset:2048
    buffer_load_dwordx4 v18, s[56:59], s82 offen offset:0 sc1 lds
    v_mfma_f32_16x16x32_bf16 v[104:107], v[76:79], v[56:59], v[104:107]
    ds_read_b128 v[36:39], v249 offset:3072
    v_mfma_f32_16x16x32_bf16 v[108:111], v[76:79], v[60:63], v[108:111]
    ds_read_b64_tr_b16 v[44:45], v253 offset:16384
    ds_read_b64_tr_b16 v[46:47], v253 offset:16896
    v_mfma_f32_16x16x32_bf16 v[112:115], v[76:79], v[64:67], v[112:115]
    ds_read_b64_tr_b16 v[48:49], v252 offset:24576
    v_mfma_f32_16x16x32_bf16 v[116:119], v[76:79], v[68:71], v[116:119]
    ds_read_b64_tr_b16 v[50:51], v252 offset:25088
    buffer_load_dwordx4 v18, s[56:59], s82 offen offset:1024 sc1 lds
    v_mfma_f32_16x16x32_bf16 v[120:123], v[80:83], v[56:59], v[120:123]
    ds_read_b64_tr_b16 v[52:53], v253 offset:24576
    v_mfma_f32_16x16x32_bf16 v[124:127], v[80:83], v[60:63], v[124:127]
    ds_read_b64_tr_b16 v[54:55], v253 offset:25088
    v_mfma_f32_16x16x32_bf16 v[128:131], v[80:83], v[64:67], v[128:131]
    v_mfma_f32_16x16x32_bf16 v[132:135], v[80:83], v[68:71], v[132:135]
    buffer_load_dwordx4 v18, s[56:59], s82 offen offset:2048 sc1 lds
    v_mfma_f32_16x16x32_bf16 v[136:139], v[84:87], v[56:59], v[136:139]
    v_mfma_f32_16x16x32_bf16 v[140:143], v[84:87], v[60:63], v[140:143]
    v_mfma_f32_16x16x32_bf16 v[144:147], v[84:87], v[64:67], v[144:147]
    v_mfma_f32_16x16x32_bf16 v[148:151], v[84:87], v[68:71], v[148:151]
    buffer_load_dwordx4 v18, s[56:59], s82 offen offset:3072 sc1 lds
    s_add_u32 s82, s82, 16384
    s_waitcnt lgkmcnt(9)
    v_mfma_f32_16x16x32_bf16 v[88:91], v[40:43], v[24:27], v[88:91]
    ds_read_b64_tr_b16 v[72:73], v252 offset:20480
    ds_read_b64_tr_b16 v[74:75], v252 offset:20992
    s_waitcnt lgkmcnt(10)
    v_mfma_f32_16x16x32_bf16 v[92:95], v[40:43], v[28:31], v[92:95]
    ds_read_b128 v[56:59], v249 offset:8192
    s_lshl1_add_u32 m0, s33, 49152
    s_waitcnt lgkmcnt(10)
    v_mfma_f32_16x16x32_bf16 v[96:99], v[40:43], v[32:35], v[96:99]
    ds_read_b128 v[60:63], v249 offset:9216
    ds_read_b128 v[64:67], v249 offset:10240
    s_waitcnt lgkmcnt(11)
    v_mfma_f32_16x16x32_bf16 v[100:103], v[40:43], v[36:39], v[100:103]
    ds_read_b128 v[68:71], v249 offset:11264
    buffer_load_dwordx4 v254, s[60:63], s83 offen lds
    s_waitcnt lgkmcnt(10)
    v_mfma_f32_16x16x32_bf16 v[104:107], v[44:47], v[24:27], v[104:107]
    ds_read_b64_tr_b16 v[76:77], v253 offset:20480
    ds_read_b64_tr_b16 v[78:79], v253 offset:20992
    v_mfma_f32_16x16x32_bf16 v[108:111], v[44:47], v[28:31], v[108:111]
    ds_read_b64_tr_b16 v[80:81], v252 offset:28672
    s_lshl1_add_u32 m0, s33, 50176
    v_mfma_f32_16x16x32_bf16 v[112:115], v[44:47], v[32:35], v[112:115]
    ds_read_b64_tr_b16 v[82:83], v252 offset:29184
    ds_read_b64_tr_b16 v[84:85], v253 offset:28672
    v_mfma_f32_16x16x32_bf16 v[116:119], v[44:47], v[36:39], v[116:119]
    ds_read_b64_tr_b16 v[86:87], v253 offset:29184
    buffer_load_dwordx4 v255, s[60:63], s83 offen lds
    s_waitcnt lgkmcnt(14)
    v_mfma_f32_16x16x32_bf16 v[120:123], v[48:51], v[24:27], v[120:123]
    v_mfma_f32_16x16x32_bf16 v[124:127], v[48:51], v[28:31], v[124:127]
    s_lshl1_add_u32 m0, s33, 57344
    v_mfma_f32_16x16x32_bf16 v[128:131], v[48:51], v[32:35], v[128:131]
    v_mfma_f32_16x16x32_bf16 v[132:135], v[48:51], v[36:39], v[132:135]
    buffer_load_dwordx4 v254, s[64:67], s83 offen lds
    s_waitcnt lgkmcnt(12)
    v_mfma_f32_16x16x32_bf16 v[136:139], v[52:55], v[24:27], v[136:139]
    v_mfma_f32_16x16x32_bf16 v[140:143], v[52:55], v[28:31], v[140:143]
    s_lshl1_add_u32 m0, s33, 58368
    v_mfma_f32_16x16x32_bf16 v[144:147], v[52:55], v[32:35], v[144:147]
    v_mfma_f32_16x16x32_bf16 v[148:151], v[52:55], v[36:39], v[148:151]
    buffer_load_dwordx4 v255, s[64:67], s83 offen lds
    s_add_u32 s83, s83, 131072
    s_waitcnt vmcnt(16) lgkmcnt(0)
    s_barrier
    v_mfma_f32_16x16x32_bf16 v[88:91], v[72:75], v[56:59], v[88:91]
    ds_read_b64_tr_b16 v[40:41], v250 offset:16384
    ds_read_b64_tr_b16 v[42:43], v250 offset:16896
    v_mfma_f32_16x16x32_bf16 v[92:95], v[72:75], v[60:63], v[92:95]
    ds_read_b128 v[24:27], v248 offset:0
    s_lshl2_add_u32 m0, s33, 65536
    v_mfma_f32_16x16x32_bf16 v[96:99], v[72:75], v[64:67], v[96:99]
    ds_read_b128 v[28:31], v248 offset:1024
    v_mfma_f32_16x16x32_bf16 v[100:103], v[72:75], v[68:71], v[100:103]
    ds_read_b128 v[32:35], v248 offset:2048
    buffer_load_dwordx4 v18, s[56:59], s82 offen offset:0 sc1 lds
    v_mfma_f32_16x16x32_bf16 v[104:107], v[76:79], v[56:59], v[104:107]
    ds_read_b128 v[36:39], v248 offset:3072
    v_mfma_f32_16x16x32_bf16 v[108:111], v[76:79], v[60:63], v[108:111]
    ds_read_b64_tr_b16 v[44:45], v251 offset:16384
    ds_read_b64_tr_b16 v[46:47], v251 offset:16896
    v_mfma_f32_16x16x32_bf16 v[112:115], v[76:79], v[64:67], v[112:115]
    ds_read_b64_tr_b16 v[48:49], v250 offset:24576
    v_mfma_f32_16x16x32_bf16 v[116:119], v[76:79], v[68:71], v[116:119]
    ds_read_b64_tr_b16 v[50:51], v250 offset:25088
    buffer_load_dwordx4 v18, s[56:59], s82 offen offset:1024 sc1 lds
    v_mfma_f32_16x16x32_bf16 v[120:123], v[80:83], v[56:59], v[120:123]
    ds_read_b64_tr_b16 v[52:53], v251 offset:24576
    v_mfma_f32_16x16x32_bf16 v[124:127], v[80:83], v[60:63], v[124:127]
    ds_read_b64_tr_b16 v[54:55], v251 offset:25088
    v_mfma_f32_16x16x32_bf16 v[128:131], v[80:83], v[64:67], v[128:131]
    v_mfma_f32_16x16x32_bf16 v[132:135], v[80:83], v[68:71], v[132:135]
    buffer_load_dwordx4 v18, s[56:59], s82 offen offset:2048 sc1 lds
    v_mfma_f32_16x16x32_bf16 v[136:139], v[84:87], v[56:59], v[136:139]
    v_mfma_f32_16x16x32_bf16 v[140:143], v[84:87], v[60:63], v[140:143]
    v_mfma_f32_16x16x32_bf16 v[144:147], v[84:87], v[64:67], v[144:147]
    v_mfma_f32_16x16x32_bf16 v[148:151], v[84:87], v[68:71], v[148:151]
    buffer_load_dwordx4 v18, s[56:59], s82 offen offset:3072 sc1 lds
    s_add_u32 s82, s82, 16384
    s_mov_b32 s34, 2
.p2align 6
L_da:
    s_waitcnt lgkmcnt(9)
    v_mfma_f32_16x16x32_bf16 v[88:91], v[40:43], v[24:27], v[88:91]
    ds_read_b64_tr_b16 v[72:73], v250 offset:20480
    ds_read_b64_tr_b16 v[74:75], v250 offset:20992
    s_waitcnt lgkmcnt(10)
    v_mfma_f32_16x16x32_bf16 v[92:95], v[40:43], v[28:31], v[92:95]
    ds_read_b128 v[56:59], v248 offset:8192
    s_lshl1_add_u32 m0, s33, 81920
    s_waitcnt lgkmcnt(10)
    v_mfma_f32_16x16x32_bf16 v[96:99], v[40:43], v[32:35], v[96:99]
    ds_read_b128 v[60:63], v248 offset:9216
    ds_read_b128 v[64:67], v248 offset:10240
    s_waitcnt lgkmcnt(11)
    v_mfma_f32_16x16x32_bf16 v[100:103], v[40:43], v[36:39], v[100:103]
    ds_read_b128 v[68:71], v248 offset:11264
    buffer_load_dwordx4 v254, s[60:63], s83 offen lds
    s_waitcnt lgkmcnt(10)
    v_mfma_f32_16x16x32_bf16 v[104:107], v[44:47], v[24:27], v[104:107]
    ds_read_b64_tr_b16 v[76:77], v251 offset:20480
    ds_read_b64_tr_b16 v[78:79], v251 offset:20992
    v_mfma_f32_16x16x32_bf16 v[108:111], v[44:47], v[28:31], v[108:111]
    ds_read_b64_tr_b16 v[80:81], v250 offset:28672
    s_lshl1_add_u32 m0, s33, 82944
    v_mfma_f32_16x16x32_bf16 v[112:115], v[44:47], v[32:35], v[112:115]
    ds_read_b64_tr_b16 v[82:83], v250 offset:29184
    ds_read_b64_tr_b16 v[84:85], v251 offset:28672
    v_mfma_f32_16x16x32_bf16 v[116:119], v[44:47], v[36:39], v[116:119]
    ds_read_b64_tr_b16 v[86:87], v251 offset:29184
    buffer_load_dwordx4 v255, s[60:63], s83 offen lds
    s_waitcnt lgkmcnt(14)
    v_mfma_f32_16x16x32_bf16 v[120:123], v[48:51], v[24:27], v[120:123]
    v_mfma_f32_16x16x32_bf16 v[124:127], v[48:51], v[28:31], v[124:127]
    s_lshl1_add_u32 m0, s33, 90112
    v_mfma_f32_16x16x32_bf16 v[128:131], v[48:51], v[32:35], v[128:131]
    v_mfma_f32_16x16x32_bf16 v[132:135], v[48:51], v[36:39], v[132:135]
    buffer_load_dwordx4 v254, s[64:67], s83 offen lds
    s_waitcnt lgkmcnt(12)
    v_mfma_f32_16x16x32_bf16 v[136:139], v[52:55], v[24:27], v[136:139]
    v_mfma_f32_16x16x32_bf16 v[140:143], v[52:55], v[28:31], v[140:143]
    s_lshl1_add_u32 m0, s33, 91136
    v_mfma_f32_16x16x32_bf16 v[144:147], v[52:55], v[32:35], v[144:147]
    v_mfma_f32_16x16x32_bf16 v[148:151], v[52:55], v[36:39], v[148:151]
    buffer_load_dwordx4 v255, s[64:67], s83 offen lds
    s_add_u32 s83, s83, 131072
    s_waitcnt vmcnt(16) lgkmcnt(0)
    s_barrier
    v_mfma_f32_16x16x32_bf16 v[88:91], v[72:75], v[56:59], v[88:91]
    ds_read_b64_tr_b16 v[40:41], v252 offset:49152
    ds_read_b64_tr_b16 v[42:43], v252 offset:49664
    v_mfma_f32_16x16x32_bf16 v[92:95], v[72:75], v[60:63], v[92:95]
    ds_read_b128 v[24:27], v249 offset:32768
    s_lshl_b32 m0, s33, 2
    v_mfma_f32_16x16x32_bf16 v[96:99], v[72:75], v[64:67], v[96:99]
    ds_read_b128 v[28:31], v249 offset:33792
    v_mfma_f32_16x16x32_bf16 v[100:103], v[72:75], v[68:71], v[100:103]
    ds_read_b128 v[32:35], v249 offset:34816
    buffer_load_dwordx4 v18, s[56:59], s82 offen offset:0 sc1 lds
    v_mfma_f32_16x16x32_bf16 v[104:107], v[76:79], v[56:59], v[104:107]
    ds_read_b128 v[36:39], v249 offset:35840
    v_mfma_f32_16x16x32_bf16 v[108:111], v[76:79], v[60:63], v[108:111]
    ds_read_b64_tr_b16 v[44:45], v253 offset:49152
    ds_read_b64_tr_b16 v[46:47], v253 offset:49664
    v_mfma_f32_16x16x32_bf16 v[112:115], v[76:79], v[64:67], v[112:115]
    ds_read_b64_tr_b16 v[48:49], v252 offset:57344
    v_mfma_f32_16x16x32_bf16 v[116:119], v[76:79], v[68:71], v[116:119]
    ds_read_b64_tr_b16 v[50:51], v252 offset:57856
    buffer_load_dwordx4 v18, s[56:59], s82 offen offset:1024 sc1 lds
    v_mfma_f32_16x16x32_bf16 v[120:123], v[80:83], v[56:59], v[120:123]
    ds_read_b64_tr_b16 v[52:53], v253 offset:57344
    v_mfma_f32_16x16x32_bf16 v[124:127], v[80:83], v[60:63], v[124:127]
    ds_read_b64_tr_b16 v[54:55], v253 offset:57856
    v_mfma_f32_16x16x32_bf16 v[128:131], v[80:83], v[64:67], v[128:131]
    v_mfma_f32_16x16x32_bf16 v[132:135], v[80:83], v[68:71], v[132:135]
    buffer_load_dwordx4 v18, s[56:59], s82 offen offset:2048 sc1 lds
    v_mfma_f32_16x16x32_bf16 v[136:139], v[84:87], v[56:59], v[136:139]
    v_mfma_f32_16x16x32_bf16 v[140:143], v[84:87], v[60:63], v[140:143]
    v_mfma_f32_16x16x32_bf16 v[144:147], v[84:87], v[64:67], v[144:147]
    v_mfma_f32_16x16x32_bf16 v[148:151], v[84:87], v[68:71], v[148:151]
    buffer_load_dwordx4 v18, s[56:59], s82 offen offset:3072 sc1 lds
    s_add_u32 s82, s82, 16384
    s_waitcnt lgkmcnt(9)
    v_mfma_f32_16x16x32_bf16 v[88:91], v[40:43], v[24:27], v[88:91]
    ds_read_b64_tr_b16 v[72:73], v252 offset:53248
    ds_read_b64_tr_b16 v[74:75], v252 offset:53760
    s_waitcnt lgkmcnt(10)
    v_mfma_f32_16x16x32_bf16 v[92:95], v[40:43], v[28:31], v[92:95]
    ds_read_b128 v[56:59], v249 offset:40960
    s_lshl1_add_u32 m0, s33, 16384
    s_waitcnt lgkmcnt(10)
    v_mfma_f32_16x16x32_bf16 v[96:99], v[40:43], v[32:35], v[96:99]
    ds_read_b128 v[60:63], v249 offset:41984
    ds_read_b128 v[64:67], v249 offset:43008
    s_waitcnt lgkmcnt(11)
    v_mfma_f32_16x16x32_bf16 v[100:103], v[40:43], v[36:39], v[100:103]
    ds_read_b128 v[68:71], v249 offset:44032
    buffer_load_dwordx4 v254, s[60:63], s83 offen lds
    s_waitcnt lgkmcnt(10)
    v_mfma_f32_16x16x32_bf16 v[104:107], v[44:47], v[24:27], v[104:107]
    ds_read_b64_tr_b16 v[76:77], v253 offset:53248
    ds_read_b64_tr_b16 v[78:79], v253 offset:53760
    v_mfma_f32_16x16x32_bf16 v[108:111], v[44:47], v[28:31], v[108:111]
    ds_read_b64_tr_b16 v[80:81], v252 offset:61440
    s_lshl1_add_u32 m0, s33, 17408
    v_mfma_f32_16x16x32_bf16 v[112:115], v[44:47], v[32:35], v[112:115]
    ds_read_b64_tr_b16 v[82:83], v252 offset:61952
    ds_read_b64_tr_b16 v[84:85], v253 offset:61440
    v_mfma_f32_16x16x32_bf16 v[116:119], v[44:47], v[36:39], v[116:119]
    ds_read_b64_tr_b16 v[86:87], v253 offset:61952
    buffer_load_dwordx4 v255, s[60:63], s83 offen lds
    s_waitcnt lgkmcnt(14)
    v_mfma_f32_16x16x32_bf16 v[120:123], v[48:51], v[24:27], v[120:123]
    v_mfma_f32_16x16x32_bf16 v[124:127], v[48:51], v[28:31], v[124:127]
    s_lshl1_add_u32 m0, s33, 24576
    v_mfma_f32_16x16x32_bf16 v[128:131], v[48:51], v[32:35], v[128:131]
    v_mfma_f32_16x16x32_bf16 v[132:135], v[48:51], v[36:39], v[132:135]
    buffer_load_dwordx4 v254, s[64:67], s83 offen lds
    s_waitcnt lgkmcnt(12)
    v_mfma_f32_16x16x32_bf16 v[136:139], v[52:55], v[24:27], v[136:139]
    v_mfma_f32_16x16x32_bf16 v[140:143], v[52:55], v[28:31], v[140:143]
    s_lshl1_add_u32 m0, s33, 25600
    v_mfma_f32_16x16x32_bf16 v[144:147], v[52:55], v[32:35], v[144:147]
    v_mfma_f32_16x16x32_bf16 v[148:151], v[52:55], v[36:39], v[148:151]
    buffer_load_dwordx4 v255, s[64:67], s83 offen lds
    s_add_u32 s83, s83, 131072
    s_waitcnt vmcnt(16) lgkmcnt(0)
    s_barrier
    v_mfma_f32_16x16x32_bf16 v[88:91], v[72:75], v[56:59], v[88:91]
    ds_read_b64_tr_b16 v[40:41], v250 offset:49152
    ds_read_b64_tr_b16 v[42:43], v250 offset:49664
    v_mfma_f32_16x16x32_bf16 v[92:95], v[72:75], v[60:63], v[92:95]
    ds_read_b128 v[24:27], v248 offset:32768
    s_lshl2_add_u32 m0, s33, 98304
    v_mfma_f32_16x16x32_bf16 v[96:99], v[72:75], v[64:67], v[96:99]
    ds_read_b128 v[28:31], v248 offset:33792
    v_mfma_f32_16x16x32_bf16 v[100:103], v[72:75], v[68:71], v[100:103]
    ds_read_b128 v[32:35], v248 offset:34816
    buffer_load_dwordx4 v18, s[56:59], s82 offen offset:0 sc1 lds
    v_mfma_f32_16x16x32_bf16 v[104:107], v[76:79], v[56:59], v[104:107]
    ds_read_b128 v[36:39], v248 offset:35840
    v_mfma_f32_16x16x32_bf16 v[108:111], v[76:79], v[60:63], v[108:111]
    ds_read_b64_tr_b16 v[44:45], v251 offset:49152
    ds_read_b64_tr_b16 v[46:47], v251 offset:49664
    v_mfma_f32_16x16x32_bf16 v[112:115], v[76:79], v[64:67], v[112:115]
    ds_read_b64_tr_b16 v[48:49], v250 offset:57344
    v_mfma_f32_16x16x32_bf16 v[116:119], v[76:79], v[68:71], v[116:119]
    ds_read_b64_tr_b16 v[50:51], v250 offset:57856
    buffer_load_dwordx4 v18, s[56:59], s82 offen offset:1024 sc1 lds
    v_mfma_f32_16x16x32_bf16 v[120:123], v[80:83], v[56:59], v[120:123]
    ds_read_b64_tr_b16 v[52:53], v251 offset:57344
    v_mfma_f32_16x16x32_bf16 v[124:127], v[80:83], v[60:63], v[124:127]
    ds_read_b64_tr_b16 v[54:55], v251 offset:57856
    v_mfma_f32_16x16x32_bf16 v[128:131], v[80:83], v[64:67], v[128:131]
    v_mfma_f32_16x16x32_bf16 v[132:135], v[80:83], v[68:71], v[132:135]
    buffer_load_dwordx4 v18, s[56:59], s82 offen offset:2048 sc1 lds
    v_mfma_f32_16x16x32_bf16 v[136:139], v[84:87], v[56:59], v[136:139]
    v_mfma_f32_16x16x32_bf16 v[140:143], v[84:87], v[60:63], v[140:143]
    v_mfma_f32_16x16x32_bf16 v[144:147], v[84:87], v[64:67], v[144:147]
    v_mfma_f32_16x16x32_bf16 v[148:151], v[84:87], v[68:71], v[148:151]
    buffer_load_dwordx4 v18, s[56:59], s82 offen offset:3072 sc1 lds
    s_add_u32 s82, s82, 16384
    s_waitcnt lgkmcnt(9)
    v_mfma_f32_16x16x32_bf16 v[88:91], v[40:43], v[24:27], v[88:91]
    ds_read_b64_tr_b16 v[72:73], v250 offset:53248
    ds_read_b64_tr_b16 v[74:75], v250 offset:53760
    s_waitcnt lgkmcnt(10)
    v_mfma_f32_16x16x32_bf16 v[92:95], v[40:43], v[28:31], v[92:95]
    ds_read_b128 v[56:59], v248 offset:40960
    s_lshl1_add_u32 m0, s33, 114688
    s_waitcnt lgkmcnt(10)
    v_mfma_f32_16x16x32_bf16 v[96:99], v[40:43], v[32:35], v[96:99]
    ds_read_b128 v[60:63], v248 offset:41984
    ds_read_b128 v[64:67], v248 offset:43008
    s_waitcnt lgkmcnt(11)
    v_mfma_f32_16x16x32_bf16 v[100:103], v[40:43], v[36:39], v[100:103]
    ds_read_b128 v[68:71], v248 offset:44032
    buffer_load_dwordx4 v254, s[60:63], s83 offen lds
    s_waitcnt lgkmcnt(10)
    v_mfma_f32_16x16x32_bf16 v[104:107], v[44:47], v[24:27], v[104:107]
    ds_read_b64_tr_b16 v[76:77], v251 offset:53248
    ds_read_b64_tr_b16 v[78:79], v251 offset:53760
    v_mfma_f32_16x16x32_bf16 v[108:111], v[44:47], v[28:31], v[108:111]
    ds_read_b64_tr_b16 v[80:81], v250 offset:61440
    s_lshl1_add_u32 m0, s33, 115712
    v_mfma_f32_16x16x32_bf16 v[112:115], v[44:47], v[32:35], v[112:115]
    ds_read_b64_tr_b16 v[82:83], v250 offset:61952
    ds_read_b64_tr_b16 v[84:85], v251 offset:61440
    v_mfma_f32_16x16x32_bf16 v[116:119], v[44:47], v[36:39], v[116:119]
    ds_read_b64_tr_b16 v[86:87], v251 offset:61952
    buffer_load_dwordx4 v255, s[60:63], s83 offen lds
    s_waitcnt lgkmcnt(14)
    v_mfma_f32_16x16x32_bf16 v[120:123], v[48:51], v[24:27], v[120:123]
    v_mfma_f32_16x16x32_bf16 v[124:127], v[48:51], v[28:31], v[124:127]
    s_lshl1_add_u32 m0, s33, 122880
    v_mfma_f32_16x16x32_bf16 v[128:131], v[48:51], v[32:35], v[128:131]
    v_mfma_f32_16x16x32_bf16 v[132:135], v[48:51], v[36:39], v[132:135]
    buffer_load_dwordx4 v254, s[64:67], s83 offen lds
    s_waitcnt lgkmcnt(12)
    v_mfma_f32_16x16x32_bf16 v[136:139], v[52:55], v[24:27], v[136:139]
    v_mfma_f32_16x16x32_bf16 v[140:143], v[52:55], v[28:31], v[140:143]
    s_lshl1_add_u32 m0, s33, 123904
    v_mfma_f32_16x16x32_bf16 v[144:147], v[52:55], v[32:35], v[144:147]
    v_mfma_f32_16x16x32_bf16 v[148:151], v[52:55], v[36:39], v[148:151]
    buffer_load_dwordx4 v255, s[64:67], s83 offen lds
    s_add_u32 s83, s83, 131072
    s_waitcnt vmcnt(16) lgkmcnt(0)
    s_barrier
    v_mfma_f32_16x16x32_bf16 v[88:91], v[72:75], v[56:59], v[88:91]
    ds_read_b64_tr_b16 v[40:41], v252 offset:16384
    ds_read_b64_tr_b16 v[42:43], v252 offset:16896
    v_mfma_f32_16x16x32_bf16 v[92:95], v[72:75], v[60:63], v[92:95]
    ds_read_b128 v[24:27], v249 offset:0
    s_lshl2_add_u32 m0, s33, 32768
    v_mfma_f32_16x16x32_bf16 v[96:99], v[72:75], v[64:67], v[96:99]
    ds_read_b128 v[28:31], v249 offset:1024
    v_mfma_f32_16x16x32_bf16 v[100:103], v[72:75], v[68:71], v[100:103]
    ds_read_b128 v[32:35], v249 offset:2048
    buffer_load_dwordx4 v18, s[56:59], s82 offen offset:0 sc1 lds
    v_mfma_f32_16x16x32_bf16 v[104:107], v[76:79], v[56:59], v[104:107]
    ds_read_b128 v[36:39], v249 offset:3072
    v_mfma_f32_16x16x32_bf16 v[108:111], v[76:79], v[60:63], v[108:111]
    ds_read_b64_tr_b16 v[44:45], v253 offset:16384
    ds_read_b64_tr_b16 v[46:47], v253 offset:16896
    v_mfma_f32_16x16x32_bf16 v[112:115], v[76:79], v[64:67], v[112:115]
    ds_read_b64_tr_b16 v[48:49], v252 offset:24576
    v_mfma_f32_16x16x32_bf16 v[116:119], v[76:79], v[68:71], v[116:119]
    ds_read_b64_tr_b16 v[50:51], v252 offset:25088
    buffer_load_dwordx4 v18, s[56:59], s82 offen offset:1024 sc1 lds
    v_mfma_f32_16x16x32_bf16 v[120:123], v[80:83], v[56:59], v[120:123]
    ds_read_b64_tr_b16 v[52:53], v253 offset:24576
    v_mfma_f32_16x16x32_bf16 v[124:127], v[80:83], v[60:63], v[124:127]
    ds_read_b64_tr_b16 v[54:55], v253 offset:25088
    v_mfma_f32_16x16x32_bf16 v[128:131], v[80:83], v[64:67], v[128:131]
    v_mfma_f32_16x16x32_bf16 v[132:135], v[80:83], v[68:71], v[132:135]
    buffer_load_dwordx4 v18, s[56:59], s82 offen offset:2048 sc1 lds
    v_mfma_f32_16x16x32_bf16 v[136:139], v[84:87], v[56:59], v[136:139]
    v_mfma_f32_16x16x32_bf16 v[140:143], v[84:87], v[60:63], v[140:143]
    v_mfma_f32_16x16x32_bf16 v[144:147], v[84:87], v[64:67], v[144:147]
    v_mfma_f32_16x16x32_bf16 v[148:151], v[84:87], v[68:71], v[148:151]
    buffer_load_dwordx4 v18, s[56:59], s82 offen offset:3072 sc1 lds
    s_add_u32 s82, s82, 16384
    s_waitcnt lgkmcnt(9)
    v_mfma_f32_16x16x32_bf16 v[88:91], v[40:43], v[24:27], v[88:91]
    ds_read_b64_tr_b16 v[72:73], v252 offset:20480
    ds_read_b64_tr_b16 v[74:75], v252 offset:20992
    s_waitcnt lgkmcnt(10)
    v_mfma_f32_16x16x32_bf16 v[92:95], v[40:43], v[28:31], v[92:95]
    ds_read_b128 v[56:59], v249 offset:8192
    s_lshl1_add_u32 m0, s33, 49152
    s_waitcnt lgkmcnt(10)
    v_mfma_f32_16x16x32_bf16 v[96:99], v[40:43], v[32:35], v[96:99]
    ds_read_b128 v[60:63], v249 offset:9216
    ds_read_b128 v[64:67], v249 offset:10240
    s_waitcnt lgkmcnt(11)
    v_mfma_f32_16x16x32_bf16 v[100:103], v[40:43], v[36:39], v[100:103]
    ds_read_b128 v[68:71], v249 offset:11264
    buffer_load_dwordx4 v254, s[60:63], s83 offen lds
    s_waitcnt lgkmcnt(10)
    v_mfma_f32_16x16x32_bf16 v[104:107], v[44:47], v[24:27], v[104:107]
    ds_read_b64_tr_b16 v[76:77], v253 offset:20480
    ds_read_b64_tr_b16 v[78:79], v253 offset:20992
    v_mfma_f32_16x16x32_bf16 v[108:111], v[44:47], v[28:31], v[108:111]
    ds_read_b64_tr_b16 v[80:81], v252 offset:28672
    s_lshl1_add_u32 m0, s33, 50176
    v_mfma_f32_16x16x32_bf16 v[112:115], v[44:47], v[32:35], v[112:115]
    ds_read_b64_tr_b16 v[82:83], v252 offset:29184
    ds_read_b64_tr_b16 v[84:85], v253 offset:28672
    v_mfma_f32_16x16x32_bf16 v[116:119], v[44:47], v[36:39], v[116:119]
    ds_read_b64_tr_b16 v[86:87], v253 offset:29184
    buffer_load_dwordx4 v255, s[60:63], s83 offen lds
    s_waitcnt lgkmcnt(14)
    v_mfma_f32_16x16x32_bf16 v[120:123], v[48:51], v[24:27], v[120:123]
    v_mfma_f32_16x16x32_bf16 v[124:127], v[48:51], v[28:31], v[124:127]
    s_lshl1_add_u32 m0, s33, 57344
    v_mfma_f32_16x16x32_bf16 v[128:131], v[48:51], v[32:35], v[128:131]
    v_mfma_f32_16x16x32_bf16 v[132:135], v[48:51], v[36:39], v[132:135]
    buffer_load_dwordx4 v254, s[64:67], s83 offen lds
    s_waitcnt lgkmcnt(12)
    v_mfma_f32_16x16x32_bf16 v[136:139], v[52:55], v[24:27], v[136:139]
    v_mfma_f32_16x16x32_bf16 v[140:143], v[52:55], v[28:31], v[140:143]
    s_lshl1_add_u32 m0, s33, 58368
    v_mfma_f32_16x16x32_bf16 v[144:147], v[52:55], v[32:35], v[144:147]
    v_mfma_f32_16x16x32_bf16 v[148:151], v[52:55], v[36:39], v[148:151]
    buffer_load_dwordx4 v255, s[64:67], s83 offen lds
    s_add_u32 s83, s83, 131072
    s_waitcnt vmcnt(16) lgkmcnt(0)
    s_barrier
    v_mfma_f32_16x16x32_bf16 v[88:91], v[72:75], v[56:59], v[88:91]
    ds_read_b64_tr_b16 v[40:41], v250 offset:16384
    ds_read_b64_tr_b16 v[42:43], v250 offset:16896
    v_mfma_f32_16x16x32_bf16 v[92:95], v[72:75], v[60:63], v[92:95]
    ds_read_b128 v[24:27], v248 offset:0
    s_lshl2_add_u32 m0, s33, 65536
    v_mfma_f32_16x16x32_bf16 v[96:99], v[72:75], v[64:67], v[96:99]
    ds_read_b128 v[28:31], v248 offset:1024
    v_mfma_f32_16x16x32_bf16 v[100:103], v[72:75], v[68:71], v[100:103]
    ds_read_b128 v[32:35], v248 offset:2048
    buffer_load_dwordx4 v18, s[56:59], s82 offen offset:0 sc1 lds
    v_mfma_f32_16x16x32_bf16 v[104:107], v[76:79], v[56:59], v[104:107]
    ds_read_b128 v[36:39], v248 offset:3072
    v_mfma_f32_16x16x32_bf16 v[108:111], v[76:79], v[60:63], v[108:111]
    ds_read_b64_tr_b16 v[44:45], v251 offset:16384
    ds_read_b64_tr_b16 v[46:47], v251 offset:16896
    v_mfma_f32_16x16x32_bf16 v[112:115], v[76:79], v[64:67], v[112:115]
    ds_read_b64_tr_b16 v[48:49], v250 offset:24576
    v_mfma_f32_16x16x32_bf16 v[116:119], v[76:79], v[68:71], v[116:119]
    ds_read_b64_tr_b16 v[50:51], v250 offset:25088
    buffer_load_dwordx4 v18, s[56:59], s82 offen offset:1024 sc1 lds
    v_mfma_f32_16x16x32_bf16 v[120:123], v[80:83], v[56:59], v[120:123]
    ds_read_b64_tr_b16 v[52:53], v251 offset:24576
    v_mfma_f32_16x16x32_bf16 v[124:127], v[80:83], v[60:63], v[124:127]
    ds_read_b64_tr_b16 v[54:55], v251 offset:25088
    v_mfma_f32_16x16x32_bf16 v[128:131], v[80:83], v[64:67], v[128:131]
    v_mfma_f32_16x16x32_bf16 v[132:135], v[80:83], v[68:71], v[132:135]
    buffer_load_dwordx4 v18, s[56:59], s82 offen offset:2048 sc1 lds
    v_mfma_f32_16x16x32_bf16 v[136:139], v[84:87], v[56:59], v[136:139]
    v_mfma_f32_16x16x32_bf16 v[140:143], v[84:87], v[60:63], v[140:143]
    v_mfma_f32_16x16x32_bf16 v[144:147], v[84:87], v[64:67], v[144:147]
    v_mfma_f32_16x16x32_bf16 v[148:151], v[84:87], v[68:71], v[148:151]
    buffer_load_dwordx4 v18, s[56:59], s82 offen offset:3072 sc1 lds
    s_add_u32 s82, s82, 16384
    s_sub_u32 s34, s34, 1
    s_cmp_lg_u32 s34, 0
    s_cbranch_scc1 L_da
    s_mov_b32 s34, 3
.p2align 6
L_d:
    s_waitcnt lgkmcnt(9)
    v_mfma_f32_16x16x32_bf16 v[88:91], v[40:43], v[24:27], v[88:91]
    ds_read_b64_tr_b16 v[72:73], v250 offset:20480
    ds_read_b64_tr_b16 v[74:75], v250 offset:20992
    s_waitcnt lgkmcnt(10)
    v_mfma_f32_16x16x32_bf16 v[92:95], v[40:43], v[28:31], v[92:95]
    ds_read_b128 v[56:59], v248 offset:8192
    s_waitcnt lgkmcnt(10)
    v_mfma_f32_16x16x32_bf16 v[96:99], v[40:43], v[32:35], v[96:99]
    ds_read_b128 v[60:63], v248 offset:9216
    ds_read_b128 v[64:67], v248 offset:10240
    s_waitcnt lgkmcnt(11)
    v_mfma_f32_16x16x32_bf16 v[100:103], v[40:43], v[36:39], v[100:103]
    ds_read_b128 v[68:71], v248 offset:11264
    s_waitcnt lgkmcnt(10)
    v_mfma_f32_16x16x32_bf16 v[104:107], v[44:47], v[24:27], v[104:107]
    ds_read_b64_tr_b16 v[76:77], v251 offset:20480
    ds_read_b64_tr_b16 v[78:79], v251 offset:20992
    v_mfma_f32_16x16x32_bf16 v[108:111], v[44:47], v[28:31], v[108:111]
    ds_read_b64_tr_b16 v[80:81], v250 offset:28672
    v_mfma_f32_16x16x32_bf16 v[112:115], v[44:47], v[32:35], v[112:115]
    ds_read_b64_tr_b16 v[82:83], v250 offset:29184
    ds_read_b64_tr_b16 v[84:85], v251 offset:28672
    v_mfma_f32_16x16x32_bf16 v[116:119], v[44:47], v[36:39], v[116:119]
    ds_read_b64_tr_b16 v[86:87], v251 offset:29184
    s_waitcnt lgkmcnt(14)
    v_mfma_f32_16x16x32_bf16 v[120:123], v[48:51], v[24:27], v[120:123]
    v_mfma_f32_16x16x32_bf16 v[124:127], v[48:51], v[28:31], v[124:127]
    v_mfma_f32_16x16x32_bf16 v[128:131], v[48:51], v[32:35], v[128:131]
    v_mfma_f32_16x16x32_bf16 v[132:135], v[48:51], v[36:39], v[132:135]
    s_waitcnt lgkmcnt(12)
    v_mfma_f32_16x16x32_bf16 v[136:139], v[52:55], v[24:27], v[136:139]
    v_mfma_f32_16x16x32_bf16 v[140:143], v[52:55], v[28:31], v[140:143]
    v_mfma_f32_16x16x32_bf16 v[144:147], v[52:55], v[32:35], v[144:147]
    v_mfma_f32_16x16x32_bf16 v[148:151], v[52:55], v[36:39], v[148:151]
    s_waitcnt vmcnt(12) lgkmcnt(0)
    s_barrier
    v_mfma_f32_16x16x32_bf16 v[88:91], v[72:75], v[56:59], v[88:91]
    ds_read_b64_tr_b16 v[40:41], v252 offset:49152
    ds_read_b64_tr_b16 v[42:43], v252 offset:49664
    v_mfma_f32_16x16x32_bf16 v[92:95], v[72:75], v[60:63], v[92:95]
    ds_read_b128 v[24:27], v249 offset:32768
    v_mfma_f32_16x16x32_bf16 v[96:99], v[72:75], v[64:67], v[96:99]
    ds_read_b128 v[28:31], v249 offset:33792
    v_mfma_f32_16x16x32_bf16 v[100:103], v[72:75], v[68:71], v[100:103]
    ds_read_b128 v[32:35], v249 offset:34816
    v_mfma_f32_16x16x32_bf16 v[104:107], v[76:79], v[56:59], v[104:107]
    ds_read_b128 v[36:39], v249 offset:35840
    v_mfma_f32_16x16x32_bf16 v[108:111], v[76:79], v[60:63], v[108:111]
    ds_read_b64_tr_b16 v[44:45], v253 offset:49152
    ds_read_b64_tr_b16 v[46:47], v253 offset:49664
    v_mfma_f32_16x16x32_bf16 v[112:115], v[76:79], v[64:67], v[112:115]
    ds_read_b64_tr_b16 v[48:49], v252 offset:57344
    v_mfma_f32_16x16x32_bf16 v[116:119], v[76:79], v[68:71], v[116:119]
    ds_read_b64_tr_b16 v[50:51], v252 offset:57856
    v_mfma_f32_16x16x32_bf16 v[120:123], v[80:83], v[56:59], v[120:123]
    ds_read_b64_tr_b16 v[52:53], v253 offset:57344
    v_mfma_f32_16x16x32_bf16 v[124:127], v[80:83], v[60:63], v[124:127]
    ds_read_b64_tr_b16 v[54:55], v253 offset:57856
    v_mfma_f32_16x16x32_bf16 v[128:131], v[80:83], v[64:67], v[128:131]
    v_mfma_f32_16x16x32_bf16 v[132:135], v[80:83], v[68:71], v[132:135]
    v_mfma_f32_16x16x32_bf16 v[136:139], v[84:87], v[56:59], v[136:139]
    v_mfma_f32_16x16x32_bf16 v[140:143], v[84:87], v[60:63], v[140:143]
    v_mfma_f32_16x16x32_bf16 v[144:147], v[84:87], v[64:67], v[144:147]
    v_mfma_f32_16x16x32_bf16 v[148:151], v[84:87], v[68:71], v[148:151]
    s_waitcnt lgkmcnt(9)
    v_mfma_f32_16x16x32_bf16 v[88:91], v[40:43], v[24:27], v[88:91]
    ds_read_b64_tr_b16 v[72:73], v252 offset:53248
    ds_read_b64_tr_b16 v[74:75], v252 offset:53760
    s_waitcnt lgkmcnt(10)
    v_mfma_f32_16x16x32_bf16 v[92:95], v[40:43], v[28:31], v[92:95]
    ds_read_b128 v[56:59], v249 offset:40960
    s_waitcnt lgkmcnt(10)
    v_mfma_f32_16x16x32_bf16 v[96:99], v[40:43], v[32:35], v[96:99]
    ds_read_b128 v[60:63], v249 offset:41984
    ds_read_b128 v[64:67], v249 offset:43008
    s_waitcnt lgkmcnt(11)
    v_mfma_f32_16x16x32_bf16 v[100:103], v[40:43], v[36:39], v[100:103]
    ds_read_b128 v[68:71], v249 offset:44032
    s_waitcnt lgkmcnt(10)
    v_mfma_f32_16x16x32_bf16 v[104:107], v[44:47], v[24:27], v[104:107]
    ds_read_b64_tr_b16 v[76:77], v253 offset:53248
    ds_read_b64_tr_b16 v[78:79], v253 offset:53760
    v_mfma_f32_16x16x32_bf16 v[108:111], v[44:47], v[28:31], v[108:111]
    ds_read_b64_tr_b16 v[80:81], v252 offset:61440
    v_mfma_f32_16x16x32_bf16 v[112:115], v[44:47], v[32:35], v[112:115]
    ds_read_b64_tr_b16 v[82:83], v252 offset:61952
    ds_read_b64_tr_b16 v[84:85], v253 offset:61440
    v_mfma_f32_16x16x32_bf16 v[116:119], v[44:47], v[36:39], v[116:119]
    ds_read_b64_tr_b16 v[86:87], v253 offset:61952
    s_waitcnt lgkmcnt(14)
    v_mfma_f32_16x16x32_bf16 v[120:123], v[48:51], v[24:27], v[120:123]
    v_mfma_f32_16x16x32_bf16 v[124:127], v[48:51], v[28:31], v[124:127]
    v_mfma_f32_16x16x32_bf16 v[128:131], v[48:51], v[32:35], v[128:131]
    v_mfma_f32_16x16x32_bf16 v[132:135], v[48:51], v[36:39], v[132:135]
    s_waitcnt lgkmcnt(12)
    v_mfma_f32_16x16x32_bf16 v[136:139], v[52:55], v[24:27], v[136:139]
    v_mfma_f32_16x16x32_bf16 v[140:143], v[52:55], v[28:31], v[140:143]
    v_mfma_f32_16x16x32_bf16 v[144:147], v[52:55], v[32:35], v[144:147]
    v_mfma_f32_16x16x32_bf16 v[148:151], v[52:55], v[36:39], v[148:151]
    s_waitcnt vmcnt(4) lgkmcnt(0)
    s_barrier
    v_mfma_f32_16x16x32_bf16 v[88:91], v[72:75], v[56:59], v[88:91]
    ds_read_b64_tr_b16 v[40:41], v250 offset:49152
    ds_read_b64_tr_b16 v[42:43], v250 offset:49664
    v_mfma_f32_16x16x32_bf16 v[92:95], v[72:75], v[60:63], v[92:95]
    ds_read_b128 v[24:27], v248 offset:32768
    v_mfma_f32_16x16x32_bf16 v[96:99], v[72:75], v[64:67], v[96:99]
    ds_read_b128 v[28:31], v248 offset:33792
    v_mfma_f32_16x16x32_bf16 v[100:103], v[72:75], v[68:71], v[100:103]
    ds_read_b128 v[32:35], v248 offset:34816
    v_mfma_f32_16x16x32_bf16 v[104:107], v[76:79], v[56:59], v[104:107]
    ds_read_b128 v[36:39], v248 offset:35840
    v_mfma_f32_16x16x32_bf16 v[108:111], v[76:79], v[60:63], v[108:111]
    ds_read_b64_tr_b16 v[44:45], v251 offset:49152
    ds_read_b64_tr_b16 v[46:47], v251 offset:49664
    v_mfma_f32_16x16x32_bf16 v[112:115], v[76:79], v[64:67], v[112:115]
    ds_read_b64_tr_b16 v[48:49], v250 offset:57344
    v_mfma_f32_16x16x32_bf16 v[116:119], v[76:79], v[68:71], v[116:119]
    ds_read_b64_tr_b16 v[50:51], v250 offset:57856
    v_mfma_f32_16x16x32_bf16 v[120:123], v[80:83], v[56:59], v[120:123]
    ds_read_b64_tr_b16 v[52:53], v251 offset:57344
    v_mfma_f32_16x16x32_bf16 v[124:127], v[80:83], v[60:63], v[124:127]
    ds_read_b64_tr_b16 v[54:55], v251 offset:57856
    v_mfma_f32_16x16x32_bf16 v[128:131], v[80:83], v[64:67], v[128:131]
    v_mfma_f32_16x16x32_bf16 v[132:135], v[80:83], v[68:71], v[132:135]
    v_mfma_f32_16x16x32_bf16 v[136:139], v[84:87], v[56:59], v[136:139]
    v_mfma_f32_16x16x32_bf16 v[140:143], v[84:87], v[60:63], v[140:143]
    v_mfma_f32_16x16x32_bf16 v[144:147], v[84:87], v[64:67], v[144:147]
    v_mfma_f32_16x16x32_bf16 v[148:151], v[84:87], v[68:71], v[148:151]
    s_waitcnt lgkmcnt(9)
    v_mfma_f32_16x16x32_bf16 v[88:91], v[40:43], v[24:27], v[88:91]
    ds_read_b64_tr_b16 v[72:73], v250 offset:53248
    ds_read_b64_tr_b16 v[74:75], v250 offset:53760
    s_waitcnt lgkmcnt(10)
    v_mfma_f32_16x16x32_bf16 v[92:95], v[40:43], v[28:31], v[92:95]
    ds_read_b128 v[56:59], v248 offset:40960
    s_waitcnt lgkmcnt(10)
    v_mfma_f32_16x16x32_bf16 v[96:99], v[40:43], v[32:35], v[96:99]
    ds_read_b128 v[60:63], v248 offset:41984
    ds_read_b128 v[64:67], v248 offset:43008
    s_waitcnt lgkmcnt(11)
    v_mfma_f32_16x16x32_bf16 v[100:103], v[40:43], v[36:39], v[100:103]
    ds_read_b128 v[68:71], v248 offset:44032
    s_waitcnt lgkmcnt(10)
    v_mfma_f32_16x16x32_bf16 v[104:107], v[44:47], v[24:27], v[104:107]
    ds_read_b64_tr_b16 v[76:77], v251 offset:53248
    ds_read_b64_tr_b16 v[78:79], v251 offset:53760
    v_mfma_f32_16x16x32_bf16 v[108:111], v[44:47], v[28:31], v[108:111]
    ds_read_b64_tr_b16 v[80:81], v250 offset:61440
    v_mfma_f32_16x16x32_bf16 v[112:115], v[44:47], v[32:35], v[112:115]
    ds_read_b64_tr_b16 v[82:83], v250 offset:61952
    ds_read_b64_tr_b16 v[84:85], v251 offset:61440
    v_mfma_f32_16x16x32_bf16 v[116:119], v[44:47], v[36:39], v[116:119]
    ds_read_b64_tr_b16 v[86:87], v251 offset:61952
    s_waitcnt lgkmcnt(14)
    v_mfma_f32_16x16x32_bf16 v[120:123], v[48:51], v[24:27], v[120:123]
    v_mfma_f32_16x16x32_bf16 v[124:127], v[48:51], v[28:31], v[124:127]
    v_mfma_f32_16x16x32_bf16 v[128:131], v[48:51], v[32:35], v[128:131]
    v_mfma_f32_16x16x32_bf16 v[132:135], v[48:51], v[36:39], v[132:135]
    s_waitcnt lgkmcnt(12)
    v_mfma_f32_16x16x32_bf16 v[136:139], v[52:55], v[24:27], v[136:139]
    v_mfma_f32_16x16x32_bf16 v[140:143], v[52:55], v[28:31], v[140:143]
    v_mfma_f32_16x16x32_bf16 v[144:147], v[52:55], v[32:35], v[144:147]
    v_mfma_f32_16x16x32_bf16 v[148:151], v[52:55], v[36:39], v[148:151]
    s_waitcnt vmcnt(0) lgkmcnt(0)
    s_barrier
    v_mfma_f32_16x16x32_bf16 v[88:91], v[72:75], v[56:59], v[88:91]
    ds_read_b64_tr_b16 v[40:41], v252 offset:16384
    ds_read_b64_tr_b16 v[42:43], v252 offset:16896
    v_mfma_f32_16x16x32_bf16 v[92:95], v[72:75], v[60:63], v[92:95]
    ds_read_b128 v[24:27], v249 offset:0
    v_mfma_f32_16x16x32_bf16 v[96:99], v[72:75], v[64:67], v[96:99]
    ds_read_b128 v[28:31], v249 offset:1024
    v_mfma_f32_16x16x32_bf16 v[100:103], v[72:75], v[68:71], v[100:103]
    ds_read_b128 v[32:35], v249 offset:2048
    v_mfma_f32_16x16x32_bf16 v[104:107], v[76:79], v[56:59], v[104:107]
    ds_read_b128 v[36:39], v249 offset:3072
    v_mfma_f32_16x16x32_bf16 v[108:111], v[76:79], v[60:63], v[108:111]
    ds_read_b64_tr_b16 v[44:45], v253 offset:16384
    ds_read_b64_tr_b16 v[46:47], v253 offset:16896
    v_mfma_f32_16x16x32_bf16 v[112:115], v[76:79], v[64:67], v[112:115]
    ds_read_b64_tr_b16 v[48:49], v252 offset:24576
    v_mfma_f32_16x16x32_bf16 v[116:119], v[76:79], v[68:71], v[116:119]
    ds_read_b64_tr_b16 v[50:51], v252 offset:25088
    v_mfma_f32_16x16x32_bf16 v[120:123], v[80:83], v[56:59], v[120:123]
    ds_read_b64_tr_b16 v[52:53], v253 offset:24576
    v_mfma_f32_16x16x32_bf16 v[124:127], v[80:83], v[60:63], v[124:127]
    ds_read_b64_tr_b16 v[54:55], v253 offset:25088
    v_mfma_f32_16x16x32_bf16 v[128:131], v[80:83], v[64:67], v[128:131]
    v_mfma_f32_16x16x32_bf16 v[132:135], v[80:83], v[68:71], v[132:135]
    v_mfma_f32_16x16x32_bf16 v[136:139], v[84:87], v[56:59], v[136:139]
    v_mfma_f32_16x16x32_bf16 v[140:143], v[84:87], v[60:63], v[140:143]
    v_mfma_f32_16x16x32_bf16 v[144:147], v[84:87], v[64:67], v[144:147]
    v_mfma_f32_16x16x32_bf16 v[148:151], v[84:87], v[68:71], v[148:151]
    s_waitcnt lgkmcnt(9)
    v_mfma_f32_16x16x32_bf16 v[88:91], v[40:43], v[24:27], v[88:91]
    ds_read_b64_tr_b16 v[72:73], v252 offset:20480
    ds_read_b64_tr_b16 v[74:75], v252 offset:20992
    s_waitcnt lgkmcnt(10)
    v_mfma_f32_16x16x32_bf16 v[92:95], v[40:43], v[28:31], v[92:95]
    ds_read_b128 v[56:59], v249 offset:8192
    s_waitcnt lgkmcnt(10)
    v_mfma_f32_16x16x32_bf16 v[96:99], v[40:43], v[32:35], v[96:99]
    ds_read_b128 v[60:63], v249 offset:9216
    ds_read_b128 v[64:67], v249 offset:10240
    s_waitcnt lgkmcnt(11)
    v_mfma_f32_16x16x32_bf16 v[100:103], v[40:43], v[36:39], v[100:103]
    ds_read_b128 v[68:71], v249 offset:11264
    s_waitcnt lgkmcnt(10)
    v_mfma_f32_16x16x32_bf16 v[104:107], v[44:47], v[24:27], v[104:107]
    ds_read_b64_tr_b16 v[76:77], v253 offset:20480
    ds_read_b64_tr_b16 v[78:79], v253 offset:20992
    v_mfma_f32_16x16x32_bf16 v[108:111], v[44:47], v[28:31], v[108:111]
    ds_read_b64_tr_b16 v[80:81], v252 offset:28672
    v_mfma_f32_16x16x32_bf16 v[112:115], v[44:47], v[32:35], v[112:115]
    ds_read_b64_tr_b16 v[82:83], v252 offset:29184
    ds_read_b64_tr_b16 v[84:85], v253 offset:28672
    v_mfma_f32_16x16x32_bf16 v[116:119], v[44:47], v[36:39], v[116:119]
    ds_read_b64_tr_b16 v[86:87], v253 offset:29184
    s_waitcnt lgkmcnt(14)
    v_mfma_f32_16x16x32_bf16 v[120:123], v[48:51], v[24:27], v[120:123]
    v_mfma_f32_16x16x32_bf16 v[124:127], v[48:51], v[28:31], v[124:127]
    v_mfma_f32_16x16x32_bf16 v[128:131], v[48:51], v[32:35], v[128:131]
    v_mfma_f32_16x16x32_bf16 v[132:135], v[48:51], v[36:39], v[132:135]
    s_waitcnt lgkmcnt(12)
    v_mfma_f32_16x16x32_bf16 v[136:139], v[52:55], v[24:27], v[136:139]
    v_mfma_f32_16x16x32_bf16 v[140:143], v[52:55], v[28:31], v[140:143]
    v_mfma_f32_16x16x32_bf16 v[144:147], v[52:55], v[32:35], v[144:147]
    v_mfma_f32_16x16x32_bf16 v[148:151], v[52:55], v[36:39], v[148:151]
    s_waitcnt lgkmcnt(0)
    s_barrier
    v_mfma_f32_16x16x32_bf16 v[88:91], v[72:75], v[56:59], v[88:91]
    ds_read_b64_tr_b16 v[40:41], v250 offset:16384
    ds_read_b64_tr_b16 v[42:43], v250 offset:16896
    v_mfma_f32_16x16x32_bf16 v[92:95], v[72:75], v[60:63], v[92:95]
    ds_read_b128 v[24:27], v248 offset:0
    v_mfma_f32_16x16x32_bf16 v[96:99], v[72:75], v[64:67], v[96:99]
    ds_read_b128 v[28:31], v248 offset:1024
    v_mfma_f32_16x16x32_bf16 v[100:103], v[72:75], v[68:71], v[100:103]
    ds_read_b128 v[32:35], v248 offset:2048
    v_mfma_f32_16x16x32_bf16 v[104:107], v[76:79], v[56:59], v[104:107]
    ds_read_b128 v[36:39], v248 offset:3072
    v_mfma_f32_16x16x32_bf16 v[108:111], v[76:79], v[60:63], v[108:111]
    ds_read_b64_tr_b16 v[44:45], v251 offset:16384
    ds_read_b64_tr_b16 v[46:47], v251 offset:16896
    v_mfma_f32_16x16x32_bf16 v[112:115], v[76:79], v[64:67], v[112:115]
    ds_read_b64_tr_b16 v[48:49], v250 offset:24576
    v_mfma_f32_16x16x32_bf16 v[116:119], v[76:79], v[68:71], v[116:119]
    ds_read_b64_tr_b16 v[50:51], v250 offset:25088
    v_mfma_f32_16x16x32_bf16 v[120:123], v[80:83], v[56:59], v[120:123]
    ds_read_b64_tr_b16 v[52:53], v251 offset:24576
    v_mfma_f32_16x16x32_bf16 v[124:127], v[80:83], v[60:63], v[124:127]
    ds_read_b64_tr_b16 v[54:55], v251 offset:25088
    v_mfma_f32_16x16x32_bf16 v[128:131], v[80:83], v[64:67], v[128:131]
    v_mfma_f32_16x16x32_bf16 v[132:135], v[80:83], v[68:71], v[132:135]
    v_mfma_f32_16x16x32_bf16 v[136:139], v[84:87], v[56:59], v[136:139]
    v_mfma_f32_16x16x32_bf16 v[140:143], v[84:87], v[60:63], v[140:143]
    v_mfma_f32_16x16x32_bf16 v[144:147], v[84:87], v[64:67], v[144:147]
    v_mfma_f32_16x16x32_bf16 v[148:151], v[84:87], v[68:71], v[148:151]
    s_sub_u32 s34, s34, 1
    s_cmp_lg_u32 s34, 0
    s_cbranch_scc1 L_d
    s_waitcnt lgkmcnt(9)
    v_mfma_f32_16x16x32_bf16 v[88:91], v[40:43], v[24:27], v[88:91]
    ds_read_b64_tr_b16 v[72:73], v250 offset:20480
    ds_read_b64_tr_b16 v[74:75], v250 offset:20992
    s_waitcnt lgkmcnt(10)
    v_mfma_f32_16x16x32_bf16 v[92:95], v[40:43], v[28:31], v[92:95]
    ds_read_b128 v[56:59], v248 offset:8192
    s_waitcnt lgkmcnt(10)
    v_mfma_f32_16x16x32_bf16 v[96:99], v[40:43], v[32:35], v[96:99]
    ds_read_b128 v[60:63], v248 offset:9216
    ds_read_b128 v[64:67], v248 offset:10240
    s_waitcnt lgkmcnt(11)
    v_mfma_f32_16x16x32_bf16 v[100:103], v[40:43], v[36:39], v[100:103]
    ds_read_b128 v[68:71], v248 offset:11264
    s_waitcnt lgkmcnt(10)
    v_mfma_f32_16x16x32_bf16 v[104:107], v[44:47], v[24:27], v[104:107]
    ds_read_b64_tr_b16 v[76:77], v251 offset:20480
    ds_read_b64_tr_b16 v[78:79], v251 offset:20992
    v_mfma_f32_16x16x32_bf16 v[108:111], v[44:47], v[28:31], v[108:111]
    ds_read_b64_tr_b16 v[80:81], v250 offset:28672
    v_mfma_f32_16x16x32_bf16 v[112:115], v[44:47], v[32:35], v[112:115]
    ds_read_b64_tr_b16 v[82:83], v250 offset:29184
    ds_read_b64_tr_b16 v[84:85], v251 offset:28672
    v_mfma_f32_16x16x32_bf16 v[116:119], v[44:47], v[36:39], v[116:119]
    ds_read_b64_tr_b16 v[86:87], v251 offset:29184
    s_waitcnt lgkmcnt(14)
    v_mfma_f32_16x16x32_bf16 v[120:123], v[48:51], v[24:27], v[120:123]
    v_mfma_f32_16x16x32_bf16 v[124:127], v[48:51], v[28:31], v[124:127]
    v_mfma_f32_16x16x32_bf16 v[128:131], v[48:51], v[32:35], v[128:131]
    v_mfma_f32_16x16x32_bf16 v[132:135], v[48:51], v[36:39], v[132:135]
    s_waitcnt lgkmcnt(12)
    v_mfma_f32_16x16x32_bf16 v[136:139], v[52:55], v[24:27], v[136:139]
    v_mfma_f32_16x16x32_bf16 v[140:143], v[52:55], v[28:31], v[140:143]
    v_mfma_f32_16x16x32_bf16 v[144:147], v[52:55], v[32:35], v[144:147]
    v_mfma_f32_16x16x32_bf16 v[148:151], v[52:55], v[36:39], v[148:151]
    s_waitcnt lgkmcnt(0)
    s_barrier
    v_mfma_f32_16x16x32_bf16 v[88:91], v[72:75], v[56:59], v[88:91]
    ds_read_b64_tr_b16 v[40:41], v252 offset:49152
    ds_read_b64_tr_b16 v[42:43], v252 offset:49664
    v_mfma_f32_16x16x32_bf16 v[92:95], v[72:75], v[60:63], v[92:95]
    ds_read_b128 v[24:27], v249 offset:32768
    v_mfma_f32_16x16x32_bf16 v[96:99], v[72:75], v[64:67], v[96:99]
    ds_read_b128 v[28:31], v249 offset:33792
    v_mfma_f32_16x16x32_bf16 v[100:103], v[72:75], v[68:71], v[100:103]
    ds_read_b128 v[32:35], v249 offset:34816
    v_mfma_f32_16x16x32_bf16 v[104:107], v[76:79], v[56:59], v[104:107]
    ds_read_b128 v[36:39], v249 offset:35840
    v_mfma_f32_16x16x32_bf16 v[108:111], v[76:79], v[60:63], v[108:111]
    ds_read_b64_tr_b16 v[44:45], v253 offset:49152
    ds_read_b64_tr_b16 v[46:47], v253 offset:49664
    v_mfma_f32_16x16x32_bf16 v[112:115], v[76:79], v[64:67], v[112:115]
    ds_read_b64_tr_b16 v[48:49], v252 offset:57344
    v_mfma_f32_16x16x32_bf16 v[116:119], v[76:79], v[68:71], v[116:119]
    ds_read_b64_tr_b16 v[50:51], v252 offset:57856
    v_mfma_f32_16x16x32_bf16 v[120:123], v[80:83], v[56:59], v[120:123]
    ds_read_b64_tr_b16 v[52:53], v253 offset:57344
    v_mfma_f32_16x16x32_bf16 v[124:127], v[80:83], v[60:63], v[124:127]
    ds_read_b64_tr_b16 v[54:55], v253 offset:57856
    v_mfma_f32_16x16x32_bf16 v[128:131], v[80:83], v[64:67], v[128:131]
    v_mfma_f32_16x16x32_bf16 v[132:135], v[80:83], v[68:71], v[132:135]
    v_mfma_f32_16x16x32_bf16 v[136:139], v[84:87], v[56:59], v[136:139]
    v_mfma_f32_16x16x32_bf16 v[140:143], v[84:87], v[60:63], v[140:143]
    v_mfma_f32_16x16x32_bf16 v[144:147], v[84:87], v[64:67], v[144:147]
    v_mfma_f32_16x16x32_bf16 v[148:151], v[84:87], v[68:71], v[148:151]
    s_waitcnt lgkmcnt(9)
    v_mfma_f32_16x16x32_bf16 v[88:91], v[40:43], v[24:27], v[88:91]
    ds_read_b64_tr_b16 v[72:73], v252 offset:53248
    ds_read_b64_tr_b16 v[74:75], v252 offset:53760
    s_waitcnt lgkmcnt(10)
    v_mfma_f32_16x16x32_bf16 v[92:95], v[40:43], v[28:31], v[92:95]
    ds_read_b128 v[56:59], v249 offset:40960
    s_waitcnt lgkmcnt(10)
    v_mfma_f32_16x16x32_bf16 v[96:99], v[40:43], v[32:35], v[96:99]
    ds_read_b128 v[60:63], v249 offset:41984
    ds_read_b128 v[64:67], v249 offset:43008
    s_waitcnt lgkmcnt(11)
    v_mfma_f32_16x16x32_bf16 v[100:103], v[40:43], v[36:39], v[100:103]
    ds_read_b128 v[68:71], v249 offset:44032
    s_waitcnt lgkmcnt(10)
    v_mfma_f32_16x16x32_bf16 v[104:107], v[44:47], v[24:27], v[104:107]
    ds_read_b64_tr_b16 v[76:77], v253 offset:53248
    ds_read_b64_tr_b16 v[78:79], v253 offset:53760
    v_mfma_f32_16x16x32_bf16 v[108:111], v[44:47], v[28:31], v[108:111]
    ds_read_b64_tr_b16 v[80:81], v252 offset:61440
    v_mfma_f32_16x16x32_bf16 v[112:115], v[44:47], v[32:35], v[112:115]
    ds_read_b64_tr_b16 v[82:83], v252 offset:61952
    ds_read_b64_tr_b16 v[84:85], v253 offset:61440
    v_mfma_f32_16x16x32_bf16 v[116:119], v[44:47], v[36:39], v[116:119]
    ds_read_b64_tr_b16 v[86:87], v253 offset:61952
    s_waitcnt lgkmcnt(14)
    v_mfma_f32_16x16x32_bf16 v[120:123], v[48:51], v[24:27], v[120:123]
    v_mfma_f32_16x16x32_bf16 v[124:127], v[48:51], v[28:31], v[124:127]
    v_mfma_f32_16x16x32_bf16 v[128:131], v[48:51], v[32:35], v[128:131]
    v_mfma_f32_16x16x32_bf16 v[132:135], v[48:51], v[36:39], v[132:135]
    s_waitcnt lgkmcnt(12)
    v_mfma_f32_16x16x32_bf16 v[136:139], v[52:55], v[24:27], v[136:139]
    v_mfma_f32_16x16x32_bf16 v[140:143], v[52:55], v[28:31], v[140:143]
    v_mfma_f32_16x16x32_bf16 v[144:147], v[52:55], v[32:35], v[144:147]
    v_mfma_f32_16x16x32_bf16 v[148:151], v[52:55], v[36:39], v[148:151]
    s_waitcnt lgkmcnt(0)
    s_barrier
    v_mfma_f32_16x16x32_bf16 v[88:91], v[72:75], v[56:59], v[88:91]
    ds_read_b64_tr_b16 v[40:41], v250 offset:49152
    ds_read_b64_tr_b16 v[42:43], v250 offset:49664
    v_mfma_f32_16x16x32_bf16 v[92:95], v[72:75], v[60:63], v[92:95]
    ds_read_b128 v[24:27], v248 offset:32768
    v_mfma_f32_16x16x32_bf16 v[96:99], v[72:75], v[64:67], v[96:99]
    ds_read_b128 v[28:31], v248 offset:33792
    v_mfma_f32_16x16x32_bf16 v[100:103], v[72:75], v[68:71], v[100:103]
    ds_read_b128 v[32:35], v248 offset:34816
    v_mfma_f32_16x16x32_bf16 v[104:107], v[76:79], v[56:59], v[104:107]
    ds_read_b128 v[36:39], v248 offset:35840
    v_mfma_f32_16x16x32_bf16 v[108:111], v[76:79], v[60:63], v[108:111]
    ds_read_b64_tr_b16 v[44:45], v251 offset:49152
    ds_read_b64_tr_b16 v[46:47], v251 offset:49664
    v_mfma_f32_16x16x32_bf16 v[112:115], v[76:79], v[64:67], v[112:115]
    ds_read_b64_tr_b16 v[48:49], v250 offset:57344
    v_mfma_f32_16x16x32_bf16 v[116:119], v[76:79], v[68:71], v[116:119]
    ds_read_b64_tr_b16 v[50:51], v250 offset:57856
    v_mfma_f32_16x16x32_bf16 v[120:123], v[80:83], v[56:59], v[120:123]
    ds_read_b64_tr_b16 v[52:53], v251 offset:57344
    v_mfma_f32_16x16x32_bf16 v[124:127], v[80:83], v[60:63], v[124:127]
    ds_read_b64_tr_b16 v[54:55], v251 offset:57856
    v_mfma_f32_16x16x32_bf16 v[128:131], v[80:83], v[64:67], v[128:131]
    v_mfma_f32_16x16x32_bf16 v[132:135], v[80:83], v[68:71], v[132:135]
    v_mfma_f32_16x16x32_bf16 v[136:139], v[84:87], v[56:59], v[136:139]
    v_mfma_f32_16x16x32_bf16 v[140:143], v[84:87], v[60:63], v[140:143]
    v_mfma_f32_16x16x32_bf16 v[144:147], v[84:87], v[64:67], v[144:147]
    v_mfma_f32_16x16x32_bf16 v[148:151], v[84:87], v[68:71], v[148:151]
    s_waitcnt lgkmcnt(9)
    v_mfma_f32_16x16x32_bf16 v[88:91], v[40:43], v[24:27], v[88:91]
    ds_read_b64_tr_b16 v[72:73], v250 offset:53248
    ds_read_b64_tr_b16 v[74:75], v250 offset:53760
    s_waitcnt lgkmcnt(10)
    v_mfma_f32_16x16x32_bf16 v[92:95], v[40:43], v[28:31], v[92:95]
    ds_read_b128 v[56:59], v248 offset:40960
    s_waitcnt lgkmcnt(10)
    v_mfma_f32_16x16x32_bf16 v[96:99], v[40:43], v[32:35], v[96:99]
    ds_read_b128 v[60:63], v248 offset:41984
    ds_read_b128 v[64:67], v248 offset:43008
    s_waitcnt lgkmcnt(11)
    v_mfma_f32_16x16x32_bf16 v[100:103], v[40:43], v[36:39], v[100:103]
    ds_read_b128 v[68:71], v248 offset:44032
    s_waitcnt lgkmcnt(10)
    v_mfma_f32_16x16x32_bf16 v[104:107], v[44:47], v[24:27], v[104:107]
    ds_read_b64_tr_b16 v[76:77], v251 offset:53248
    ds_read_b64_tr_b16 v[78:79], v251 offset:53760
    v_mfma_f32_16x16x32_bf16 v[108:111], v[44:47], v[28:31], v[108:111]
    ds_read_b64_tr_b16 v[80:81], v250 offset:61440
    v_mfma_f32_16x16x32_bf16 v[112:115], v[44:47], v[32:35], v[112:115]
    ds_read_b64_tr_b16 v[82:83], v250 offset:61952
    ds_read_b64_tr_b16 v[84:85], v251 offset:61440
    v_mfma_f32_16x16x32_bf16 v[116:119], v[44:47], v[36:39], v[116:119]
    ds_read_b64_tr_b16 v[86:87], v251 offset:61952
    s_waitcnt lgkmcnt(14)
    v_mfma_f32_16x16x32_bf16 v[120:123], v[48:51], v[24:27], v[120:123]
    v_mfma_f32_16x16x32_bf16 v[124:127], v[48:51], v[28:31], v[124:127]
    v_mfma_f32_16x16x32_bf16 v[128:131], v[48:51], v[32:35], v[128:131]
    v_mfma_f32_16x16x32_bf16 v[132:135], v[48:51], v[36:39], v[132:135]
    s_waitcnt lgkmcnt(12)
    v_mfma_f32_16x16x32_bf16 v[136:139], v[52:55], v[24:27], v[136:139]
    v_mfma_f32_16x16x32_bf16 v[140:143], v[52:55], v[28:31], v[140:143]
    v_mfma_f32_16x16x32_bf16 v[144:147], v[52:55], v[32:35], v[144:147]
    v_mfma_f32_16x16x32_bf16 v[148:151], v[52:55], v[36:39], v[148:151]
    s_waitcnt lgkmcnt(0)
    s_barrier
    v_mfma_f32_16x16x32_bf16 v[88:91], v[72:75], v[56:59], v[88:91]
    ds_read_b64_tr_b16 v[40:41], v252 offset:16384
    ds_read_b64_tr_b16 v[42:43], v252 offset:16896
    v_mfma_f32_16x16x32_bf16 v[92:95], v[72:75], v[60:63], v[92:95]
    ds_read_b128 v[24:27], v249 offset:0
    v_mfma_f32_16x16x32_bf16 v[96:99], v[72:75], v[64:67], v[96:99]
    ds_read_b128 v[28:31], v249 offset:1024
    v_mfma_f32_16x16x32_bf16 v[100:103], v[72:75], v[68:71], v[100:103]
    ds_read_b128 v[32:35], v249 offset:2048
    v_mfma_f32_16x16x32_bf16 v[104:107], v[76:79], v[56:59], v[104:107]
    ds_read_b128 v[36:39], v249 offset:3072
    v_mfma_f32_16x16x32_bf16 v[108:111], v[76:79], v[60:63], v[108:111]
    ds_read_b64_tr_b16 v[44:45], v253 offset:16384
    ds_read_b64_tr_b16 v[46:47], v253 offset:16896
    v_mfma_f32_16x16x32_bf16 v[112:115], v[76:79], v[64:67], v[112:115]
    ds_read_b64_tr_b16 v[48:49], v252 offset:24576
    v_mfma_f32_16x16x32_bf16 v[116:119], v[76:79], v[68:71], v[116:119]
    ds_read_b64_tr_b16 v[50:51], v252 offset:25088
    v_mfma_f32_16x16x32_bf16 v[120:123], v[80:83], v[56:59], v[120:123]
    ds_read_b64_tr_b16 v[52:53], v253 offset:24576
    v_mfma_f32_16x16x32_bf16 v[124:127], v[80:83], v[60:63], v[124:127]
    ds_read_b64_tr_b16 v[54:55], v253 offset:25088
    v_mfma_f32_16x16x32_bf16 v[128:131], v[80:83], v[64:67], v[128:131]
    v_mfma_f32_16x16x32_bf16 v[132:135], v[80:83], v[68:71], v[132:135]
    v_mfma_f32_16x16x32_bf16 v[136:139], v[84:87], v[56:59], v[136:139]
    v_mfma_f32_16x16x32_bf16 v[140:143], v[84:87], v[60:63], v[140:143]
    v_mfma_f32_16x16x32_bf16 v[144:147], v[84:87], v[64:67], v[144:147]
    v_mfma_f32_16x16x32_bf16 v[148:151], v[84:87], v[68:71], v[148:151]
    s_waitcnt lgkmcnt(9)
    v_mfma_f32_16x16x32_bf16 v[88:91], v[40:43], v[24:27], v[88:91]
    ds_read_b64_tr_b16 v[72:73], v252 offset:20480
    ds_read_b64_tr_b16 v[74:75], v252 offset:20992
    s_waitcnt lgkmcnt(10)
    v_mfma_f32_16x16x32_bf16 v[92:95], v[40:43], v[28:31], v[92:95]
    ds_read_b128 v[56:59], v249 offset:8192
    s_waitcnt lgkmcnt(10)
    v_mfma_f32_16x16x32_bf16 v[96:99], v[40:43], v[32:35], v[96:99]
    ds_read_b128 v[60:63], v249 offset:9216
    ds_read_b128 v[64:67], v249 offset:10240
    s_waitcnt lgkmcnt(11)
    v_mfma_f32_16x16x32_bf16 v[100:103], v[40:43], v[36:39], v[100:103]
    ds_read_b128 v[68:71], v249 offset:11264
    s_waitcnt lgkmcnt(10)
    v_mfma_f32_16x16x32_bf16 v[104:107], v[44:47], v[24:27], v[104:107]
    ds_read_b64_tr_b16 v[76:77], v253 offset:20480
    ds_read_b64_tr_b16 v[78:79], v253 offset:20992
    v_mfma_f32_16x16x32_bf16 v[108:111], v[44:47], v[28:31], v[108:111]
    ds_read_b64_tr_b16 v[80:81], v252 offset:28672
    v_mfma_f32_16x16x32_bf16 v[112:115], v[44:47], v[32:35], v[112:115]
    ds_read_b64_tr_b16 v[82:83], v252 offset:29184
    ds_read_b64_tr_b16 v[84:85], v253 offset:28672
    v_mfma_f32_16x16x32_bf16 v[116:119], v[44:47], v[36:39], v[116:119]
    ds_read_b64_tr_b16 v[86:87], v253 offset:29184
    s_waitcnt lgkmcnt(14)
    v_mfma_f32_16x16x32_bf16 v[120:123], v[48:51], v[24:27], v[120:123]
    v_mfma_f32_16x16x32_bf16 v[124:127], v[48:51], v[28:31], v[124:127]
    v_mfma_f32_16x16x32_bf16 v[128:131], v[48:51], v[32:35], v[128:131]
    v_mfma_f32_16x16x32_bf16 v[132:135], v[48:51], v[36:39], v[132:135]
    s_waitcnt lgkmcnt(12)
    v_mfma_f32_16x16x32_bf16 v[136:139], v[52:55], v[24:27], v[136:139]
    v_mfma_f32_16x16x32_bf16 v[140:143], v[52:55], v[28:31], v[140:143]
    v_mfma_f32_16x16x32_bf16 v[144:147], v[52:55], v[32:35], v[144:147]
    v_mfma_f32_16x16x32_bf16 v[148:151], v[52:55], v[36:39], v[148:151]
    s_waitcnt lgkmcnt(0)
    s_barrier
    v_mfma_f32_16x16x32_bf16 v[88:91], v[72:75], v[56:59], v[88:91]
    v_mfma_f32_16x16x32_bf16 v[92:95], v[72:75], v[60:63], v[92:95]
    v_mfma_f32_16x16x32_bf16 v[96:99], v[72:75], v[64:67], v[96:99]
    v_mfma_f32_16x16x32_bf16 v[100:103], v[72:75], v[68:71], v[100:103]
    v_mfma_f32_16x16x32_bf16 v[104:107], v[76:79], v[56:59], v[104:107]
    v_mfma_f32_16x16x32_bf16 v[108:111], v[76:79], v[60:63], v[108:111]
    v_mfma_f32_16x16x32_bf16 v[112:115], v[76:79], v[64:67], v[112:115]
    v_mfma_f32_16x16x32_bf16 v[116:119], v[76:79], v[68:71], v[116:119]
    v_mfma_f32_16x16x32_bf16 v[120:123], v[80:83], v[56:59], v[120:123]
    v_mfma_f32_16x16x32_bf16 v[124:127], v[80:83], v[60:63], v[124:127]
    v_mfma_f32_16x16x32_bf16 v[128:131], v[80:83], v[64:67], v[128:131]
    v_mfma_f32_16x16x32_bf16 v[132:135], v[80:83], v[68:71], v[132:135]
    v_mfma_f32_16x16x32_bf16 v[136:139], v[84:87], v[56:59], v[136:139]
    v_mfma_f32_16x16x32_bf16 v[140:143], v[84:87], v[60:63], v[140:143]
    v_mfma_f32_16x16x32_bf16 v[144:147], v[84:87], v[64:67], v[144:147]
    v_mfma_f32_16x16x32_bf16 v[148:151], v[84:87], v[68:71], v[148:151]
    s_setprio 0
    s_nop 7
    buffer_store_dwordx4 v[120:123], v4, s[68:71], s36 offen offset:0 sc1
    buffer_store_dwordx4 v[124:127], v4, s[68:71], s36 offen offset:1024 sc1
    s_barrier
    buffer_store_dwordx4 v[128:131], v4, s[68:71], s36 offen offset:2048 sc1
    buffer_store_dwordx4 v[132:135], v4, s[68:71], s36 offen offset:3072 sc1
    s_barrier
    buffer_store_dwordx4 v[136:139], v4, s[68:71], s37 offen offset:0 sc1
    buffer_store_dwordx4 v[140:143], v4, s[68:71], s37 offen offset:1024 sc1
    s_barrier
    buffer_store_dwordx4 v[144:147], v4, s[68:71], s37 offen offset:2048 sc1
    buffer_store_dwordx4 v[148:151], v4, s[68:71], s37 offen offset:3072 sc1
    s_barrier
    s_barrier
    s_barrier
    s_waitcnt vmcnt(0)
    s_barrier
    s_cmp_lg_u32 s4, 0
    s_cbranch_scc1 L_fP
    s_lshl_b32 s91, s28, 4
    s_add_u32 s91, s91, s29
    s_lshl_b32 s91, s91, 7
    s_add_u32 s91, s91, 0x1ea0000
    v_mov_b32 v12, s91
    v_mov_b32 v14, s100
    v_mov_b32 v15, s101
    s_mov_b64 exec, 1
    global_store_dwordx2 v12, v[14:15], s[26:27] sc1
    s_mov_b64 exec, -1
L_fP:
    s_lshl4_add_u32 s91, s28, s29
    s_xor_b32 s91, s91, 128
    s_lshl_b32 s91, s91, 7
    s_add_u32 s91, s91, 0x1ea0000
    v_mov_b32 v13, s91
    s_barrier
    s_mov_b64 exec, 1
    global_load_dwordx2 v[14:15], v13, s[26:27] sc1
    s_mov_b64 exec, -1
    s_barrier
    s_barrier
    s_waitcnt vmcnt(0)
    s_mov_b64 exec, 1
    s_movk_i32 s98, 0x4000
L_pP_chk:
    v_cmp_ne_u64 vcc, s[100:101], v[14:15]
    s_nop 1
    s_cmp_eq_u64 vcc, 0
    s_cbranch_scc1 L_pP_ok
    s_sub_u32 s98, s98, 1
    s_cbranch_scc1 L_pP_ok
    s_sleep 1
    global_load_dwordx2 v[14:15], v13, s[26:27] sc1
    s_waitcnt vmcnt(0)
    s_branch L_pP_chk
L_pP_ok:
    s_mov_b64 exec, -1
    buffer_load_dwordx4 v[152:155], v4, s[68:71], s38 offen offset:0 sc1
    buffer_load_dwordx4 v[156:159], v4, s[68:71], s38 offen offset:1024 sc1
    s_barrier
    buffer_load_dwordx4 v[160:163], v4, s[68:71], s38 offen offset:2048 sc1
    buffer_load_dwordx4 v[164:167], v4, s[68:71], s38 offen offset:3072 sc1
    s_barrier
    buffer_load_dwordx4 v[168:171], v4, s[68:71], s39 offen offset:0 sc1
    buffer_load_dwordx4 v[172:175], v4, s[68:71], s39 offen offset:1024 sc1
    s_barrier
    buffer_load_dwordx4 v[176:179], v4, s[68:71], s39 offen offset:2048 sc1
    buffer_load_dwordx4 v[180:183], v4, s[68:71], s39 offen offset:3072 sc1
    s_waitcnt vmcnt(7)
    v_add_f32 v88, v88, v152
    v_add_f32 v89, v89, v153
    v_add_f32 v90, v90, v154
    v_add_f32 v91, v91, v155
    v_cvt_pk_bf16_f32 v28, v88, v89
    v_cvt_pk_bf16_f32 v29, v90, v91
    v_lshlrev_b32 v88, 16, v28
    v_and_b32 v89, 0xffff0000, v28
    v_lshlrev_b32 v90, 16, v29
    v_and_b32 v91, 0xffff0000, v29
    v_mul_f32 v24, 0xbfb8aa3b, v88
    v_mul_f32 v25, 0xbfb8aa3b, v89
    v_mul_f32 v26, 0xbfb8aa3b, v90
    v_mul_f32 v27, 0xbfb8aa3b, v91
    v_exp_f32 v24, v24
    v_exp_f32 v25, v25
    v_exp_f32 v26, v26
    v_exp_f32 v27, v27
    s_nop 0
    v_add_f32 v24, 1.0, v24
    v_add_f32 v25, 1.0, v25
    v_add_f32 v26, 1.0, v26
    v_add_f32 v27, 1.0, v27
    v_rcp_f32 v24, v24
    v_rcp_f32 v25, v25
    v_rcp_f32 v26, v26
    v_rcp_f32 v27, v27
    s_nop 0
    v_mul_f32 v24, v24, v88
    v_mul_f32 v25, v25, v89
    v_mul_f32 v26, v26, v90
    v_mul_f32 v27, v27, v91
    v_cvt_pk_bf16_f32 v88, v24, v25
    v_cvt_pk_bf16_f32 v89, v26, v27
    ds_write_b64 v5, v[88:89] offset:0
    s_waitcnt vmcnt(6)
    v_add_f32 v92, v92, v156
    v_add_f32 v93, v93, v157
    v_add_f32 v94, v94, v158
    v_add_f32 v95, v95, v159
    v_cvt_pk_bf16_f32 v28, v92, v93
    v_cvt_pk_bf16_f32 v29, v94, v95
    v_lshlrev_b32 v92, 16, v28
    v_and_b32 v93, 0xffff0000, v28
    v_lshlrev_b32 v94, 16, v29
    v_and_b32 v95, 0xffff0000, v29
    v_mul_f32 v24, 0xbfb8aa3b, v92
    v_mul_f32 v25, 0xbfb8aa3b, v93
    v_mul_f32 v26, 0xbfb8aa3b, v94
    v_mul_f32 v27, 0xbfb8aa3b, v95
    v_exp_f32 v24, v24
    v_exp_f32 v25, v25
    v_exp_f32 v26, v26
    v_exp_f32 v27, v27
    s_nop 0
    v_add_f32 v24, 1.0, v24
    v_add_f32 v25, 1.0, v25
    v_add_f32 v26, 1.0, v26
    v_add_f32 v27, 1.0, v27
    v_rcp_f32 v24, v24
    v_rcp_f32 v25, v25
    v_rcp_f32 v26, v26
    v_rcp_f32 v27, v27
    s_nop 0
    v_mul_f32 v24, v24, v92
    v_mul_f32 v25, v25, v93
    v_mul_f32 v26, v26, v94
    v_mul_f32 v27, v27, v95
    v_cvt_pk_bf16_f32 v92, v24, v25
    v_cvt_pk_bf16_f32 v93, v26, v27
    ds_write_b64 v5, v[92:93] offset:512
    s_waitcnt vmcnt(5)
    v_add_f32 v96, v96, v160
    v_add_f32 v97, v97, v161
    v_add_f32 v98, v98, v162
    v_add_f32 v99, v99, v163
    v_cvt_pk_bf16_f32 v28, v96, v97
    v_cvt_pk_bf16_f32 v29, v98, v99
    v_lshlrev_b32 v96, 16, v28
    v_and_b32 v97, 0xffff0000, v28
    v_lshlrev_b32 v98, 16, v29
    v_and_b32 v99, 0xffff0000, v29
    v_mul_f32 v24, 0xbfb8aa3b, v96
    v_mul_f32 v25, 0xbfb8aa3b, v97
    v_mul_f32 v26, 0xbfb8aa3b, v98
    v_mul_f32 v27, 0xbfb8aa3b, v99
    v_exp_f32 v24, v24
    v_exp_f32 v25, v25
    v_exp_f32 v26, v26
    v_exp_f32 v27, v27
    s_nop 0
    v_add_f32 v24, 1.0, v24
    v_add_f32 v25, 1.0, v25
    v_add_f32 v26, 1.0, v26
    v_add_f32 v27, 1.0, v27
    v_rcp_f32 v24, v24
    v_rcp_f32 v25, v25
    v_rcp_f32 v26, v26
    v_rcp_f32 v27, v27
    s_nop 0
    v_mul_f32 v24, v24, v96
    v_mul_f32 v25, v25, v97
    v_mul_f32 v26, v26, v98
    v_mul_f32 v27, v27, v99
    v_cvt_pk_bf16_f32 v96, v24, v25
    v_cvt_pk_bf16_f32 v97, v26, v27
    s_barrier
    ds_write_b64 v5, v[96:97] offset:1024
    s_waitcnt vmcnt(4)
    v_add_f32 v100, v100, v164
    v_add_f32 v101, v101, v165
    v_add_f32 v102, v102, v166
    v_add_f32 v103, v103, v167
    v_cvt_pk_bf16_f32 v28, v100, v101
    v_cvt_pk_bf16_f32 v29, v102, v103
    v_lshlrev_b32 v100, 16, v28
    v_and_b32 v101, 0xffff0000, v28
    v_lshlrev_b32 v102, 16, v29
    v_and_b32 v103, 0xffff0000, v29
    v_mul_f32 v24, 0xbfb8aa3b, v100
    v_mul_f32 v25, 0xbfb8aa3b, v101
    v_mul_f32 v26, 0xbfb8aa3b, v102
    v_mul_f32 v27, 0xbfb8aa3b, v103
    v_exp_f32 v24, v24
    v_exp_f32 v25, v25
    v_exp_f32 v26, v26
    v_exp_f32 v27, v27
    s_nop 0
    v_add_f32 v24, 1.0, v24
    v_add_f32 v25, 1.0, v25
    v_add_f32 v26, 1.0, v26
    v_add_f32 v27, 1.0, v27
    v_rcp_f32 v24, v24
    v_rcp_f32 v25, v25
    v_rcp_f32 v26, v26
    v_rcp_f32 v27, v27
    s_nop 0
    v_mul_f32 v24, v24, v100
    v_mul_f32 v25, v25, v101
    v_mul_f32 v26, v26, v102
    v_mul_f32 v27, v27, v103
    v_cvt_pk_bf16_f32 v100, v24, v25
    v_cvt_pk_bf16_f32 v101, v26, v27
    ds_write_b64 v5, v[100:101] offset:1536
    s_waitcnt vmcnt(3)
    v_add_f32 v104, v104, v168
    v_add_f32 v105, v105, v169
    v_add_f32 v106, v106, v170
    v_add_f32 v107, v107, v171
    v_cvt_pk_bf16_f32 v28, v104, v105
    v_cvt_pk_bf16_f32 v29, v106, v107
    v_lshlrev_b32 v104, 16, v28
    v_and_b32 v105, 0xffff0000, v28
    v_lshlrev_b32 v106, 16, v29
    v_and_b32 v107, 0xffff0000, v29
    v_mul_f32 v24, 0xbfb8aa3b, v104
    v_mul_f32 v25, 0xbfb8aa3b, v105
    v_mul_f32 v26, 0xbfb8aa3b, v106
    v_mul_f32 v27, 0xbfb8aa3b, v107
    v_exp_f32 v24, v24
    v_exp_f32 v25, v25
    v_exp_f32 v26, v26
    v_exp_f32 v27, v27
    s_nop 0
    v_add_f32 v24, 1.0, v24
    v_add_f32 v25, 1.0, v25
    v_add_f32 v26, 1.0, v26
    v_add_f32 v27, 1.0, v27
    v_rcp_f32 v24, v24
    v_rcp_f32 v25, v25
    v_rcp_f32 v26, v26
    v_rcp_f32 v27, v27
    s_nop 0
    v_mul_f32 v24, v24, v104
    v_mul_f32 v25, v25, v105
    v_mul_f32 v26, v26, v106
    v_mul_f32 v27, v27, v107
    v_cvt_pk_bf16_f32 v104, v24, v25
    v_cvt_pk_bf16_f32 v105, v26, v27
    ds_write_b64 v5, v[104:105] offset:2048
    s_waitcnt vmcnt(2)
    v_add_f32 v108, v108, v172
    v_add_f32 v109, v109, v173
    v_add_f32 v110, v110, v174
    v_add_f32 v111, v111, v175
    v_cvt_pk_bf16_f32 v28, v108, v109
    v_cvt_pk_bf16_f32 v29, v110, v111
    v_lshlrev_b32 v108, 16, v28
    v_and_b32 v109, 0xffff0000, v28
    v_lshlrev_b32 v110, 16, v29
    v_and_b32 v111, 0xffff0000, v29
    v_mul_f32 v24, 0xbfb8aa3b, v108
    v_mul_f32 v25, 0xbfb8aa3b, v109
    v_mul_f32 v26, 0xbfb8aa3b, v110
    v_mul_f32 v27, 0xbfb8aa3b, v111
    v_exp_f32 v24, v24
    v_exp_f32 v25, v25
    v_exp_f32 v26, v26
    v_exp_f32 v27, v27
    s_nop 0
    v_add_f32 v24, 1.0, v24
    v_add_f32 v25, 1.0, v25
    v_add_f32 v26, 1.0, v26
    v_add_f32 v27, 1.0, v27
    v_rcp_f32 v24, v24
    v_rcp_f32 v25, v25
    v_rcp_f32 v26, v26
    v_rcp_f32 v27, v27
    s_nop 0
    v_mul_f32 v24, v24, v108
    v_mul_f32 v25, v25, v109
    v_mul_f32 v26, v26, v110
    v_mul_f32 v27, v27, v111
    v_cvt_pk_bf16_f32 v108, v24, v25
    v_cvt_pk_bf16_f32 v109, v26, v27
    s_barrier
    ds_write_b64 v5, v[108:109] offset:2560
    s_waitcnt vmcnt(1)
    v_add_f32 v112, v112, v176
    v_add_f32 v113, v113, v177
    v_add_f32 v114, v114, v178
    v_add_f32 v115, v115, v179
    v_cvt_pk_bf16_f32 v28, v112, v113
    v_cvt_pk_bf16_f32 v29, v114, v115
    v_lshlrev_b32 v112, 16, v28
    v_and_b32 v113, 0xffff0000, v28
    v_lshlrev_b32 v114, 16, v29
    v_and_b32 v115, 0xffff0000, v29
    v_mul_f32 v24, 0xbfb8aa3b, v112
    v_mul_f32 v25, 0xbfb8aa3b, v113
    v_mul_f32 v26, 0xbfb8aa3b, v114
    v_mul_f32 v27, 0xbfb8aa3b, v115
    v_exp_f32 v24, v24
    v_exp_f32 v25, v25
    v_exp_f32 v26, v26
    v_exp_f32 v27, v27
    s_nop 0
    v_add_f32 v24, 1.0, v24
    v_add_f32 v25, 1.0, v25
    v_add_f32 v26, 1.0, v26
    v_add_f32 v27, 1.0, v27
    v_rcp_f32 v24, v24
    v_rcp_f32 v25, v25
    v_rcp_f32 v26, v26
    v_rcp_f32 v27, v27
    s_nop 0
    v_mul_f32 v24, v24, v112
    v_mul_f32 v25, v25, v113
    v_mul_f32 v26, v26, v114
    v_mul_f32 v27, v27, v115
    v_cvt_pk_bf16_f32 v112, v24, v25
    v_cvt_pk_bf16_f32 v113, v26, v27
    ds_write_b64 v5, v[112:113] offset:3072
    s_waitcnt vmcnt(0)
    v_add_f32 v116, v116, v180
    v_add_f32 v117, v117, v181
    v_add_f32 v118, v118, v182
    v_add_f32 v119, v119, v183
    v_cvt_pk_bf16_f32 v28, v116, v117
    v_cvt_pk_bf16_f32 v29, v118, v119
    v_lshlrev_b32 v116, 16, v28
    v_and_b32 v117, 0xffff0000, v28
    v_lshlrev_b32 v118, 16, v29
    v_and_b32 v119, 0xffff0000, v29
    v_mul_f32 v24, 0xbfb8aa3b, v116
    v_mul_f32 v25, 0xbfb8aa3b, v117
    v_mul_f32 v26, 0xbfb8aa3b, v118
    v_mul_f32 v27, 0xbfb8aa3b, v119
    v_exp_f32 v24, v24
    v_exp_f32 v25, v25
    v_exp_f32 v26, v26
    v_exp_f32 v27, v27
    s_nop 0
    v_add_f32 v24, 1.0, v24
    v_add_f32 v25, 1.0, v25
    v_add_f32 v26, 1.0, v26
    v_add_f32 v27, 1.0, v27
    v_rcp_f32 v24, v24
    v_rcp_f32 v25, v25
    v_rcp_f32 v26, v26
    v_rcp_f32 v27, v27
    s_nop 0
    v_mul_f32 v24, v24, v116
    v_mul_f32 v25, v25, v117
    v_mul_f32 v26, v26, v118
    v_mul_f32 v27, v27, v119
    v_cvt_pk_bf16_f32 v116, v24, v25
    v_cvt_pk_bf16_f32 v117, v26, v27
    ds_write_b64 v5, v[116:117] offset:3584
    s_waitcnt lgkmcnt(0)
    s_barrier
    s_branch L_fin
L_teamB:
    s_setprio 3
    v_lshrrev_b32 v64, 4, v1
    v_bfe_u32 v65, v1, 2, 2
    v_and_b32 v66, 3, v1
    v_and_b32 v67, 15, v1
    v_lshrrev_b32 v68, 3, v1
    v_and_b32 v69, 7, v1
    s_lshl_b32 s85, s28, 7
    s_lshl_b32 s86, s4, 5
    s_add_u32 s86, s85, s86
    v_add_u32 v71, s86, v68
    v_xor_b32 v70, v69, v64
    v_lshlrev_b32 v70, 4, v70
    v_lshl_add_u32 v20, v71, 11, v70
    v_xor_b32 v21, 64, v20
    v_add_u32 v21, 16384, v21
    s_lshl_b32 s79, s4, 12
    s_mov_b32 s36, s8
    s_mov_b32 s37, s9
    s_mov_b32 s38, 0x400000
    s_mov_b32 s39, 0x20000
    s_and_b32 s72, s28, 3
    s_bitcmp1_b32 s28, 3
    s_cselect_b32 s91, 4, 0
    s_add_u32 s72, s72, s91
    s_mul_i32 s72, s72, 256
    s_sub_u32 s72, s72, 128
    s_add_u32 m0, s79, 116736
    s_add_u32 s72, s72, 128
    s_and_b32 s78, s72, 0x7ff
    buffer_load_dwordx4 v20, s[36:39], s78 offen lds
    s_add_u32 m0, s79, 117760
    s_nop 0
    buffer_load_dwordx4 v21, s[36:39], s78 offen lds
    s_add_u32 m0, s79, 118784
    s_add_u32 s78, s78, 32768
    buffer_load_dwordx4 v20, s[36:39], s78 offen lds
    s_add_u32 m0, s79, 119808
    s_nop 0
    buffer_load_dwordx4 v21, s[36:39], s78 offen lds
    s_setprio 0
    s_lshl_b32 s85, s4, 3
    s_and_b32 s86, s4, 1
    s_lshl_b32 s86, s86, 2
    v_and_b32 v70, 2, v68
    v_xor_b32 v70, v70, v69
    v_xor_b32 v70, s86, v70
    v_add_u32 v71, s85, v68
    v_mul_u32_u24 v71, 7168, v71
    v_lshl_add_u32 v22, v70, 4, v71
    v_lshrrev_b32 v71, 2, v1
    s_lshl_b32 s86, s86, 2
    v_add_u32 v71, s86, v71
    v_mul_u32_u24 v71, 7168, v71
    v_and_b32 v70, 2, v64
    v_xor_b32 v70, v70, v66
    v_lshl_add_u32 v9, v70, 4, v71
    s_mul_i32 s85, s29, 320
    s_and_b32 s86, s29, 1
    s_lshl_b32 s87, s86, 6
    s_add_u32 s87, s87, s85
    s_add_u32 s40, s16, s87
    s_addc_u32 s41, s17, 0
    s_sub_u32 s42, 7340032, s87
    s_mov_b32 s43, 0x20000
    s_add_u32 s44, s18, s87
    s_addc_u32 s45, s19, 0
    s_sub_u32 s46, 7340032, s87
    s_mov_b32 s47, 0x20000
    s_xor_b32 s86, s86, 1
    s_lshl_b32 s86, s86, 8
    s_add_u32 s87, s86, s85
    s_cmp_lt_u32 s4, 2
    s_cselect_b32 s88, s16, s18
    s_cselect_b32 s89, s17, s19
    s_add_u32 s48, s88, s87
    s_addc_u32 s49, s89, 0
    s_sub_u32 s50, 7340032, s87
    s_mov_b32 s51, 0x20000
    s_and_b32 s77, s28, 3
    s_bitcmp1_b32 s28, 3
    s_cselect_b32 s91, 4, 0
    s_add_u32 s77, s77, s91
    s_mul_i32 s77, s77, 917504
    s_add_u32 s77, s77, 0x38000
    s_add_u32 m0, s79, 135168
    s_add_u32 s72, s72, 128
    s_and_b32 s78, s72, 0x7ff
    buffer_load_dwordx4 v20, s[36:39], s78 offen lds
    s_add_u32 m0, s79, 136192
    s_nop 0
    buffer_load_dwordx4 v21, s[36:39], s78 offen lds
    s_add_u32 m0, s79, 137216
    s_add_u32 s78, s78, 32768
    buffer_load_dwordx4 v20, s[36:39], s78 offen lds
    s_add_u32 m0, s79, 138240
    s_nop 0
    buffer_load_dwordx4 v21, s[36:39], s78 offen lds
    s_add_u32 m0, s33, 57344
    s_add_u32 s77, s77, 229376
    s_cmp_eq_u32 s77, 7340032
    s_cselect_b32 s77, 0, s77
    buffer_load_dwordx4 v22, s[40:43], s77 offen offset:0 lds
    s_add_u32 m0, s33, 61312
    s_nop 0
    buffer_load_dwordx4 v22, s[40:43], s77 offen offset:128 lds
    s_add_u32 m0, s33, 65536
    s_nop 0
    buffer_load_dwordx4 v22, s[44:47], s77 offen offset:0 lds
    s_add_u32 m0, s33, 69504
    s_nop 0
    buffer_load_dwordx4 v22, s[44:47], s77 offen offset:128 lds
    s_add_u32 m0, s33, 73728
    s_nop 0
    buffer_load_dwordx4 v9, s[48:51], s77 offen lds
    s_lshl_b32 s84, s28, 7
    s_lshl_b32 s85, s29, 3
    s_add_u32 s84, s84, s85
    s_lshl1_add_u32 s84, s4, s84
    s_lshl_b32 s90, s84, 3
    s_lshl_b32 s84, s84, 11
    v_lshl_add_u32 v86, v1, 4, s84
    v_and_b32 v70, 1, v67
    v_lshlrev_b32 v70, 4, v70
    v_mov_b32 v71, 0x3f80
    v_lshlrev_b32 v70, v70, v71
    v_lshrrev_b32 v71, 1, v67
    v_cmp_eq_u32 vcc, 0, v71
    s_nop 1
    v_cndmask_b32 v144, 0, v70, vcc
    v_cmp_eq_u32 vcc, 1, v71
    s_nop 1
    v_cndmask_b32 v145, 0, v70, vcc
    v_cmp_eq_u32 vcc, 2, v71
    s_nop 1
    v_cndmask_b32 v146, 0, v70, vcc
    v_cmp_eq_u32 vcc, 3, v71
    s_nop 1
    v_cndmask_b32 v147, 0, v70, vcc
    s_lshl_b32 s91, s4, 12
    s_add_u32 s91, s91, 16384
    v_lshlrev_b32 v70, 1, v64
    v_xor_b32 v71, v69, v70
    v_lshl_add_u32 v71, v71, 4, s91
    v_and_b32 v148, 4, v70
    v_add_u32 v70, v70, v148
    v_and_b32 v148, 1, v68
    v_add_u32 v70, v70, v148
    v_lshl_add_u32 v148, v70, 7, v71
    s_lshl_b32 s91, s5, 11
    s_add_u32 s91, s91, 32768
    v_and_b32 v70, 2, v64
    v_xor_b32 v70, v66, v70
    v_lshl_add_u32 v70, v70, 4, s91
    v_lshrrev_b32 v71, 2, v1
    v_lshl_add_u32 v149, v71, 6, v70
    s_lshl2_add_u32 s91, s2, s4
    s_lshl_b32 s52, s91, 9
    s_lshr_b32 s92, s91, 2
    s_mul_i32 s92, s92, 7168
    s_and_b32 s91, s91, 3
    s_lshl_b32 s91, s91, 9
    s_add_u32 s92, s92, s91
    s_add_u32 s53, s92, 5120
    s_waitcnt vmcnt(9)
    s_barrier
    s_and_b32 s91, s28, 4
    s_cmp_eq_u32 s91, 0
    s_cbranch_scc0 L_cr0
    ds_read_b128 v[112:115], v148 offset:0
    ds_read_b128 v[116:119], v148 offset:512
    ds_read_b128 v[120:123], v148 offset:2048
    ds_read_b128 v[124:127], v148 offset:2560
    ds_read_b128 v[128:131], v149 offset:0
    ds_read_b128 v[132:135], v149 offset:1024
L_cr0:
    s_add_u32 m0, s33, 77824
    s_add_u32 s77, s77, 229376
    buffer_load_dwordx4 v22, s[40:43], s77 offen offset:0 lds
    s_add_u32 m0, s33, 81792
    s_nop 0
    buffer_load_dwordx4 v22, s[40:43], s77 offen offset:128 lds
    s_add_u32 m0, s33, 86016
    s_nop 0
    buffer_load_dwordx4 v22, s[44:47], s77 offen offset:0 lds
    s_add_u32 m0, s33, 89984
    s_nop 0
    buffer_load_dwordx4 v22, s[44:47], s77 offen offset:128 lds
    s_add_u32 m0, s33, 94208
    s_nop 0
    buffer_load_dwordx4 v9, s[48:51], s77 offen lds
    s_add_u32 m0, s79, 98304
    s_add_u32 s72, s72, 128
    s_and_b32 s78, s72, 0x7ff
    buffer_load_dwordx4 v20, s[36:39], s78 offen lds
    s_add_u32 m0, s79, 99328
    s_nop 0
    buffer_load_dwordx4 v21, s[36:39], s78 offen lds
    s_and_b32 s91, s28, 4
    s_cmp_eq_u32 s91, 0
    s_cbranch_scc0 L_cm0
    s_waitcnt lgkmcnt(0)
    s_setprio 2
    v_mfma_f32_16x16x32_bf16 v[136:139], v[144:147], v[112:115], 0
    v_mfma_f32_16x16x32_bf16 v[140:143], v[144:147], v[128:131], 0
    v_mfma_f32_16x16x32_bf16 v[136:139], v[144:147], v[116:119], v[136:139]
    v_mfma_f32_16x16x32_bf16 v[140:143], v[144:147], v[132:135], v[140:143]
    v_mfma_f32_16x16x32_bf16 v[136:139], v[144:147], v[120:123], v[136:139]
    v_mfma_f32_16x16x32_bf16 v[136:139], v[144:147], v[124:127], v[136:139]
    s_setprio 0
L_cm0:
    s_waitcnt vmcnt(16)
    s_barrier
    s_and_b32 s91, s28, 4
    s_cmp_eq_u32 s91, 0
    s_cbranch_scc0 L_cr1
    ds_read_b128 v[112:115], v148 offset:20480
    ds_read_b128 v[116:119], v148 offset:20992
    ds_read_b128 v[120:123], v148 offset:22528
    ds_read_b128 v[124:127], v148 offset:23040
    ds_read_b128 v[128:131], v149 offset:20480
    ds_read_b128 v[132:135], v149 offset:21504
L_cr1:
    s_add_u32 m0, s79, 100352
    s_add_u32 s78, s78, 32768
    buffer_load_dwordx4 v20, s[36:39], s78 offen lds
    s_add_u32 m0, s79, 101376
    s_nop 0
    buffer_load_dwordx4 v21, s[36:39], s78 offen lds
    s_add_u32 m0, s33, 16384
    s_add_u32 s77, s77, 229376
    s_cmp_eq_u32 s77, 7340032
    s_cselect_b32 s77, 0, s77
    buffer_load_dwordx4 v22, s[40:43], s77 offen offset:0 lds
    s_add_u32 m0, s33, 20352
    s_nop 0
    buffer_load_dwordx4 v22, s[40:43], s77 offen offset:128 lds
    s_add_u32 m0, s33, 24576
    s_nop 0
    buffer_load_dwordx4 v22, s[44:47], s77 offen offset:0 lds
    s_add_u32 m0, s33, 28544
    s_nop 0
    buffer_load_dwordx4 v22, s[44:47], s77 offen offset:128 lds
    s_add_u32 m0, s33, 32768
    s_nop 0
    buffer_load_dwordx4 v9, s[48:51], s77 offen lds
    s_and_b32 s91, s28, 4
    s_cmp_eq_u32 s91, 0
    s_cbranch_scc0 L_cm1
    s_waitcnt lgkmcnt(0)
    s_setprio 2
    v_mfma_f32_16x16x32_bf16 v[136:139], v[144:147], v[112:115], v[136:139]
    v_mfma_f32_16x16x32_bf16 v[140:143], v[144:147], v[128:131], v[140:143]
    v_mfma_f32_16x16x32_bf16 v[136:139], v[144:147], v[116:119], v[136:139]
    v_mfma_f32_16x16x32_bf16 v[140:143], v[144:147], v[132:135], v[140:143]
    v_mfma_f32_16x16x32_bf16 v[136:139], v[144:147], v[120:123], v[136:139]
    v_mfma_f32_16x16x32_bf16 v[136:139], v[144:147], v[124:127], v[136:139]
    s_setprio 0
L_cm1:
    s_waitcnt vmcnt(14)
    s_barrier
    s_and_b32 s91, s28, 4
    s_cmp_eq_u32 s91, 4
    s_cbranch_scc0 L_cr2
    ds_read_b128 v[112:115], v148 offset:40960
    ds_read_b128 v[116:119], v148 offset:41472
    ds_read_b128 v[120:123], v148 offset:43008
    ds_read_b128 v[124:127], v148 offset:43520
    ds_read_b128 v[128:131], v149 offset:40960
    ds_read_b128 v[132:135], v149 offset:41984
L_cr2:
    global_load_dwordx4 v[24:27], v86, s[8:9] offset:0
    global_load_dwordx4 v[32:35], v86, s[8:9] offset:2048
    global_load_dwordx4 v[28:31], v86, s[8:9] offset:1024
    global_load_dwordx4 v[36:39], v86, s[8:9] offset:3072
    s_add_u32 m0, s79, 116736
    s_add_u32 s72, s72, 128
    s_and_b32 s78, s72, 0x7ff
    buffer_load_dwordx4 v20, s[36:39], s78 offen lds
    s_add_u32 m0, s79, 117760
    s_nop 0
    buffer_load_dwordx4 v21, s[36:39], s78 offen lds
    s_add_u32 m0, s33, 36864
    s_add_u32 s77, s77, 229376
    buffer_load_dwordx4 v22, s[40:43], s77 offen offset:0 lds
    s_add_u32 m0, s33, 40832
    s_nop 0
    buffer_load_dwordx4 v22, s[40:43], s77 offen offset:128 lds
    s_add_u32 m0, s33, 45056
    s_nop 0
    buffer_load_dwordx4 v22, s[44:47], s77 offen offset:0 lds
    s_add_u32 m0, s33, 49024
    s_nop 0
    buffer_load_dwordx4 v22, s[44:47], s77 offen offset:128 lds
    s_add_u32 m0, s33, 53248
    s_nop 0
    buffer_load_dwordx4 v9, s[48:51], s77 offen lds
    s_and_b32 s91, s28, 4
    s_cmp_eq_u32 s91, 4
    s_cbranch_scc0 L_cm2
    s_waitcnt lgkmcnt(0)
    s_setprio 2
    v_mfma_f32_16x16x32_bf16 v[136:139], v[144:147], v[112:115], 0
    v_mfma_f32_16x16x32_bf16 v[140:143], v[144:147], v[128:131], 0
    v_mfma_f32_16x16x32_bf16 v[136:139], v[144:147], v[116:119], v[136:139]
    v_mfma_f32_16x16x32_bf16 v[140:143], v[144:147], v[132:135], v[140:143]
    v_mfma_f32_16x16x32_bf16 v[136:139], v[144:147], v[120:123], v[136:139]
    v_mfma_f32_16x16x32_bf16 v[136:139], v[144:147], v[124:127], v[136:139]
    s_setprio 0
L_cm2:
    s_waitcnt vmcnt(20)
    s_barrier
    s_and_b32 s91, s28, 4
    s_cmp_eq_u32 s91, 4
    s_cbranch_scc0 L_cr3
    ds_read_b128 v[112:115], v148 offset:61440
    ds_read_b128 v[116:119], v148 offset:61952
    ds_read_b128 v[120:123], v148 offset:63488
    ds_read_b128 v[124:127], v148 offset:64000
    ds_read_b128 v[128:131], v149 offset:61440
    ds_read_b128 v[132:135], v149 offset:62464
L_cr3:
    s_add_u32 m0, s79, 118784
    s_add_u32 s78, s78, 32768
    buffer_load_dwordx4 v20, s[36:39], s78 offen lds
    s_add_u32 m0, s79, 119808
    s_nop 0
    buffer_load_dwordx4 v21, s[36:39], s78 offen lds
    s_add_u32 m0, s33, 57344
    s_add_u32 s77, s77, 229376
    s_cmp_eq_u32 s77, 7340032
    s_cselect_b32 s77, 0, s77
    buffer_load_dwordx4 v22, s[40:43], s77 offen offset:0 lds
    s_add_u32 m0, s33, 61312
    s_nop 0
    buffer_load_dwordx4 v22, s[40:43], s77 offen offset:128 lds
    s_add_u32 m0, s33, 65536
    s_nop 0
    buffer_load_dwordx4 v22, s[44:47], s77 offen offset:0 lds
    s_add_u32 m0, s33, 69504
    s_nop 0
    buffer_load_dwordx4 v22, s[44:47], s77 offen offset:128 lds
    s_add_u32 m0, s33, 73728
    s_nop 0
    buffer_load_dwordx4 v9, s[48:51], s77 offen lds
    s_and_b32 s91, s28, 4
    s_cmp_eq_u32 s91, 4
    s_cbranch_scc0 L_cm3
    s_waitcnt lgkmcnt(0)
    s_setprio 2
    v_mfma_f32_16x16x32_bf16 v[136:139], v[144:147], v[112:115], v[136:139]
    v_mfma_f32_16x16x32_bf16 v[140:143], v[144:147], v[128:131], v[140:143]
    v_mfma_f32_16x16x32_bf16 v[136:139], v[144:147], v[116:119], v[136:139]
    v_mfma_f32_16x16x32_bf16 v[140:143], v[144:147], v[132:135], v[140:143]
    v_mfma_f32_16x16x32_bf16 v[136:139], v[144:147], v[120:123], v[136:139]
    v_mfma_f32_16x16x32_bf16 v[136:139], v[144:147], v[124:127], v[136:139]
    s_setprio 0
L_cm3:
    s_waitcnt vmcnt(18)
    s_barrier
    s_add_u32 m0, s79, 135168
    s_add_u32 s72, s72, 128
    s_and_b32 s78, s72, 0x7ff
    buffer_load_dwordx4 v20, s[36:39], s78 offen lds
    s_add_u32 m0, s79, 136192
    s_nop 0
    buffer_load_dwordx4 v21, s[36:39], s78 offen lds
    s_add_u32 m0, s33, 77824
    s_add_u32 s77, s77, 229376
    buffer_load_dwordx4 v22, s[40:43], s77 offen offset:0 lds
    s_add_u32 m0, s33, 81792
    s_nop 0
    buffer_load_dwordx4 v22, s[40:43], s77 offen offset:128 lds
    s_add_u32 m0, s33, 86016
    s_nop 0
    buffer_load_dwordx4 v22, s[44:47], s77 offen offset:0 lds
    s_add_u32 m0, s33, 89984
    s_nop 0
    buffer_load_dwordx4 v22, s[44:47], s77 offen offset:128 lds
    s_add_u32 m0, s33, 94208
    s_nop 0
    buffer_load_dwordx4 v9, s[48:51], s77 offen lds
    v_add_f32_dpp v136, v136, v136 row_ror:8 row_mask:0xf bank_mask:0xf
    v_add_f32_dpp v137, v137, v137 row_ror:8 row_mask:0xf bank_mask:0xf
    v_add_f32_dpp v138, v138, v138 row_ror:8 row_mask:0xf bank_mask:0xf
    v_add_f32_dpp v139, v139, v139 row_ror:8 row_mask:0xf bank_mask:0xf
    v_add_f32_dpp v140, v140, v140 row_ror:8 row_mask:0xf bank_mask:0xf
    v_add_f32_dpp v141, v141, v141 row_ror:8 row_mask:0xf bank_mask:0xf
    v_add_f32_dpp v142, v142, v142 row_ror:8 row_mask:0xf bank_mask:0xf
    v_add_f32_dpp v143, v143, v143 row_ror:8 row_mask:0xf bank_mask:0xf
    v_add_f32_dpp v140, v140, v140 row_ror:4 row_mask:0xf bank_mask:0xf
    v_add_f32_dpp v141, v141, v141 row_ror:4 row_mask:0xf bank_mask:0xf
    v_add_f32_dpp v142, v142, v142 row_ror:4 row_mask:0xf bank_mask:0xf
    v_add_f32_dpp v143, v143, v143 row_ror:4 row_mask:0xf bank_mask:0xf
    s_lshl_b32 s91, s29, 4
    s_add_u32 s91, s91, s28
    s_mul_i32 s91, s91, 1280
    s_mul_i32 s92, s5, 640
    s_add_u32 s91, s91, s92
    s_add_u32 s91, s91, 0x1e10000
    s_lshl_b32 s92, s6, 8
    v_and_b32 v112, 8, v1
    v_cmp_eq_u32 vcc, 0, v112
    v_mov_b32 v112, s92
    v_mov_b32 v113, 256
    v_cndmask_b32 v112, v113, v112, vcc
    v_cndmask_b32 v136, v140, v136, vcc
    v_cndmask_b32 v137, v141, v137, vcc
    v_cndmask_b32 v138, v142, v138, vcc
    v_cndmask_b32 v139, v143, v139, vcc
    v_and_b32 v113, 15, v1
    v_lshl_add_u32 v112, v113, 5, v112
    v_and_b32 v113, 16, v1
    v_add3_u32 v112, v112, v113, s91
    s_mov_b64 exec, 0x0fff0fff
    global_store_dwordx4 v112, v[136:139], s[26:27] sc1
    s_mov_b64 exec, -1
    s_waitcnt vmcnt(15)
    s_barrier
    s_add_u32 m0, s79, 137216
    s_add_u32 s78, s78, 32768
    buffer_load_dwordx4 v20, s[36:39], s78 offen lds
    s_waitcnt vmcnt(23)
    v_lshlrev_b32 v40, 16, v24
    v_and_b32 v41, 0xffff0000, v24
    v_lshlrev_b32 v42, 16, v25
    v_and_b32 v43, 0xffff0000, v25
    v_lshlrev_b32 v44, 16, v26
    v_and_b32 v45, 0xffff0000, v26
    v_lshlrev_b32 v46, 16, v27
    v_and_b32 v47, 0xffff0000, v27
    s_add_u32 m0, s79, 138240
    s_nop 0
    buffer_load_dwordx4 v21, s[36:39], s78 offen lds
    v_lshlrev_b32 v48, 16, v28
    v_and_b32 v49, 0xffff0000, v28
    v_lshlrev_b32 v50, 16, v29
    v_and_b32 v51, 0xffff0000, v29
    v_lshlrev_b32 v52, 16, v30
    v_and_b32 v53, 0xffff0000, v30
    v_lshlrev_b32 v54, 16, v31
    v_and_b32 v55, 0xffff0000, v31
    s_add_u32 m0, s33, 16384
    s_add_u32 s77, s77, 229376
    s_cmp_eq_u32 s77, 7340032
    s_cselect_b32 s77, 0, s77
    buffer_load_dwordx4 v22, s[40:43], s77 offen offset:0 lds
    v_lshlrev_b32 v56, 16, v32
    v_and_b32 v57, 0xffff0000, v32
    v_lshlrev_b32 v58, 16, v33
    v_and_b32 v59, 0xffff0000, v33
    v_lshlrev_b32 v60, 16, v34
    v_and_b32 v61, 0xffff0000, v34
    v_lshlrev_b32 v62, 16, v35
    v_and_b32 v63, 0xffff0000, v35
    s_add_u32 m0, s33, 20352
    s_nop 0
    buffer_load_dwordx4 v22, s[40:43], s77 offen offset:128 lds
    v_lshlrev_b32 v64, 16, v36
    v_and_b32 v65, 0xffff0000, v36
    v_lshlrev_b32 v66, 16, v37
    v_and_b32 v67, 0xffff0000, v37
    v_lshlrev_b32 v68, 16, v38
    v_and_b32 v69, 0xffff0000, v38
    v_lshlrev_b32 v70, 16, v39
    v_and_b32 v71, 0xffff0000, v39
    s_add_u32 m0, s33, 24576
    s_nop 0
    buffer_load_dwordx4 v22, s[44:47], s77 offen offset:0 lds
    v_add_f32 v72, v40, v41
    v_add_f32 v74, v56, v57
    v_add_f32 v72, v72, v42
    v_add_f32 v74, v74, v58
    v_add_f32 v72, v72, v43
    v_add_f32 v74, v74, v59
    v_add_f32 v72, v72, v44
    v_add_f32 v74, v74, v60
    s_add_u32 m0, s33, 28544
    s_nop 0
    buffer_load_dwordx4 v22, s[44:47], s77 offen offset:128 lds
    s_add_u32 m0, s33, 32768
    s_nop 0
    buffer_load_dwordx4 v9, s[48:51], s77 offen lds
    v_add_f32 v72, v72, v45
    v_add_f32 v74, v74, v61
    v_add_f32 v72, v72, v46
    v_add_f32 v74, v74, v62
    v_add_f32 v72, v72, v47
    v_add_f32 v74, v74, v63
    v_add_f32 v72, v72, v48
    v_add_f32 v74, v74, v64
    s_load_dword s94, s[10:11], s52 offset:0x0
    s_load_dword s94, s[10:11], s52 offset:0x40
    s_load_dword s94, s[10:11], s52 offset:0x80
    s_load_dword s94, s[10:11], s52 offset:0xc0
    s_waitcnt vmcnt(15)
    s_barrier
    s_add_u32 m0, s79, 98304
    s_add_u32 s72, s72, 128
    s_and_b32 s78, s72, 0x7ff
    buffer_load_dwordx4 v20, s[36:39], s78 offen lds
    v_add_f32 v72, v72, v49
    v_add_f32 v74, v74, v65
    v_add_f32 v72, v72, v50
    v_add_f32 v74, v74, v66
    v_add_f32 v72, v72, v51
    v_add_f32 v74, v74, v67
    v_add_f32 v72, v72, v52
    v_add_f32 v74, v74, v68
    s_add_u32 m0, s79, 99328
    s_nop 0
    buffer_load_dwordx4 v21, s[36:39], s78 offen lds
    v_add_f32 v72, v72, v53
    v_add_f32 v74, v74, v69
    v_add_f32 v72, v72, v54
    v_add_f32 v74, v74, v70
    v_add_f32 v72, v72, v55
    v_add_f32 v74, v74, v71
    s_nop 0
    v_add_f32_dpp v72, v72, v72 quad_perm:[1,0,3,2] row_mask:0xf bank_mask:0xf
    v_add_f32_dpp v74, v74, v74 quad_perm:[1,0,3,2] row_mask:0xf bank_mask:0xf
    s_add_u32 m0, s33, 36864
    s_add_u32 s77, s77, 229376
    buffer_load_dwordx4 v22, s[40:43], s77 offen offset:0 lds
    s_nop 0
    v_add_f32_dpp v72, v72, v72 quad_perm:[2,3,0,1] row_mask:0xf bank_mask:0xf
    v_add_f32_dpp v74, v74, v74 quad_perm:[2,3,0,1] row_mask:0xf bank_mask:0xf
    s_nop 0
    v_add_f32_dpp v72, v72, v72 row_half_mirror row_mask:0xf bank_mask:0xf
    v_add_f32_dpp v74, v74, v74 row_half_mirror row_mask:0xf bank_mask:0xf
    s_nop 0
    v_add_f32_dpp v72, v72, v72 row_mirror row_mask:0xf bank_mask:0xf
    v_add_f32_dpp v74, v74, v74 row_mirror row_mask:0xf bank_mask:0xf
    v_mov_b32 v78, v72
    s_add_u32 m0, s33, 40832
    s_nop 0
    buffer_load_dwordx4 v22, s[40:43], s77 offen offset:128 lds
    v_mov_b32 v79, v74
    s_nop 0
    v_permlane16_swap_b32 v72, v78
    v_permlane16_swap_b32 v74, v79
    v_add_f32 v72, v72, v78
    v_add_f32 v74, v74, v79
    v_mov_b32 v78, v72
    v_mov_b32 v79, v74
    s_nop 0
    v_permlane32_swap_b32 v72, v78
    s_add_u32 m0, s33, 45056
    s_nop 0
    buffer_load_dwordx4 v22, s[44:47], s77 offen offset:0 lds
    s_add_u32 m0, s33, 49024
    s_nop 0
    buffer_load_dwordx4 v22, s[44:47], s77 offen offset:128 lds
    v_permlane32_swap_b32 v74, v79
    v_add_f32 v72, v72, v78
    v_add_f32 v74, v74, v79
    v_mul_f32 v72, 0x3a800000, v72
    v_mul_f32 v74, 0x3a800000, v74
    v_sub_f32 v78, v40, v72
    v_sub_f32 v79, v56, v74
    v_mul_f32 v73, v78, v78
    s_add_u32 m0, s33, 53248
    s_nop 0
    buffer_load_dwordx4 v9, s[48:51], s77 offen lds
    v_mul_f32 v75, v79, v79
    v_sub_f32 v78, v41, v72
    v_sub_f32 v79, v57, v74
    v_fmac_f32 v73, v78, v78
    v_fmac_f32 v75, v79, v79
    v_sub_f32 v78, v42, v72
    v_sub_f32 v79, v58, v74
    v_fmac_f32 v73, v78, v78
    s_load_dword s94, s[10:11], s52 offset:0x100
    s_load_dword s94, s[10:11], s52 offset:0x140
    s_load_dword s94, s[10:11], s52 offset:0x180
    s_load_dword s94, s[10:11], s52 offset:0x1c0
    s_waitcnt vmcnt(15)
    s_barrier
    s_add_u32 m0, s79, 100352
    s_add_u32 s78, s78, 32768
    buffer_load_dwordx4 v20, s[36:39], s78 offen lds
    v_fmac_f32 v75, v79, v79
    v_sub_f32 v78, v43, v72
    v_sub_f32 v79, v59, v74
    v_fmac_f32 v73, v78, v78
    v_fmac_f32 v75, v79, v79
    v_sub_f32 v78, v44, v72
    v_sub_f32 v79, v60, v74
    v_fmac_f32 v73, v78, v78
    s_add_u32 m0, s79, 101376
    s_nop 0
    buffer_load_dwordx4 v21, s[36:39], s78 offen lds
    v_fmac_f32 v75, v79, v79
    v_sub_f32 v78, v45, v72
    v_sub_f32 v79, v61, v74
    v_fmac_f32 v73, v78, v78
    v_fmac_f32 v75, v79, v79
    v_sub_f32 v78, v46, v72
    v_sub_f32 v79, v62, v74
    v_fmac_f32 v73, v78, v78
    s_add_u32 m0, s33, 57344
    s_add_u32 s77, s77, 229376
    s_cmp_eq_u32 s77, 7340032
    s_cselect_b32 s77, 0, s77
    buffer_load_dwordx4 v22, s[40:43], s77 offen offset:0 lds
    v_fmac_f32 v75, v79, v79
    v_sub_f32 v78, v47, v72
    v_sub_f32 v79, v63, v74
    v_fmac_f32 v73, v78, v78
    v_fmac_f32 v75, v79, v79
    v_sub_f32 v78, v48, v72
    v_sub_f32 v79, v64, v74
    v_fmac_f32 v73, v78, v78
    s_add_u32 m0, s33, 61312
    s_nop 0
    buffer_load_dwordx4 v22, s[40:43], s77 offen offset:128 lds
    v_fmac_f32 v75, v79, v79
    v_sub_f32 v78, v49, v72
    v_sub_f32 v79, v65, v74
    v_fmac_f32 v73, v78, v78
    v_fmac_f32 v75, v79, v79
    v_sub_f32 v78, v50, v72
    v_sub_f32 v79, v66, v74
    v_fmac_f32 v73, v78, v78
    s_add_u32 m0, s33, 65536
    s_nop 0
    buffer_load_dwordx4 v22, s[44:47], s77 offen offset:0 lds
    v_fmac_f32 v75, v79, v79
    v_sub_f32 v78, v51, v72
    v_sub_f32 v79, v67, v74
    v_fmac_f32 v73, v78, v78
    v_fmac_f32 v75, v79, v79
    v_sub_f32 v78, v52, v72
    v_sub_f32 v79, v68, v74
    v_fmac_f32 v73, v78, v78
    s_add_u32 m0, s33, 69504
    s_nop 0
    buffer_load_dwordx4 v22, s[44:47], s77 offen offset:128 lds
    s_add_u32 m0, s33, 73728
    s_nop 0
    buffer_load_dwordx4 v9, s[48:51], s77 offen lds
    v_fmac_f32 v75, v79, v79
    v_sub_f32 v78, v53, v72
    v_sub_f32 v79, v69, v74
    v_fmac_f32 v73, v78, v78
    v_fmac_f32 v75, v79, v79
    v_sub_f32 v78, v54, v72
    v_sub_f32 v79, v70, v74
    v_fmac_f32 v73, v78, v78
    s_load_dword s94, s[16:17], s53 offset:0x0
    s_load_dword s94, s[16:17], s53 offset:0x40
    s_load_dword s94, s[16:17], s53 offset:0x80
    s_load_dword s94, s[16:17], s53 offset:0xc0
    s_waitcnt vmcnt(14)
    s_barrier
    s_add_u32 m0, s79, 116736
    s_add_u32 s72, s72, 128
    s_and_b32 s78, s72, 0x7ff
    buffer_load_dwordx4 v20, s[36:39], s78 offen lds
    v_fmac_f32 v75, v79, v79
    v_sub_f32 v78, v55, v72
    v_sub_f32 v79, v71, v74
    v_fmac_f32 v73, v78, v78
    v_fmac_f32 v75, v79, v79
    s_nop 0
    v_add_f32_dpp v73, v73, v73 quad_perm:[1,0,3,2] row_mask:0xf bank_mask:0xf
    v_add_f32_dpp v75, v75, v75 quad_perm:[1,0,3,2] row_mask:0xf bank_mask:0xf
    s_nop 0
    v_add_f32_dpp v73, v73, v73 quad_perm:[2,3,0,1] row_mask:0xf bank_mask:0xf
    s_add_u32 m0, s79, 117760
    s_nop 0
    buffer_load_dwordx4 v21, s[36:39], s78 offen lds
    v_add_f32_dpp v75, v75, v75 quad_perm:[2,3,0,1] row_mask:0xf bank_mask:0xf
    s_nop 0
    v_add_f32_dpp v73, v73, v73 row_half_mirror row_mask:0xf bank_mask:0xf
    v_add_f32_dpp v75, v75, v75 row_half_mirror row_mask:0xf bank_mask:0xf
    s_nop 0
    v_add_f32_dpp v73, v73, v73 row_mirror row_mask:0xf bank_mask:0xf
    v_add_f32_dpp v75, v75, v75 row_mirror row_mask:0xf bank_mask:0xf
    v_mov_b32 v78, v73
    v_mov_b32 v79, v75
    s_add_u32 m0, s33, 77824
    s_add_u32 s77, s77, 229376
    buffer_load_dwordx4 v22, s[40:43], s77 offen offset:0 lds
    s_nop 0
    v_permlane16_swap_b32 v73, v78
    v_permlane16_swap_b32 v75, v79
    v_add_f32 v73, v73, v78
    v_add_f32 v75, v75, v79
    v_mov_b32 v78, v73
    v_mov_b32 v79, v75
    s_nop 0
    v_permlane32_swap_b32 v73, v78
    s_add_u32 m0, s33, 81792
    s_nop 0
    buffer_load_dwordx4 v22, s[40:43], s77 offen offset:128 lds
    v_permlane32_swap_b32 v75, v79
    v_add_f32 v73, v73, v78
    v_add_f32 v75, v75, v79
    v_mul_f32 v73, 0x3a800000, v73
    v_mul_f32 v75, 0x3a800000, v75
    v_cvt_pk_bf16_f32 v72, v72, v72
    v_lshlrev_b32 v72, 16, v72
    v_cvt_pk_bf16_f32 v73, v73, v73
    s_add_u32 m0, s33, 86016
    s_nop 0
    buffer_load_dwordx4 v22, s[44:47], s77 offen offset:0 lds
    s_add_u32 m0, s33, 89984
    s_nop 0
    buffer_load_dwordx4 v22, s[44:47], s77 offen offset:128 lds
    v_lshlrev_b32 v73, 16, v73
    v_add_f32 v73, 0x3727c5ac, v73
    v_cvt_pk_bf16_f32 v73, v73, v73
    v_lshlrev_b32 v73, 16, v73
    v_sqrt_f32 v73, v73
    v_cvt_pk_bf16_f32 v74, v74, v74
    v_lshlrev_b32 v74, 16, v74
    s_add_u32 m0, s33, 94208
    s_nop 0
    buffer_load_dwordx4 v9, s[48:51], s77 offen lds
    v_cvt_pk_bf16_f32 v75, v75, v75
    v_lshlrev_b32 v75, 16, v75
    v_add_f32 v75, 0x3727c5ac, v75
    v_cvt_pk_bf16_f32 v75, v75, v75
    v_lshlrev_b32 v75, 16, v75
    v_sqrt_f32 v75, v75
    s_nop 0
    v_cvt_pk_bf16_f32 v73, v73, v73
    s_load_dword s94, s[16:17], s53 offset:0x100
    s_load_dword s94, s[16:17], s53 offset:0x140
    s_load_dword s94, s[16:17], s53 offset:0x180
    s_load_dword s94, s[16:17], s53 offset:0x1c0
    s_waitcnt vmcnt(14)
    s_barrier
    s_add_u32 m0, s79, 118784
    s_add_u32 s78, s78, 32768
    buffer_load_dwordx4 v20, s[36:39], s78 offen lds
    v_lshlrev_b32 v73, 16, v73
    v_rcp_f32 v76, v73
    s_nop 0
    v_cvt_pk_bf16_f32 v75, v75, v75
    v_lshlrev_b32 v75, 16, v75
    v_rcp_f32 v77, v75
    s_nop 0
    v_fma_f32 v78, -v73, v76, 1.0
    s_add_u32 m0, s79, 119808
    s_nop 0
    buffer_load_dwordx4 v21, s[36:39], s78 offen lds
    v_fma_f32 v76, v78, v76, v76
    s_nop 0
    v_fma_f32 v79, -v75, v77, 1.0
    v_fma_f32 v77, v79, v77, v77
    v_sub_f32 v80, v40, v72
    v_sub_f32 v81, v41, v72
    v_cvt_pk_bf16_f32 v80, v80, v81
    v_and_b32 v81, 0xffff0000, v80
    v_lshlrev_b32 v80, 16, v80
    s_add_u32 m0, s33, 16384
    s_add_u32 s77, s77, 229376
    s_cmp_eq_u32 s77, 7340032
    s_cselect_b32 s77, 0, s77
    buffer_load_dwordx4 v22, s[40:43], s77 offen offset:0 lds
    v_mul_f32 v80, v80, v76
    v_mul_f32 v81, v81, v76
    v_cvt_pk_bf16_f32 v24, v80, v81
    v_sub_f32 v80, v42, v72
    v_sub_f32 v81, v43, v72
    v_cvt_pk_bf16_f32 v80, v80, v81
    v_and_b32 v81, 0xffff0000, v80
    v_lshlrev_b32 v80, 16, v80
    s_add_u32 m0, s33, 20352
    s_nop 0
    buffer_load_dwordx4 v22, s[40:43], s77 offen offset:128 lds
    v_mul_f32 v80, v80, v76
    v_mul_f32 v81, v81, v76
    v_cvt_pk_bf16_f32 v25, v80, v81
    v_sub_f32 v80, v44, v72
    v_sub_f32 v81, v45, v72
    v_cvt_pk_bf16_f32 v80, v80, v81
    v_and_b32 v81, 0xffff0000, v80
    v_lshlrev_b32 v80, 16, v80
    s_add_u32 m0, s33, 24576
    s_nop 0
    buffer_load_dwordx4 v22, s[44:47], s77 offen offset:0 lds
    s_add_u32 m0, s33, 28544
    s_nop 0
    buffer_load_dwordx4 v22, s[44:47], s77 offen offset:128 lds
    v_mul_f32 v80, v80, v76
    v_mul_f32 v81, v81, v76
    v_cvt_pk_bf16_f32 v26, v80, v81
    v_sub_f32 v80, v46, v72
    v_sub_f32 v81, v47, v72
    v_cvt_pk_bf16_f32 v80, v80, v81
    v_and_b32 v81, 0xffff0000, v80
    v_lshlrev_b32 v80, 16, v80
    s_add_u32 m0, s33, 32768
    s_nop 0
    buffer_load_dwordx4 v9, s[48:51], s77 offen lds
    v_mul_f32 v80, v80, v76
    v_mul_f32 v81, v81, v76
    v_cvt_pk_bf16_f32 v27, v80, v81
    v_sub_f32 v80, v48, v72
    v_sub_f32 v81, v49, v72
    v_cvt_pk_bf16_f32 v80, v80, v81
    v_and_b32 v81, 0xffff0000, v80
    v_lshlrev_b32 v80, 16, v80
    s_load_dword s94, s[18:19], s53 offset:0x0
    s_load_dword s94, s[18:19], s53 offset:0x40
    s_load_dword s94, s[18:19], s53 offset:0x80
    s_load_dword s94, s[18:19], s53 offset:0xc0
    s_waitcnt vmcnt(14)
    s_barrier
    s_add_u32 m0, s79, 135168
    s_add_u32 s72, s72, 128
    s_and_b32 s78, s72, 0x7ff
    buffer_load_dwordx4 v20, s[36:39], s78 offen lds
    v_mul_f32 v80, v80, v76
    v_mul_f32 v81, v81, v76
    v_cvt_pk_bf16_f32 v28, v80, v81
    v_sub_f32 v80, v50, v72
    v_sub_f32 v81, v51, v72
    v_cvt_pk_bf16_f32 v80, v80, v81
    v_and_b32 v81, 0xffff0000, v80
    v_lshlrev_b32 v80, 16, v80
    s_add_u32 m0, s79, 136192
    s_nop 0
    buffer_load_dwordx4 v21, s[36:39], s78 offen lds
    v_mul_f32 v80, v80, v76
    v_mul_f32 v81, v81, v76
    v_cvt_pk_bf16_f32 v29, v80, v81
    v_sub_f32 v80, v52, v72
    v_sub_f32 v81, v53, v72
    v_cvt_pk_bf16_f32 v80, v80, v81
    v_and_b32 v81, 0xffff0000, v80
    v_lshlrev_b32 v80, 16, v80
    s_add_u32 m0, s33, 36864
    s_add_u32 s77, s77, 229376
    buffer_load_dwordx4 v22, s[40:43], s77 offen offset:0 lds
    v_mul_f32 v80, v80, v76
    v_mul_f32 v81, v81, v76
    v_cvt_pk_bf16_f32 v30, v80, v81
    v_sub_f32 v80, v54, v72
    v_sub_f32 v81, v55, v72
    v_cvt_pk_bf16_f32 v80, v80, v81
    v_and_b32 v81, 0xffff0000, v80
    v_lshlrev_b32 v80, 16, v80
    s_add_u32 m0, s33, 40832
    s_nop 0
    buffer_load_dwordx4 v22, s[40:43], s77 offen offset:128 lds
    v_mul_f32 v80, v80, v76
    v_mul_f32 v81, v81, v76
    v_cvt_pk_bf16_f32 v31, v80, v81
    v_sub_f32 v80, v56, v74
    v_sub_f32 v81, v57, v74
    v_cvt_pk_bf16_f32 v80, v80, v81
    v_and_b32 v81, 0xffff0000, v80
    v_lshlrev_b32 v80, 16, v80
    s_add_u32 m0, s33, 45056
    s_nop 0
    buffer_load_dwordx4 v22, s[44:47], s77 offen offset:0 lds
    v_mul_f32 v80, v80, v77
    v_mul_f32 v81, v81, v77
    v_cvt_pk_bf16_f32 v32, v80, v81
    v_sub_f32 v80, v58, v74
    v_sub_f32 v81, v59, v74
    v_cvt_pk_bf16_f32 v80, v80, v81
    v_and_b32 v81, 0xffff0000, v80
    v_lshlrev_b32 v80, 16, v80
    s_add_u32 m0, s33, 49024
    s_nop 0
    buffer_load_dwordx4 v22, s[44:47], s77 offen offset:128 lds
    s_add_u32 m0, s33, 53248
    s_nop 0
    buffer_load_dwordx4 v9, s[48:51], s77 offen lds
    v_mul_f32 v80, v80, v77
    v_mul_f32 v81, v81, v77
    v_cvt_pk_bf16_f32 v33, v80, v81
    v_sub_f32 v80, v60, v74
    v_sub_f32 v81, v61, v74
    v_cvt_pk_bf16_f32 v80, v80, v81
    v_and_b32 v81, 0xffff0000, v80
    v_lshlrev_b32 v80, 16, v80
    s_load_dword s94, s[18:19], s53 offset:0x100
    s_load_dword s94, s[18:19], s53 offset:0x140
    s_load_dword s94, s[18:19], s53 offset:0x180
    s_load_dword s94, s[18:19], s53 offset:0x1c0
    s_waitcnt vmcnt(14)
    s_barrier
    s_add_u32 m0, s79, 137216
    s_add_u32 s78, s78, 32768
    buffer_load_dwordx4 v20, s[36:39], s78 offen lds
    v_mul_f32 v80, v80, v77
    v_mul_f32 v81, v81, v77
    v_cvt_pk_bf16_f32 v34, v80, v81
    v_sub_f32 v80, v62, v74
    v_sub_f32 v81, v63, v74
    v_cvt_pk_bf16_f32 v80, v80, v81
    v_and_b32 v81, 0xffff0000, v80
    v_lshlrev_b32 v80, 16, v80
    s_add_u32 m0, s79, 138240
    s_nop 0
    buffer_load_dwordx4 v21, s[36:39], s78 offen lds
    v_mul_f32 v80, v80, v77
    v_mul_f32 v81, v81, v77
    v_cvt_pk_bf16_f32 v35, v80, v81
    v_sub_f32 v80, v64, v74
    v_sub_f32 v81, v65, v74
    v_cvt_pk_bf16_f32 v80, v80, v81
    v_and_b32 v81, 0xffff0000, v80
    v_lshlrev_b32 v80, 16, v80
    s_add_u32 m0, s33, 57344
    s_add_u32 s77, s77, 229376
    s_cmp_eq_u32 s77, 7340032
    s_cselect_b32 s77, 0, s77
    buffer_load_dwordx4 v22, s[40:43], s77 offen offset:0 lds
    v_mul_f32 v80, v80, v77
    v_mul_f32 v81, v81, v77
    v_cvt_pk_bf16_f32 v36, v80, v81
    v_sub_f32 v80, v66, v74
    v_sub_f32 v81, v67, v74
    v_cvt_pk_bf16_f32 v80, v80, v81
    v_and_b32 v81, 0xffff0000, v80
    v_lshlrev_b32 v80, 16, v80
    s_add_u32 m0, s33, 61312
    s_nop 0
    buffer_load_dwordx4 v22, s[40:43], s77 offen offset:128 lds
    v_mul_f32 v80, v80, v77
    v_mul_f32 v81, v81, v77
    v_cvt_pk_bf16_f32 v37, v80, v81
    v_sub_f32 v80, v68, v74
    v_sub_f32 v81, v69, v74
    v_cvt_pk_bf16_f32 v80, v80, v81
    v_and_b32 v81, 0xffff0000, v80
    v_lshlrev_b32 v80, 16, v80
    s_add_u32 m0, s33, 65536
    s_nop 0
    buffer_load_dwordx4 v22, s[44:47], s77 offen offset:0 lds
    v_mul_f32 v80, v80, v77
    v_mul_f32 v81, v81, v77
    v_cvt_pk_bf16_f32 v38, v80, v81
    v_sub_f32 v80, v70, v74
    v_sub_f32 v81, v71, v74
    v_cvt_pk_bf16_f32 v80, v80, v81
    v_and_b32 v81, 0xffff0000, v80
    v_lshlrev_b32 v80, 16, v80
    s_add_u32 m0, s33, 69504
    s_nop 0
    buffer_load_dwordx4 v22, s[44:47], s77 offen offset:128 lds
    s_add_u32 m0, s33, 73728
    s_nop 0
    buffer_load_dwordx4 v9, s[48:51], s77 offen lds
    v_mul_f32 v80, v80, v77
    v_mul_f32 v81, v81, v77
    v_cvt_pk_bf16_f32 v39, v80, v81
    s_add_u32 s90, s90, 0x1e00000
    v_mov_b32 v7, s90
    s_mov_b64 exec, 1
    global_store_dwordx4 v7, v[72:75], s[26:27] sc1
    s_mov_b64 exec, -1
    v_lshrrev_b32 v64, 4, v1
    v_bfe_u32 v65, v1, 2, 2
    v_and_b32 v66, 3, v1
    v_and_b32 v67, 15, v1
    v_lshrrev_b32 v68, 3, v1
    v_and_b32 v69, 7, v1
    s_lshl_b32 s85, s6, 2
    s_lshl_b32 s86, s5, 1
    s_or_b32 s85, s85, s86
    v_lshl_add_u32 v70, v64, 3, v65
    v_lshlrev_b32 v70, 7, v70
    s_load_dword s94, s[10:11], s52 offset:0x80000
    s_load_dword s94, s[10:11], s52 offset:0x80040
    s_load_dword s94, s[10:11], s52 offset:0x80080
    s_load_dword s94, s[10:11], s52 offset:0x800c0
    global_store_dwordx4 v86, v[24:27], s[26:27] offset:0 sc1
    s_waitcnt vmcnt(16)
    s_barrier
    s_add_u32 m0, s79, 98304
    s_add_u32 s72, s72, 128
    s_and_b32 s78, s72, 0x7ff
    buffer_load_dwordx4 v20, s[36:39], s78 offen lds
    v_and_b32 v71, 1, v66
    v_lshl_add_u32 v70, v71, 3, v70
    v_add_u32 v70, 16384, v70
    v_and_b32 v71, 2, v65
    v_and_b32 v72, 1, v64
    v_lshl_add_u32 v71, v72, 2, v71
    v_lshrrev_b32 v72, 1, v66
    v_xor_b32 v71, v71, v72
    s_add_u32 m0, s79, 99328
    s_nop 0
    buffer_load_dwordx4 v21, s[36:39], s78 offen lds
    v_xor_b32 v71, s85, v71
    v_xor_b32 v72, 0, v71
    v_lshl_add_u32 v4, v72, 4, v70
    v_add_u32 v6, 40960, v4
    v_xor_b32 v72, 2, v71
    v_lshl_add_u32 v5, v72, 4, v70
    v_add_u32 v7, 40960, v5
    v_lshrrev_b32 v70, 1, v67
    s_add_u32 m0, s33, 77824
    s_add_u32 s77, s77, 229376
    buffer_load_dwordx4 v22, s[40:43], s77 offen offset:0 lds
    v_xor_b32 v70, v70, v64
    v_lshlrev_b32 v70, 4, v70
    v_lshl_add_u32 v70, v67, 7, v70
    s_lshl_b32 s85, s5, 13
    v_add_u32 v16, s85, v70
    v_xor_b32 v17, 64, v16
    s_sub_u32 s95, 16384, s85
    s_mov_b32 s80, 135168
    s_lshl_b32 s86, s28, 7
    s_sub_u32 s86, s86, 16
    s_max_i32 s86, s86, 0
    s_lshl_b32 s87, s4, 2
    v_add_u32 v71, s87, v68
    s_add_u32 m0, s33, 81792
    s_nop 0
    buffer_load_dwordx4 v22, s[40:43], s77 offen offset:128 lds
    v_lshrrev_b32 v70, 1, v71
    v_and_b32 v70, 7, v70
    v_xor_b32 v70, v70, v69
    v_lshlrev_b32 v70, 4, v70
    v_add_u32 v71, s86, v71
    v_lshl_add_u32 v3, v71, 11, v70
    s_lshl_b32 s81, s4, 9
    s_lshl_b32 s85, s4, 3
    s_and_b32 s86, s4, 1
    s_lshl_b32 s86, s86, 2
    v_and_b32 v70, 2, v68
    s_add_u32 m0, s33, 86016
    s_nop 0
    buffer_load_dwordx4 v22, s[44:47], s77 offen offset:0 lds
    v_xor_b32 v70, v70, v69
    v_xor_b32 v70, s86, v70
    v_add_u32 v71, s85, v68
    v_mul_u32_u24 v71, 6144, v71
    v_lshl_add_u32 v23, v70, 4, v71
    s_lshl_b32 s85, s4, 12
    v_lshl_add_u32 v10, v1, 4, s85
    s_lshl_b32 s85, s4, 4
    v_and_b32 v70, 2, v68
    v_xor_b32 v70, v70, v69
    s_add_u32 m0, s33, 89984
    s_nop 0
    buffer_load_dwordx4 v22, s[44:47], s77 offen offset:128 lds
    s_add_u32 m0, s33, 94208
    s_nop 0
    buffer_load_dwordx4 v9, s[48:51], s77 offen lds
    v_xor_b32 v70, 0, v70
    v_add_u32 v71, s85, v68
    v_mul_u32_u24 v71, 2048, v71
    v_lshl_add_u32 v11, v70, 4, v71
    s_add_u32 s85, s85, 8
    v_and_b32 v70, 2, v68
    v_xor_b32 v70, v70, v69
    v_xor_b32 v70, 4, v70
    v_add_u32 v71, s85, v68
    s_load_dword s94, s[10:11], s52 offset:0x80100
    s_load_dword s94, s[10:11], s52 offset:0x80140
    s_load_dword s94, s[10:11], s52 offset:0x80180
    s_load_dword s94, s[10:11], s52 offset:0x801c0
    global_store_dwordx4 v86, v[28:31], s[26:27] offset:1024 sc1
    v_mov_b32 v87, 0
    s_mov_b64 exec, 1
    global_load_dwordx2 v[18:19], v87, s[24:25] sc1
    s_mov_b64 exec, -1
    s_waitcnt vmcnt(18)
    s_barrier
    s_add_u32 m0, s79, 100352
    s_add_u32 s78, s78, 32768
    buffer_load_dwordx4 v20, s[36:39], s78 offen lds
    v_mul_u32_u24 v71, 2048, v71
    v_lshl_add_u32 v12, v70, 4, v71
    s_lshl_b32 s85, s31, 8
    s_lshl_b32 s86, s32, 7
    s_add_u32 s86, s85, s86
    s_xor_b32 s87, s86, 128
    s_add_u32 s60, s20, s86
    s_addc_u32 s61, s21, 0
    s_sub_u32 s62, 7340032, s86
    s_mov_b32 s63, 0x20000
    s_add_u32 s64, s20, s87
    s_addc_u32 s65, s21, 0
    s_sub_u32 s66, 7340032, s87
    s_mov_b32 s67, 0x20000
    s_add_u32 s56, s26, 0x400000
    s_addc_u32 s57, s27, 0
    s_mov_b32 s58, 0xe00000
    s_mov_b32 s59, 0x20000
    s_mul_i32 s82, s30, 917504
    s_mul_i32 s85, s32, 327680
    s_add_u32 s82, s82, s85
    s_mul_i32 s83, s32, 2621440
    s_mul_i32 s85, s32, 24
    s_add_u32 m0, s79, 101376
    s_nop 0
    buffer_load_dwordx4 v21, s[36:39], s78 offen lds
    s_sub_u32 s85, 40, s85
    s_lshl_b32 s14, s85, 13
    s_lshl_b32 s35, s85, 16
    s_add_u32 s83, s83, 1966080
    s_add_u32 s82, s82, 262144
    s_lshl_b32 s84, s30, 7
    s_lshl_b32 s85, s5, 6
    s_add_u32 s84, s84, s85
    s_lshl_b32 s84, s84, 11
    s_lshl_b32 s85, s31, 8
    s_add_u32 s84, s84, s85
    s_lshl_b32 s85, s32, 7
    s_add_u32 s84, s84, s85
    s_lshl_b32 s85, s6, 6
    s_add_u32 s84, s84, s85
    v_lshrrev_b32 v70, 2, v1
    v_lshl_add_u32 v71, v66, 4, s84
    v_lshl_add_u32 v13, v70, 11, v71
    v_lshrrev_b32 v72, 4, v1
    s_add_u32 m0, s33, 16384
    s_add_u32 s77, s77, 229376
    s_cmp_eq_u32 s77, 7340032
    s_cselect_b32 s77, 0, s77
    buffer_load_dwordx4 v22, s[40:43], s77 offen offset:0 lds
    v_and_b32 v73, 15, v1
    v_and_b32 v74, 1, v72
    v_xor_b32 v74, s5, v74
    v_lshrrev_b32 v75, 1, v72
    v_lshl_add_u32 v74, v74, 1, v75
    v_lshlrev_b32 v74, 8, v74
    v_lshl_add_u32 v0, v73, 4, v74
    v_lshrrev_b32 v72, 4, v1
    s_add_u32 m0, s33, 20352
    s_nop 0
    buffer_load_dwordx4 v22, s[40:43], s77 offen offset:128 lds
    v_and_b32 v73, 1, v72
    v_lshrrev_b32 v72, 1, v72
    v_lshlrev_b32 v72, 8, v72
    v_lshl_add_u32 v72, v73, 10, v72
    v_and_b32 v73, 15, v1
    v_lshl_add_u32 v8, v73, 4, v72
    s_mov_b32 s54, 7332992
    s_mov_b32 s55, 0x20000
    s_mul_i32 s84, s6, 3072
    s_add_u32 s84, s84, 153600
    v_lshl_add_u32 v85, v1, 3, s84
    s_add_u32 m0, s33, 24576
    s_nop 0
    buffer_load_dwordx4 v22, s[44:47], s77 offen offset:0 lds
    s_add_u32 m0, s33, 28544
    s_nop 0
    buffer_load_dwordx4 v22, s[44:47], s77 offen offset:128 lds
    s_mul_i32 s84, s28, 112
    s_lshl1_add_u32 s85, s29, s6
    s_add_u32 s84, s84, s85
    s_add_u32 s84, s84, 80
    s_lshl_b32 s84, s84, 13
    s_lshl_b32 s86, s5, 12
    s_add_u32 s84, s84, s86
    s_add_u32 s84, s84, 0x400000
    s_lshl_b32 s87, s5, 9
    s_add_u32 s73, s84, s87
    s_xor_b32 s87, s87, 512
    s_add_u32 s74, s84, s87
    s_lshl_b32 s84, s28, 5
    s_add_u32 s84, s84, s85
    s_lshl_b32 s84, s84, 13
    s_add_u32 s84, s84, s86
    s_add_u32 s75, s84, 0x1200000
    v_mov_b32 v84, 0xc0135761
    v_mov_b32 v152, 0
    v_mov_b32 v153, 0
    s_add_u32 m0, s33, 32768
    s_nop 0
    buffer_load_dwordx4 v9, s[48:51], s77 offen lds
    v_mov_b32 v154, 0
    v_mov_b32 v155, 0
    v_mov_b32 v156, 0
    v_mov_b32 v157, 0
    v_mov_b32 v158, 0
    v_mov_b32 v159, 0
    v_mov_b32 v160, 0
    v_mov_b32 v161, 0
    s_add_u32 s52, s52, 0x100000
    s_load_dword s94, s[10:11], s52 offset:0x0
    s_load_dword s94, s[10:11], s52 offset:0x40
    s_load_dword s94, s[10:11], s52 offset:0x80
    s_load_dword s94, s[10:11], s52 offset:0xc0
    global_store_dwordx4 v86, v[32:35], s[26:27] offset:2048 sc1
    s_waitcnt vmcnt(19)
    s_barrier
    s_add_u32 m0, s79, 116736
    s_add_u32 s72, s72, 128
    s_and_b32 s78, s72, 0x7ff
    buffer_load_dwordx4 v20, s[36:39], s78 offen lds
    v_mov_b32 v162, 0
    v_mov_b32 v163, 0
    v_mov_b32 v164, 0
    v_mov_b32 v165, 0
    v_mov_b32 v166, 0
    v_mov_b32 v167, 0
    v_mov_b32 v168, 0
    v_mov_b32 v169, 0
    s_add_u32 m0, s79, 117760
    s_nop 0
    buffer_load_dwordx4 v21, s[36:39], s78 offen lds
    v_mov_b32 v170, 0
    v_mov_b32 v171, 0
    v_mov_b32 v172, 0
    v_mov_b32 v173, 0
    v_mov_b32 v174, 0
    v_mov_b32 v175, 0
    v_mov_b32 v176, 0
    v_mov_b32 v177, 0
    s_add_u32 m0, s33, 36864
    s_add_u32 s77, s77, 229376
    buffer_load_dwordx4 v22, s[40:43], s77 offen offset:0 lds
    v_mov_b32 v178, 0
    v_mov_b32 v179, 0
    v_mov_b32 v180, 0
    v_mov_b32 v181, 0
    v_mov_b32 v182, 0
    v_mov_b32 v183, 0
    v_mov_b32 v184, 0
    v_mov_b32 v185, 0
    s_add_u32 m0, s33, 40832
    s_nop 0
    buffer_load_dwordx4 v22, s[40:43], s77 offen offset:128 lds
    v_mov_b32 v186, 0
    v_mov_b32 v187, 0
    v_mov_b32 v188, 0
    v_mov_b32 v189, 0
    v_mov_b32 v190, 0
    v_mov_b32 v191, 0
    v_mov_b32 v192, 0
    v_mov_b32 v193, 0
    s_add_u32 m0, s33, 45056
    s_nop 0
    buffer_load_dwordx4 v22, s[44:47], s77 offen offset:0 lds
    v_mov_b32 v194, 0
    v_mov_b32 v195, 0
    v_mov_b32 v196, 0
    v_mov_b32 v197, 0
    v_mov_b32 v198, 0
    v_mov_b32 v199, 0
    v_mov_b32 v200, 0
    v_mov_b32 v201, 0
    s_add_u32 m0, s33, 49024
    s_nop 0
    buffer_load_dwordx4 v22, s[44:47], s77 offen offset:128 lds
    s_add_u32 m0, s33, 53248
    s_nop 0
    buffer_load_dwordx4 v9, s[48:51], s77 offen lds
    v_mov_b32 v202, 0
    v_mov_b32 v203, 0
    v_mov_b32 v204, 0
    v_mov_b32 v205, 0
    v_mov_b32 v206, 0
    v_mov_b32 v207, 0
    v_mov_b32 v208, 0
    v_mov_b32 v209, 0
    s_load_dword s94, s[10:11], s52 offset:0x100
    s_load_dword s94, s[10:11], s52 offset:0x140
    s_load_dword s94, s[10:11], s52 offset:0x180
    s_load_dword s94, s[10:11], s52 offset:0x1c0
    global_store_dwordx4 v86, v[36:39], s[26:27] offset:3072 sc1
    s_waitcnt vmcnt(18)
    s_barrier
    s_add_u32 m0, s79, 118784
    s_add_u32 s78, s78, 32768
    buffer_load_dwordx4 v20, s[36:39], s78 offen lds
    v_mov_b32 v210, 0
    v_mov_b32 v211, 0
    v_mov_b32 v212, 0
    v_mov_b32 v213, 0
    v_mov_b32 v214, 0
    v_mov_b32 v215, 0
    v_mov_b32 v216, 0
    v_mov_b32 v217, 0
    s_add_u32 m0, s79, 119808
    s_nop 0
    buffer_load_dwordx4 v21, s[36:39], s78 offen lds
    v_mov_b32 v218, 0
    v_mov_b32 v219, 0
    v_mov_b32 v220, 0
    v_mov_b32 v221, 0
    v_mov_b32 v222, 0
    v_mov_b32 v223, 0
    v_mov_b32 v224, 0
    v_mov_b32 v225, 0
    s_add_u32 m0, s33, 57344
    s_add_u32 s77, s77, 229376
    s_cmp_eq_u32 s77, 7340032
    s_cselect_b32 s77, 0, s77
    buffer_load_dwordx4 v22, s[40:43], s77 offen offset:0 lds
    v_mov_b32 v226, 0
    v_mov_b32 v227, 0
    v_mov_b32 v228, 0
    v_mov_b32 v229, 0
    v_mov_b32 v230, 0
    v_mov_b32 v231, 0
    v_mov_b32 v232, 0
    v_mov_b32 v233, 0
    s_add_u32 m0, s33, 61312
    s_nop 0
    buffer_load_dwordx4 v22, s[40:43], s77 offen offset:128 lds
    v_mov_b32 v234, 0
    v_mov_b32 v235, 0
    v_mov_b32 v236, 0
    v_mov_b32 v237, 0
    v_mov_b32 v238, 0
    v_mov_b32 v239, 0
    v_mov_b32 v240, 0
    v_mov_b32 v241, 0
    s_add_u32 m0, s33, 65536
    s_nop 0
    buffer_load_dwordx4 v22, s[44:47], s77 offen offset:0 lds
    v_mov_b32 v242, 0
    v_mov_b32 v243, 0
    v_mov_b32 v244, 0
    v_mov_b32 v245, 0
    v_mov_b32 v246, 0
    v_mov_b32 v247, 0
    v_mov_b32 v248, 0
    v_mov_b32 v249, 0
    s_add_u32 m0, s33, 69504
    s_nop 0
    buffer_load_dwordx4 v22, s[44:47], s77 offen offset:128 lds
    s_add_u32 m0, s33, 73728
    s_nop 0
    buffer_load_dwordx4 v9, s[48:51], s77 offen lds
    v_mov_b32 v250, 0
    v_mov_b32 v251, 0
    v_mov_b32 v252, 0
    v_mov_b32 v253, 0
    v_mov_b32 v254, 0
    v_mov_b32 v255, 0
    s_load_dword s94, s[10:11], s52 offset:0x80000
    s_load_dword s94, s[10:11], s52 offset:0x80040
    s_load_dword s94, s[10:11], s52 offset:0x80080
    s_load_dword s94, s[10:11], s52 offset:0x800c0
    s_waitcnt vmcnt(16)
    s_barrier
    s_add_u32 m0, s79, 135168
    s_add_u32 s72, s72, 128
    s_and_b32 s78, s72, 0x7ff
    buffer_load_dwordx4 v20, s[36:39], s78 offen lds
    v_mov_b32 v112, 0
    v_mov_b32 v113, 0
    v_mov_b32 v114, 0
    v_mov_b32 v115, 0
    v_mov_b32 v116, 0
    v_mov_b32 v117, 0
    v_mov_b32 v118, 0
    v_mov_b32 v119, 0
    s_add_u32 m0, s79, 136192
    s_nop 0
    buffer_load_dwordx4 v21, s[36:39], s78 offen lds
    v_mov_b32 v120, 0
    v_mov_b32 v121, 0
    v_mov_b32 v122, 0
    v_mov_b32 v123, 0
    v_mov_b32 v124, 0
    v_mov_b32 v125, 0
    v_mov_b32 v126, 0
    v_mov_b32 v127, 0
    s_add_u32 m0, s33, 77824
    s_add_u32 s77, s77, 229376
    buffer_load_dwordx4 v22, s[40:43], s77 offen offset:0 lds
    v_mov_b32 v128, 0
    v_mov_b32 v129, 0
    v_mov_b32 v130, 0
    v_mov_b32 v131, 0
    v_mov_b32 v132, 0
    v_mov_b32 v133, 0
    v_mov_b32 v134, 0
    v_mov_b32 v135, 0
    s_add_u32 m0, s33, 81792
    s_nop 0
    buffer_load_dwordx4 v22, s[40:43], s77 offen offset:128 lds
    v_mov_b32 v136, 0
    v_mov_b32 v137, 0
    v_mov_b32 v138, 0
    v_mov_b32 v139, 0
    v_mov_b32 v140, 0
    v_mov_b32 v141, 0
    v_mov_b32 v142, 0
    v_mov_b32 v143, 0
    s_add_u32 m0, s33, 86016
    s_nop 0
    buffer_load_dwordx4 v22, s[44:47], s77 offen offset:0 lds
    v_mov_b32 v144, 0
    v_mov_b32 v145, 0
    v_mov_b32 v146, 0
    v_mov_b32 v147, 0
    v_mov_b32 v148, 0
    v_mov_b32 v149, 0
    v_mov_b32 v150, 0
    v_mov_b32 v151, 0
    s_add_u32 m0, s33, 89984
    s_nop 0
    buffer_load_dwordx4 v22, s[44:47], s77 offen offset:128 lds
    s_add_u32 m0, s33, 94208
    s_nop 0
    buffer_load_dwordx4 v9, s[48:51], s77 offen lds
    s_load_dword s94, s[10:11], s52 offset:0x80100
    s_load_dword s94, s[10:11], s52 offset:0x80140
    s_load_dword s94, s[10:11], s52 offset:0x80180
    s_load_dword s94, s[10:11], s52 offset:0x801c0
    s_waitcnt vmcnt(30)
    s_movk_i32 s98, 0x4000
L_tokB_chk:
    v_readfirstlane_b32 s100, v18
    v_readfirstlane_b32 s101, v19
    s_nop 1
    s_cmp_lg_u32 s100, 0
    s_cbranch_scc1 L_tokB_ok
    s_sub_u32 s98, s98, 1
    s_cbranch_scc1 L_tokB_ok
    s_sleep 1
    global_load_dwordx2 v[18:19], v87, s[24:25] sc1
    s_waitcnt vmcnt(0)
    s_branch L_tokB_chk
L_tokB_ok:
    s_waitcnt vmcnt(14)
    s_waitcnt vmcnt(15)
    s_barrier
    s_add_u32 m0, s79, 137216
    s_add_u32 s78, s78, 32768
    buffer_load_dwordx4 v20, s[36:39], s78 offen lds
    s_add_u32 m0, s79, 138240
    s_nop 0
    buffer_load_dwordx4 v21, s[36:39], s78 offen lds
    s_add_u32 m0, s33, 16384
    s_add_u32 s77, s77, 229376
    s_cmp_eq_u32 s77, 7340032
    s_cselect_b32 s77, 0, s77
    buffer_load_dwordx4 v22, s[40:43], s77 offen offset:0 lds
    s_add_u32 m0, s33, 20352
    s_nop 0
    buffer_load_dwordx4 v22, s[40:43], s77 offen offset:128 lds
    s_add_u32 m0, s33, 24576
    s_nop 0
    buffer_load_dwordx4 v22, s[44:47], s77 offen offset:0 lds
    s_add_u32 m0, s33, 28544
    s_nop 0
    buffer_load_dwordx4 v22, s[44:47], s77 offen offset:128 lds
    s_add_u32 m0, s33, 32768
    s_nop 0
    buffer_load_dwordx4 v9, s[48:51], s77 offen lds
    s_add_u32 s53, s53, 0x1c0000
    s_load_dword s94, s[16:17], s53 offset:0x0
    s_load_dword s94, s[16:17], s53 offset:0x40
    s_load_dword s94, s[16:17], s53 offset:0x80
    s_load_dword s94, s[16:17], s53 offset:0xc0
    s_cmp_lg_u32 s4, 0
    s_cbranch_scc1 L_fLN
    s_lshl_b32 s91, s28, 4
    s_add_u32 s91, s91, s29
    s_lshl_b32 s91, s91, 7
    s_add_u32 s91, s91, 0x1e80000
    v_mov_b32 v24, s91
    v_mov_b32 v26, s100
    v_mov_b32 v27, s101
    s_mov_b64 exec, 1
    global_store_dwordx2 v24, v[26:27], s[26:27] sc1
    s_mov_b64 exec, -1
L_fLN:
    s_waitcnt vmcnt(14)
    s_barrier
    s_add_u32 m0, s79, 98304
    s_add_u32 s72, s72, 128
    s_and_b32 s78, s72, 0x7ff
    buffer_load_dwordx4 v20, s[36:39], s78 offen lds
    s_add_u32 m0, s79, 99328
    s_nop 0
    buffer_load_dwordx4 v21, s[36:39], s78 offen lds
    s_add_u32 m0, s33, 36864
    s_add_u32 s77, s77, 229376
    buffer_load_dwordx4 v22, s[40:43], s77 offen offset:0 lds
    s_add_u32 m0, s33, 40832
    s_nop 0
    buffer_load_dwordx4 v22, s[40:43], s77 offen offset:128 lds
    s_add_u32 m0, s33, 45056
    s_nop 0
    buffer_load_dwordx4 v22, s[44:47], s77 offen offset:0 lds
    s_add_u32 m0, s33, 49024
    s_nop 0
    buffer_load_dwordx4 v22, s[44:47], s77 offen offset:128 lds
    s_add_u32 m0, s33, 53248
    s_nop 0
    buffer_load_dwordx4 v9, s[48:51], s77 offen lds
    s_load_dword s94, s[16:17], s53 offset:0x100
    s_load_dword s94, s[16:17], s53 offset:0x140
    s_load_dword s94, s[16:17], s53 offset:0x180
    s_load_dword s94, s[16:17], s53 offset:0x1c0
    s_waitcnt vmcnt(14)
    s_barrier
    s_add_u32 m0, s79, 100352
    s_add_u32 s78, s78, 32768
    buffer_load_dwordx4 v20, s[36:39], s78 offen lds
    s_add_u32 m0, s79, 101376
    s_nop 0
    buffer_load_dwordx4 v21, s[36:39], s78 offen lds
    s_add_u32 m0, s33, 57344
    s_add_u32 s77, s77, 229376
    s_cmp_eq_u32 s77, 7340032
    s_cselect_b32 s77, 0, s77
    buffer_load_dwordx4 v22, s[40:43], s77 offen offset:0 lds
    s_add_u32 m0, s33, 61312
    s_nop 0
    buffer_load_dwordx4 v22, s[40:43], s77 offen offset:128 lds
    s_add_u32 m0, s33, 65536
    s_nop 0
    buffer_load_dwordx4 v22, s[44:47], s77 offen offset:0 lds
    s_add_u32 m0, s33, 69504
    s_nop 0
    buffer_load_dwordx4 v22, s[44:47], s77 offen offset:128 lds
    s_add_u32 m0, s33, 73728
    s_nop 0
    buffer_load_dwordx4 v9, s[48:51], s77 offen lds
    s_load_dword s94, s[18:19], s53 offset:0x0
    s_load_dword s94, s[18:19], s53 offset:0x40
    s_load_dword s94, s[18:19], s53 offset:0x80
    s_load_dword s94, s[18:19], s53 offset:0xc0
    s_waitcnt vmcnt(14)
    s_barrier
    s_add_u32 m0, s79, 116736
    s_add_u32 s72, s72, 128
    s_and_b32 s78, s72, 0x7ff
    buffer_load_dwordx4 v20, s[36:39], s78 offen lds
    s_add_u32 m0, s79, 117760
    s_nop 0
    buffer_load_dwordx4 v21, s[36:39], s78 offen lds
    s_add_u32 m0, s33, 77824
    s_add_u32 s77, s77, 229376
    buffer_load_dwordx4 v22, s[40:43], s77 offen offset:0 lds
    s_add_u32 m0, s33, 81792
    s_nop 0
    buffer_load_dwordx4 v22, s[40:43], s77 offen offset:128 lds
    s_add_u32 m0, s33, 86016
    s_nop 0
    buffer_load_dwordx4 v22, s[44:47], s77 offen offset:0 lds
    s_add_u32 m0, s33, 89984
    s_nop 0
    buffer_load_dwordx4 v22, s[44:47], s77 offen offset:128 lds
    s_add_u32 m0, s33, 94208
    s_nop 0
    buffer_load_dwordx4 v9, s[48:51], s77 offen lds
    s_load_dword s94, s[18:19], s53 offset:0x100
    s_load_dword s94, s[18:19], s53 offset:0x140
    s_load_dword s94, s[18:19], s53 offset:0x180
    s_load_dword s94, s[18:19], s53 offset:0x1c0
    s_waitcnt vmcnt(14)
    s_barrier
    s_add_u32 m0, s79, 118784
    s_add_u32 s78, s78, 32768
    buffer_load_dwordx4 v20, s[36:39], s78 offen lds
    s_add_u32 m0, s79, 119808
    s_nop 0
    buffer_load_dwordx4 v21, s[36:39], s78 offen lds
    s_add_u32 m0, s33, 16384
    s_add_u32 s77, s77, 229376
    s_cmp_eq_u32 s77, 7340032
    s_cselect_b32 s77, 0, s77
    buffer_load_dwordx4 v22, s[40:43], s77 offen offset:0 lds
    s_add_u32 m0, s33, 20352
    s_nop 0
    buffer_load_dwordx4 v22, s[40:43], s77 offen offset:128 lds
    s_add_u32 m0, s33, 24576
    s_nop 0
    buffer_load_dwordx4 v22, s[44:47], s77 offen offset:0 lds
    s_add_u32 m0, s33, 28544
    s_nop 0
    buffer_load_dwordx4 v22, s[44:47], s77 offen offset:128 lds
    s_add_u32 m0, s33, 32768
    s_nop 0
    buffer_load_dwordx4 v9, s[48:51], s77 offen lds
    s_add_u32 s52, s52, 0x100000
    s_load_dword s94, s[10:11], s52 offset:0x0
    s_load_dword s94, s[10:11], s52 offset:0x40
    s_load_dword s94, s[10:11], s52 offset:0x80
    s_load_dword s94, s[10:11], s52 offset:0xc0
    s_waitcnt vmcnt(14)
    s_barrier
    s_add_u32 m0, s79, 135168
    s_add_u32 s72, s72, 128
    s_and_b32 s78, s72, 0x7ff
    buffer_load_dwordx4 v20, s[36:39], s78 offen lds
    s_add_u32 m0, s79, 136192
    s_nop 0
    buffer_load_dwordx4 v21, s[36:39], s78 offen lds
    s_add_u32 m0, s33, 36864
    s_add_u32 s77, s77, 229376
    buffer_load_dwordx4 v22, s[40:43], s77 offen offset:0 lds
    s_add_u32 m0, s33, 40832
    s_nop 0
    buffer_load_dwordx4 v22, s[40:43], s77 offen offset:128 lds
    s_add_u32 m0, s33, 45056
    s_nop 0
    buffer_load_dwordx4 v22, s[44:47], s77 offen offset:0 lds
    s_add_u32 m0, s33, 49024
    s_nop 0
    buffer_load_dwordx4 v22, s[44:47], s77 offen offset:128 lds
    s_add_u32 m0, s33, 53248
    s_nop 0
    buffer_load_dwordx4 v9, s[48:51], s77 offen lds
    s_load_dword s94, s[10:11], s52 offset:0x100
    s_load_dword s94, s[10:11], s52 offset:0x140
    s_load_dword s94, s[10:11], s52 offset:0x180
    s_load_dword s94, s[10:11], s52 offset:0x1c0
    s_waitcnt vmcnt(14)
    s_barrier
    s_add_u32 m0, s79, 137216
    s_add_u32 s78, s78, 32768
    buffer_load_dwordx4 v20, s[36:39], s78 offen lds
    s_add_u32 m0, s79, 138240
    s_nop 0
    buffer_load_dwordx4 v21, s[36:39], s78 offen lds
    s_add_u32 m0, s33, 57344
    s_add_u32 s77, s77, 229376
    s_cmp_eq_u32 s77, 7340032
    s_cselect_b32 s77, 0, s77
    buffer_load_dwordx4 v22, s[40:43], s77 offen offset:0 lds
    s_add_u32 m0, s33, 61312
    s_nop 0
    buffer_load_dwordx4 v22, s[40:43], s77 offen offset:128 lds
    s_add_u32 m0, s33, 65536
    s_nop 0
    buffer_load_dwordx4 v22, s[44:47], s77 offen offset:0 lds
    s_add_u32 m0, s33, 69504
    s_nop 0
    buffer_load_dwordx4 v22, s[44:47], s77 offen offset:128 lds
    s_add_u32 m0, s33, 73728
    s_nop 0
    buffer_load_dwordx4 v9, s[48:51], s77 offen lds
    s_load_dword s94, s[10:11], s52 offset:0x80000
    s_load_dword s94, s[10:11], s52 offset:0x80040
    s_load_dword s94, s[10:11], s52 offset:0x80080
    s_load_dword s94, s[10:11], s52 offset:0x800c0
    s_sub_u32 s91, s28, s6
    s_max_i32 s91, s91, 0
    s_lshl_b32 s91, s91, 4
    s_cmp_lg_u32 s5, 0
    s_cselect_b32 s91, s29, s91
    s_cselect_b32 s92, 11, 7
    s_lshl_b32 s91, s91, 7
    s_add_u32 s91, s91, 0x1e80000
    v_lshlrev_b32 v87, s92, v1
    v_add_u32 v87, s91, v87
    s_mov_b64 exec, 0xffff
    global_load_dwordx2 v[18:19], v87, s[26:27] sc1
    s_mov_b64 exec, -1
    s_waitcnt vmcnt(15)
    s_barrier
    s_add_u32 m0, s79, 98304
    s_add_u32 s72, s72, 128
    s_and_b32 s78, s72, 0x7ff
    buffer_load_dwordx4 v20, s[36:39], s78 offen lds
    s_add_u32 m0, s79, 99328
    s_nop 0
    buffer_load_dwordx4 v21, s[36:39], s78 offen lds
    s_add_u32 m0, s33, 77824
    s_add_u32 s77, s77, 229376
    buffer_load_dwordx4 v22, s[40:43], s77 offen offset:0 lds
    s_add_u32 m0, s33, 81792
    s_nop 0
    buffer_load_dwordx4 v22, s[40:43], s77 offen offset:128 lds
    s_add_u32 m0, s33, 86016
    s_nop 0
    buffer_load_dwordx4 v22, s[44:47], s77 offen offset:0 lds
    s_add_u32 m0, s33, 89984
    s_nop 0
    buffer_load_dwordx4 v22, s[44:47], s77 offen offset:128 lds
    s_add_u32 m0, s33, 94208
    s_nop 0
    buffer_load_dwordx4 v9, s[48:51], s77 offen lds
    s_load_dword s94, s[10:11], s52 offset:0x80100
    s_load_dword s94, s[10:11], s52 offset:0x80140
    s_load_dword s94, s[10:11], s52 offset:0x80180
    s_load_dword s94, s[10:11], s52 offset:0x801c0
    s_waitcnt vmcnt(7)
    s_mov_b64 exec, 0xffff
    s_movk_i32 s98, 0x4000
L_pLN_chk:
    v_cmp_ne_u64 vcc, s[100:101], v[18:19]
    s_nop 1
    s_cmp_eq_u64 vcc, 0
    s_cbranch_scc1 L_pLN_ok
    s_sub_u32 s98, s98, 1
    s_cbranch_scc1 L_pLN_ok
    s_sleep 1
    global_load_dwordx2 v[18:19], v87, s[26:27] sc1
    s_waitcnt vmcnt(0)
    s_branch L_pLN_chk
L_pLN_ok:
    s_mov_b64 exec, -1
    s_waitcnt vmcnt(15)
    s_barrier
    s_mul_i32 s91, s29, 20480
    s_mul_i32 s92, s4, 320
    s_add_u32 s91, s91, s92
    s_add_u32 s91, s91, 0x1e10000
    v_lshrrev_b32 v24, 2, v1
    v_mul_u32_u24 v24, 1280, v24
    v_and_b32 v25, 3, v1
    v_lshlrev_b32 v25, 4, v25
    v_add3_u32 v24, v24, v25, s91
    global_load_dwordx4 v[88:91], v24, s[26:27] offset:0 sc1
    global_load_dwordx4 v[92:95], v24, s[26:27] offset:64 sc1
    global_load_dwordx4 v[96:99], v24, s[26:27] offset:128 sc1
    global_load_dwordx4 v[100:103], v24, s[26:27] offset:192 sc1
    global_load_dwordx4 v[104:107], v24, s[26:27] offset:256 sc1
    s_add_u32 s92, s92, 159744
    v_lshrrev_b32 v37, 4, v1
    v_add_u32 v25, s92, v25
    v_lshl_add_u32 v36, v37, 2, v25
    v_lshl_add_u32 v25, v37, 6, v25
    s_lshl_b32 s91, s28, 2
    s_add_u32 s91, s91, s4
    s_lshl_b32 s91, s91, 8
    s_add_u32 s91, s91, 0x1e00000
    v_and_b32 v27, 31, v1
    v_lshl_add_u32 v26, v27, 3, s91
    global_load_dwordx2 v[28:29], v26, s[26:27] sc1
    s_lshl_b32 s91, s4, 9
    s_add_u32 s91, s91, 161024
    v_lshl_add_u32 v27, v27, 4, s91
    s_add_u32 m0, s79, 100352
    s_add_u32 s78, s78, 32768
    buffer_load_dwordx4 v20, s[36:39], s78 offen lds
    s_add_u32 m0, s79, 101376
    s_nop 0
    buffer_load_dwordx4 v21, s[36:39], s78 offen lds
    s_add_u32 m0, s33, 16384
    s_add_u32 s77, s77, 229376
    s_cmp_eq_u32 s77, 7340032
    s_cselect_b32 s77, 0, s77
    buffer_load_dwordx4 v22, s[40:43], s77 offen offset:0 lds
    s_add_u32 m0, s33, 20352
    s_nop 0
    buffer_load_dwordx4 v22, s[40:43], s77 offen offset:128 lds
    s_add_u32 m0, s33, 24576
    s_nop 0
    buffer_load_dwordx4 v22, s[44:47], s77 offen offset:0 lds
    s_add_u32 m0, s33, 28544
    s_nop 0
    buffer_load_dwordx4 v22, s[44:47], s77 offen offset:128 lds
    s_add_u32 m0, s33, 32768
    s_nop 0
    buffer_load_dwordx4 v9, s[48:51], s77 offen lds
    s_add_u32 s52, s52, 0x100000
    s_load_dword s94, s[10:11], s52 offset:0x0
    s_load_dword s94, s[10:11], s52 offset:0x40
    s_load_dword s94, s[10:11], s52 offset:0x80
    s_load_dword s94, s[10:11], s52 offset:0xc0
    s_waitcnt vmcnt(21)
    s_barrier
    s_add_u32 m0, s79, 116736
    s_add_u32 s72, s72, 128
    s_and_b32 s78, s72, 0x7ff
    buffer_load_dwordx4 v20, s[36:39], s78 offen lds
    s_add_u32 m0, s79, 117760
    s_nop 0
    buffer_load_dwordx4 v21, s[36:39], s78 offen lds
    s_add_u32 m0, s33, 36864
    s_add_u32 s77, s77, 229376
    buffer_load_dwordx4 v22, s[40:43], s77 offen offset:0 lds
    s_add_u32 m0, s33, 40832
    s_nop 0
    buffer_load_dwordx4 v22, s[40:43], s77 offen offset:128 lds
    s_add_u32 m0, s33, 45056
    s_nop 0
    buffer_load_dwordx4 v22, s[44:47], s77 offen offset:0 lds
    s_add_u32 m0, s33, 49024
    s_nop 0
    buffer_load_dwordx4 v22, s[44:47], s77 offen offset:128 lds
    s_add_u32 m0, s33, 53248
    s_nop 0
    buffer_load_dwordx4 v9, s[48:51], s77 offen lds
    s_load_dword s94, s[10:11], s52 offset:0x100
    s_load_dword s94, s[10:11], s52 offset:0x140
    s_load_dword s94, s[10:11], s52 offset:0x180
    s_load_dword s94, s[10:11], s52 offset:0x1c0
    s_waitcnt vmcnt(20)
    s_barrier
    s_add_u32 m0, s79, 118784
    s_add_u32 s78, s78, 32768
    buffer_load_dwordx4 v20, s[36:39], s78 offen lds
    s_waitcnt vmcnt(15)
    v_rcp_f32 v30, v29
    v_mul_f32 v32, -1.0, v28
    v_mul_f32 v35, v29, v29
    v_fma_f32 v31, -v29, v30, 1.0
    v_fma_f32 v30, v31, v30, v30
    v_mul_f32 v33, 0xc0135761, v30
    v_mul_f32 v31, v30, v30
    s_add_u32 m0, s79, 119808
    s_nop 0
    buffer_load_dwordx4 v21, s[36:39], s78 offen lds
    v_mul_f32 v31, v31, v30
    v_mul_f32 v34, 0xbdd2d3e8, v31
    ds_write_b128 v27, v[32:35]
    v_permlane16_swap_b32 v88, v92
    v_permlane16_swap_b32 v96, v100
    v_permlane16_swap_b32 v89, v93
    v_permlane16_swap_b32 v97, v101
    v_permlane16_swap_b32 v90, v94
    v_permlane16_swap_b32 v98, v102
    s_add_u32 m0, s33, 57344
    s_add_u32 s77, s77, 229376
    s_cmp_eq_u32 s77, 7340032
    s_cselect_b32 s77, 0, s77
    buffer_load_dwordx4 v22, s[40:43], s77 offen offset:0 lds
    v_permlane16_swap_b32 v91, v95
    v_permlane16_swap_b32 v99, v103
    v_permlane16_swap_b32 v104, v105
    v_permlane16_swap_b32 v106, v107
    v_add_f32 v88, v88, v92
    v_add_f32 v96, v96, v100
    v_add_f32 v89, v89, v93
    v_add_f32 v97, v97, v101
    s_add_u32 m0, s33, 61312
    s_nop 0
    buffer_load_dwordx4 v22, s[40:43], s77 offen offset:128 lds
    v_add_f32 v90, v90, v94
    v_add_f32 v98, v98, v102
    v_add_f32 v91, v91, v95
    v_add_f32 v99, v99, v103
    v_add_f32 v104, v104, v105
    v_add_f32 v106, v106, v107
    s_nop 0
    v_permlane32_swap_b32 v88, v96
    v_permlane32_swap_b32 v89, v97
    s_add_u32 m0, s33, 65536
    s_nop 0
    buffer_load_dwordx4 v22, s[44:47], s77 offen offset:0 lds
    v_permlane32_swap_b32 v90, v98
    v_permlane32_swap_b32 v91, v99
    v_permlane32_swap_b32 v104, v106
    v_add_f32 v88, v88, v96
    v_add_f32 v89, v89, v97
    v_add_f32 v90, v90, v98
    v_add_f32 v91, v91, v99
    v_add_f32 v104, v104, v106
    s_add_u32 m0, s33, 69504
    s_nop 0
    buffer_load_dwordx4 v22, s[44:47], s77 offen offset:128 lds
    s_add_u32 m0, s33, 73728
    s_nop 0
    buffer_load_dwordx4 v9, s[48:51], s77 offen lds
    v_add_f32_dpp v88, v88, v88 row_ror:8 row_mask:0xf bank_mask:0xf
    v_add_f32_dpp v89, v89, v89 row_ror:8 row_mask:0xf bank_mask:0xf
    v_add_f32_dpp v90, v90, v90 row_ror:8 row_mask:0xf bank_mask:0xf
    v_add_f32_dpp v91, v91, v91 row_ror:8 row_mask:0xf bank_mask:0xf
    v_add_f32_dpp v104, v104, v104 row_ror:8 row_mask:0xf bank_mask:0xf
    v_add_f32_dpp v88, v88, v88 row_ror:4 row_mask:0xf bank_mask:0xf
    v_add_f32_dpp v89, v89, v89 row_ror:4 row_mask:0xf bank_mask:0xf
    v_add_f32_dpp v90, v90, v90 row_ror:4 row_mask:0xf bank_mask:0xf
    s_add_u32 s53, s53, 0x1c0000
    s_load_dword s94, s[16:17], s53 offset:0x0
    s_load_dword s94, s[16:17], s53 offset:0x40
    s_load_dword s94, s[16:17], s53 offset:0x80
    s_load_dword s94, s[16:17], s53 offset:0xc0
    s_waitcnt vmcnt(14)
    s_barrier
    s_mov_b32 s36, s26
    s_mov_b32 s37, s27
    s_mov_b32 s38, 0x400000
    s_mov_b32 s39, 0x20000
    s_add_u32 m0, s33, 77824
    s_add_u32 s77, s77, 229376
    buffer_load_dwordx4 v22, s[40:43], s77 offen offset:0 lds
    v_add_f32_dpp v91, v91, v91 row_ror:4 row_mask:0xf bank_mask:0xf
    v_add_f32_dpp v104, v104, v104 row_ror:4 row_mask:0xf bank_mask:0xf
    s_mov_b32 s92, 0x000f000f
    s_mov_b32 s93, s92
    s_mov_b64 exec, s[92:93]
    ds_write_b128 v25, v[88:91]
    ds_write_b32 v36, v104 offset:256
    s_mov_b64 exec, -1
    v_mov_b32 v88, 0
    v_mov_b32 v89, 0
    v_mov_b32 v90, 0
    v_mov_b32 v91, 0
    v_mov_b32 v92, 0
    v_mov_b32 v93, 0
    v_mov_b32 v94, 0
    v_mov_b32 v95, 0
    s_add_u32 m0, s33, 81792
    s_nop 0
    buffer_load_dwordx4 v22, s[40:43], s77 offen offset:128 lds
    s_add_u32 m0, s33, 86016
    s_nop 0
    buffer_load_dwordx4 v22, s[44:47], s77 offen offset:0 lds
    v_mov_b32 v96, 0
    v_mov_b32 v97, 0
    v_mov_b32 v98, 0
    v_mov_b32 v99, 0
    v_mov_b32 v100, 0
    v_mov_b32 v101, 0
    v_mov_b32 v102, 0
    v_mov_b32 v103, 0
    s_add_u32 m0, s33, 89984
    s_nop 0
    buffer_load_dwordx4 v22, s[44:47], s77 offen offset:128 lds
    v_mov_b32 v104, 0
    v_mov_b32 v105, 0
    v_mov_b32 v106, 0
    v_mov_b32 v107, 0
    v_mov_b32 v108, 0
    v_mov_b32 v109, 0
    v_mov_b32 v110, 0
    v_mov_b32 v111, 0
    s_add_u32 m0, s33, 94208
    s_nop 0
    buffer_load_dwordx4 v9, s[48:51], s77 offen lds
    s_add_u32 m0, s79, 135168
    s_mov_b32 s78, 0
    buffer_load_dwordx4 v20, s[36:39], s78 offen sc1 lds
    s_add_u32 m0, s79, 136192
    s_nop 0
    buffer_load_dwordx4 v21, s[36:39], s78 offen sc1 lds
    s_waitcnt vmcnt(14)
    s_barrier
    s_lshl_b32 s85, s29, 7
    s_add_u32 s86, s85, 4096
    s_add_u32 s87, s85, 5120
    s_add_u32 s40, s10, s85
    s_addc_u32 s41, s11, 0
    s_add_u32 s44, s10, s86
    s_addc_u32 s45, s11, 0
    s_add_u32 s48, s16, s87
    s_addc_u32 s49, s17, 0
    s_add_u32 s52, s18, s87
    s_addc_u32 s53, s19, 0
    s_sub_u32 s42, 6291456, s85
    s_sub_u32 s46, 6291456, s86
    s_mov_b32 s50, s54
    s_add_u32 m0, s79, 137216
    s_mov_b32 s78, 32768
    buffer_load_dwordx4 v20, s[36:39], s78 offen sc1 lds
    s_add_u32 m0, s79, 138240
    s_nop 0
    buffer_load_dwordx4 v21, s[36:39], s78 offen sc1 lds
    s_add_u32 m0, s81, 151552
    s_mov_b32 s78, 0
    s_mov_b64 exec, 0xffffffff
    buffer_load_dwordx4 v3, s[36:39], s78 offen sc1 lds
    s_mov_b64 exec, -1
    s_add_u32 m0, s33, 16384
    s_mov_b32 s76, 0
    buffer_load_dwordx4 v23, s[40:43], s76 offen offset:0 lds
    s_add_u32 m0, s33, 18432
    s_nop 0
    buffer_load_dwordx4 v23, s[40:43], s76 offen offset:2048 lds
    s_add_u32 m0, s33, 24576
    s_nop 0
    buffer_load_dwordx4 v23, s[44:47], s76 offen offset:0 lds
    s_add_u32 m0, s33, 28672
    s_mov_b32 s77, 0
    buffer_load_dwordx4 v22, s[48:51], s77 offen offset:0 lds
    s_add_u32 m0, s33, 32768
    s_nop 0
    buffer_load_dwordx4 v22, s[52:55], s77 offen offset:0 lds
    s_waitcnt vmcnt(15)
    s_barrier
    s_add_u32 m0, s79, 98304
    s_mov_b32 s78, 128
    buffer_load_dwordx4 v20, s[36:39], s78 offen sc1 lds
    s_add_u32 m0, s79, 99328
    s_nop 0
    buffer_load_dwordx4 v21, s[36:39], s78 offen sc1 lds
    s_add_u32 m0, s33, 36864
    s_mov_b32 s76, 196608
    buffer_load_dwordx4 v23, s[40:43], s76 offen offset:0 lds
    s_add_u32 m0, s33, 38912
    s_nop 0
    buffer_load_dwordx4 v23, s[40:43], s76 offen offset:2048 lds
    s_add_u32 m0, s33, 45056
    s_nop 0
    buffer_load_dwordx4 v23, s[44:47], s76 offen offset:0 lds
    s_add_u32 m0, s33, 49152
    s_mov_b32 s77, 229376
    buffer_load_dwordx4 v22, s[48:51], s77 offen offset:0 lds
    s_add_u32 m0, s33, 53248
    s_nop 0
    buffer_load_dwordx4 v22, s[52:55], s77 offen offset:0 lds
    s_waitcnt vmcnt(17)
    s_barrier
    s_add_u32 m0, s79, 100352
    s_mov_b32 s78, 32896
    buffer_load_dwordx4 v20, s[36:39], s78 offen sc1 lds
    s_add_u32 m0, s79, 101376
    s_nop 0
    buffer_load_dwordx4 v21, s[36:39], s78 offen sc1 lds
    s_add_u32 m0, s81, 114688
    s_mov_b32 s78, 128
    s_mov_b64 exec, 0xffffffff
    buffer_load_dwordx4 v3, s[36:39], s78 offen sc1 lds
    s_mov_b64 exec, -1
    s_add_u32 m0, s33, 57344
    s_mov_b32 s76, 393216
    buffer_load_dwordx4 v23, s[40:43], s76 offen offset:0 lds
    s_add_u32 m0, s33, 59392
    s_nop 0
    buffer_load_dwordx4 v23, s[40:43], s76 offen offset:2048 lds
    s_add_u32 m0, s33, 65536
    s_nop 0
    buffer_load_dwordx4 v23, s[44:47], s76 offen offset:0 lds
    s_add_u32 m0, s33, 69632
    s_mov_b32 s77, 458752
    buffer_load_dwordx4 v22, s[48:51], s77 offen offset:0 lds
    s_add_u32 m0, s33, 73728
    s_nop 0
    buffer_load_dwordx4 v22, s[52:55], s77 offen offset:0 lds
    s_waitcnt lgkmcnt(0)
    s_waitcnt vmcnt(15)
    s_barrier
    s_setprio 1
    v_add_u32 v14, s80, v16
    v_add_u32 v15, s80, v17
    s_add_u32 s84, s80, s95
    v_add_u32 v18, s84, v16
    v_add_u32 v19, s84, v17
    s_add_u32 s80, s80, 18432
    s_cmp_ge_u32 s80, 153600
    s_cselect_b32 s84, 55296, 0
    s_sub_u32 s80, s80, s84
    ds_read_b64_tr_b16 v[64:65], v4 offset:4096
    ds_read_b64_tr_b16 v[66:67], v4 offset:4608
    ds_read_b128 v[24:27], v14 offset:0
    ds_read_b128 v[28:31], v14 offset:2048
    ds_read_b128 v[32:35], v14 offset:4096
    ds_read_b128 v[36:39], v14 offset:6144
    ds_read_b64_tr_b16 v[68:69], v5 offset:4096
    ds_read_b64_tr_b16 v[70:71], v5 offset:4608
    ds_read_b64_tr_b16 v[72:73], v4 offset:8192
    ds_read_b64_tr_b16 v[74:75], v4 offset:8704
    ds_read_b128 v[56:59], v18
    s_mov_b32 s34, 7
.p2align 6
L_p2:
    s_waitcnt lgkmcnt(8)
    v_mfma_f32_16x16x32_bf16 v[88:91], v[64:67], v[24:27], v[88:91]
    ds_read_b64_tr_b16 v[76:77], v5 offset:8192
    s_waitcnt lgkmcnt(8)
    v_mfma_f32_16x16x32_bf16 v[92:95], v[64:67], v[28:31], v[92:95]
    ds_read_b64_tr_b16 v[78:79], v5 offset:8704
    s_waitcnt lgkmcnt(8)
    v_mfma_f32_16x16x32_bf16 v[96:99], v[64:67], v[32:35], v[96:99]
    ds_read_b64_tr_b16 v[80:81], v4 offset:0
    s_waitcnt lgkmcnt(8)
    v_mfma_f32_16x16x32_bf16 v[100:103], v[64:67], v[36:39], v[100:103]
    ds_read_b64_tr_b16 v[82:83], v4 offset:512
    s_waitcnt lgkmcnt(4)
    v_mfma_f32_16x16x32_bf16 v[248:251], v[64:67], v[56:59], v[248:251]
    v_mfma_f32_16x16x32_bf16 v[104:107], v[68:71], v[24:27], v[104:107]
    ds_read_b64_tr_b16 v[64:65], v5 offset:0
    v_mfma_f32_16x16x32_bf16 v[108:111], v[68:71], v[28:31], v[108:111]
    v_mfma_f32_16x16x32_bf16 v[112:115], v[68:71], v[32:35], v[112:115]
    ds_read_b64_tr_b16 v[66:67], v5 offset:512
    v_mfma_f32_16x16x32_bf16 v[116:119], v[68:71], v[36:39], v[116:119]
    v_mfma_f32_16x16x32_bf16 v[120:123], v[24:27], v[72:75], v[120:123]
    ds_read_b64_tr_b16 v[68:69], v4 offset:12288
    v_mfma_f32_16x16x32_bf16 v[124:127], v[28:31], v[72:75], v[124:127]
    v_mfma_f32_16x16x32_bf16 v[128:131], v[32:35], v[72:75], v[128:131]
    ds_read_b64_tr_b16 v[70:71], v4 offset:12800
    v_mfma_f32_16x16x32_bf16 v[132:135], v[36:39], v[72:75], v[132:135]
    v_mfma_f32_16x16x32_bf16 v[252:255], v[56:59], v[72:75], v[252:255]
    s_waitcnt lgkmcnt(6)
    v_mfma_f32_16x16x32_bf16 v[136:139], v[24:27], v[76:79], v[136:139]
    ds_read_b64_tr_b16 v[72:73], v4 offset:16384
    v_mfma_f32_16x16x32_bf16 v[140:143], v[28:31], v[76:79], v[140:143]
    v_mfma_f32_16x16x32_bf16 v[144:147], v[32:35], v[76:79], v[144:147]
    ds_read_b64_tr_b16 v[74:75], v4 offset:16896
    v_mfma_f32_16x16x32_bf16 v[148:151], v[36:39], v[76:79], v[148:151]
    s_waitcnt lgkmcnt(6)
    v_mfma_f32_16x16x32_bf16 v[152:155], v[80:83], v[24:27], v[152:155]
    ds_read_b64_tr_b16 v[76:77], v5 offset:12288
    v_mfma_f32_16x16x32_bf16 v[156:159], v[80:83], v[28:31], v[156:159]
    v_mfma_f32_16x16x32_bf16 v[160:163], v[80:83], v[32:35], v[160:163]
    ds_read_b64_tr_b16 v[78:79], v5 offset:12800
    v_mfma_f32_16x16x32_bf16 v[164:167], v[80:83], v[36:39], v[164:167]
    s_waitcnt lgkmcnt(6)
    v_mfma_f32_16x16x32_bf16 v[168:171], v[64:67], v[24:27], v[168:171]
    ds_read_b64_tr_b16 v[80:81], v5 offset:16384
    v_mfma_f32_16x16x32_bf16 v[172:175], v[64:67], v[28:31], v[172:175]
    v_mfma_f32_16x16x32_bf16 v[176:179], v[64:67], v[32:35], v[176:179]
    ds_read_b64_tr_b16 v[82:83], v5 offset:16896
    v_mfma_f32_16x16x32_bf16 v[180:183], v[64:67], v[36:39], v[180:183]
    s_waitcnt lgkmcnt(6)
    v_mfma_f32_16x16x32_bf16 v[184:187], v[68:71], v[24:27], v[184:187]
    v_mfma_f32_16x16x32_bf16 v[188:191], v[68:71], v[28:31], v[188:191]
    v_mfma_f32_16x16x32_bf16 v[192:195], v[68:71], v[32:35], v[192:195]
    v_mfma_f32_16x16x32_bf16 v[196:199], v[68:71], v[36:39], v[196:199]
    s_waitcnt vmcnt(8) lgkmcnt(0)
    s_barrier
    v_mfma_f32_16x16x32_bf16 v[200:203], v[72:75], v[24:27], v[200:203]
    ds_read_b64_tr_b16 v[64:65], v4 offset:24576
    v_mfma_f32_16x16x32_bf16 v[204:207], v[72:75], v[28:31], v[204:207]
    ds_read_b64_tr_b16 v[66:67], v4 offset:25088
    v_mfma_f32_16x16x32_bf16 v[208:211], v[72:75], v[32:35], v[208:211]
    ds_read_b128 v[40:43], v15 offset:0
    v_mfma_f32_16x16x32_bf16 v[212:215], v[72:75], v[36:39], v[212:215]
    ds_read_b128 v[44:47], v15 offset:2048
    v_mfma_f32_16x16x32_bf16 v[216:219], v[76:79], v[24:27], v[216:219]
    ds_read_b128 v[48:51], v15 offset:4096
    v_mfma_f32_16x16x32_bf16 v[220:223], v[76:79], v[28:31], v[220:223]
    ds_read_b128 v[52:55], v15 offset:6144
    v_mfma_f32_16x16x32_bf16 v[224:227], v[76:79], v[32:35], v[224:227]
    ds_read_b64_tr_b16 v[68:69], v5 offset:24576
    v_mfma_f32_16x16x32_bf16 v[228:231], v[76:79], v[36:39], v[228:231]
    ds_read_b64_tr_b16 v[70:71], v5 offset:25088
    v_mfma_f32_16x16x32_bf16 v[232:235], v[80:83], v[24:27], v[232:235]
    ds_read_b64_tr_b16 v[72:73], v4 offset:28672
    v_mfma_f32_16x16x32_bf16 v[236:239], v[80:83], v[28:31], v[236:239]
    ds_read_b64_tr_b16 v[74:75], v4 offset:29184
    v_mfma_f32_16x16x32_bf16 v[240:243], v[80:83], v[32:35], v[240:243]
    ds_read_b128 v[60:63], v19
    v_mfma_f32_16x16x32_bf16 v[244:247], v[80:83], v[36:39], v[244:247]
    s_waitcnt lgkmcnt(8)
    v_mfma_f32_16x16x32_bf16 v[88:91], v[64:67], v[40:43], v[88:91]
    ds_read_b64_tr_b16 v[76:77], v5 offset:28672
    s_waitcnt lgkmcnt(8)
    v_mfma_f32_16x16x32_bf16 v[92:95], v[64:67], v[44:47], v[92:95]
    ds_read_b64_tr_b16 v[78:79], v5 offset:29184
    s_waitcnt lgkmcnt(8)
    v_mfma_f32_16x16x32_bf16 v[96:99], v[64:67], v[48:51], v[96:99]
    ds_read_b64_tr_b16 v[80:81], v4 offset:20480
    s_waitcnt lgkmcnt(8)
    v_mfma_f32_16x16x32_bf16 v[100:103], v[64:67], v[52:55], v[100:103]
    ds_read_b64_tr_b16 v[82:83], v4 offset:20992
    s_waitcnt lgkmcnt(4)
    v_mfma_f32_16x16x32_bf16 v[248:251], v[64:67], v[60:63], v[248:251]
    v_mfma_f32_16x16x32_bf16 v[104:107], v[68:71], v[40:43], v[104:107]
    ds_read_b64_tr_b16 v[64:65], v5 offset:20480
    v_mfma_f32_16x16x32_bf16 v[108:111], v[68:71], v[44:47], v[108:111]
    v_add_u32 v14, s80, v16
    v_mfma_f32_16x16x32_bf16 v[112:115], v[68:71], v[48:51], v[112:115]
    ds_read_b64_tr_b16 v[66:67], v5 offset:20992
    v_mfma_f32_16x16x32_bf16 v[116:119], v[68:71], v[52:55], v[116:119]
    v_add_u32 v15, s80, v17
    v_mfma_f32_16x16x32_bf16 v[120:123], v[40:43], v[72:75], v[120:123]
    ds_read_b64_tr_b16 v[68:69], v4 offset:32768
    v_mfma_f32_16x16x32_bf16 v[124:127], v[44:47], v[72:75], v[124:127]
    s_add_u32 s84, s80, s95
    v_mfma_f32_16x16x32_bf16 v[128:131], v[48:51], v[72:75], v[128:131]
    ds_read_b64_tr_b16 v[70:71], v4 offset:33280
    v_mfma_f32_16x16x32_bf16 v[132:135], v[52:55], v[72:75], v[132:135]
    v_add_u32 v18, s84, v16
    v_mfma_f32_16x16x32_bf16 v[252:255], v[60:63], v[72:75], v[252:255]
    s_waitcnt lgkmcnt(6)
    v_mfma_f32_16x16x32_bf16 v[136:139], v[40:43], v[76:79], v[136:139]
    ds_read_b64_tr_b16 v[72:73], v4 offset:36864
    v_mfma_f32_16x16x32_bf16 v[140:143], v[44:47], v[76:79], v[140:143]
    v_add_u32 v19, s84, v17
    v_mfma_f32_16x16x32_bf16 v[144:147], v[48:51], v[76:79], v[144:147]
    ds_read_b64_tr_b16 v[74:75], v4 offset:37376
    v_mfma_f32_16x16x32_bf16 v[148:151], v[52:55], v[76:79], v[148:151]
    s_add_u32 s80, s80, 18432
    s_waitcnt lgkmcnt(6)
    v_mfma_f32_16x16x32_bf16 v[152:155], v[80:83], v[40:43], v[152:155]
    ds_read_b64_tr_b16 v[76:77], v5 offset:32768
    v_mfma_f32_16x16x32_bf16 v[156:159], v[80:83], v[44:47], v[156:159]
    s_cmp_ge_u32 s80, 153600
    s_cselect_b32 s84, 55296, 0
    v_mfma_f32_16x16x32_bf16 v[160:163], v[80:83], v[48:51], v[160:163]
    ds_read_b64_tr_b16 v[78:79], v5 offset:33280
    v_mfma_f32_16x16x32_bf16 v[164:167], v[80:83], v[52:55], v[164:167]
    s_sub_u32 s80, s80, s84
    s_waitcnt lgkmcnt(6)
    v_mfma_f32_16x16x32_bf16 v[168:171], v[64:67], v[40:43], v[168:171]
    ds_read_b64_tr_b16 v[80:81], v5 offset:36864
    v_mfma_f32_16x16x32_bf16 v[172:175], v[64:67], v[44:47], v[172:175]
    v_mfma_f32_16x16x32_bf16 v[176:179], v[64:67], v[48:51], v[176:179]
    ds_read_b64_tr_b16 v[82:83], v5 offset:37376
    v_mfma_f32_16x16x32_bf16 v[180:183], v[64:67], v[52:55], v[180:183]
    s_waitcnt lgkmcnt(6)
    v_mfma_f32_16x16x32_bf16 v[184:187], v[68:71], v[40:43], v[184:187]
    v_mfma_f32_16x16x32_bf16 v[188:191], v[68:71], v[44:47], v[188:191]
    v_mfma_f32_16x16x32_bf16 v[192:195], v[68:71], v[48:51], v[192:195]
    v_mfma_f32_16x16x32_bf16 v[196:199], v[68:71], v[52:55], v[196:199]
    s_waitcnt vmcnt(0) lgkmcnt(0)
    s_barrier
    v_mfma_f32_16x16x32_bf16 v[200:203], v[72:75], v[40:43], v[200:203]
    ds_read_b64_tr_b16 v[64:65], v6 offset:4096
    v_mfma_f32_16x16x32_bf16 v[204:207], v[72:75], v[44:47], v[204:207]
    ds_read_b64_tr_b16 v[66:67], v6 offset:4608
    v_mfma_f32_16x16x32_bf16 v[208:211], v[72:75], v[48:51], v[208:211]
    ds_read_b128 v[24:27], v14 offset:0
    v_mfma_f32_16x16x32_bf16 v[212:215], v[72:75], v[52:55], v[212:215]
    ds_read_b128 v[28:31], v14 offset:2048
    v_mfma_f32_16x16x32_bf16 v[216:219], v[76:79], v[40:43], v[216:219]
    ds_read_b128 v[32:35], v14 offset:4096
    v_mfma_f32_16x16x32_bf16 v[220:223], v[76:79], v[44:47], v[220:223]
    ds_read_b128 v[36:39], v14 offset:6144
    v_mfma_f32_16x16x32_bf16 v[224:227], v[76:79], v[48:51], v[224:227]
    ds_read_b64_tr_b16 v[68:69], v7 offset:4096
    v_mfma_f32_16x16x32_bf16 v[228:231], v[76:79], v[52:55], v[228:231]
    ds_read_b64_tr_b16 v[70:71], v7 offset:4608
    v_mfma_f32_16x16x32_bf16 v[232:235], v[80:83], v[40:43], v[232:235]
    ds_read_b64_tr_b16 v[72:73], v6 offset:8192
    v_mfma_f32_16x16x32_bf16 v[236:239], v[80:83], v[44:47], v[236:239]
    ds_read_b64_tr_b16 v[74:75], v6 offset:8704
    v_mfma_f32_16x16x32_bf16 v[240:243], v[80:83], v[48:51], v[240:243]
    ds_read_b128 v[56:59], v18
    v_mfma_f32_16x16x32_bf16 v[244:247], v[80:83], v[52:55], v[244:247]
    s_waitcnt lgkmcnt(8)
    v_mfma_f32_16x16x32_bf16 v[88:91], v[64:67], v[24:27], v[88:91]
    ds_read_b64_tr_b16 v[76:77], v7 offset:8192
    s_waitcnt lgkmcnt(8)
    v_mfma_f32_16x16x32_bf16 v[92:95], v[64:67], v[28:31], v[92:95]
    ds_read_b64_tr_b16 v[78:79], v7 offset:8704
    s_waitcnt lgkmcnt(8)
    v_mfma_f32_16x16x32_bf16 v[96:99], v[64:67], v[32:35], v[96:99]
    ds_read_b64_tr_b16 v[80:81], v6 offset:0
    s_waitcnt lgkmcnt(8)
    v_mfma_f32_16x16x32_bf16 v[100:103], v[64:67], v[36:39], v[100:103]
    ds_read_b64_tr_b16 v[82:83], v6 offset:512
    s_waitcnt lgkmcnt(4)
    v_mfma_f32_16x16x32_bf16 v[248:251], v[64:67], v[56:59], v[248:251]
    v_mfma_f32_16x16x32_bf16 v[104:107], v[68:71], v[24:27], v[104:107]
    ds_read_b64_tr_b16 v[64:65], v7 offset:0
    v_mfma_f32_16x16x32_bf16 v[108:111], v[68:71], v[28:31], v[108:111]
    v_mfma_f32_16x16x32_bf16 v[112:115], v[68:71], v[32:35], v[112:115]
    ds_read_b64_tr_b16 v[66:67], v7 offset:512
    v_mfma_f32_16x16x32_bf16 v[116:119], v[68:71], v[36:39], v[116:119]
    v_mfma_f32_16x16x32_bf16 v[120:123], v[24:27], v[72:75], v[120:123]
    ds_read_b64_tr_b16 v[68:69], v6 offset:12288
    v_mfma_f32_16x16x32_bf16 v[124:127], v[28:31], v[72:75], v[124:127]
    v_mfma_f32_16x16x32_bf16 v[128:131], v[32:35], v[72:75], v[128:131]
    ds_read_b64_tr_b16 v[70:71], v6 offset:12800
    v_mfma_f32_16x16x32_bf16 v[132:135], v[36:39], v[72:75], v[132:135]
    v_mfma_f32_16x16x32_bf16 v[252:255], v[56:59], v[72:75], v[252:255]
    s_waitcnt lgkmcnt(6)
    v_mfma_f32_16x16x32_bf16 v[136:139], v[24:27], v[76:79], v[136:139]
    ds_read_b64_tr_b16 v[72:73], v6 offset:16384
    v_mfma_f32_16x16x32_bf16 v[140:143], v[28:31], v[76:79], v[140:143]
    v_mfma_f32_16x16x32_bf16 v[144:147], v[32:35], v[76:79], v[144:147]
    ds_read_b64_tr_b16 v[74:75], v6 offset:16896
    v_mfma_f32_16x16x32_bf16 v[148:151], v[36:39], v[76:79], v[148:151]
    s_waitcnt lgkmcnt(6)
    v_mfma_f32_16x16x32_bf16 v[152:155], v[80:83], v[24:27], v[152:155]
    ds_read_b64_tr_b16 v[76:77], v7 offset:12288
    v_mfma_f32_16x16x32_bf16 v[156:159], v[80:83], v[28:31], v[156:159]
    v_mfma_f32_16x16x32_bf16 v[160:163], v[80:83], v[32:35], v[160:163]
    ds_read_b64_tr_b16 v[78:79], v7 offset:12800
    v_mfma_f32_16x16x32_bf16 v[164:167], v[80:83], v[36:39], v[164:167]
    s_waitcnt lgkmcnt(6)
    v_mfma_f32_16x16x32_bf16 v[168:171], v[64:67], v[24:27], v[168:171]
    ds_read_b64_tr_b16 v[80:81], v7 offset:16384
    v_mfma_f32_16x16x32_bf16 v[172:175], v[64:67], v[28:31], v[172:175]
    v_mfma_f32_16x16x32_bf16 v[176:179], v[64:67], v[32:35], v[176:179]
    ds_read_b64_tr_b16 v[82:83], v7 offset:16896
    v_mfma_f32_16x16x32_bf16 v[180:183], v[64:67], v[36:39], v[180:183]
    s_waitcnt lgkmcnt(6)
    v_mfma_f32_16x16x32_bf16 v[184:187], v[68:71], v[24:27], v[184:187]
    v_mfma_f32_16x16x32_bf16 v[188:191], v[68:71], v[28:31], v[188:191]
    v_mfma_f32_16x16x32_bf16 v[192:195], v[68:71], v[32:35], v[192:195]
    v_mfma_f32_16x16x32_bf16 v[196:199], v[68:71], v[36:39], v[196:199]
    s_waitcnt lgkmcnt(0)
    s_barrier
    v_mfma_f32_16x16x32_bf16 v[200:203], v[72:75], v[24:27], v[200:203]
    ds_read_b64_tr_b16 v[64:65], v6 offset:24576
    v_mfma_f32_16x16x32_bf16 v[204:207], v[72:75], v[28:31], v[204:207]
    ds_read_b64_tr_b16 v[66:67], v6 offset:25088
    v_mfma_f32_16x16x32_bf16 v[208:211], v[72:75], v[32:35], v[208:211]
    ds_read_b128 v[40:43], v15 offset:0
    v_mfma_f32_16x16x32_bf16 v[212:215], v[72:75], v[36:39], v[212:215]
    ds_read_b128 v[44:47], v15 offset:2048
    v_mfma_f32_16x16x32_bf16 v[216:219], v[76:79], v[24:27], v[216:219]
    ds_read_b128 v[48:51], v15 offset:4096
    v_mfma_f32_16x16x32_bf16 v[220:223], v[76:79], v[28:31], v[220:223]
    ds_read_b128 v[52:55], v15 offset:6144
    v_mfma_f32_16x16x32_bf16 v[224:227], v[76:79], v[32:35], v[224:227]
    ds_read_b64_tr_b16 v[68:69], v7 offset:24576
    v_mfma_f32_16x16x32_bf16 v[228:231], v[76:79], v[36:39], v[228:231]
    ds_read_b64_tr_b16 v[70:71], v7 offset:25088
    v_mfma_f32_16x16x32_bf16 v[232:235], v[80:83], v[24:27], v[232:235]
    ds_read_b64_tr_b16 v[72:73], v6 offset:28672
    v_mfma_f32_16x16x32_bf16 v[236:239], v[80:83], v[28:31], v[236:239]
    ds_read_b64_tr_b16 v[74:75], v6 offset:29184
    v_mfma_f32_16x16x32_bf16 v[240:243], v[80:83], v[32:35], v[240:243]
    ds_read_b128 v[60:63], v19
    v_mfma_f32_16x16x32_bf16 v[244:247], v[80:83], v[36:39], v[244:247]
    s_waitcnt lgkmcnt(8)
    v_mfma_f32_16x16x32_bf16 v[88:91], v[64:67], v[40:43], v[88:91]
    ds_read_b64_tr_b16 v[76:77], v7 offset:28672
    s_waitcnt lgkmcnt(8)
    v_mfma_f32_16x16x32_bf16 v[92:95], v[64:67], v[44:47], v[92:95]
    ds_read_b64_tr_b16 v[78:79], v7 offset:29184
    s_waitcnt lgkmcnt(8)
    v_mfma_f32_16x16x32_bf16 v[96:99], v[64:67], v[48:51], v[96:99]
    ds_read_b64_tr_b16 v[80:81], v6 offset:20480
    s_waitcnt lgkmcnt(8)
    v_mfma_f32_16x16x32_bf16 v[100:103], v[64:67], v[52:55], v[100:103]
    ds_read_b64_tr_b16 v[82:83], v6 offset:20992
    s_waitcnt lgkmcnt(4)
    v_mfma_f32_16x16x32_bf16 v[248:251], v[64:67], v[60:63], v[248:251]
    v_mfma_f32_16x16x32_bf16 v[104:107], v[68:71], v[40:43], v[104:107]
    ds_read_b64_tr_b16 v[64:65], v7 offset:20480
    v_mfma_f32_16x16x32_bf16 v[108:111], v[68:71], v[44:47], v[108:111]
    v_add_u32 v14, s80, v16
    v_mfma_f32_16x16x32_bf16 v[112:115], v[68:71], v[48:51], v[112:115]
    ds_read_b64_tr_b16 v[66:67], v7 offset:20992
    v_mfma_f32_16x16x32_bf16 v[116:119], v[68:71], v[52:55], v[116:119]
    v_add_u32 v15, s80, v17
    v_mfma_f32_16x16x32_bf16 v[120:123], v[40:43], v[72:75], v[120:123]
    ds_read_b64_tr_b16 v[68:69], v6 offset:32768
    v_mfma_f32_16x16x32_bf16 v[124:127], v[44:47], v[72:75], v[124:127]
    s_add_u32 s84, s80, s95
    v_mfma_f32_16x16x32_bf16 v[128:131], v[48:51], v[72:75], v[128:131]
    ds_read_b64_tr_b16 v[70:71], v6 offset:33280
    v_mfma_f32_16x16x32_bf16 v[132:135], v[52:55], v[72:75], v[132:135]
    v_add_u32 v18, s84, v16
    v_mfma_f32_16x16x32_bf16 v[252:255], v[60:63], v[72:75], v[252:255]
    s_waitcnt lgkmcnt(6)
    v_mfma_f32_16x16x32_bf16 v[136:139], v[40:43], v[76:79], v[136:139]
    ds_read_b64_tr_b16 v[72:73], v6 offset:36864
    v_mfma_f32_16x16x32_bf16 v[140:143], v[44:47], v[76:79], v[140:143]
    v_add_u32 v19, s84, v17
    v_mfma_f32_16x16x32_bf16 v[144:147], v[48:51], v[76:79], v[144:147]
    ds_read_b64_tr_b16 v[74:75], v6 offset:37376
    v_mfma_f32_16x16x32_bf16 v[148:151], v[52:55], v[76:79], v[148:151]
    s_add_u32 s80, s80, 18432
    s_waitcnt lgkmcnt(6)
    v_mfma_f32_16x16x32_bf16 v[152:155], v[80:83], v[40:43], v[152:155]
    ds_read_b64_tr_b16 v[76:77], v7 offset:32768
    v_mfma_f32_16x16x32_bf16 v[156:159], v[80:83], v[44:47], v[156:159]
    s_cmp_ge_u32 s80, 153600
    s_cselect_b32 s84, 55296, 0
    v_mfma_f32_16x16x32_bf16 v[160:163], v[80:83], v[48:51], v[160:163]
    ds_read_b64_tr_b16 v[78:79], v7 offset:33280
    v_mfma_f32_16x16x32_bf16 v[164:167], v[80:83], v[52:55], v[164:167]
    s_sub_u32 s80, s80, s84
    s_waitcnt lgkmcnt(6)
    v_mfma_f32_16x16x32_bf16 v[168:171], v[64:67], v[40:43], v[168:171]
    ds_read_b64_tr_b16 v[80:81], v7 offset:36864
    v_mfma_f32_16x16x32_bf16 v[172:175], v[64:67], v[44:47], v[172:175]
    v_mfma_f32_16x16x32_bf16 v[176:179], v[64:67], v[48:51], v[176:179]
    ds_read_b64_tr_b16 v[82:83], v7 offset:37376
    v_mfma_f32_16x16x32_bf16 v[180:183], v[64:67], v[52:55], v[180:183]
    s_waitcnt lgkmcnt(6)
    v_mfma_f32_16x16x32_bf16 v[184:187], v[68:71], v[40:43], v[184:187]
    v_mfma_f32_16x16x32_bf16 v[188:191], v[68:71], v[44:47], v[188:191]
    v_mfma_f32_16x16x32_bf16 v[192:195], v[68:71], v[48:51], v[192:195]
    v_mfma_f32_16x16x32_bf16 v[196:199], v[68:71], v[52:55], v[196:199]
    s_waitcnt lgkmcnt(0)
    s_barrier
    v_mfma_f32_16x16x32_bf16 v[200:203], v[72:75], v[40:43], v[200:203]
    ds_read_b64_tr_b16 v[64:65], v4 offset:4096
    v_mfma_f32_16x16x32_bf16 v[204:207], v[72:75], v[44:47], v[204:207]
    ds_read_b64_tr_b16 v[66:67], v4 offset:4608
    v_mfma_f32_16x16x32_bf16 v[208:211], v[72:75], v[48:51], v[208:211]
    ds_read_b128 v[24:27], v14 offset:0
    v_mfma_f32_16x16x32_bf16 v[212:215], v[72:75], v[52:55], v[212:215]
    ds_read_b128 v[28:31], v14 offset:2048
    v_mfma_f32_16x16x32_bf16 v[216:219], v[76:79], v[40:43], v[216:219]
    ds_read_b128 v[32:35], v14 offset:4096
    v_mfma_f32_16x16x32_bf16 v[220:223], v[76:79], v[44:47], v[220:223]
    ds_read_b128 v[36:39], v14 offset:6144
    v_mfma_f32_16x16x32_bf16 v[224:227], v[76:79], v[48:51], v[224:227]
    ds_read_b64_tr_b16 v[68:69], v5 offset:4096
    v_mfma_f32_16x16x32_bf16 v[228:231], v[76:79], v[52:55], v[228:231]
    ds_read_b64_tr_b16 v[70:71], v5 offset:4608
    v_mfma_f32_16x16x32_bf16 v[232:235], v[80:83], v[40:43], v[232:235]
    ds_read_b64_tr_b16 v[72:73], v4 offset:8192
    v_mfma_f32_16x16x32_bf16 v[236:239], v[80:83], v[44:47], v[236:239]
    ds_read_b64_tr_b16 v[74:75], v4 offset:8704
    v_mfma_f32_16x16x32_bf16 v[240:243], v[80:83], v[48:51], v[240:243]
    ds_read_b128 v[56:59], v18
    v_mfma_f32_16x16x32_bf16 v[244:247], v[80:83], v[52:55], v[244:247]
    s_sub_u32 s34, s34, 1
    s_cmp_lg_u32 s34, 0
    s_cbranch_scc1 L_p2
    s_waitcnt lgkmcnt(8)
    v_mfma_f32_16x16x32_bf16 v[88:91], v[64:67], v[24:27], v[88:91]
    ds_read_b64_tr_b16 v[76:77], v5 offset:8192
    s_waitcnt lgkmcnt(8)
    v_mfma_f32_16x16x32_bf16 v[92:95], v[64:67], v[28:31], v[92:95]
    ds_read_b64_tr_b16 v[78:79], v5 offset:8704
    s_waitcnt lgkmcnt(8)
    v_mfma_f32_16x16x32_bf16 v[96:99], v[64:67], v[32:35], v[96:99]
    ds_read_b64_tr_b16 v[80:81], v4 offset:0
    s_waitcnt lgkmcnt(8)
    v_mfma_f32_16x16x32_bf16 v[100:103], v[64:67], v[36:39], v[100:103]
    ds_read_b64_tr_b16 v[82:83], v4 offset:512
    s_waitcnt lgkmcnt(4)
    v_mfma_f32_16x16x32_bf16 v[248:251], v[64:67], v[56:59], v[248:251]
    v_mfma_f32_16x16x32_bf16 v[104:107], v[68:71], v[24:27], v[104:107]
    ds_read_b64_tr_b16 v[64:65], v5 offset:0
    v_mfma_f32_16x16x32_bf16 v[108:111], v[68:71], v[28:31], v[108:111]
    v_mfma_f32_16x16x32_bf16 v[112:115], v[68:71], v[32:35], v[112:115]
    ds_read_b64_tr_b16 v[66:67], v5 offset:512
    v_mfma_f32_16x16x32_bf16 v[116:119], v[68:71], v[36:39], v[116:119]
    v_mfma_f32_16x16x32_bf16 v[120:123], v[24:27], v[72:75], v[120:123]
    ds_read_b64_tr_b16 v[68:69], v4 offset:12288
    v_mfma_f32_16x16x32_bf16 v[124:127], v[28:31], v[72:75], v[124:127]
    v_mfma_f32_16x16x32_bf16 v[128:131], v[32:35], v[72:75], v[128:131]
    ds_read_b64_tr_b16 v[70:71], v4 offset:12800
    v_mfma_f32_16x16x32_bf16 v[132:135], v[36:39], v[72:75], v[132:135]
    v_mfma_f32_16x16x32_bf16 v[252:255], v[56:59], v[72:75], v[252:255]
    s_waitcnt lgkmcnt(6)
    v_mfma_f32_16x16x32_bf16 v[136:139], v[24:27], v[76:79], v[136:139]
    ds_read_b64_tr_b16 v[72:73], v4 offset:16384
    v_mfma_f32_16x16x32_bf16 v[140:143], v[28:31], v[76:79], v[140:143]
    v_mfma_f32_16x16x32_bf16 v[144:147], v[32:35], v[76:79], v[144:147]
    ds_read_b64_tr_b16 v[74:75], v4 offset:16896
    v_mfma_f32_16x16x32_bf16 v[148:151], v[36:39], v[76:79], v[148:151]
    s_waitcnt lgkmcnt(6)
    v_mfma_f32_16x16x32_bf16 v[152:155], v[80:83], v[24:27], v[152:155]
    ds_read_b64_tr_b16 v[76:77], v5 offset:12288
    v_mfma_f32_16x16x32_bf16 v[156:159], v[80:83], v[28:31], v[156:159]
    v_mfma_f32_16x16x32_bf16 v[160:163], v[80:83], v[32:35], v[160:163]
    ds_read_b64_tr_b16 v[78:79], v5 offset:12800
    v_mfma_f32_16x16x32_bf16 v[164:167], v[80:83], v[36:39], v[164:167]
    s_waitcnt lgkmcnt(6)
    v_mfma_f32_16x16x32_bf16 v[168:171], v[64:67], v[24:27], v[168:171]
    ds_read_b64_tr_b16 v[80:81], v5 offset:16384
    v_mfma_f32_16x16x32_bf16 v[172:175], v[64:67], v[28:31], v[172:175]
    v_mfma_f32_16x16x32_bf16 v[176:179], v[64:67], v[32:35], v[176:179]
    ds_read_b64_tr_b16 v[82:83], v5 offset:16896
    v_mfma_f32_16x16x32_bf16 v[180:183], v[64:67], v[36:39], v[180:183]
    s_waitcnt lgkmcnt(6)
    v_mfma_f32_16x16x32_bf16 v[184:187], v[68:71], v[24:27], v[184:187]
    v_mfma_f32_16x16x32_bf16 v[188:191], v[68:71], v[28:31], v[188:191]
    v_mfma_f32_16x16x32_bf16 v[192:195], v[68:71], v[32:35], v[192:195]
    v_mfma_f32_16x16x32_bf16 v[196:199], v[68:71], v[36:39], v[196:199]
    s_waitcnt lgkmcnt(0)
    s_barrier
    v_mfma_f32_16x16x32_bf16 v[200:203], v[72:75], v[24:27], v[200:203]
    ds_read_b64_tr_b16 v[64:65], v4 offset:24576
    v_mfma_f32_16x16x32_bf16 v[204:207], v[72:75], v[28:31], v[204:207]
    ds_read_b64_tr_b16 v[66:67], v4 offset:25088
    v_mfma_f32_16x16x32_bf16 v[208:211], v[72:75], v[32:35], v[208:211]
    ds_read_b128 v[40:43], v15 offset:0
    v_mfma_f32_16x16x32_bf16 v[212:215], v[72:75], v[36:39], v[212:215]
    ds_read_b128 v[44:47], v15 offset:2048
    v_mfma_f32_16x16x32_bf16 v[216:219], v[76:79], v[24:27], v[216:219]
    ds_read_b128 v[48:51], v15 offset:4096
    v_mfma_f32_16x16x32_bf16 v[220:223], v[76:79], v[28:31], v[220:223]
    ds_read_b128 v[52:55], v15 offset:6144
    v_mfma_f32_16x16x32_bf16 v[224:227], v[76:79], v[32:35], v[224:227]
    ds_read_b64_tr_b16 v[68:69], v5 offset:24576
    v_mfma_f32_16x16x32_bf16 v[228:231], v[76:79], v[36:39], v[228:231]
    ds_read_b64_tr_b16 v[70:71], v5 offset:25088
    v_mfma_f32_16x16x32_bf16 v[232:235], v[80:83], v[24:27], v[232:235]
    ds_read_b64_tr_b16 v[72:73], v4 offset:28672
    v_mfma_f32_16x16x32_bf16 v[236:239], v[80:83], v[28:31], v[236:239]
    ds_read_b64_tr_b16 v[74:75], v4 offset:29184
    v_mfma_f32_16x16x32_bf16 v[240:243], v[80:83], v[32:35], v[240:243]
    ds_read_b128 v[60:63], v19
    v_mfma_f32_16x16x32_bf16 v[244:247], v[80:83], v[36:39], v[244:247]
    s_waitcnt lgkmcnt(8)
    v_mfma_f32_16x16x32_bf16 v[88:91], v[64:67], v[40:43], v[88:91]
    ds_read_b64_tr_b16 v[76:77], v5 offset:28672
    s_waitcnt lgkmcnt(8)
    v_mfma_f32_16x16x32_bf16 v[92:95], v[64:67], v[44:47], v[92:95]
    ds_read_b64_tr_b16 v[78:79], v5 offset:29184
    s_waitcnt lgkmcnt(8)
    v_mfma_f32_16x16x32_bf16 v[96:99], v[64:67], v[48:51], v[96:99]
    ds_read_b64_tr_b16 v[80:81], v4 offset:20480
    s_waitcnt lgkmcnt(8)
    v_mfma_f32_16x16x32_bf16 v[100:103], v[64:67], v[52:55], v[100:103]
    ds_read_b64_tr_b16 v[82:83], v4 offset:20992
    s_waitcnt lgkmcnt(4)
    v_mfma_f32_16x16x32_bf16 v[248:251], v[64:67], v[60:63], v[248:251]
    v_mfma_f32_16x16x32_bf16 v[104:107], v[68:71], v[40:43], v[104:107]
    ds_read_b64_tr_b16 v[64:65], v5 offset:20480
    v_mfma_f32_16x16x32_bf16 v[108:111], v[68:71], v[44:47], v[108:111]
    v_add_u32 v14, s80, v16
    v_mfma_f32_16x16x32_bf16 v[112:115], v[68:71], v[48:51], v[112:115]
    ds_read_b64_tr_b16 v[66:67], v5 offset:20992
    v_mfma_f32_16x16x32_bf16 v[116:119], v[68:71], v[52:55], v[116:119]
    v_add_u32 v15, s80, v17
    v_mfma_f32_16x16x32_bf16 v[120:123], v[40:43], v[72:75], v[120:123]
    ds_read_b64_tr_b16 v[68:69], v4 offset:32768
    v_mfma_f32_16x16x32_bf16 v[124:127], v[44:47], v[72:75], v[124:127]
    s_add_u32 s84, s80, s95
    v_mfma_f32_16x16x32_bf16 v[128:131], v[48:51], v[72:75], v[128:131]
    ds_read_b64_tr_b16 v[70:71], v4 offset:33280
    v_mfma_f32_16x16x32_bf16 v[132:135], v[52:55], v[72:75], v[132:135]
    v_add_u32 v18, s84, v16
    v_mfma_f32_16x16x32_bf16 v[252:255], v[60:63], v[72:75], v[252:255]
    s_waitcnt lgkmcnt(6)
    v_mfma_f32_16x16x32_bf16 v[136:139], v[40:43], v[76:79], v[136:139]
    ds_read_b64_tr_b16 v[72:73], v4 offset:36864
    v_mfma_f32_16x16x32_bf16 v[140:143], v[44:47], v[76:79], v[140:143]
    v_add_u32 v19, s84, v17
    v_mfma_f32_16x16x32_bf16 v[144:147], v[48:51], v[76:79], v[144:147]
    ds_read_b64_tr_b16 v[74:75], v4 offset:37376
    v_mfma_f32_16x16x32_bf16 v[148:151], v[52:55], v[76:79], v[148:151]
    s_add_u32 s80, s80, 18432
    s_waitcnt lgkmcnt(6)
    v_mfma_f32_16x16x32_bf16 v[152:155], v[80:83], v[40:43], v[152:155]
    ds_read_b64_tr_b16 v[76:77], v5 offset:32768
    v_mfma_f32_16x16x32_bf16 v[156:159], v[80:83], v[44:47], v[156:159]
    s_cmp_ge_u32 s80, 153600
    s_cselect_b32 s84, 55296, 0
    v_mfma_f32_16x16x32_bf16 v[160:163], v[80:83], v[48:51], v[160:163]
    ds_read_b64_tr_b16 v[78:79], v5 offset:33280
    v_mfma_f32_16x16x32_bf16 v[164:167], v[80:83], v[52:55], v[164:167]
    s_sub_u32 s80, s80, s84
    s_waitcnt lgkmcnt(6)
    v_mfma_f32_16x16x32_bf16 v[168:171], v[64:67], v[40:43], v[168:171]
    ds_read_b64_tr_b16 v[80:81], v5 offset:36864
    v_mfma_f32_16x16x32_bf16 v[172:175], v[64:67], v[44:47], v[172:175]
    v_mfma_f32_16x16x32_bf16 v[176:179], v[64:67], v[48:51], v[176:179]
    ds_read_b64_tr_b16 v[82:83], v5 offset:37376
    v_mfma_f32_16x16x32_bf16 v[180:183], v[64:67], v[52:55], v[180:183]
    s_waitcnt lgkmcnt(6)
    v_mfma_f32_16x16x32_bf16 v[184:187], v[68:71], v[40:43], v[184:187]
    v_mfma_f32_16x16x32_bf16 v[188:191], v[68:71], v[44:47], v[188:191]
    v_mfma_f32_16x16x32_bf16 v[192:195], v[68:71], v[48:51], v[192:195]
    v_mfma_f32_16x16x32_bf16 v[196:199], v[68:71], v[52:55], v[196:199]
    s_waitcnt lgkmcnt(0)
    s_barrier
    v_mfma_f32_16x16x32_bf16 v[200:203], v[72:75], v[40:43], v[200:203]
    ds_read_b64_tr_b16 v[64:65], v6 offset:4096
    v_mfma_f32_16x16x32_bf16 v[204:207], v[72:75], v[44:47], v[204:207]
    ds_read_b64_tr_b16 v[66:67], v6 offset:4608
    v_mfma_f32_16x16x32_bf16 v[208:211], v[72:75], v[48:51], v[208:211]
    ds_read_b128 v[24:27], v14 offset:0
    v_mfma_f32_16x16x32_bf16 v[212:215], v[72:75], v[52:55], v[212:215]
    ds_read_b128 v[28:31], v14 offset:2048
    v_mfma_f32_16x16x32_bf16 v[216:219], v[76:79], v[40:43], v[216:219]
    ds_read_b128 v[32:35], v14 offset:4096
    v_mfma_f32_16x16x32_bf16 v[220:223], v[76:79], v[44:47], v[220:223]
    ds_read_b128 v[36:39], v14 offset:6144
    v_mfma_f32_16x16x32_bf16 v[224:227], v[76:79], v[48:51], v[224:227]
    ds_read_b64_tr_b16 v[68:69], v7 offset:4096
    v_mfma_f32_16x16x32_bf16 v[228:231], v[76:79], v[52:55], v[228:231]
    ds_read_b64_tr_b16 v[70:71], v7 offset:4608
    v_mfma_f32_16x16x32_bf16 v[232:235], v[80:83], v[40:43], v[232:235]
    ds_read_b64_tr_b16 v[72:73], v6 offset:8192
    v_mfma_f32_16x16x32_bf16 v[236:239], v[80:83], v[44:47], v[236:239]
    ds_read_b64_tr_b16 v[74:75], v6 offset:8704
    v_mfma_f32_16x16x32_bf16 v[240:243], v[80:83], v[48:51], v[240:243]
    ds_read_b128 v[56:59], v18
    v_mfma_f32_16x16x32_bf16 v[244:247], v[80:83], v[52:55], v[244:247]
    s_waitcnt lgkmcnt(8)
    v_mfma_f32_16x16x32_bf16 v[88:91], v[64:67], v[24:27], v[88:91]
    ds_read_b64_tr_b16 v[76:77], v7 offset:8192
    s_waitcnt lgkmcnt(8)
    v_mfma_f32_16x16x32_bf16 v[92:95], v[64:67], v[28:31], v[92:95]
    ds_read_b64_tr_b16 v[78:79], v7 offset:8704
    s_waitcnt lgkmcnt(8)
    v_mfma_f32_16x16x32_bf16 v[96:99], v[64:67], v[32:35], v[96:99]
    ds_read_b64_tr_b16 v[80:81], v6 offset:0
    s_waitcnt lgkmcnt(8)
    v_mfma_f32_16x16x32_bf16 v[100:103], v[64:67], v[36:39], v[100:103]
    ds_read_b64_tr_b16 v[82:83], v6 offset:512
    s_waitcnt lgkmcnt(4)
    v_mfma_f32_16x16x32_bf16 v[248:251], v[64:67], v[56:59], v[248:251]
    v_mfma_f32_16x16x32_bf16 v[104:107], v[68:71], v[24:27], v[104:107]
    ds_read_b64_tr_b16 v[64:65], v7 offset:0
    v_mfma_f32_16x16x32_bf16 v[108:111], v[68:71], v[28:31], v[108:111]
    v_mfma_f32_16x16x32_bf16 v[112:115], v[68:71], v[32:35], v[112:115]
    ds_read_b64_tr_b16 v[66:67], v7 offset:512
    v_mfma_f32_16x16x32_bf16 v[116:119], v[68:71], v[36:39], v[116:119]
    v_mfma_f32_16x16x32_bf16 v[120:123], v[24:27], v[72:75], v[120:123]
    ds_read_b64_tr_b16 v[68:69], v6 offset:12288
    v_mfma_f32_16x16x32_bf16 v[124:127], v[28:31], v[72:75], v[124:127]
    v_mfma_f32_16x16x32_bf16 v[128:131], v[32:35], v[72:75], v[128:131]
    ds_read_b64_tr_b16 v[70:71], v6 offset:12800
    v_mfma_f32_16x16x32_bf16 v[132:135], v[36:39], v[72:75], v[132:135]
    v_mfma_f32_16x16x32_bf16 v[252:255], v[56:59], v[72:75], v[252:255]
    s_waitcnt lgkmcnt(6)
    v_mfma_f32_16x16x32_bf16 v[136:139], v[24:27], v[76:79], v[136:139]
    ds_read_b64_tr_b16 v[72:73], v6 offset:16384
    v_mfma_f32_16x16x32_bf16 v[140:143], v[28:31], v[76:79], v[140:143]
    v_mfma_f32_16x16x32_bf16 v[144:147], v[32:35], v[76:79], v[144:147]
    ds_read_b64_tr_b16 v[74:75], v6 offset:16896
    v_mfma_f32_16x16x32_bf16 v[148:151], v[36:39], v[76:79], v[148:151]
    s_waitcnt lgkmcnt(6)
    v_mfma_f32_16x16x32_bf16 v[152:155], v[80:83], v[24:27], v[152:155]
    ds_read_b64_tr_b16 v[76:77], v7 offset:12288
    v_mfma_f32_16x16x32_bf16 v[156:159], v[80:83], v[28:31], v[156:159]
    v_mfma_f32_16x16x32_bf16 v[160:163], v[80:83], v[32:35], v[160:163]
    ds_read_b64_tr_b16 v[78:79], v7 offset:12800
    v_mfma_f32_16x16x32_bf16 v[164:167], v[80:83], v[36:39], v[164:167]
    s_waitcnt lgkmcnt(6)
    v_mfma_f32_16x16x32_bf16 v[168:171], v[64:67], v[24:27], v[168:171]
    ds_read_b64_tr_b16 v[80:81], v7 offset:16384
    v_mfma_f32_16x16x32_bf16 v[172:175], v[64:67], v[28:31], v[172:175]
    v_mfma_f32_16x16x32_bf16 v[176:179], v[64:67], v[32:35], v[176:179]
    ds_read_b64_tr_b16 v[82:83], v7 offset:16896
    v_mfma_f32_16x16x32_bf16 v[180:183], v[64:67], v[36:39], v[180:183]
    s_waitcnt lgkmcnt(6)
    v_mfma_f32_16x16x32_bf16 v[184:187], v[68:71], v[24:27], v[184:187]
    v_mfma_f32_16x16x32_bf16 v[188:191], v[68:71], v[28:31], v[188:191]
    v_mfma_f32_16x16x32_bf16 v[192:195], v[68:71], v[32:35], v[192:195]
    v_mfma_f32_16x16x32_bf16 v[196:199], v[68:71], v[36:39], v[196:199]
    s_waitcnt lgkmcnt(0)
    s_barrier
    v_mfma_f32_16x16x32_bf16 v[200:203], v[72:75], v[24:27], v[200:203]
    ds_read_b64_tr_b16 v[64:65], v6 offset:24576
    v_mfma_f32_16x16x32_bf16 v[204:207], v[72:75], v[28:31], v[204:207]
    ds_read_b64_tr_b16 v[66:67], v6 offset:25088
    v_mfma_f32_16x16x32_bf16 v[208:211], v[72:75], v[32:35], v[208:211]
    ds_read_b128 v[40:43], v15 offset:0
    v_mfma_f32_16x16x32_bf16 v[212:215], v[72:75], v[36:39], v[212:215]
    ds_read_b128 v[44:47], v15 offset:2048
    v_mfma_f32_16x16x32_bf16 v[216:219], v[76:79], v[24:27], v[216:219]
    ds_read_b128 v[48:51], v15 offset:4096
    v_mfma_f32_16x16x32_bf16 v[220:223], v[76:79], v[28:31], v[220:223]
    ds_read_b128 v[52:55], v15 offset:6144
    v_mfma_f32_16x16x32_bf16 v[224:227], v[76:79], v[32:35], v[224:227]
    ds_read_b64_tr_b16 v[68:69], v7 offset:24576
    v_mfma_f32_16x16x32_bf16 v[228:231], v[76:79], v[36:39], v[228:231]
    ds_read_b64_tr_b16 v[70:71], v7 offset:25088
    v_mfma_f32_16x16x32_bf16 v[232:235], v[80:83], v[24:27], v[232:235]
    ds_read_b64_tr_b16 v[72:73], v6 offset:28672
    v_mfma_f32_16x16x32_bf16 v[236:239], v[80:83], v[28:31], v[236:239]
    ds_read_b64_tr_b16 v[74:75], v6 offset:29184
    v_mfma_f32_16x16x32_bf16 v[240:243], v[80:83], v[32:35], v[240:243]
    ds_read_b128 v[60:63], v19
    v_mfma_f32_16x16x32_bf16 v[244:247], v[80:83], v[36:39], v[244:247]
    s_waitcnt lgkmcnt(8)
    v_mfma_f32_16x16x32_bf16 v[88:91], v[64:67], v[40:43], v[88:91]
    ds_read_b64_tr_b16 v[76:77], v7 offset:28672
    s_waitcnt lgkmcnt(8)
    v_mfma_f32_16x16x32_bf16 v[92:95], v[64:67], v[44:47], v[92:95]
    ds_read_b64_tr_b16 v[78:79], v7 offset:29184
    s_waitcnt lgkmcnt(8)
    v_mfma_f32_16x16x32_bf16 v[96:99], v[64:67], v[48:51], v[96:99]
    ds_read_b64_tr_b16 v[80:81], v6 offset:20480
    s_waitcnt lgkmcnt(8)
    v_mfma_f32_16x16x32_bf16 v[100:103], v[64:67], v[52:55], v[100:103]
    ds_read_b64_tr_b16 v[82:83], v6 offset:20992
    s_waitcnt lgkmcnt(4)
    v_mfma_f32_16x16x32_bf16 v[248:251], v[64:67], v[60:63], v[248:251]
    v_mfma_f32_16x16x32_bf16 v[104:107], v[68:71], v[40:43], v[104:107]
    ds_read_b64_tr_b16 v[64:65], v7 offset:20480
    v_mfma_f32_16x16x32_bf16 v[108:111], v[68:71], v[44:47], v[108:111]
    v_mfma_f32_16x16x32_bf16 v[112:115], v[68:71], v[48:51], v[112:115]
    ds_read_b64_tr_b16 v[66:67], v7 offset:20992
    v_mfma_f32_16x16x32_bf16 v[116:119], v[68:71], v[52:55], v[116:119]
    v_mfma_f32_16x16x32_bf16 v[120:123], v[40:43], v[72:75], v[120:123]
    ds_read_b64_tr_b16 v[68:69], v6 offset:32768
    v_mfma_f32_16x16x32_bf16 v[124:127], v[44:47], v[72:75], v[124:127]
    v_mfma_f32_16x16x32_bf16 v[128:131], v[48:51], v[72:75], v[128:131]
    ds_read_b64_tr_b16 v[70:71], v6 offset:33280
    v_mfma_f32_16x16x32_bf16 v[132:135], v[52:55], v[72:75], v[132:135]
    v_mfma_f32_16x16x32_bf16 v[252:255], v[60:63], v[72:75], v[252:255]
    s_waitcnt lgkmcnt(6)
    v_mfma_f32_16x16x32_bf16 v[136:139], v[40:43], v[76:79], v[136:139]
    ds_read_b64_tr_b16 v[72:73], v6 offset:36864
    v_mfma_f32_16x16x32_bf16 v[140:143], v[44:47], v[76:79], v[140:143]
    v_mfma_f32_16x16x32_bf16 v[144:147], v[48:51], v[76:79], v[144:147]
    ds_read_b64_tr_b16 v[74:75], v6 offset:37376
    v_mfma_f32_16x16x32_bf16 v[148:151], v[52:55], v[76:79], v[148:151]
    s_waitcnt lgkmcnt(6)
    v_mfma_f32_16x16x32_bf16 v[152:155], v[80:83], v[40:43], v[152:155]
    ds_read_b64_tr_b16 v[76:77], v7 offset:32768
    v_mfma_f32_16x16x32_bf16 v[156:159], v[80:83], v[44:47], v[156:159]
    v_mfma_f32_16x16x32_bf16 v[160:163], v[80:83], v[48:51], v[160:163]
    ds_read_b64_tr_b16 v[78:79], v7 offset:33280
    v_mfma_f32_16x16x32_bf16 v[164:167], v[80:83], v[52:55], v[164:167]
    s_waitcnt lgkmcnt(6)
    v_mfma_f32_16x16x32_bf16 v[168:171], v[64:67], v[40:43], v[168:171]
    ds_read_b64_tr_b16 v[80:81], v7 offset:36864
    v_mfma_f32_16x16x32_bf16 v[172:175], v[64:67], v[44:47], v[172:175]
    v_mfma_f32_16x16x32_bf16 v[176:179], v[64:67], v[48:51], v[176:179]
    ds_read_b64_tr_b16 v[82:83], v7 offset:37376
    v_mfma_f32_16x16x32_bf16 v[180:183], v[64:67], v[52:55], v[180:183]
    s_waitcnt lgkmcnt(6)
    v_mfma_f32_16x16x32_bf16 v[184:187], v[68:71], v[40:43], v[184:187]
    v_mfma_f32_16x16x32_bf16 v[188:191], v[68:71], v[44:47], v[188:191]
    v_mfma_f32_16x16x32_bf16 v[192:195], v[68:71], v[48:51], v[192:195]
    v_mfma_f32_16x16x32_bf16 v[196:199], v[68:71], v[52:55], v[196:199]
    s_waitcnt lgkmcnt(0)
    s_barrier
    v_mfma_f32_16x16x32_bf16 v[200:203], v[72:75], v[40:43], v[200:203]
    v_mfma_f32_16x16x32_bf16 v[204:207], v[72:75], v[44:47], v[204:207]
    v_mfma_f32_16x16x32_bf16 v[208:211], v[72:75], v[48:51], v[208:211]
    v_mfma_f32_16x16x32_bf16 v[212:215], v[72:75], v[52:55], v[212:215]
    v_mfma_f32_16x16x32_bf16 v[216:219], v[76:79], v[40:43], v[216:219]
    v_mfma_f32_16x16x32_bf16 v[220:223], v[76:79], v[44:47], v[220:223]
    v_mfma_f32_16x16x32_bf16 v[224:227], v[76:79], v[48:51], v[224:227]
    v_mfma_f32_16x16x32_bf16 v[228:231], v[76:79], v[52:55], v[228:231]
    v_mfma_f32_16x16x32_bf16 v[232:235], v[80:83], v[40:43], v[232:235]
    v_mfma_f32_16x16x32_bf16 v[236:239], v[80:83], v[44:47], v[236:239]
    v_mfma_f32_16x16x32_bf16 v[240:243], v[80:83], v[48:51], v[240:243]
    v_mfma_f32_16x16x32_bf16 v[244:247], v[80:83], v[52:55], v[244:247]
    s_setprio 0
    s_mov_b32 s76, 0xbdd2d3e8
    v_cvt_pk_bf16_f32 v100, v100, v101
    v_cvt_pk_bf16_f32 v101, v102, v103
    v_cvt_pk_bf16_f32 v102, v116, v117
    v_cvt_pk_bf16_f32 v103, v118, v119
    v_cvt_pk_bf16_f32 v32, v132, v133
    v_cvt_pk_bf16_f32 v33, v134, v135
    v_cvt_pk_bf16_f32 v42, v148, v149
    v_cvt_pk_bf16_f32 v43, v150, v151
    v_cvt_pk_bf16_f32 v44, v248, v249
    v_cvt_pk_bf16_f32 v45, v250, v251
    v_cvt_pk_bf16_f32 v24, v252, v253
    v_cvt_pk_bf16_f32 v25, v254, v255
    s_cmp_lg_u32 s5, 0
    s_cbranch_scc1 L_hx1
    ds_write_b64 v85, v[100:101]
    ds_write_b64 v85, v[102:103] offset:512
    ds_write_b64 v85, v[32:33] offset:1024
    ds_write_b64 v85, v[42:43] offset:1536
    s_branch L_hx2
L_hx1:
    ds_write_b64 v85, v[44:45] offset:2048
    ds_write_b64 v85, v[24:25] offset:2560
L_hx2:
    s_waitcnt lgkmcnt(0)
    v_mul_f32 v80, v184, v184
    v_mul_f32 v81, v185, v185
    v_mul_f32 v82, v186, v186
    v_mul_f32 v83, v187, v187
    v_fma_f32 v80, v80, s76, v84
    v_fma_f32 v81, v81, s76, v84
    v_fma_f32 v82, v82, s76, v84
    v_fma_f32 v83, v83, s76, v84
    v_mul_f32 v80, v80, v184
    v_mul_f32 v81, v81, v185
    v_mul_f32 v82, v82, v186
    v_mul_f32 v83, v83, v187
    v_exp_f32 v80, v80
    v_mul_f32 v184, v184, v200
    v_exp_f32 v81, v81
    v_mul_f32 v185, v185, v201
    v_exp_f32 v82, v82
    v_mul_f32 v186, v186, v202
    v_exp_f32 v83, v83
    v_mul_f32 v187, v187, v203
    v_add_f32 v80, 1.0, v80
    v_add_f32 v81, 1.0, v81
    v_add_f32 v82, 1.0, v82
    v_add_f32 v83, 1.0, v83
    v_rcp_f32 v80, v80
    v_rcp_f32 v81, v81
    v_rcp_f32 v82, v82
    v_rcp_f32 v83, v83
    s_nop 0
    v_mul_f32 v184, v184, v80
    v_mul_f32 v185, v185, v81
    v_mul_f32 v186, v186, v82
    v_mul_f32 v187, v187, v83
    v_cvt_pk_bf16_f32 v184, v184, v185
    v_cvt_pk_bf16_f32 v185, v186, v187
    v_mul_f32 v80, v188, v188
    v_mul_f32 v81, v189, v189
    v_mul_f32 v82, v190, v190
    v_mul_f32 v83, v191, v191
    v_fma_f32 v80, v80, s76, v84
    v_fma_f32 v81, v81, s76, v84
    v_fma_f32 v82, v82, s76, v84
    v_fma_f32 v83, v83, s76, v84
    v_mul_f32 v80, v80, v188
    v_mul_f32 v81, v81, v189
    v_mul_f32 v82, v82, v190
    v_mul_f32 v83, v83, v191
    v_exp_f32 v80, v80
    v_mul_f32 v188, v188, v204
    v_exp_f32 v81, v81
    v_mul_f32 v189, v189, v205
    v_exp_f32 v82, v82
    v_mul_f32 v190, v190, v206
    v_exp_f32 v83, v83
    v_mul_f32 v191, v191, v207
    v_add_f32 v80, 1.0, v80
    v_add_f32 v81, 1.0, v81
    v_add_f32 v82, 1.0, v82
    v_add_f32 v83, 1.0, v83
    v_rcp_f32 v80, v80
    v_rcp_f32 v81, v81
    v_rcp_f32 v82, v82
    s_barrier
    s_cmp_lg_u32 s5, 0
    s_cbranch_scc1 L_hx3
    ds_read_b64 v[46:47], v85 offset:2048
    ds_read_b64 v[34:35], v85 offset:2560
    s_branch L_hx4
L_hx3:
    ds_read_b64 v[44:45], v85 offset:512
    ds_read_b64 v[46:47], v85
    ds_read_b64 v[24:25], v85 offset:1536
    ds_read_b64 v[34:35], v85 offset:1024
L_hx4:
    v_rcp_f32 v83, v83
    s_nop 0
    v_mul_f32 v188, v188, v80
    v_mul_f32 v189, v189, v81
    v_mul_f32 v190, v190, v82
    v_mul_f32 v191, v191, v83
    v_cvt_pk_bf16_f32 v186, v188, v189
    v_cvt_pk_bf16_f32 v187, v190, v191
    s_nop 1
    v_permlane16_swap_b32 v184, v186
    v_permlane16_swap_b32 v185, v187
    buffer_store_dwordx4 v[184:187], v8, s[68:71], s73 offen offset:0 sc1
    v_mul_f32 v80, v192, v192
    v_mul_f32 v81, v193, v193
    v_mul_f32 v82, v194, v194
    v_mul_f32 v83, v195, v195
    v_fma_f32 v80, v80, s76, v84
    v_fma_f32 v81, v81, s76, v84
    v_fma_f32 v82, v82, s76, v84
    v_fma_f32 v83, v83, s76, v84
    v_mul_f32 v80, v80, v192
    v_mul_f32 v81, v81, v193
    v_mul_f32 v82, v82, v194
    v_mul_f32 v83, v83, v195
    v_exp_f32 v80, v80
    v_mul_f32 v192, v192, v208
    v_exp_f32 v81, v81
    v_mul_f32 v193, v193, v209
    v_exp_f32 v82, v82
    v_mul_f32 v194, v194, v210
    v_exp_f32 v83, v83
    v_mul_f32 v195, v195, v211
    v_add_f32 v80, 1.0, v80
    v_add_f32 v81, 1.0, v81
    v_add_f32 v82, 1.0, v82
    v_add_f32 v83, 1.0, v83
    v_rcp_f32 v80, v80
    v_rcp_f32 v81, v81
    v_rcp_f32 v82, v82
    v_rcp_f32 v83, v83
    s_nop 0
    v_mul_f32 v192, v192, v80
    v_mul_f32 v193, v193, v81
    v_mul_f32 v194, v194, v82
    v_mul_f32 v195, v195, v83
    v_cvt_pk_bf16_f32 v192, v192, v193
    v_cvt_pk_bf16_f32 v193, v194, v195
    v_mul_f32 v80, v196, v196
    v_mul_f32 v81, v197, v197
    v_mul_f32 v82, v198, v198
    v_mul_f32 v83, v199, v199
    v_fma_f32 v80, v80, s76, v84
    v_fma_f32 v81, v81, s76, v84
    v_fma_f32 v82, v82, s76, v84
    v_fma_f32 v83, v83, s76, v84
    v_mul_f32 v80, v80, v196
    v_mul_f32 v81, v81, v197
    v_mul_f32 v82, v82, v198
    v_mul_f32 v83, v83, v199
    v_exp_f32 v80, v80
    v_mul_f32 v196, v196, v212
    v_exp_f32 v81, v81
    v_mul_f32 v197, v197, v213
    v_exp_f32 v82, v82
    v_mul_f32 v198, v198, v214
    v_exp_f32 v83, v83
    v_mul_f32 v199, v199, v215
    v_add_f32 v80, 1.0, v80
    s_barrier
    s_waitcnt lgkmcnt(0)
    v_add_f32 v81, 1.0, v81
    v_add_f32 v82, 1.0, v82
    v_add_f32 v83, 1.0, v83
    v_rcp_f32 v80, v80
    v_rcp_f32 v81, v81
    v_rcp_f32 v82, v82
    v_rcp_f32 v83, v83
    s_nop 0
    v_mul_f32 v196, v196, v80
    v_mul_f32 v197, v197, v81
    v_mul_f32 v198, v198, v82
    v_mul_f32 v199, v199, v83
    v_cvt_pk_bf16_f32 v194, v196, v197
    v_cvt_pk_bf16_f32 v195, v198, v199
    s_nop 1
    v_permlane16_swap_b32 v192, v194
    v_permlane16_swap_b32 v193, v195
    buffer_store_dwordx4 v[192:195], v8, s[68:71], s73 offen offset:2048 sc1
    v_mul_f32 v80, v216, v216
    v_mul_f32 v81, v217, v217
    v_mul_f32 v82, v218, v218
    v_mul_f32 v83, v219, v219
    v_fma_f32 v80, v80, s76, v84
    v_fma_f32 v81, v81, s76, v84
    v_fma_f32 v82, v82, s76, v84
    v_fma_f32 v83, v83, s76, v84
    v_mul_f32 v80, v80, v216
    v_mul_f32 v81, v81, v217
    v_mul_f32 v82, v82, v218
    v_mul_f32 v83, v83, v219
    v_exp_f32 v80, v80
    v_mul_f32 v216, v216, v232
    v_exp_f32 v81, v81
    v_mul_f32 v217, v217, v233
    v_exp_f32 v82, v82
    v_mul_f32 v218, v218, v234
    v_exp_f32 v83, v83
    v_mul_f32 v219, v219, v235
    v_add_f32 v80, 1.0, v80
    v_add_f32 v81, 1.0, v81
    v_add_f32 v82, 1.0, v82
    v_add_f32 v83, 1.0, v83
    v_rcp_f32 v80, v80
    v_rcp_f32 v81, v81
    v_rcp_f32 v82, v82
    v_rcp_f32 v83, v83
    s_nop 0
    v_mul_f32 v216, v216, v80
    v_mul_f32 v217, v217, v81
    v_mul_f32 v218, v218, v82
    v_mul_f32 v219, v219, v83
    v_cvt_pk_bf16_f32 v216, v216, v217
    v_cvt_pk_bf16_f32 v217, v218, v219
    v_mul_f32 v80, v220, v220
    v_mul_f32 v81, v221, v221
    v_mul_f32 v82, v222, v222
    v_mul_f32 v83, v223, v223
    v_fma_f32 v80, v80, s76, v84
    v_fma_f32 v81, v81, s76, v84
    v_fma_f32 v82, v82, s76, v84
    v_fma_f32 v83, v83, s76, v84
    v_mul_f32 v80, v80, v220
    v_mul_f32 v81, v81, v221
    v_mul_f32 v82, v82, v222
    v_mul_f32 v83, v83, v223
    v_exp_f32 v80, v80
    v_mul_f32 v220, v220, v236
    v_exp_f32 v81, v81
    s_lshl2_add_u32 s91, s2, s4
    s_lshl_b32 s39, s91, 9
    s_lshr_b32 s92, s91, 2
    s_mul_i32 s92, s92, 7168
    s_and_b32 s91, s91, 3
    s_lshl_b32 s91, s91, 9
    s_add_u32 s92, s92, s91
    s_add_u32 s34, s92, 5120
    s_add_u32 s39, s39, 0x180100
    s_load_dword s94, s[20:21], s39 offset:0x0
    s_load_dword s94, s[20:21], s39 offset:0x40
    s_load_dword s94, s[20:21], s39 offset:0x80
    s_load_dword s94, s[20:21], s39 offset:0xc0
    s_barrier
    v_mul_f32 v221, v221, v237
    v_exp_f32 v82, v82
    v_mul_f32 v222, v222, v238
    v_exp_f32 v83, v83
    v_mul_f32 v223, v223, v239
    v_add_f32 v80, 1.0, v80
    v_add_f32 v81, 1.0, v81
    v_add_f32 v82, 1.0, v82
    v_add_f32 v83, 1.0, v83
    v_rcp_f32 v80, v80
    v_rcp_f32 v81, v81
    v_rcp_f32 v82, v82
    v_rcp_f32 v83, v83
    s_nop 0
    v_mul_f32 v220, v220, v80
    v_mul_f32 v221, v221, v81
    v_mul_f32 v222, v222, v82
    v_mul_f32 v223, v223, v83
    v_cvt_pk_bf16_f32 v218, v220, v221
    v_cvt_pk_bf16_f32 v219, v222, v223
    s_nop 1
    v_permlane16_swap_b32 v216, v218
    v_permlane16_swap_b32 v217, v219
    buffer_store_dwordx4 v[216:219], v8, s[68:71], s74 offen offset:0 sc1
    v_mul_f32 v80, v224, v224
    v_mul_f32 v81, v225, v225
    v_mul_f32 v82, v226, v226
    v_mul_f32 v83, v227, v227
    v_fma_f32 v80, v80, s76, v84
    v_fma_f32 v81, v81, s76, v84
    v_fma_f32 v82, v82, s76, v84
    v_fma_f32 v83, v83, s76, v84
    v_mul_f32 v80, v80, v224
    v_mul_f32 v81, v81, v225
    v_mul_f32 v82, v82, v226
    v_mul_f32 v83, v83, v227
    v_exp_f32 v80, v80
    v_mul_f32 v224, v224, v240
    v_exp_f32 v81, v81
    v_mul_f32 v225, v225, v241
    v_exp_f32 v82, v82
    v_mul_f32 v226, v226, v242
    v_exp_f32 v83, v83
    v_mul_f32 v227, v227, v243
    v_add_f32 v80, 1.0, v80
    v_add_f32 v81, 1.0, v81
    v_add_f32 v82, 1.0, v82
    v_add_f32 v83, 1.0, v83
    v_rcp_f32 v80, v80
    v_rcp_f32 v81, v81
    v_rcp_f32 v82, v82
    v_rcp_f32 v83, v83
    s_nop 0
    v_mul_f32 v224, v224, v80
    v_mul_f32 v225, v225, v81
    v_mul_f32 v226, v226, v82
    v_mul_f32 v227, v227, v83
    v_cvt_pk_bf16_f32 v224, v224, v225
    v_cvt_pk_bf16_f32 v225, v226, v227
    v_mul_f32 v80, v228, v228
    v_mul_f32 v81, v229, v229
    v_mul_f32 v82, v230, v230
    v_mul_f32 v83, v231, v231
    v_fma_f32 v80, v80, s76, v84
    v_fma_f32 v81, v81, s76, v84
    v_fma_f32 v82, v82, s76, v84
    v_fma_f32 v83, v83, s76, v84
    s_add_u32 s39, s39, 0x27ff00
    s_load_dword s94, s[20:21], s39 offset:0x0
    s_load_dword s94, s[20:21], s39 offset:0x40
    s_load_dword s94, s[20:21], s39 offset:0x80
    s_load_dword s94, s[20:21], s39 offset:0xc0
    s_barrier
    v_mul_f32 v80, v80, v228
    v_mul_f32 v81, v81, v229
    v_mul_f32 v82, v82, v230
    v_mul_f32 v83, v83, v231
    v_exp_f32 v80, v80
    v_mul_f32 v228, v228, v244
    v_exp_f32 v81, v81
    v_mul_f32 v229, v229, v245
    v_exp_f32 v82, v82
    v_mul_f32 v230, v230, v246
    v_exp_f32 v83, v83
    v_mul_f32 v231, v231, v247
    v_add_f32 v80, 1.0, v80
    v_add_f32 v81, 1.0, v81
    v_add_f32 v82, 1.0, v82
    v_add_f32 v83, 1.0, v83
    v_rcp_f32 v80, v80
    v_rcp_f32 v81, v81
    v_rcp_f32 v82, v82
    v_rcp_f32 v83, v83
    s_nop 0
    v_mul_f32 v228, v228, v80
    v_mul_f32 v229, v229, v81
    v_mul_f32 v230, v230, v82
    v_mul_f32 v231, v231, v83
    v_cvt_pk_bf16_f32 v226, v228, v229
    v_cvt_pk_bf16_f32 v227, v230, v231
    s_nop 1
    v_permlane16_swap_b32 v224, v226
    v_permlane16_swap_b32 v225, v227
    buffer_store_dwordx4 v[224:227], v8, s[68:71], s74 offen offset:2048 sc1
    v_lshrrev_b32 v64, 4, v1
    v_and_b32 v66, 14, v1
    v_lshlrev_b32 v64, 2, v64
    v_sub_u32 v64, v66, v64
    v_and_b32 v65, 1, v1
    v_cmp_le_i32 s[40:41], 0, v64
    v_cmp_le_i32 s[42:43], 2, v64
    v_mul_u32_u24 v66, 0x202, v65
    s_mov_b32 s80, 0x01000c0c
    v_lshl_add_u32 v66, v66, 16, s80
    v_add_u32 v67, 0x04040000, v66
    v_cndmask_b32 v76, v66, v67, s[40:41]
    v_cndmask_b32 v77, v66, v67, s[42:43]
    v_lshlrev_b32 v65, 4, v65
    v_mov_b32 v68, 0x0c0c0c0c
    v_mov_b32 v66, 0xc0c0100
    v_alignbit_b32 v66, v66, v66, v65
    v_cndmask_b32 v78, v66, v68, s[40:41]
    v_cndmask_b32 v86, v68, v66, s[40:41]
    v_mov_b32 v66, 0xc0c0302
    v_alignbit_b32 v66, v66, v66, v65
    v_cndmask_b32 v79, v66, v68, s[42:43]
    v_cndmask_b32 v87, v68, v66, s[42:43]
    s_or_b32 s80, s28, s5
    s_cmp_eq_u32 s80, 0
    s_cselect_b64 s[80:81], 0, -1
    s_or_b64 s[40:41], s[40:41], s[80:81]
    s_or_b64 s[42:43], s[42:43], s[80:81]
    v_mov_b32 v7, 0xce6e6b28
    s_mov_b32 s77, 0x3e3504f3
    s_mov_b32 s78, 0x3fb8aa3b
    v_cvt_pk_bf16_f32 v88, v88, v89
    v_cvt_pk_bf16_f32 v89, v90, v91
    v_cvt_pk_bf16_f32 v90, v104, v105
    v_cvt_pk_bf16_f32 v91, v106, v107
    v_cvt_pk_bf16_f32 v152, v152, v153
    v_cvt_pk_bf16_f32 v153, v154, v155
    v_cvt_pk_bf16_f32 v154, v168, v169
    v_cvt_pk_bf16_f32 v155, v170, v171
    v_cvt_pk_bf16_f32 v92, v92, v93
    v_cvt_pk_bf16_f32 v93, v94, v95
    v_cvt_pk_bf16_f32 v94, v108, v109
    v_cvt_pk_bf16_f32 v95, v110, v111
    v_cvt_pk_bf16_f32 v156, v156, v157
    v_cvt_pk_bf16_f32 v157, v158, v159
    v_cvt_pk_bf16_f32 v158, v172, v173
    v_cvt_pk_bf16_f32 v159, v174, v175
    s_load_dword s94, s[20:21], s39 offset:0x100
    s_load_dword s94, s[20:21], s39 offset:0x140
    s_load_dword s94, s[20:21], s39 offset:0x180
    s_load_dword s94, s[20:21], s39 offset:0x1c0
    s_barrier
    s_setprio 3
    v_mfma_f32_16x16x32_bf16 v[48:51], v[44:47], v[152:155], 0
    v_mfma_f32_16x16x32_bf16 v[52:55], v[88:91], v[152:155], 0
    s_setprio 0
    v_cvt_pk_bf16_f32 v96, v96, v97
    v_cvt_pk_bf16_f32 v97, v98, v99
    v_cvt_pk_bf16_f32 v98, v112, v113
    v_cvt_pk_bf16_f32 v99, v114, v115
    v_cvt_pk_bf16_f32 v160, v160, v161
    v_cvt_pk_bf16_f32 v161, v162, v163
    v_cvt_pk_bf16_f32 v162, v176, v177
    v_cvt_pk_bf16_f32 v163, v178, v179
    s_setprio 3
    v_mfma_f32_16x16x32_bf16 v[56:59], v[88:91], v[156:159], 0
    v_mfma_f32_16x16x32_bf16 v[60:63], v[92:95], v[156:159], 0
    s_setprio 0
    v_cvt_pk_bf16_f32 v48, v48, v49
    v_cvt_pk_bf16_f32 v49, v50, v51
    v_cvt_pk_bf16_f32 v50, v52, v53
    v_cvt_pk_bf16_f32 v51, v54, v55
    v_perm_b32 v64, v50, v48, v76
    v_perm_b32 v65, v51, v49, v77
    v_mul_f32 v64, s77, v64
    v_mul_f32 v65, s77, v65
    v_cvt_pk_bf16_f32 v65, v64, v65
    v_lshlrev_b32 v64, 16, v65
    v_and_b32 v65, 0xffff0000, v65
    v_cndmask_b32 v64, v7, v64, s[40:41]
    v_cndmask_b32 v65, v7, v65, s[42:43]
    v_max_f32 v72, v64, v65
    v_cvt_pk_bf16_f32 v164, v164, v165
    v_cvt_pk_bf16_f32 v165, v166, v167
    v_cvt_pk_bf16_f32 v166, v180, v181
    v_cvt_pk_bf16_f32 v167, v182, v183
    s_setprio 3
    v_mfma_f32_16x16x32_bf16 v[48:51], v[92:95], v[160:163], 0
    v_mfma_f32_16x16x32_bf16 v[52:55], v[96:99], v[160:163], 0
    s_setprio 0
    v_cvt_pk_bf16_f32 v56, v56, v57
    v_cvt_pk_bf16_f32 v57, v58, v59
    v_cvt_pk_bf16_f32 v58, v60, v61
    v_cvt_pk_bf16_f32 v59, v62, v63
    v_perm_b32 v66, v58, v56, v76
    v_perm_b32 v67, v59, v57, v77
    v_mul_f32 v66, s77, v66
    v_mul_f32 v67, s77, v67
    v_cvt_pk_bf16_f32 v67, v66, v67
    v_lshlrev_b32 v66, 16, v67
    v_and_b32 v67, 0xffff0000, v67
    v_max_f32 v73, v66, v67
    s_setprio 3
    v_mfma_f32_16x16x32_bf16 v[56:59], v[96:99], v[164:167], 0
    v_mfma_f32_16x16x32_bf16 v[60:63], v[100:103], v[164:167], 0
    s_setprio 0
    v_cvt_pk_bf16_f32 v26, v120, v121
    v_cvt_pk_bf16_f32 v27, v122, v123
    v_cvt_pk_bf16_f32 v36, v136, v137
    v_cvt_pk_bf16_f32 v37, v138, v139
    s_add_u32 s39, s39, 0xffe00000
    s_load_dword s94, s[20:21], s39 offset:0x0
    s_load_dword s94, s[20:21], s39 offset:0x40
    s_load_dword s94, s[20:21], s39 offset:0x80
    s_load_dword s94, s[20:21], s39 offset:0xc0
    s_barrier
    v_cvt_pk_bf16_f32 v28, v124, v125
    v_cvt_pk_bf16_f32 v29, v126, v127
    v_cvt_pk_bf16_f32 v38, v140, v141
    v_cvt_pk_bf16_f32 v39, v142, v143
    v_cvt_pk_bf16_f32 v30, v128, v129
    v_cvt_pk_bf16_f32 v31, v130, v131
    v_cvt_pk_bf16_f32 v40, v144, v145
    v_cvt_pk_bf16_f32 v41, v146, v147
    v_cvt_pk_bf16_f32 v48, v48, v49
    v_cvt_pk_bf16_f32 v49, v50, v51
    v_cvt_pk_bf16_f32 v50, v52, v53
    v_cvt_pk_bf16_f32 v51, v54, v55
    v_perm_b32 v68, v50, v48, v76
    v_perm_b32 v69, v51, v49, v77
    v_mul_f32 v68, s77, v68
    v_mul_f32 v69, s77, v69
    v_cvt_pk_bf16_f32 v69, v68, v69
    v_lshlrev_b32 v68, 16, v69
    v_and_b32 v69, 0xffff0000, v69
    v_max_f32 v74, v68, v69
    v_cvt_pk_bf16_f32 v56, v56, v57
    v_cvt_pk_bf16_f32 v57, v58, v59
    v_cvt_pk_bf16_f32 v58, v60, v61
    v_cvt_pk_bf16_f32 v59, v62, v63
    v_perm_b32 v70, v58, v56, v76
    v_perm_b32 v71, v59, v57, v77
    v_mul_f32 v70, s77, v70
    v_mul_f32 v71, s77, v71
    v_cvt_pk_bf16_f32 v71, v70, v71
    v_lshlrev_b32 v70, 16, v71
    v_and_b32 v71, 0xffff0000, v71
    v_max_f32 v75, v70, v71
    v_permlane32_swap_b32 v72, v73
    v_max_f32 v72, v72, v73
    v_permlane32_swap_b32 v74, v75
    v_max_f32 v74, v74, v75
    s_nop 1
    v_permlane16_swap_b32 v72, v74
    v_max_f32 v72, v72, v74
    v_mov_b32 v74, v72
    s_nop 1
    v_permlane16_swap_b32 v72, v74
    v_mov_b32 v73, v72
    v_mov_b32 v75, v74
    s_nop 0
    v_permlane32_swap_b32 v72, v73
    v_permlane32_swap_b32 v74, v75
    v_sub_f32 v64, v64, v72
    v_sub_f32 v65, v65, v72
    v_sub_f32 v66, v66, v73
    v_sub_f32 v67, v67, v73
    v_sub_f32 v68, v68, v74
    v_sub_f32 v69, v69, v74
    v_sub_f32 v70, v70, v75
    v_sub_f32 v71, v71, v75
    v_mul_f32 v64, s78, v64
    v_mul_f32 v65, s78, v65
    v_mul_f32 v66, s78, v66
    v_mul_f32 v67, s78, v67
    v_mul_f32 v68, s78, v68
    v_mul_f32 v69, s78, v69
    v_mul_f32 v70, s78, v70
    v_mul_f32 v71, s78, v71
    v_exp_f32 v64, v64
    v_exp_f32 v65, v65
    v_exp_f32 v66, v66
    v_exp_f32 v67, v67
    v_exp_f32 v68, v68
    v_exp_f32 v69, v69
    v_exp_f32 v70, v70
    v_exp_f32 v71, v71
    v_add_f32 v72, v64, v65
    v_add_f32 v73, v66, v67
    s_load_dword s94, s[20:21], s39 offset:0x100
    s_load_dword s94, s[20:21], s39 offset:0x140
    s_load_dword s94, s[20:21], s39 offset:0x180
    s_load_dword s94, s[20:21], s39 offset:0x1c0
    s_barrier
    v_add_f32 v74, v68, v69
    v_add_f32 v75, v70, v71
    v_permlane32_swap_b32 v72, v73
    v_add_f32 v72, v72, v73
    v_permlane32_swap_b32 v74, v75
    v_add_f32 v74, v74, v75
    s_nop 1
    v_permlane16_swap_b32 v72, v74
    v_add_f32 v72, v72, v74
    v_rcp_f32 v72, v72
    s_nop 0
    v_mov_b32 v74, v72
    s_nop 1
    v_permlane16_swap_b32 v72, v74
    v_mov_b32 v73, v72
    v_mov_b32 v75, v74
    s_nop 0
    v_permlane32_swap_b32 v72, v73
    v_permlane32_swap_b32 v74, v75
    v_mul_f32 v64, v64, v72
    v_mul_f32 v65, v65, v72
    v_mul_f32 v66, v66, v73
    v_mul_f32 v67, v67, v73
    v_mul_f32 v68, v68, v74
    v_mul_f32 v69, v69, v74
    v_mul_f32 v70, v70, v75
    v_mul_f32 v71, v71, v75
    v_cvt_pk_bf16_f32 v72, v64, v65
    v_cvt_pk_bf16_f32 v73, v66, v67
    v_cvt_pk_bf16_f32 v74, v68, v69
    v_cvt_pk_bf16_f32 v75, v70, v71
    v_perm_b32 v152, v72, v72, v78
    v_perm_b32 v153, v72, v72, v79
    v_perm_b32 v154, v72, v72, v86
    v_perm_b32 v155, v72, v72, v87
    v_perm_b32 v156, v73, v73, v78
    v_perm_b32 v157, v73, v73, v79
    v_perm_b32 v158, v73, v73, v86
    v_perm_b32 v159, v73, v73, v87
    s_setprio 3
    v_mfma_f32_16x16x32_bf16 v[48:51], v[24:27], v[152:155], 0
    v_mfma_f32_16x16x32_bf16 v[52:55], v[34:37], v[152:155], 0
    s_setprio 0
    v_perm_b32 v160, v74, v74, v78
    v_perm_b32 v161, v74, v74, v79
    v_perm_b32 v162, v74, v74, v86
    v_perm_b32 v163, v74, v74, v87
    s_setprio 3
    v_mfma_f32_16x16x32_bf16 v[56:59], v[26:29], v[156:159], 0
    v_mfma_f32_16x16x32_bf16 v[60:63], v[36:39], v[156:159], 0
    s_setprio 0
    v_perm_b32 v164, v75, v75, v78
    v_perm_b32 v165, v75, v75, v79
    v_perm_b32 v166, v75, v75, v86
    v_perm_b32 v167, v75, v75, v87
    v_cvt_pk_bf16_f32 v168, v48, v49
    v_cvt_pk_bf16_f32 v169, v50, v51
    v_cvt_pk_bf16_f32 v170, v52, v53
    v_cvt_pk_bf16_f32 v171, v54, v55
    s_setprio 3
    v_mfma_f32_16x16x32_bf16 v[48:51], v[28:31], v[160:163], 0
    v_mfma_f32_16x16x32_bf16 v[52:55], v[38:41], v[160:163], 0
    s_add_u32 s39, s39, 0x280000
    s_load_dword s94, s[20:21], s39 offset:0x0
    s_load_dword s94, s[20:21], s39 offset:0x40
    s_load_dword s94, s[20:21], s39 offset:0x80
    s_load_dword s94, s[20:21], s39 offset:0xc0
    s_waitcnt vmcnt(0)
    s_barrier
    s_setprio 0
    v_cvt_pk_bf16_f32 v172, v56, v57
    v_cvt_pk_bf16_f32 v173, v58, v59
    v_cvt_pk_bf16_f32 v174, v60, v61
    v_cvt_pk_bf16_f32 v175, v62, v63
    s_setprio 3
    v_mfma_f32_16x16x32_bf16 v[56:59], v[30:33], v[164:167], 0
    v_mfma_f32_16x16x32_bf16 v[60:63], v[40:43], v[164:167], 0
    s_setprio 0
    v_permlane16_swap_b32 v168, v170
    v_permlane16_swap_b32 v169, v171
    buffer_store_dwordx4 v[168:171], v0, s[68:71], s75 offen offset:0 sc1
    v_permlane16_swap_b32 v172, v174
    v_permlane16_swap_b32 v173, v175
    buffer_store_dwordx4 v[172:175], v0, s[68:71], s75 offen offset:1024 sc1
    v_cvt_pk_bf16_f32 v176, v48, v49
    v_cvt_pk_bf16_f32 v177, v50, v51
    v_cvt_pk_bf16_f32 v178, v52, v53
    v_cvt_pk_bf16_f32 v179, v54, v55
    v_cvt_pk_bf16_f32 v180, v56, v57
    v_cvt_pk_bf16_f32 v181, v58, v59
    v_cvt_pk_bf16_f32 v182, v60, v61
    v_cvt_pk_bf16_f32 v183, v62, v63
    v_permlane16_swap_b32 v176, v178
    v_permlane16_swap_b32 v177, v179
    buffer_store_dwordx4 v[176:179], v0, s[68:71], s75 offen offset:2048 sc1
    v_permlane16_swap_b32 v180, v182
    v_permlane16_swap_b32 v181, v183
    buffer_store_dwordx4 v[180:183], v0, s[68:71], s75 offen offset:3072 sc1
    v_lshrrev_b32 v64, 4, v1
    v_bfe_u32 v65, v1, 2, 2
    v_and_b32 v66, 3, v1
    v_and_b32 v67, 15, v1
    v_lshrrev_b32 v68, 3, v1
    v_and_b32 v69, 7, v1
    s_lshl_b32 s85, s6, 2
    v_lshl_add_u32 v70, v64, 3, v65
    v_lshlrev_b32 v70, 7, v70
    v_and_b32 v71, 1, v66
    v_lshl_add_u32 v70, v71, 3, v70
    v_add_u32 v70, 0, v70
    v_and_b32 v71, 2, v65
    v_and_b32 v72, 1, v64
    v_lshl_add_u32 v71, v72, 2, v71
    v_lshrrev_b32 v72, 1, v66
    v_xor_b32 v71, v71, v72
    v_xor_b32 v71, s85, v71
    v_xor_b32 v72, 0, v71
    v_lshl_add_u32 v80, v72, 4, v70
    v_add_u32 v82, 49152, v80
    v_add_u32 v84, 98304, v80
    v_xor_b32 v72, 2, v71
    v_lshl_add_u32 v81, v72, 4, v70
    v_add_u32 v83, 49152, v81
    v_add_u32 v85, 98304, v81
    s_lshl_b32 s85, s5, 12
    v_lshl_add_u32 v48, v1, 4, s85
    v_add_u32 v49, 49152, v48
    v_add_u32 v50, 98304, v48
    v_mov_b32 v88, 0
    v_mov_b32 v89, 0
    v_mov_b32 v90, 0
    v_mov_b32 v91, 0
    v_mov_b32 v92, 0
    v_mov_b32 v93, 0
    v_mov_b32 v94, 0
    v_mov_b32 v95, 0
    v_mov_b32 v96, 0
    v_mov_b32 v97, 0
    v_mov_b32 v98, 0
    v_mov_b32 v99, 0
    v_mov_b32 v100, 0
    v_mov_b32 v101, 0
    v_mov_b32 v102, 0
    v_mov_b32 v103, 0
    v_mov_b32 v104, 0
    v_mov_b32 v105, 0
    v_mov_b32 v106, 0
    v_mov_b32 v107, 0
    s_load_dword s94, s[20:21], s39 offset:0x100
    s_load_dword s94, s[20:21], s39 offset:0x140
    s_load_dword s94, s[20:21], s39 offset:0x180
    s_load_dword s94, s[20:21], s39 offset:0x1c0
    s_cmp_lg_u32 s4, 0
    s_cbranch_scc1 L_fH2
    s_lshl_b32 s91, s28, 4
    s_add_u32 s91, s91, s29
    s_lshl_b32 s91, s91, 7
    s_add_u32 s91, s91, 0x1e90000
    v_mov_b32 v16, s91
    v_mov_b32 v18, s100
    v_mov_b32 v19, s101
    s_mov_b64 exec, 1
    global_store_dwordx2 v16, v[18:19], s[26:27] sc1
    s_mov_b64 exec, -1
L_fH2:
    s_barrier
    v_mov_b32 v108, 0
    v_mov_b32 v109, 0
    v_mov_b32 v110, 0
    v_mov_b32 v111, 0
    v_mov_b32 v112, 0
    v_mov_b32 v113, 0
    v_mov_b32 v114, 0
    v_mov_b32 v115, 0
    v_mov_b32 v116, 0
    v_mov_b32 v117, 0
    v_mov_b32 v118, 0
    v_mov_b32 v119, 0
    s_lshl_b32 s84, s4, 12
    s_add_u32 s84, s84, 147456
    v_lshl_add_u32 v3, v1, 3, s84
    v_lshrrev_b32 v70, 1, v64
    v_xor_b32 v70, v70, v65
    v_lshl_add_u32 v70, v70, 4, s84
    v_lshl_add_u32 v70, v67, 6, v70
    v_and_b32 v71, 1, v64
    v_lshl_add_u32 v14, v71, 3, v70
    v_xor_b32 v15, 32, v14
    v_xor_b32 v70, v66, v64
    v_lshl_add_u32 v70, v70, 4, s84
    v_lshrrev_b32 v71, 2, v1
    v_lshl_add_u32 v17, v71, 6, v70
    s_mov_b32 s72, s8
    s_mov_b32 s73, s9
    s_mov_b32 s74, 0x400000
    s_mov_b32 s75, 0x20000
    s_load_dword s94, s[20:21], s39 offset:0x80000
    s_load_dword s94, s[20:21], s39 offset:0x80040
    s_load_dword s94, s[20:21], s39 offset:0x80080
    s_load_dword s94, s[20:21], s39 offset:0x800c0
    s_barrier
    s_load_dword s94, s[20:21], s39 offset:0x80100
    s_load_dword s94, s[20:21], s39 offset:0x80140
    s_load_dword s94, s[20:21], s39 offset:0x80180
    s_load_dword s94, s[20:21], s39 offset:0x801c0
    s_barrier
    s_mov_b32 s84, 0
    buffer_load_dwordx4 v[120:123], v13, s[72:75], s84 offen
    s_add_u32 s39, s39, 0x180000
    s_load_dword s94, s[20:21], s39 offset:0x0
    s_load_dword s94, s[20:21], s39 offset:0x40
    s_load_dword s94, s[20:21], s39 offset:0x80
    s_load_dword s94, s[20:21], s39 offset:0xc0
    s_barrier
    s_lshl1_add_u32 m0, s33, 81920
    s_nop 0
    buffer_load_dwordx4 v11, s[60:63], s83 offen lds
    s_mov_b32 s84, 32768
    buffer_load_dwordx4 v[124:127], v13, s[72:75], s84 offen
    s_lshl1_add_u32 m0, s33, 82944
    s_nop 0
    buffer_load_dwordx4 v12, s[60:63], s83 offen lds
    s_lshl1_add_u32 m0, s33, 90112
    s_nop 0
    buffer_load_dwordx4 v11, s[64:67], s83 offen lds
    s_lshl1_add_u32 m0, s33, 91136
    s_nop 0
    buffer_load_dwordx4 v12, s[64:67], s83 offen lds
    s_add_u32 s83, s83, 131072
    s_load_dword s94, s[20:21], s39 offset:0x100
    s_load_dword s94, s[20:21], s39 offset:0x140
    s_load_dword s94, s[20:21], s39 offset:0x180
    s_load_dword s94, s[20:21], s39 offset:0x1c0
    s_barrier
    s_lshl_b32 m0, s33, 2
    s_nop 0
    buffer_load_dwordx4 v10, s[56:59], s82 offen offset:0 sc1 lds
    s_mov_b32 s84, 65536
    buffer_load_dwordx4 v[128:131], v13, s[72:75], s84 offen
    buffer_load_dwordx4 v10, s[56:59], s82 offen offset:1024 sc1 lds
    buffer_load_dwordx4 v10, s[56:59], s82 offen offset:2048 sc1 lds
    buffer_load_dwordx4 v10, s[56:59], s82 offen offset:3072 sc1 lds
    s_add_u32 s82, s82, 16384
    s_lshl1_add_u32 m0, s33, 16384
    s_nop 0
    buffer_load_dwordx4 v11, s[60:63], s83 offen lds
    s_lshl1_add_u32 m0, s33, 17408
    s_nop 0
    buffer_load_dwordx4 v12, s[60:63], s83 offen lds
    s_lshl1_add_u32 m0, s33, 24576
    s_nop 0
    buffer_load_dwordx4 v11, s[64:67], s83 offen lds
    s_lshl1_add_u32 m0, s33, 25600
    s_nop 0
    buffer_load_dwordx4 v12, s[64:67], s83 offen lds
    s_add_u32 s83, s83, 131072
    s_add_u32 s39, s39, 0xfff80000
    s_load_dword s94, s[20:21], s39 offset:0x0
    s_load_dword s94, s[20:21], s39 offset:0x40
    s_load_dword s94, s[20:21], s39 offset:0x80
    s_load_dword s94, s[20:21], s39 offset:0xc0
    s_waitcnt vmcnt(15)
    s_barrier
    s_lshl2_add_u32 m0, s33, 98304
    s_nop 0
    buffer_load_dwordx4 v10, s[56:59], s82 offen offset:0 sc1 lds
    s_mov_b32 s84, 98304
    buffer_load_dwordx4 v[132:135], v13, s[72:75], s84 offen
    buffer_load_dwordx4 v10, s[56:59], s82 offen offset:1024 sc1 lds
    buffer_load_dwordx4 v10, s[56:59], s82 offen offset:2048 sc1 lds
    buffer_load_dwordx4 v10, s[56:59], s82 offen offset:3072 sc1 lds
    s_add_u32 s82, s82, 16384
    s_lshl1_add_u32 m0, s33, 114688
    s_nop 0
    buffer_load_dwordx4 v11, s[60:63], s83 offen lds
    s_lshl1_add_u32 m0, s33, 115712
    s_nop 0
    buffer_load_dwordx4 v12, s[60:63], s83 offen lds
    s_lshl1_add_u32 m0, s33, 122880
    s_nop 0
    buffer_load_dwordx4 v11, s[64:67], s83 offen lds
    s_lshl1_add_u32 m0, s33, 123904
    s_nop 0
    buffer_load_dwordx4 v12, s[64:67], s83 offen lds
    s_add_u32 s83, s83, 131072
    s_load_dword s94, s[20:21], s39 offset:0x100
    s_load_dword s94, s[20:21], s39 offset:0x140
    s_load_dword s94, s[20:21], s39 offset:0x180
    s_load_dword s94, s[20:21], s39 offset:0x1c0
    s_cmp_lg_u32 s4, 0
    s_cbranch_scc1 L_fO
    s_lshl_b32 s91, s28, 4
    s_add_u32 s91, s91, s29
    s_lshl_b32 s91, s91, 7
    s_add_u32 s91, s91, 0x1e98000
    v_mov_b32 v16, s91
    v_mov_b32 v18, s100
    v_mov_b32 v19, s101
    s_mov_b64 exec, 1
    global_store_dwordx2 v16, v[18:19], s[26:27] sc1
    s_mov_b64 exec, -1
L_fO:
    s_waitcnt vmcnt(18)
    s_barrier
    s_lshl2_add_u32 m0, s33, 32768
    s_nop 0
    buffer_load_dwordx4 v10, s[56:59], s82 offen offset:0 sc1 lds
    buffer_load_dwordx4 v10, s[56:59], s82 offen offset:1024 sc1 lds
    buffer_load_dwordx4 v10, s[56:59], s82 offen offset:2048 sc1 lds
    buffer_load_dwordx4 v10, s[56:59], s82 offen offset:3072 sc1 lds
    s_add_u32 s82, s82, 16384
    s_lshl1_add_u32 m0, s33, 49152
    s_nop 0
    buffer_load_dwordx4 v11, s[60:63], s83 offen lds
    s_lshl1_add_u32 m0, s33, 50176
    s_nop 0
    buffer_load_dwordx4 v12, s[60:63], s83 offen lds
    s_lshl1_add_u32 m0, s33, 57344
    s_nop 0
    buffer_load_dwordx4 v11, s[64:67], s83 offen lds
    s_lshl1_add_u32 m0, s33, 58368
    s_nop 0
    buffer_load_dwordx4 v12, s[64:67], s83 offen lds
    s_add_u32 s83, s83, 131072
    s_add_u32 s39, s39, 0x100000
    s_load_dword s94, s[20:21], s39 offset:0x0
    s_load_dword s94, s[20:21], s39 offset:0x40
    s_load_dword s94, s[20:21], s39 offset:0x80
    s_load_dword s94, s[20:21], s39 offset:0xc0
    s_lshl2_add_u32 s91, s30, s4
    s_lshl_b32 s91, s91, 9
    s_add_u32 s91, s91, 0x1e90000
    v_lshl_add_u32 v20, v1, 7, s91
    s_mov_b64 exec, 15
    global_load_dwordx2 v[22:23], v20, s[26:27] sc1
    s_mov_b64 exec, -1
    s_waitcnt vmcnt(18)
    s_barrier
    s_lshl2_add_u32 m0, s33, 65536
    s_nop 0
    buffer_load_dwordx4 v10, s[56:59], s82 offen offset:0 sc1 lds
    buffer_load_dwordx4 v10, s[56:59], s82 offen offset:1024 sc1 lds
    buffer_load_dwordx4 v10, s[56:59], s82 offen offset:2048 sc1 lds
    buffer_load_dwordx4 v10, s[56:59], s82 offen offset:3072 sc1 lds
    s_add_u32 s82, s82, 16384
    s_lshl1_add_u32 m0, s33, 81920
    s_nop 0
    buffer_load_dwordx4 v11, s[60:63], s83 offen lds
    s_lshl1_add_u32 m0, s33, 82944
    s_nop 0
    buffer_load_dwordx4 v12, s[60:63], s83 offen lds
    s_lshl1_add_u32 m0, s33, 90112
    s_nop 0
    buffer_load_dwordx4 v11, s[64:67], s83 offen lds
    s_lshl1_add_u32 m0, s33, 91136
    s_nop 0
    buffer_load_dwordx4 v12, s[64:67], s83 offen lds
    s_add_u32 s83, s83, 131072
    s_load_dword s94, s[20:21], s39 offset:0x100
    s_load_dword s94, s[20:21], s39 offset:0x140
    s_load_dword s94, s[20:21], s39 offset:0x180
    s_load_dword s94, s[20:21], s39 offset:0x1c0
    s_waitcnt vmcnt(8)
    s_mov_b64 exec, 15
    s_movk_i32 s98, 0x4000
L_pH2_chk:
    v_cmp_ne_u64 vcc, s[100:101], v[22:23]
    s_nop 1
    s_cmp_eq_u64 vcc, 0
    s_cbranch_scc1 L_pH2_ok
    s_sub_u32 s98, s98, 1
    s_cbranch_scc1 L_pH2_ok
    s_sleep 1
    global_load_dwordx2 v[22:23], v20, s[26:27] sc1
    s_waitcnt vmcnt(0)
    s_branch L_pH2_chk
L_pH2_ok:
    s_mov_b64 exec, -1
    s_waitcnt vmcnt(17)
    s_barrier
    s_add_u32 s82, s82, s14
    s_add_u32 s83, s83, s35
    s_lshl_b32 m0, s33, 2
    s_nop 0
    buffer_load_dwordx4 v10, s[56:59], s82 offen offset:0 sc1 lds
    buffer_load_dwordx4 v10, s[56:59], s82 offen offset:1024 sc1 lds
    buffer_load_dwordx4 v10, s[56:59], s82 offen offset:2048 sc1 lds
    buffer_load_dwordx4 v10, s[56:59], s82 offen offset:3072 sc1 lds
    s_add_u32 s82, s82, 16384
    s_lshl1_add_u32 m0, s33, 16384
    s_nop 0
    buffer_load_dwordx4 v11, s[60:63], s83 offen lds
    s_lshl1_add_u32 m0, s33, 17408
    s_nop 0
    buffer_load_dwordx4 v12, s[60:63], s83 offen lds
    s_lshl1_add_u32 m0, s33, 24576
    s_nop 0
    buffer_load_dwordx4 v11, s[64:67], s83 offen lds
    s_lshl1_add_u32 m0, s33, 25600
    s_nop 0
    buffer_load_dwordx4 v12, s[64:67], s83 offen lds
    s_add_u32 s83, s83, 131072
    s_add_u32 s39, s39, 0xff980000
    s_load_dword s94, s[12:13], s39 offset:0x0
    s_load_dword s94, s[12:13], s39 offset:0x40
    s_load_dword s94, s[12:13], s39 offset:0x80
    s_load_dword s94, s[12:13], s39 offset:0xc0
    s_waitcnt vmcnt(17)
    s_barrier
    s_lshl2_add_u32 m0, s33, 98304
    s_nop 0
    buffer_load_dwordx4 v10, s[56:59], s82 offen offset:0 sc1 lds
    buffer_load_dwordx4 v10, s[56:59], s82 offen offset:1024 sc1 lds
    buffer_load_dwordx4 v10, s[56:59], s82 offen offset:2048 sc1 lds
    buffer_load_dwordx4 v10, s[56:59], s82 offen offset:3072 sc1 lds
    s_add_u32 s82, s82, 16384
    s_lshl1_add_u32 m0, s33, 114688
    s_nop 0
    buffer_load_dwordx4 v11, s[60:63], s83 offen lds
    s_lshl1_add_u32 m0, s33, 115712
    s_nop 0
    buffer_load_dwordx4 v12, s[60:63], s83 offen lds
    s_lshl1_add_u32 m0, s33, 122880
    s_nop 0
    buffer_load_dwordx4 v11, s[64:67], s83 offen lds
    s_lshl1_add_u32 m0, s33, 123904
    s_nop 0
    buffer_load_dwordx4 v12, s[64:67], s83 offen lds
    s_add_u32 s83, s83, 131072
    s_load_dword s94, s[12:13], s39 offset:0x100
    s_load_dword s94, s[12:13], s39 offset:0x140
    s_load_dword s94, s[12:13], s39 offset:0x180
    s_load_dword s94, s[12:13], s39 offset:0x1c0
    s_waitcnt vmcnt(16)
    s_barrier
    s_lshl2_add_u32 m0, s33, 32768
    s_nop 0
    buffer_load_dwordx4 v10, s[56:59], s82 offen offset:0 sc1 lds
    buffer_load_dwordx4 v10, s[56:59], s82 offen offset:1024 sc1 lds
    buffer_load_dwordx4 v10, s[56:59], s82 offen offset:2048 sc1 lds
    buffer_load_dwordx4 v10, s[56:59], s82 offen offset:3072 sc1 lds
    s_add_u32 s82, s82, 16384
    s_lshl1_add_u32 m0, s33, 49152
    s_nop 0
    buffer_load_dwordx4 v11, s[60:63], s83 offen lds
    s_lshl1_add_u32 m0, s33, 50176
    s_nop 0
    buffer_load_dwordx4 v12, s[60:63], s83 offen lds
    s_lshl1_add_u32 m0, s33, 57344
    s_nop 0
    buffer_load_dwordx4 v11, s[64:67], s83 offen lds
    s_lshl1_add_u32 m0, s33, 58368
    s_nop 0
    buffer_load_dwordx4 v12, s[64:67], s83 offen lds
    s_add_u32 s83, s83, 131072
    s_load_dword s94, s[12:13], s39 offset:0x80000
    s_load_dword s94, s[12:13], s39 offset:0x80040
    s_load_dword s94, s[12:13], s39 offset:0x80080
    s_load_dword s94, s[12:13], s39 offset:0x800c0
    s_waitcnt vmcnt(16)
    s_barrier
    s_lshl2_add_u32 m0, s33, 65536
    s_nop 0
    buffer_load_dwordx4 v10, s[56:59], s82 offen offset:0 sc1 lds
    buffer_load_dwordx4 v10, s[56:59], s82 offen offset:1024 sc1 lds
    buffer_load_dwordx4 v10, s[56:59], s82 offen offset:2048 sc1 lds
    buffer_load_dwordx4 v10, s[56:59], s82 offen offset:3072 sc1 lds
    s_add_u32 s82, s82, 16384
    s_lshl1_add_u32 m0, s33, 81920
    s_nop 0
    buffer_load_dwordx4 v11, s[60:63], s83 offen lds
    s_lshl1_add_u32 m0, s33, 82944
    s_nop 0
    buffer_load_dwordx4 v12, s[60:63], s83 offen lds
    s_lshl1_add_u32 m0, s33, 90112
    s_nop 0
    buffer_load_dwordx4 v11, s[64:67], s83 offen lds
    s_lshl1_add_u32 m0, s33, 91136
    s_nop 0
    buffer_load_dwordx4 v12, s[64:67], s83 offen lds
    s_add_u32 s83, s83, 131072
    s_load_dword s94, s[12:13], s39 offset:0x80100
    s_load_dword s94, s[12:13], s39 offset:0x80140
    s_load_dword s94, s[12:13], s39 offset:0x80180
    s_load_dword s94, s[12:13], s39 offset:0x801c0
    s_waitcnt vmcnt(16)
    s_barrier
    s_lshl_b32 m0, s33, 2
    s_nop 0
    buffer_load_dwordx4 v10, s[56:59], s82 offen offset:0 sc1 lds
    buffer_load_dwordx4 v10, s[56:59], s82 offen offset:1024 sc1 lds
    buffer_load_dwordx4 v10, s[56:59], s82 offen offset:2048 sc1 lds
    buffer_load_dwordx4 v10, s[56:59], s82 offen offset:3072 sc1 lds
    s_add_u32 s82, s82, 16384
    s_lshl1_add_u32 m0, s33, 16384
    s_nop 0
    buffer_load_dwordx4 v11, s[60:63], s83 offen lds
    s_lshl1_add_u32 m0, s33, 17408
    s_nop 0
    buffer_load_dwordx4 v12, s[60:63], s83 offen lds
    s_lshl1_add_u32 m0, s33, 24576
    s_nop 0
    buffer_load_dwordx4 v11, s[64:67], s83 offen lds
    s_lshl1_add_u32 m0, s33, 25600
    s_nop 0
    buffer_load_dwordx4 v12, s[64:67], s83 offen lds
    s_add_u32 s83, s83, 131072
    s_add_u32 s39, s39, 0x100000
    s_load_dword s94, s[12:13], s39 offset:0x0
    s_load_dword s94, s[12:13], s39 offset:0x40
    s_load_dword s94, s[12:13], s39 offset:0x80
    s_load_dword s94, s[12:13], s39 offset:0xc0
    s_waitcnt vmcnt(16)
    s_barrier
    s_lshl2_add_u32 m0, s33, 98304
    s_nop 0
    buffer_load_dwordx4 v10, s[56:59], s82 offen offset:0 sc1 lds
    buffer_load_dwordx4 v10, s[56:59], s82 offen offset:1024 sc1 lds
    buffer_load_dwordx4 v10, s[56:59], s82 offen offset:2048 sc1 lds
    buffer_load_dwordx4 v10, s[56:59], s82 offen offset:3072 sc1 lds
    s_add_u32 s82, s82, 16384
    s_lshl1_add_u32 m0, s33, 114688
    s_nop 0
    buffer_load_dwordx4 v11, s[60:63], s83 offen lds
    s_lshl1_add_u32 m0, s33, 115712
    s_nop 0
    buffer_load_dwordx4 v12, s[60:63], s83 offen lds
    s_lshl1_add_u32 m0, s33, 122880
    s_nop 0
    buffer_load_dwordx4 v11, s[64:67], s83 offen lds
    s_lshl1_add_u32 m0, s33, 123904
    s_nop 0
    buffer_load_dwordx4 v12, s[64:67], s83 offen lds
    s_add_u32 s83, s83, 131072
    s_load_dword s94, s[12:13], s39 offset:0x100
    s_load_dword s94, s[12:13], s39 offset:0x140
    s_load_dword s94, s[12:13], s39 offset:0x180
    s_load_dword s94, s[12:13], s39 offset:0x1c0
    s_waitcnt vmcnt(16)
    s_barrier
    s_lshl2_add_u32 m0, s33, 32768
    s_nop 0
    buffer_load_dwordx4 v10, s[56:59], s82 offen offset:0 sc1 lds
    buffer_load_dwordx4 v10, s[56:59], s82 offen offset:1024 sc1 lds
    buffer_load_dwordx4 v10, s[56:59], s82 offen offset:2048 sc1 lds
    buffer_load_dwordx4 v10, s[56:59], s82 offen offset:3072 sc1 lds
    s_add_u32 s82, s82, 16384
    s_lshl1_add_u32 m0, s33, 49152
    s_nop 0
    buffer_load_dwordx4 v11, s[60:63], s83 offen lds
    s_lshl1_add_u32 m0, s33, 50176
    s_nop 0
    buffer_load_dwordx4 v12, s[60:63], s83 offen lds
    s_lshl1_add_u32 m0, s33, 57344
    s_nop 0
    buffer_load_dwordx4 v11, s[64:67], s83 offen lds
    s_lshl1_add_u32 m0, s33, 58368
    s_nop 0
    buffer_load_dwordx4 v12, s[64:67], s83 offen lds
    s_add_u32 s83, s83, 131072
    s_load_dword s94, s[12:13], s39 offset:0x80000
    s_load_dword s94, s[12:13], s39 offset:0x80040
    s_load_dword s94, s[12:13], s39 offset:0x80080
    s_load_dword s94, s[12:13], s39 offset:0x800c0
    s_lshl2_add_u32 s91, s30, s4
    s_lshl_b32 s91, s91, 9
    s_add_u32 s91, s91, 0x1e98000
    v_lshl_add_u32 v20, v1, 7, s91
    s_mov_b64 exec, 15
    global_load_dwordx2 v[22:23], v20, s[26:27] sc1
    s_mov_b64 exec, -1
    s_waitcnt vmcnt(17)
    s_barrier
    s_lshl2_add_u32 m0, s33, 65536
    s_nop 0
    buffer_load_dwordx4 v10, s[56:59], s82 offen offset:0 sc1 lds
    buffer_load_dwordx4 v10, s[56:59], s82 offen offset:1024 sc1 lds
    buffer_load_dwordx4 v10, s[56:59], s82 offen offset:2048 sc1 lds
    buffer_load_dwordx4 v10, s[56:59], s82 offen offset:3072 sc1 lds
    s_add_u32 s82, s82, 16384
    s_lshl1_add_u32 m0, s33, 81920
    s_nop 0
    buffer_load_dwordx4 v11, s[60:63], s83 offen lds
    s_lshl1_add_u32 m0, s33, 82944
    s_nop 0
    buffer_load_dwordx4 v12, s[60:63], s83 offen lds
    s_lshl1_add_u32 m0, s33, 90112
    s_nop 0
    buffer_load_dwordx4 v11, s[64:67], s83 offen lds
    s_lshl1_add_u32 m0, s33, 91136
    s_nop 0
    buffer_load_dwordx4 v12, s[64:67], s83 offen lds
    s_add_u32 s83, s83, 131072
    s_load_dword s94, s[12:13], s39 offset:0x80100
    s_load_dword s94, s[12:13], s39 offset:0x80140
    s_load_dword s94, s[12:13], s39 offset:0x80180
    s_load_dword s94, s[12:13], s39 offset:0x801c0
    s_waitcnt vmcnt(8)
    s_mov_b64 exec, 15
    s_movk_i32 s98, 0x4000
L_pO_chk:
    v_cmp_ne_u64 vcc, s[100:101], v[22:23]
    s_nop 1
    s_cmp_eq_u64 vcc, 0
    s_cbranch_scc1 L_pO_ok
    s_sub_u32 s98, s98, 1
    s_cbranch_scc1 L_pO_ok
    s_sleep 1
    global_load_dwordx2 v[22:23], v20, s[26:27] sc1
    s_waitcnt vmcnt(0)
    s_branch L_pO_chk
L_pO_ok:
    s_mov_b64 exec, -1
    s_waitcnt vmcnt(17)
    s_barrier
    s_lshl_b32 s85, s31, 8
    s_lshl_b32 s86, s32, 7
    s_add_u32 s86, s85, s86
    s_xor_b32 s87, s86, 128
    s_add_u32 s60, s12, s86
    s_addc_u32 s61, s13, 0
    s_sub_u32 s62, 2097152, s86
    s_mov_b32 s63, 0x20000
    s_add_u32 s56, s26, 0x1200000
    s_addc_u32 s57, s27, 0
    s_mov_b32 s58, 0x400000
    s_mov_b32 s59, 0x20000
    s_lshl_b32 s82, s30, 18
    s_mov_b32 s83, 0
    s_lshl_b32 m0, s33, 2
    s_nop 0
    buffer_load_dwordx4 v10, s[56:59], s82 offen offset:0 sc1 lds
    buffer_load_dwordx4 v10, s[56:59], s82 offen offset:1024 sc1 lds
    buffer_load_dwordx4 v10, s[56:59], s82 offen offset:2048 sc1 lds
    buffer_load_dwordx4 v10, s[56:59], s82 offen offset:3072 sc1 lds
    s_add_u32 s82, s82, 16384
    s_lshl1_add_u32 m0, s33, 16384
    s_nop 0
    buffer_load_dwordx4 v11, s[60:63], s83 offen lds
    s_lshl1_add_u32 m0, s33, 17408
    s_nop 0
    buffer_load_dwordx4 v12, s[60:63], s83 offen lds
    s_add_u32 s83, s83, 131072
    s_waitcnt vmcnt(15)
    s_barrier
    s_lshl2_add_u32 m0, s33, 98304
    s_nop 0
    buffer_load_dwordx4 v10, s[56:59], s82 offen offset:0 sc1 lds
    buffer_load_dwordx4 v10, s[56:59], s82 offen offset:1024 sc1 lds
    buffer_load_dwordx4 v10, s[56:59], s82 offen offset:2048 sc1 lds
    buffer_load_dwordx4 v10, s[56:59], s82 offen offset:3072 sc1 lds
    s_add_u32 s82, s82, 16384
    s_lshl1_add_u32 m0, s33, 114688
    s_nop 0
    buffer_load_dwordx4 v11, s[60:63], s83 offen lds
    s_lshl1_add_u32 m0, s33, 115712
    s_nop 0
    buffer_load_dwordx4 v12, s[60:63], s83 offen lds
    s_add_u32 s83, s83, 131072
    s_lshl2_add_u32 m0, s33, 122880
    s_nop 0
    buffer_load_dwordx4 v10, s[56:59], s82 offen offset:0 sc1 lds
    buffer_load_dwordx4 v10, s[56:59], s82 offen offset:1024 sc1 lds
    buffer_load_dwordx4 v10, s[56:59], s82 offen offset:2048 sc1 lds
    buffer_load_dwordx4 v10, s[56:59], s82 offen offset:3072 sc1 lds
    s_add_u32 s82, s82, 16384
    s_lshl1_add_u32 m0, s33, 139264
    s_nop 0
    buffer_load_dwordx4 v11, s[60:63], s83 offen lds
    s_lshl1_add_u32 m0, s33, 140288
    s_nop 0
    buffer_load_dwordx4 v12, s[60:63], s83 offen lds
    s_add_u32 s83, s83, 131072
    s_waitcnt vmcnt(18)
    s_barrier
    s_lshl2_add_u32 m0, s33, 24576
    s_nop 0
    buffer_load_dwordx4 v10, s[56:59], s82 offen offset:0 sc1 lds
    buffer_load_dwordx4 v10, s[56:59], s82 offen offset:1024 sc1 lds
    buffer_load_dwordx4 v10, s[56:59], s82 offen offset:2048 sc1 lds
    buffer_load_dwordx4 v10, s[56:59], s82 offen offset:3072 sc1 lds
    s_add_u32 s82, s82, 16384
    s_lshl1_add_u32 m0, s33, 40960
    s_nop 0
    buffer_load_dwordx4 v11, s[60:63], s83 offen lds
    s_lshl1_add_u32 m0, s33, 41984
    s_nop 0
    buffer_load_dwordx4 v12, s[60:63], s83 offen lds
    s_add_u32 s83, s83, 131072
    s_waitcnt vmcnt(18)
    s_barrier
    s_setprio 1
    ds_read_b64_tr_b16 v[40:41], v80 offset:16384
    ds_read_b64_tr_b16 v[42:43], v80 offset:16896
    ds_read_b128 v[24:27], v48 offset:0
    ds_read_b128 v[28:31], v48 offset:1024
    ds_read_b128 v[32:35], v48 offset:2048
    ds_read_b128 v[36:39], v48 offset:3072
    ds_read_b64_tr_b16 v[44:45], v81 offset:16384
    ds_read_b64_tr_b16 v[46:47], v81 offset:16896
    s_waitcnt lgkmcnt(5)
    v_mfma_f32_16x16x32_bf16 v[88:91], v[40:43], v[24:27], v[88:91]
    ds_read_b64_tr_b16 v[72:73], v80 offset:20480
    ds_read_b64_tr_b16 v[74:75], v80 offset:20992
    s_lshl2_add_u32 m0, s33, 49152
    s_waitcnt lgkmcnt(6)
    v_mfma_f32_16x16x32_bf16 v[92:95], v[40:43], v[28:31], v[92:95]
    buffer_load_dwordx4 v10, s[56:59], s82 offen offset:0 sc1 lds
    ds_read_b128 v[56:59], v48 offset:8192
    ds_read_b128 v[60:63], v48 offset:9216
    s_waitcnt lgkmcnt(7)
    v_mfma_f32_16x16x32_bf16 v[96:99], v[40:43], v[32:35], v[96:99]
    buffer_load_dwordx4 v10, s[56:59], s82 offen offset:1024 sc1 lds
    ds_read_b128 v[64:67], v48 offset:10240
    ds_read_b128 v[68:71], v48 offset:11264
    s_waitcnt lgkmcnt(8)
    v_mfma_f32_16x16x32_bf16 v[100:103], v[40:43], v[36:39], v[100:103]
    buffer_load_dwordx4 v10, s[56:59], s82 offen offset:2048 sc1 lds
    ds_read_b64_tr_b16 v[76:77], v81 offset:20480
    ds_read_b64_tr_b16 v[78:79], v81 offset:20992
    s_waitcnt lgkmcnt(8)
    v_mfma_f32_16x16x32_bf16 v[104:107], v[44:47], v[24:27], v[104:107]
    buffer_load_dwordx4 v10, s[56:59], s82 offen offset:3072 sc1 lds
    s_add_u32 s82, s82, 16384
    s_lshl1_add_u32 m0, s33, 65536
    v_mfma_f32_16x16x32_bf16 v[108:111], v[44:47], v[28:31], v[108:111]
    buffer_load_dwordx4 v11, s[60:63], s83 offen lds
    s_lshl1_add_u32 m0, s33, 66560
    v_mfma_f32_16x16x32_bf16 v[112:115], v[44:47], v[32:35], v[112:115]
    buffer_load_dwordx4 v12, s[60:63], s83 offen lds
    s_add_u32 s83, s83, 131072
    v_mfma_f32_16x16x32_bf16 v[116:119], v[44:47], v[36:39], v[116:119]
    s_waitcnt vmcnt(18) lgkmcnt(0)
    s_barrier
    v_mfma_f32_16x16x32_bf16 v[88:91], v[72:75], v[56:59], v[88:91]
    ds_read_b64_tr_b16 v[40:41], v84 offset:16384
    ds_read_b64_tr_b16 v[42:43], v84 offset:16896
    s_lshl2_add_u32 m0, s33, 73728
    v_mfma_f32_16x16x32_bf16 v[92:95], v[72:75], v[60:63], v[92:95]
    buffer_load_dwordx4 v10, s[56:59], s82 offen offset:0 sc1 lds
    ds_read_b128 v[24:27], v50 offset:0
    ds_read_b128 v[28:31], v50 offset:1024
    v_mfma_f32_16x16x32_bf16 v[96:99], v[72:75], v[64:67], v[96:99]
    buffer_load_dwordx4 v10, s[56:59], s82 offen offset:1024 sc1 lds
    ds_read_b128 v[32:35], v50 offset:2048
    v_mfma_f32_16x16x32_bf16 v[100:103], v[72:75], v[68:71], v[100:103]
    buffer_load_dwordx4 v10, s[56:59], s82 offen offset:2048 sc1 lds
    ds_read_b128 v[36:39], v50 offset:3072
    ds_read_b64_tr_b16 v[44:45], v85 offset:16384
    v_mfma_f32_16x16x32_bf16 v[104:107], v[76:79], v[56:59], v[104:107]
    buffer_load_dwordx4 v10, s[56:59], s82 offen offset:3072 sc1 lds
    s_add_u32 s82, s82, 16384
    ds_read_b64_tr_b16 v[46:47], v85 offset:16896
    s_lshl1_add_u32 m0, s33, 90112
    v_mfma_f32_16x16x32_bf16 v[108:111], v[76:79], v[60:63], v[108:111]
    buffer_load_dwordx4 v11, s[60:63], s83 offen lds
    s_lshl1_add_u32 m0, s33, 91136
    v_mfma_f32_16x16x32_bf16 v[112:115], v[76:79], v[64:67], v[112:115]
    buffer_load_dwordx4 v12, s[60:63], s83 offen lds
    s_add_u32 s83, s83, 131072
    v_mfma_f32_16x16x32_bf16 v[116:119], v[76:79], v[68:71], v[116:119]
    s_waitcnt lgkmcnt(5)
    v_mfma_f32_16x16x32_bf16 v[88:91], v[40:43], v[24:27], v[88:91]
    ds_read_b64_tr_b16 v[72:73], v84 offset:20480
    ds_read_b64_tr_b16 v[74:75], v84 offset:20992
    s_lshl_b32 m0, s33, 2
    s_waitcnt lgkmcnt(6)
    v_mfma_f32_16x16x32_bf16 v[92:95], v[40:43], v[28:31], v[92:95]
    buffer_load_dwordx4 v10, s[56:59], s82 offen offset:0 sc1 lds
    ds_read_b128 v[56:59], v50 offset:8192
    ds_read_b128 v[60:63], v50 offset:9216
    s_waitcnt lgkmcnt(7)
    v_mfma_f32_16x16x32_bf16 v[96:99], v[40:43], v[32:35], v[96:99]
    buffer_load_dwordx4 v10, s[56:59], s82 offen offset:1024 sc1 lds
    ds_read_b128 v[64:67], v50 offset:10240
    ds_read_b128 v[68:71], v50 offset:11264
    s_waitcnt lgkmcnt(8)
    v_mfma_f32_16x16x32_bf16 v[100:103], v[40:43], v[36:39], v[100:103]
    buffer_load_dwordx4 v10, s[56:59], s82 offen offset:2048 sc1 lds
    ds_read_b64_tr_b16 v[76:77], v85 offset:20480
    ds_read_b64_tr_b16 v[78:79], v85 offset:20992
    s_waitcnt lgkmcnt(8)
    v_mfma_f32_16x16x32_bf16 v[104:107], v[44:47], v[24:27], v[104:107]
    buffer_load_dwordx4 v10, s[56:59], s82 offen offset:3072 sc1 lds
    s_add_u32 s82, s82, 16384
    s_lshl1_add_u32 m0, s33, 16384
    v_mfma_f32_16x16x32_bf16 v[108:111], v[44:47], v[28:31], v[108:111]
    buffer_load_dwordx4 v11, s[60:63], s83 offen lds
    s_lshl1_add_u32 m0, s33, 17408
    v_mfma_f32_16x16x32_bf16 v[112:115], v[44:47], v[32:35], v[112:115]
    buffer_load_dwordx4 v12, s[60:63], s83 offen lds
    s_add_u32 s83, s83, 131072
    v_mfma_f32_16x16x32_bf16 v[116:119], v[44:47], v[36:39], v[116:119]
    s_waitcnt vmcnt(24) lgkmcnt(0)
    s_barrier
    v_mfma_f32_16x16x32_bf16 v[88:91], v[72:75], v[56:59], v[88:91]
    ds_read_b64_tr_b16 v[40:41], v84 offset:40960
    ds_read_b64_tr_b16 v[42:43], v84 offset:41472
    s_lshl2_add_u32 m0, s33, 98304
    v_mfma_f32_16x16x32_bf16 v[92:95], v[72:75], v[60:63], v[92:95]
    buffer_load_dwordx4 v10, s[56:59], s82 offen offset:0 sc1 lds
    ds_read_b128 v[24:27], v50 offset:24576
    ds_read_b128 v[28:31], v50 offset:25600
    v_mfma_f32_16x16x32_bf16 v[96:99], v[72:75], v[64:67], v[96:99]
    buffer_load_dwordx4 v10, s[56:59], s82 offen offset:1024 sc1 lds
    ds_read_b128 v[32:35], v50 offset:26624
    v_mfma_f32_16x16x32_bf16 v[100:103], v[72:75], v[68:71], v[100:103]
    buffer_load_dwordx4 v10, s[56:59], s82 offen offset:2048 sc1 lds
    ds_read_b128 v[36:39], v50 offset:27648
    ds_read_b64_tr_b16 v[44:45], v85 offset:40960
    v_mfma_f32_16x16x32_bf16 v[104:107], v[76:79], v[56:59], v[104:107]
    buffer_load_dwordx4 v10, s[56:59], s82 offen offset:3072 sc1 lds
    s_add_u32 s82, s82, 16384
    ds_read_b64_tr_b16 v[46:47], v85 offset:41472
    s_lshl1_add_u32 m0, s33, 114688
    v_mfma_f32_16x16x32_bf16 v[108:111], v[76:79], v[60:63], v[108:111]
    buffer_load_dwordx4 v11, s[60:63], s83 offen lds
    s_lshl1_add_u32 m0, s33, 115712
    v_mfma_f32_16x16x32_bf16 v[112:115], v[76:79], v[64:67], v[112:115]
    buffer_load_dwordx4 v12, s[60:63], s83 offen lds
    s_add_u32 s83, s83, 131072
    v_mfma_f32_16x16x32_bf16 v[116:119], v[76:79], v[68:71], v[116:119]
    s_waitcnt lgkmcnt(5)
    v_mfma_f32_16x16x32_bf16 v[88:91], v[40:43], v[24:27], v[88:91]
    ds_read_b64_tr_b16 v[72:73], v84 offset:45056
    ds_read_b64_tr_b16 v[74:75], v84 offset:45568
    s_waitcnt lgkmcnt(6)
    v_mfma_f32_16x16x32_bf16 v[92:95], v[40:43], v[28:31], v[92:95]
    ds_read_b128 v[56:59], v50 offset:32768
    ds_read_b128 v[60:63], v50 offset:33792
    s_waitcnt lgkmcnt(7)
    v_mfma_f32_16x16x32_bf16 v[96:99], v[40:43], v[32:35], v[96:99]
    ds_read_b128 v[64:67], v50 offset:34816
    ds_read_b128 v[68:71], v50 offset:35840
    s_waitcnt lgkmcnt(8)
    v_mfma_f32_16x16x32_bf16 v[100:103], v[40:43], v[36:39], v[100:103]
    ds_read_b64_tr_b16 v[76:77], v85 offset:45056
    ds_read_b64_tr_b16 v[78:79], v85 offset:45568
    s_waitcnt lgkmcnt(8)
    v_mfma_f32_16x16x32_bf16 v[104:107], v[44:47], v[24:27], v[104:107]
    v_mfma_f32_16x16x32_bf16 v[108:111], v[44:47], v[28:31], v[108:111]
    v_mfma_f32_16x16x32_bf16 v[112:115], v[44:47], v[32:35], v[112:115]
    v_mfma_f32_16x16x32_bf16 v[116:119], v[44:47], v[36:39], v[116:119]
    s_waitcnt vmcnt(24) lgkmcnt(0)
    s_barrier
    v_mfma_f32_16x16x32_bf16 v[88:91], v[72:75], v[56:59], v[88:91]
    ds_read_b64_tr_b16 v[40:41], v80 offset:40960
    ds_read_b64_tr_b16 v[42:43], v80 offset:41472
    s_lshl2_add_u32 m0, s33, 122880
    v_mfma_f32_16x16x32_bf16 v[92:95], v[72:75], v[60:63], v[92:95]
    buffer_load_dwordx4 v10, s[56:59], s82 offen offset:0 sc1 lds
    ds_read_b128 v[24:27], v48 offset:24576
    ds_read_b128 v[28:31], v48 offset:25600
    v_mfma_f32_16x16x32_bf16 v[96:99], v[72:75], v[64:67], v[96:99]
    ds_read_b128 v[32:35], v48 offset:26624
    v_mfma_f32_16x16x32_bf16 v[100:103], v[72:75], v[68:71], v[100:103]
    buffer_load_dwordx4 v10, s[56:59], s82 offen offset:1024 sc1 lds
    ds_read_b128 v[36:39], v48 offset:27648
    ds_read_b64_tr_b16 v[44:45], v81 offset:40960
    v_mfma_f32_16x16x32_bf16 v[104:107], v[76:79], v[56:59], v[104:107]
    ds_read_b64_tr_b16 v[46:47], v81 offset:41472
    v_mfma_f32_16x16x32_bf16 v[108:111], v[76:79], v[60:63], v[108:111]
    buffer_load_dwordx4 v10, s[56:59], s82 offen offset:2048 sc1 lds
    v_mfma_f32_16x16x32_bf16 v[112:115], v[76:79], v[64:67], v[112:115]
    v_mfma_f32_16x16x32_bf16 v[116:119], v[76:79], v[68:71], v[116:119]
    s_waitcnt lgkmcnt(5)
    v_mfma_f32_16x16x32_bf16 v[88:91], v[40:43], v[24:27], v[88:91]
    ds_read_b64_tr_b16 v[72:73], v80 offset:45056
    ds_read_b64_tr_b16 v[74:75], v80 offset:45568
    s_waitcnt lgkmcnt(6)
    v_mfma_f32_16x16x32_bf16 v[92:95], v[40:43], v[28:31], v[92:95]
    buffer_load_dwordx4 v10, s[56:59], s82 offen offset:3072 sc1 lds
    s_add_u32 s82, s82, 16384
    ds_read_b128 v[56:59], v48 offset:32768
    ds_read_b128 v[60:63], v48 offset:33792
    s_waitcnt lgkmcnt(7)
    v_mfma_f32_16x16x32_bf16 v[96:99], v[40:43], v[32:35], v[96:99]
    ds_read_b128 v[64:67], v48 offset:34816
    ds_read_b128 v[68:71], v48 offset:35840
    s_lshl1_add_u32 m0, s33, 139264
    s_waitcnt lgkmcnt(8)
    v_mfma_f32_16x16x32_bf16 v[100:103], v[40:43], v[36:39], v[100:103]
    buffer_load_dwordx4 v11, s[60:63], s83 offen lds
    ds_read_b64_tr_b16 v[76:77], v81 offset:45056
    ds_read_b64_tr_b16 v[78:79], v81 offset:45568
    s_waitcnt lgkmcnt(8)
    v_mfma_f32_16x16x32_bf16 v[104:107], v[44:47], v[24:27], v[104:107]
    s_lshl1_add_u32 m0, s33, 140288
    v_mfma_f32_16x16x32_bf16 v[108:111], v[44:47], v[28:31], v[108:111]
    buffer_load_dwordx4 v12, s[60:63], s83 offen lds
    s_add_u32 s83, s83, 131072
    v_mfma_f32_16x16x32_bf16 v[112:115], v[44:47], v[32:35], v[112:115]
    v_mfma_f32_16x16x32_bf16 v[116:119], v[44:47], v[36:39], v[116:119]
    s_waitcnt vmcnt(24) lgkmcnt(0)
    s_barrier
    v_mfma_f32_16x16x32_bf16 v[88:91], v[72:75], v[56:59], v[88:91]
    ds_read_b64_tr_b16 v[40:41], v82 offset:16384
    ds_read_b64_tr_b16 v[42:43], v82 offset:16896
    s_lshl2_add_u32 m0, s33, 24576
    v_mfma_f32_16x16x32_bf16 v[92:95], v[72:75], v[60:63], v[92:95]
    buffer_load_dwordx4 v10, s[56:59], s82 offen offset:0 sc1 lds
    ds_read_b128 v[24:27], v49 offset:0
    ds_read_b128 v[28:31], v49 offset:1024
    v_mfma_f32_16x16x32_bf16 v[96:99], v[72:75], v[64:67], v[96:99]
    ds_read_b128 v[32:35], v49 offset:2048
    v_mfma_f32_16x16x32_bf16 v[100:103], v[72:75], v[68:71], v[100:103]
    buffer_load_dwordx4 v10, s[56:59], s82 offen offset:1024 sc1 lds
    ds_read_b128 v[36:39], v49 offset:3072
    ds_read_b64_tr_b16 v[44:45], v83 offset:16384
    v_mfma_f32_16x16x32_bf16 v[104:107], v[76:79], v[56:59], v[104:107]
    ds_read_b64_tr_b16 v[46:47], v83 offset:16896
    v_mfma_f32_16x16x32_bf16 v[108:111], v[76:79], v[60:63], v[108:111]
    buffer_load_dwordx4 v10, s[56:59], s82 offen offset:2048 sc1 lds
    v_mfma_f32_16x16x32_bf16 v[112:115], v[76:79], v[64:67], v[112:115]
    v_mfma_f32_16x16x32_bf16 v[116:119], v[76:79], v[68:71], v[116:119]
    s_waitcnt lgkmcnt(5)
    v_mfma_f32_16x16x32_bf16 v[88:91], v[40:43], v[24:27], v[88:91]
    ds_read_b64_tr_b16 v[72:73], v82 offset:20480
    ds_read_b64_tr_b16 v[74:75], v82 offset:20992
    s_waitcnt lgkmcnt(6)
    v_mfma_f32_16x16x32_bf16 v[92:95], v[40:43], v[28:31], v[92:95]
    buffer_load_dwordx4 v10, s[56:59], s82 offen offset:3072 sc1 lds
    s_add_u32 s82, s82, 16384
    ds_read_b128 v[56:59], v49 offset:8192
    ds_read_b128 v[60:63], v49 offset:9216
    s_waitcnt lgkmcnt(7)
    v_mfma_f32_16x16x32_bf16 v[96:99], v[40:43], v[32:35], v[96:99]
    ds_read_b128 v[64:67], v49 offset:10240
    ds_read_b128 v[68:71], v49 offset:11264
    s_lshl1_add_u32 m0, s33, 40960
    s_waitcnt lgkmcnt(8)
    v_mfma_f32_16x16x32_bf16 v[100:103], v[40:43], v[36:39], v[100:103]
    buffer_load_dwordx4 v11, s[60:63], s83 offen lds
    ds_read_b64_tr_b16 v[76:77], v83 offset:20480
    ds_read_b64_tr_b16 v[78:79], v83 offset:20992
    s_waitcnt lgkmcnt(8)
    v_mfma_f32_16x16x32_bf16 v[104:107], v[44:47], v[24:27], v[104:107]
    s_lshl1_add_u32 m0, s33, 41984
    v_mfma_f32_16x16x32_bf16 v[108:111], v[44:47], v[28:31], v[108:111]
    buffer_load_dwordx4 v12, s[60:63], s83 offen lds
    s_add_u32 s83, s83, 131072
    v_mfma_f32_16x16x32_bf16 v[112:115], v[44:47], v[32:35], v[112:115]
    v_mfma_f32_16x16x32_bf16 v[116:119], v[44:47], v[36:39], v[116:119]
    s_waitcnt vmcnt(24) lgkmcnt(0)
    s_barrier
    v_mfma_f32_16x16x32_bf16 v[88:91], v[72:75], v[56:59], v[88:91]
    ds_read_b64_tr_b16 v[40:41], v82 offset:40960
    ds_read_b64_tr_b16 v[42:43], v82 offset:41472
    s_lshl2_add_u32 m0, s33, 49152
    v_mfma_f32_16x16x32_bf16 v[92:95], v[72:75], v[60:63], v[92:95]
    buffer_load_dwordx4 v10, s[56:59], s82 offen offset:0 sc1 lds
    ds_read_b128 v[24:27], v49 offset:24576
    ds_read_b128 v[28:31], v49 offset:25600
    v_mfma_f32_16x16x32_bf16 v[96:99], v[72:75], v[64:67], v[96:99]
    ds_read_b128 v[32:35], v49 offset:26624
    v_mfma_f32_16x16x32_bf16 v[100:103], v[72:75], v[68:71], v[100:103]
    buffer_load_dwordx4 v10, s[56:59], s82 offen offset:1024 sc1 lds
    ds_read_b128 v[36:39], v49 offset:27648
    ds_read_b64_tr_b16 v[44:45], v83 offset:40960
    v_mfma_f32_16x16x32_bf16 v[104:107], v[76:79], v[56:59], v[104:107]
    ds_read_b64_tr_b16 v[46:47], v83 offset:41472
    v_mfma_f32_16x16x32_bf16 v[108:111], v[76:79], v[60:63], v[108:111]
    buffer_load_dwordx4 v10, s[56:59], s82 offen offset:2048 sc1 lds
    v_mfma_f32_16x16x32_bf16 v[112:115], v[76:79], v[64:67], v[112:115]
    v_mfma_f32_16x16x32_bf16 v[116:119], v[76:79], v[68:71], v[116:119]
    s_waitcnt lgkmcnt(5)
    v_mfma_f32_16x16x32_bf16 v[88:91], v[40:43], v[24:27], v[88:91]
    ds_read_b64_tr_b16 v[72:73], v82 offset:45056
    ds_read_b64_tr_b16 v[74:75], v82 offset:45568
    s_waitcnt lgkmcnt(6)
    v_mfma_f32_16x16x32_bf16 v[92:95], v[40:43], v[28:31], v[92:95]
    buffer_load_dwordx4 v10, s[56:59], s82 offen offset:3072 sc1 lds
    s_add_u32 s82, s82, 16384
    ds_read_b128 v[56:59], v49 offset:32768
    ds_read_b128 v[60:63], v49 offset:33792
    s_waitcnt lgkmcnt(7)
    v_mfma_f32_16x16x32_bf16 v[96:99], v[40:43], v[32:35], v[96:99]
    ds_read_b128 v[64:67], v49 offset:34816
    ds_read_b128 v[68:71], v49 offset:35840
    s_lshl1_add_u32 m0, s33, 65536
    s_waitcnt lgkmcnt(8)
    v_mfma_f32_16x16x32_bf16 v[100:103], v[40:43], v[36:39], v[100:103]
    buffer_load_dwordx4 v11, s[60:63], s83 offen lds
    ds_read_b64_tr_b16 v[76:77], v83 offset:45056
    ds_read_b64_tr_b16 v[78:79], v83 offset:45568
    s_waitcnt lgkmcnt(8)
    v_mfma_f32_16x16x32_bf16 v[104:107], v[44:47], v[24:27], v[104:107]
    s_lshl1_add_u32 m0, s33, 66560
    v_mfma_f32_16x16x32_bf16 v[108:111], v[44:47], v[28:31], v[108:111]
    buffer_load_dwordx4 v12, s[60:63], s83 offen lds
    s_add_u32 s83, s83, 131072
    v_mfma_f32_16x16x32_bf16 v[112:115], v[44:47], v[32:35], v[112:115]
    v_mfma_f32_16x16x32_bf16 v[116:119], v[44:47], v[36:39], v[116:119]
    s_waitcnt vmcnt(24) lgkmcnt(0)
    s_barrier
    v_mfma_f32_16x16x32_bf16 v[88:91], v[72:75], v[56:59], v[88:91]
    ds_read_b64_tr_b16 v[40:41], v80 offset:16384
    ds_read_b64_tr_b16 v[42:43], v80 offset:16896
    s_lshl2_add_u32 m0, s33, 73728
    v_mfma_f32_16x16x32_bf16 v[92:95], v[72:75], v[60:63], v[92:95]
    buffer_load_dwordx4 v10, s[56:59], s82 offen offset:0 sc1 lds
    ds_read_b128 v[24:27], v48 offset:0
    ds_read_b128 v[28:31], v48 offset:1024
    v_mfma_f32_16x16x32_bf16 v[96:99], v[72:75], v[64:67], v[96:99]
    ds_read_b128 v[32:35], v48 offset:2048
    v_mfma_f32_16x16x32_bf16 v[100:103], v[72:75], v[68:71], v[100:103]
    buffer_load_dwordx4 v10, s[56:59], s82 offen offset:1024 sc1 lds
    ds_read_b128 v[36:39], v48 offset:3072
    ds_read_b64_tr_b16 v[44:45], v81 offset:16384
    v_mfma_f32_16x16x32_bf16 v[104:107], v[76:79], v[56:59], v[104:107]
    ds_read_b64_tr_b16 v[46:47], v81 offset:16896
    v_mfma_f32_16x16x32_bf16 v[108:111], v[76:79], v[60:63], v[108:111]
    buffer_load_dwordx4 v10, s[56:59], s82 offen offset:2048 sc1 lds
    v_mfma_f32_16x16x32_bf16 v[112:115], v[76:79], v[64:67], v[112:115]
    v_mfma_f32_16x16x32_bf16 v[116:119], v[76:79], v[68:71], v[116:119]
    s_waitcnt lgkmcnt(5)
    v_mfma_f32_16x16x32_bf16 v[88:91], v[40:43], v[24:27], v[88:91]
    ds_read_b64_tr_b16 v[72:73], v80 offset:20480
    ds_read_b64_tr_b16 v[74:75], v80 offset:20992
    s_waitcnt lgkmcnt(6)
    v_mfma_f32_16x16x32_bf16 v[92:95], v[40:43], v[28:31], v[92:95]
    buffer_load_dwordx4 v10, s[56:59], s82 offen offset:3072 sc1 lds
    s_add_u32 s82, s82, 16384
    ds_read_b128 v[56:59], v48 offset:8192
    ds_read_b128 v[60:63], v48 offset:9216
    s_waitcnt lgkmcnt(7)
    v_mfma_f32_16x16x32_bf16 v[96:99], v[40:43], v[32:35], v[96:99]
    ds_read_b128 v[64:67], v48 offset:10240
    ds_read_b128 v[68:71], v48 offset:11264
    s_lshl1_add_u32 m0, s33, 90112
    s_waitcnt lgkmcnt(8)
    v_mfma_f32_16x16x32_bf16 v[100:103], v[40:43], v[36:39], v[100:103]
    buffer_load_dwordx4 v11, s[60:63], s83 offen lds
    ds_read_b64_tr_b16 v[76:77], v81 offset:20480
    ds_read_b64_tr_b16 v[78:79], v81 offset:20992
    s_waitcnt lgkmcnt(8)
    v_mfma_f32_16x16x32_bf16 v[104:107], v[44:47], v[24:27], v[104:107]
    s_lshl1_add_u32 m0, s33, 91136
    v_mfma_f32_16x16x32_bf16 v[108:111], v[44:47], v[28:31], v[108:111]
    buffer_load_dwordx4 v12, s[60:63], s83 offen lds
    s_add_u32 s83, s83, 131072
    v_mfma_f32_16x16x32_bf16 v[112:115], v[44:47], v[32:35], v[112:115]
    v_mfma_f32_16x16x32_bf16 v[116:119], v[44:47], v[36:39], v[116:119]
    s_waitcnt vmcnt(24) lgkmcnt(0)
    s_barrier
    v_mfma_f32_16x16x32_bf16 v[88:91], v[72:75], v[56:59], v[88:91]
    ds_read_b64_tr_b16 v[40:41], v84 offset:16384
    ds_read_b64_tr_b16 v[42:43], v84 offset:16896
    s_lshl_b32 m0, s33, 2
    v_mfma_f32_16x16x32_bf16 v[92:95], v[72:75], v[60:63], v[92:95]
    buffer_load_dwordx4 v10, s[56:59], s82 offen offset:0 sc1 lds
    ds_read_b128 v[24:27], v50 offset:0
    ds_read_b128 v[28:31], v50 offset:1024
    v_mfma_f32_16x16x32_bf16 v[96:99], v[72:75], v[64:67], v[96:99]
    ds_read_b128 v[32:35], v50 offset:2048
    v_mfma_f32_16x16x32_bf16 v[100:103], v[72:75], v[68:71], v[100:103]
    buffer_load_dwordx4 v10, s[56:59], s82 offen offset:1024 sc1 lds
    ds_read_b128 v[36:39], v50 offset:3072
    ds_read_b64_tr_b16 v[44:45], v85 offset:16384
    v_mfma_f32_16x16x32_bf16 v[104:107], v[76:79], v[56:59], v[104:107]
    ds_read_b64_tr_b16 v[46:47], v85 offset:16896
    v_mfma_f32_16x16x32_bf16 v[108:111], v[76:79], v[60:63], v[108:111]
    buffer_load_dwordx4 v10, s[56:59], s82 offen offset:2048 sc1 lds
    v_mfma_f32_16x16x32_bf16 v[112:115], v[76:79], v[64:67], v[112:115]
    v_mfma_f32_16x16x32_bf16 v[116:119], v[76:79], v[68:71], v[116:119]
    s_waitcnt lgkmcnt(5)
    v_mfma_f32_16x16x32_bf16 v[88:91], v[40:43], v[24:27], v[88:91]
    ds_read_b64_tr_b16 v[72:73], v84 offset:20480
    ds_read_b64_tr_b16 v[74:75], v84 offset:20992
    s_waitcnt lgkmcnt(6)
    v_mfma_f32_16x16x32_bf16 v[92:95], v[40:43], v[28:31], v[92:95]
    buffer_load_dwordx4 v10, s[56:59], s82 offen offset:3072 sc1 lds
    s_add_u32 s82, s82, 16384
    ds_read_b128 v[56:59], v50 offset:8192
    ds_read_b128 v[60:63], v50 offset:9216
    s_waitcnt lgkmcnt(7)
    v_mfma_f32_16x16x32_bf16 v[96:99], v[40:43], v[32:35], v[96:99]
    ds_read_b128 v[64:67], v50 offset:10240
    ds_read_b128 v[68:71], v50 offset:11264
    s_lshl1_add_u32 m0, s33, 16384
    s_waitcnt lgkmcnt(8)
    v_mfma_f32_16x16x32_bf16 v[100:103], v[40:43], v[36:39], v[100:103]
    buffer_load_dwordx4 v11, s[60:63], s83 offen lds
    ds_read_b64_tr_b16 v[76:77], v85 offset:20480
    ds_read_b64_tr_b16 v[78:79], v85 offset:20992
    s_waitcnt lgkmcnt(8)
    v_mfma_f32_16x16x32_bf16 v[104:107], v[44:47], v[24:27], v[104:107]
    s_lshl1_add_u32 m0, s33, 17408
    v_mfma_f32_16x16x32_bf16 v[108:111], v[44:47], v[28:31], v[108:111]
    buffer_load_dwordx4 v12, s[60:63], s83 offen lds
    s_add_u32 s83, s83, 131072
    v_mfma_f32_16x16x32_bf16 v[112:115], v[44:47], v[32:35], v[112:115]
    v_mfma_f32_16x16x32_bf16 v[116:119], v[44:47], v[36:39], v[116:119]
    s_waitcnt vmcnt(24) lgkmcnt(0)
    s_barrier
    v_mfma_f32_16x16x32_bf16 v[88:91], v[72:75], v[56:59], v[88:91]
    ds_read_b64_tr_b16 v[40:41], v84 offset:40960
    ds_read_b64_tr_b16 v[42:43], v84 offset:41472
    s_lshl2_add_u32 m0, s33, 98304
    v_mfma_f32_16x16x32_bf16 v[92:95], v[72:75], v[60:63], v[92:95]
    buffer_load_dwordx4 v10, s[56:59], s82 offen offset:0 sc1 lds
    ds_read_b128 v[24:27], v50 offset:24576
    ds_read_b128 v[28:31], v50 offset:25600
    v_mfma_f32_16x16x32_bf16 v[96:99], v[72:75], v[64:67], v[96:99]
    ds_read_b128 v[32:35], v50 offset:26624
    v_mfma_f32_16x16x32_bf16 v[100:103], v[72:75], v[68:71], v[100:103]
    buffer_load_dwordx4 v10, s[56:59], s82 offen offset:1024 sc1 lds
    ds_read_b128 v[36:39], v50 offset:27648
    ds_read_b64_tr_b16 v[44:45], v85 offset:40960
    v_mfma_f32_16x16x32_bf16 v[104:107], v[76:79], v[56:59], v[104:107]
    ds_read_b64_tr_b16 v[46:47], v85 offset:41472
    v_mfma_f32_16x16x32_bf16 v[108:111], v[76:79], v[60:63], v[108:111]
    buffer_load_dwordx4 v10, s[56:59], s82 offen offset:2048 sc1 lds
    v_mfma_f32_16x16x32_bf16 v[112:115], v[76:79], v[64:67], v[112:115]
    v_mfma_f32_16x16x32_bf16 v[116:119], v[76:79], v[68:71], v[116:119]
    s_waitcnt lgkmcnt(5)
    v_mfma_f32_16x16x32_bf16 v[88:91], v[40:43], v[24:27], v[88:91]
    ds_read_b64_tr_b16 v[72:73], v84 offset:45056
    ds_read_b64_tr_b16 v[74:75], v84 offset:45568
    s_waitcnt lgkmcnt(6)
    v_mfma_f32_16x16x32_bf16 v[92:95], v[40:43], v[28:31], v[92:95]
    buffer_load_dwordx4 v10, s[56:59], s82 offen offset:3072 sc1 lds
    s_add_u32 s82, s82, 16384
    ds_read_b128 v[56:59], v50 offset:32768
    ds_read_b128 v[60:63], v50 offset:33792
    s_waitcnt lgkmcnt(7)
    v_mfma_f32_16x16x32_bf16 v[96:99], v[40:43], v[32:35], v[96:99]
    ds_read_b128 v[64:67], v50 offset:34816
    ds_read_b128 v[68:71], v50 offset:35840
    s_lshl1_add_u32 m0, s33, 114688
    s_waitcnt lgkmcnt(8)
    v_mfma_f32_16x16x32_bf16 v[100:103], v[40:43], v[36:39], v[100:103]
    buffer_load_dwordx4 v11, s[60:63], s83 offen lds
    ds_read_b64_tr_b16 v[76:77], v85 offset:45056
    ds_read_b64_tr_b16 v[78:79], v85 offset:45568
    s_waitcnt lgkmcnt(8)
    v_mfma_f32_16x16x32_bf16 v[104:107], v[44:47], v[24:27], v[104:107]
    s_lshl1_add_u32 m0, s33, 115712
    v_mfma_f32_16x16x32_bf16 v[108:111], v[44:47], v[28:31], v[108:111]
    buffer_load_dwordx4 v12, s[60:63], s83 offen lds
    s_add_u32 s83, s83, 131072
    v_mfma_f32_16x16x32_bf16 v[112:115], v[44:47], v[32:35], v[112:115]
    v_mfma_f32_16x16x32_bf16 v[116:119], v[44:47], v[36:39], v[116:119]
    s_waitcnt vmcnt(24) lgkmcnt(0)
    s_barrier
    v_mfma_f32_16x16x32_bf16 v[88:91], v[72:75], v[56:59], v[88:91]
    ds_read_b64_tr_b16 v[40:41], v80 offset:40960
    ds_read_b64_tr_b16 v[42:43], v80 offset:41472
    s_lshl2_add_u32 m0, s33, 122880
    v_mfma_f32_16x16x32_bf16 v[92:95], v[72:75], v[60:63], v[92:95]
    buffer_load_dwordx4 v10, s[56:59], s82 offen offset:0 sc1 lds
    ds_read_b128 v[24:27], v48 offset:24576
    ds_read_b128 v[28:31], v48 offset:25600
    v_mfma_f32_16x16x32_bf16 v[96:99], v[72:75], v[64:67], v[96:99]
    ds_read_b128 v[32:35], v48 offset:26624
    v_mfma_f32_16x16x32_bf16 v[100:103], v[72:75], v[68:71], v[100:103]
    buffer_load_dwordx4 v10, s[56:59], s82 offen offset:1024 sc1 lds
    ds_read_b128 v[36:39], v48 offset:27648
    ds_read_b64_tr_b16 v[44:45], v81 offset:40960
    v_mfma_f32_16x16x32_bf16 v[104:107], v[76:79], v[56:59], v[104:107]
    ds_read_b64_tr_b16 v[46:47], v81 offset:41472
    v_mfma_f32_16x16x32_bf16 v[108:111], v[76:79], v[60:63], v[108:111]
    buffer_load_dwordx4 v10, s[56:59], s82 offen offset:2048 sc1 lds
    v_mfma_f32_16x16x32_bf16 v[112:115], v[76:79], v[64:67], v[112:115]
    v_mfma_f32_16x16x32_bf16 v[116:119], v[76:79], v[68:71], v[116:119]
    s_waitcnt lgkmcnt(5)
    v_mfma_f32_16x16x32_bf16 v[88:91], v[40:43], v[24:27], v[88:91]
    ds_read_b64_tr_b16 v[72:73], v80 offset:45056
    ds_read_b64_tr_b16 v[74:75], v80 offset:45568
    s_waitcnt lgkmcnt(6)
    v_mfma_f32_16x16x32_bf16 v[92:95], v[40:43], v[28:31], v[92:95]
    buffer_load_dwordx4 v10, s[56:59], s82 offen offset:3072 sc1 lds
    s_add_u32 s82, s82, 16384
    ds_read_b128 v[56:59], v48 offset:32768
    ds_read_b128 v[60:63], v48 offset:33792
    s_waitcnt lgkmcnt(7)
    v_mfma_f32_16x16x32_bf16 v[96:99], v[40:43], v[32:35], v[96:99]
    ds_read_b128 v[64:67], v48 offset:34816
    ds_read_b128 v[68:71], v48 offset:35840
    s_lshl1_add_u32 m0, s33, 139264
    s_waitcnt lgkmcnt(8)
    v_mfma_f32_16x16x32_bf16 v[100:103], v[40:43], v[36:39], v[100:103]
    buffer_load_dwordx4 v11, s[60:63], s83 offen lds
    ds_read_b64_tr_b16 v[76:77], v81 offset:45056
    ds_read_b64_tr_b16 v[78:79], v81 offset:45568
    s_waitcnt lgkmcnt(8)
    v_mfma_f32_16x16x32_bf16 v[104:107], v[44:47], v[24:27], v[104:107]
    s_lshl1_add_u32 m0, s33, 140288
    v_mfma_f32_16x16x32_bf16 v[108:111], v[44:47], v[28:31], v[108:111]
    buffer_load_dwordx4 v12, s[60:63], s83 offen lds
    s_add_u32 s83, s83, 131072
    v_mfma_f32_16x16x32_bf16 v[112:115], v[44:47], v[32:35], v[112:115]
    v_mfma_f32_16x16x32_bf16 v[116:119], v[44:47], v[36:39], v[116:119]
    s_waitcnt vmcnt(24) lgkmcnt(0)
    s_barrier
    v_mfma_f32_16x16x32_bf16 v[88:91], v[72:75], v[56:59], v[88:91]
    ds_read_b64_tr_b16 v[40:41], v82 offset:16384
    ds_read_b64_tr_b16 v[42:43], v82 offset:16896
    s_lshl2_add_u32 m0, s33, 24576
    v_mfma_f32_16x16x32_bf16 v[92:95], v[72:75], v[60:63], v[92:95]
    buffer_load_dwordx4 v10, s[56:59], s82 offen offset:0 sc1 lds
    ds_read_b128 v[24:27], v49 offset:0
    ds_read_b128 v[28:31], v49 offset:1024
    v_mfma_f32_16x16x32_bf16 v[96:99], v[72:75], v[64:67], v[96:99]
    ds_read_b128 v[32:35], v49 offset:2048
    v_mfma_f32_16x16x32_bf16 v[100:103], v[72:75], v[68:71], v[100:103]
    buffer_load_dwordx4 v10, s[56:59], s82 offen offset:1024 sc1 lds
    ds_read_b128 v[36:39], v49 offset:3072
    ds_read_b64_tr_b16 v[44:45], v83 offset:16384
    v_mfma_f32_16x16x32_bf16 v[104:107], v[76:79], v[56:59], v[104:107]
    ds_read_b64_tr_b16 v[46:47], v83 offset:16896
    v_mfma_f32_16x16x32_bf16 v[108:111], v[76:79], v[60:63], v[108:111]
    buffer_load_dwordx4 v10, s[56:59], s82 offen offset:2048 sc1 lds
    v_mfma_f32_16x16x32_bf16 v[112:115], v[76:79], v[64:67], v[112:115]
    v_mfma_f32_16x16x32_bf16 v[116:119], v[76:79], v[68:71], v[116:119]
    s_waitcnt lgkmcnt(5)
    v_mfma_f32_16x16x32_bf16 v[88:91], v[40:43], v[24:27], v[88:91]
    ds_read_b64_tr_b16 v[72:73], v82 offset:20480
    ds_read_b64_tr_b16 v[74:75], v82 offset:20992
    s_waitcnt lgkmcnt(6)
    v_mfma_f32_16x16x32_bf16 v[92:95], v[40:43], v[28:31], v[92:95]
    buffer_load_dwordx4 v10, s[56:59], s82 offen offset:3072 sc1 lds
    s_add_u32 s82, s82, 16384
    ds_read_b128 v[56:59], v49 offset:8192
    ds_read_b128 v[60:63], v49 offset:9216
    s_waitcnt lgkmcnt(7)
    v_mfma_f32_16x16x32_bf16 v[96:99], v[40:43], v[32:35], v[96:99]
    ds_read_b128 v[64:67], v49 offset:10240
    ds_read_b128 v[68:71], v49 offset:11264
    s_lshl1_add_u32 m0, s33, 40960
    s_waitcnt lgkmcnt(8)
    v_mfma_f32_16x16x32_bf16 v[100:103], v[40:43], v[36:39], v[100:103]
    buffer_load_dwordx4 v11, s[60:63], s83 offen lds
    ds_read_b64_tr_b16 v[76:77], v83 offset:20480
    ds_read_b64_tr_b16 v[78:79], v83 offset:20992
    s_waitcnt lgkmcnt(8)
    v_mfma_f32_16x16x32_bf16 v[104:107], v[44:47], v[24:27], v[104:107]
    s_lshl1_add_u32 m0, s33, 41984
    v_mfma_f32_16x16x32_bf16 v[108:111], v[44:47], v[28:31], v[108:111]
    buffer_load_dwordx4 v12, s[60:63], s83 offen lds
    s_add_u32 s83, s83, 131072
    v_mfma_f32_16x16x32_bf16 v[112:115], v[44:47], v[32:35], v[112:115]
    v_mfma_f32_16x16x32_bf16 v[116:119], v[44:47], v[36:39], v[116:119]
    s_waitcnt vmcnt(24) lgkmcnt(0)
    s_barrier
    v_mfma_f32_16x16x32_bf16 v[88:91], v[72:75], v[56:59], v[88:91]
    ds_read_b64_tr_b16 v[40:41], v82 offset:40960
    ds_read_b64_tr_b16 v[42:43], v82 offset:41472
    v_mfma_f32_16x16x32_bf16 v[92:95], v[72:75], v[60:63], v[92:95]
    ds_read_b128 v[24:27], v49 offset:24576
    ds_read_b128 v[28:31], v49 offset:25600
    v_mfma_f32_16x16x32_bf16 v[96:99], v[72:75], v[64:67], v[96:99]
    ds_read_b128 v[32:35], v49 offset:26624
    v_mfma_f32_16x16x32_bf16 v[100:103], v[72:75], v[68:71], v[100:103]
    ds_read_b128 v[36:39], v49 offset:27648
    ds_read_b64_tr_b16 v[44:45], v83 offset:40960
    v_mfma_f32_16x16x32_bf16 v[104:107], v[76:79], v[56:59], v[104:107]
    ds_read_b64_tr_b16 v[46:47], v83 offset:41472
    v_mfma_f32_16x16x32_bf16 v[108:111], v[76:79], v[60:63], v[108:111]
    v_mfma_f32_16x16x32_bf16 v[112:115], v[76:79], v[64:67], v[112:115]
    v_mfma_f32_16x16x32_bf16 v[116:119], v[76:79], v[68:71], v[116:119]
    s_waitcnt lgkmcnt(5)
    v_mfma_f32_16x16x32_bf16 v[88:91], v[40:43], v[24:27], v[88:91]
    ds_read_b64_tr_b16 v[72:73], v82 offset:45056
    ds_read_b64_tr_b16 v[74:75], v82 offset:45568
    s_waitcnt lgkmcnt(6)
    v_mfma_f32_16x16x32_bf16 v[92:95], v[40:43], v[28:31], v[92:95]
    ds_read_b128 v[56:59], v49 offset:32768
    ds_read_b128 v[60:63], v49 offset:33792
    s_waitcnt lgkmcnt(7)
    v_mfma_f32_16x16x32_bf16 v[96:99], v[40:43], v[32:35], v[96:99]
    ds_read_b128 v[64:67], v49 offset:34816
    ds_read_b128 v[68:71], v49 offset:35840
    s_waitcnt lgkmcnt(8)
    v_mfma_f32_16x16x32_bf16 v[100:103], v[40:43], v[36:39], v[100:103]
    ds_read_b64_tr_b16 v[76:77], v83 offset:45056
    ds_read_b64_tr_b16 v[78:79], v83 offset:45568
    s_waitcnt lgkmcnt(8)
    v_mfma_f32_16x16x32_bf16 v[104:107], v[44:47], v[24:27], v[104:107]
    v_mfma_f32_16x16x32_bf16 v[108:111], v[44:47], v[28:31], v[108:111]
    v_mfma_f32_16x16x32_bf16 v[112:115], v[44:47], v[32:35], v[112:115]
    v_mfma_f32_16x16x32_bf16 v[116:119], v[44:47], v[36:39], v[116:119]
    s_waitcnt vmcnt(18) lgkmcnt(0)
    s_barrier
    v_mfma_f32_16x16x32_bf16 v[88:91], v[72:75], v[56:59], v[88:91]
    ds_read_b64_tr_b16 v[40:41], v80 offset:16384
    ds_read_b64_tr_b16 v[42:43], v80 offset:16896
    v_mfma_f32_16x16x32_bf16 v[92:95], v[72:75], v[60:63], v[92:95]
    ds_read_b128 v[24:27], v48 offset:0
    ds_read_b128 v[28:31], v48 offset:1024
    v_mfma_f32_16x16x32_bf16 v[96:99], v[72:75], v[64:67], v[96:99]
    ds_read_b128 v[32:35], v48 offset:2048
    v_mfma_f32_16x16x32_bf16 v[100:103], v[72:75], v[68:71], v[100:103]
    ds_read_b128 v[36:39], v48 offset:3072
    ds_read_b64_tr_b16 v[44:45], v81 offset:16384
    v_mfma_f32_16x16x32_bf16 v[104:107], v[76:79], v[56:59], v[104:107]
    ds_read_b64_tr_b16 v[46:47], v81 offset:16896
    v_mfma_f32_16x16x32_bf16 v[108:111], v[76:79], v[60:63], v[108:111]
    v_mfma_f32_16x16x32_bf16 v[112:115], v[76:79], v[64:67], v[112:115]
    v_mfma_f32_16x16x32_bf16 v[116:119], v[76:79], v[68:71], v[116:119]
    s_waitcnt lgkmcnt(5)
    v_mfma_f32_16x16x32_bf16 v[88:91], v[40:43], v[24:27], v[88:91]
    ds_read_b64_tr_b16 v[72:73], v80 offset:20480
    ds_read_b64_tr_b16 v[74:75], v80 offset:20992
    s_waitcnt lgkmcnt(6)
    v_mfma_f32_16x16x32_bf16 v[92:95], v[40:43], v[28:31], v[92:95]
    ds_read_b128 v[56:59], v48 offset:8192
    ds_read_b128 v[60:63], v48 offset:9216
    s_waitcnt lgkmcnt(7)
    v_mfma_f32_16x16x32_bf16 v[96:99], v[40:43], v[32:35], v[96:99]
    ds_read_b128 v[64:67], v48 offset:10240
    ds_read_b128 v[68:71], v48 offset:11264
    s_waitcnt lgkmcnt(8)
    v_mfma_f32_16x16x32_bf16 v[100:103], v[40:43], v[36:39], v[100:103]
    ds_read_b64_tr_b16 v[76:77], v81 offset:20480
    ds_read_b64_tr_b16 v[78:79], v81 offset:20992
    s_waitcnt lgkmcnt(8)
    v_mfma_f32_16x16x32_bf16 v[104:107], v[44:47], v[24:27], v[104:107]
    v_mfma_f32_16x16x32_bf16 v[108:111], v[44:47], v[28:31], v[108:111]
    v_mfma_f32_16x16x32_bf16 v[112:115], v[44:47], v[32:35], v[112:115]
    v_mfma_f32_16x16x32_bf16 v[116:119], v[44:47], v[36:39], v[116:119]
    s_waitcnt vmcnt(12) lgkmcnt(0)
    s_barrier
    v_mfma_f32_16x16x32_bf16 v[88:91], v[72:75], v[56:59], v[88:91]
    ds_read_b64_tr_b16 v[40:41], v84 offset:16384
    ds_read_b64_tr_b16 v[42:43], v84 offset:16896
    v_mfma_f32_16x16x32_bf16 v[92:95], v[72:75], v[60:63], v[92:95]
    ds_read_b128 v[24:27], v50 offset:0
    ds_read_b128 v[28:31], v50 offset:1024
    v_mfma_f32_16x16x32_bf16 v[96:99], v[72:75], v[64:67], v[96:99]
    ds_read_b128 v[32:35], v50 offset:2048
    v_mfma_f32_16x16x32_bf16 v[100:103], v[72:75], v[68:71], v[100:103]
    ds_read_b128 v[36:39], v50 offset:3072
    ds_read_b64_tr_b16 v[44:45], v85 offset:16384
    v_mfma_f32_16x16x32_bf16 v[104:107], v[76:79], v[56:59], v[104:107]
    ds_read_b64_tr_b16 v[46:47], v85 offset:16896
    v_mfma_f32_16x16x32_bf16 v[108:111], v[76:79], v[60:63], v[108:111]
    v_mfma_f32_16x16x32_bf16 v[112:115], v[76:79], v[64:67], v[112:115]
    v_mfma_f32_16x16x32_bf16 v[116:119], v[76:79], v[68:71], v[116:119]
    s_waitcnt lgkmcnt(5)
    v_mfma_f32_16x16x32_bf16 v[88:91], v[40:43], v[24:27], v[88:91]
    ds_read_b64_tr_b16 v[72:73], v84 offset:20480
    ds_read_b64_tr_b16 v[74:75], v84 offset:20992
    s_waitcnt lgkmcnt(6)
    v_mfma_f32_16x16x32_bf16 v[92:95], v[40:43], v[28:31], v[92:95]
    ds_read_b128 v[56:59], v50 offset:8192
    ds_read_b128 v[60:63], v50 offset:9216
    s_waitcnt lgkmcnt(7)
    v_mfma_f32_16x16x32_bf16 v[96:99], v[40:43], v[32:35], v[96:99]
    ds_read_b128 v[64:67], v50 offset:10240
    ds_read_b128 v[68:71], v50 offset:11264
    s_waitcnt lgkmcnt(8)
    v_mfma_f32_16x16x32_bf16 v[100:103], v[40:43], v[36:39], v[100:103]
    ds_read_b64_tr_b16 v[76:77], v85 offset:20480
    ds_read_b64_tr_b16 v[78:79], v85 offset:20992
    s_waitcnt lgkmcnt(8)
    v_mfma_f32_16x16x32_bf16 v[104:107], v[44:47], v[24:27], v[104:107]
    v_mfma_f32_16x16x32_bf16 v[108:111], v[44:47], v[28:31], v[108:111]
    v_mfma_f32_16x16x32_bf16 v[112:115], v[44:47], v[32:35], v[112:115]
    v_mfma_f32_16x16x32_bf16 v[116:119], v[44:47], v[36:39], v[116:119]
    s_waitcnt vmcnt(6) lgkmcnt(0)
    s_barrier
    v_mfma_f32_16x16x32_bf16 v[88:91], v[72:75], v[56:59], v[88:91]
    ds_read_b64_tr_b16 v[40:41], v84 offset:40960
    ds_read_b64_tr_b16 v[42:43], v84 offset:41472
    v_mfma_f32_16x16x32_bf16 v[92:95], v[72:75], v[60:63], v[92:95]
    ds_read_b128 v[24:27], v50 offset:24576
    ds_read_b128 v[28:31], v50 offset:25600
    v_mfma_f32_16x16x32_bf16 v[96:99], v[72:75], v[64:67], v[96:99]
    ds_read_b128 v[32:35], v50 offset:26624
    v_mfma_f32_16x16x32_bf16 v[100:103], v[72:75], v[68:71], v[100:103]
    ds_read_b128 v[36:39], v50 offset:27648
    ds_read_b64_tr_b16 v[44:45], v85 offset:40960
    v_mfma_f32_16x16x32_bf16 v[104:107], v[76:79], v[56:59], v[104:107]
    ds_read_b64_tr_b16 v[46:47], v85 offset:41472
    v_mfma_f32_16x16x32_bf16 v[108:111], v[76:79], v[60:63], v[108:111]
    v_mfma_f32_16x16x32_bf16 v[112:115], v[76:79], v[64:67], v[112:115]
    v_mfma_f32_16x16x32_bf16 v[116:119], v[76:79], v[68:71], v[116:119]
    s_waitcnt lgkmcnt(5)
    v_mfma_f32_16x16x32_bf16 v[88:91], v[40:43], v[24:27], v[88:91]
    ds_read_b64_tr_b16 v[72:73], v84 offset:45056
    ds_read_b64_tr_b16 v[74:75], v84 offset:45568
    s_waitcnt lgkmcnt(6)
    v_mfma_f32_16x16x32_bf16 v[92:95], v[40:43], v[28:31], v[92:95]
    ds_read_b128 v[56:59], v50 offset:32768
    ds_read_b128 v[60:63], v50 offset:33792
    s_waitcnt lgkmcnt(7)
    v_mfma_f32_16x16x32_bf16 v[96:99], v[40:43], v[32:35], v[96:99]
    ds_read_b128 v[64:67], v50 offset:34816
    ds_read_b128 v[68:71], v50 offset:35840
    s_waitcnt lgkmcnt(8)
    v_mfma_f32_16x16x32_bf16 v[100:103], v[40:43], v[36:39], v[100:103]
    ds_read_b64_tr_b16 v[76:77], v85 offset:45056
    ds_read_b64_tr_b16 v[78:79], v85 offset:45568
    s_waitcnt lgkmcnt(8)
    v_mfma_f32_16x16x32_bf16 v[104:107], v[44:47], v[24:27], v[104:107]
    v_mfma_f32_16x16x32_bf16 v[108:111], v[44:47], v[28:31], v[108:111]
    v_mfma_f32_16x16x32_bf16 v[112:115], v[44:47], v[32:35], v[112:115]
    v_mfma_f32_16x16x32_bf16 v[116:119], v[44:47], v[36:39], v[116:119]
    s_waitcnt vmcnt(0) lgkmcnt(0)
    s_barrier
    v_mfma_f32_16x16x32_bf16 v[88:91], v[72:75], v[56:59], v[88:91]
    ds_read_b64_tr_b16 v[40:41], v80 offset:40960
    ds_read_b64_tr_b16 v[42:43], v80 offset:41472
    v_mfma_f32_16x16x32_bf16 v[92:95], v[72:75], v[60:63], v[92:95]
    ds_read_b128 v[24:27], v48 offset:24576
    ds_read_b128 v[28:31], v48 offset:25600
    v_mfma_f32_16x16x32_bf16 v[96:99], v[72:75], v[64:67], v[96:99]
    ds_read_b128 v[32:35], v48 offset:26624
    v_mfma_f32_16x16x32_bf16 v[100:103], v[72:75], v[68:71], v[100:103]
    ds_read_b128 v[36:39], v48 offset:27648
    ds_read_b64_tr_b16 v[44:45], v81 offset:40960
    v_mfma_f32_16x16x32_bf16 v[104:107], v[76:79], v[56:59], v[104:107]
    ds_read_b64_tr_b16 v[46:47], v81 offset:41472
    v_mfma_f32_16x16x32_bf16 v[108:111], v[76:79], v[60:63], v[108:111]
    v_mfma_f32_16x16x32_bf16 v[112:115], v[76:79], v[64:67], v[112:115]
    v_mfma_f32_16x16x32_bf16 v[116:119], v[76:79], v[68:71], v[116:119]
    s_waitcnt lgkmcnt(5)
    v_mfma_f32_16x16x32_bf16 v[88:91], v[40:43], v[24:27], v[88:91]
    ds_read_b64_tr_b16 v[72:73], v80 offset:45056
    ds_read_b64_tr_b16 v[74:75], v80 offset:45568
    s_waitcnt lgkmcnt(6)
    v_mfma_f32_16x16x32_bf16 v[92:95], v[40:43], v[28:31], v[92:95]
    ds_read_b128 v[56:59], v48 offset:32768
    ds_read_b128 v[60:63], v48 offset:33792
    s_waitcnt lgkmcnt(7)
    v_mfma_f32_16x16x32_bf16 v[96:99], v[40:43], v[32:35], v[96:99]
    ds_read_b128 v[64:67], v48 offset:34816
    ds_read_b128 v[68:71], v48 offset:35840
    s_waitcnt lgkmcnt(8)
    v_mfma_f32_16x16x32_bf16 v[100:103], v[40:43], v[36:39], v[100:103]
    ds_read_b64_tr_b16 v[76:77], v81 offset:45056
    ds_read_b64_tr_b16 v[78:79], v81 offset:45568
    s_waitcnt lgkmcnt(8)
    v_mfma_f32_16x16x32_bf16 v[104:107], v[44:47], v[24:27], v[104:107]
    v_mfma_f32_16x16x32_bf16 v[108:111], v[44:47], v[28:31], v[108:111]
    v_mfma_f32_16x16x32_bf16 v[112:115], v[44:47], v[32:35], v[112:115]
    v_mfma_f32_16x16x32_bf16 v[116:119], v[44:47], v[36:39], v[116:119]
    s_waitcnt lgkmcnt(5)
    v_mfma_f32_16x16x32_bf16 v[88:91], v[72:75], v[56:59], v[88:91]
    s_waitcnt lgkmcnt(4)
    v_mfma_f32_16x16x32_bf16 v[92:95], v[72:75], v[60:63], v[92:95]
    s_waitcnt lgkmcnt(3)
    v_mfma_f32_16x16x32_bf16 v[96:99], v[72:75], v[64:67], v[96:99]
    s_waitcnt lgkmcnt(2)
    v_mfma_f32_16x16x32_bf16 v[100:103], v[72:75], v[68:71], v[100:103]
    s_waitcnt lgkmcnt(0)
    v_mfma_f32_16x16x32_bf16 v[104:107], v[76:79], v[56:59], v[104:107]
    v_mfma_f32_16x16x32_bf16 v[108:111], v[76:79], v[60:63], v[108:111]
    v_mfma_f32_16x16x32_bf16 v[112:115], v[76:79], v[64:67], v[112:115]
    v_mfma_f32_16x16x32_bf16 v[116:119], v[76:79], v[68:71], v[116:119]
    s_barrier
    ds_read_b64 v[24:25], v3 offset:0
    ds_read_b64 v[26:27], v3 offset:512
    ds_read_b64 v[28:29], v3 offset:1024
    ds_read_b64 v[30:31], v3 offset:1536
    ds_read_b64 v[32:33], v3 offset:2048
    ds_read_b64 v[34:35], v3 offset:2560
    ds_read_b64 v[36:37], v3 offset:3072
    ds_read_b64 v[38:39], v3 offset:3584
    s_mov_b32 s72, s22
    s_mov_b32 s73, s23
    s_mov_b32 s74, 0x400000
    s_mov_b32 s75, 0x20000
    v_cvt_pk_bf16_f32 v44, v88, v89
    v_cvt_pk_bf16_f32 v45, v90, v91
    v_lshlrev_b32 v88, 16, v44
    v_and_b32 v89, 0xffff0000, v44
    v_lshlrev_b32 v90, 16, v45
    v_and_b32 v91, 0xffff0000, v45
    v_cvt_pk_bf16_f32 v44, v92, v93
    v_cvt_pk_bf16_f32 v45, v94, v95
    v_lshlrev_b32 v92, 16, v44
    v_and_b32 v93, 0xffff0000, v44
    v_lshlrev_b32 v94, 16, v45
    v_and_b32 v95, 0xffff0000, v45
    v_cvt_pk_bf16_f32 v44, v96, v97
    v_cvt_pk_bf16_f32 v45, v98, v99
    v_lshlrev_b32 v96, 16, v44
    v_and_b32 v97, 0xffff0000, v44
    v_lshlrev_b32 v98, 16, v45
    v_and_b32 v99, 0xffff0000, v45
    v_cvt_pk_bf16_f32 v44, v100, v101
    v_cvt_pk_bf16_f32 v45, v102, v103
    v_lshlrev_b32 v100, 16, v44
    v_and_b32 v101, 0xffff0000, v44
    v_lshlrev_b32 v102, 16, v45
    v_and_b32 v103, 0xffff0000, v45
    v_cvt_pk_bf16_f32 v44, v104, v105
    v_cvt_pk_bf16_f32 v45, v106, v107
    v_lshlrev_b32 v104, 16, v44
    v_and_b32 v105, 0xffff0000, v44
    v_lshlrev_b32 v106, 16, v45
    v_and_b32 v107, 0xffff0000, v45
    v_cvt_pk_bf16_f32 v44, v108, v109
    v_cvt_pk_bf16_f32 v45, v110, v111
    v_lshlrev_b32 v108, 16, v44
    v_and_b32 v109, 0xffff0000, v44
    v_lshlrev_b32 v110, 16, v45
    v_and_b32 v111, 0xffff0000, v45
    v_cvt_pk_bf16_f32 v44, v112, v113
    v_cvt_pk_bf16_f32 v45, v114, v115
    v_lshlrev_b32 v112, 16, v44
    v_and_b32 v113, 0xffff0000, v44
    v_lshlrev_b32 v114, 16, v45
    v_and_b32 v115, 0xffff0000, v45
    v_cvt_pk_bf16_f32 v44, v116, v117
    v_cvt_pk_bf16_f32 v45, v118, v119
    v_lshlrev_b32 v116, 16, v44
    v_and_b32 v117, 0xffff0000, v44
    v_lshlrev_b32 v118, 16, v45
    v_and_b32 v119, 0xffff0000, v45
    s_waitcnt lgkmcnt(0)
    v_lshlrev_b32 v40, 16, v24
    v_and_b32 v41, 0xffff0000, v24
    v_lshlrev_b32 v42, 16, v25
    v_and_b32 v43, 0xffff0000, v25
    v_mul_f32 v40, v40, v88
    v_mul_f32 v41, v41, v89
    v_mul_f32 v42, v42, v90
    v_mul_f32 v43, v43, v91
    v_cvt_pk_bf16_f32 v88, v40, v41
    v_cvt_pk_bf16_f32 v89, v42, v43
    ds_write_b64 v14, v[88:89] offset:0
    v_lshlrev_b32 v40, 16, v32
    v_and_b32 v41, 0xffff0000, v32
    v_lshlrev_b32 v42, 16, v33
    v_and_b32 v43, 0xffff0000, v33
    v_mul_f32 v40, v40, v104
    v_mul_f32 v41, v41, v105
    v_mul_f32 v42, v42, v106
    v_mul_f32 v43, v43, v107
    v_cvt_pk_bf16_f32 v104, v40, v41
    v_cvt_pk_bf16_f32 v105, v42, v43
    ds_write_b64 v15, v[104:105] offset:0
    ds_read_b128 v[48:51], v17 offset:0
    v_lshlrev_b32 v40, 16, v26
    v_and_b32 v41, 0xffff0000, v26
    v_lshlrev_b32 v42, 16, v27
    v_and_b32 v43, 0xffff0000, v27
    v_mul_f32 v40, v40, v92
    v_mul_f32 v41, v41, v93
    v_mul_f32 v42, v42, v94
    v_mul_f32 v43, v43, v95
    v_cvt_pk_bf16_f32 v92, v40, v41
    v_cvt_pk_bf16_f32 v93, v42, v43
    ds_write_b64 v14, v[92:93] offset:1024
    v_lshlrev_b32 v40, 16, v34
    v_and_b32 v41, 0xffff0000, v34
    v_lshlrev_b32 v42, 16, v35
    v_and_b32 v43, 0xffff0000, v35
    v_mul_f32 v40, v40, v108
    v_mul_f32 v41, v41, v109
    v_mul_f32 v42, v42, v110
    v_mul_f32 v43, v43, v111
    v_cvt_pk_bf16_f32 v108, v40, v41
    v_cvt_pk_bf16_f32 v109, v42, v43
    ds_write_b64 v15, v[108:109] offset:1024
    ds_read_b128 v[52:55], v17 offset:1024
    s_waitcnt lgkmcnt(3)
    v_lshlrev_b32 v40, 16, v48
    v_and_b32 v41, 0xffff0000, v48
    v_lshlrev_b32 v42, 16, v120
    v_and_b32 v43, 0xffff0000, v120
    v_add_f32 v40, v40, v42
    v_add_f32 v41, v41, v43
    v_cvt_pk_bf16_f32 v48, v40, v41
    v_lshlrev_b32 v40, 16, v49
    v_and_b32 v41, 0xffff0000, v49
    v_lshlrev_b32 v42, 16, v121
    v_and_b32 v43, 0xffff0000, v121
    v_add_f32 v40, v40, v42
    v_add_f32 v41, v41, v43
    v_cvt_pk_bf16_f32 v49, v40, v41
    v_lshlrev_b32 v40, 16, v50
    v_and_b32 v41, 0xffff0000, v50
    v_lshlrev_b32 v42, 16, v122
    v_and_b32 v43, 0xffff0000, v122
    v_add_f32 v40, v40, v42
    v_add_f32 v41, v41, v43
    v_cvt_pk_bf16_f32 v50, v40, v41
    v_lshlrev_b32 v40, 16, v51
    v_and_b32 v41, 0xffff0000, v51
    v_lshlrev_b32 v42, 16, v123
    v_and_b32 v43, 0xffff0000, v123
    v_add_f32 v40, v40, v42
    v_add_f32 v41, v41, v43
    v_cvt_pk_bf16_f32 v51, v40, v41
    s_mov_b32 s84, 0
    buffer_store_dwordx4 v[48:51], v13, s[72:75], s84 offen
    v_lshlrev_b32 v40, 16, v28
    v_and_b32 v41, 0xffff0000, v28
    v_lshlrev_b32 v42, 16, v29
    v_and_b32 v43, 0xffff0000, v29
    v_mul_f32 v40, v40, v96
    v_mul_f32 v41, v41, v97
    v_mul_f32 v42, v42, v98
    v_mul_f32 v43, v43, v99
    v_cvt_pk_bf16_f32 v96, v40, v41
    v_cvt_pk_bf16_f32 v97, v42, v43
    ds_write_b64 v14, v[96:97] offset:2048
    v_lshlrev_b32 v40, 16, v36
    v_and_b32 v41, 0xffff0000, v36
    v_lshlrev_b32 v42, 16, v37
    v_and_b32 v43, 0xffff0000, v37
    v_mul_f32 v40, v40, v112
    v_mul_f32 v41, v41, v113
    v_mul_f32 v42, v42, v114
    v_mul_f32 v43, v43, v115
    v_cvt_pk_bf16_f32 v112, v40, v41
    v_cvt_pk_bf16_f32 v113, v42, v43
    ds_write_b64 v15, v[112:113] offset:2048
    ds_read_b128 v[56:59], v17 offset:2048
    s_waitcnt lgkmcnt(3)
    v_lshlrev_b32 v40, 16, v52
    v_and_b32 v41, 0xffff0000, v52
    v_lshlrev_b32 v42, 16, v124
    v_and_b32 v43, 0xffff0000, v124
    v_add_f32 v40, v40, v42
    v_add_f32 v41, v41, v43
    v_cvt_pk_bf16_f32 v52, v40, v41
    v_lshlrev_b32 v40, 16, v53
    v_and_b32 v41, 0xffff0000, v53
    v_lshlrev_b32 v42, 16, v125
    v_and_b32 v43, 0xffff0000, v125
    v_add_f32 v40, v40, v42
    v_add_f32 v41, v41, v43
    v_cvt_pk_bf16_f32 v53, v40, v41
    v_lshlrev_b32 v40, 16, v54
    v_and_b32 v41, 0xffff0000, v54
    v_lshlrev_b32 v42, 16, v126
    v_and_b32 v43, 0xffff0000, v126
    v_add_f32 v40, v40, v42
    v_add_f32 v41, v41, v43
    v_cvt_pk_bf16_f32 v54, v40, v41
    v_lshlrev_b32 v40, 16, v55
    v_and_b32 v41, 0xffff0000, v55
    v_lshlrev_b32 v42, 16, v127
    v_and_b32 v43, 0xffff0000, v127
    v_add_f32 v40, v40, v42
    v_add_f32 v41, v41, v43
    v_cvt_pk_bf16_f32 v55, v40, v41
    s_mov_b32 s84, 32768
    buffer_store_dwordx4 v[52:55], v13, s[72:75], s84 offen
    v_lshlrev_b32 v40, 16, v30
    v_and_b32 v41, 0xffff0000, v30
    v_lshlrev_b32 v42, 16, v31
    v_and_b32 v43, 0xffff0000, v31
    v_mul_f32 v40, v40, v100
    v_mul_f32 v41, v41, v101
    v_mul_f32 v42, v42, v102
    v_mul_f32 v43, v43, v103
    v_cvt_pk_bf16_f32 v100, v40, v41
    v_cvt_pk_bf16_f32 v101, v42, v43
    ds_write_b64 v14, v[100:101] offset:3072
    v_lshlrev_b32 v40, 16, v38
    v_and_b32 v41, 0xffff0000, v38
    v_lshlrev_b32 v42, 16, v39
    v_and_b32 v43, 0xffff0000, v39
    v_mul_f32 v40, v40, v116
    v_mul_f32 v41, v41, v117
    v_mul_f32 v42, v42, v118
    v_mul_f32 v43, v43, v119
    v_cvt_pk_bf16_f32 v116, v40, v41
    v_cvt_pk_bf16_f32 v117, v42, v43
    ds_write_b64 v15, v[116:117] offset:3072
    ds_read_b128 v[60:63], v17 offset:3072
    s_waitcnt lgkmcnt(3)
    v_lshlrev_b32 v40, 16, v56
    v_and_b32 v41, 0xffff0000, v56
    v_lshlrev_b32 v42, 16, v128
    v_and_b32 v43, 0xffff0000, v128
    v_add_f32 v40, v40, v42
    v_add_f32 v41, v41, v43
    v_cvt_pk_bf16_f32 v56, v40, v41
    v_lshlrev_b32 v40, 16, v57
    v_and_b32 v41, 0xffff0000, v57
    v_lshlrev_b32 v42, 16, v129
    v_and_b32 v43, 0xffff0000, v129
    v_add_f32 v40, v40, v42
    v_add_f32 v41, v41, v43
    v_cvt_pk_bf16_f32 v57, v40, v41
    v_lshlrev_b32 v40, 16, v58
    v_and_b32 v41, 0xffff0000, v58
    v_lshlrev_b32 v42, 16, v130
    v_and_b32 v43, 0xffff0000, v130
    v_add_f32 v40, v40, v42
    v_add_f32 v41, v41, v43
    v_cvt_pk_bf16_f32 v58, v40, v41
    v_lshlrev_b32 v40, 16, v59
    v_and_b32 v41, 0xffff0000, v59
    v_lshlrev_b32 v42, 16, v131
    v_and_b32 v43, 0xffff0000, v131
    v_add_f32 v40, v40, v42
    v_add_f32 v41, v41, v43
    v_cvt_pk_bf16_f32 v59, v40, v41
    s_mov_b32 s84, 65536
    buffer_store_dwordx4 v[56:59], v13, s[72:75], s84 offen
    s_waitcnt lgkmcnt(0)
    v_lshlrev_b32 v40, 16, v60
    v_and_b32 v41, 0xffff0000, v60
    v_lshlrev_b32 v42, 16, v132
    v_and_b32 v43, 0xffff0000, v132
    v_add_f32 v40, v40, v42
    v_add_f32 v41, v41, v43
    v_cvt_pk_bf16_f32 v60, v40, v41
    v_lshlrev_b32 v40, 16, v61
    v_and_b32 v41, 0xffff0000, v61
    v_lshlrev_b32 v42, 16, v133
    v_and_b32 v43, 0xffff0000, v133
    v_add_f32 v40, v40, v42
    v_add_f32 v41, v41, v43
    v_cvt_pk_bf16_f32 v61, v40, v41
    v_lshlrev_b32 v40, 16, v62
    v_and_b32 v41, 0xffff0000, v62
    v_lshlrev_b32 v42, 16, v134
    v_and_b32 v43, 0xffff0000, v134
    v_add_f32 v40, v40, v42
    v_add_f32 v41, v41, v43
    v_cvt_pk_bf16_f32 v62, v40, v41
    v_lshlrev_b32 v40, 16, v63
    v_and_b32 v41, 0xffff0000, v63
    v_lshlrev_b32 v42, 16, v135
    v_and_b32 v43, 0xffff0000, v135
    v_add_f32 v40, v40, v42
    v_add_f32 v41, v41, v43
    v_cvt_pk_bf16_f32 v63, v40, v41
    s_mov_b32 s84, 98304
    buffer_store_dwordx4 v[60:63], v13, s[72:75], s84 offen
L_fin:
L_end:
    s_endpgm
L_code_end:
.section .rodata,"a"
.p2align 6
.amdhsa_kernel recurrent_scan__sliding_local_dilated__glu_gated_geglu__prompt_kernel
  .amdhsa_next_free_vgpr 256
  .amdhsa_next_free_sgpr 102
  .amdhsa_accum_offset 256
  .amdhsa_group_segment_fixed_size 0
  .amdhsa_kernarg_size 80
  .amdhsa_user_sgpr_count 2
  .amdhsa_user_sgpr_kernarg_segment_ptr 1
  .amdhsa_system_sgpr_workgroup_id_x 1
.end_amdhsa_kernel
```

```asm
; @launch grid=(256,1,1) block=(512,1,1) lds=163840
.amdgcn_target "amdgcn-amd-amdhsa--gfx950"
.text
.globl recurrent_scan__sliding_local_dilated__glu_gated_geglu__prompt_kernel
.p2align 8
.type recurrent_scan__sliding_local_dilated__glu_gated_geglu__prompt_kernel,@function
recurrent_scan__sliding_local_dilated__glu_gated_geglu__prompt_kernel:
    s_cmp_ge_u32 s2, 256
    s_cbranch_scc1 L_end
    s_load_dwordx4 s[8:11], s[0:1], 0
    s_load_dwordx2 s[12:13], s[0:1], 16
    s_load_dwordx4 s[16:19], s[0:1], 32
    s_load_dwordx4 s[20:23], s[0:1], 48
    s_load_dwordx4 s[24:27], s[0:1], 64
    v_lshrrev_b32 v3, 6, v0
    v_and_b32 v1, 63, v0
    v_readfirstlane_b32 s3, v3
    s_and_b32 s84, s2, 7
    s_lshr_b32 s85, s2, 3
    s_mov_b32 s15, s85
    s_and_b32 s32, s84, 1
    s_lshl_b32 s86, s32, 3
    s_and_b32 s87, s85, 7
    s_add_u32 s28, s86, s87
    s_lshr_b32 s86, s84, 1
    s_lshl_b32 s86, s86, 2
    s_lshr_b32 s87, s85, 3
    s_add_u32 s29, s86, s87
    s_lshl_b32 s87, s32, 3
    s_xor_b32 s86, s86, s87
    s_and_b32 s87, s85, 3
    s_add_u32 s30, s86, s87
    s_lshr_b32 s31, s85, 2
    s_and_b32 s4, s3, 3
    s_lshr_b32 s5, s4, 1
    s_and_b32 s6, s4, 1
    s_lshr_b32 s7, s3, 2
    s_lshl_b32 s33, s4, 10
    s_waitcnt lgkmcnt(0)
    s_mov_b32 s68, s26
    s_mov_b32 s69, s27
    s_mov_b32 s70, 0x10000000
    s_mov_b32 s71, 0x20000
    s_cmp_lg_u32 s7, 0
    s_cbranch_scc1 L_teamB
    v_lshrrev_b32 v64, 4, v1
    v_bfe_u32 v65, v1, 2, 2
    v_and_b32 v66, 3, v1
    v_and_b32 v67, 15, v1
    v_lshrrev_b32 v68, 3, v1
    v_and_b32 v69, 7, v1
    s_lshl_b32 s85, s4, 3
    s_and_b32 s86, s4, 1
    s_lshl_b32 s86, s86, 2
    v_and_b32 v70, 2, v68
    v_xor_b32 v70, v70, v69
    v_xor_b32 v70, s86, v70
    v_add_u32 v71, s85, v68
    v_mul_u32_u24 v71, 7168, v71
    v_lshl_add_u32 v22, v70, 4, v71
    v_lshrrev_b32 v71, 2, v1
    s_lshl_b32 s86, s86, 2
    v_add_u32 v71, s86, v71
    v_mul_u32_u24 v71, 7168, v71
    v_and_b32 v70, 2, v64
    v_xor_b32 v70, v70, v66
    v_lshl_add_u32 v76, v70, 4, v71
    s_mul_i32 s85, s29, 320
    s_and_b32 s86, s29, 1
    s_lshl_b32 s87, s86, 6
    s_add_u32 s87, s87, s85
    s_add_u32 s40, s16, s87
    s_addc_u32 s41, s17, 0
    s_sub_u32 s42, 7340032, s87
    s_mov_b32 s43, 0x20000
    s_add_u32 s44, s18, s87
    s_addc_u32 s45, s19, 0
    s_sub_u32 s46, 7340032, s87
    s_mov_b32 s47, 0x20000
    s_xor_b32 s86, s86, 1
    s_lshl_b32 s86, s86, 8
    s_add_u32 s87, s86, s85
    s_cmp_lt_u32 s4, 2
    s_cselect_b32 s88, s16, s18
    s_cselect_b32 s89, s17, s19
    s_add_u32 s48, s88, s87
    s_addc_u32 s49, s89, 0
    s_sub_u32 s50, 7340032, s87
    s_mov_b32 s51, 0x20000
    s_and_b32 s77, s28, 3
    s_bitcmp1_b32 s28, 3
    s_cselect_b32 s91, 4, 0
    s_add_u32 s77, s77, s91
    s_mul_i32 s77, s77, 917504
    s_add_u32 s77, s77, 0xfffc8000
    s_add_u32 m0, s33, 16384
    s_add_u32 s77, s77, 229376
    buffer_load_dwordx4 v22, s[40:43], s77 offen offset:0 lds
    s_add_u32 m0, s33, 20352
    s_nop 0
    buffer_load_dwordx4 v22, s[40:43], s77 offen offset:128 lds
    s_add_u32 m0, s33, 24576
    s_nop 0
    buffer_load_dwordx4 v22, s[44:47], s77 offen offset:0 lds
    s_add_u32 m0, s33, 28544
    s_nop 0
    buffer_load_dwordx4 v22, s[44:47], s77 offen offset:128 lds
    s_add_u32 m0, s33, 32768
    s_nop 0
    buffer_load_dwordx4 v76, s[48:51], s77 offen lds
    s_add_u32 m0, s33, 36864
    s_add_u32 s77, s77, 229376
    buffer_load_dwordx4 v22, s[40:43], s77 offen offset:0 lds
    s_add_u32 m0, s33, 40832
    s_nop 0
    buffer_load_dwordx4 v22, s[40:43], s77 offen offset:128 lds
    s_add_u32 m0, s33, 45056
    s_nop 0
    buffer_load_dwordx4 v22, s[44:47], s77 offen offset:0 lds
    s_add_u32 m0, s33, 49024
    s_nop 0
    buffer_load_dwordx4 v22, s[44:47], s77 offen offset:128 lds
    s_add_u32 m0, s33, 53248
    s_nop 0
    buffer_load_dwordx4 v76, s[48:51], s77 offen lds
    s_getpc_b64 s[92:93]
L_pc:
    s_lshl2_add_u32 s91, s15, s4
    s_lshl_b32 s91, s91, 9
    s_min_u32 s91, s91, L_code_end - L_pc - 512
    s_load_dword s94, s[92:93], s91 offset:0
    s_load_dword s94, s[92:93], s91 offset:64
    s_load_dword s94, s[92:93], s91 offset:128
    s_load_dword s94, s[92:93], s91 offset:192
    s_load_dword s94, s[92:93], s91 offset:256
    s_load_dword s94, s[92:93], s91 offset:320
    s_load_dword s94, s[92:93], s91 offset:384
    s_load_dword s94, s[92:93], s91 offset:448
    v_lshrrev_b32 v64, 4, v1
    v_bfe_u32 v65, v1, 2, 2
    v_and_b32 v66, 3, v1
    v_and_b32 v67, 15, v1
    v_lshrrev_b32 v68, 3, v1
    v_and_b32 v69, 7, v1
    s_lshl_b32 s85, s6, 12
    s_add_u32 s85, s85, 16384
    v_lshl_add_u32 v70, v64, 3, v65
    v_lshlrev_b32 v70, 7, v70
    v_and_b32 v71, 1, v66
    v_lshl_add_u32 v70, v71, 3, v70
    v_add_u32 v70, s85, v70
    v_and_b32 v71, 2, v65
    v_and_b32 v72, 1, v64
    v_lshl_add_u32 v71, v72, 2, v71
    v_lshrrev_b32 v72, 1, v66
    v_xor_b32 v71, v71, v72
    v_xor_b32 v72, 0, v71
    v_lshl_add_u32 v4, v72, 4, v70
    v_add_u32 v9, 40960, v4
    v_xor_b32 v72, 2, v71
    v_lshl_add_u32 v5, v72, 4, v70
    v_add_u32 v10, 40960, v5
    v_xor_b32 v72, 4, v71
    v_lshl_add_u32 v6, v72, 4, v70
    v_add_u32 v11, 40960, v6
    v_xor_b32 v72, 6, v71
    v_lshl_add_u32 v7, v72, 4, v70
    v_add_u32 v12, 40960, v7
    v_lshl_add_u32 v70, v64, 3, v65
    v_lshlrev_b32 v70, 6, v70
    v_and_b32 v71, 1, v66
    v_lshl_add_u32 v70, v71, 3, v70
    v_and_b32 v71, 1, v64
    v_xor_b32 v71, s6, v71
    v_lshl_add_u32 v70, v71, 5, v70
    v_lshrrev_b32 v71, 1, v66
    v_lshl_add_u32 v70, v71, 4, v70
    v_add_u32 v8, 16384, v70
    v_add_u32 v13, 57344, v70
    v_lshrrev_b32 v70, 1, v67
    v_xor_b32 v70, v70, v64
    v_lshlrev_b32 v70, 4, v70
    v_lshl_add_u32 v70, v67, 7, v70
    s_lshl_b32 s85, s5, 13
    v_add_u32 v16, s85, v70
    v_xor_b32 v17, 64, v16
    s_mov_b32 s80, 116736
    s_lshl_b32 s85, s28, 7
    s_lshl_b32 s86, s4, 5
    s_add_u32 s86, s85, s86
    v_add_u32 v71, s86, v68
    v_xor_b32 v70, v69, v64
    v_lshlrev_b32 v70, 4, v70
    v_lshl_add_u32 v20, v71, 11, v70
    v_xor_b32 v21, 64, v20
    v_add_u32 v21, 16384, v21
    s_lshl_b32 s79, s4, 12
    s_lshl_b32 s86, s28, 7
    s_sub_u32 s86, s86, 16
    s_max_i32 s86, s86, 0
    s_lshl_b32 s87, s4, 2
    v_add_u32 v71, s87, v68
    v_lshrrev_b32 v70, 1, v71
    v_and_b32 v70, 7, v70
    v_xor_b32 v70, v70, v69
    v_lshlrev_b32 v70, 4, v70
    v_add_u32 v71, s86, v71
    v_lshl_add_u32 v3, v71, 11, v70
    s_lshl_b32 s81, s4, 9
    s_lshl_b32 s85, s4, 3
    s_and_b32 s86, s4, 1
    s_lshl_b32 s86, s86, 2
    v_and_b32 v70, 2, v68
    v_xor_b32 v70, v70, v69
    v_xor_b32 v70, s86, v70
    v_add_u32 v71, s85, v68
    v_mul_u32_u24 v71, 6144, v71
    v_lshl_add_u32 v23, v70, 4, v71
    s_lshl_b32 s85, s6, 2
    v_lshl_add_u32 v70, v64, 3, v65
    v_lshlrev_b32 v70, 7, v70
    v_and_b32 v71, 1, v66
    v_lshl_add_u32 v70, v71, 3, v70
    v_add_u32 v70, 0, v70
    v_and_b32 v71, 2, v65
    v_and_b32 v72, 1, v64
    v_lshl_add_u32 v71, v72, 2, v71
    v_lshrrev_b32 v72, 1, v66
    v_xor_b32 v71, v71, v72
    v_xor_b32 v71, s85, v71
    v_xor_b32 v72, 0, v71
    v_lshl_add_u32 v250, v72, 4, v70
    v_add_u32 v252, 65536, v250
    v_xor_b32 v72, 2, v71
    v_lshl_add_u32 v251, v72, 4, v70
    v_add_u32 v253, 65536, v251
    s_lshl_b32 s85, s5, 12
    v_lshl_add_u32 v248, v1, 4, s85
    v_add_u32 v249, 65536, v248
    s_lshl_b32 s85, s4, 12
    v_lshl_add_u32 v18, v1, 4, s85
    s_lshl_b32 s85, s4, 4
    v_and_b32 v70, 2, v68
    v_xor_b32 v70, v70, v69
    v_xor_b32 v70, 0, v70
    v_add_u32 v71, s85, v68
    v_mul_u32_u24 v71, 2048, v71
    v_lshl_add_u32 v254, v70, 4, v71
    s_add_u32 s85, s85, 8
    v_and_b32 v70, 2, v68
    v_xor_b32 v70, v70, v69
    v_xor_b32 v70, 4, v70
    v_add_u32 v71, s85, v68
    v_mul_u32_u24 v71, 2048, v71
    v_lshl_add_u32 v255, v70, 4, v71
    s_lshl_b32 s85, s31, 8
    s_lshl_b32 s86, s32, 7
    s_add_u32 s86, s85, s86
    s_xor_b32 s87, s86, 128
    s_add_u32 s60, s20, s86
    s_addc_u32 s61, s21, 0
    s_sub_u32 s62, 7340032, s86
    s_mov_b32 s63, 0x20000
    s_add_u32 s64, s20, s87
    s_addc_u32 s65, s21, 0
    s_sub_u32 s66, 7340032, s87
    s_mov_b32 s67, 0x20000
    s_add_u32 s56, s26, 0x400000
    s_addc_u32 s57, s27, 0
    s_mov_b32 s58, 0xe00000
    s_mov_b32 s59, 0x20000
    s_mul_i32 s82, s30, 917504
    s_mul_i32 s85, s32, 327680
    s_add_u32 s82, s82, s85
    s_mul_i32 s83, s32, 2621440
    s_mul_i32 s85, s32, 10
    s_sub_u32 s85, 40, s85
    s_lshl_b32 s14, s85, 13
    s_lshl_b32 s35, s85, 16
    v_lshrrev_b32 v78, 4, v1
    v_and_b32 v79, 1, v78
    v_lshrrev_b32 v78, 1, v78
    v_lshlrev_b32 v78, 8, v78
    v_lshl_add_u32 v78, v79, 10, v78
    v_and_b32 v79, 15, v1
    v_lshl_add_u32 v19, v79, 4, v78
    s_mul_i32 s84, s28, 112
    s_mul_i32 s85, s29, 5
    s_add_u32 s84, s84, s85
    s_lshl_b32 s84, s84, 13
    s_lshl_b32 s85, s5, 12
    s_add_u32 s84, s84, s85
    s_add_u32 s84, s84, 0x400000
    s_and_b32 s85, s29, 1
    s_lshl1_add_u32 s86, s6, s85
    s_lshl_b32 s86, s86, 13
    s_add_u32 s72, s84, s86
    s_add_u32 s73, s72, 8192
    s_xor_b32 s85, s85, 1
    s_lshl_b32 s85, s85, 15
    s_add_u32 s84, s84, s85
    s_lshl_b32 s85, s6, 9
    s_add_u32 s74, s84, s85
    s_lshl2_add_u32 s91, s2, s4
    s_lshl_b32 s75, s91, 9
    s_lshr_b32 s92, s91, 2
    s_mul_i32 s92, s92, 7168
    s_and_b32 s91, s91, 3
    s_lshl_b32 s91, s91, 9
    s_add_u32 s92, s92, s91
    s_add_u32 s99, s92, 5120
    s_mov_b32 s36, s26
    s_mov_b32 s37, s27
    s_mov_b32 s38, 0x400000
    s_mov_b32 s39, 0x20000
    s_lshl_b32 s85, s29, 7
    s_add_u32 s40, s10, s85
    s_addc_u32 s41, s11, 0
    s_sub_u32 s42, 6291456, s85
    s_mov_b32 s43, 0x20000
    s_add_u32 s86, s85, 4096
    s_add_u32 s44, s10, s86
    s_addc_u32 s45, s11, 0
    s_sub_u32 s46, 6291456, s86
    s_mov_b32 s47, 0x20000
    s_add_u32 s86, s85, 128
    s_and_b32 s86, s86, 0x7ff
    s_add_u32 s86, s86, 5120
    s_add_u32 s48, s16, s86
    s_addc_u32 s49, s17, 0
    s_sub_u32 s50, 7340032, s86
    s_mov_b32 s51, 0x20000
    s_add_u32 s52, s18, s86
    s_addc_u32 s53, s19, 0
    s_sub_u32 s54, 7340032, s86
    s_mov_b32 s55, 0x20000
    s_mov_b64 exec, 0
    s_cmp_eq_u32 s4, 0
    s_cbranch_scc1 L_pad6
    s_cmp_eq_u32 s4, 1
    s_cbranch_scc1 L_pad7
    s_cmp_eq_u32 s4, 2
    s_cbranch_scc1 L_pad8
    s_cmp_eq_u32 s4, 3
    s_cbranch_scc1 L_pad0
L_vret0:
    s_mov_b64 exec, -1
    s_mov_b64 exec, 0
    s_cmp_eq_u32 s4, 0
    s_cbranch_scc1 L_pad9
    s_cmp_eq_u32 s4, 1
    s_cbranch_scc1 L_pad1
    s_cmp_eq_u32 s4, 2
    s_cbranch_scc1 L_pad2
    s_cmp_eq_u32 s4, 3
    s_cbranch_scc1 L_pad3
L_vret1:
    s_mov_b64 exec, -1
    s_setprio 1
    s_waitcnt vmcnt(5)
    s_barrier
    v_add_u32 v14, s80, v16
    v_add_u32 v15, s80, v17
    s_add_u32 s80, s80, 18432
    s_cmp_ge_u32 s80, 153600
    s_cselect_b32 s84, 55296, 0
    s_sub_u32 s80, s80, s84
    ds_read_b64_tr_b16 v[64:65], v4 offset:0
    ds_read_b64_tr_b16 v[66:67], v4 offset:512
    ds_read_b128 v[24:27], v14 offset:0
    ds_read_b128 v[28:31], v14 offset:2048
    ds_read_b128 v[32:35], v14 offset:4096
    ds_read_b128 v[36:39], v14 offset:6144
    ds_read_b64_tr_b16 v[68:69], v4 offset:8192
    ds_read_b64_tr_b16 v[70:71], v4 offset:8704
    ds_read_b64_tr_b16 v[72:73], v5 offset:0
    ds_read_b64_tr_b16 v[74:75], v5 offset:512
    s_waitcnt lgkmcnt(7)
    v_mfma_f32_16x16x32_bf16 v[88:91], v[64:67], v[24:27], 0
    ds_read_b64_tr_b16 v[76:77], v5 offset:8192
    s_waitcnt lgkmcnt(7)
    v_mfma_f32_16x16x32_bf16 v[92:95], v[64:67], v[28:31], 0
    ds_read_b64_tr_b16 v[78:79], v5 offset:8704
    s_waitcnt lgkmcnt(7)
    v_mfma_f32_16x16x32_bf16 v[96:99], v[64:67], v[32:35], 0
    ds_read_b64_tr_b16 v[80:81], v6 offset:0
    s_waitcnt lgkmcnt(7)
    v_mfma_f32_16x16x32_bf16 v[100:103], v[64:67], v[36:39], 0
    ds_read_b64_tr_b16 v[82:83], v6 offset:512
    s_waitcnt lgkmcnt(6)
    v_mfma_f32_16x16x32_bf16 v[104:107], v[68:71], v[24:27], 0
    ds_read_b64_tr_b16 v[64:65], v6 offset:8192
    v_mfma_f32_16x16x32_bf16 v[108:111], v[68:71], v[28:31], 0
    v_mfma_f32_16x16x32_bf16 v[112:115], v[68:71], v[32:35], 0
    ds_read_b64_tr_b16 v[66:67], v6 offset:8704
    v_mfma_f32_16x16x32_bf16 v[116:119], v[68:71], v[36:39], 0
    s_waitcnt lgkmcnt(6)
    v_mfma_f32_16x16x32_bf16 v[120:123], v[72:75], v[24:27], 0
    ds_read_b64_tr_b16 v[68:69], v7 offset:0
    v_mfma_f32_16x16x32_bf16 v[124:127], v[72:75], v[28:31], 0
    v_mfma_f32_16x16x32_bf16 v[128:131], v[72:75], v[32:35], 0
    ds_read_b64_tr_b16 v[70:71], v7 offset:512
    v_mfma_f32_16x16x32_bf16 v[132:135], v[72:75], v[36:39], 0
    s_waitcnt lgkmcnt(6)
    v_mfma_f32_16x16x32_bf16 v[136:139], v[76:79], v[24:27], 0
    ds_read_b64_tr_b16 v[72:73], v7 offset:8192
    v_mfma_f32_16x16x32_bf16 v[140:143], v[76:79], v[28:31], 0
    v_mfma_f32_16x16x32_bf16 v[144:147], v[76:79], v[32:35], 0
    ds_read_b64_tr_b16 v[74:75], v7 offset:8704
    v_mfma_f32_16x16x32_bf16 v[148:151], v[76:79], v[36:39], 0
    s_waitcnt lgkmcnt(6)
    v_mfma_f32_16x16x32_bf16 v[152:155], v[80:83], v[24:27], 0
    ds_read_b64_tr_b16 v[76:77], v8 offset:16384
    v_mfma_f32_16x16x32_bf16 v[156:159], v[80:83], v[28:31], 0
    v_mfma_f32_16x16x32_bf16 v[160:163], v[80:83], v[32:35], 0
    ds_read_b64_tr_b16 v[78:79], v8 offset:16640
    v_mfma_f32_16x16x32_bf16 v[164:167], v[80:83], v[36:39], 0
    s_waitcnt lgkmcnt(6)
    v_mfma_f32_16x16x32_bf16 v[168:171], v[64:67], v[24:27], 0
    ds_read_b64_tr_b16 v[80:81], v8 offset:18432
    v_mfma_f32_16x16x32_bf16 v[172:175], v[64:67], v[28:31], 0
    v_mfma_f32_16x16x32_bf16 v[176:179], v[64:67], v[32:35], 0
    ds_read_b64_tr_b16 v[82:83], v8 offset:18688
    v_mfma_f32_16x16x32_bf16 v[180:183], v[64:67], v[36:39], 0
    s_waitcnt lgkmcnt(6)
    v_mfma_f32_16x16x32_bf16 v[184:187], v[68:71], v[24:27], 0
    v_mfma_f32_16x16x32_bf16 v[188:191], v[68:71], v[28:31], 0
    v_mfma_f32_16x16x32_bf16 v[192:195], v[68:71], v[32:35], 0
    v_mfma_f32_16x16x32_bf16 v[196:199], v[68:71], v[36:39], 0
    s_waitcnt vmcnt(0) lgkmcnt(0)
    s_barrier
    v_mfma_f32_16x16x32_bf16 v[200:203], v[72:75], v[24:27], 0
    ds_read_b64_tr_b16 v[64:65], v4 offset:20480
    v_mfma_f32_16x16x32_bf16 v[204:207], v[72:75], v[28:31], 0
    ds_read_b64_tr_b16 v[66:67], v4 offset:20992
    v_mfma_f32_16x16x32_bf16 v[208:211], v[72:75], v[32:35], 0
    ds_read_b128 v[40:43], v15 offset:0
    v_mfma_f32_16x16x32_bf16 v[212:215], v[72:75], v[36:39], 0
    ds_read_b128 v[44:47], v15 offset:2048
    v_mfma_f32_16x16x32_bf16 v[216:219], v[76:79], v[24:27], 0
    ds_read_b128 v[48:51], v15 offset:4096
    v_mfma_f32_16x16x32_bf16 v[220:223], v[76:79], v[28:31], 0
    ds_read_b128 v[52:55], v15 offset:6144
    v_mfma_f32_16x16x32_bf16 v[224:227], v[76:79], v[32:35], 0
    ds_read_b64_tr_b16 v[68:69], v4 offset:28672
    v_mfma_f32_16x16x32_bf16 v[228:231], v[76:79], v[36:39], 0
    ds_read_b64_tr_b16 v[70:71], v4 offset:29184
    v_mfma_f32_16x16x32_bf16 v[232:235], v[80:83], v[24:27], 0
    ds_read_b64_tr_b16 v[72:73], v5 offset:20480
    v_mfma_f32_16x16x32_bf16 v[236:239], v[80:83], v[28:31], 0
    v_mfma_f32_16x16x32_bf16 v[240:243], v[80:83], v[32:35], 0
    ds_read_b64_tr_b16 v[74:75], v5 offset:20992
    v_mfma_f32_16x16x32_bf16 v[244:247], v[80:83], v[36:39], 0
    s_waitcnt lgkmcnt(7)
    v_mfma_f32_16x16x32_bf16 v[88:91], v[64:67], v[40:43], v[88:91]
    ds_read_b64_tr_b16 v[76:77], v5 offset:28672
    s_waitcnt lgkmcnt(7)
    v_mfma_f32_16x16x32_bf16 v[92:95], v[64:67], v[44:47], v[92:95]
    ds_read_b64_tr_b16 v[78:79], v5 offset:29184
    s_waitcnt lgkmcnt(7)
    v_mfma_f32_16x16x32_bf16 v[96:99], v[64:67], v[48:51], v[96:99]
    ds_read_b64_tr_b16 v[80:81], v6 offset:20480
    s_waitcnt lgkmcnt(7)
    v_mfma_f32_16x16x32_bf16 v[100:103], v[64:67], v[52:55], v[100:103]
    ds_read_b64_tr_b16 v[82:83], v6 offset:20992
    s_waitcnt lgkmcnt(6)
    v_mfma_f32_16x16x32_bf16 v[104:107], v[68:71], v[40:43], v[104:107]
    ds_read_b64_tr_b16 v[64:65], v6 offset:28672
    v_mfma_f32_16x16x32_bf16 v[108:111], v[68:71], v[44:47], v[108:111]
    v_add_u32 v14, s80, v16
    v_mfma_f32_16x16x32_bf16 v[112:115], v[68:71], v[48:51], v[112:115]
    ds_read_b64_tr_b16 v[66:67], v6 offset:29184
    v_mfma_f32_16x16x32_bf16 v[116:119], v[68:71], v[52:55], v[116:119]
    v_add_u32 v15, s80, v17
    s_waitcnt lgkmcnt(6)
    v_mfma_f32_16x16x32_bf16 v[120:123], v[72:75], v[40:43], v[120:123]
    ds_read_b64_tr_b16 v[68:69], v7 offset:20480
    v_mfma_f32_16x16x32_bf16 v[124:127], v[72:75], v[44:47], v[124:127]
    s_add_u32 s80, s80, 18432
    v_mfma_f32_16x16x32_bf16 v[128:131], v[72:75], v[48:51], v[128:131]
    ds_read_b64_tr_b16 v[70:71], v7 offset:20992
    v_mfma_f32_16x16x32_bf16 v[132:135], v[72:75], v[52:55], v[132:135]
    s_cmp_ge_u32 s80, 153600
    s_cselect_b32 s84, 55296, 0
    s_waitcnt lgkmcnt(6)
    v_mfma_f32_16x16x32_bf16 v[136:139], v[76:79], v[40:43], v[136:139]
    ds_read_b64_tr_b16 v[72:73], v7 offset:28672
    v_mfma_f32_16x16x32_bf16 v[140:143], v[76:79], v[44:47], v[140:143]
    s_sub_u32 s80, s80, s84
    v_mfma_f32_16x16x32_bf16 v[144:147], v[76:79], v[48:51], v[144:147]
    ds_read_b64_tr_b16 v[74:75], v7 offset:29184
    v_mfma_f32_16x16x32_bf16 v[148:151], v[76:79], v[52:55], v[148:151]
    s_waitcnt lgkmcnt(6)
    v_mfma_f32_16x16x32_bf16 v[152:155], v[80:83], v[40:43], v[152:155]
    ds_read_b64_tr_b16 v[76:77], v8 offset:36864
    v_mfma_f32_16x16x32_bf16 v[156:159], v[80:83], v[44:47], v[156:159]
    v_mfma_f32_16x16x32_bf16 v[160:163], v[80:83], v[48:51], v[160:163]
    ds_read_b64_tr_b16 v[78:79], v8 offset:37120
    v_mfma_f32_16x16x32_bf16 v[164:167], v[80:83], v[52:55], v[164:167]
    s_waitcnt lgkmcnt(6)
    v_mfma_f32_16x16x32_bf16 v[168:171], v[64:67], v[40:43], v[168:171]
    ds_read_b64_tr_b16 v[80:81], v8 offset:38912
    v_mfma_f32_16x16x32_bf16 v[172:175], v[64:67], v[44:47], v[172:175]
    v_mfma_f32_16x16x32_bf16 v[176:179], v[64:67], v[48:51], v[176:179]
    ds_read_b64_tr_b16 v[82:83], v8 offset:39168
    v_mfma_f32_16x16x32_bf16 v[180:183], v[64:67], v[52:55], v[180:183]
    s_waitcnt lgkmcnt(6)
    v_mfma_f32_16x16x32_bf16 v[184:187], v[68:71], v[40:43], v[184:187]
    v_mfma_f32_16x16x32_bf16 v[188:191], v[68:71], v[44:47], v[188:191]
    v_mfma_f32_16x16x32_bf16 v[192:195], v[68:71], v[48:51], v[192:195]
    v_mfma_f32_16x16x32_bf16 v[196:199], v[68:71], v[52:55], v[196:199]
    s_waitcnt lgkmcnt(0)
    s_barrier
    v_mfma_f32_16x16x32_bf16 v[200:203], v[72:75], v[40:43], v[200:203]
    ds_read_b64_tr_b16 v[64:65], v9 offset:0
    v_mfma_f32_16x16x32_bf16 v[204:207], v[72:75], v[44:47], v[204:207]
    ds_read_b64_tr_b16 v[66:67], v9 offset:512
    v_mfma_f32_16x16x32_bf16 v[208:211], v[72:75], v[48:51], v[208:211]
    ds_read_b128 v[24:27], v14 offset:0
    v_mfma_f32_16x16x32_bf16 v[212:215], v[72:75], v[52:55], v[212:215]
    ds_read_b128 v[28:31], v14 offset:2048
    v_mfma_f32_16x16x32_bf16 v[216:219], v[76:79], v[40:43], v[216:219]
    ds_read_b128 v[32:35], v14 offset:4096
    v_mfma_f32_16x16x32_bf16 v[220:223], v[76:79], v[44:47], v[220:223]
    ds_read_b128 v[36:39], v14 offset:6144
    v_mfma_f32_16x16x32_bf16 v[224:227], v[76:79], v[48:51], v[224:227]
    ds_read_b64_tr_b16 v[68:69], v9 offset:8192
    v_mfma_f32_16x16x32_bf16 v[228:231], v[76:79], v[52:55], v[228:231]
    ds_read_b64_tr_b16 v[70:71], v9 offset:8704
    v_mfma_f32_16x16x32_bf16 v[232:235], v[80:83], v[40:43], v[232:235]
    ds_read_b64_tr_b16 v[72:73], v10 offset:0
    v_mfma_f32_16x16x32_bf16 v[236:239], v[80:83], v[44:47], v[236:239]
    v_mfma_f32_16x16x32_bf16 v[240:243], v[80:83], v[48:51], v[240:243]
    ds_read_b64_tr_b16 v[74:75], v10 offset:512
    v_mfma_f32_16x16x32_bf16 v[244:247], v[80:83], v[52:55], v[244:247]
    s_waitcnt lgkmcnt(7)
    v_mfma_f32_16x16x32_bf16 v[88:91], v[64:67], v[24:27], v[88:91]
    ds_read_b64_tr_b16 v[76:77], v10 offset:8192
    s_waitcnt lgkmcnt(7)
    v_mfma_f32_16x16x32_bf16 v[92:95], v[64:67], v[28:31], v[92:95]
    ds_read_b64_tr_b16 v[78:79], v10 offset:8704
    s_waitcnt lgkmcnt(7)
    v_mfma_f32_16x16x32_bf16 v[96:99], v[64:67], v[32:35], v[96:99]
    ds_read_b64_tr_b16 v[80:81], v11 offset:0
    s_waitcnt lgkmcnt(7)
    v_mfma_f32_16x16x32_bf16 v[100:103], v[64:67], v[36:39], v[100:103]
    ds_read_b64_tr_b16 v[82:83], v11 offset:512
    s_waitcnt lgkmcnt(6)
    v_mfma_f32_16x16x32_bf16 v[104:107], v[68:71], v[24:27], v[104:107]
    ds_read_b64_tr_b16 v[64:65], v11 offset:8192
    v_mfma_f32_16x16x32_bf16 v[108:111], v[68:71], v[28:31], v[108:111]
    v_mfma_f32_16x16x32_bf16 v[112:115], v[68:71], v[32:35], v[112:115]
    ds_read_b64_tr_b16 v[66:67], v11 offset:8704
    v_mfma_f32_16x16x32_bf16 v[116:119], v[68:71], v[36:39], v[116:119]
    s_waitcnt lgkmcnt(6)
    v_mfma_f32_16x16x32_bf16 v[120:123], v[72:75], v[24:27], v[120:123]
    ds_read_b64_tr_b16 v[68:69], v12 offset:0
    v_mfma_f32_16x16x32_bf16 v[124:127], v[72:75], v[28:31], v[124:127]
    v_mfma_f32_16x16x32_bf16 v[128:131], v[72:75], v[32:35], v[128:131]
    ds_read_b64_tr_b16 v[70:71], v12 offset:512
    v_mfma_f32_16x16x32_bf16 v[132:135], v[72:75], v[36:39], v[132:135]
    s_waitcnt lgkmcnt(6)
    v_mfma_f32_16x16x32_bf16 v[136:139], v[76:79], v[24:27], v[136:139]
    ds_read_b64_tr_b16 v[72:73], v12 offset:8192
    v_mfma_f32_16x16x32_bf16 v[140:143], v[76:79], v[28:31], v[140:143]
    v_mfma_f32_16x16x32_bf16 v[144:147], v[76:79], v[32:35], v[144:147]
    ds_read_b64_tr_b16 v[74:75], v12 offset:8704
    v_mfma_f32_16x16x32_bf16 v[148:151], v[76:79], v[36:39], v[148:151]
    s_waitcnt lgkmcnt(6)
    v_mfma_f32_16x16x32_bf16 v[152:155], v[80:83], v[24:27], v[152:155]
    ds_read_b64_tr_b16 v[76:77], v13 offset:16384
    v_mfma_f32_16x16x32_bf16 v[156:159], v[80:83], v[28:31], v[156:159]
    v_mfma_f32_16x16x32_bf16 v[160:163], v[80:83], v[32:35], v[160:163]
    ds_read_b64_tr_b16 v[78:79], v13 offset:16640
    v_mfma_f32_16x16x32_bf16 v[164:167], v[80:83], v[36:39], v[164:167]
    s_waitcnt lgkmcnt(6)
    v_mfma_f32_16x16x32_bf16 v[168:171], v[64:67], v[24:27], v[168:171]
    ds_read_b64_tr_b16 v[80:81], v13 offset:18432
    v_mfma_f32_16x16x32_bf16 v[172:175], v[64:67], v[28:31], v[172:175]
    v_mfma_f32_16x16x32_bf16 v[176:179], v[64:67], v[32:35], v[176:179]
    ds_read_b64_tr_b16 v[82:83], v13 offset:18688
    v_mfma_f32_16x16x32_bf16 v[180:183], v[64:67], v[36:39], v[180:183]
    s_waitcnt lgkmcnt(6)
    v_mfma_f32_16x16x32_bf16 v[184:187], v[68:71], v[24:27], v[184:187]
    v_mfma_f32_16x16x32_bf16 v[188:191], v[68:71], v[28:31], v[188:191]
    v_mfma_f32_16x16x32_bf16 v[192:195], v[68:71], v[32:35], v[192:195]
    v_mfma_f32_16x16x32_bf16 v[196:199], v[68:71], v[36:39], v[196:199]
    s_waitcnt lgkmcnt(0)
    s_barrier
    v_mfma_f32_16x16x32_bf16 v[200:203], v[72:75], v[24:27], v[200:203]
    ds_read_b64_tr_b16 v[64:65], v9 offset:20480
    v_mfma_f32_16x16x32_bf16 v[204:207], v[72:75], v[28:31], v[204:207]
    ds_read_b64_tr_b16 v[66:67], v9 offset:20992
    v_mfma_f32_16x16x32_bf16 v[208:211], v[72:75], v[32:35], v[208:211]
    ds_read_b128 v[40:43], v15 offset:0
    v_mfma_f32_16x16x32_bf16 v[212:215], v[72:75], v[36:39], v[212:215]
    ds_read_b128 v[44:47], v15 offset:2048
    v_mfma_f32_16x16x32_bf16 v[216:219], v[76:79], v[24:27], v[216:219]
    ds_read_b128 v[48:51], v15 offset:4096
    v_mfma_f32_16x16x32_bf16 v[220:223], v[76:79], v[28:31], v[220:223]
    ds_read_b128 v[52:55], v15 offset:6144
    v_mfma_f32_16x16x32_bf16 v[224:227], v[76:79], v[32:35], v[224:227]
    ds_read_b64_tr_b16 v[68:69], v9 offset:28672
    v_mfma_f32_16x16x32_bf16 v[228:231], v[76:79], v[36:39], v[228:231]
    ds_read_b64_tr_b16 v[70:71], v9 offset:29184
    v_mfma_f32_16x16x32_bf16 v[232:235], v[80:83], v[24:27], v[232:235]
    ds_read_b64_tr_b16 v[72:73], v10 offset:20480
    v_mfma_f32_16x16x32_bf16 v[236:239], v[80:83], v[28:31], v[236:239]
    v_mfma_f32_16x16x32_bf16 v[240:243], v[80:83], v[32:35], v[240:243]
    ds_read_b64_tr_b16 v[74:75], v10 offset:20992
    v_mfma_f32_16x16x32_bf16 v[244:247], v[80:83], v[36:39], v[244:247]
    s_waitcnt lgkmcnt(7)
    v_mfma_f32_16x16x32_bf16 v[88:91], v[64:67], v[40:43], v[88:91]
    ds_read_b64_tr_b16 v[76:77], v10 offset:28672
    s_waitcnt lgkmcnt(7)
    v_mfma_f32_16x16x32_bf16 v[92:95], v[64:67], v[44:47], v[92:95]
    ds_read_b64_tr_b16 v[78:79], v10 offset:29184
    s_waitcnt lgkmcnt(7)
    v_mfma_f32_16x16x32_bf16 v[96:99], v[64:67], v[48:51], v[96:99]
    ds_read_b64_tr_b16 v[80:81], v11 offset:20480
    s_waitcnt lgkmcnt(7)
    v_mfma_f32_16x16x32_bf16 v[100:103], v[64:67], v[52:55], v[100:103]
    ds_read_b64_tr_b16 v[82:83], v11 offset:20992
    s_waitcnt lgkmcnt(6)
    v_mfma_f32_16x16x32_bf16 v[104:107], v[68:71], v[40:43], v[104:107]
    ds_read_b64_tr_b16 v[64:65], v11 offset:28672
    v_mfma_f32_16x16x32_bf16 v[108:111], v[68:71], v[44:47], v[108:111]
    v_add_u32 v14, s80, v16
    v_mfma_f32_16x16x32_bf16 v[112:115], v[68:71], v[48:51], v[112:115]
    ds_read_b64_tr_b16 v[66:67], v11 offset:29184
    v_mfma_f32_16x16x32_bf16 v[116:119], v[68:71], v[52:55], v[116:119]
    v_add_u32 v15, s80, v17
    s_waitcnt lgkmcnt(6)
    v_mfma_f32_16x16x32_bf16 v[120:123], v[72:75], v[40:43], v[120:123]
    ds_read_b64_tr_b16 v[68:69], v12 offset:20480
    v_mfma_f32_16x16x32_bf16 v[124:127], v[72:75], v[44:47], v[124:127]
    s_add_u32 s80, s80, 18432
    v_mfma_f32_16x16x32_bf16 v[128:131], v[72:75], v[48:51], v[128:131]
    ds_read_b64_tr_b16 v[70:71], v12 offset:20992
    v_mfma_f32_16x16x32_bf16 v[132:135], v[72:75], v[52:55], v[132:135]
    s_cmp_ge_u32 s80, 153600
    s_cselect_b32 s84, 55296, 0
    s_waitcnt lgkmcnt(6)
    v_mfma_f32_16x16x32_bf16 v[136:139], v[76:79], v[40:43], v[136:139]
    ds_read_b64_tr_b16 v[72:73], v12 offset:28672
    v_mfma_f32_16x16x32_bf16 v[140:143], v[76:79], v[44:47], v[140:143]
    s_sub_u32 s80, s80, s84
    v_mfma_f32_16x16x32_bf16 v[144:147], v[76:79], v[48:51], v[144:147]
    ds_read_b64_tr_b16 v[74:75], v12 offset:29184
    v_mfma_f32_16x16x32_bf16 v[148:151], v[76:79], v[52:55], v[148:151]
    s_waitcnt lgkmcnt(6)
    v_mfma_f32_16x16x32_bf16 v[152:155], v[80:83], v[40:43], v[152:155]
    ds_read_b64_tr_b16 v[76:77], v13 offset:36864
    v_mfma_f32_16x16x32_bf16 v[156:159], v[80:83], v[44:47], v[156:159]
    v_mfma_f32_16x16x32_bf16 v[160:163], v[80:83], v[48:51], v[160:163]
    ds_read_b64_tr_b16 v[78:79], v13 offset:37120
    v_mfma_f32_16x16x32_bf16 v[164:167], v[80:83], v[52:55], v[164:167]
    s_waitcnt lgkmcnt(6)
    v_mfma_f32_16x16x32_bf16 v[168:171], v[64:67], v[40:43], v[168:171]
    ds_read_b64_tr_b16 v[80:81], v13 offset:38912
    v_mfma_f32_16x16x32_bf16 v[172:175], v[64:67], v[44:47], v[172:175]
    v_mfma_f32_16x16x32_bf16 v[176:179], v[64:67], v[48:51], v[176:179]
    ds_read_b64_tr_b16 v[82:83], v13 offset:39168
    v_mfma_f32_16x16x32_bf16 v[180:183], v[64:67], v[52:55], v[180:183]
    s_waitcnt lgkmcnt(6)
    v_mfma_f32_16x16x32_bf16 v[184:187], v[68:71], v[40:43], v[184:187]
    v_mfma_f32_16x16x32_bf16 v[188:191], v[68:71], v[44:47], v[188:191]
    v_mfma_f32_16x16x32_bf16 v[192:195], v[68:71], v[48:51], v[192:195]
    v_mfma_f32_16x16x32_bf16 v[196:199], v[68:71], v[52:55], v[196:199]
    s_waitcnt lgkmcnt(0)
    s_barrier
    v_mfma_f32_16x16x32_bf16 v[200:203], v[72:75], v[40:43], v[200:203]
    ds_read_b64_tr_b16 v[64:65], v4 offset:0
    v_mfma_f32_16x16x32_bf16 v[204:207], v[72:75], v[44:47], v[204:207]
    ds_read_b64_tr_b16 v[66:67], v4 offset:512
    v_mfma_f32_16x16x32_bf16 v[208:211], v[72:75], v[48:51], v[208:211]
    ds_read_b128 v[24:27], v14 offset:0
    v_mfma_f32_16x16x32_bf16 v[212:215], v[72:75], v[52:55], v[212:215]
    ds_read_b128 v[28:31], v14 offset:2048
    v_mfma_f32_16x16x32_bf16 v[216:219], v[76:79], v[40:43], v[216:219]
    ds_read_b128 v[32:35], v14 offset:4096
    v_mfma_f32_16x16x32_bf16 v[220:223], v[76:79], v[44:47], v[220:223]
    ds_read_b128 v[36:39], v14 offset:6144
    v_mfma_f32_16x16x32_bf16 v[224:227], v[76:79], v[48:51], v[224:227]
    ds_read_b64_tr_b16 v[68:69], v4 offset:8192
    v_mfma_f32_16x16x32_bf16 v[228:231], v[76:79], v[52:55], v[228:231]
    ds_read_b64_tr_b16 v[70:71], v4 offset:8704
    v_mfma_f32_16x16x32_bf16 v[232:235], v[80:83], v[40:43], v[232:235]
    ds_read_b64_tr_b16 v[72:73], v5 offset:0
    v_mfma_f32_16x16x32_bf16 v[236:239], v[80:83], v[44:47], v[236:239]
    v_mfma_f32_16x16x32_bf16 v[240:243], v[80:83], v[48:51], v[240:243]
    ds_read_b64_tr_b16 v[74:75], v5 offset:512
    v_mfma_f32_16x16x32_bf16 v[244:247], v[80:83], v[52:55], v[244:247]
    s_or_b32 s91, s2, s4
    s_cbranch_scc1 L_notok
    s_memrealtime s[92:93]
    v_mov_b32 v60, 0
    s_waitcnt lgkmcnt(0)
    s_or_b32 s92, s92, 1
    v_mov_b32 v62, s92
    v_mov_b32 v63, s93
    s_mov_b64 exec, 1
    global_store_dwordx2 v60, v[62:63], s[24:25] sc1
    s_mov_b64 exec, -1
L_notok:
    s_mov_b32 s34, 6
.p2align 6
L_p1:
    s_waitcnt lgkmcnt(7)
    v_mfma_f32_16x16x32_bf16 v[88:91], v[64:67], v[24:27], v[88:91]
    ds_read_b64_tr_b16 v[76:77], v5 offset:8192
    s_waitcnt lgkmcnt(7)
    v_mfma_f32_16x16x32_bf16 v[92:95], v[64:67], v[28:31], v[92:95]
    ds_read_b64_tr_b16 v[78:79], v5 offset:8704
    s_waitcnt lgkmcnt(7)
    v_mfma_f32_16x16x32_bf16 v[96:99], v[64:67], v[32:35], v[96:99]
    ds_read_b64_tr_b16 v[80:81], v6 offset:0
    s_waitcnt lgkmcnt(7)
    v_mfma_f32_16x16x32_bf16 v[100:103], v[64:67], v[36:39], v[100:103]
    ds_read_b64_tr_b16 v[82:83], v6 offset:512
    s_waitcnt lgkmcnt(6)
    v_mfma_f32_16x16x32_bf16 v[104:107], v[68:71], v[24:27], v[104:107]
    ds_read_b64_tr_b16 v[64:65], v6 offset:8192
    v_mfma_f32_16x16x32_bf16 v[108:111], v[68:71], v[28:31], v[108:111]
    v_mfma_f32_16x16x32_bf16 v[112:115], v[68:71], v[32:35], v[112:115]
    ds_read_b64_tr_b16 v[66:67], v6 offset:8704
    v_mfma_f32_16x16x32_bf16 v[116:119], v[68:71], v[36:39], v[116:119]
    s_waitcnt lgkmcnt(6)
    v_mfma_f32_16x16x32_bf16 v[120:123], v[72:75], v[24:27], v[120:123]
    ds_read_b64_tr_b16 v[68:69], v7 offset:0
    v_mfma_f32_16x16x32_bf16 v[124:127], v[72:75], v[28:31], v[124:127]
    v_mfma_f32_16x16x32_bf16 v[128:131], v[72:75], v[32:35], v[128:131]
    ds_read_b64_tr_b16 v[70:71], v7 offset:512
    v_mfma_f32_16x16x32_bf16 v[132:135], v[72:75], v[36:39], v[132:135]
    s_waitcnt lgkmcnt(6)
    v_mfma_f32_16x16x32_bf16 v[136:139], v[76:79], v[24:27], v[136:139]
    ds_read_b64_tr_b16 v[72:73], v7 offset:8192
    v_mfma_f32_16x16x32_bf16 v[140:143], v[76:79], v[28:31], v[140:143]
    v_mfma_f32_16x16x32_bf16 v[144:147], v[76:79], v[32:35], v[144:147]
    ds_read_b64_tr_b16 v[74:75], v7 offset:8704
    v_mfma_f32_16x16x32_bf16 v[148:151], v[76:79], v[36:39], v[148:151]
    s_waitcnt lgkmcnt(6)
    v_mfma_f32_16x16x32_bf16 v[152:155], v[80:83], v[24:27], v[152:155]
    ds_read_b64_tr_b16 v[76:77], v8 offset:16384
    v_mfma_f32_16x16x32_bf16 v[156:159], v[80:83], v[28:31], v[156:159]
    v_mfma_f32_16x16x32_bf16 v[160:163], v[80:83], v[32:35], v[160:163]
    ds_read_b64_tr_b16 v[78:79], v8 offset:16640
    v_mfma_f32_16x16x32_bf16 v[164:167], v[80:83], v[36:39], v[164:167]
    s_waitcnt lgkmcnt(6)
    v_mfma_f32_16x16x32_bf16 v[168:171], v[64:67], v[24:27], v[168:171]
    ds_read_b64_tr_b16 v[80:81], v8 offset:18432
    v_mfma_f32_16x16x32_bf16 v[172:175], v[64:67], v[28:31], v[172:175]
    v_mfma_f32_16x16x32_bf16 v[176:179], v[64:67], v[32:35], v[176:179]
    ds_read_b64_tr_b16 v[82:83], v8 offset:18688
    v_mfma_f32_16x16x32_bf16 v[180:183], v[64:67], v[36:39], v[180:183]
    s_waitcnt lgkmcnt(6)
    v_mfma_f32_16x16x32_bf16 v[184:187], v[68:71], v[24:27], v[184:187]
    v_mfma_f32_16x16x32_bf16 v[188:191], v[68:71], v[28:31], v[188:191]
    v_mfma_f32_16x16x32_bf16 v[192:195], v[68:71], v[32:35], v[192:195]
    v_mfma_f32_16x16x32_bf16 v[196:199], v[68:71], v[36:39], v[196:199]
    s_waitcnt lgkmcnt(0)
    s_barrier
    v_mfma_f32_16x16x32_bf16 v[200:203], v[72:75], v[24:27], v[200:203]
    ds_read_b64_tr_b16 v[64:65], v4 offset:20480
    v_mfma_f32_16x16x32_bf16 v[204:207], v[72:75], v[28:31], v[204:207]
    ds_read_b64_tr_b16 v[66:67], v4 offset:20992
    v_mfma_f32_16x16x32_bf16 v[208:211], v[72:75], v[32:35], v[208:211]
    ds_read_b128 v[40:43], v15 offset:0
    v_mfma_f32_16x16x32_bf16 v[212:215], v[72:75], v[36:39], v[212:215]
    ds_read_b128 v[44:47], v15 offset:2048
    v_mfma_f32_16x16x32_bf16 v[216:219], v[76:79], v[24:27], v[216:219]
    ds_read_b128 v[48:51], v15 offset:4096
    v_mfma_f32_16x16x32_bf16 v[220:223], v[76:79], v[28:31], v[220:223]
    ds_read_b128 v[52:55], v15 offset:6144
    v_mfma_f32_16x16x32_bf16 v[224:227], v[76:79], v[32:35], v[224:227]
    ds_read_b64_tr_b16 v[68:69], v4 offset:28672
    v_mfma_f32_16x16x32_bf16 v[228:231], v[76:79], v[36:39], v[228:231]
    ds_read_b64_tr_b16 v[70:71], v4 offset:29184
    v_mfma_f32_16x16x32_bf16 v[232:235], v[80:83], v[24:27], v[232:235]
    ds_read_b64_tr_b16 v[72:73], v5 offset:20480
    v_mfma_f32_16x16x32_bf16 v[236:239], v[80:83], v[28:31], v[236:239]
    v_mfma_f32_16x16x32_bf16 v[240:243], v[80:83], v[32:35], v[240:243]
    ds_read_b64_tr_b16 v[74:75], v5 offset:20992
    v_mfma_f32_16x16x32_bf16 v[244:247], v[80:83], v[36:39], v[244:247]
    s_waitcnt lgkmcnt(7)
    v_mfma_f32_16x16x32_bf16 v[88:91], v[64:67], v[40:43], v[88:91]
    ds_read_b64_tr_b16 v[76:77], v5 offset:28672
    s_waitcnt lgkmcnt(7)
    v_mfma_f32_16x16x32_bf16 v[92:95], v[64:67], v[44:47], v[92:95]
    ds_read_b64_tr_b16 v[78:79], v5 offset:29184
    s_waitcnt lgkmcnt(7)
    v_mfma_f32_16x16x32_bf16 v[96:99], v[64:67], v[48:51], v[96:99]
    ds_read_b64_tr_b16 v[80:81], v6 offset:20480
    s_waitcnt lgkmcnt(7)
    v_mfma_f32_16x16x32_bf16 v[100:103], v[64:67], v[52:55], v[100:103]
    ds_read_b64_tr_b16 v[82:83], v6 offset:20992
    s_waitcnt lgkmcnt(6)
    v_mfma_f32_16x16x32_bf16 v[104:107], v[68:71], v[40:43], v[104:107]
    ds_read_b64_tr_b16 v[64:65], v6 offset:28672
    v_mfma_f32_16x16x32_bf16 v[108:111], v[68:71], v[44:47], v[108:111]
    v_add_u32 v14, s80, v16
    v_mfma_f32_16x16x32_bf16 v[112:115], v[68:71], v[48:51], v[112:115]
    ds_read_b64_tr_b16 v[66:67], v6 offset:29184
    v_mfma_f32_16x16x32_bf16 v[116:119], v[68:71], v[52:55], v[116:119]
    v_add_u32 v15, s80, v17
    s_waitcnt lgkmcnt(6)
    v_mfma_f32_16x16x32_bf16 v[120:123], v[72:75], v[40:43], v[120:123]
    ds_read_b64_tr_b16 v[68:69], v7 offset:20480
    v_mfma_f32_16x16x32_bf16 v[124:127], v[72:75], v[44:47], v[124:127]
    s_add_u32 s80, s80, 18432
    v_mfma_f32_16x16x32_bf16 v[128:131], v[72:75], v[48:51], v[128:131]
    ds_read_b64_tr_b16 v[70:71], v7 offset:20992
    v_mfma_f32_16x16x32_bf16 v[132:135], v[72:75], v[52:55], v[132:135]
    s_cmp_ge_u32 s80, 153600
    s_cselect_b32 s84, 55296, 0
    s_waitcnt lgkmcnt(6)
    v_mfma_f32_16x16x32_bf16 v[136:139], v[76:79], v[40:43], v[136:139]
    ds_read_b64_tr_b16 v[72:73], v7 offset:28672
    v_mfma_f32_16x16x32_bf16 v[140:143], v[76:79], v[44:47], v[140:143]
    s_sub_u32 s80, s80, s84
    v_mfma_f32_16x16x32_bf16 v[144:147], v[76:79], v[48:51], v[144:147]
    ds_read_b64_tr_b16 v[74:75], v7 offset:29184
    v_mfma_f32_16x16x32_bf16 v[148:151], v[76:79], v[52:55], v[148:151]
    s_waitcnt lgkmcnt(6)
    v_mfma_f32_16x16x32_bf16 v[152:155], v[80:83], v[40:43], v[152:155]
    ds_read_b64_tr_b16 v[76:77], v8 offset:36864
    v_mfma_f32_16x16x32_bf16 v[156:159], v[80:83], v[44:47], v[156:159]
    v_mfma_f32_16x16x32_bf16 v[160:163], v[80:83], v[48:51], v[160:163]
    ds_read_b64_tr_b16 v[78:79], v8 offset:37120
    v_mfma_f32_16x16x32_bf16 v[164:167], v[80:83], v[52:55], v[164:167]
    s_waitcnt lgkmcnt(6)
    v_mfma_f32_16x16x32_bf16 v[168:171], v[64:67], v[40:43], v[168:171]
    ds_read_b64_tr_b16 v[80:81], v8 offset:38912
    v_mfma_f32_16x16x32_bf16 v[172:175], v[64:67], v[44:47], v[172:175]
    v_mfma_f32_16x16x32_bf16 v[176:179], v[64:67], v[48:51], v[176:179]
    ds_read_b64_tr_b16 v[82:83], v8 offset:39168
    v_mfma_f32_16x16x32_bf16 v[180:183], v[64:67], v[52:55], v[180:183]
    s_waitcnt lgkmcnt(6)
    v_mfma_f32_16x16x32_bf16 v[184:187], v[68:71], v[40:43], v[184:187]
    v_mfma_f32_16x16x32_bf16 v[188:191], v[68:71], v[44:47], v[188:191]
    v_mfma_f32_16x16x32_bf16 v[192:195], v[68:71], v[48:51], v[192:195]
    v_mfma_f32_16x16x32_bf16 v[196:199], v[68:71], v[52:55], v[196:199]
    s_waitcnt lgkmcnt(0)
    s_barrier
    v_mfma_f32_16x16x32_bf16 v[200:203], v[72:75], v[40:43], v[200:203]
    ds_read_b64_tr_b16 v[64:65], v9 offset:0
    v_mfma_f32_16x16x32_bf16 v[204:207], v[72:75], v[44:47], v[204:207]
    ds_read_b64_tr_b16 v[66:67], v9 offset:512
    v_mfma_f32_16x16x32_bf16 v[208:211], v[72:75], v[48:51], v[208:211]
    ds_read_b128 v[24:27], v14 offset:0
    v_mfma_f32_16x16x32_bf16 v[212:215], v[72:75], v[52:55], v[212:215]
    ds_read_b128 v[28:31], v14 offset:2048
    v_mfma_f32_16x16x32_bf16 v[216:219], v[76:79], v[40:43], v[216:219]
    ds_read_b128 v[32:35], v14 offset:4096
    v_mfma_f32_16x16x32_bf16 v[220:223], v[76:79], v[44:47], v[220:223]
    ds_read_b128 v[36:39], v14 offset:6144
    v_mfma_f32_16x16x32_bf16 v[224:227], v[76:79], v[48:51], v[224:227]
    ds_read_b64_tr_b16 v[68:69], v9 offset:8192
    v_mfma_f32_16x16x32_bf16 v[228:231], v[76:79], v[52:55], v[228:231]
    ds_read_b64_tr_b16 v[70:71], v9 offset:8704
    v_mfma_f32_16x16x32_bf16 v[232:235], v[80:83], v[40:43], v[232:235]
    ds_read_b64_tr_b16 v[72:73], v10 offset:0
    v_mfma_f32_16x16x32_bf16 v[236:239], v[80:83], v[44:47], v[236:239]
    v_mfma_f32_16x16x32_bf16 v[240:243], v[80:83], v[48:51], v[240:243]
    ds_read_b64_tr_b16 v[74:75], v10 offset:512
    v_mfma_f32_16x16x32_bf16 v[244:247], v[80:83], v[52:55], v[244:247]
    s_waitcnt lgkmcnt(7)
    v_mfma_f32_16x16x32_bf16 v[88:91], v[64:67], v[24:27], v[88:91]
    ds_read_b64_tr_b16 v[76:77], v10 offset:8192
    s_waitcnt lgkmcnt(7)
    v_mfma_f32_16x16x32_bf16 v[92:95], v[64:67], v[28:31], v[92:95]
    ds_read_b64_tr_b16 v[78:79], v10 offset:8704
    s_waitcnt lgkmcnt(7)
    v_mfma_f32_16x16x32_bf16 v[96:99], v[64:67], v[32:35], v[96:99]
    ds_read_b64_tr_b16 v[80:81], v11 offset:0
    s_waitcnt lgkmcnt(7)
    v_mfma_f32_16x16x32_bf16 v[100:103], v[64:67], v[36:39], v[100:103]
    ds_read_b64_tr_b16 v[82:83], v11 offset:512
    s_waitcnt lgkmcnt(6)
    v_mfma_f32_16x16x32_bf16 v[104:107], v[68:71], v[24:27], v[104:107]
    ds_read_b64_tr_b16 v[64:65], v11 offset:8192
    v_mfma_f32_16x16x32_bf16 v[108:111], v[68:71], v[28:31], v[108:111]
    v_mfma_f32_16x16x32_bf16 v[112:115], v[68:71], v[32:35], v[112:115]
    ds_read_b64_tr_b16 v[66:67], v11 offset:8704
    v_mfma_f32_16x16x32_bf16 v[116:119], v[68:71], v[36:39], v[116:119]
    s_waitcnt lgkmcnt(6)
    v_mfma_f32_16x16x32_bf16 v[120:123], v[72:75], v[24:27], v[120:123]
    ds_read_b64_tr_b16 v[68:69], v12 offset:0
    v_mfma_f32_16x16x32_bf16 v[124:127], v[72:75], v[28:31], v[124:127]
    v_mfma_f32_16x16x32_bf16 v[128:131], v[72:75], v[32:35], v[128:131]
    ds_read_b64_tr_b16 v[70:71], v12 offset:512
    v_mfma_f32_16x16x32_bf16 v[132:135], v[72:75], v[36:39], v[132:135]
    s_waitcnt lgkmcnt(6)
    v_mfma_f32_16x16x32_bf16 v[136:139], v[76:79], v[24:27], v[136:139]
    ds_read_b64_tr_b16 v[72:73], v12 offset:8192
    v_mfma_f32_16x16x32_bf16 v[140:143], v[76:79], v[28:31], v[140:143]
    v_mfma_f32_16x16x32_bf16 v[144:147], v[76:79], v[32:35], v[144:147]
    ds_read_b64_tr_b16 v[74:75], v12 offset:8704
    v_mfma_f32_16x16x32_bf16 v[148:151], v[76:79], v[36:39], v[148:151]
    s_waitcnt lgkmcnt(6)
    v_mfma_f32_16x16x32_bf16 v[152:155], v[80:83], v[24:27], v[152:155]
    ds_read_b64_tr_b16 v[76:77], v13 offset:16384
    v_mfma_f32_16x16x32_bf16 v[156:159], v[80:83], v[28:31], v[156:159]
    v_mfma_f32_16x16x32_bf16 v[160:163], v[80:83], v[32:35], v[160:163]
    ds_read_b64_tr_b16 v[78:79], v13 offset:16640
    v_mfma_f32_16x16x32_bf16 v[164:167], v[80:83], v[36:39], v[164:167]
    s_waitcnt lgkmcnt(6)
    v_mfma_f32_16x16x32_bf16 v[168:171], v[64:67], v[24:27], v[168:171]
    ds_read_b64_tr_b16 v[80:81], v13 offset:18432
    v_mfma_f32_16x16x32_bf16 v[172:175], v[64:67], v[28:31], v[172:175]
    v_mfma_f32_16x16x32_bf16 v[176:179], v[64:67], v[32:35], v[176:179]
    ds_read_b64_tr_b16 v[82:83], v13 offset:18688
    v_mfma_f32_16x16x32_bf16 v[180:183], v[64:67], v[36:39], v[180:183]
    s_waitcnt lgkmcnt(6)
    v_mfma_f32_16x16x32_bf16 v[184:187], v[68:71], v[24:27], v[184:187]
    v_mfma_f32_16x16x32_bf16 v[188:191], v[68:71], v[28:31], v[188:191]
    v_mfma_f32_16x16x32_bf16 v[192:195], v[68:71], v[32:35], v[192:195]
    v_mfma_f32_16x16x32_bf16 v[196:199], v[68:71], v[36:39], v[196:199]
    s_waitcnt lgkmcnt(0)
    s_barrier
    v_mfma_f32_16x16x32_bf16 v[200:203], v[72:75], v[24:27], v[200:203]
    ds_read_b64_tr_b16 v[64:65], v9 offset:20480
    v_mfma_f32_16x16x32_bf16 v[204:207], v[72:75], v[28:31], v[204:207]
    ds_read_b64_tr_b16 v[66:67], v9 offset:20992
    v_mfma_f32_16x16x32_bf16 v[208:211], v[72:75], v[32:35], v[208:211]
    ds_read_b128 v[40:43], v15 offset:0
    v_mfma_f32_16x16x32_bf16 v[212:215], v[72:75], v[36:39], v[212:215]
    ds_read_b128 v[44:47], v15 offset:2048
    v_mfma_f32_16x16x32_bf16 v[216:219], v[76:79], v[24:27], v[216:219]
    ds_read_b128 v[48:51], v15 offset:4096
    v_mfma_f32_16x16x32_bf16 v[220:223], v[76:79], v[28:31], v[220:223]
    ds_read_b128 v[52:55], v15 offset:6144
    v_mfma_f32_16x16x32_bf16 v[224:227], v[76:79], v[32:35], v[224:227]
    ds_read_b64_tr_b16 v[68:69], v9 offset:28672
    v_mfma_f32_16x16x32_bf16 v[228:231], v[76:79], v[36:39], v[228:231]
    ds_read_b64_tr_b16 v[70:71], v9 offset:29184
    v_mfma_f32_16x16x32_bf16 v[232:235], v[80:83], v[24:27], v[232:235]
    ds_read_b64_tr_b16 v[72:73], v10 offset:20480
    v_mfma_f32_16x16x32_bf16 v[236:239], v[80:83], v[28:31], v[236:239]
    v_mfma_f32_16x16x32_bf16 v[240:243], v[80:83], v[32:35], v[240:243]
    ds_read_b64_tr_b16 v[74:75], v10 offset:20992
    v_mfma_f32_16x16x32_bf16 v[244:247], v[80:83], v[36:39], v[244:247]
    s_waitcnt lgkmcnt(7)
    v_mfma_f32_16x16x32_bf16 v[88:91], v[64:67], v[40:43], v[88:91]
    ds_read_b64_tr_b16 v[76:77], v10 offset:28672
    s_waitcnt lgkmcnt(7)
    v_mfma_f32_16x16x32_bf16 v[92:95], v[64:67], v[44:47], v[92:95]
    ds_read_b64_tr_b16 v[78:79], v10 offset:29184
    s_waitcnt lgkmcnt(7)
    v_mfma_f32_16x16x32_bf16 v[96:99], v[64:67], v[48:51], v[96:99]
    ds_read_b64_tr_b16 v[80:81], v11 offset:20480
    s_waitcnt lgkmcnt(7)
    v_mfma_f32_16x16x32_bf16 v[100:103], v[64:67], v[52:55], v[100:103]
    ds_read_b64_tr_b16 v[82:83], v11 offset:20992
    s_waitcnt lgkmcnt(6)
    v_mfma_f32_16x16x32_bf16 v[104:107], v[68:71], v[40:43], v[104:107]
    ds_read_b64_tr_b16 v[64:65], v11 offset:28672
    v_mfma_f32_16x16x32_bf16 v[108:111], v[68:71], v[44:47], v[108:111]
    v_add_u32 v14, s80, v16
    v_mfma_f32_16x16x32_bf16 v[112:115], v[68:71], v[48:51], v[112:115]
    ds_read_b64_tr_b16 v[66:67], v11 offset:29184
    v_mfma_f32_16x16x32_bf16 v[116:119], v[68:71], v[52:55], v[116:119]
    v_add_u32 v15, s80, v17
    s_waitcnt lgkmcnt(6)
    v_mfma_f32_16x16x32_bf16 v[120:123], v[72:75], v[40:43], v[120:123]
    ds_read_b64_tr_b16 v[68:69], v12 offset:20480
    v_mfma_f32_16x16x32_bf16 v[124:127], v[72:75], v[44:47], v[124:127]
    s_add_u32 s80, s80, 18432
    v_mfma_f32_16x16x32_bf16 v[128:131], v[72:75], v[48:51], v[128:131]
    ds_read_b64_tr_b16 v[70:71], v12 offset:20992
    v_mfma_f32_16x16x32_bf16 v[132:135], v[72:75], v[52:55], v[132:135]
    s_cmp_ge_u32 s80, 153600
    s_cselect_b32 s84, 55296, 0
    s_waitcnt lgkmcnt(6)
    v_mfma_f32_16x16x32_bf16 v[136:139], v[76:79], v[40:43], v[136:139]
    ds_read_b64_tr_b16 v[72:73], v12 offset:28672
    v_mfma_f32_16x16x32_bf16 v[140:143], v[76:79], v[44:47], v[140:143]
    s_sub_u32 s80, s80, s84
    v_mfma_f32_16x16x32_bf16 v[144:147], v[76:79], v[48:51], v[144:147]
    ds_read_b64_tr_b16 v[74:75], v12 offset:29184
    v_mfma_f32_16x16x32_bf16 v[148:151], v[76:79], v[52:55], v[148:151]
    s_waitcnt lgkmcnt(6)
    v_mfma_f32_16x16x32_bf16 v[152:155], v[80:83], v[40:43], v[152:155]
    ds_read_b64_tr_b16 v[76:77], v13 offset:36864
    v_mfma_f32_16x16x32_bf16 v[156:159], v[80:83], v[44:47], v[156:159]
    v_mfma_f32_16x16x32_bf16 v[160:163], v[80:83], v[48:51], v[160:163]
    ds_read_b64_tr_b16 v[78:79], v13 offset:37120
    v_mfma_f32_16x16x32_bf16 v[164:167], v[80:83], v[52:55], v[164:167]
    s_waitcnt lgkmcnt(6)
    v_mfma_f32_16x16x32_bf16 v[168:171], v[64:67], v[40:43], v[168:171]
    ds_read_b64_tr_b16 v[80:81], v13 offset:38912
    v_mfma_f32_16x16x32_bf16 v[172:175], v[64:67], v[44:47], v[172:175]
    v_mfma_f32_16x16x32_bf16 v[176:179], v[64:67], v[48:51], v[176:179]
    ds_read_b64_tr_b16 v[82:83], v13 offset:39168
    v_mfma_f32_16x16x32_bf16 v[180:183], v[64:67], v[52:55], v[180:183]
    s_waitcnt lgkmcnt(6)
    v_mfma_f32_16x16x32_bf16 v[184:187], v[68:71], v[40:43], v[184:187]
    v_mfma_f32_16x16x32_bf16 v[188:191], v[68:71], v[44:47], v[188:191]
    v_mfma_f32_16x16x32_bf16 v[192:195], v[68:71], v[48:51], v[192:195]
    v_mfma_f32_16x16x32_bf16 v[196:199], v[68:71], v[52:55], v[196:199]
    s_waitcnt lgkmcnt(0)
    s_barrier
    v_mfma_f32_16x16x32_bf16 v[200:203], v[72:75], v[40:43], v[200:203]
    ds_read_b64_tr_b16 v[64:65], v4 offset:0
    v_mfma_f32_16x16x32_bf16 v[204:207], v[72:75], v[44:47], v[204:207]
    ds_read_b64_tr_b16 v[66:67], v4 offset:512
    v_mfma_f32_16x16x32_bf16 v[208:211], v[72:75], v[48:51], v[208:211]
    ds_read_b128 v[24:27], v14 offset:0
    v_mfma_f32_16x16x32_bf16 v[212:215], v[72:75], v[52:55], v[212:215]
    ds_read_b128 v[28:31], v14 offset:2048
    v_mfma_f32_16x16x32_bf16 v[216:219], v[76:79], v[40:43], v[216:219]
    ds_read_b128 v[32:35], v14 offset:4096
    v_mfma_f32_16x16x32_bf16 v[220:223], v[76:79], v[44:47], v[220:223]
    ds_read_b128 v[36:39], v14 offset:6144
    v_mfma_f32_16x16x32_bf16 v[224:227], v[76:79], v[48:51], v[224:227]
    ds_read_b64_tr_b16 v[68:69], v4 offset:8192
    v_mfma_f32_16x16x32_bf16 v[228:231], v[76:79], v[52:55], v[228:231]
    ds_read_b64_tr_b16 v[70:71], v4 offset:8704
    v_mfma_f32_16x16x32_bf16 v[232:235], v[80:83], v[40:43], v[232:235]
    ds_read_b64_tr_b16 v[72:73], v5 offset:0
    v_mfma_f32_16x16x32_bf16 v[236:239], v[80:83], v[44:47], v[236:239]
    v_mfma_f32_16x16x32_bf16 v[240:243], v[80:83], v[48:51], v[240:243]
    ds_read_b64_tr_b16 v[74:75], v5 offset:512
    v_mfma_f32_16x16x32_bf16 v[244:247], v[80:83], v[52:55], v[244:247]
    s_sub_u32 s34, s34, 1
    s_cmp_lg_u32 s34, 0
    s_cbranch_scc1 L_p1
    s_waitcnt lgkmcnt(7)
    v_mfma_f32_16x16x32_bf16 v[88:91], v[64:67], v[24:27], v[88:91]
    ds_read_b64_tr_b16 v[76:77], v5 offset:8192
    s_waitcnt lgkmcnt(7)
    v_mfma_f32_16x16x32_bf16 v[92:95], v[64:67], v[28:31], v[92:95]
    ds_read_b64_tr_b16 v[78:79], v5 offset:8704
    s_waitcnt lgkmcnt(7)
    v_mfma_f32_16x16x32_bf16 v[96:99], v[64:67], v[32:35], v[96:99]
    ds_read_b64_tr_b16 v[80:81], v6 offset:0
    s_waitcnt lgkmcnt(7)
    v_mfma_f32_16x16x32_bf16 v[100:103], v[64:67], v[36:39], v[100:103]
    ds_read_b64_tr_b16 v[82:83], v6 offset:512
    s_waitcnt lgkmcnt(6)
    v_mfma_f32_16x16x32_bf16 v[104:107], v[68:71], v[24:27], v[104:107]
    ds_read_b64_tr_b16 v[64:65], v6 offset:8192
    v_mfma_f32_16x16x32_bf16 v[108:111], v[68:71], v[28:31], v[108:111]
    v_mfma_f32_16x16x32_bf16 v[112:115], v[68:71], v[32:35], v[112:115]
    ds_read_b64_tr_b16 v[66:67], v6 offset:8704
    v_mfma_f32_16x16x32_bf16 v[116:119], v[68:71], v[36:39], v[116:119]
    s_waitcnt lgkmcnt(6)
    v_mfma_f32_16x16x32_bf16 v[120:123], v[72:75], v[24:27], v[120:123]
    ds_read_b64_tr_b16 v[68:69], v7 offset:0
    v_mfma_f32_16x16x32_bf16 v[124:127], v[72:75], v[28:31], v[124:127]
    v_mfma_f32_16x16x32_bf16 v[128:131], v[72:75], v[32:35], v[128:131]
    ds_read_b64_tr_b16 v[70:71], v7 offset:512
    v_mfma_f32_16x16x32_bf16 v[132:135], v[72:75], v[36:39], v[132:135]
    s_waitcnt lgkmcnt(6)
    v_mfma_f32_16x16x32_bf16 v[136:139], v[76:79], v[24:27], v[136:139]
    ds_read_b64_tr_b16 v[72:73], v7 offset:8192
    v_mfma_f32_16x16x32_bf16 v[140:143], v[76:79], v[28:31], v[140:143]
    v_mfma_f32_16x16x32_bf16 v[144:147], v[76:79], v[32:35], v[144:147]
    ds_read_b64_tr_b16 v[74:75], v7 offset:8704
    v_mfma_f32_16x16x32_bf16 v[148:151], v[76:79], v[36:39], v[148:151]
    s_waitcnt lgkmcnt(6)
    v_mfma_f32_16x16x32_bf16 v[152:155], v[80:83], v[24:27], v[152:155]
    ds_read_b64_tr_b16 v[76:77], v8 offset:16384
    v_mfma_f32_16x16x32_bf16 v[156:159], v[80:83], v[28:31], v[156:159]
    v_mfma_f32_16x16x32_bf16 v[160:163], v[80:83], v[32:35], v[160:163]
    ds_read_b64_tr_b16 v[78:79], v8 offset:16640
    v_mfma_f32_16x16x32_bf16 v[164:167], v[80:83], v[36:39], v[164:167]
    s_waitcnt lgkmcnt(6)
    v_mfma_f32_16x16x32_bf16 v[168:171], v[64:67], v[24:27], v[168:171]
    ds_read_b64_tr_b16 v[80:81], v8 offset:18432
    v_mfma_f32_16x16x32_bf16 v[172:175], v[64:67], v[28:31], v[172:175]
    v_mfma_f32_16x16x32_bf16 v[176:179], v[64:67], v[32:35], v[176:179]
    ds_read_b64_tr_b16 v[82:83], v8 offset:18688
    v_mfma_f32_16x16x32_bf16 v[180:183], v[64:67], v[36:39], v[180:183]
    s_waitcnt lgkmcnt(6)
    v_mfma_f32_16x16x32_bf16 v[184:187], v[68:71], v[24:27], v[184:187]
    v_mfma_f32_16x16x32_bf16 v[188:191], v[68:71], v[28:31], v[188:191]
    v_mfma_f32_16x16x32_bf16 v[192:195], v[68:71], v[32:35], v[192:195]
    v_mfma_f32_16x16x32_bf16 v[196:199], v[68:71], v[36:39], v[196:199]
    s_waitcnt lgkmcnt(0)
    s_barrier
    v_mfma_f32_16x16x32_bf16 v[200:203], v[72:75], v[24:27], v[200:203]
    ds_read_b64_tr_b16 v[64:65], v4 offset:20480
    v_mfma_f32_16x16x32_bf16 v[204:207], v[72:75], v[28:31], v[204:207]
    ds_read_b64_tr_b16 v[66:67], v4 offset:20992
    v_mfma_f32_16x16x32_bf16 v[208:211], v[72:75], v[32:35], v[208:211]
    ds_read_b128 v[40:43], v15 offset:0
    v_mfma_f32_16x16x32_bf16 v[212:215], v[72:75], v[36:39], v[212:215]
    ds_read_b128 v[44:47], v15 offset:2048
    v_mfma_f32_16x16x32_bf16 v[216:219], v[76:79], v[24:27], v[216:219]
    ds_read_b128 v[48:51], v15 offset:4096
    v_mfma_f32_16x16x32_bf16 v[220:223], v[76:79], v[28:31], v[220:223]
    ds_read_b128 v[52:55], v15 offset:6144
    v_mfma_f32_16x16x32_bf16 v[224:227], v[76:79], v[32:35], v[224:227]
    ds_read_b64_tr_b16 v[68:69], v4 offset:28672
    v_mfma_f32_16x16x32_bf16 v[228:231], v[76:79], v[36:39], v[228:231]
    ds_read_b64_tr_b16 v[70:71], v4 offset:29184
    v_mfma_f32_16x16x32_bf16 v[232:235], v[80:83], v[24:27], v[232:235]
    ds_read_b64_tr_b16 v[72:73], v5 offset:20480
    v_mfma_f32_16x16x32_bf16 v[236:239], v[80:83], v[28:31], v[236:239]
    v_mfma_f32_16x16x32_bf16 v[240:243], v[80:83], v[32:35], v[240:243]
    ds_read_b64_tr_b16 v[74:75], v5 offset:20992
    v_mfma_f32_16x16x32_bf16 v[244:247], v[80:83], v[36:39], v[244:247]
    s_waitcnt lgkmcnt(7)
    v_mfma_f32_16x16x32_bf16 v[88:91], v[64:67], v[40:43], v[88:91]
    ds_read_b64_tr_b16 v[76:77], v5 offset:28672
    s_waitcnt lgkmcnt(7)
    v_mfma_f32_16x16x32_bf16 v[92:95], v[64:67], v[44:47], v[92:95]
    ds_read_b64_tr_b16 v[78:79], v5 offset:29184
    s_waitcnt lgkmcnt(7)
    v_mfma_f32_16x16x32_bf16 v[96:99], v[64:67], v[48:51], v[96:99]
    ds_read_b64_tr_b16 v[80:81], v6 offset:20480
    s_waitcnt lgkmcnt(7)
    v_mfma_f32_16x16x32_bf16 v[100:103], v[64:67], v[52:55], v[100:103]
    ds_read_b64_tr_b16 v[82:83], v6 offset:20992
    s_waitcnt lgkmcnt(6)
    v_mfma_f32_16x16x32_bf16 v[104:107], v[68:71], v[40:43], v[104:107]
    ds_read_b64_tr_b16 v[64:65], v6 offset:28672
    v_mfma_f32_16x16x32_bf16 v[108:111], v[68:71], v[44:47], v[108:111]
    v_add_u32 v14, s80, v16
    v_mfma_f32_16x16x32_bf16 v[112:115], v[68:71], v[48:51], v[112:115]
    ds_read_b64_tr_b16 v[66:67], v6 offset:29184
    v_mfma_f32_16x16x32_bf16 v[116:119], v[68:71], v[52:55], v[116:119]
    v_add_u32 v15, s80, v17
    s_waitcnt lgkmcnt(6)
    v_mfma_f32_16x16x32_bf16 v[120:123], v[72:75], v[40:43], v[120:123]
    ds_read_b64_tr_b16 v[68:69], v7 offset:20480
    v_mfma_f32_16x16x32_bf16 v[124:127], v[72:75], v[44:47], v[124:127]
    s_add_u32 s80, s80, 18432
    v_mfma_f32_16x16x32_bf16 v[128:131], v[72:75], v[48:51], v[128:131]
    ds_read_b64_tr_b16 v[70:71], v7 offset:20992
    v_mfma_f32_16x16x32_bf16 v[132:135], v[72:75], v[52:55], v[132:135]
    s_cmp_ge_u32 s80, 153600
    s_cselect_b32 s84, 55296, 0
    s_waitcnt lgkmcnt(6)
    v_mfma_f32_16x16x32_bf16 v[136:139], v[76:79], v[40:43], v[136:139]
    ds_read_b64_tr_b16 v[72:73], v7 offset:28672
    v_mfma_f32_16x16x32_bf16 v[140:143], v[76:79], v[44:47], v[140:143]
    s_sub_u32 s80, s80, s84
    v_mfma_f32_16x16x32_bf16 v[144:147], v[76:79], v[48:51], v[144:147]
    ds_read_b64_tr_b16 v[74:75], v7 offset:29184
    v_mfma_f32_16x16x32_bf16 v[148:151], v[76:79], v[52:55], v[148:151]
    s_waitcnt lgkmcnt(6)
    v_mfma_f32_16x16x32_bf16 v[152:155], v[80:83], v[40:43], v[152:155]
    ds_read_b64_tr_b16 v[76:77], v8 offset:36864
    v_mfma_f32_16x16x32_bf16 v[156:159], v[80:83], v[44:47], v[156:159]
    v_mfma_f32_16x16x32_bf16 v[160:163], v[80:83], v[48:51], v[160:163]
    ds_read_b64_tr_b16 v[78:79], v8 offset:37120
    v_mfma_f32_16x16x32_bf16 v[164:167], v[80:83], v[52:55], v[164:167]
    s_waitcnt lgkmcnt(6)
    v_mfma_f32_16x16x32_bf16 v[168:171], v[64:67], v[40:43], v[168:171]
    ds_read_b64_tr_b16 v[80:81], v8 offset:38912
    v_mfma_f32_16x16x32_bf16 v[172:175], v[64:67], v[44:47], v[172:175]
    v_mfma_f32_16x16x32_bf16 v[176:179], v[64:67], v[48:51], v[176:179]
    ds_read_b64_tr_b16 v[82:83], v8 offset:39168
    v_mfma_f32_16x16x32_bf16 v[180:183], v[64:67], v[52:55], v[180:183]
    s_waitcnt lgkmcnt(6)
    v_mfma_f32_16x16x32_bf16 v[184:187], v[68:71], v[40:43], v[184:187]
    v_mfma_f32_16x16x32_bf16 v[188:191], v[68:71], v[44:47], v[188:191]
    v_mfma_f32_16x16x32_bf16 v[192:195], v[68:71], v[48:51], v[192:195]
    v_mfma_f32_16x16x32_bf16 v[196:199], v[68:71], v[52:55], v[196:199]
    s_waitcnt lgkmcnt(0)
    s_barrier
    v_mfma_f32_16x16x32_bf16 v[200:203], v[72:75], v[40:43], v[200:203]
    ds_read_b64_tr_b16 v[64:65], v9 offset:0
    v_mfma_f32_16x16x32_bf16 v[204:207], v[72:75], v[44:47], v[204:207]
    ds_read_b64_tr_b16 v[66:67], v9 offset:512
    v_mfma_f32_16x16x32_bf16 v[208:211], v[72:75], v[48:51], v[208:211]
    ds_read_b128 v[24:27], v14 offset:0
    v_mfma_f32_16x16x32_bf16 v[212:215], v[72:75], v[52:55], v[212:215]
    ds_read_b128 v[28:31], v14 offset:2048
    v_mfma_f32_16x16x32_bf16 v[216:219], v[76:79], v[40:43], v[216:219]
    ds_read_b128 v[32:35], v14 offset:4096
    v_mfma_f32_16x16x32_bf16 v[220:223], v[76:79], v[44:47], v[220:223]
    ds_read_b128 v[36:39], v14 offset:6144
    v_mfma_f32_16x16x32_bf16 v[224:227], v[76:79], v[48:51], v[224:227]
    ds_read_b64_tr_b16 v[68:69], v9 offset:8192
    v_mfma_f32_16x16x32_bf16 v[228:231], v[76:79], v[52:55], v[228:231]
    ds_read_b64_tr_b16 v[70:71], v9 offset:8704
    v_mfma_f32_16x16x32_bf16 v[232:235], v[80:83], v[40:43], v[232:235]
    ds_read_b64_tr_b16 v[72:73], v10 offset:0
    v_mfma_f32_16x16x32_bf16 v[236:239], v[80:83], v[44:47], v[236:239]
    v_mfma_f32_16x16x32_bf16 v[240:243], v[80:83], v[48:51], v[240:243]
    ds_read_b64_tr_b16 v[74:75], v10 offset:512
    v_mfma_f32_16x16x32_bf16 v[244:247], v[80:83], v[52:55], v[244:247]
    s_waitcnt lgkmcnt(7)
    v_mfma_f32_16x16x32_bf16 v[88:91], v[64:67], v[24:27], v[88:91]
    ds_read_b64_tr_b16 v[76:77], v10 offset:8192
    s_waitcnt lgkmcnt(7)
    v_mfma_f32_16x16x32_bf16 v[92:95], v[64:67], v[28:31], v[92:95]
    ds_read_b64_tr_b16 v[78:79], v10 offset:8704
    s_waitcnt lgkmcnt(7)
    v_mfma_f32_16x16x32_bf16 v[96:99], v[64:67], v[32:35], v[96:99]
    ds_read_b64_tr_b16 v[80:81], v11 offset:0
    s_waitcnt lgkmcnt(7)
    v_mfma_f32_16x16x32_bf16 v[100:103], v[64:67], v[36:39], v[100:103]
    ds_read_b64_tr_b16 v[82:83], v11 offset:512
    s_waitcnt lgkmcnt(6)
    v_mfma_f32_16x16x32_bf16 v[104:107], v[68:71], v[24:27], v[104:107]
    ds_read_b64_tr_b16 v[64:65], v11 offset:8192
    v_mfma_f32_16x16x32_bf16 v[108:111], v[68:71], v[28:31], v[108:111]
    v_mfma_f32_16x16x32_bf16 v[112:115], v[68:71], v[32:35], v[112:115]
    ds_read_b64_tr_b16 v[66:67], v11 offset:8704
    v_mfma_f32_16x16x32_bf16 v[116:119], v[68:71], v[36:39], v[116:119]
    s_waitcnt lgkmcnt(6)
    v_mfma_f32_16x16x32_bf16 v[120:123], v[72:75], v[24:27], v[120:123]
    ds_read_b64_tr_b16 v[68:69], v12 offset:0
    v_mfma_f32_16x16x32_bf16 v[124:127], v[72:75], v[28:31], v[124:127]
    v_mfma_f32_16x16x32_bf16 v[128:131], v[72:75], v[32:35], v[128:131]
    ds_read_b64_tr_b16 v[70:71], v12 offset:512
    v_mfma_f32_16x16x32_bf16 v[132:135], v[72:75], v[36:39], v[132:135]
    s_waitcnt lgkmcnt(6)
    v_mfma_f32_16x16x32_bf16 v[136:139], v[76:79], v[24:27], v[136:139]
    ds_read_b64_tr_b16 v[72:73], v12 offset:8192
    v_mfma_f32_16x16x32_bf16 v[140:143], v[76:79], v[28:31], v[140:143]
    v_mfma_f32_16x16x32_bf16 v[144:147], v[76:79], v[32:35], v[144:147]
    ds_read_b64_tr_b16 v[74:75], v12 offset:8704
    v_mfma_f32_16x16x32_bf16 v[148:151], v[76:79], v[36:39], v[148:151]
    s_waitcnt lgkmcnt(6)
    v_mfma_f32_16x16x32_bf16 v[152:155], v[80:83], v[24:27], v[152:155]
    ds_read_b64_tr_b16 v[76:77], v13 offset:16384
    v_mfma_f32_16x16x32_bf16 v[156:159], v[80:83], v[28:31], v[156:159]
    v_mfma_f32_16x16x32_bf16 v[160:163], v[80:83], v[32:35], v[160:163]
    ds_read_b64_tr_b16 v[78:79], v13 offset:16640
    v_mfma_f32_16x16x32_bf16 v[164:167], v[80:83], v[36:39], v[164:167]
    s_waitcnt lgkmcnt(6)
    v_mfma_f32_16x16x32_bf16 v[168:171], v[64:67], v[24:27], v[168:171]
    ds_read_b64_tr_b16 v[80:81], v13 offset:18432
    v_mfma_f32_16x16x32_bf16 v[172:175], v[64:67], v[28:31], v[172:175]
    v_mfma_f32_16x16x32_bf16 v[176:179], v[64:67], v[32:35], v[176:179]
    ds_read_b64_tr_b16 v[82:83], v13 offset:18688
    v_mfma_f32_16x16x32_bf16 v[180:183], v[64:67], v[36:39], v[180:183]
    s_waitcnt lgkmcnt(6)
    v_mfma_f32_16x16x32_bf16 v[184:187], v[68:71], v[24:27], v[184:187]
    v_mfma_f32_16x16x32_bf16 v[188:191], v[68:71], v[28:31], v[188:191]
    v_mfma_f32_16x16x32_bf16 v[192:195], v[68:71], v[32:35], v[192:195]
    v_mfma_f32_16x16x32_bf16 v[196:199], v[68:71], v[36:39], v[196:199]
    s_waitcnt lgkmcnt(0)
    s_barrier
    v_mfma_f32_16x16x32_bf16 v[200:203], v[72:75], v[24:27], v[200:203]
    ds_read_b64_tr_b16 v[64:65], v9 offset:20480
    v_mfma_f32_16x16x32_bf16 v[204:207], v[72:75], v[28:31], v[204:207]
    ds_read_b64_tr_b16 v[66:67], v9 offset:20992
    v_mfma_f32_16x16x32_bf16 v[208:211], v[72:75], v[32:35], v[208:211]
    ds_read_b128 v[40:43], v15 offset:0
    v_mfma_f32_16x16x32_bf16 v[212:215], v[72:75], v[36:39], v[212:215]
    ds_read_b128 v[44:47], v15 offset:2048
    v_mfma_f32_16x16x32_bf16 v[216:219], v[76:79], v[24:27], v[216:219]
    ds_read_b128 v[48:51], v15 offset:4096
    v_mfma_f32_16x16x32_bf16 v[220:223], v[76:79], v[28:31], v[220:223]
    ds_read_b128 v[52:55], v15 offset:6144
    v_mfma_f32_16x16x32_bf16 v[224:227], v[76:79], v[32:35], v[224:227]
    ds_read_b64_tr_b16 v[68:69], v9 offset:28672
    v_mfma_f32_16x16x32_bf16 v[228:231], v[76:79], v[36:39], v[228:231]
    ds_read_b64_tr_b16 v[70:71], v9 offset:29184
    v_mfma_f32_16x16x32_bf16 v[232:235], v[80:83], v[24:27], v[232:235]
    ds_read_b64_tr_b16 v[72:73], v10 offset:20480
    v_mfma_f32_16x16x32_bf16 v[236:239], v[80:83], v[28:31], v[236:239]
    v_mfma_f32_16x16x32_bf16 v[240:243], v[80:83], v[32:35], v[240:243]
    ds_read_b64_tr_b16 v[74:75], v10 offset:20992
L_pad0:
    s_cbranch_execz L_vret0
    v_mfma_f32_16x16x32_bf16 v[244:247], v[80:83], v[36:39], v[244:247]
    s_waitcnt lgkmcnt(7)
    v_mfma_f32_16x16x32_bf16 v[88:91], v[64:67], v[40:43], v[88:91]
    ds_read_b64_tr_b16 v[76:77], v10 offset:28672
    s_waitcnt lgkmcnt(7)
    v_mfma_f32_16x16x32_bf16 v[92:95], v[64:67], v[44:47], v[92:95]
    ds_read_b64_tr_b16 v[78:79], v10 offset:29184
    s_waitcnt lgkmcnt(7)
    v_mfma_f32_16x16x32_bf16 v[96:99], v[64:67], v[48:51], v[96:99]
    ds_read_b64_tr_b16 v[80:81], v11 offset:20480
    s_waitcnt lgkmcnt(7)
    v_mfma_f32_16x16x32_bf16 v[100:103], v[64:67], v[52:55], v[100:103]
    ds_read_b64_tr_b16 v[82:83], v11 offset:20992
    s_waitcnt lgkmcnt(6)
    v_mfma_f32_16x16x32_bf16 v[104:107], v[68:71], v[40:43], v[104:107]
    ds_read_b64_tr_b16 v[64:65], v11 offset:28672
    v_mfma_f32_16x16x32_bf16 v[108:111], v[68:71], v[44:47], v[108:111]
    v_mfma_f32_16x16x32_bf16 v[112:115], v[68:71], v[48:51], v[112:115]
    ds_read_b64_tr_b16 v[66:67], v11 offset:29184
    v_mfma_f32_16x16x32_bf16 v[116:119], v[68:71], v[52:55], v[116:119]
    s_waitcnt lgkmcnt(6)
    v_mfma_f32_16x16x32_bf16 v[120:123], v[72:75], v[40:43], v[120:123]
    ds_read_b64_tr_b16 v[68:69], v12 offset:20480
    v_mfma_f32_16x16x32_bf16 v[124:127], v[72:75], v[44:47], v[124:127]
    v_mfma_f32_16x16x32_bf16 v[128:131], v[72:75], v[48:51], v[128:131]
    ds_read_b64_tr_b16 v[70:71], v12 offset:20992
    v_mfma_f32_16x16x32_bf16 v[132:135], v[72:75], v[52:55], v[132:135]
    s_waitcnt lgkmcnt(6)
    v_mfma_f32_16x16x32_bf16 v[136:139], v[76:79], v[40:43], v[136:139]
    ds_read_b64_tr_b16 v[72:73], v12 offset:28672
    v_mfma_f32_16x16x32_bf16 v[140:143], v[76:79], v[44:47], v[140:143]
    v_mfma_f32_16x16x32_bf16 v[144:147], v[76:79], v[48:51], v[144:147]
    ds_read_b64_tr_b16 v[74:75], v12 offset:29184
    v_mfma_f32_16x16x32_bf16 v[148:151], v[76:79], v[52:55], v[148:151]
    s_waitcnt lgkmcnt(6)
    v_mfma_f32_16x16x32_bf16 v[152:155], v[80:83], v[40:43], v[152:155]
    ds_read_b64_tr_b16 v[76:77], v13 offset:36864
    v_mfma_f32_16x16x32_bf16 v[156:159], v[80:83], v[44:47], v[156:159]
    v_mfma_f32_16x16x32_bf16 v[160:163], v[80:83], v[48:51], v[160:163]
    ds_read_b64_tr_b16 v[78:79], v13 offset:37120
    v_mfma_f32_16x16x32_bf16 v[164:167], v[80:83], v[52:55], v[164:167]
    s_waitcnt lgkmcnt(6)
    v_mfma_f32_16x16x32_bf16 v[168:171], v[64:67], v[40:43], v[168:171]
    ds_read_b64_tr_b16 v[80:81], v13 offset:38912
    v_mfma_f32_16x16x32_bf16 v[172:175], v[64:67], v[44:47], v[172:175]
    v_mfma_f32_16x16x32_bf16 v[176:179], v[64:67], v[48:51], v[176:179]
    ds_read_b64_tr_b16 v[82:83], v13 offset:39168
    v_mfma_f32_16x16x32_bf16 v[180:183], v[64:67], v[52:55], v[180:183]
    s_waitcnt lgkmcnt(6)
    v_mfma_f32_16x16x32_bf16 v[184:187], v[68:71], v[40:43], v[184:187]
    v_mfma_f32_16x16x32_bf16 v[188:191], v[68:71], v[44:47], v[188:191]
    v_mfma_f32_16x16x32_bf16 v[192:195], v[68:71], v[48:51], v[192:195]
    v_mfma_f32_16x16x32_bf16 v[196:199], v[68:71], v[52:55], v[196:199]
    s_waitcnt lgkmcnt(0)
    s_barrier
    v_mfma_f32_16x16x32_bf16 v[200:203], v[72:75], v[40:43], v[200:203]
    v_mfma_f32_16x16x32_bf16 v[204:207], v[72:75], v[44:47], v[204:207]
    v_mfma_f32_16x16x32_bf16 v[208:211], v[72:75], v[48:51], v[208:211]
    v_mfma_f32_16x16x32_bf16 v[212:215], v[72:75], v[52:55], v[212:215]
    v_mfma_f32_16x16x32_bf16 v[216:219], v[76:79], v[40:43], v[216:219]
    v_mfma_f32_16x16x32_bf16 v[220:223], v[76:79], v[44:47], v[220:223]
    v_mfma_f32_16x16x32_bf16 v[224:227], v[76:79], v[48:51], v[224:227]
    v_mfma_f32_16x16x32_bf16 v[228:231], v[76:79], v[52:55], v[228:231]
    v_mfma_f32_16x16x32_bf16 v[232:235], v[80:83], v[40:43], v[232:235]
    v_mfma_f32_16x16x32_bf16 v[236:239], v[80:83], v[44:47], v[236:239]
    v_mfma_f32_16x16x32_bf16 v[240:243], v[80:83], v[48:51], v[240:243]
    v_mfma_f32_16x16x32_bf16 v[244:247], v[80:83], v[52:55], v[244:247]
    s_setprio 0
    s_lshl_b32 s84, s5, 10
    s_add_u32 s84, s84, 161024
    v_and_b32 v16, 15, v1
    v_lshl_add_u32 v16, v16, 4, s84
    ds_read_b128 v[64:67], v16 offset:0
    ds_read_b128 v[68:71], v16 offset:256
    ds_read_b128 v[72:75], v16 offset:512
    ds_read_b128 v[76:79], v16 offset:768
    v_and_b32 v17, 48, v1
    s_lshl_b32 s84, s6, 8
    s_add_u32 s84, s84, 159744
    v_add_u32 v16, s84, v17
    s_lshl_b32 s84, s6, 6
    s_add_u32 s84, s84, 159744
    v_add_u32 v17, s84, v17
    ds_read_b128 v[24:27], v16 offset:0
    ds_read_b128 v[28:31], v16 offset:640
    ds_read_b128 v[32:35], v16 offset:64
    ds_read_b128 v[36:39], v16 offset:704
    ds_read_b128 v[40:43], v16 offset:128
    ds_read_b128 v[44:47], v16 offset:768
    ds_read_b128 v[48:51], v16 offset:192
    ds_read_b128 v[52:55], v16 offset:832
    ds_read_b128 v[56:59], v17 offset:512
    ds_read_b128 v[60:63], v17 offset:1152
    s_memrealtime s[92:93]
    s_memtime s[90:91]
    s_add_u32 m0, s79, 116736
    s_mov_b32 s78, 256
    buffer_load_dwordx4 v20, s[36:39], s78 offen sc1 lds
    s_waitcnt lgkmcnt(0)
    s_mov_b32 s34, s92
    s_mov_b32 s35, s90
    v_fmac_f32 v88, v24, v64
    v_fmac_f32 v89, v25, v64
    v_fmac_f32 v90, v26, v64
    v_fmac_f32 v91, v27, v64
    v_fmac_f32 v104, v28, v64
    v_fmac_f32 v105, v29, v64
    v_fmac_f32 v106, v30, v64
    v_fmac_f32 v107, v31, v64
    s_add_u32 m0, s79, 117760
    s_nop 0
    buffer_load_dwordx4 v21, s[36:39], s78 offen sc1 lds
    v_mul_f32 v80, v88, v88
    v_mul_f32 v81, v89, v89
    v_mul_f32 v82, v90, v90
    v_mul_f32 v83, v91, v91
    v_fma_f32 v80, v80, v66, v65
    v_fma_f32 v81, v81, v66, v65
    v_fma_f32 v82, v82, v66, v65
    v_fma_f32 v83, v83, v66, v65
    s_add_u32 m0, s33, 77824
    s_mov_b32 s76, 589824
    buffer_load_dwordx4 v23, s[40:43], s76 offen offset:0 lds
    v_mul_f32 v80, v80, v88
    v_mul_f32 v81, v81, v89
    v_mul_f32 v82, v82, v90
    v_mul_f32 v83, v83, v91
    v_exp_f32 v80, v80
    v_mul_f32 v88, v88, v104
    v_exp_f32 v81, v81
    s_add_u32 m0, s33, 79872
    s_nop 0
    buffer_load_dwordx4 v23, s[40:43], s76 offen offset:2048 lds
    v_mul_f32 v89, v89, v105
    v_exp_f32 v82, v82
    v_mul_f32 v90, v90, v106
    v_exp_f32 v83, v83
    v_mul_f32 v91, v91, v107
    v_fma_f32 v80, v80, v67, v67
    s_add_u32 m0, s33, 86016
    s_nop 0
    buffer_load_dwordx4 v23, s[44:47], s76 offen offset:0 lds
    v_fma_f32 v81, v81, v67, v67
    v_fma_f32 v82, v82, v67, v67
    v_fma_f32 v83, v83, v67, v67
    v_rcp_f32 v80, v80
    v_rcp_f32 v81, v81
    v_rcp_f32 v82, v82
    s_add_u32 m0, s33, 90112
    s_mov_b32 s77, 688128
    buffer_load_dwordx4 v22, s[48:51], s77 offen offset:0 lds
    v_rcp_f32 v83, v83
    s_nop 0
    v_mul_f32 v88, v88, v80
    v_mul_f32 v89, v89, v81
    v_mul_f32 v90, v90, v82
    v_mul_f32 v91, v91, v83
    v_cvt_pk_bf16_f32 v88, v88, v89
    v_cvt_pk_bf16_f32 v89, v90, v91
    s_add_u32 m0, s33, 94208
    s_nop 0
    buffer_load_dwordx4 v22, s[52:55], s77 offen offset:0 lds
    s_barrier
    s_add_u32 m0, s79, 118784
    s_mov_b32 s78, 33024
    buffer_load_dwordx4 v20, s[36:39], s78 offen sc1 lds
    v_fmac_f32 v92, v24, v68
    v_fmac_f32 v93, v25, v68
    v_fmac_f32 v94, v26, v68
    v_fmac_f32 v95, v27, v68
    v_fmac_f32 v108, v28, v68
    v_fmac_f32 v109, v29, v68
    v_fmac_f32 v110, v30, v68
    v_fmac_f32 v111, v31, v68
    s_add_u32 m0, s79, 119808
    s_nop 0
    buffer_load_dwordx4 v21, s[36:39], s78 offen sc1 lds
    v_mul_f32 v80, v92, v92
    v_mul_f32 v81, v93, v93
    v_mul_f32 v82, v94, v94
    v_mul_f32 v83, v95, v95
    v_fma_f32 v80, v80, v70, v69
    v_fma_f32 v81, v81, v70, v69
    v_fma_f32 v82, v82, v70, v69
    v_fma_f32 v83, v83, v70, v69
    s_add_u32 m0, s81, 133120
    s_mov_b32 s78, 256
    s_mov_b64 exec, 0xffffffff
    buffer_load_dwordx4 v3, s[36:39], s78 offen sc1 lds
    s_mov_b64 exec, -1
    v_mul_f32 v80, v80, v92
    v_mul_f32 v81, v81, v93
    v_mul_f32 v82, v82, v94
    v_mul_f32 v83, v83, v95
    v_exp_f32 v80, v80
    v_mul_f32 v92, v92, v108
    v_exp_f32 v81, v81
    s_add_u32 m0, s33, 16384
    s_mov_b32 s76, 786432
    buffer_load_dwordx4 v23, s[40:43], s76 offen offset:0 lds
    s_add_u32 m0, s33, 18432
    s_nop 0
    buffer_load_dwordx4 v23, s[40:43], s76 offen offset:2048 lds
    v_mul_f32 v93, v93, v109
    v_exp_f32 v82, v82
    v_mul_f32 v94, v94, v110
    v_exp_f32 v83, v83
    v_mul_f32 v95, v95, v111
    v_fma_f32 v80, v80, v71, v71
    s_add_u32 m0, s33, 24576
    s_nop 0
    buffer_load_dwordx4 v23, s[44:47], s76 offen offset:0 lds
    v_fma_f32 v81, v81, v71, v71
    v_fma_f32 v82, v82, v71, v71
    v_fma_f32 v83, v83, v71, v71
    v_rcp_f32 v80, v80
    v_rcp_f32 v81, v81
    v_rcp_f32 v82, v82
    s_add_u32 m0, s33, 28672
    s_mov_b32 s77, 917504
    buffer_load_dwordx4 v22, s[48:51], s77 offen offset:0 lds
    v_rcp_f32 v83, v83
    s_nop 0
    v_mul_f32 v92, v92, v80
    v_mul_f32 v93, v93, v81
    v_mul_f32 v94, v94, v82
    v_mul_f32 v95, v95, v83
    v_cvt_pk_bf16_f32 v90, v92, v93
    v_cvt_pk_bf16_f32 v91, v94, v95
    s_add_u32 m0, s33, 32768
    s_nop 0
    buffer_load_dwordx4 v22, s[52:55], s77 offen offset:0 lds
    s_add_u32 s75, s75, 0x480000
    s_load_dword s94, s[10:11], s75 offset:0x0
    s_load_dword s94, s[10:11], s75 offset:0x40
    s_load_dword s94, s[10:11], s75 offset:0x80
    s_load_dword s94, s[10:11], s75 offset:0xc0
    v_mov_b32 v5, 0
    s_mov_b64 exec, 1
    global_load_dwordx2 v[6:7], v5, s[24:25] sc1
    s_mov_b64 exec, -1
    s_barrier
    s_add_u32 m0, s79, 135168
    s_mov_b32 s78, 384
    buffer_load_dwordx4 v20, s[36:39], s78 offen sc1 lds
    s_nop 1
    v_permlane16_swap_b32 v88, v90
    v_permlane16_swap_b32 v89, v91
    v_fmac_f32 v96, v24, v72
    v_fmac_f32 v97, v25, v72
    v_fmac_f32 v98, v26, v72
    v_fmac_f32 v99, v27, v72
    v_fmac_f32 v112, v28, v72
    v_fmac_f32 v113, v29, v72
    v_fmac_f32 v114, v30, v72
    v_fmac_f32 v115, v31, v72
    s_add_u32 m0, s79, 136192
    s_nop 0
    buffer_load_dwordx4 v21, s[36:39], s78 offen sc1 lds
    v_mul_f32 v80, v96, v96
    v_mul_f32 v81, v97, v97
    v_mul_f32 v82, v98, v98
    v_mul_f32 v83, v99, v99
    v_fma_f32 v80, v80, v74, v73
    v_fma_f32 v81, v81, v74, v73
    v_fma_f32 v82, v82, v74, v73
    v_fma_f32 v83, v83, v74, v73
    s_add_u32 m0, s33, 36864
    s_mov_b32 s76, 983040
    buffer_load_dwordx4 v23, s[40:43], s76 offen offset:0 lds
    v_mul_f32 v80, v80, v96
    v_mul_f32 v81, v81, v97
    v_mul_f32 v82, v82, v98
    v_mul_f32 v83, v83, v99
    v_exp_f32 v80, v80
    v_mul_f32 v96, v96, v112
    v_exp_f32 v81, v81
    s_add_u32 m0, s33, 38912
    s_nop 0
    buffer_load_dwordx4 v23, s[40:43], s76 offen offset:2048 lds
    s_add_u32 m0, s33, 45056
    s_nop 0
    buffer_load_dwordx4 v23, s[44:47], s76 offen offset:0 lds
    v_mul_f32 v97, v97, v113
    v_exp_f32 v82, v82
    v_mul_f32 v98, v98, v114
    v_exp_f32 v83, v83
    v_mul_f32 v99, v99, v115
    v_fma_f32 v80, v80, v75, v75
    s_add_u32 m0, s33, 49152
    s_mov_b32 s77, 1146880
    buffer_load_dwordx4 v22, s[48:51], s77 offen offset:0 lds
    v_fma_f32 v81, v81, v75, v75
    v_fma_f32 v82, v82, v75, v75
    v_fma_f32 v83, v83, v75, v75
    v_rcp_f32 v80, v80
    v_rcp_f32 v81, v81
    v_rcp_f32 v82, v82
    s_add_u32 m0, s33, 53248
    s_nop 0
    buffer_load_dwordx4 v22, s[52:55], s77 offen offset:0 lds
    v_rcp_f32 v83, v83
    s_nop 0
    v_mul_f32 v96, v96, v80
    v_mul_f32 v97, v97, v81
    v_mul_f32 v98, v98, v82
    v_mul_f32 v99, v99, v83
    v_cvt_pk_bf16_f32 v96, v96, v97
    v_cvt_pk_bf16_f32 v97, v98, v99
    buffer_store_dwordx4 v[88:91], v19, s[68:71], s72 offen offset:0 sc1
    s_load_dword s94, s[10:11], s75 offset:0x100
    s_load_dword s94, s[10:11], s75 offset:0x140
    s_load_dword s94, s[10:11], s75 offset:0x180
    s_load_dword s94, s[10:11], s75 offset:0x1c0
    s_waitcnt vmcnt(17)
    s_barrier
    s_add_u32 m0, s79, 137216
    s_mov_b32 s78, 33152
    buffer_load_dwordx4 v20, s[36:39], s78 offen sc1 lds
    v_fmac_f32 v100, v24, v76
    v_fmac_f32 v101, v25, v76
    v_fmac_f32 v102, v26, v76
    v_fmac_f32 v103, v27, v76
    v_fmac_f32 v116, v28, v76
    v_fmac_f32 v117, v29, v76
    v_fmac_f32 v118, v30, v76
    v_fmac_f32 v119, v31, v76
    s_add_u32 m0, s79, 138240
    s_nop 0
    buffer_load_dwordx4 v21, s[36:39], s78 offen sc1 lds
    v_mul_f32 v80, v100, v100
    v_mul_f32 v81, v101, v101
    v_mul_f32 v82, v102, v102
    v_mul_f32 v83, v103, v103
    v_fma_f32 v80, v80, v78, v77
    v_fma_f32 v81, v81, v78, v77
    v_fma_f32 v82, v82, v78, v77
    v_fma_f32 v83, v83, v78, v77
    s_add_u32 m0, s81, 151552
    s_mov_b32 s78, 384
    s_mov_b64 exec, 0xffffffff
    buffer_load_dwordx4 v3, s[36:39], s78 offen sc1 lds
    s_mov_b64 exec, -1
    v_mul_f32 v80, v80, v100
    v_mul_f32 v81, v81, v101
    v_mul_f32 v82, v82, v102
    v_mul_f32 v83, v83, v103
    v_exp_f32 v80, v80
    v_mul_f32 v100, v100, v116
    v_exp_f32 v81, v81
    s_add_u32 m0, s33, 57344
    s_mov_b32 s76, 1179648
    buffer_load_dwordx4 v23, s[40:43], s76 offen offset:0 lds
    s_add_u32 m0, s33, 59392
    s_nop 0
    buffer_load_dwordx4 v23, s[40:43], s76 offen offset:2048 lds
    v_mul_f32 v101, v101, v117
    v_exp_f32 v82, v82
    v_mul_f32 v102, v102, v118
    v_exp_f32 v83, v83
    v_mul_f32 v103, v103, v119
    v_fma_f32 v80, v80, v79, v79
    s_add_u32 m0, s33, 65536
    s_nop 0
    buffer_load_dwordx4 v23, s[44:47], s76 offen offset:0 lds
    v_fma_f32 v81, v81, v79, v79
    v_fma_f32 v82, v82, v79, v79
    v_fma_f32 v83, v83, v79, v79
    v_rcp_f32 v80, v80
    v_rcp_f32 v81, v81
    v_rcp_f32 v82, v82
    s_add_u32 m0, s33, 69632
    s_mov_b32 s77, 1376256
    buffer_load_dwordx4 v22, s[48:51], s77 offen offset:0 lds
    v_rcp_f32 v83, v83
    s_nop 0
    v_mul_f32 v100, v100, v80
    v_mul_f32 v101, v101, v81
    v_mul_f32 v102, v102, v82
    v_mul_f32 v103, v103, v83
    v_cvt_pk_bf16_f32 v98, v100, v101
    v_cvt_pk_bf16_f32 v99, v102, v103
    s_add_u32 m0, s33, 73728
    s_nop 0
    buffer_load_dwordx4 v22, s[52:55], s77 offen offset:0 lds
    s_add_u32 s99, s99, 0x540000
    s_load_dword s94, s[16:17], s99 offset:0x0
    s_load_dword s94, s[16:17], s99 offset:0x40
    s_load_dword s94, s[16:17], s99 offset:0x80
    s_load_dword s94, s[16:17], s99 offset:0xc0
    s_waitcnt vmcnt(17)
    s_barrier
    s_add_u32 m0, s79, 98304
    s_mov_b32 s78, 512
    buffer_load_dwordx4 v20, s[36:39], s78 offen sc1 lds
    s_nop 1
    v_permlane16_swap_b32 v96, v98
    v_permlane16_swap_b32 v97, v99
    v_fmac_f32 v120, v32, v64
    v_fmac_f32 v121, v33, v64
    v_fmac_f32 v122, v34, v64
    v_fmac_f32 v123, v35, v64
    v_fmac_f32 v136, v36, v64
    v_fmac_f32 v137, v37, v64
    v_fmac_f32 v138, v38, v64
    v_fmac_f32 v139, v39, v64
    s_add_u32 m0, s79, 99328
    s_nop 0
    buffer_load_dwordx4 v21, s[36:39], s78 offen sc1 lds
    v_mul_f32 v80, v120, v120
    v_mul_f32 v81, v121, v121
    v_mul_f32 v82, v122, v122
    v_mul_f32 v83, v123, v123
    v_fma_f32 v80, v80, v66, v65
    v_fma_f32 v81, v81, v66, v65
    v_fma_f32 v82, v82, v66, v65
    v_fma_f32 v83, v83, v66, v65
    s_add_u32 m0, s33, 77824
    s_mov_b32 s76, 1376256
    buffer_load_dwordx4 v23, s[40:43], s76 offen offset:0 lds
    v_mul_f32 v80, v80, v120
    v_mul_f32 v81, v81, v121
    v_mul_f32 v82, v82, v122
    v_mul_f32 v83, v83, v123
    v_exp_f32 v80, v80
    v_mul_f32 v120, v120, v136
    v_exp_f32 v81, v81
    s_add_u32 m0, s33, 79872
    s_nop 0
    buffer_load_dwordx4 v23, s[40:43], s76 offen offset:2048 lds
    s_add_u32 m0, s33, 86016
    s_nop 0
    buffer_load_dwordx4 v23, s[44:47], s76 offen offset:0 lds
    v_mul_f32 v121, v121, v137
    v_exp_f32 v82, v82
    v_mul_f32 v122, v122, v138
    v_exp_f32 v83, v83
    v_mul_f32 v123, v123, v139
    v_fma_f32 v80, v80, v67, v67
    s_add_u32 m0, s33, 90112
    s_mov_b32 s77, 1605632
    buffer_load_dwordx4 v22, s[48:51], s77 offen offset:0 lds
    v_fma_f32 v81, v81, v67, v67
    v_fma_f32 v82, v82, v67, v67
    v_fma_f32 v83, v83, v67, v67
    v_rcp_f32 v80, v80
    v_rcp_f32 v81, v81
    v_rcp_f32 v82, v82
    s_add_u32 m0, s33, 94208
    s_nop 0
    buffer_load_dwordx4 v22, s[52:55], s77 offen offset:0 lds
    v_rcp_f32 v83, v83
    s_nop 0
    v_mul_f32 v120, v120, v80
    v_mul_f32 v121, v121, v81
    v_mul_f32 v122, v122, v82
    v_mul_f32 v123, v123, v83
    v_cvt_pk_bf16_f32 v120, v120, v121
    v_cvt_pk_bf16_f32 v121, v122, v123
    buffer_store_dwordx4 v[96:99], v19, s[68:71], s72 offen offset:2048 sc1
    s_load_dword s94, s[16:17], s99 offset:0x100
    s_load_dword s94, s[16:17], s99 offset:0x140
    s_load_dword s94, s[16:17], s99 offset:0x180
    s_load_dword s94, s[16:17], s99 offset:0x1c0
    s_waitcnt vmcnt(17)
    s_barrier
    s_add_u32 m0, s79, 100352
    s_mov_b32 s78, 33280
    buffer_load_dwordx4 v20, s[36:39], s78 offen sc1 lds
    v_fmac_f32 v124, v32, v68
    v_fmac_f32 v125, v33, v68
    v_fmac_f32 v126, v34, v68
    v_fmac_f32 v127, v35, v68
    v_fmac_f32 v140, v36, v68
    v_fmac_f32 v141, v37, v68
    v_fmac_f32 v142, v38, v68
    v_fmac_f32 v143, v39, v68
    s_add_u32 m0, s79, 101376
    s_nop 0
    buffer_load_dwordx4 v21, s[36:39], s78 offen sc1 lds
    v_mul_f32 v80, v124, v124
    v_mul_f32 v81, v125, v125
    v_mul_f32 v82, v126, v126
    v_mul_f32 v83, v127, v127
    v_fma_f32 v80, v80, v70, v69
    v_fma_f32 v81, v81, v70, v69
    v_fma_f32 v82, v82, v70, v69
    v_fma_f32 v83, v83, v70, v69
    s_add_u32 m0, s81, 114688
    s_mov_b32 s78, 512
    s_mov_b64 exec, 0xffffffff
    buffer_load_dwordx4 v3, s[36:39], s78 offen sc1 lds
    s_mov_b64 exec, -1
    v_mul_f32 v80, v80, v124
    v_mul_f32 v81, v81, v125
    v_mul_f32 v82, v82, v126
    v_mul_f32 v83, v83, v127
    v_exp_f32 v80, v80
    v_mul_f32 v124, v124, v140
    v_exp_f32 v81, v81
    s_add_u32 m0, s33, 16384
    s_mov_b32 s76, 1572864
    buffer_load_dwordx4 v23, s[40:43], s76 offen offset:0 lds
    s_add_u32 m0, s33, 18432
    s_nop 0
    buffer_load_dwordx4 v23, s[40:43], s76 offen offset:2048 lds
    v_mul_f32 v125, v125, v141
    v_exp_f32 v82, v82
    v_mul_f32 v126, v126, v142
    v_exp_f32 v83, v83
    v_mul_f32 v127, v127, v143
    v_fma_f32 v80, v80, v71, v71
    s_add_u32 m0, s33, 24576
    s_nop 0
    buffer_load_dwordx4 v23, s[44:47], s76 offen offset:0 lds
    v_fma_f32 v81, v81, v71, v71
    v_fma_f32 v82, v82, v71, v71
    v_fma_f32 v83, v83, v71, v71
    v_rcp_f32 v80, v80
    v_rcp_f32 v81, v81
    v_rcp_f32 v82, v82
    s_add_u32 m0, s33, 28672
    s_mov_b32 s77, 1835008
    buffer_load_dwordx4 v22, s[48:51], s77 offen offset:0 lds
    v_rcp_f32 v83, v83
    s_nop 0
    v_mul_f32 v124, v124, v80
    v_mul_f32 v125, v125, v81
    v_mul_f32 v126, v126, v82
    v_mul_f32 v127, v127, v83
    v_cvt_pk_bf16_f32 v122, v124, v125
    v_cvt_pk_bf16_f32 v123, v126, v127
    s_add_u32 m0, s33, 32768
    s_nop 0
    buffer_load_dwordx4 v22, s[52:55], s77 offen offset:0 lds
    s_load_dword s94, s[18:19], s99 offset:0x0
    s_load_dword s94, s[18:19], s99 offset:0x40
    s_load_dword s94, s[18:19], s99 offset:0x80
    s_load_dword s94, s[18:19], s99 offset:0xc0
    s_waitcnt vmcnt(16)
    s_barrier
    s_add_u32 m0, s79, 116736
    s_mov_b32 s78, 640
    buffer_load_dwordx4 v20, s[36:39], s78 offen sc1 lds
    s_nop 1
    v_permlane16_swap_b32 v120, v122
    v_permlane16_swap_b32 v121, v123
    v_fmac_f32 v128, v32, v72
    v_fmac_f32 v129, v33, v72
    v_fmac_f32 v130, v34, v72
    v_fmac_f32 v131, v35, v72
    v_fmac_f32 v144, v36, v72
    v_fmac_f32 v145, v37, v72
    v_fmac_f32 v146, v38, v72
    v_fmac_f32 v147, v39, v72
    s_add_u32 m0, s79, 117760
    s_nop 0
    buffer_load_dwordx4 v21, s[36:39], s78 offen sc1 lds
    v_mul_f32 v80, v128, v128
    v_mul_f32 v81, v129, v129
    v_mul_f32 v82, v130, v130
    v_mul_f32 v83, v131, v131
    v_fma_f32 v80, v80, v74, v73
    v_fma_f32 v81, v81, v74, v73
    v_fma_f32 v82, v82, v74, v73
    v_fma_f32 v83, v83, v74, v73
    s_add_u32 m0, s33, 36864
    s_mov_b32 s76, 1769472
    buffer_load_dwordx4 v23, s[40:43], s76 offen offset:0 lds
    v_mul_f32 v80, v80, v128
    v_mul_f32 v81, v81, v129
    v_mul_f32 v82, v82, v130
    v_mul_f32 v83, v83, v131
    v_exp_f32 v80, v80
    v_mul_f32 v128, v128, v144
    v_exp_f32 v81, v81
    s_add_u32 m0, s33, 38912
    s_nop 0
    buffer_load_dwordx4 v23, s[40:43], s76 offen offset:2048 lds
    s_add_u32 m0, s33, 45056
    s_nop 0
    buffer_load_dwordx4 v23, s[44:47], s76 offen offset:0 lds
    v_mul_f32 v129, v129, v145
    v_exp_f32 v82, v82
    v_mul_f32 v130, v130, v146
    v_exp_f32 v83, v83
    v_mul_f32 v131, v131, v147
    v_fma_f32 v80, v80, v75, v75
    s_add_u32 m0, s33, 49152
    s_mov_b32 s77, 2064384
    buffer_load_dwordx4 v22, s[48:51], s77 offen offset:0 lds
    v_fma_f32 v81, v81, v75, v75
    v_fma_f32 v82, v82, v75, v75
    v_fma_f32 v83, v83, v75, v75
    v_rcp_f32 v80, v80
    v_rcp_f32 v81, v81
    v_rcp_f32 v82, v82
    s_add_u32 m0, s33, 53248
    s_nop 0
    buffer_load_dwordx4 v22, s[52:55], s77 offen offset:0 lds
    v_rcp_f32 v83, v83
    s_nop 0
    v_mul_f32 v128, v128, v80
    v_mul_f32 v129, v129, v81
    v_mul_f32 v130, v130, v82
    v_mul_f32 v131, v131, v83
    v_cvt_pk_bf16_f32 v128, v128, v129
    v_cvt_pk_bf16_f32 v129, v130, v131
    buffer_store_dwordx4 v[120:123], v19, s[68:71], s72 offen offset:512 sc1
    s_load_dword s94, s[18:19], s99 offset:0x100
    s_load_dword s94, s[18:19], s99 offset:0x140
    s_load_dword s94, s[18:19], s99 offset:0x180
    s_load_dword s94, s[18:19], s99 offset:0x1c0
    s_waitcnt vmcnt(17)
    s_barrier
    s_add_u32 m0, s79, 118784
    s_mov_b32 s78, 33408
    buffer_load_dwordx4 v20, s[36:39], s78 offen sc1 lds
    v_fmac_f32 v132, v32, v76
    v_fmac_f32 v133, v33, v76
    v_fmac_f32 v134, v34, v76
    v_fmac_f32 v135, v35, v76
    v_fmac_f32 v148, v36, v76
    v_fmac_f32 v149, v37, v76
    v_fmac_f32 v150, v38, v76
    v_fmac_f32 v151, v39, v76
    s_add_u32 m0, s79, 119808
    s_nop 0
    buffer_load_dwordx4 v21, s[36:39], s78 offen sc1 lds
    v_mul_f32 v80, v132, v132
    v_mul_f32 v81, v133, v133
    v_mul_f32 v82, v134, v134
    v_mul_f32 v83, v135, v135
    v_fma_f32 v80, v80, v78, v77
    v_fma_f32 v81, v81, v78, v77
    v_fma_f32 v82, v82, v78, v77
    v_fma_f32 v83, v83, v78, v77
    s_add_u32 m0, s81, 133120
    s_mov_b32 s78, 640
    s_mov_b64 exec, 0xffffffff
    buffer_load_dwordx4 v3, s[36:39], s78 offen sc1 lds
    s_mov_b64 exec, -1
    v_mul_f32 v80, v80, v132
    v_mul_f32 v81, v81, v133
    v_mul_f32 v82, v82, v134
    v_mul_f32 v83, v83, v135
    v_exp_f32 v80, v80
    v_mul_f32 v132, v132, v148
    v_exp_f32 v81, v81
    s_add_u32 m0, s33, 57344
    s_mov_b32 s76, 1966080
    buffer_load_dwordx4 v23, s[40:43], s76 offen offset:0 lds
    s_add_u32 m0, s33, 59392
    s_nop 0
    buffer_load_dwordx4 v23, s[40:43], s76 offen offset:2048 lds
    v_mul_f32 v133, v133, v149
    v_exp_f32 v82, v82
    v_mul_f32 v134, v134, v150
    v_exp_f32 v83, v83
    v_mul_f32 v135, v135, v151
    v_fma_f32 v80, v80, v79, v79
    s_add_u32 m0, s33, 65536
    s_nop 0
    buffer_load_dwordx4 v23, s[44:47], s76 offen offset:0 lds
    v_fma_f32 v81, v81, v79, v79
    v_fma_f32 v82, v82, v79, v79
    v_fma_f32 v83, v83, v79, v79
    v_rcp_f32 v80, v80
    v_rcp_f32 v81, v81
    v_rcp_f32 v82, v82
    s_add_u32 m0, s33, 69632
    s_mov_b32 s77, 2293760
    buffer_load_dwordx4 v22, s[48:51], s77 offen offset:0 lds
    v_rcp_f32 v83, v83
    s_nop 0
    v_mul_f32 v132, v132, v80
    v_mul_f32 v133, v133, v81
    v_mul_f32 v134, v134, v82
    v_mul_f32 v135, v135, v83
    v_cvt_pk_bf16_f32 v130, v132, v133
    v_cvt_pk_bf16_f32 v131, v134, v135
    s_add_u32 m0, s33, 73728
    s_nop 0
    buffer_load_dwordx4 v22, s[52:55], s77 offen offset:0 lds
    s_load_dword s94, s[10:11], s75 offset:0x80000
L_pad1:
    s_cbranch_execz L_vret1
    s_load_dword s94, s[10:11], s75 offset:0x80040
    s_load_dword s94, s[10:11], s75 offset:0x80080
    s_load_dword s94, s[10:11], s75 offset:0x800c0
    s_waitcnt vmcnt(16)
    s_barrier
    s_add_u32 m0, s79, 135168
    s_mov_b32 s78, 768
    buffer_load_dwordx4 v20, s[36:39], s78 offen sc1 lds
    s_nop 1
    v_permlane16_swap_b32 v128, v130
    v_permlane16_swap_b32 v129, v131
    v_fmac_f32 v152, v40, v64
    v_fmac_f32 v153, v41, v64
    v_fmac_f32 v154, v42, v64
    v_fmac_f32 v155, v43, v64
    v_fmac_f32 v168, v44, v64
    v_fmac_f32 v169, v45, v64
    v_fmac_f32 v170, v46, v64
    v_fmac_f32 v171, v47, v64
    s_add_u32 m0, s79, 136192
    s_nop 0
    buffer_load_dwordx4 v21, s[36:39], s78 offen sc1 lds
    v_mul_f32 v80, v152, v152
    v_mul_f32 v81, v153, v153
    v_mul_f32 v82, v154, v154
    v_mul_f32 v83, v155, v155
    v_fma_f32 v80, v80, v66, v65
    v_fma_f32 v81, v81, v66, v65
    v_fma_f32 v82, v82, v66, v65
    v_fma_f32 v83, v83, v66, v65
    s_add_u32 m0, s33, 77824
    s_mov_b32 s76, 2162688
    buffer_load_dwordx4 v23, s[40:43], s76 offen offset:0 lds
    v_mul_f32 v80, v80, v152
    v_mul_f32 v81, v81, v153
    v_mul_f32 v82, v82, v154
    v_mul_f32 v83, v83, v155
    v_exp_f32 v80, v80
    v_mul_f32 v152, v152, v168
    v_exp_f32 v81, v81
    s_add_u32 m0, s33, 79872
    s_nop 0
    buffer_load_dwordx4 v23, s[40:43], s76 offen offset:2048 lds
    s_add_u32 m0, s33, 86016
    s_nop 0
    buffer_load_dwordx4 v23, s[44:47], s76 offen offset:0 lds
    v_mul_f32 v153, v153, v169
    v_exp_f32 v82, v82
    v_mul_f32 v154, v154, v170
    v_exp_f32 v83, v83
    v_mul_f32 v155, v155, v171
    v_fma_f32 v80, v80, v67, v67
    s_add_u32 m0, s33, 90112
    s_mov_b32 s77, 2523136
    buffer_load_dwordx4 v22, s[48:51], s77 offen offset:0 lds
    v_fma_f32 v81, v81, v67, v67
    v_fma_f32 v82, v82, v67, v67
    v_fma_f32 v83, v83, v67, v67
    v_rcp_f32 v80, v80
    v_rcp_f32 v81, v81
    v_rcp_f32 v82, v82
    s_add_u32 m0, s33, 94208
    s_nop 0
    buffer_load_dwordx4 v22, s[52:55], s77 offen offset:0 lds
    v_rcp_f32 v83, v83
    s_nop 0
    v_mul_f32 v152, v152, v80
    v_mul_f32 v153, v153, v81
    v_mul_f32 v154, v154, v82
    v_mul_f32 v155, v155, v83
    v_cvt_pk_bf16_f32 v152, v152, v153
    v_cvt_pk_bf16_f32 v153, v154, v155
    buffer_store_dwordx4 v[128:131], v19, s[68:71], s72 offen offset:2560 sc1
    s_load_dword s94, s[10:11], s75 offset:0x80100
    s_load_dword s94, s[10:11], s75 offset:0x80140
    s_load_dword s94, s[10:11], s75 offset:0x80180
    s_load_dword s94, s[10:11], s75 offset:0x801c0
    s_waitcnt vmcnt(56)
    s_movk_i32 s98, 0x4000
L_tokA_chk:
    v_readfirstlane_b32 s100, v6
    v_readfirstlane_b32 s101, v7
    s_nop 1
    s_cmp_lg_u32 s100, 0
    s_cbranch_scc1 L_tokA_ok
    s_sub_u32 s98, s98, 1
    s_cbranch_scc1 L_tokA_ok
    s_sleep 1
    global_load_dwordx2 v[6:7], v5, s[24:25] sc1
    s_waitcnt vmcnt(0)
    s_branch L_tokA_chk
L_tokA_ok:
    s_waitcnt vmcnt(17)
    s_barrier
    s_add_u32 m0, s79, 137216
    s_mov_b32 s78, 33536
    buffer_load_dwordx4 v20, s[36:39], s78 offen sc1 lds
    v_fmac_f32 v156, v40, v68
    v_fmac_f32 v157, v41, v68
    v_fmac_f32 v158, v42, v68
    v_fmac_f32 v159, v43, v68
    v_fmac_f32 v172, v44, v68
    v_fmac_f32 v173, v45, v68
    v_fmac_f32 v174, v46, v68
    v_fmac_f32 v175, v47, v68
    s_add_u32 m0, s79, 138240
    s_nop 0
    buffer_load_dwordx4 v21, s[36:39], s78 offen sc1 lds
    v_mul_f32 v80, v156, v156
    v_mul_f32 v81, v157, v157
    v_mul_f32 v82, v158, v158
    v_mul_f32 v83, v159, v159
    v_fma_f32 v80, v80, v70, v69
    v_fma_f32 v81, v81, v70, v69
    v_fma_f32 v82, v82, v70, v69
    v_fma_f32 v83, v83, v70, v69
    s_add_u32 m0, s81, 151552
    s_mov_b32 s78, 768
    s_mov_b64 exec, 0xffffffff
    buffer_load_dwordx4 v3, s[36:39], s78 offen sc1 lds
    s_mov_b64 exec, -1
    v_mul_f32 v80, v80, v156
    v_mul_f32 v81, v81, v157
    v_mul_f32 v82, v82, v158
    v_mul_f32 v83, v83, v159
    v_exp_f32 v80, v80
    v_mul_f32 v156, v156, v172
    v_exp_f32 v81, v81
    s_add_u32 m0, s33, 16384
    s_mov_b32 s76, 2359296
    buffer_load_dwordx4 v23, s[40:43], s76 offen offset:0 lds
    s_add_u32 m0, s33, 18432
    s_nop 0
    buffer_load_dwordx4 v23, s[40:43], s76 offen offset:2048 lds
    v_mul_f32 v157, v157, v173
    v_exp_f32 v82, v82
    v_mul_f32 v158, v158, v174
    v_exp_f32 v83, v83
    v_mul_f32 v159, v159, v175
    v_fma_f32 v80, v80, v71, v71
    s_add_u32 m0, s33, 24576
    s_nop 0
    buffer_load_dwordx4 v23, s[44:47], s76 offen offset:0 lds
    v_fma_f32 v81, v81, v71, v71
    v_fma_f32 v82, v82, v71, v71
    v_fma_f32 v83, v83, v71, v71
    v_rcp_f32 v80, v80
    v_rcp_f32 v81, v81
    v_rcp_f32 v82, v82
    s_add_u32 m0, s33, 28672
    s_mov_b32 s77, 2752512
    buffer_load_dwordx4 v22, s[48:51], s77 offen offset:0 lds
    v_rcp_f32 v83, v83
    s_nop 0
    v_mul_f32 v156, v156, v80
    v_mul_f32 v157, v157, v81
    v_mul_f32 v158, v158, v82
    v_mul_f32 v159, v159, v83
    v_cvt_pk_bf16_f32 v154, v156, v157
    v_cvt_pk_bf16_f32 v155, v158, v159
    s_add_u32 m0, s33, 32768
    s_nop 0
    buffer_load_dwordx4 v22, s[52:55], s77 offen offset:0 lds
    s_add_u32 s75, s75, 0x100000
    s_load_dword s94, s[10:11], s75 offset:0x0
    s_load_dword s94, s[10:11], s75 offset:0x40
    s_load_dword s94, s[10:11], s75 offset:0x80
    s_load_dword s94, s[10:11], s75 offset:0xc0
    s_waitcnt vmcnt(16)
    s_barrier
    s_add_u32 m0, s79, 98304
    s_mov_b32 s78, 896
    buffer_load_dwordx4 v20, s[36:39], s78 offen sc1 lds
    s_nop 1
    v_permlane16_swap_b32 v152, v154
    v_permlane16_swap_b32 v153, v155
    v_fmac_f32 v160, v40, v72
    v_fmac_f32 v161, v41, v72
    v_fmac_f32 v162, v42, v72
    v_fmac_f32 v163, v43, v72
    v_fmac_f32 v176, v44, v72
    v_fmac_f32 v177, v45, v72
    v_fmac_f32 v178, v46, v72
    v_fmac_f32 v179, v47, v72
    s_add_u32 m0, s79, 99328
    s_nop 0
    buffer_load_dwordx4 v21, s[36:39], s78 offen sc1 lds
    v_mul_f32 v80, v160, v160
    v_mul_f32 v81, v161, v161
    v_mul_f32 v82, v162, v162
    v_mul_f32 v83, v163, v163
    v_fma_f32 v80, v80, v74, v73
    v_fma_f32 v81, v81, v74, v73
    v_fma_f32 v82, v82, v74, v73
    v_fma_f32 v83, v83, v74, v73
    s_add_u32 m0, s33, 36864
    s_mov_b32 s76, 2555904
    buffer_load_dwordx4 v23, s[40:43], s76 offen offset:0 lds
    v_mul_f32 v80, v80, v160
    v_mul_f32 v81, v81, v161
    v_mul_f32 v82, v82, v162
    v_mul_f32 v83, v83, v163
    v_exp_f32 v80, v80
    v_mul_f32 v160, v160, v176
    v_exp_f32 v81, v81
    s_add_u32 m0, s33, 38912
    s_nop 0
    buffer_load_dwordx4 v23, s[40:43], s76 offen offset:2048 lds
    s_add_u32 m0, s33, 45056
    s_nop 0
    buffer_load_dwordx4 v23, s[44:47], s76 offen offset:0 lds
    v_mul_f32 v161, v161, v177
    v_exp_f32 v82, v82
    v_mul_f32 v162, v162, v178
    v_exp_f32 v83, v83
    v_mul_f32 v163, v163, v179
    v_fma_f32 v80, v80, v75, v75
    s_add_u32 m0, s33, 49152
    s_mov_b32 s77, 2981888
    buffer_load_dwordx4 v22, s[48:51], s77 offen offset:0 lds
    v_fma_f32 v81, v81, v75, v75
    v_fma_f32 v82, v82, v75, v75
    v_fma_f32 v83, v83, v75, v75
    v_rcp_f32 v80, v80
    v_rcp_f32 v81, v81
    v_rcp_f32 v82, v82
    s_add_u32 m0, s33, 53248
    s_nop 0
    buffer_load_dwordx4 v22, s[52:55], s77 offen offset:0 lds
    v_rcp_f32 v83, v83
    s_nop 0
    v_mul_f32 v160, v160, v80
    v_mul_f32 v161, v161, v81
    v_mul_f32 v162, v162, v82
    v_mul_f32 v163, v163, v83
    v_cvt_pk_bf16_f32 v160, v160, v161
    v_cvt_pk_bf16_f32 v161, v162, v163
    buffer_store_dwordx4 v[152:155], v19, s[68:71], s73 offen offset:0 sc1
    s_load_dword s94, s[10:11], s75 offset:0x100
    s_load_dword s94, s[10:11], s75 offset:0x140
    s_load_dword s94, s[10:11], s75 offset:0x180
    s_load_dword s94, s[10:11], s75 offset:0x1c0
    s_waitcnt vmcnt(17)
    s_barrier
    s_add_u32 m0, s79, 100352
    s_mov_b32 s78, 33664
    buffer_load_dwordx4 v20, s[36:39], s78 offen sc1 lds
    v_fmac_f32 v164, v40, v76
    v_fmac_f32 v165, v41, v76
    v_fmac_f32 v166, v42, v76
    v_fmac_f32 v167, v43, v76
    v_fmac_f32 v180, v44, v76
    v_fmac_f32 v181, v45, v76
    v_fmac_f32 v182, v46, v76
    v_fmac_f32 v183, v47, v76
    s_add_u32 m0, s79, 101376
    s_nop 0
    buffer_load_dwordx4 v21, s[36:39], s78 offen sc1 lds
    v_mul_f32 v80, v164, v164
    v_mul_f32 v81, v165, v165
    v_mul_f32 v82, v166, v166
    v_mul_f32 v83, v167, v167
    v_fma_f32 v80, v80, v78, v77
    v_fma_f32 v81, v81, v78, v77
    v_fma_f32 v82, v82, v78, v77
    v_fma_f32 v83, v83, v78, v77
    s_add_u32 m0, s81, 114688
    s_mov_b32 s78, 896
    s_mov_b64 exec, 0xffffffff
    buffer_load_dwordx4 v3, s[36:39], s78 offen sc1 lds
    s_mov_b64 exec, -1
    v_mul_f32 v80, v80, v164
    v_mul_f32 v81, v81, v165
    v_mul_f32 v82, v82, v166
    v_mul_f32 v83, v83, v167
    v_exp_f32 v80, v80
    v_mul_f32 v164, v164, v180
    v_exp_f32 v81, v81
    s_add_u32 m0, s33, 57344
    s_mov_b32 s76, 2752512
    buffer_load_dwordx4 v23, s[40:43], s76 offen offset:0 lds
    s_add_u32 m0, s33, 59392
    s_nop 0
    buffer_load_dwordx4 v23, s[40:43], s76 offen offset:2048 lds
    v_mul_f32 v165, v165, v181
    v_exp_f32 v82, v82
    v_mul_f32 v166, v166, v182
    v_exp_f32 v83, v83
    v_mul_f32 v167, v167, v183
    v_fma_f32 v80, v80, v79, v79
    s_add_u32 m0, s33, 65536
    s_nop 0
    buffer_load_dwordx4 v23, s[44:47], s76 offen offset:0 lds
    v_fma_f32 v81, v81, v79, v79
    v_fma_f32 v82, v82, v79, v79
    v_fma_f32 v83, v83, v79, v79
    v_rcp_f32 v80, v80
    v_rcp_f32 v81, v81
    v_rcp_f32 v82, v82
    s_add_u32 m0, s33, 69632
    s_mov_b32 s77, 3211264
    buffer_load_dwordx4 v22, s[48:51], s77 offen offset:0 lds
    v_rcp_f32 v83, v83
    s_nop 0
    v_mul_f32 v164, v164, v80
    v_mul_f32 v165, v165, v81
    v_mul_f32 v166, v166, v82
    v_mul_f32 v167, v167, v83
    v_cvt_pk_bf16_f32 v162, v164, v165
    v_cvt_pk_bf16_f32 v163, v166, v167
    s_add_u32 m0, s33, 73728
    s_nop 0
    buffer_load_dwordx4 v22, s[52:55], s77 offen offset:0 lds
    s_add_u32 s75, s75, 0xffa80000
    s_load_dword s94, s[20:21], s75 offset:0x0
    s_load_dword s94, s[20:21], s75 offset:0x40
    s_load_dword s94, s[20:21], s75 offset:0x80
    s_load_dword s94, s[20:21], s75 offset:0xc0
    s_waitcnt vmcnt(16)
    s_barrier
    s_add_u32 m0, s79, 116736
    s_mov_b32 s78, 1024
    buffer_load_dwordx4 v20, s[36:39], s78 offen sc1 lds
    s_nop 1
    v_permlane16_swap_b32 v160, v162
    v_permlane16_swap_b32 v161, v163
    v_fmac_f32 v184, v48, v64
    v_fmac_f32 v185, v49, v64
    v_fmac_f32 v186, v50, v64
    v_fmac_f32 v187, v51, v64
    v_fmac_f32 v200, v52, v64
    v_fmac_f32 v201, v53, v64
    v_fmac_f32 v202, v54, v64
    v_fmac_f32 v203, v55, v64
    s_add_u32 m0, s79, 117760
    s_nop 0
    buffer_load_dwordx4 v21, s[36:39], s78 offen sc1 lds
    v_mul_f32 v80, v184, v184
    v_mul_f32 v81, v185, v185
    v_mul_f32 v82, v186, v186
    v_mul_f32 v83, v187, v187
    v_fma_f32 v80, v80, v66, v65
    v_fma_f32 v81, v81, v66, v65
    v_fma_f32 v82, v82, v66, v65
    v_fma_f32 v83, v83, v66, v65
    s_add_u32 m0, s33, 77824
    s_mov_b32 s76, 2949120
    buffer_load_dwordx4 v23, s[40:43], s76 offen offset:0 lds
    v_mul_f32 v80, v80, v184
    v_mul_f32 v81, v81, v185
    v_mul_f32 v82, v82, v186
    v_mul_f32 v83, v83, v187
    v_exp_f32 v80, v80
    v_mul_f32 v184, v184, v200
    v_exp_f32 v81, v81
    s_add_u32 m0, s33, 79872
    s_nop 0
    buffer_load_dwordx4 v23, s[40:43], s76 offen offset:2048 lds
    s_add_u32 m0, s33, 86016
    s_nop 0
    buffer_load_dwordx4 v23, s[44:47], s76 offen offset:0 lds
    v_mul_f32 v185, v185, v201
    v_exp_f32 v82, v82
    v_mul_f32 v186, v186, v202
    v_exp_f32 v83, v83
    v_mul_f32 v187, v187, v203
    v_fma_f32 v80, v80, v67, v67
    s_add_u32 m0, s33, 90112
    s_mov_b32 s77, 3440640
    buffer_load_dwordx4 v22, s[48:51], s77 offen offset:0 lds
    v_fma_f32 v81, v81, v67, v67
    v_fma_f32 v82, v82, v67, v67
    v_fma_f32 v83, v83, v67, v67
    v_rcp_f32 v80, v80
    v_rcp_f32 v81, v81
    v_rcp_f32 v82, v82
    s_add_u32 m0, s33, 94208
    s_nop 0
    buffer_load_dwordx4 v22, s[52:55], s77 offen offset:0 lds
    v_rcp_f32 v83, v83
    s_nop 0
    v_mul_f32 v184, v184, v80
    v_mul_f32 v185, v185, v81
    v_mul_f32 v186, v186, v82
    v_mul_f32 v187, v187, v83
    v_cvt_pk_bf16_f32 v184, v184, v185
    v_cvt_pk_bf16_f32 v185, v186, v187
    buffer_store_dwordx4 v[160:163], v19, s[68:71], s73 offen offset:2048 sc1
    s_load_dword s94, s[20:21], s75 offset:0x100
    s_load_dword s94, s[20:21], s75 offset:0x140
    s_load_dword s94, s[20:21], s75 offset:0x180
    s_load_dword s94, s[20:21], s75 offset:0x1c0
    s_waitcnt vmcnt(17)
    s_barrier
    s_add_u32 m0, s79, 118784
    s_mov_b32 s78, 33792
    buffer_load_dwordx4 v20, s[36:39], s78 offen sc1 lds
    v_fmac_f32 v188, v48, v68
    v_fmac_f32 v189, v49, v68
    v_fmac_f32 v190, v50, v68
    v_fmac_f32 v191, v51, v68
    v_fmac_f32 v204, v52, v68
    v_fmac_f32 v205, v53, v68
    v_fmac_f32 v206, v54, v68
    v_fmac_f32 v207, v55, v68
    s_add_u32 m0, s79, 119808
    s_nop 0
    buffer_load_dwordx4 v21, s[36:39], s78 offen sc1 lds
    v_mul_f32 v80, v188, v188
    v_mul_f32 v81, v189, v189
    v_mul_f32 v82, v190, v190
    v_mul_f32 v83, v191, v191
    v_fma_f32 v80, v80, v70, v69
    v_fma_f32 v81, v81, v70, v69
    v_fma_f32 v82, v82, v70, v69
    v_fma_f32 v83, v83, v70, v69
    s_add_u32 m0, s81, 133120
    s_mov_b32 s78, 1024
    s_mov_b64 exec, 0xffffffff
    buffer_load_dwordx4 v3, s[36:39], s78 offen sc1 lds
    s_mov_b64 exec, -1
    v_mul_f32 v80, v80, v188
    v_mul_f32 v81, v81, v189
    v_mul_f32 v82, v82, v190
    v_mul_f32 v83, v83, v191
    v_exp_f32 v80, v80
    v_mul_f32 v188, v188, v204
    v_exp_f32 v81, v81
    s_add_u32 m0, s33, 16384
    s_mov_b32 s76, 3145728
    buffer_load_dwordx4 v23, s[40:43], s76 offen offset:0 lds
    s_add_u32 m0, s33, 18432
    s_nop 0
    buffer_load_dwordx4 v23, s[40:43], s76 offen offset:2048 lds
    v_mul_f32 v189, v189, v205
    v_exp_f32 v82, v82
    v_mul_f32 v190, v190, v206
    v_exp_f32 v83, v83
    v_mul_f32 v191, v191, v207
    v_fma_f32 v80, v80, v71, v71
    s_add_u32 m0, s33, 24576
    s_nop 0
    buffer_load_dwordx4 v23, s[44:47], s76 offen offset:0 lds
    v_fma_f32 v81, v81, v71, v71
    v_fma_f32 v82, v82, v71, v71
    v_fma_f32 v83, v83, v71, v71
    v_rcp_f32 v80, v80
    v_rcp_f32 v81, v81
    v_rcp_f32 v82, v82
    s_add_u32 m0, s33, 28672
    s_mov_b32 s77, 3670016
    buffer_load_dwordx4 v22, s[48:51], s77 offen offset:0 lds
    v_rcp_f32 v83, v83
    s_nop 0
    v_mul_f32 v188, v188, v80
    v_mul_f32 v189, v189, v81
    v_mul_f32 v190, v190, v82
    v_mul_f32 v191, v191, v83
    v_cvt_pk_bf16_f32 v186, v188, v189
    v_cvt_pk_bf16_f32 v187, v190, v191
    s_add_u32 m0, s33, 32768
    s_nop 0
    buffer_load_dwordx4 v22, s[52:55], s77 offen offset:0 lds
    s_add_u32 s75, s75, 0x280000
    s_load_dword s94, s[20:21], s75 offset:0x0
    s_load_dword s94, s[20:21], s75 offset:0x40
    s_load_dword s94, s[20:21], s75 offset:0x80
    s_load_dword s94, s[20:21], s75 offset:0xc0
    s_waitcnt vmcnt(16)
    s_barrier
    s_add_u32 m0, s79, 135168
    s_mov_b32 s78, 1152
    buffer_load_dwordx4 v20, s[36:39], s78 offen sc1 lds
    s_nop 1
    v_permlane16_swap_b32 v184, v186
    v_permlane16_swap_b32 v185, v187
    v_fmac_f32 v192, v48, v72
    v_fmac_f32 v193, v49, v72
    v_fmac_f32 v194, v50, v72
    v_fmac_f32 v195, v51, v72
    v_fmac_f32 v208, v52, v72
    v_fmac_f32 v209, v53, v72
    v_fmac_f32 v210, v54, v72
    v_fmac_f32 v211, v55, v72
    s_add_u32 m0, s79, 136192
    s_nop 0
    buffer_load_dwordx4 v21, s[36:39], s78 offen sc1 lds
    v_mul_f32 v80, v192, v192
    v_mul_f32 v81, v193, v193
    v_mul_f32 v82, v194, v194
    v_mul_f32 v83, v195, v195
    v_fma_f32 v80, v80, v74, v73
    v_fma_f32 v81, v81, v74, v73
    v_fma_f32 v82, v82, v74, v73
    v_fma_f32 v83, v83, v74, v73
    s_add_u32 m0, s33, 36864
    s_mov_b32 s76, 3342336
    buffer_load_dwordx4 v23, s[40:43], s76 offen offset:0 lds
    v_mul_f32 v80, v80, v192
    v_mul_f32 v81, v81, v193
    v_mul_f32 v82, v82, v194
    v_mul_f32 v83, v83, v195
    v_exp_f32 v80, v80
    v_mul_f32 v192, v192, v208
    v_exp_f32 v81, v81
    s_add_u32 m0, s33, 38912
    s_nop 0
    buffer_load_dwordx4 v23, s[40:43], s76 offen offset:2048 lds
    s_add_u32 m0, s33, 45056
    s_nop 0
    buffer_load_dwordx4 v23, s[44:47], s76 offen offset:0 lds
    v_mul_f32 v193, v193, v209
    v_exp_f32 v82, v82
    v_mul_f32 v194, v194, v210
    v_exp_f32 v83, v83
    v_mul_f32 v195, v195, v211
    v_fma_f32 v80, v80, v75, v75
    s_add_u32 m0, s33, 49152
    s_mov_b32 s77, 3899392
    buffer_load_dwordx4 v22, s[48:51], s77 offen offset:0 lds
    v_fma_f32 v81, v81, v75, v75
    v_fma_f32 v82, v82, v75, v75
    v_fma_f32 v83, v83, v75, v75
    v_rcp_f32 v80, v80
    v_rcp_f32 v81, v81
    v_rcp_f32 v82, v82
    s_add_u32 m0, s33, 53248
    s_nop 0
    buffer_load_dwordx4 v22, s[52:55], s77 offen offset:0 lds
    v_rcp_f32 v83, v83
    s_nop 0
    v_mul_f32 v192, v192, v80
    v_mul_f32 v193, v193, v81
    v_mul_f32 v194, v194, v82
    v_mul_f32 v195, v195, v83
    v_cvt_pk_bf16_f32 v192, v192, v193
    v_cvt_pk_bf16_f32 v193, v194, v195
    buffer_store_dwordx4 v[184:187], v19, s[68:71], s73 offen offset:512 sc1
    s_load_dword s94, s[20:21], s75 offset:0x100
    s_load_dword s94, s[20:21], s75 offset:0x140
    s_load_dword s94, s[20:21], s75 offset:0x180
    s_load_dword s94, s[20:21], s75 offset:0x1c0
    s_waitcnt vmcnt(17)
    s_barrier
    s_add_u32 m0, s79, 137216
    s_mov_b32 s78, 33920
    buffer_load_dwordx4 v20, s[36:39], s78 offen sc1 lds
    v_fmac_f32 v196, v48, v76
    v_fmac_f32 v197, v49, v76
    v_fmac_f32 v198, v50, v76
    v_fmac_f32 v199, v51, v76
    v_fmac_f32 v212, v52, v76
    v_fmac_f32 v213, v53, v76
    v_fmac_f32 v214, v54, v76
    v_fmac_f32 v215, v55, v76
    s_add_u32 m0, s79, 138240
    s_nop 0
    buffer_load_dwordx4 v21, s[36:39], s78 offen sc1 lds
    v_mul_f32 v80, v196, v196
    v_mul_f32 v81, v197, v197
    v_mul_f32 v82, v198, v198
    v_mul_f32 v83, v199, v199
    v_fma_f32 v80, v80, v78, v77
    v_fma_f32 v81, v81, v78, v77
    v_fma_f32 v82, v82, v78, v77
    v_fma_f32 v83, v83, v78, v77
    s_add_u32 m0, s81, 151552
    s_mov_b32 s78, 1152
    s_mov_b64 exec, 0xffffffff
    buffer_load_dwordx4 v3, s[36:39], s78 offen sc1 lds
    s_mov_b64 exec, -1
    v_mul_f32 v80, v80, v196
    v_mul_f32 v81, v81, v197
    v_mul_f32 v82, v82, v198
    v_mul_f32 v83, v83, v199
    v_exp_f32 v80, v80
    v_mul_f32 v196, v196, v212
    v_exp_f32 v81, v81
    s_add_u32 m0, s33, 57344
    s_mov_b32 s76, 3538944
    buffer_load_dwordx4 v23, s[40:43], s76 offen offset:0 lds
    s_add_u32 m0, s33, 59392
    s_nop 0
    buffer_load_dwordx4 v23, s[40:43], s76 offen offset:2048 lds
    v_mul_f32 v197, v197, v213
    v_exp_f32 v82, v82
    v_mul_f32 v198, v198, v214
    v_exp_f32 v83, v83
    v_mul_f32 v199, v199, v215
    v_fma_f32 v80, v80, v79, v79
    s_add_u32 m0, s33, 65536
    s_nop 0
    buffer_load_dwordx4 v23, s[44:47], s76 offen offset:0 lds
    v_fma_f32 v81, v81, v79, v79
    v_fma_f32 v82, v82, v79, v79
    v_fma_f32 v83, v83, v79, v79
    v_rcp_f32 v80, v80
    v_rcp_f32 v81, v81
    v_rcp_f32 v82, v82
    s_add_u32 m0, s33, 69632
    s_mov_b32 s77, 4128768
    buffer_load_dwordx4 v22, s[48:51], s77 offen offset:0 lds
    v_rcp_f32 v83, v83
    s_nop 0
    v_mul_f32 v196, v196, v80
    v_mul_f32 v197, v197, v81
    v_mul_f32 v198, v198, v82
    v_mul_f32 v199, v199, v83
    v_cvt_pk_bf16_f32 v194, v196, v197
    v_cvt_pk_bf16_f32 v195, v198, v199
    s_add_u32 m0, s33, 73728
    s_nop 0
    buffer_load_dwordx4 v22, s[52:55], s77 offen offset:0 lds
    s_add_u32 s75, s75, 0xffe00000
    s_load_dword s94, s[20:21], s75 offset:0x0
    s_load_dword s94, s[20:21], s75 offset:0x40
    s_load_dword s94, s[20:21], s75 offset:0x80
    s_load_dword s94, s[20:21], s75 offset:0xc0
    s_waitcnt vmcnt(16)
    s_barrier
    s_add_u32 m0, s79, 98304
    s_mov_b32 s78, 1280
    buffer_load_dwordx4 v20, s[36:39], s78 offen sc1 lds
    s_nop 1
    v_permlane16_swap_b32 v192, v194
    v_permlane16_swap_b32 v193, v195
    v_fmac_f32 v216, v56, v64
    v_fmac_f32 v217, v57, v64
    v_fmac_f32 v218, v58, v64
    v_fmac_f32 v219, v59, v64
    v_fmac_f32 v232, v60, v64
    v_fmac_f32 v233, v61, v64
    v_fmac_f32 v234, v62, v64
    v_fmac_f32 v235, v63, v64
    s_add_u32 m0, s79, 99328
    s_nop 0
    buffer_load_dwordx4 v21, s[36:39], s78 offen sc1 lds
    v_mul_f32 v80, v216, v216
    v_mul_f32 v81, v217, v217
    v_mul_f32 v82, v218, v218
    v_mul_f32 v83, v219, v219
    v_fma_f32 v80, v80, v66, v65
    v_fma_f32 v81, v81, v66, v65
    v_fma_f32 v82, v82, v66, v65
    v_fma_f32 v83, v83, v66, v65
    s_add_u32 m0, s33, 77824
    s_mov_b32 s76, 3735552
    buffer_load_dwordx4 v23, s[40:43], s76 offen offset:0 lds
    v_mul_f32 v80, v80, v216
    v_mul_f32 v81, v81, v217
    v_mul_f32 v82, v82, v218
    v_mul_f32 v83, v83, v219
    v_exp_f32 v80, v80
    v_mul_f32 v216, v216, v232
    v_exp_f32 v81, v81
    s_add_u32 m0, s33, 79872
    s_nop 0
    buffer_load_dwordx4 v23, s[40:43], s76 offen offset:2048 lds
    s_add_u32 m0, s33, 86016
    s_nop 0
    buffer_load_dwordx4 v23, s[44:47], s76 offen offset:0 lds
    v_mul_f32 v217, v217, v233
    v_exp_f32 v82, v82
    v_mul_f32 v218, v218, v234
    v_exp_f32 v83, v83
    v_mul_f32 v219, v219, v235
    v_fma_f32 v80, v80, v67, v67
    s_add_u32 m0, s33, 90112
    s_mov_b32 s77, 4358144
    buffer_load_dwordx4 v22, s[48:51], s77 offen offset:0 lds
    v_fma_f32 v81, v81, v67, v67
    v_fma_f32 v82, v82, v67, v67
    v_fma_f32 v83, v83, v67, v67
    v_rcp_f32 v80, v80
    v_rcp_f32 v81, v81
    v_rcp_f32 v82, v82
    s_add_u32 m0, s33, 94208
    s_nop 0
    buffer_load_dwordx4 v22, s[52:55], s77 offen offset:0 lds
    v_rcp_f32 v83, v83
    s_nop 0
    v_mul_f32 v216, v216, v80
    v_mul_f32 v217, v217, v81
    v_mul_f32 v218, v218, v82
    v_mul_f32 v219, v219, v83
    v_cvt_pk_bf16_f32 v216, v216, v217
    v_cvt_pk_bf16_f32 v217, v218, v219
    buffer_store_dwordx4 v[192:195], v19, s[68:71], s73 offen offset:2560 sc1
    s_load_dword s94, s[20:21], s75 offset:0x100
    s_load_dword s94, s[20:21], s75 offset:0x140
    s_load_dword s94, s[20:21], s75 offset:0x180
    s_load_dword s94, s[20:21], s75 offset:0x1c0
    s_waitcnt vmcnt(17)
    s_barrier
    s_add_u32 m0, s79, 100352
    s_mov_b32 s78, 34048
    buffer_load_dwordx4 v20, s[36:39], s78 offen sc1 lds
    v_fmac_f32 v220, v56, v68
    v_fmac_f32 v221, v57, v68
    v_fmac_f32 v222, v58, v68
    v_fmac_f32 v223, v59, v68
    v_fmac_f32 v236, v60, v68
    v_fmac_f32 v237, v61, v68
    v_fmac_f32 v238, v62, v68
    v_fmac_f32 v239, v63, v68
    s_add_u32 m0, s79, 101376
    s_nop 0
    buffer_load_dwordx4 v21, s[36:39], s78 offen sc1 lds
    v_mul_f32 v80, v220, v220
    v_mul_f32 v81, v221, v221
    v_mul_f32 v82, v222, v222
    v_mul_f32 v83, v223, v223
L_pad2:
    s_cbranch_execz L_vret1
    v_fma_f32 v80, v80, v70, v69
    v_fma_f32 v81, v81, v70, v69
    v_fma_f32 v82, v82, v70, v69
    v_fma_f32 v83, v83, v70, v69
    s_add_u32 m0, s81, 114688
    s_mov_b32 s78, 1280
    s_mov_b64 exec, 0xffffffff
    buffer_load_dwordx4 v3, s[36:39], s78 offen sc1 lds
    s_mov_b64 exec, -1
    v_mul_f32 v80, v80, v220
    v_mul_f32 v81, v81, v221
    v_mul_f32 v82, v82, v222
    v_mul_f32 v83, v83, v223
    v_exp_f32 v80, v80
    v_mul_f32 v220, v220, v236
    v_exp_f32 v81, v81
    s_add_u32 m0, s33, 16384
    s_mov_b32 s76, 3932160
    buffer_load_dwordx4 v23, s[40:43], s76 offen offset:0 lds
    s_add_u32 m0, s33, 18432
    s_nop 0
    buffer_load_dwordx4 v23, s[40:43], s76 offen offset:2048 lds
    v_mul_f32 v221, v221, v237
    v_exp_f32 v82, v82
    v_mul_f32 v222, v222, v238
    v_exp_f32 v83, v83
    v_mul_f32 v223, v223, v239
    v_fma_f32 v80, v80, v71, v71
    s_add_u32 m0, s33, 24576
    s_nop 0
    buffer_load_dwordx4 v23, s[44:47], s76 offen offset:0 lds
    v_fma_f32 v81, v81, v71, v71
    v_fma_f32 v82, v82, v71, v71
    v_fma_f32 v83, v83, v71, v71
    v_rcp_f32 v80, v80
    v_rcp_f32 v81, v81
    v_rcp_f32 v82, v82
    s_add_u32 m0, s33, 28672
    s_mov_b32 s77, 4587520
    buffer_load_dwordx4 v22, s[48:51], s77 offen offset:0 lds
    v_rcp_f32 v83, v83
    s_nop 0
    v_mul_f32 v220, v220, v80
    v_mul_f32 v221, v221, v81
    v_mul_f32 v222, v222, v82
    v_mul_f32 v223, v223, v83
    v_cvt_pk_bf16_f32 v218, v220, v221
    v_cvt_pk_bf16_f32 v219, v222, v223
    s_add_u32 m0, s33, 32768
    s_nop 0
    buffer_load_dwordx4 v22, s[52:55], s77 offen offset:0 lds
    s_add_u32 s75, s75, 0x280000
    s_load_dword s94, s[20:21], s75 offset:0x0
    s_load_dword s94, s[20:21], s75 offset:0x40
    s_load_dword s94, s[20:21], s75 offset:0x80
    s_load_dword s94, s[20:21], s75 offset:0xc0
    s_waitcnt vmcnt(16)
    s_barrier
    s_add_u32 m0, s79, 116736
    s_mov_b32 s78, 1408
    buffer_load_dwordx4 v20, s[36:39], s78 offen sc1 lds
    s_nop 1
    v_permlane16_swap_b32 v216, v218
    v_permlane16_swap_b32 v217, v219
    v_fmac_f32 v224, v56, v72
    v_fmac_f32 v225, v57, v72
    v_fmac_f32 v226, v58, v72
    v_fmac_f32 v227, v59, v72
    v_fmac_f32 v240, v60, v72
    v_fmac_f32 v241, v61, v72
    v_fmac_f32 v242, v62, v72
    v_fmac_f32 v243, v63, v72
    s_add_u32 m0, s79, 117760
    s_nop 0
    buffer_load_dwordx4 v21, s[36:39], s78 offen sc1 lds
    v_mul_f32 v80, v224, v224
    v_mul_f32 v81, v225, v225
    v_mul_f32 v82, v226, v226
    v_mul_f32 v83, v227, v227
    v_fma_f32 v80, v80, v74, v73
    v_fma_f32 v81, v81, v74, v73
    v_fma_f32 v82, v82, v74, v73
    v_fma_f32 v83, v83, v74, v73
    s_add_u32 m0, s33, 36864
    s_mov_b32 s76, 4128768
    buffer_load_dwordx4 v23, s[40:43], s76 offen offset:0 lds
    v_mul_f32 v80, v80, v224
    v_mul_f32 v81, v81, v225
    v_mul_f32 v82, v82, v226
    v_mul_f32 v83, v83, v227
    v_exp_f32 v80, v80
    v_mul_f32 v224, v224, v240
    v_exp_f32 v81, v81
    s_add_u32 m0, s33, 38912
    s_nop 0
    buffer_load_dwordx4 v23, s[40:43], s76 offen offset:2048 lds
    s_add_u32 m0, s33, 45056
    s_nop 0
    buffer_load_dwordx4 v23, s[44:47], s76 offen offset:0 lds
    v_mul_f32 v225, v225, v241
    v_exp_f32 v82, v82
    v_mul_f32 v226, v226, v242
    v_exp_f32 v83, v83
    v_mul_f32 v227, v227, v243
    v_fma_f32 v80, v80, v75, v75
    s_add_u32 m0, s33, 49152
    s_mov_b32 s77, 4816896
    buffer_load_dwordx4 v22, s[48:51], s77 offen offset:0 lds
    v_fma_f32 v81, v81, v75, v75
    v_fma_f32 v82, v82, v75, v75
    v_fma_f32 v83, v83, v75, v75
    v_rcp_f32 v80, v80
    v_rcp_f32 v81, v81
    v_rcp_f32 v82, v82
    s_add_u32 m0, s33, 53248
    s_nop 0
    buffer_load_dwordx4 v22, s[52:55], s77 offen offset:0 lds
    v_rcp_f32 v83, v83
    s_nop 0
    v_mul_f32 v224, v224, v80
    v_mul_f32 v225, v225, v81
    v_mul_f32 v226, v226, v82
    v_mul_f32 v227, v227, v83
    v_cvt_pk_bf16_f32 v224, v224, v225
    v_cvt_pk_bf16_f32 v225, v226, v227
    buffer_store_dwordx4 v[216:219], v19, s[68:71], s74 offen offset:0 sc1
    s_load_dword s94, s[20:21], s75 offset:0x100
    s_load_dword s94, s[20:21], s75 offset:0x140
    s_load_dword s94, s[20:21], s75 offset:0x180
    s_load_dword s94, s[20:21], s75 offset:0x1c0
    s_waitcnt vmcnt(17)
    s_barrier
    s_add_u32 m0, s79, 118784
    s_mov_b32 s78, 34176
    buffer_load_dwordx4 v20, s[36:39], s78 offen sc1 lds
    v_fmac_f32 v228, v56, v76
    v_fmac_f32 v229, v57, v76
    v_fmac_f32 v230, v58, v76
    v_fmac_f32 v231, v59, v76
    v_fmac_f32 v244, v60, v76
    v_fmac_f32 v245, v61, v76
    v_fmac_f32 v246, v62, v76
    v_fmac_f32 v247, v63, v76
    s_add_u32 m0, s79, 119808
    s_nop 0
    buffer_load_dwordx4 v21, s[36:39], s78 offen sc1 lds
    v_mul_f32 v80, v228, v228
    v_mul_f32 v81, v229, v229
    v_mul_f32 v82, v230, v230
    v_mul_f32 v83, v231, v231
    v_fma_f32 v80, v80, v78, v77
    v_fma_f32 v81, v81, v78, v77
    v_fma_f32 v82, v82, v78, v77
    v_fma_f32 v83, v83, v78, v77
    s_add_u32 m0, s81, 133120
    s_mov_b32 s78, 1408
    s_mov_b64 exec, 0xffffffff
    buffer_load_dwordx4 v3, s[36:39], s78 offen sc1 lds
    s_mov_b64 exec, -1
    v_mul_f32 v80, v80, v228
    v_mul_f32 v81, v81, v229
    v_mul_f32 v82, v82, v230
    v_mul_f32 v83, v83, v231
    v_exp_f32 v80, v80
    v_mul_f32 v228, v228, v244
    v_exp_f32 v81, v81
    s_add_u32 m0, s33, 57344
    s_mov_b32 s76, 4325376
    buffer_load_dwordx4 v23, s[40:43], s76 offen offset:0 lds
    s_add_u32 m0, s33, 59392
    s_nop 0
    buffer_load_dwordx4 v23, s[40:43], s76 offen offset:2048 lds
    v_mul_f32 v229, v229, v245
    v_exp_f32 v82, v82
    v_mul_f32 v230, v230, v246
    v_exp_f32 v83, v83
    v_mul_f32 v231, v231, v247
    v_fma_f32 v80, v80, v79, v79
    s_add_u32 m0, s33, 65536
    s_nop 0
    buffer_load_dwordx4 v23, s[44:47], s76 offen offset:0 lds
    v_fma_f32 v81, v81, v79, v79
    v_fma_f32 v82, v82, v79, v79
    v_fma_f32 v83, v83, v79, v79
    v_rcp_f32 v80, v80
    v_rcp_f32 v81, v81
    v_rcp_f32 v82, v82
    s_add_u32 m0, s33, 69632
    s_mov_b32 s77, 5046272
    buffer_load_dwordx4 v22, s[48:51], s77 offen offset:0 lds
    v_rcp_f32 v83, v83
    s_nop 0
    v_mul_f32 v228, v228, v80
    v_mul_f32 v229, v229, v81
    v_mul_f32 v230, v230, v82
    v_mul_f32 v231, v231, v83
    v_cvt_pk_bf16_f32 v226, v228, v229
    v_cvt_pk_bf16_f32 v227, v230, v231
    s_add_u32 m0, s33, 73728
    s_nop 0
    buffer_load_dwordx4 v22, s[52:55], s77 offen offset:0 lds
    s_add_u32 s75, s75, 0xffe00000
    s_load_dword s94, s[20:21], s75 offset:0x0
    s_load_dword s94, s[20:21], s75 offset:0x40
    s_load_dword s94, s[20:21], s75 offset:0x80
    s_load_dword s94, s[20:21], s75 offset:0xc0
    s_waitcnt vmcnt(16)
    s_barrier
    s_add_u32 m0, s79, 135168
    s_mov_b32 s78, 1536
    buffer_load_dwordx4 v20, s[36:39], s78 offen sc1 lds
    s_nop 1
    v_permlane16_swap_b32 v224, v226
    v_permlane16_swap_b32 v225, v227
    s_add_u32 m0, s79, 136192
    s_nop 0
    buffer_load_dwordx4 v21, s[36:39], s78 offen sc1 lds
    s_add_u32 m0, s33, 77824
    s_mov_b32 s76, 4521984
    buffer_load_dwordx4 v23, s[40:43], s76 offen offset:0 lds
    s_add_u32 m0, s33, 79872
    s_nop 0
    buffer_load_dwordx4 v23, s[40:43], s76 offen offset:2048 lds
    s_add_u32 m0, s33, 86016
    s_nop 0
    buffer_load_dwordx4 v23, s[44:47], s76 offen offset:0 lds
    s_add_u32 m0, s33, 90112
    s_mov_b32 s77, 5275648
    buffer_load_dwordx4 v22, s[48:51], s77 offen offset:0 lds
    s_add_u32 m0, s33, 94208
    s_nop 0
    buffer_load_dwordx4 v22, s[52:55], s77 offen offset:0 lds
    buffer_store_dwordx4 v[224:227], v19, s[68:71], s74 offen offset:2048 sc1
    s_load_dword s94, s[20:21], s75 offset:0x100
    s_load_dword s94, s[20:21], s75 offset:0x140
    s_load_dword s94, s[20:21], s75 offset:0x180
    s_load_dword s94, s[20:21], s75 offset:0x1c0
    s_waitcnt vmcnt(17)
    s_barrier
    s_add_u32 m0, s79, 137216
    s_mov_b32 s78, 34304
    buffer_load_dwordx4 v20, s[36:39], s78 offen sc1 lds
    s_add_u32 m0, s79, 138240
    s_nop 0
    buffer_load_dwordx4 v21, s[36:39], s78 offen sc1 lds
    s_add_u32 m0, s81, 151552
    s_mov_b32 s78, 1536
    s_mov_b64 exec, 0xffffffff
    buffer_load_dwordx4 v3, s[36:39], s78 offen sc1 lds
    s_mov_b64 exec, -1
    s_add_u32 m0, s33, 16384
    s_mov_b32 s76, 4718592
    buffer_load_dwordx4 v23, s[40:43], s76 offen offset:0 lds
    s_add_u32 m0, s33, 18432
    s_nop 0
    buffer_load_dwordx4 v23, s[40:43], s76 offen offset:2048 lds
    s_add_u32 m0, s33, 24576
    s_nop 0
    buffer_load_dwordx4 v23, s[44:47], s76 offen offset:0 lds
    s_add_u32 m0, s33, 28672
    s_mov_b32 s77, 5505024
    buffer_load_dwordx4 v22, s[48:51], s77 offen offset:0 lds
    s_add_u32 m0, s33, 32768
    s_nop 0
    buffer_load_dwordx4 v22, s[52:55], s77 offen offset:0 lds
    s_add_u32 s75, s75, 0x280000
    s_load_dword s94, s[20:21], s75 offset:0x0
    s_load_dword s94, s[20:21], s75 offset:0x40
    s_load_dword s94, s[20:21], s75 offset:0x80
    s_load_dword s94, s[20:21], s75 offset:0xc0
    s_waitcnt vmcnt(16)
    s_barrier
    s_mov_b64 exec, 0
    s_cmp_eq_u32 s4, 0
    s_cbranch_scc1 L_pad13
    s_cmp_eq_u32 s4, 1
    s_cbranch_scc1 L_pad5
L_vret3:
    s_mov_b64 exec, -1
    s_load_dword s94, s[20:21], s75 offset:0x100
    s_load_dword s94, s[20:21], s75 offset:0x140
    s_load_dword s94, s[20:21], s75 offset:0x180
    s_load_dword s94, s[20:21], s75 offset:0x1c0
    s_waitcnt vmcnt(9)
    s_barrier
    s_add_u32 m0, s79, 98304
    s_mov_b32 s78, 1664
    buffer_load_dwordx4 v20, s[36:39], s78 offen sc1 lds
    s_add_u32 m0, s79, 99328
    s_nop 0
    buffer_load_dwordx4 v21, s[36:39], s78 offen sc1 lds
    s_add_u32 m0, s33, 36864
    s_mov_b32 s76, 4915200
    buffer_load_dwordx4 v23, s[40:43], s76 offen offset:0 lds
    s_add_u32 m0, s33, 38912
    s_nop 0
    buffer_load_dwordx4 v23, s[40:43], s76 offen offset:2048 lds
    s_add_u32 m0, s33, 45056
    s_nop 0
    buffer_load_dwordx4 v23, s[44:47], s76 offen offset:0 lds
    s_add_u32 m0, s33, 49152
    s_mov_b32 s77, 5734400
    buffer_load_dwordx4 v22, s[48:51], s77 offen offset:0 lds
    s_add_u32 m0, s33, 53248
    s_nop 0
    buffer_load_dwordx4 v22, s[52:55], s77 offen offset:0 lds
    s_add_u32 m0, s79, 100352
    s_mov_b32 s78, 34432
    buffer_load_dwordx4 v20, s[36:39], s78 offen sc1 lds
    s_add_u32 m0, s79, 101376
    s_nop 0
    buffer_load_dwordx4 v21, s[36:39], s78 offen sc1 lds
    s_add_u32 s75, s75, 0xffe00000
    s_load_dword s94, s[20:21], s75 offset:0x0
    s_load_dword s94, s[20:21], s75 offset:0x40
    s_load_dword s94, s[20:21], s75 offset:0x80
    s_load_dword s94, s[20:21], s75 offset:0xc0
    s_waitcnt vmcnt(17)
    s_waitcnt vmcnt(9)
    s_barrier
    s_add_u32 m0, s81, 114688
    s_mov_b32 s78, 1664
    s_mov_b64 exec, 0xffffffff
    buffer_load_dwordx4 v3, s[36:39], s78 offen sc1 lds
    s_mov_b64 exec, -1
    s_add_u32 m0, s33, 57344
    s_mov_b32 s76, 5111808
    buffer_load_dwordx4 v23, s[40:43], s76 offen offset:0 lds
    s_add_u32 m0, s33, 59392
    s_nop 0
    buffer_load_dwordx4 v23, s[40:43], s76 offen offset:2048 lds
    s_add_u32 m0, s33, 65536
    s_nop 0
    buffer_load_dwordx4 v23, s[44:47], s76 offen offset:0 lds
    s_add_u32 m0, s33, 69632
    s_mov_b32 s77, 5963776
    buffer_load_dwordx4 v22, s[48:51], s77 offen offset:0 lds
    s_add_u32 m0, s33, 73728
    s_nop 0
    buffer_load_dwordx4 v22, s[52:55], s77 offen offset:0 lds
    s_add_u32 m0, s79, 116736
    s_mov_b32 s78, 1792
    buffer_load_dwordx4 v20, s[36:39], s78 offen sc1 lds
    s_add_u32 m0, s79, 117760
    s_nop 0
    buffer_load_dwordx4 v21, s[36:39], s78 offen sc1 lds
    s_add_u32 m0, s33, 77824
    s_mov_b32 s76, 5308416
    buffer_load_dwordx4 v23, s[40:43], s76 offen offset:0 lds
    s_load_dword s94, s[20:21], s75 offset:0x100
    s_load_dword s94, s[20:21], s75 offset:0x140
    s_load_dword s94, s[20:21], s75 offset:0x180
    s_load_dword s94, s[20:21], s75 offset:0x1c0
    s_cmp_lg_u32 s4, 0
    s_cbranch_scc1 L_fH1
    s_lshl_b32 s91, s28, 4
    s_add_u32 s91, s91, s29
    s_lshl_b32 s91, s91, 7
    s_add_u32 s91, s91, 0x1e88000
    v_mov_b32 v12, s91
    v_mov_b32 v14, s100
    v_mov_b32 v15, s101
    s_mov_b64 exec, 1
    global_store_dwordx2 v12, v[14:15], s[26:27] sc1
    s_mov_b64 exec, -1
L_fH1:
    s_waitcnt vmcnt(11)
    s_barrier
    s_add_u32 m0, s33, 79872
    s_nop 0
    buffer_load_dwordx4 v23, s[40:43], s76 offen offset:2048 lds
    s_add_u32 m0, s33, 86016
    s_nop 0
    buffer_load_dwordx4 v23, s[44:47], s76 offen offset:0 lds
    s_add_u32 m0, s33, 90112
    s_mov_b32 s77, 6193152
    buffer_load_dwordx4 v22, s[48:51], s77 offen offset:0 lds
    s_add_u32 m0, s33, 94208
    s_nop 0
    buffer_load_dwordx4 v22, s[52:55], s77 offen offset:0 lds
    s_add_u32 m0, s79, 118784
    s_mov_b32 s78, 34560
    buffer_load_dwordx4 v20, s[36:39], s78 offen sc1 lds
    s_add_u32 m0, s79, 119808
    s_nop 0
    buffer_load_dwordx4 v21, s[36:39], s78 offen sc1 lds
    s_add_u32 m0, s81, 133120
    s_mov_b32 s78, 1792
    s_mov_b64 exec, 0xffffffff
    buffer_load_dwordx4 v3, s[36:39], s78 offen sc1 lds
    s_mov_b64 exec, -1
    s_add_u32 m0, s33, 16384
    s_mov_b32 s76, 5505024
    buffer_load_dwordx4 v23, s[40:43], s76 offen offset:0 lds
    s_add_u32 m0, s33, 18432
    s_nop 0
    buffer_load_dwordx4 v23, s[40:43], s76 offen offset:2048 lds
    s_add_u32 s75, s75, 0x280000
    s_load_dword s94, s[20:21], s75 offset:0x0
    s_load_dword s94, s[20:21], s75 offset:0x40
    s_load_dword s94, s[20:21], s75 offset:0x80
    s_load_dword s94, s[20:21], s75 offset:0xc0
    s_waitcnt vmcnt(12)
    s_barrier
    s_add_u32 m0, s33, 24576
    s_nop 0
    buffer_load_dwordx4 v23, s[44:47], s76 offen offset:0 lds
    s_add_u32 m0, s33, 28672
    s_mov_b32 s77, 6422528
    buffer_load_dwordx4 v22, s[48:51], s77 offen offset:0 lds
    s_add_u32 m0, s33, 32768
    s_nop 0
    buffer_load_dwordx4 v22, s[52:55], s77 offen offset:0 lds
    s_add_u32 m0, s79, 135168
    s_mov_b32 s78, 1920
    buffer_load_dwordx4 v20, s[36:39], s78 offen sc1 lds
    s_add_u32 m0, s79, 136192
    s_nop 0
    buffer_load_dwordx4 v21, s[36:39], s78 offen sc1 lds
    s_add_u32 m0, s33, 36864
    s_mov_b32 s76, 5701632
    buffer_load_dwordx4 v23, s[40:43], s76 offen offset:0 lds
    s_add_u32 m0, s33, 38912
    s_nop 0
    buffer_load_dwordx4 v23, s[40:43], s76 offen offset:2048 lds
    s_add_u32 m0, s33, 45056
    s_nop 0
    buffer_load_dwordx4 v23, s[44:47], s76 offen offset:0 lds
    s_add_u32 m0, s33, 49152
    s_mov_b32 s77, 6651904
    buffer_load_dwordx4 v22, s[48:51], s77 offen offset:0 lds
    s_add_u32 m0, s33, 53248
    s_nop 0
    buffer_load_dwordx4 v22, s[52:55], s77 offen offset:0 lds
    s_load_dword s94, s[20:21], s75 offset:0x100
    s_load_dword s94, s[20:21], s75 offset:0x140
    s_load_dword s94, s[20:21], s75 offset:0x180
    s_load_dword s94, s[20:21], s75 offset:0x1c0
    s_waitcnt vmcnt(15)
    s_barrier
    s_add_u32 m0, s79, 137216
    s_mov_b32 s78, 34688
    buffer_load_dwordx4 v20, s[36:39], s78 offen sc1 lds
    s_add_u32 m0, s79, 138240
    s_nop 0
    buffer_load_dwordx4 v21, s[36:39], s78 offen sc1 lds
    s_add_u32 m0, s81, 151552
    s_mov_b32 s78, 1920
    s_mov_b64 exec, 0xffffffff
    buffer_load_dwordx4 v3, s[36:39], s78 offen sc1 lds
    s_mov_b64 exec, -1
    s_add_u32 m0, s33, 57344
    s_mov_b32 s76, 5898240
    buffer_load_dwordx4 v23, s[40:43], s76 offen offset:0 lds
    s_add_u32 m0, s33, 59392
    s_nop 0
    buffer_load_dwordx4 v23, s[40:43], s76 offen offset:2048 lds
    s_add_u32 m0, s33, 65536
    s_nop 0
    buffer_load_dwordx4 v23, s[44:47], s76 offen offset:0 lds
    s_add_u32 m0, s33, 69632
    s_mov_b32 s77, 6881280
    buffer_load_dwordx4 v22, s[48:51], s77 offen offset:0 lds
    s_add_u32 m0, s33, 73728
    s_nop 0
    buffer_load_dwordx4 v22, s[52:55], s77 offen offset:0 lds
    s_lshl2_add_u32 s91, s30, s4
    s_lshl_b32 s91, s91, 9
    s_add_u32 s91, s91, 0x1e88000
    v_lshl_add_u32 v13, v1, 7, s91
    s_mov_b64 exec, 15
    global_load_dwordx2 v[14:15], v13, s[26:27] sc1
    s_mov_b64 exec, -1
    s_waitcnt vmcnt(16)
    s_barrier
    s_add_u32 m0, s33, 77824
    s_mov_b32 s76, 6094848
    buffer_load_dwordx4 v23, s[40:43], s76 offen offset:0 lds
    s_add_u32 m0, s33, 79872
    s_nop 0
    buffer_load_dwordx4 v23, s[40:43], s76 offen offset:2048 lds
    s_add_u32 m0, s33, 86016
    s_nop 0
    buffer_load_dwordx4 v23, s[44:47], s76 offen offset:0 lds
    s_add_u32 m0, s33, 90112
    s_mov_b32 s77, 7110656
    buffer_load_dwordx4 v22, s[48:51], s77 offen offset:0 lds
    s_add_u32 m0, s33, 94208
    s_nop 0
    buffer_load_dwordx4 v22, s[52:55], s77 offen offset:0 lds
    s_waitcnt vmcnt(5)
    s_mov_b64 exec, 15
    s_movk_i32 s98, 0x4000
L_pH1_chk:
    v_cmp_ne_u64 vcc, s[100:101], v[14:15]
    s_nop 1
    s_cmp_eq_u64 vcc, 0
    s_cbranch_scc1 L_pH1_ok
    s_sub_u32 s98, s98, 1
    s_cbranch_scc1 L_pH1_ok
    s_sleep 1
    global_load_dwordx2 v[14:15], v13, s[26:27] sc1
    s_waitcnt vmcnt(0)
    s_branch L_pH1_chk
L_pH1_ok:
    s_mov_b64 exec, -1
    s_waitcnt vmcnt(14)
    s_barrier
    s_mov_b32 s40, s34
    s_mov_b32 s42, s35
    s_memrealtime s[44:45]
    s_memtime s[46:47]
    s_lshl4_add_u32 s91, s28, s29
    s_lshl_b32 s91, s91, 7
    s_add_u32 s92, s91, 0x1ea8000
    s_xor_b32 s91, s91, 17408
    s_add_u32 s91, s91, 0x1ea8000
    v_mov_b32 v239, s92
    v_writelane_b32 v239, s91, 1
    s_lshl_b32 m0, s33, 2
    s_nop 0
    buffer_load_dwordx4 v18, s[56:59], s82 offen offset:0 sc1 lds
    buffer_load_dwordx4 v18, s[56:59], s82 offen offset:1024 sc1 lds
    buffer_load_dwordx4 v18, s[56:59], s82 offen offset:2048 sc1 lds
    buffer_load_dwordx4 v18, s[56:59], s82 offen offset:3072 sc1 lds
    s_add_u32 s82, s82, 16384
    s_lshl1_add_u32 m0, s33, 16384
    s_nop 0
    buffer_load_dwordx4 v254, s[60:63], s83 offen lds
    s_lshl1_add_u32 m0, s33, 17408
    s_nop 0
    buffer_load_dwordx4 v255, s[60:63], s83 offen lds
    s_lshl1_add_u32 m0, s33, 24576
    s_nop 0
    buffer_load_dwordx4 v254, s[64:67], s83 offen lds
    s_lshl1_add_u32 m0, s33, 25600
    s_nop 0
    buffer_load_dwordx4 v255, s[64:67], s83 offen lds
    s_add_u32 s83, s83, 131072
    s_lshl_b32 s84, s2, 15
    s_lshl_b32 s85, s4, 13
    s_add_u32 s84, s84, s85
    s_add_u32 s36, s84, 0x1600000
    s_add_u32 s37, s36, 4096
    s_xor_b32 s84, s84, 163840
    s_add_u32 s38, s84, 0x1600000
    s_add_u32 s39, s38, 4096
    v_lshlrev_b32 v4, 4, v1
    s_lshl_b32 s84, s4, 12
    s_add_u32 s84, s84, 147456
    v_lshl_add_u32 v5, v1, 3, s84
    v_lshlrev_b32 v6, 2, v1
    s_waitcnt vmcnt(14)
    s_barrier
    s_lshl2_add_u32 m0, s33, 98304
    s_nop 0
    buffer_load_dwordx4 v18, s[56:59], s82 offen offset:0 sc1 lds
    buffer_load_dwordx4 v18, s[56:59], s82 offen offset:1024 sc1 lds
    buffer_load_dwordx4 v18, s[56:59], s82 offen offset:2048 sc1 lds
    buffer_load_dwordx4 v18, s[56:59], s82 offen offset:3072 sc1 lds
    s_add_u32 s82, s82, 16384
    s_lshl1_add_u32 m0, s33, 114688
    s_nop 0
    buffer_load_dwordx4 v254, s[60:63], s83 offen lds
    s_lshl1_add_u32 m0, s33, 115712
    s_nop 0
    buffer_load_dwordx4 v255, s[60:63], s83 offen lds
    s_lshl1_add_u32 m0, s33, 122880
    s_nop 0
    buffer_load_dwordx4 v254, s[64:67], s83 offen lds
    s_lshl1_add_u32 m0, s33, 123904
    s_nop 0
    buffer_load_dwordx4 v255, s[64:67], s83 offen lds
    s_add_u32 s83, s83, 131072
    s_waitcnt lgkmcnt(0)
    s_sub_u32 s40, s44, s40
    s_sub_u32 s42, s46, s42
    v_cvt_f32_u32 v8, s42
    v_cvt_f32_u32 v9, s40
    v_rcp_f32 v8, v8
    v_mul_f32 v9, 0x463b8000, v9
    v_mul_f32 v8, v8, v9
    v_cvt_u32_f32 v10, v8
    v_add_u32 v10, s44, v10
    v_mov_b32 v8, s100
    v_mov_b32 v9, s101
    s_cmp_eq_u32 s4, 0
    s_cselect_b64 exec, 1, 0
    s_cbranch_execz L_tp
    global_store_dwordx3 v239, v[8:10], s[26:27] sc1
L_tp:
    s_mov_b64 exec, -1
    s_waitcnt vmcnt(16)
    s_barrier
    s_lshl2_add_u32 m0, s33, 32768
    s_nop 0
    buffer_load_dwordx4 v18, s[56:59], s82 offen offset:0 sc1 lds
    buffer_load_dwordx4 v18, s[56:59], s82 offen offset:1024 sc1 lds
    buffer_load_dwordx4 v18, s[56:59], s82 offen offset:2048 sc1 lds
    buffer_load_dwordx4 v18, s[56:59], s82 offen offset:3072 sc1 lds
    s_add_u32 s82, s82, 16384
    s_lshl1_add_u32 m0, s33, 49152
    s_nop 0
    buffer_load_dwordx4 v254, s[60:63], s83 offen lds
    s_lshl1_add_u32 m0, s33, 50176
    s_nop 0
    buffer_load_dwordx4 v255, s[60:63], s83 offen lds
    s_lshl1_add_u32 m0, s33, 57344
    s_nop 0
    buffer_load_dwordx4 v254, s[64:67], s83 offen lds
    s_lshl1_add_u32 m0, s33, 58368
    s_nop 0
    buffer_load_dwordx4 v255, s[64:67], s83 offen lds
    s_add_u32 s83, s83, 131072
    s_waitcnt vmcnt(16)
    s_barrier
    s_setprio 1
    ds_read_b64_tr_b16 v[40:41], v250 offset:16384
    ds_read_b64_tr_b16 v[42:43], v250 offset:16896
    ds_read_b128 v[24:27], v248 offset:0
    ds_read_b128 v[28:31], v248 offset:1024
    ds_read_b128 v[32:35], v248 offset:2048
    ds_read_b128 v[36:39], v248 offset:3072
    ds_read_b64_tr_b16 v[44:45], v251 offset:16384
    ds_read_b64_tr_b16 v[46:47], v251 offset:16896
    ds_read_b64_tr_b16 v[48:49], v250 offset:24576
    ds_read_b64_tr_b16 v[50:51], v250 offset:25088
    ds_read_b64_tr_b16 v[52:53], v251 offset:24576
    ds_read_b64_tr_b16 v[54:55], v251 offset:25088
    s_lshl2_add_u32 m0, s33, 65536
    s_nop 0
    buffer_load_dwordx4 v18, s[56:59], s82 offen offset:0 sc1 lds
    buffer_load_dwordx4 v18, s[56:59], s82 offen offset:1024 sc1 lds
    buffer_load_dwordx4 v18, s[56:59], s82 offen offset:2048 sc1 lds
    buffer_load_dwordx4 v18, s[56:59], s82 offen offset:3072 sc1 lds
    s_add_u32 s82, s82, 16384
    s_waitcnt lgkmcnt(9)
    v_mfma_f32_16x16x32_bf16 v[88:91], v[40:43], v[24:27], 0
    ds_read_b64_tr_b16 v[72:73], v250 offset:20480
    ds_read_b64_tr_b16 v[74:75], v250 offset:20992
    s_waitcnt lgkmcnt(10)
    v_mfma_f32_16x16x32_bf16 v[92:95], v[40:43], v[28:31], 0
    ds_read_b128 v[56:59], v248 offset:8192
    s_lshl1_add_u32 m0, s33, 81920
L_pad3:
    s_cbranch_execz L_vret1
    s_waitcnt lgkmcnt(10)
    v_mfma_f32_16x16x32_bf16 v[96:99], v[40:43], v[32:35], 0
    ds_read_b128 v[60:63], v248 offset:9216
    ds_read_b128 v[64:67], v248 offset:10240
    s_waitcnt lgkmcnt(11)
    v_mfma_f32_16x16x32_bf16 v[100:103], v[40:43], v[36:39], 0
    ds_read_b128 v[68:71], v248 offset:11264
    buffer_load_dwordx4 v254, s[60:63], s83 offen lds
    s_waitcnt lgkmcnt(10)
    v_mfma_f32_16x16x32_bf16 v[104:107], v[44:47], v[24:27], 0
    ds_read_b64_tr_b16 v[76:77], v251 offset:20480
    ds_read_b64_tr_b16 v[78:79], v251 offset:20992
    v_mfma_f32_16x16x32_bf16 v[108:111], v[44:47], v[28:31], 0
    ds_read_b64_tr_b16 v[80:81], v250 offset:28672
    s_lshl1_add_u32 m0, s33, 82944
    v_mfma_f32_16x16x32_bf16 v[112:115], v[44:47], v[32:35], 0
    ds_read_b64_tr_b16 v[82:83], v250 offset:29184
    ds_read_b64_tr_b16 v[84:85], v251 offset:28672
    v_mfma_f32_16x16x32_bf16 v[116:119], v[44:47], v[36:39], 0
    ds_read_b64_tr_b16 v[86:87], v251 offset:29184
    buffer_load_dwordx4 v255, s[60:63], s83 offen lds
    s_waitcnt lgkmcnt(14)
    v_mfma_f32_16x16x32_bf16 v[120:123], v[48:51], v[24:27], 0
    v_mfma_f32_16x16x32_bf16 v[124:127], v[48:51], v[28:31], 0
    s_lshl1_add_u32 m0, s33, 90112
    v_mfma_f32_16x16x32_bf16 v[128:131], v[48:51], v[32:35], 0
    v_mfma_f32_16x16x32_bf16 v[132:135], v[48:51], v[36:39], 0
    buffer_load_dwordx4 v254, s[64:67], s83 offen lds
    s_waitcnt lgkmcnt(12)
    v_mfma_f32_16x16x32_bf16 v[136:139], v[52:55], v[24:27], 0
    v_mfma_f32_16x16x32_bf16 v[140:143], v[52:55], v[28:31], 0
    s_lshl1_add_u32 m0, s33, 91136
    v_mfma_f32_16x16x32_bf16 v[144:147], v[52:55], v[32:35], 0
    v_mfma_f32_16x16x32_bf16 v[148:151], v[52:55], v[36:39], 0
    buffer_load_dwordx4 v255, s[64:67], s83 offen lds
    s_add_u32 s83, s83, 131072
    s_waitcnt vmcnt(16) lgkmcnt(0)
    s_barrier
    v_mfma_f32_16x16x32_bf16 v[88:91], v[72:75], v[56:59], v[88:91]
    ds_read_b64_tr_b16 v[40:41], v252 offset:49152
    ds_read_b64_tr_b16 v[42:43], v252 offset:49664
    v_mfma_f32_16x16x32_bf16 v[92:95], v[72:75], v[60:63], v[92:95]
    ds_read_b128 v[24:27], v249 offset:32768
    s_lshl_b32 m0, s33, 2
    v_mfma_f32_16x16x32_bf16 v[96:99], v[72:75], v[64:67], v[96:99]
    ds_read_b128 v[28:31], v249 offset:33792
    v_mfma_f32_16x16x32_bf16 v[100:103], v[72:75], v[68:71], v[100:103]
    ds_read_b128 v[32:35], v249 offset:34816
    buffer_load_dwordx4 v18, s[56:59], s82 offen offset:0 sc1 lds
    v_mfma_f32_16x16x32_bf16 v[104:107], v[76:79], v[56:59], v[104:107]
    ds_read_b128 v[36:39], v249 offset:35840
    v_mfma_f32_16x16x32_bf16 v[108:111], v[76:79], v[60:63], v[108:111]
    ds_read_b64_tr_b16 v[44:45], v253 offset:49152
    ds_read_b64_tr_b16 v[46:47], v253 offset:49664
    v_mfma_f32_16x16x32_bf16 v[112:115], v[76:79], v[64:67], v[112:115]
    ds_read_b64_tr_b16 v[48:49], v252 offset:57344
    v_mfma_f32_16x16x32_bf16 v[116:119], v[76:79], v[68:71], v[116:119]
    ds_read_b64_tr_b16 v[50:51], v252 offset:57856
    buffer_load_dwordx4 v18, s[56:59], s82 offen offset:1024 sc1 lds
    v_mfma_f32_16x16x32_bf16 v[120:123], v[80:83], v[56:59], v[120:123]
    ds_read_b64_tr_b16 v[52:53], v253 offset:57344
    v_mfma_f32_16x16x32_bf16 v[124:127], v[80:83], v[60:63], v[124:127]
    ds_read_b64_tr_b16 v[54:55], v253 offset:57856
    v_mfma_f32_16x16x32_bf16 v[128:131], v[80:83], v[64:67], v[128:131]
    v_mfma_f32_16x16x32_bf16 v[132:135], v[80:83], v[68:71], v[132:135]
    buffer_load_dwordx4 v18, s[56:59], s82 offen offset:2048 sc1 lds
    v_mfma_f32_16x16x32_bf16 v[136:139], v[84:87], v[56:59], v[136:139]
    v_mfma_f32_16x16x32_bf16 v[140:143], v[84:87], v[60:63], v[140:143]
    v_mfma_f32_16x16x32_bf16 v[144:147], v[84:87], v[64:67], v[144:147]
    v_mfma_f32_16x16x32_bf16 v[148:151], v[84:87], v[68:71], v[148:151]
    buffer_load_dwordx4 v18, s[56:59], s82 offen offset:3072 sc1 lds
    s_add_u32 s82, s82, 16384
    s_waitcnt lgkmcnt(9)
    v_mfma_f32_16x16x32_bf16 v[88:91], v[40:43], v[24:27], v[88:91]
    ds_read_b64_tr_b16 v[72:73], v252 offset:53248
    ds_read_b64_tr_b16 v[74:75], v252 offset:53760
    s_waitcnt lgkmcnt(10)
    v_mfma_f32_16x16x32_bf16 v[92:95], v[40:43], v[28:31], v[92:95]
    ds_read_b128 v[56:59], v249 offset:40960
    s_lshl1_add_u32 m0, s33, 16384
    s_waitcnt lgkmcnt(10)
    v_mfma_f32_16x16x32_bf16 v[96:99], v[40:43], v[32:35], v[96:99]
    ds_read_b128 v[60:63], v249 offset:41984
    ds_read_b128 v[64:67], v249 offset:43008
    s_waitcnt lgkmcnt(11)
    v_mfma_f32_16x16x32_bf16 v[100:103], v[40:43], v[36:39], v[100:103]
    ds_read_b128 v[68:71], v249 offset:44032
    buffer_load_dwordx4 v254, s[60:63], s83 offen lds
    s_waitcnt lgkmcnt(10)
    v_mfma_f32_16x16x32_bf16 v[104:107], v[44:47], v[24:27], v[104:107]
    ds_read_b64_tr_b16 v[76:77], v253 offset:53248
    ds_read_b64_tr_b16 v[78:79], v253 offset:53760
    v_mfma_f32_16x16x32_bf16 v[108:111], v[44:47], v[28:31], v[108:111]
    ds_read_b64_tr_b16 v[80:81], v252 offset:61440
    s_lshl1_add_u32 m0, s33, 17408
    v_mfma_f32_16x16x32_bf16 v[112:115], v[44:47], v[32:35], v[112:115]
    ds_read_b64_tr_b16 v[82:83], v252 offset:61952
    ds_read_b64_tr_b16 v[84:85], v253 offset:61440
    v_mfma_f32_16x16x32_bf16 v[116:119], v[44:47], v[36:39], v[116:119]
    ds_read_b64_tr_b16 v[86:87], v253 offset:61952
    buffer_load_dwordx4 v255, s[60:63], s83 offen lds
    s_waitcnt lgkmcnt(14)
    v_mfma_f32_16x16x32_bf16 v[120:123], v[48:51], v[24:27], v[120:123]
    v_mfma_f32_16x16x32_bf16 v[124:127], v[48:51], v[28:31], v[124:127]
    s_lshl1_add_u32 m0, s33, 24576
    v_mfma_f32_16x16x32_bf16 v[128:131], v[48:51], v[32:35], v[128:131]
    v_mfma_f32_16x16x32_bf16 v[132:135], v[48:51], v[36:39], v[132:135]
    buffer_load_dwordx4 v254, s[64:67], s83 offen lds
    s_waitcnt lgkmcnt(12)
    v_mfma_f32_16x16x32_bf16 v[136:139], v[52:55], v[24:27], v[136:139]
    v_mfma_f32_16x16x32_bf16 v[140:143], v[52:55], v[28:31], v[140:143]
    s_lshl1_add_u32 m0, s33, 25600
    v_mfma_f32_16x16x32_bf16 v[144:147], v[52:55], v[32:35], v[144:147]
    v_mfma_f32_16x16x32_bf16 v[148:151], v[52:55], v[36:39], v[148:151]
    buffer_load_dwordx4 v255, s[64:67], s83 offen lds
    s_add_u32 s83, s83, 131072
    s_waitcnt vmcnt(16) lgkmcnt(0)
    s_barrier
    v_mfma_f32_16x16x32_bf16 v[88:91], v[72:75], v[56:59], v[88:91]
    ds_read_b64_tr_b16 v[40:41], v250 offset:49152
    ds_read_b64_tr_b16 v[42:43], v250 offset:49664
    v_mfma_f32_16x16x32_bf16 v[92:95], v[72:75], v[60:63], v[92:95]
    ds_read_b128 v[24:27], v248 offset:32768
    s_lshl2_add_u32 m0, s33, 98304
    v_mfma_f32_16x16x32_bf16 v[96:99], v[72:75], v[64:67], v[96:99]
    ds_read_b128 v[28:31], v248 offset:33792
    v_mfma_f32_16x16x32_bf16 v[100:103], v[72:75], v[68:71], v[100:103]
    ds_read_b128 v[32:35], v248 offset:34816
    buffer_load_dwordx4 v18, s[56:59], s82 offen offset:0 sc1 lds
    v_mfma_f32_16x16x32_bf16 v[104:107], v[76:79], v[56:59], v[104:107]
    ds_read_b128 v[36:39], v248 offset:35840
    v_mfma_f32_16x16x32_bf16 v[108:111], v[76:79], v[60:63], v[108:111]
    ds_read_b64_tr_b16 v[44:45], v251 offset:49152
    ds_read_b64_tr_b16 v[46:47], v251 offset:49664
    v_mfma_f32_16x16x32_bf16 v[112:115], v[76:79], v[64:67], v[112:115]
    ds_read_b64_tr_b16 v[48:49], v250 offset:57344
    v_mfma_f32_16x16x32_bf16 v[116:119], v[76:79], v[68:71], v[116:119]
    ds_read_b64_tr_b16 v[50:51], v250 offset:57856
    buffer_load_dwordx4 v18, s[56:59], s82 offen offset:1024 sc1 lds
    v_mfma_f32_16x16x32_bf16 v[120:123], v[80:83], v[56:59], v[120:123]
    ds_read_b64_tr_b16 v[52:53], v251 offset:57344
    v_mfma_f32_16x16x32_bf16 v[124:127], v[80:83], v[60:63], v[124:127]
    ds_read_b64_tr_b16 v[54:55], v251 offset:57856
    v_mfma_f32_16x16x32_bf16 v[128:131], v[80:83], v[64:67], v[128:131]
    v_mfma_f32_16x16x32_bf16 v[132:135], v[80:83], v[68:71], v[132:135]
    buffer_load_dwordx4 v18, s[56:59], s82 offen offset:2048 sc1 lds
    v_mfma_f32_16x16x32_bf16 v[136:139], v[84:87], v[56:59], v[136:139]
    v_mfma_f32_16x16x32_bf16 v[140:143], v[84:87], v[60:63], v[140:143]
    v_mfma_f32_16x16x32_bf16 v[144:147], v[84:87], v[64:67], v[144:147]
    v_mfma_f32_16x16x32_bf16 v[148:151], v[84:87], v[68:71], v[148:151]
    buffer_load_dwordx4 v18, s[56:59], s82 offen offset:3072 sc1 lds
    s_add_u32 s82, s82, 16384
    s_waitcnt lgkmcnt(9)
    v_mfma_f32_16x16x32_bf16 v[88:91], v[40:43], v[24:27], v[88:91]
    ds_read_b64_tr_b16 v[72:73], v250 offset:53248
    ds_read_b64_tr_b16 v[74:75], v250 offset:53760
    s_waitcnt lgkmcnt(10)
    v_mfma_f32_16x16x32_bf16 v[92:95], v[40:43], v[28:31], v[92:95]
    ds_read_b128 v[56:59], v248 offset:40960
    s_lshl1_add_u32 m0, s33, 114688
    s_waitcnt lgkmcnt(10)
    v_mfma_f32_16x16x32_bf16 v[96:99], v[40:43], v[32:35], v[96:99]
    ds_read_b128 v[60:63], v248 offset:41984
    ds_read_b128 v[64:67], v248 offset:43008
    s_waitcnt lgkmcnt(11)
    v_mfma_f32_16x16x32_bf16 v[100:103], v[40:43], v[36:39], v[100:103]
    ds_read_b128 v[68:71], v248 offset:44032
    buffer_load_dwordx4 v254, s[60:63], s83 offen lds
    s_waitcnt lgkmcnt(10)
    v_mfma_f32_16x16x32_bf16 v[104:107], v[44:47], v[24:27], v[104:107]
    ds_read_b64_tr_b16 v[76:77], v251 offset:53248
    ds_read_b64_tr_b16 v[78:79], v251 offset:53760
    v_mfma_f32_16x16x32_bf16 v[108:111], v[44:47], v[28:31], v[108:111]
    ds_read_b64_tr_b16 v[80:81], v250 offset:61440
    s_lshl1_add_u32 m0, s33, 115712
    v_mfma_f32_16x16x32_bf16 v[112:115], v[44:47], v[32:35], v[112:115]
    ds_read_b64_tr_b16 v[82:83], v250 offset:61952
    ds_read_b64_tr_b16 v[84:85], v251 offset:61440
    v_mfma_f32_16x16x32_bf16 v[116:119], v[44:47], v[36:39], v[116:119]
    ds_read_b64_tr_b16 v[86:87], v251 offset:61952
    buffer_load_dwordx4 v255, s[60:63], s83 offen lds
    s_waitcnt lgkmcnt(14)
    v_mfma_f32_16x16x32_bf16 v[120:123], v[48:51], v[24:27], v[120:123]
    v_mfma_f32_16x16x32_bf16 v[124:127], v[48:51], v[28:31], v[124:127]
    s_lshl1_add_u32 m0, s33, 122880
    v_mfma_f32_16x16x32_bf16 v[128:131], v[48:51], v[32:35], v[128:131]
    v_mfma_f32_16x16x32_bf16 v[132:135], v[48:51], v[36:39], v[132:135]
    buffer_load_dwordx4 v254, s[64:67], s83 offen lds
    s_waitcnt lgkmcnt(12)
    v_mfma_f32_16x16x32_bf16 v[136:139], v[52:55], v[24:27], v[136:139]
    v_mfma_f32_16x16x32_bf16 v[140:143], v[52:55], v[28:31], v[140:143]
    s_lshl1_add_u32 m0, s33, 123904
    v_mfma_f32_16x16x32_bf16 v[144:147], v[52:55], v[32:35], v[144:147]
    v_mfma_f32_16x16x32_bf16 v[148:151], v[52:55], v[36:39], v[148:151]
    buffer_load_dwordx4 v255, s[64:67], s83 offen lds
    s_add_u32 s83, s83, 131072
    s_waitcnt vmcnt(16) lgkmcnt(0)
    s_barrier
    v_mfma_f32_16x16x32_bf16 v[88:91], v[72:75], v[56:59], v[88:91]
    ds_read_b64_tr_b16 v[40:41], v252 offset:16384
    ds_read_b64_tr_b16 v[42:43], v252 offset:16896
    v_mfma_f32_16x16x32_bf16 v[92:95], v[72:75], v[60:63], v[92:95]
    ds_read_b128 v[24:27], v249 offset:0
    s_lshl2_add_u32 m0, s33, 32768
    v_mfma_f32_16x16x32_bf16 v[96:99], v[72:75], v[64:67], v[96:99]
    ds_read_b128 v[28:31], v249 offset:1024
    v_mfma_f32_16x16x32_bf16 v[100:103], v[72:75], v[68:71], v[100:103]
    ds_read_b128 v[32:35], v249 offset:2048
    buffer_load_dwordx4 v18, s[56:59], s82 offen offset:0 sc1 lds
    v_mfma_f32_16x16x32_bf16 v[104:107], v[76:79], v[56:59], v[104:107]
    ds_read_b128 v[36:39], v249 offset:3072
    v_mfma_f32_16x16x32_bf16 v[108:111], v[76:79], v[60:63], v[108:111]
    ds_read_b64_tr_b16 v[44:45], v253 offset:16384
    ds_read_b64_tr_b16 v[46:47], v253 offset:16896
    v_mfma_f32_16x16x32_bf16 v[112:115], v[76:79], v[64:67], v[112:115]
    ds_read_b64_tr_b16 v[48:49], v252 offset:24576
    v_mfma_f32_16x16x32_bf16 v[116:119], v[76:79], v[68:71], v[116:119]
    ds_read_b64_tr_b16 v[50:51], v252 offset:25088
    buffer_load_dwordx4 v18, s[56:59], s82 offen offset:1024 sc1 lds
    v_mfma_f32_16x16x32_bf16 v[120:123], v[80:83], v[56:59], v[120:123]
    ds_read_b64_tr_b16 v[52:53], v253 offset:24576
    v_mfma_f32_16x16x32_bf16 v[124:127], v[80:83], v[60:63], v[124:127]
    ds_read_b64_tr_b16 v[54:55], v253 offset:25088
    v_mfma_f32_16x16x32_bf16 v[128:131], v[80:83], v[64:67], v[128:131]
    v_mfma_f32_16x16x32_bf16 v[132:135], v[80:83], v[68:71], v[132:135]
    buffer_load_dwordx4 v18, s[56:59], s82 offen offset:2048 sc1 lds
    v_mfma_f32_16x16x32_bf16 v[136:139], v[84:87], v[56:59], v[136:139]
    v_mfma_f32_16x16x32_bf16 v[140:143], v[84:87], v[60:63], v[140:143]
    v_mfma_f32_16x16x32_bf16 v[144:147], v[84:87], v[64:67], v[144:147]
    v_mfma_f32_16x16x32_bf16 v[148:151], v[84:87], v[68:71], v[148:151]
    buffer_load_dwordx4 v18, s[56:59], s82 offen offset:3072 sc1 lds
    s_add_u32 s82, s82, 16384
    s_waitcnt lgkmcnt(9)
    v_mfma_f32_16x16x32_bf16 v[88:91], v[40:43], v[24:27], v[88:91]
    ds_read_b64_tr_b16 v[72:73], v252 offset:20480
    ds_read_b64_tr_b16 v[74:75], v252 offset:20992
    s_waitcnt lgkmcnt(10)
    v_mfma_f32_16x16x32_bf16 v[92:95], v[40:43], v[28:31], v[92:95]
    ds_read_b128 v[56:59], v249 offset:8192
    s_lshl1_add_u32 m0, s33, 49152
    s_waitcnt lgkmcnt(10)
    v_mfma_f32_16x16x32_bf16 v[96:99], v[40:43], v[32:35], v[96:99]
    ds_read_b128 v[60:63], v249 offset:9216
    ds_read_b128 v[64:67], v249 offset:10240
    s_waitcnt lgkmcnt(11)
    v_mfma_f32_16x16x32_bf16 v[100:103], v[40:43], v[36:39], v[100:103]
    ds_read_b128 v[68:71], v249 offset:11264
    buffer_load_dwordx4 v254, s[60:63], s83 offen lds
    s_waitcnt lgkmcnt(10)
    v_mfma_f32_16x16x32_bf16 v[104:107], v[44:47], v[24:27], v[104:107]
    ds_read_b64_tr_b16 v[76:77], v253 offset:20480
    ds_read_b64_tr_b16 v[78:79], v253 offset:20992
    v_mfma_f32_16x16x32_bf16 v[108:111], v[44:47], v[28:31], v[108:111]
    ds_read_b64_tr_b16 v[80:81], v252 offset:28672
    s_lshl1_add_u32 m0, s33, 50176
    v_mfma_f32_16x16x32_bf16 v[112:115], v[44:47], v[32:35], v[112:115]
    ds_read_b64_tr_b16 v[82:83], v252 offset:29184
    ds_read_b64_tr_b16 v[84:85], v253 offset:28672
    v_mfma_f32_16x16x32_bf16 v[116:119], v[44:47], v[36:39], v[116:119]
    ds_read_b64_tr_b16 v[86:87], v253 offset:29184
    buffer_load_dwordx4 v255, s[60:63], s83 offen lds
    s_waitcnt lgkmcnt(14)
    v_mfma_f32_16x16x32_bf16 v[120:123], v[48:51], v[24:27], v[120:123]
    v_mfma_f32_16x16x32_bf16 v[124:127], v[48:51], v[28:31], v[124:127]
    s_lshl1_add_u32 m0, s33, 57344
    v_mfma_f32_16x16x32_bf16 v[128:131], v[48:51], v[32:35], v[128:131]
    v_mfma_f32_16x16x32_bf16 v[132:135], v[48:51], v[36:39], v[132:135]
    buffer_load_dwordx4 v254, s[64:67], s83 offen lds
    s_waitcnt lgkmcnt(12)
    v_mfma_f32_16x16x32_bf16 v[136:139], v[52:55], v[24:27], v[136:139]
    v_mfma_f32_16x16x32_bf16 v[140:143], v[52:55], v[28:31], v[140:143]
    s_lshl1_add_u32 m0, s33, 58368
    v_mfma_f32_16x16x32_bf16 v[144:147], v[52:55], v[32:35], v[144:147]
    v_mfma_f32_16x16x32_bf16 v[148:151], v[52:55], v[36:39], v[148:151]
    buffer_load_dwordx4 v255, s[64:67], s83 offen lds
    s_add_u32 s83, s83, 131072
    s_waitcnt vmcnt(16) lgkmcnt(0)
    s_barrier
    v_mfma_f32_16x16x32_bf16 v[88:91], v[72:75], v[56:59], v[88:91]
    ds_read_b64_tr_b16 v[40:41], v250 offset:16384
    ds_read_b64_tr_b16 v[42:43], v250 offset:16896
    v_mfma_f32_16x16x32_bf16 v[92:95], v[72:75], v[60:63], v[92:95]
    ds_read_b128 v[24:27], v248 offset:0
    s_lshl2_add_u32 m0, s33, 65536
    v_mfma_f32_16x16x32_bf16 v[96:99], v[72:75], v[64:67], v[96:99]
    ds_read_b128 v[28:31], v248 offset:1024
    v_mfma_f32_16x16x32_bf16 v[100:103], v[72:75], v[68:71], v[100:103]
    ds_read_b128 v[32:35], v248 offset:2048
    buffer_load_dwordx4 v18, s[56:59], s82 offen offset:0 sc1 lds
    v_mfma_f32_16x16x32_bf16 v[104:107], v[76:79], v[56:59], v[104:107]
    ds_read_b128 v[36:39], v248 offset:3072
    v_mfma_f32_16x16x32_bf16 v[108:111], v[76:79], v[60:63], v[108:111]
    ds_read_b64_tr_b16 v[44:45], v251 offset:16384
    ds_read_b64_tr_b16 v[46:47], v251 offset:16896
    v_mfma_f32_16x16x32_bf16 v[112:115], v[76:79], v[64:67], v[112:115]
    ds_read_b64_tr_b16 v[48:49], v250 offset:24576
    v_mfma_f32_16x16x32_bf16 v[116:119], v[76:79], v[68:71], v[116:119]
    ds_read_b64_tr_b16 v[50:51], v250 offset:25088
    buffer_load_dwordx4 v18, s[56:59], s82 offen offset:1024 sc1 lds
    v_mfma_f32_16x16x32_bf16 v[120:123], v[80:83], v[56:59], v[120:123]
    ds_read_b64_tr_b16 v[52:53], v251 offset:24576
    v_mfma_f32_16x16x32_bf16 v[124:127], v[80:83], v[60:63], v[124:127]
    ds_read_b64_tr_b16 v[54:55], v251 offset:25088
    v_mfma_f32_16x16x32_bf16 v[128:131], v[80:83], v[64:67], v[128:131]
    v_mfma_f32_16x16x32_bf16 v[132:135], v[80:83], v[68:71], v[132:135]
    buffer_load_dwordx4 v18, s[56:59], s82 offen offset:2048 sc1 lds
    v_mfma_f32_16x16x32_bf16 v[136:139], v[84:87], v[56:59], v[136:139]
    v_mfma_f32_16x16x32_bf16 v[140:143], v[84:87], v[60:63], v[140:143]
    v_mfma_f32_16x16x32_bf16 v[144:147], v[84:87], v[64:67], v[144:147]
    v_mfma_f32_16x16x32_bf16 v[148:151], v[84:87], v[68:71], v[148:151]
    buffer_load_dwordx4 v18, s[56:59], s82 offen offset:3072 sc1 lds
    s_add_u32 s82, s82, 16384
    s_waitcnt lgkmcnt(9)
    v_mfma_f32_16x16x32_bf16 v[88:91], v[40:43], v[24:27], v[88:91]
    ds_read_b64_tr_b16 v[72:73], v250 offset:20480
    ds_read_b64_tr_b16 v[74:75], v250 offset:20992
    s_waitcnt lgkmcnt(10)
    v_mfma_f32_16x16x32_bf16 v[92:95], v[40:43], v[28:31], v[92:95]
    ds_read_b128 v[56:59], v248 offset:8192
    s_lshl1_add_u32 m0, s33, 81920
    s_waitcnt lgkmcnt(10)
    v_mfma_f32_16x16x32_bf16 v[96:99], v[40:43], v[32:35], v[96:99]
    ds_read_b128 v[60:63], v248 offset:9216
    ds_read_b128 v[64:67], v248 offset:10240
    s_waitcnt lgkmcnt(11)
    v_mfma_f32_16x16x32_bf16 v[100:103], v[40:43], v[36:39], v[100:103]
    ds_read_b128 v[68:71], v248 offset:11264
    buffer_load_dwordx4 v254, s[60:63], s83 offen lds
    s_waitcnt lgkmcnt(10)
    v_mfma_f32_16x16x32_bf16 v[104:107], v[44:47], v[24:27], v[104:107]
    ds_read_b64_tr_b16 v[76:77], v251 offset:20480
    ds_read_b64_tr_b16 v[78:79], v251 offset:20992
    v_mfma_f32_16x16x32_bf16 v[108:111], v[44:47], v[28:31], v[108:111]
    ds_read_b64_tr_b16 v[80:81], v250 offset:28672
    s_lshl1_add_u32 m0, s33, 82944
    v_mfma_f32_16x16x32_bf16 v[112:115], v[44:47], v[32:35], v[112:115]
    ds_read_b64_tr_b16 v[82:83], v250 offset:29184
    ds_read_b64_tr_b16 v[84:85], v251 offset:28672
    v_mfma_f32_16x16x32_bf16 v[116:119], v[44:47], v[36:39], v[116:119]
    ds_read_b64_tr_b16 v[86:87], v251 offset:29184
    buffer_load_dwordx4 v255, s[60:63], s83 offen lds
    s_waitcnt lgkmcnt(14)
    v_mfma_f32_16x16x32_bf16 v[120:123], v[48:51], v[24:27], v[120:123]
    v_mfma_f32_16x16x32_bf16 v[124:127], v[48:51], v[28:31], v[124:127]
    s_lshl1_add_u32 m0, s33, 90112
    v_mfma_f32_16x16x32_bf16 v[128:131], v[48:51], v[32:35], v[128:131]
    v_mfma_f32_16x16x32_bf16 v[132:135], v[48:51], v[36:39], v[132:135]
    buffer_load_dwordx4 v254, s[64:67], s83 offen lds
    s_waitcnt lgkmcnt(12)
    v_mfma_f32_16x16x32_bf16 v[136:139], v[52:55], v[24:27], v[136:139]
    v_mfma_f32_16x16x32_bf16 v[140:143], v[52:55], v[28:31], v[140:143]
    s_lshl1_add_u32 m0, s33, 91136
    v_mfma_f32_16x16x32_bf16 v[144:147], v[52:55], v[32:35], v[144:147]
    v_mfma_f32_16x16x32_bf16 v[148:151], v[52:55], v[36:39], v[148:151]
    buffer_load_dwordx4 v255, s[64:67], s83 offen lds
    s_add_u32 s83, s83, 131072
    s_waitcnt vmcnt(16) lgkmcnt(0)
    s_barrier
    v_mfma_f32_16x16x32_bf16 v[88:91], v[72:75], v[56:59], v[88:91]
    ds_read_b64_tr_b16 v[40:41], v252 offset:49152
    ds_read_b64_tr_b16 v[42:43], v252 offset:49664
    v_mfma_f32_16x16x32_bf16 v[92:95], v[72:75], v[60:63], v[92:95]
    ds_read_b128 v[24:27], v249 offset:32768
    s_lshl_b32 m0, s33, 2
    v_mfma_f32_16x16x32_bf16 v[96:99], v[72:75], v[64:67], v[96:99]
    ds_read_b128 v[28:31], v249 offset:33792
    v_mfma_f32_16x16x32_bf16 v[100:103], v[72:75], v[68:71], v[100:103]
    ds_read_b128 v[32:35], v249 offset:34816
    buffer_load_dwordx4 v18, s[56:59], s82 offen offset:0 sc1 lds
    v_mfma_f32_16x16x32_bf16 v[104:107], v[76:79], v[56:59], v[104:107]
    ds_read_b128 v[36:39], v249 offset:35840
    v_mfma_f32_16x16x32_bf16 v[108:111], v[76:79], v[60:63], v[108:111]
    ds_read_b64_tr_b16 v[44:45], v253 offset:49152
    ds_read_b64_tr_b16 v[46:47], v253 offset:49664
    v_mfma_f32_16x16x32_bf16 v[112:115], v[76:79], v[64:67], v[112:115]
    ds_read_b64_tr_b16 v[48:49], v252 offset:57344
    v_mfma_f32_16x16x32_bf16 v[116:119], v[76:79], v[68:71], v[116:119]
    ds_read_b64_tr_b16 v[50:51], v252 offset:57856
    buffer_load_dwordx4 v18, s[56:59], s82 offen offset:1024 sc1 lds
    v_mfma_f32_16x16x32_bf16 v[120:123], v[80:83], v[56:59], v[120:123]
    ds_read_b64_tr_b16 v[52:53], v253 offset:57344
    v_mfma_f32_16x16x32_bf16 v[124:127], v[80:83], v[60:63], v[124:127]
    ds_read_b64_tr_b16 v[54:55], v253 offset:57856
    v_mfma_f32_16x16x32_bf16 v[128:131], v[80:83], v[64:67], v[128:131]
    v_mfma_f32_16x16x32_bf16 v[132:135], v[80:83], v[68:71], v[132:135]
    buffer_load_dwordx4 v18, s[56:59], s82 offen offset:2048 sc1 lds
    v_mfma_f32_16x16x32_bf16 v[136:139], v[84:87], v[56:59], v[136:139]
    v_mfma_f32_16x16x32_bf16 v[140:143], v[84:87], v[60:63], v[140:143]
    v_mfma_f32_16x16x32_bf16 v[144:147], v[84:87], v[64:67], v[144:147]
    v_mfma_f32_16x16x32_bf16 v[148:151], v[84:87], v[68:71], v[148:151]
    buffer_load_dwordx4 v18, s[56:59], s82 offen offset:3072 sc1 lds
    s_add_u32 s82, s82, 16384
    s_waitcnt lgkmcnt(9)
    v_mfma_f32_16x16x32_bf16 v[88:91], v[40:43], v[24:27], v[88:91]
    ds_read_b64_tr_b16 v[72:73], v252 offset:53248
    ds_read_b64_tr_b16 v[74:75], v252 offset:53760
    s_waitcnt lgkmcnt(10)
    v_mfma_f32_16x16x32_bf16 v[92:95], v[40:43], v[28:31], v[92:95]
    ds_read_b128 v[56:59], v249 offset:40960
    s_lshl1_add_u32 m0, s33, 16384
    s_waitcnt lgkmcnt(10)
    v_mfma_f32_16x16x32_bf16 v[96:99], v[40:43], v[32:35], v[96:99]
    ds_read_b128 v[60:63], v249 offset:41984
    ds_read_b128 v[64:67], v249 offset:43008
    s_waitcnt lgkmcnt(11)
    v_mfma_f32_16x16x32_bf16 v[100:103], v[40:43], v[36:39], v[100:103]
    ds_read_b128 v[68:71], v249 offset:44032
    buffer_load_dwordx4 v254, s[60:63], s83 offen lds
    s_waitcnt lgkmcnt(10)
    v_mfma_f32_16x16x32_bf16 v[104:107], v[44:47], v[24:27], v[104:107]
    ds_read_b64_tr_b16 v[76:77], v253 offset:53248
    ds_read_b64_tr_b16 v[78:79], v253 offset:53760
    v_mfma_f32_16x16x32_bf16 v[108:111], v[44:47], v[28:31], v[108:111]
    ds_read_b64_tr_b16 v[80:81], v252 offset:61440
    s_lshl1_add_u32 m0, s33, 17408
    v_mfma_f32_16x16x32_bf16 v[112:115], v[44:47], v[32:35], v[112:115]
    ds_read_b64_tr_b16 v[82:83], v252 offset:61952
    ds_read_b64_tr_b16 v[84:85], v253 offset:61440
    v_mfma_f32_16x16x32_bf16 v[116:119], v[44:47], v[36:39], v[116:119]
    ds_read_b64_tr_b16 v[86:87], v253 offset:61952
    buffer_load_dwordx4 v255, s[60:63], s83 offen lds
    s_waitcnt lgkmcnt(14)
    v_mfma_f32_16x16x32_bf16 v[120:123], v[48:51], v[24:27], v[120:123]
    v_mfma_f32_16x16x32_bf16 v[124:127], v[48:51], v[28:31], v[124:127]
    s_lshl1_add_u32 m0, s33, 24576
    v_mfma_f32_16x16x32_bf16 v[128:131], v[48:51], v[32:35], v[128:131]
    v_mfma_f32_16x16x32_bf16 v[132:135], v[48:51], v[36:39], v[132:135]
    buffer_load_dwordx4 v254, s[64:67], s83 offen lds
    s_waitcnt lgkmcnt(12)
    v_mfma_f32_16x16x32_bf16 v[136:139], v[52:55], v[24:27], v[136:139]
    v_mfma_f32_16x16x32_bf16 v[140:143], v[52:55], v[28:31], v[140:143]
    s_lshl1_add_u32 m0, s33, 25600
    v_mfma_f32_16x16x32_bf16 v[144:147], v[52:55], v[32:35], v[144:147]
    v_mfma_f32_16x16x32_bf16 v[148:151], v[52:55], v[36:39], v[148:151]
    buffer_load_dwordx4 v255, s[64:67], s83 offen lds
    s_add_u32 s83, s83, 131072
    s_waitcnt vmcnt(16) lgkmcnt(0)
    s_barrier
    v_mfma_f32_16x16x32_bf16 v[88:91], v[72:75], v[56:59], v[88:91]
    ds_read_b64_tr_b16 v[40:41], v250 offset:49152
    ds_read_b64_tr_b16 v[42:43], v250 offset:49664
    v_mfma_f32_16x16x32_bf16 v[92:95], v[72:75], v[60:63], v[92:95]
    ds_read_b128 v[24:27], v248 offset:32768
    s_lshl2_add_u32 m0, s33, 98304
    v_mfma_f32_16x16x32_bf16 v[96:99], v[72:75], v[64:67], v[96:99]
    ds_read_b128 v[28:31], v248 offset:33792
    v_mfma_f32_16x16x32_bf16 v[100:103], v[72:75], v[68:71], v[100:103]
    ds_read_b128 v[32:35], v248 offset:34816
    buffer_load_dwordx4 v18, s[56:59], s82 offen offset:0 sc1 lds
    v_mfma_f32_16x16x32_bf16 v[104:107], v[76:79], v[56:59], v[104:107]
    ds_read_b128 v[36:39], v248 offset:35840
    v_mfma_f32_16x16x32_bf16 v[108:111], v[76:79], v[60:63], v[108:111]
    ds_read_b64_tr_b16 v[44:45], v251 offset:49152
    ds_read_b64_tr_b16 v[46:47], v251 offset:49664
    v_mfma_f32_16x16x32_bf16 v[112:115], v[76:79], v[64:67], v[112:115]
    ds_read_b64_tr_b16 v[48:49], v250 offset:57344
    v_mfma_f32_16x16x32_bf16 v[116:119], v[76:79], v[68:71], v[116:119]
    ds_read_b64_tr_b16 v[50:51], v250 offset:57856
    buffer_load_dwordx4 v18, s[56:59], s82 offen offset:1024 sc1 lds
    v_mfma_f32_16x16x32_bf16 v[120:123], v[80:83], v[56:59], v[120:123]
    ds_read_b64_tr_b16 v[52:53], v251 offset:57344
    v_mfma_f32_16x16x32_bf16 v[124:127], v[80:83], v[60:63], v[124:127]
    ds_read_b64_tr_b16 v[54:55], v251 offset:57856
    v_mfma_f32_16x16x32_bf16 v[128:131], v[80:83], v[64:67], v[128:131]
    v_mfma_f32_16x16x32_bf16 v[132:135], v[80:83], v[68:71], v[132:135]
    buffer_load_dwordx4 v18, s[56:59], s82 offen offset:2048 sc1 lds
    v_mfma_f32_16x16x32_bf16 v[136:139], v[84:87], v[56:59], v[136:139]
    v_mfma_f32_16x16x32_bf16 v[140:143], v[84:87], v[60:63], v[140:143]
    v_mfma_f32_16x16x32_bf16 v[144:147], v[84:87], v[64:67], v[144:147]
    v_mfma_f32_16x16x32_bf16 v[148:151], v[84:87], v[68:71], v[148:151]
    buffer_load_dwordx4 v18, s[56:59], s82 offen offset:3072 sc1 lds
    s_add_u32 s82, s82, 16384
    s_waitcnt lgkmcnt(9)
    v_mfma_f32_16x16x32_bf16 v[88:91], v[40:43], v[24:27], v[88:91]
    ds_read_b64_tr_b16 v[72:73], v250 offset:53248
    ds_read_b64_tr_b16 v[74:75], v250 offset:53760
    s_waitcnt lgkmcnt(10)
    v_mfma_f32_16x16x32_bf16 v[92:95], v[40:43], v[28:31], v[92:95]
    ds_read_b128 v[56:59], v248 offset:40960
    s_lshl1_add_u32 m0, s33, 114688
    s_waitcnt lgkmcnt(10)
    v_mfma_f32_16x16x32_bf16 v[96:99], v[40:43], v[32:35], v[96:99]
    ds_read_b128 v[60:63], v248 offset:41984
    ds_read_b128 v[64:67], v248 offset:43008
    s_waitcnt lgkmcnt(11)
    v_mfma_f32_16x16x32_bf16 v[100:103], v[40:43], v[36:39], v[100:103]
    ds_read_b128 v[68:71], v248 offset:44032
    buffer_load_dwordx4 v254, s[60:63], s83 offen lds
    s_waitcnt lgkmcnt(10)
    v_mfma_f32_16x16x32_bf16 v[104:107], v[44:47], v[24:27], v[104:107]
    ds_read_b64_tr_b16 v[76:77], v251 offset:53248
    ds_read_b64_tr_b16 v[78:79], v251 offset:53760
    v_mfma_f32_16x16x32_bf16 v[108:111], v[44:47], v[28:31], v[108:111]
    ds_read_b64_tr_b16 v[80:81], v250 offset:61440
    s_lshl1_add_u32 m0, s33, 115712
    v_mfma_f32_16x16x32_bf16 v[112:115], v[44:47], v[32:35], v[112:115]
    ds_read_b64_tr_b16 v[82:83], v250 offset:61952
    ds_read_b64_tr_b16 v[84:85], v251 offset:61440
    v_mfma_f32_16x16x32_bf16 v[116:119], v[44:47], v[36:39], v[116:119]
    ds_read_b64_tr_b16 v[86:87], v251 offset:61952
    buffer_load_dwordx4 v255, s[60:63], s83 offen lds
    s_waitcnt lgkmcnt(14)
    v_mfma_f32_16x16x32_bf16 v[120:123], v[48:51], v[24:27], v[120:123]
    v_mfma_f32_16x16x32_bf16 v[124:127], v[48:51], v[28:31], v[124:127]
    s_lshl1_add_u32 m0, s33, 122880
    v_mfma_f32_16x16x32_bf16 v[128:131], v[48:51], v[32:35], v[128:131]
    v_mfma_f32_16x16x32_bf16 v[132:135], v[48:51], v[36:39], v[132:135]
    buffer_load_dwordx4 v254, s[64:67], s83 offen lds
    s_waitcnt lgkmcnt(12)
    v_mfma_f32_16x16x32_bf16 v[136:139], v[52:55], v[24:27], v[136:139]
    v_mfma_f32_16x16x32_bf16 v[140:143], v[52:55], v[28:31], v[140:143]
    s_lshl1_add_u32 m0, s33, 123904
    v_mfma_f32_16x16x32_bf16 v[144:147], v[52:55], v[32:35], v[144:147]
    v_mfma_f32_16x16x32_bf16 v[148:151], v[52:55], v[36:39], v[148:151]
    buffer_load_dwordx4 v255, s[64:67], s83 offen lds
    s_add_u32 s83, s83, 131072
    s_waitcnt vmcnt(16) lgkmcnt(0)
    s_barrier
    v_mfma_f32_16x16x32_bf16 v[88:91], v[72:75], v[56:59], v[88:91]
    ds_read_b64_tr_b16 v[40:41], v252 offset:16384
    ds_read_b64_tr_b16 v[42:43], v252 offset:16896
    v_mfma_f32_16x16x32_bf16 v[92:95], v[72:75], v[60:63], v[92:95]
    ds_read_b128 v[24:27], v249 offset:0
    s_lshl2_add_u32 m0, s33, 32768
    v_mfma_f32_16x16x32_bf16 v[96:99], v[72:75], v[64:67], v[96:99]
    ds_read_b128 v[28:31], v249 offset:1024
    v_mfma_f32_16x16x32_bf16 v[100:103], v[72:75], v[68:71], v[100:103]
    ds_read_b128 v[32:35], v249 offset:2048
    buffer_load_dwordx4 v18, s[56:59], s82 offen offset:0 sc1 lds
    v_mfma_f32_16x16x32_bf16 v[104:107], v[76:79], v[56:59], v[104:107]
    ds_read_b128 v[36:39], v249 offset:3072
    v_mfma_f32_16x16x32_bf16 v[108:111], v[76:79], v[60:63], v[108:111]
    ds_read_b64_tr_b16 v[44:45], v253 offset:16384
    ds_read_b64_tr_b16 v[46:47], v253 offset:16896
    v_mfma_f32_16x16x32_bf16 v[112:115], v[76:79], v[64:67], v[112:115]
    ds_read_b64_tr_b16 v[48:49], v252 offset:24576
    v_mfma_f32_16x16x32_bf16 v[116:119], v[76:79], v[68:71], v[116:119]
    ds_read_b64_tr_b16 v[50:51], v252 offset:25088
    buffer_load_dwordx4 v18, s[56:59], s82 offen offset:1024 sc1 lds
    v_mfma_f32_16x16x32_bf16 v[120:123], v[80:83], v[56:59], v[120:123]
    ds_read_b64_tr_b16 v[52:53], v253 offset:24576
    v_mfma_f32_16x16x32_bf16 v[124:127], v[80:83], v[60:63], v[124:127]
    ds_read_b64_tr_b16 v[54:55], v253 offset:25088
L_pad4:
    s_cbranch_execz L_vret2
    v_mfma_f32_16x16x32_bf16 v[128:131], v[80:83], v[64:67], v[128:131]
    v_mfma_f32_16x16x32_bf16 v[132:135], v[80:83], v[68:71], v[132:135]
    buffer_load_dwordx4 v18, s[56:59], s82 offen offset:2048 sc1 lds
    v_mfma_f32_16x16x32_bf16 v[136:139], v[84:87], v[56:59], v[136:139]
    v_mfma_f32_16x16x32_bf16 v[140:143], v[84:87], v[60:63], v[140:143]
    v_mfma_f32_16x16x32_bf16 v[144:147], v[84:87], v[64:67], v[144:147]
    v_mfma_f32_16x16x32_bf16 v[148:151], v[84:87], v[68:71], v[148:151]
    buffer_load_dwordx4 v18, s[56:59], s82 offen offset:3072 sc1 lds
    s_add_u32 s82, s82, 16384
    s_waitcnt lgkmcnt(9)
    v_mfma_f32_16x16x32_bf16 v[88:91], v[40:43], v[24:27], v[88:91]
    ds_read_b64_tr_b16 v[72:73], v252 offset:20480
    ds_read_b64_tr_b16 v[74:75], v252 offset:20992
    s_waitcnt lgkmcnt(10)
    v_mfma_f32_16x16x32_bf16 v[92:95], v[40:43], v[28:31], v[92:95]
    ds_read_b128 v[56:59], v249 offset:8192
    s_lshl1_add_u32 m0, s33, 49152
    s_waitcnt lgkmcnt(10)
    v_mfma_f32_16x16x32_bf16 v[96:99], v[40:43], v[32:35], v[96:99]
    ds_read_b128 v[60:63], v249 offset:9216
    ds_read_b128 v[64:67], v249 offset:10240
    s_waitcnt lgkmcnt(11)
    v_mfma_f32_16x16x32_bf16 v[100:103], v[40:43], v[36:39], v[100:103]
    ds_read_b128 v[68:71], v249 offset:11264
    buffer_load_dwordx4 v254, s[60:63], s83 offen lds
    s_waitcnt lgkmcnt(10)
    v_mfma_f32_16x16x32_bf16 v[104:107], v[44:47], v[24:27], v[104:107]
    ds_read_b64_tr_b16 v[76:77], v253 offset:20480
    ds_read_b64_tr_b16 v[78:79], v253 offset:20992
    v_mfma_f32_16x16x32_bf16 v[108:111], v[44:47], v[28:31], v[108:111]
    ds_read_b64_tr_b16 v[80:81], v252 offset:28672
    s_lshl1_add_u32 m0, s33, 50176
    v_mfma_f32_16x16x32_bf16 v[112:115], v[44:47], v[32:35], v[112:115]
    ds_read_b64_tr_b16 v[82:83], v252 offset:29184
    ds_read_b64_tr_b16 v[84:85], v253 offset:28672
    v_mfma_f32_16x16x32_bf16 v[116:119], v[44:47], v[36:39], v[116:119]
    ds_read_b64_tr_b16 v[86:87], v253 offset:29184
    buffer_load_dwordx4 v255, s[60:63], s83 offen lds
    s_waitcnt lgkmcnt(14)
    v_mfma_f32_16x16x32_bf16 v[120:123], v[48:51], v[24:27], v[120:123]
    v_mfma_f32_16x16x32_bf16 v[124:127], v[48:51], v[28:31], v[124:127]
    s_lshl1_add_u32 m0, s33, 57344
    v_mfma_f32_16x16x32_bf16 v[128:131], v[48:51], v[32:35], v[128:131]
    v_mfma_f32_16x16x32_bf16 v[132:135], v[48:51], v[36:39], v[132:135]
    buffer_load_dwordx4 v254, s[64:67], s83 offen lds
    s_waitcnt lgkmcnt(12)
    v_mfma_f32_16x16x32_bf16 v[136:139], v[52:55], v[24:27], v[136:139]
    v_mfma_f32_16x16x32_bf16 v[140:143], v[52:55], v[28:31], v[140:143]
    s_lshl1_add_u32 m0, s33, 58368
    v_mfma_f32_16x16x32_bf16 v[144:147], v[52:55], v[32:35], v[144:147]
    v_mfma_f32_16x16x32_bf16 v[148:151], v[52:55], v[36:39], v[148:151]
    buffer_load_dwordx4 v255, s[64:67], s83 offen lds
    s_add_u32 s83, s83, 131072
    s_waitcnt vmcnt(16) lgkmcnt(0)
    s_barrier
    v_mfma_f32_16x16x32_bf16 v[88:91], v[72:75], v[56:59], v[88:91]
    ds_read_b64_tr_b16 v[40:41], v250 offset:16384
    ds_read_b64_tr_b16 v[42:43], v250 offset:16896
    v_mfma_f32_16x16x32_bf16 v[92:95], v[72:75], v[60:63], v[92:95]
    ds_read_b128 v[24:27], v248 offset:0
    s_lshl2_add_u32 m0, s33, 65536
    v_mfma_f32_16x16x32_bf16 v[96:99], v[72:75], v[64:67], v[96:99]
    ds_read_b128 v[28:31], v248 offset:1024
    v_mfma_f32_16x16x32_bf16 v[100:103], v[72:75], v[68:71], v[100:103]
    ds_read_b128 v[32:35], v248 offset:2048
    buffer_load_dwordx4 v18, s[56:59], s82 offen offset:0 sc1 lds
    v_mfma_f32_16x16x32_bf16 v[104:107], v[76:79], v[56:59], v[104:107]
    ds_read_b128 v[36:39], v248 offset:3072
    v_mfma_f32_16x16x32_bf16 v[108:111], v[76:79], v[60:63], v[108:111]
    ds_read_b64_tr_b16 v[44:45], v251 offset:16384
    ds_read_b64_tr_b16 v[46:47], v251 offset:16896
    v_mfma_f32_16x16x32_bf16 v[112:115], v[76:79], v[64:67], v[112:115]
    ds_read_b64_tr_b16 v[48:49], v250 offset:24576
    v_mfma_f32_16x16x32_bf16 v[116:119], v[76:79], v[68:71], v[116:119]
    ds_read_b64_tr_b16 v[50:51], v250 offset:25088
    buffer_load_dwordx4 v18, s[56:59], s82 offen offset:1024 sc1 lds
    v_mfma_f32_16x16x32_bf16 v[120:123], v[80:83], v[56:59], v[120:123]
    ds_read_b64_tr_b16 v[52:53], v251 offset:24576
    v_mfma_f32_16x16x32_bf16 v[124:127], v[80:83], v[60:63], v[124:127]
    ds_read_b64_tr_b16 v[54:55], v251 offset:25088
    v_mfma_f32_16x16x32_bf16 v[128:131], v[80:83], v[64:67], v[128:131]
    v_mfma_f32_16x16x32_bf16 v[132:135], v[80:83], v[68:71], v[132:135]
    buffer_load_dwordx4 v18, s[56:59], s82 offen offset:2048 sc1 lds
    v_mfma_f32_16x16x32_bf16 v[136:139], v[84:87], v[56:59], v[136:139]
    v_mfma_f32_16x16x32_bf16 v[140:143], v[84:87], v[60:63], v[140:143]
    v_mfma_f32_16x16x32_bf16 v[144:147], v[84:87], v[64:67], v[144:147]
    v_mfma_f32_16x16x32_bf16 v[148:151], v[84:87], v[68:71], v[148:151]
    buffer_load_dwordx4 v18, s[56:59], s82 offen offset:3072 sc1 lds
    s_add_u32 s82, s82, 16384
    s_waitcnt lgkmcnt(9)
    v_mfma_f32_16x16x32_bf16 v[88:91], v[40:43], v[24:27], v[88:91]
    ds_read_b64_tr_b16 v[72:73], v250 offset:20480
    ds_read_b64_tr_b16 v[74:75], v250 offset:20992
    s_waitcnt lgkmcnt(10)
    v_mfma_f32_16x16x32_bf16 v[92:95], v[40:43], v[28:31], v[92:95]
    ds_read_b128 v[56:59], v248 offset:8192
    s_waitcnt lgkmcnt(10)
    v_mfma_f32_16x16x32_bf16 v[96:99], v[40:43], v[32:35], v[96:99]
    ds_read_b128 v[60:63], v248 offset:9216
    ds_read_b128 v[64:67], v248 offset:10240
    s_waitcnt lgkmcnt(11)
    v_mfma_f32_16x16x32_bf16 v[100:103], v[40:43], v[36:39], v[100:103]
    ds_read_b128 v[68:71], v248 offset:11264
    s_waitcnt lgkmcnt(10)
    v_mfma_f32_16x16x32_bf16 v[104:107], v[44:47], v[24:27], v[104:107]
    ds_read_b64_tr_b16 v[76:77], v251 offset:20480
    ds_read_b64_tr_b16 v[78:79], v251 offset:20992
    v_mfma_f32_16x16x32_bf16 v[108:111], v[44:47], v[28:31], v[108:111]
    ds_read_b64_tr_b16 v[80:81], v250 offset:28672
    v_mfma_f32_16x16x32_bf16 v[112:115], v[44:47], v[32:35], v[112:115]
    ds_read_b64_tr_b16 v[82:83], v250 offset:29184
    ds_read_b64_tr_b16 v[84:85], v251 offset:28672
    v_mfma_f32_16x16x32_bf16 v[116:119], v[44:47], v[36:39], v[116:119]
    ds_read_b64_tr_b16 v[86:87], v251 offset:29184
    s_waitcnt lgkmcnt(14)
    v_mfma_f32_16x16x32_bf16 v[120:123], v[48:51], v[24:27], v[120:123]
    v_mfma_f32_16x16x32_bf16 v[124:127], v[48:51], v[28:31], v[124:127]
    v_mfma_f32_16x16x32_bf16 v[128:131], v[48:51], v[32:35], v[128:131]
    v_mfma_f32_16x16x32_bf16 v[132:135], v[48:51], v[36:39], v[132:135]
    s_waitcnt lgkmcnt(12)
    v_mfma_f32_16x16x32_bf16 v[136:139], v[52:55], v[24:27], v[136:139]
    v_mfma_f32_16x16x32_bf16 v[140:143], v[52:55], v[28:31], v[140:143]
    v_mfma_f32_16x16x32_bf16 v[144:147], v[52:55], v[32:35], v[144:147]
    v_mfma_f32_16x16x32_bf16 v[148:151], v[52:55], v[36:39], v[148:151]
    s_waitcnt vmcnt(12) lgkmcnt(0)
    s_barrier
    v_mfma_f32_16x16x32_bf16 v[88:91], v[72:75], v[56:59], v[88:91]
    ds_read_b64_tr_b16 v[40:41], v252 offset:49152
    ds_read_b64_tr_b16 v[42:43], v252 offset:49664
    v_mfma_f32_16x16x32_bf16 v[92:95], v[72:75], v[60:63], v[92:95]
    ds_read_b128 v[24:27], v249 offset:32768
    v_mfma_f32_16x16x32_bf16 v[96:99], v[72:75], v[64:67], v[96:99]
    ds_read_b128 v[28:31], v249 offset:33792
    v_mfma_f32_16x16x32_bf16 v[100:103], v[72:75], v[68:71], v[100:103]
    ds_read_b128 v[32:35], v249 offset:34816
    v_mfma_f32_16x16x32_bf16 v[104:107], v[76:79], v[56:59], v[104:107]
    ds_read_b128 v[36:39], v249 offset:35840
    v_mfma_f32_16x16x32_bf16 v[108:111], v[76:79], v[60:63], v[108:111]
    ds_read_b64_tr_b16 v[44:45], v253 offset:49152
    ds_read_b64_tr_b16 v[46:47], v253 offset:49664
    v_mfma_f32_16x16x32_bf16 v[112:115], v[76:79], v[64:67], v[112:115]
    ds_read_b64_tr_b16 v[48:49], v252 offset:57344
    v_mfma_f32_16x16x32_bf16 v[116:119], v[76:79], v[68:71], v[116:119]
    ds_read_b64_tr_b16 v[50:51], v252 offset:57856
    v_mfma_f32_16x16x32_bf16 v[120:123], v[80:83], v[56:59], v[120:123]
    ds_read_b64_tr_b16 v[52:53], v253 offset:57344
    v_mfma_f32_16x16x32_bf16 v[124:127], v[80:83], v[60:63], v[124:127]
    ds_read_b64_tr_b16 v[54:55], v253 offset:57856
    v_mfma_f32_16x16x32_bf16 v[128:131], v[80:83], v[64:67], v[128:131]
    v_mfma_f32_16x16x32_bf16 v[132:135], v[80:83], v[68:71], v[132:135]
    v_mfma_f32_16x16x32_bf16 v[136:139], v[84:87], v[56:59], v[136:139]
    s_mov_b64 exec, 3
    global_load_dwordx3 v[236:238], v239, s[26:27] sc1
    s_mov_b64 exec, -1
    v_mfma_f32_16x16x32_bf16 v[140:143], v[84:87], v[60:63], v[140:143]
    v_mfma_f32_16x16x32_bf16 v[144:147], v[84:87], v[64:67], v[144:147]
    v_mfma_f32_16x16x32_bf16 v[148:151], v[84:87], v[68:71], v[148:151]
    s_waitcnt lgkmcnt(9)
    v_mfma_f32_16x16x32_bf16 v[88:91], v[40:43], v[24:27], v[88:91]
    ds_read_b64_tr_b16 v[72:73], v252 offset:53248
    ds_read_b64_tr_b16 v[74:75], v252 offset:53760
    s_waitcnt lgkmcnt(10)
    v_mfma_f32_16x16x32_bf16 v[92:95], v[40:43], v[28:31], v[92:95]
    ds_read_b128 v[56:59], v249 offset:40960
    s_waitcnt lgkmcnt(10)
    v_mfma_f32_16x16x32_bf16 v[96:99], v[40:43], v[32:35], v[96:99]
    ds_read_b128 v[60:63], v249 offset:41984
    ds_read_b128 v[64:67], v249 offset:43008
    s_waitcnt lgkmcnt(11)
    v_mfma_f32_16x16x32_bf16 v[100:103], v[40:43], v[36:39], v[100:103]
    ds_read_b128 v[68:71], v249 offset:44032
    s_waitcnt lgkmcnt(10)
    v_mfma_f32_16x16x32_bf16 v[104:107], v[44:47], v[24:27], v[104:107]
    ds_read_b64_tr_b16 v[76:77], v253 offset:53248
    ds_read_b64_tr_b16 v[78:79], v253 offset:53760
    v_mfma_f32_16x16x32_bf16 v[108:111], v[44:47], v[28:31], v[108:111]
    ds_read_b64_tr_b16 v[80:81], v252 offset:61440
    v_mfma_f32_16x16x32_bf16 v[112:115], v[44:47], v[32:35], v[112:115]
    ds_read_b64_tr_b16 v[82:83], v252 offset:61952
    ds_read_b64_tr_b16 v[84:85], v253 offset:61440
    v_mfma_f32_16x16x32_bf16 v[116:119], v[44:47], v[36:39], v[116:119]
    ds_read_b64_tr_b16 v[86:87], v253 offset:61952
    s_waitcnt lgkmcnt(14)
    v_mfma_f32_16x16x32_bf16 v[120:123], v[48:51], v[24:27], v[120:123]
    v_mfma_f32_16x16x32_bf16 v[124:127], v[48:51], v[28:31], v[124:127]
    v_mfma_f32_16x16x32_bf16 v[128:131], v[48:51], v[32:35], v[128:131]
    v_mfma_f32_16x16x32_bf16 v[132:135], v[48:51], v[36:39], v[132:135]
    s_waitcnt lgkmcnt(12)
    v_mfma_f32_16x16x32_bf16 v[136:139], v[52:55], v[24:27], v[136:139]
    v_mfma_f32_16x16x32_bf16 v[140:143], v[52:55], v[28:31], v[140:143]
    v_mfma_f32_16x16x32_bf16 v[144:147], v[52:55], v[32:35], v[144:147]
    v_mfma_f32_16x16x32_bf16 v[148:151], v[52:55], v[36:39], v[148:151]
    s_waitcnt vmcnt(5) lgkmcnt(0)
    s_barrier
    v_mfma_f32_16x16x32_bf16 v[88:91], v[72:75], v[56:59], v[88:91]
    ds_read_b64_tr_b16 v[40:41], v250 offset:49152
    ds_read_b64_tr_b16 v[42:43], v250 offset:49664
    v_mfma_f32_16x16x32_bf16 v[92:95], v[72:75], v[60:63], v[92:95]
    ds_read_b128 v[24:27], v248 offset:32768
    v_mfma_f32_16x16x32_bf16 v[96:99], v[72:75], v[64:67], v[96:99]
    ds_read_b128 v[28:31], v248 offset:33792
    v_mfma_f32_16x16x32_bf16 v[100:103], v[72:75], v[68:71], v[100:103]
    ds_read_b128 v[32:35], v248 offset:34816
    v_mfma_f32_16x16x32_bf16 v[104:107], v[76:79], v[56:59], v[104:107]
    ds_read_b128 v[36:39], v248 offset:35840
    v_mfma_f32_16x16x32_bf16 v[108:111], v[76:79], v[60:63], v[108:111]
    ds_read_b64_tr_b16 v[44:45], v251 offset:49152
    ds_read_b64_tr_b16 v[46:47], v251 offset:49664
    v_mfma_f32_16x16x32_bf16 v[112:115], v[76:79], v[64:67], v[112:115]
    ds_read_b64_tr_b16 v[48:49], v250 offset:57344
    v_mfma_f32_16x16x32_bf16 v[116:119], v[76:79], v[68:71], v[116:119]
    ds_read_b64_tr_b16 v[50:51], v250 offset:57856
    v_mfma_f32_16x16x32_bf16 v[120:123], v[80:83], v[56:59], v[120:123]
    ds_read_b64_tr_b16 v[52:53], v251 offset:57344
    v_mfma_f32_16x16x32_bf16 v[124:127], v[80:83], v[60:63], v[124:127]
    ds_read_b64_tr_b16 v[54:55], v251 offset:57856
    v_mfma_f32_16x16x32_bf16 v[128:131], v[80:83], v[64:67], v[128:131]
    v_mfma_f32_16x16x32_bf16 v[132:135], v[80:83], v[68:71], v[132:135]
    v_mfma_f32_16x16x32_bf16 v[136:139], v[84:87], v[56:59], v[136:139]
    v_mfma_f32_16x16x32_bf16 v[140:143], v[84:87], v[60:63], v[140:143]
    v_mfma_f32_16x16x32_bf16 v[144:147], v[84:87], v[64:67], v[144:147]
    v_mfma_f32_16x16x32_bf16 v[148:151], v[84:87], v[68:71], v[148:151]
    s_waitcnt lgkmcnt(9)
    v_mfma_f32_16x16x32_bf16 v[88:91], v[40:43], v[24:27], v[88:91]
    ds_read_b64_tr_b16 v[72:73], v250 offset:53248
    ds_read_b64_tr_b16 v[74:75], v250 offset:53760
    s_waitcnt lgkmcnt(10)
    v_mfma_f32_16x16x32_bf16 v[92:95], v[40:43], v[28:31], v[92:95]
    ds_read_b128 v[56:59], v248 offset:40960
    s_waitcnt lgkmcnt(10)
    v_mfma_f32_16x16x32_bf16 v[96:99], v[40:43], v[32:35], v[96:99]
    ds_read_b128 v[60:63], v248 offset:41984
    ds_read_b128 v[64:67], v248 offset:43008
    s_waitcnt lgkmcnt(11)
    v_mfma_f32_16x16x32_bf16 v[100:103], v[40:43], v[36:39], v[100:103]
    ds_read_b128 v[68:71], v248 offset:44032
    s_waitcnt lgkmcnt(10)
    v_mfma_f32_16x16x32_bf16 v[104:107], v[44:47], v[24:27], v[104:107]
    ds_read_b64_tr_b16 v[76:77], v251 offset:53248
    ds_read_b64_tr_b16 v[78:79], v251 offset:53760
    v_mfma_f32_16x16x32_bf16 v[108:111], v[44:47], v[28:31], v[108:111]
    ds_read_b64_tr_b16 v[80:81], v250 offset:61440
    v_mfma_f32_16x16x32_bf16 v[112:115], v[44:47], v[32:35], v[112:115]
    ds_read_b64_tr_b16 v[82:83], v250 offset:61952
    ds_read_b64_tr_b16 v[84:85], v251 offset:61440
    v_mfma_f32_16x16x32_bf16 v[116:119], v[44:47], v[36:39], v[116:119]
    ds_read_b64_tr_b16 v[86:87], v251 offset:61952
    s_waitcnt lgkmcnt(14)
    v_mfma_f32_16x16x32_bf16 v[120:123], v[48:51], v[24:27], v[120:123]
    v_mfma_f32_16x16x32_bf16 v[124:127], v[48:51], v[28:31], v[124:127]
    v_mfma_f32_16x16x32_bf16 v[128:131], v[48:51], v[32:35], v[128:131]
    v_mfma_f32_16x16x32_bf16 v[132:135], v[48:51], v[36:39], v[132:135]
    s_waitcnt lgkmcnt(12)
    v_mfma_f32_16x16x32_bf16 v[136:139], v[52:55], v[24:27], v[136:139]
    v_mfma_f32_16x16x32_bf16 v[140:143], v[52:55], v[28:31], v[140:143]
    v_mfma_f32_16x16x32_bf16 v[144:147], v[52:55], v[32:35], v[144:147]
    v_mfma_f32_16x16x32_bf16 v[148:151], v[52:55], v[36:39], v[148:151]
    s_waitcnt vmcnt(0) lgkmcnt(0)
    s_barrier
    v_mfma_f32_16x16x32_bf16 v[88:91], v[72:75], v[56:59], v[88:91]
    ds_read_b64_tr_b16 v[40:41], v252 offset:16384
    ds_read_b64_tr_b16 v[42:43], v252 offset:16896
    v_readlane_b32 s90, v238, 0
    v_readlane_b32 s91, v238, 1
    v_mfma_f32_16x16x32_bf16 v[92:95], v[72:75], v[60:63], v[92:95]
    ds_read_b128 v[24:27], v249 offset:0
    s_nop 1
    s_sub_u32 s90, s91, s90
    v_mfma_f32_16x16x32_bf16 v[96:99], v[72:75], v[64:67], v[96:99]
    ds_read_b128 v[28:31], v249 offset:1024
    s_abs_i32 s91, s90
    v_mfma_f32_16x16x32_bf16 v[100:103], v[72:75], v[68:71], v[100:103]
    ds_read_b128 v[32:35], v249 offset:2048
    s_min_u32 s91, s91, 0x1000
    s_add_u32 s91, s91, 35
    v_mfma_f32_16x16x32_bf16 v[104:107], v[76:79], v[56:59], v[104:107]
    ds_read_b128 v[36:39], v249 offset:3072
    s_mul_i32 s91, s91, 937
    s_lshr_b32 s91, s91, 16
    v_mfma_f32_16x16x32_bf16 v[108:111], v[76:79], v[60:63], v[108:111]
    ds_read_b64_tr_b16 v[44:45], v253 offset:16384
    ds_read_b64_tr_b16 v[46:47], v253 offset:16896
    s_min_u32 s91, s91, 4
    v_mfma_f32_16x16x32_bf16 v[112:115], v[76:79], v[64:67], v[112:115]
    ds_read_b64_tr_b16 v[48:49], v252 offset:24576
    s_sub_u32 s92, 0, s91
    s_cmp_lt_i32 s90, 0
    v_mfma_f32_16x16x32_bf16 v[116:119], v[76:79], v[68:71], v[116:119]
    ds_read_b64_tr_b16 v[50:51], v252 offset:25088
    s_cselect_b32 s91, s92, s91
    v_mfma_f32_16x16x32_bf16 v[120:123], v[80:83], v[56:59], v[120:123]
    ds_read_b64_tr_b16 v[52:53], v253 offset:24576
    s_add_u32 s34, s91, 16
    s_and_b32 s91, s91, 3
    v_mfma_f32_16x16x32_bf16 v[124:127], v[80:83], v[60:63], v[124:127]
    ds_read_b64_tr_b16 v[54:55], v253 offset:25088
    s_mov_b32 s46, 0x9a69a69a
    s_mov_b32 s47, 0x269a69a6
    v_mfma_f32_16x16x32_bf16 v[128:131], v[80:83], v[64:67], v[128:131]
    s_cmp_eq_u32 s91, 1
    v_mfma_f32_16x16x32_bf16 v[132:135], v[80:83], v[68:71], v[132:135]
    s_cselect_b32 s46, 0xd34d34e6, s46
    s_cselect_b32 s47, 0x34d34d34, s47
    v_mfma_f32_16x16x32_bf16 v[136:139], v[84:87], v[56:59], v[136:139]
    s_cmp_eq_u32 s91, 2
    s_cselect_b32 s46, 0x9a7334e6, s46
    v_mfma_f32_16x16x32_bf16 v[140:143], v[84:87], v[60:63], v[140:143]
    s_cselect_b32 s47, 0x269a69a6, s47
    v_mfma_f32_16x16x32_bf16 v[144:147], v[84:87], v[64:67], v[144:147]
    s_cmp_eq_u32 s91, 3
    s_cselect_b32 s46, 0x9a7334e6, s46
    v_mfma_f32_16x16x32_bf16 v[148:151], v[84:87], v[68:71], v[148:151]
    s_cselect_b32 s47, 0x34d34d39, s47
    s_waitcnt lgkmcnt(9)
    v_mfma_f32_16x16x32_bf16 v[88:91], v[40:43], v[24:27], v[88:91]
    ds_read_b64_tr_b16 v[72:73], v252 offset:20480
    ds_read_b64_tr_b16 v[74:75], v252 offset:20992
    s_waitcnt lgkmcnt(10)
    v_mfma_f32_16x16x32_bf16 v[92:95], v[40:43], v[28:31], v[92:95]
    ds_read_b128 v[56:59], v249 offset:8192
    s_waitcnt lgkmcnt(10)
    v_mfma_f32_16x16x32_bf16 v[96:99], v[40:43], v[32:35], v[96:99]
    ds_read_b128 v[60:63], v249 offset:9216
    ds_read_b128 v[64:67], v249 offset:10240
    s_waitcnt lgkmcnt(11)
    v_mfma_f32_16x16x32_bf16 v[100:103], v[40:43], v[36:39], v[100:103]
    ds_read_b128 v[68:71], v249 offset:11264
    s_waitcnt lgkmcnt(10)
    v_mfma_f32_16x16x32_bf16 v[104:107], v[44:47], v[24:27], v[104:107]
    ds_read_b64_tr_b16 v[76:77], v253 offset:20480
    ds_read_b64_tr_b16 v[78:79], v253 offset:20992
    v_mfma_f32_16x16x32_bf16 v[108:111], v[44:47], v[28:31], v[108:111]
    ds_read_b64_tr_b16 v[80:81], v252 offset:28672
    v_mfma_f32_16x16x32_bf16 v[112:115], v[44:47], v[32:35], v[112:115]
    ds_read_b64_tr_b16 v[82:83], v252 offset:29184
    ds_read_b64_tr_b16 v[84:85], v253 offset:28672
    v_mfma_f32_16x16x32_bf16 v[116:119], v[44:47], v[36:39], v[116:119]
    ds_read_b64_tr_b16 v[86:87], v253 offset:29184
    s_waitcnt lgkmcnt(14)
    v_mfma_f32_16x16x32_bf16 v[120:123], v[48:51], v[24:27], v[120:123]
    v_mfma_f32_16x16x32_bf16 v[124:127], v[48:51], v[28:31], v[124:127]
    s_lshl_b32 s48, s46, 15
    s_and_b32 s48, s48, 0x38000
    v_mfma_f32_16x16x32_bf16 v[128:131], v[48:51], v[32:35], v[128:131]
    s_lshr_b64 s[46:47], s[46:47], 3
    v_mfma_f32_16x16x32_bf16 v[132:135], v[48:51], v[36:39], v[132:135]
    v_xor_b32 v252, s48, v252
    s_waitcnt lgkmcnt(12)
    v_mfma_f32_16x16x32_bf16 v[136:139], v[52:55], v[24:27], v[136:139]
    v_xor_b32 v249, s48, v249
    v_mfma_f32_16x16x32_bf16 v[140:143], v[52:55], v[28:31], v[140:143]
    v_xor_b32 v253, s48, v253
    v_mfma_f32_16x16x32_bf16 v[144:147], v[52:55], v[32:35], v[144:147]
    s_sub_u32 s34, s34, 1
    v_mfma_f32_16x16x32_bf16 v[148:151], v[52:55], v[36:39], v[148:151]
.p2align 6
L_dl:
    s_waitcnt lgkmcnt(0)
    s_barrier
    v_mfma_f32_16x16x32_bf16 v[88:91], v[72:75], v[56:59], v[88:91]
    ds_read_b64_tr_b16 v[40:41], v252 offset:16384
    ds_read_b64_tr_b16 v[42:43], v252 offset:16896
    v_mfma_f32_16x16x32_bf16 v[92:95], v[72:75], v[60:63], v[92:95]
    ds_read_b128 v[24:27], v249 offset:0
    v_mfma_f32_16x16x32_bf16 v[96:99], v[72:75], v[64:67], v[96:99]
    ds_read_b128 v[28:31], v249 offset:1024
    v_mfma_f32_16x16x32_bf16 v[100:103], v[72:75], v[68:71], v[100:103]
    ds_read_b128 v[32:35], v249 offset:2048
    v_mfma_f32_16x16x32_bf16 v[104:107], v[76:79], v[56:59], v[104:107]
    ds_read_b128 v[36:39], v249 offset:3072
    v_mfma_f32_16x16x32_bf16 v[108:111], v[76:79], v[60:63], v[108:111]
    ds_read_b64_tr_b16 v[44:45], v253 offset:16384
    ds_read_b64_tr_b16 v[46:47], v253 offset:16896
    v_mfma_f32_16x16x32_bf16 v[112:115], v[76:79], v[64:67], v[112:115]
    ds_read_b64_tr_b16 v[48:49], v252 offset:24576
    v_mfma_f32_16x16x32_bf16 v[116:119], v[76:79], v[68:71], v[116:119]
    ds_read_b64_tr_b16 v[50:51], v252 offset:25088
    v_mfma_f32_16x16x32_bf16 v[120:123], v[80:83], v[56:59], v[120:123]
    ds_read_b64_tr_b16 v[52:53], v253 offset:24576
    v_mfma_f32_16x16x32_bf16 v[124:127], v[80:83], v[60:63], v[124:127]
    ds_read_b64_tr_b16 v[54:55], v253 offset:25088
    v_mfma_f32_16x16x32_bf16 v[128:131], v[80:83], v[64:67], v[128:131]
    v_mfma_f32_16x16x32_bf16 v[132:135], v[80:83], v[68:71], v[132:135]
    v_mfma_f32_16x16x32_bf16 v[136:139], v[84:87], v[56:59], v[136:139]
    v_mfma_f32_16x16x32_bf16 v[140:143], v[84:87], v[60:63], v[140:143]
    v_mfma_f32_16x16x32_bf16 v[144:147], v[84:87], v[64:67], v[144:147]
    v_mfma_f32_16x16x32_bf16 v[148:151], v[84:87], v[68:71], v[148:151]
    s_waitcnt lgkmcnt(9)
    v_mfma_f32_16x16x32_bf16 v[88:91], v[40:43], v[24:27], v[88:91]
    ds_read_b64_tr_b16 v[72:73], v252 offset:20480
    ds_read_b64_tr_b16 v[74:75], v252 offset:20992
    s_waitcnt lgkmcnt(10)
    v_mfma_f32_16x16x32_bf16 v[92:95], v[40:43], v[28:31], v[92:95]
    ds_read_b128 v[56:59], v249 offset:8192
    s_waitcnt lgkmcnt(10)
    v_mfma_f32_16x16x32_bf16 v[96:99], v[40:43], v[32:35], v[96:99]
    ds_read_b128 v[60:63], v249 offset:9216
    ds_read_b128 v[64:67], v249 offset:10240
    s_waitcnt lgkmcnt(11)
    v_mfma_f32_16x16x32_bf16 v[100:103], v[40:43], v[36:39], v[100:103]
    ds_read_b128 v[68:71], v249 offset:11264
    s_waitcnt lgkmcnt(10)
    v_mfma_f32_16x16x32_bf16 v[104:107], v[44:47], v[24:27], v[104:107]
    ds_read_b64_tr_b16 v[76:77], v253 offset:20480
    ds_read_b64_tr_b16 v[78:79], v253 offset:20992
    v_mfma_f32_16x16x32_bf16 v[108:111], v[44:47], v[28:31], v[108:111]
    ds_read_b64_tr_b16 v[80:81], v252 offset:28672
    v_mfma_f32_16x16x32_bf16 v[112:115], v[44:47], v[32:35], v[112:115]
    ds_read_b64_tr_b16 v[82:83], v252 offset:29184
    ds_read_b64_tr_b16 v[84:85], v253 offset:28672
    v_mfma_f32_16x16x32_bf16 v[116:119], v[44:47], v[36:39], v[116:119]
    ds_read_b64_tr_b16 v[86:87], v253 offset:29184
    s_waitcnt lgkmcnt(14)
    v_mfma_f32_16x16x32_bf16 v[120:123], v[48:51], v[24:27], v[120:123]
    v_mfma_f32_16x16x32_bf16 v[124:127], v[48:51], v[28:31], v[124:127]
    s_lshl_b32 s48, s46, 15
    s_and_b32 s48, s48, 0x38000
    v_mfma_f32_16x16x32_bf16 v[128:131], v[48:51], v[32:35], v[128:131]
    s_lshr_b64 s[46:47], s[46:47], 3
    v_mfma_f32_16x16x32_bf16 v[132:135], v[48:51], v[36:39], v[132:135]
    v_xor_b32 v252, s48, v252
    s_waitcnt lgkmcnt(12)
    v_mfma_f32_16x16x32_bf16 v[136:139], v[52:55], v[24:27], v[136:139]
    v_xor_b32 v249, s48, v249
    v_mfma_f32_16x16x32_bf16 v[140:143], v[52:55], v[28:31], v[140:143]
    v_xor_b32 v253, s48, v253
    v_mfma_f32_16x16x32_bf16 v[144:147], v[52:55], v[32:35], v[144:147]
    s_sub_u32 s34, s34, 1
    v_mfma_f32_16x16x32_bf16 v[148:151], v[52:55], v[36:39], v[148:151]
    s_cbranch_scc0 L_dl
    s_waitcnt lgkmcnt(0)
    s_barrier
    v_mfma_f32_16x16x32_bf16 v[88:91], v[72:75], v[56:59], v[88:91]
    v_mfma_f32_16x16x32_bf16 v[92:95], v[72:75], v[60:63], v[92:95]
    v_mfma_f32_16x16x32_bf16 v[96:99], v[72:75], v[64:67], v[96:99]
    v_mfma_f32_16x16x32_bf16 v[100:103], v[72:75], v[68:71], v[100:103]
    v_mfma_f32_16x16x32_bf16 v[104:107], v[76:79], v[56:59], v[104:107]
    v_mfma_f32_16x16x32_bf16 v[108:111], v[76:79], v[60:63], v[108:111]
    v_mfma_f32_16x16x32_bf16 v[112:115], v[76:79], v[64:67], v[112:115]
    v_mfma_f32_16x16x32_bf16 v[116:119], v[76:79], v[68:71], v[116:119]
    v_mfma_f32_16x16x32_bf16 v[120:123], v[80:83], v[56:59], v[120:123]
    v_mfma_f32_16x16x32_bf16 v[124:127], v[80:83], v[60:63], v[124:127]
    v_mfma_f32_16x16x32_bf16 v[128:131], v[80:83], v[64:67], v[128:131]
    v_mfma_f32_16x16x32_bf16 v[132:135], v[80:83], v[68:71], v[132:135]
    v_mfma_f32_16x16x32_bf16 v[136:139], v[84:87], v[56:59], v[136:139]
    v_mfma_f32_16x16x32_bf16 v[140:143], v[84:87], v[60:63], v[140:143]
    v_mfma_f32_16x16x32_bf16 v[144:147], v[84:87], v[64:67], v[144:147]
    v_mfma_f32_16x16x32_bf16 v[148:151], v[84:87], v[68:71], v[148:151]
    s_setprio 0
    s_lshl4_add_u32 s91, s28, s29
    s_xor_b32 s91, s91, 136
    s_lshl_b32 s91, s91, 7
    s_add_u32 s91, s91, 0x1ea0000
    v_mov_b32 v13, s91
    s_nop 7
    v_max_f32_e64 v8, |v120|, |v121|
    v_max_f32_e64 v9, |v128|, |v129|
    v_max_f32_e64 v10, |v136|, |v137|
    v_max_f32_e64 v11, |v144|, |v145|
    v_max3_f32 v8, |v122|, |v123|, v8
    v_max3_f32 v9, |v130|, |v131|, v9
    v_max3_f32 v10, |v138|, |v139|, v10
    v_max3_f32 v11, |v146|, |v147|, v11
    v_max3_f32 v8, |v124|, |v125|, v8
    v_max3_f32 v9, |v132|, |v133|, v9
    v_max3_f32 v10, |v140|, |v141|, v10
    v_max3_f32 v11, |v148|, |v149|, v11
    v_max3_f32 v8, |v126|, |v127|, v8
    v_max3_f32 v9, |v134|, |v135|, v9
    v_max3_f32 v10, |v142|, |v143|, v10
    v_max3_f32 v11, |v150|, |v151|, v11
    v_max3_f32 v8, v8, v9, v10
    v_max_f32 v8, v8, v11
    v_min_f32 v8, 0x7f7fffff, v8
    v_frexp_exp_i32_f32 v8, v8
    v_max_i32 v8, -100, v8
    v_sub_u32 v9, 15, v8
    v_add_u32 v8, -15, v8
    v_ldexp_f32 v9, 1.0, v9
    v_ldexp_f32 v8, 1.0, v8
    buffer_store_dword v8, v6, s[68:71], s37 offen sc1
    v_fma_mixlo_f16 v32, v120, v9, 0
    v_fma_mixlo_f16 v33, v122, v9, 0
    v_fma_mixlo_f16 v34, v124, v9, 0
    v_fma_mixlo_f16 v35, v126, v9, 0
    v_fma_mixhi_f16 v32, v121, v9, 0
    v_fma_mixhi_f16 v33, v123, v9, 0
    v_fma_mixhi_f16 v34, v125, v9, 0
    v_fma_mixhi_f16 v35, v127, v9, 0
    s_nop 0
    buffer_store_dwordx4 v[32:35], v4, s[68:71], s36 offen offset:0 sc1
    v_fma_mixlo_f16 v36, v128, v9, 0
    v_fma_mixlo_f16 v37, v130, v9, 0
    v_fma_mixlo_f16 v38, v132, v9, 0
    v_fma_mixlo_f16 v39, v134, v9, 0
    v_fma_mixhi_f16 v36, v129, v9, 0
    v_fma_mixhi_f16 v37, v131, v9, 0
    v_fma_mixhi_f16 v38, v133, v9, 0
    v_fma_mixhi_f16 v39, v135, v9, 0
    s_nop 0
    buffer_store_dwordx4 v[36:39], v4, s[68:71], s36 offen offset:1024 sc1
    s_barrier
    v_fma_mixlo_f16 v40, v136, v9, 0
    v_fma_mixlo_f16 v41, v138, v9, 0
    v_fma_mixlo_f16 v42, v140, v9, 0
    v_fma_mixlo_f16 v43, v142, v9, 0
    v_fma_mixhi_f16 v40, v137, v9, 0
    v_fma_mixhi_f16 v41, v139, v9, 0
    v_fma_mixhi_f16 v42, v141, v9, 0
    v_fma_mixhi_f16 v43, v143, v9, 0
    s_nop 0
    buffer_store_dwordx4 v[40:43], v4, s[68:71], s36 offen offset:2048 sc1
    v_fma_mixlo_f16 v44, v144, v9, 0
    v_fma_mixlo_f16 v45, v146, v9, 0
    v_fma_mixlo_f16 v46, v148, v9, 0
    v_fma_mixlo_f16 v47, v150, v9, 0
    v_fma_mixhi_f16 v44, v145, v9, 0
    v_fma_mixhi_f16 v45, v147, v9, 0
    v_fma_mixhi_f16 v46, v149, v9, 0
    v_fma_mixhi_f16 v47, v151, v9, 0
    s_nop 0
    buffer_store_dwordx4 v[44:47], v4, s[68:71], s36 offen offset:3072 sc1
    s_barrier
    s_barrier
    s_waitcnt vmcnt(0)
    s_barrier
    s_cmp_lg_u32 s4, 0
    s_cbranch_scc1 L_fP
    s_lshl_b32 s91, s28, 4
    s_add_u32 s91, s91, s29
    s_lshl_b32 s91, s91, 7
    s_add_u32 s91, s91, 0x1ea0000
    v_mov_b32 v16, s91
    v_mov_b32 v18, s100
    v_mov_b32 v19, s101
    s_mov_b64 exec, 1
    global_store_dwordx2 v16, v[18:19], s[26:27] sc1
    s_mov_b64 exec, -1
L_fP:
    s_barrier
    s_mov_b64 exec, 1
    global_load_dwordx2 v[14:15], v13, s[26:27] sc1
    s_mov_b64 exec, -1
    s_barrier
    s_barrier
    s_waitcnt vmcnt(0)
    s_mov_b64 exec, 1
    s_movk_i32 s98, 0x4000
L_pP_chk:
    v_cmp_ne_u64 vcc, s[100:101], v[14:15]
    s_nop 1
    s_cmp_eq_u64 vcc, 0
    s_cbranch_scc1 L_pP_ok
    s_sub_u32 s98, s98, 1
    s_cbranch_scc1 L_pP_ok
    s_sleep 1
    global_load_dwordx2 v[14:15], v13, s[26:27] sc1
    s_waitcnt vmcnt(0)
    s_branch L_pP_chk
L_pP_ok:
    s_mov_b64 exec, -1
    buffer_load_dword v168, v6, s[68:71], s39 offen sc1
    buffer_load_dwordx4 v[152:155], v4, s[68:71], s38 offen offset:0 sc1
    buffer_load_dwordx4 v[156:159], v4, s[68:71], s38 offen offset:1024 sc1
    buffer_load_dwordx4 v[160:163], v4, s[68:71], s38 offen offset:2048 sc1
    buffer_load_dwordx4 v[164:167], v4, s[68:71], s38 offen offset:3072 sc1
    s_barrier
    s_barrier
    s_waitcnt vmcnt(3)
    v_fma_mix_f32 v88, v152, v168, v88 op_sel:[0,0,0] op_sel_hi:[1,0,0]
    v_fma_mix_f32 v89, v152, v168, v89 op_sel:[1,0,0] op_sel_hi:[1,0,0]
    v_fma_mix_f32 v90, v153, v168, v90 op_sel:[0,0,0] op_sel_hi:[1,0,0]
    v_fma_mix_f32 v91, v153, v168, v91 op_sel:[1,0,0] op_sel_hi:[1,0,0]
    v_cvt_pk_bf16_f32 v28, v88, v89
    v_cvt_pk_bf16_f32 v29, v90, v91
    v_lshlrev_b32 v88, 16, v28
    v_and_b32 v89, 0xffff0000, v28
    v_lshlrev_b32 v90, 16, v29
    v_and_b32 v91, 0xffff0000, v29
L_pad5:
    s_cbranch_execz L_vret3
    v_mul_f32 v24, 0xbfb8aa3b, v88
    v_mul_f32 v25, 0xbfb8aa3b, v89
    v_mul_f32 v26, 0xbfb8aa3b, v90
    v_mul_f32 v27, 0xbfb8aa3b, v91
    v_exp_f32 v24, v24
    v_exp_f32 v25, v25
    v_exp_f32 v26, v26
    v_exp_f32 v27, v27
    s_nop 0
    v_add_f32 v24, 1.0, v24
    v_add_f32 v25, 1.0, v25
    v_add_f32 v26, 1.0, v26
    v_add_f32 v27, 1.0, v27
    v_rcp_f32 v24, v24
    v_rcp_f32 v25, v25
    v_rcp_f32 v26, v26
    v_rcp_f32 v27, v27
    s_nop 0
    v_mul_f32 v24, v24, v88
    v_mul_f32 v25, v25, v89
    v_mul_f32 v26, v26, v90
    v_mul_f32 v27, v27, v91
    v_cvt_pk_bf16_f32 v88, v24, v25
    v_cvt_pk_bf16_f32 v89, v26, v27
    ds_write_b64 v5, v[88:89] offset:0
    v_fma_mix_f32 v92, v154, v168, v92 op_sel:[0,0,0] op_sel_hi:[1,0,0]
    v_fma_mix_f32 v93, v154, v168, v93 op_sel:[1,0,0] op_sel_hi:[1,0,0]
    v_fma_mix_f32 v94, v155, v168, v94 op_sel:[0,0,0] op_sel_hi:[1,0,0]
    v_fma_mix_f32 v95, v155, v168, v95 op_sel:[1,0,0] op_sel_hi:[1,0,0]
    v_cvt_pk_bf16_f32 v28, v92, v93
    v_cvt_pk_bf16_f32 v29, v94, v95
    v_lshlrev_b32 v92, 16, v28
    v_and_b32 v93, 0xffff0000, v28
    v_lshlrev_b32 v94, 16, v29
    v_and_b32 v95, 0xffff0000, v29
    v_mul_f32 v24, 0xbfb8aa3b, v92
    v_mul_f32 v25, 0xbfb8aa3b, v93
    v_mul_f32 v26, 0xbfb8aa3b, v94
    v_mul_f32 v27, 0xbfb8aa3b, v95
    v_exp_f32 v24, v24
    v_exp_f32 v25, v25
    v_exp_f32 v26, v26
    v_exp_f32 v27, v27
    s_nop 0
    v_add_f32 v24, 1.0, v24
    v_add_f32 v25, 1.0, v25
    s_barrier
    v_add_f32 v26, 1.0, v26
    v_add_f32 v27, 1.0, v27
    v_rcp_f32 v24, v24
    v_rcp_f32 v25, v25
    v_rcp_f32 v26, v26
    v_rcp_f32 v27, v27
    s_nop 0
    v_mul_f32 v24, v24, v92
    v_mul_f32 v25, v25, v93
    v_mul_f32 v26, v26, v94
    v_mul_f32 v27, v27, v95
    v_cvt_pk_bf16_f32 v92, v24, v25
    v_cvt_pk_bf16_f32 v93, v26, v27
    ds_write_b64 v5, v[92:93] offset:512
    s_waitcnt vmcnt(2)
    v_fma_mix_f32 v96, v156, v168, v96 op_sel:[0,0,0] op_sel_hi:[1,0,0]
    v_fma_mix_f32 v97, v156, v168, v97 op_sel:[1,0,0] op_sel_hi:[1,0,0]
    v_fma_mix_f32 v98, v157, v168, v98 op_sel:[0,0,0] op_sel_hi:[1,0,0]
    v_fma_mix_f32 v99, v157, v168, v99 op_sel:[1,0,0] op_sel_hi:[1,0,0]
    v_cvt_pk_bf16_f32 v28, v96, v97
    v_cvt_pk_bf16_f32 v29, v98, v99
    v_lshlrev_b32 v96, 16, v28
    v_and_b32 v97, 0xffff0000, v28
    v_lshlrev_b32 v98, 16, v29
    v_and_b32 v99, 0xffff0000, v29
    v_mul_f32 v24, 0xbfb8aa3b, v96
    v_mul_f32 v25, 0xbfb8aa3b, v97
    v_mul_f32 v26, 0xbfb8aa3b, v98
    v_mul_f32 v27, 0xbfb8aa3b, v99
    v_exp_f32 v24, v24
    v_exp_f32 v25, v25
    v_exp_f32 v26, v26
    v_exp_f32 v27, v27
    s_nop 0
    v_add_f32 v24, 1.0, v24
    v_add_f32 v25, 1.0, v25
    v_add_f32 v26, 1.0, v26
    v_add_f32 v27, 1.0, v27
    v_rcp_f32 v24, v24
    v_rcp_f32 v25, v25
    v_rcp_f32 v26, v26
    v_rcp_f32 v27, v27
    s_nop 0
    v_mul_f32 v24, v24, v96
    v_mul_f32 v25, v25, v97
    v_mul_f32 v26, v26, v98
    v_mul_f32 v27, v27, v99
    v_cvt_pk_bf16_f32 v96, v24, v25
    v_cvt_pk_bf16_f32 v97, v26, v27
    ds_write_b64 v5, v[96:97] offset:1024
    s_barrier
    v_fma_mix_f32 v100, v158, v168, v100 op_sel:[0,0,0] op_sel_hi:[1,0,0]
    v_fma_mix_f32 v101, v158, v168, v101 op_sel:[1,0,0] op_sel_hi:[1,0,0]
    v_fma_mix_f32 v102, v159, v168, v102 op_sel:[0,0,0] op_sel_hi:[1,0,0]
    v_fma_mix_f32 v103, v159, v168, v103 op_sel:[1,0,0] op_sel_hi:[1,0,0]
    v_cvt_pk_bf16_f32 v28, v100, v101
    v_cvt_pk_bf16_f32 v29, v102, v103
    v_lshlrev_b32 v100, 16, v28
    v_and_b32 v101, 0xffff0000, v28
    v_lshlrev_b32 v102, 16, v29
    v_and_b32 v103, 0xffff0000, v29
    v_mul_f32 v24, 0xbfb8aa3b, v100
    v_mul_f32 v25, 0xbfb8aa3b, v101
    v_mul_f32 v26, 0xbfb8aa3b, v102
    v_mul_f32 v27, 0xbfb8aa3b, v103
    v_exp_f32 v24, v24
    v_exp_f32 v25, v25
    v_exp_f32 v26, v26
    v_exp_f32 v27, v27
    s_nop 0
    v_add_f32 v24, 1.0, v24
    v_add_f32 v25, 1.0, v25
    v_add_f32 v26, 1.0, v26
    v_add_f32 v27, 1.0, v27
    v_rcp_f32 v24, v24
    v_rcp_f32 v25, v25
    v_rcp_f32 v26, v26
    v_rcp_f32 v27, v27
    s_nop 0
    v_mul_f32 v24, v24, v100
    v_mul_f32 v25, v25, v101
    v_mul_f32 v26, v26, v102
    v_mul_f32 v27, v27, v103
    v_cvt_pk_bf16_f32 v100, v24, v25
    v_cvt_pk_bf16_f32 v101, v26, v27
    ds_write_b64 v5, v[100:101] offset:1536
    s_waitcnt vmcnt(1)
    v_fma_mix_f32 v104, v160, v168, v104 op_sel:[0,0,0] op_sel_hi:[1,0,0]
    v_fma_mix_f32 v105, v160, v168, v105 op_sel:[1,0,0] op_sel_hi:[1,0,0]
    v_fma_mix_f32 v106, v161, v168, v106 op_sel:[0,0,0] op_sel_hi:[1,0,0]
    v_fma_mix_f32 v107, v161, v168, v107 op_sel:[1,0,0] op_sel_hi:[1,0,0]
    v_cvt_pk_bf16_f32 v28, v104, v105
    v_cvt_pk_bf16_f32 v29, v106, v107
    v_lshlrev_b32 v104, 16, v28
    v_and_b32 v105, 0xffff0000, v28
    v_lshlrev_b32 v106, 16, v29
    v_and_b32 v107, 0xffff0000, v29
    v_mul_f32 v24, 0xbfb8aa3b, v104
    v_mul_f32 v25, 0xbfb8aa3b, v105
    v_mul_f32 v26, 0xbfb8aa3b, v106
    v_mul_f32 v27, 0xbfb8aa3b, v107
    v_exp_f32 v24, v24
    v_exp_f32 v25, v25
    v_exp_f32 v26, v26
    v_exp_f32 v27, v27
    s_nop 0
    v_add_f32 v24, 1.0, v24
    v_add_f32 v25, 1.0, v25
    s_barrier
    v_add_f32 v26, 1.0, v26
    v_add_f32 v27, 1.0, v27
    v_rcp_f32 v24, v24
    v_rcp_f32 v25, v25
    v_rcp_f32 v26, v26
    v_rcp_f32 v27, v27
    s_nop 0
    v_mul_f32 v24, v24, v104
    v_mul_f32 v25, v25, v105
    v_mul_f32 v26, v26, v106
    v_mul_f32 v27, v27, v107
    v_cvt_pk_bf16_f32 v104, v24, v25
    v_cvt_pk_bf16_f32 v105, v26, v27
    ds_write_b64 v5, v[104:105] offset:2048
    v_fma_mix_f32 v108, v162, v168, v108 op_sel:[0,0,0] op_sel_hi:[1,0,0]
    v_fma_mix_f32 v109, v162, v168, v109 op_sel:[1,0,0] op_sel_hi:[1,0,0]
    v_fma_mix_f32 v110, v163, v168, v110 op_sel:[0,0,0] op_sel_hi:[1,0,0]
    v_fma_mix_f32 v111, v163, v168, v111 op_sel:[1,0,0] op_sel_hi:[1,0,0]
    v_cvt_pk_bf16_f32 v28, v108, v109
    v_cvt_pk_bf16_f32 v29, v110, v111
    v_lshlrev_b32 v108, 16, v28
    v_and_b32 v109, 0xffff0000, v28
    v_lshlrev_b32 v110, 16, v29
    v_and_b32 v111, 0xffff0000, v29
    v_mul_f32 v24, 0xbfb8aa3b, v108
    v_mul_f32 v25, 0xbfb8aa3b, v109
    v_mul_f32 v26, 0xbfb8aa3b, v110
    v_mul_f32 v27, 0xbfb8aa3b, v111
    v_exp_f32 v24, v24
    v_exp_f32 v25, v25
    v_exp_f32 v26, v26
    v_exp_f32 v27, v27
    s_nop 0
    v_add_f32 v24, 1.0, v24
    v_add_f32 v25, 1.0, v25
    v_add_f32 v26, 1.0, v26
    v_add_f32 v27, 1.0, v27
    v_rcp_f32 v24, v24
    v_rcp_f32 v25, v25
    v_rcp_f32 v26, v26
    v_rcp_f32 v27, v27
    s_nop 0
    v_mul_f32 v24, v24, v108
    v_mul_f32 v25, v25, v109
    v_mul_f32 v26, v26, v110
    v_mul_f32 v27, v27, v111
    v_cvt_pk_bf16_f32 v108, v24, v25
    v_cvt_pk_bf16_f32 v109, v26, v27
    ds_write_b64 v5, v[108:109] offset:2560
    s_barrier
    s_waitcnt vmcnt(0)
    v_fma_mix_f32 v112, v164, v168, v112 op_sel:[0,0,0] op_sel_hi:[1,0,0]
    v_fma_mix_f32 v113, v164, v168, v113 op_sel:[1,0,0] op_sel_hi:[1,0,0]
    v_fma_mix_f32 v114, v165, v168, v114 op_sel:[0,0,0] op_sel_hi:[1,0,0]
    v_fma_mix_f32 v115, v165, v168, v115 op_sel:[1,0,0] op_sel_hi:[1,0,0]
    v_cvt_pk_bf16_f32 v28, v112, v113
    v_cvt_pk_bf16_f32 v29, v114, v115
    v_lshlrev_b32 v112, 16, v28
    v_and_b32 v113, 0xffff0000, v28
    v_lshlrev_b32 v114, 16, v29
    v_and_b32 v115, 0xffff0000, v29
    v_mul_f32 v24, 0xbfb8aa3b, v112
    v_mul_f32 v25, 0xbfb8aa3b, v113
    v_mul_f32 v26, 0xbfb8aa3b, v114
    v_mul_f32 v27, 0xbfb8aa3b, v115
    v_exp_f32 v24, v24
    v_exp_f32 v25, v25
    v_exp_f32 v26, v26
    v_exp_f32 v27, v27
    s_nop 0
    v_add_f32 v24, 1.0, v24
    v_add_f32 v25, 1.0, v25
    v_add_f32 v26, 1.0, v26
    v_add_f32 v27, 1.0, v27
    v_rcp_f32 v24, v24
    v_rcp_f32 v25, v25
    v_rcp_f32 v26, v26
    v_rcp_f32 v27, v27
    s_nop 0
    v_mul_f32 v24, v24, v112
    v_mul_f32 v25, v25, v113
    v_mul_f32 v26, v26, v114
    v_mul_f32 v27, v27, v115
    v_cvt_pk_bf16_f32 v112, v24, v25
    v_cvt_pk_bf16_f32 v113, v26, v27
    ds_write_b64 v5, v[112:113] offset:3072
    v_fma_mix_f32 v116, v166, v168, v116 op_sel:[0,0,0] op_sel_hi:[1,0,0]
    v_fma_mix_f32 v117, v166, v168, v117 op_sel:[1,0,0] op_sel_hi:[1,0,0]
    v_fma_mix_f32 v118, v167, v168, v118 op_sel:[0,0,0] op_sel_hi:[1,0,0]
    v_fma_mix_f32 v119, v167, v168, v119 op_sel:[1,0,0] op_sel_hi:[1,0,0]
    v_cvt_pk_bf16_f32 v28, v116, v117
    v_cvt_pk_bf16_f32 v29, v118, v119
    v_lshlrev_b32 v116, 16, v28
    v_and_b32 v117, 0xffff0000, v28
    v_lshlrev_b32 v118, 16, v29
    v_and_b32 v119, 0xffff0000, v29
    v_mul_f32 v24, 0xbfb8aa3b, v116
    v_mul_f32 v25, 0xbfb8aa3b, v117
    v_mul_f32 v26, 0xbfb8aa3b, v118
    v_mul_f32 v27, 0xbfb8aa3b, v119
    v_exp_f32 v24, v24
    v_exp_f32 v25, v25
    v_exp_f32 v26, v26
    v_exp_f32 v27, v27
    s_nop 0
    v_add_f32 v24, 1.0, v24
    v_add_f32 v25, 1.0, v25
    s_barrier
    v_add_f32 v26, 1.0, v26
    v_add_f32 v27, 1.0, v27
    v_rcp_f32 v24, v24
    v_rcp_f32 v25, v25
    v_rcp_f32 v26, v26
    v_rcp_f32 v27, v27
    s_nop 0
    v_mul_f32 v24, v24, v116
    v_mul_f32 v25, v25, v117
    v_mul_f32 v26, v26, v118
    v_mul_f32 v27, v27, v119
    v_cvt_pk_bf16_f32 v116, v24, v25
    v_cvt_pk_bf16_f32 v117, v26, v27
    ds_write_b64 v5, v[116:117] offset:3584
    s_waitcnt lgkmcnt(0)
    s_barrier
    s_branch L_fin
L_teamB:
    s_setprio 3
    v_lshrrev_b32 v64, 4, v1
    v_bfe_u32 v65, v1, 2, 2
    v_and_b32 v66, 3, v1
    v_and_b32 v67, 15, v1
    v_lshrrev_b32 v68, 3, v1
    v_and_b32 v69, 7, v1
    s_lshl_b32 s85, s28, 7
    s_lshl_b32 s86, s4, 5
    s_add_u32 s86, s85, s86
    v_add_u32 v71, s86, v68
    v_xor_b32 v70, v69, v64
    v_lshlrev_b32 v70, 4, v70
    v_lshl_add_u32 v20, v71, 11, v70
    v_xor_b32 v21, 64, v20
    v_add_u32 v21, 16384, v21
    s_lshl_b32 s79, s4, 12
    s_mov_b32 s36, s8
    s_mov_b32 s37, s9
    s_mov_b32 s38, 0x400000
    s_mov_b32 s39, 0x20000
    s_and_b32 s72, s28, 3
    s_bitcmp1_b32 s28, 3
    s_cselect_b32 s91, 4, 0
    s_add_u32 s72, s72, s91
    s_mul_i32 s72, s72, 256
    s_sub_u32 s72, s72, 128
    s_add_u32 m0, s79, 116736
    s_add_u32 s72, s72, 128
    s_and_b32 s78, s72, 0x7ff
    buffer_load_dwordx4 v20, s[36:39], s78 offen lds
    s_add_u32 m0, s79, 117760
    s_nop 0
    buffer_load_dwordx4 v21, s[36:39], s78 offen lds
    s_add_u32 m0, s79, 118784
    s_add_u32 s78, s78, 32768
    buffer_load_dwordx4 v20, s[36:39], s78 offen lds
    s_add_u32 m0, s79, 119808
    s_nop 0
    buffer_load_dwordx4 v21, s[36:39], s78 offen lds
    s_setprio 0
    s_lshl_b32 s85, s4, 3
    s_and_b32 s86, s4, 1
    s_lshl_b32 s86, s86, 2
    v_and_b32 v70, 2, v68
    v_xor_b32 v70, v70, v69
    v_xor_b32 v70, s86, v70
    v_add_u32 v71, s85, v68
    v_mul_u32_u24 v71, 7168, v71
    v_lshl_add_u32 v22, v70, 4, v71
    v_lshrrev_b32 v71, 2, v1
    s_lshl_b32 s86, s86, 2
    v_add_u32 v71, s86, v71
    v_mul_u32_u24 v71, 7168, v71
    v_and_b32 v70, 2, v64
    v_xor_b32 v70, v70, v66
    v_lshl_add_u32 v9, v70, 4, v71
    s_mul_i32 s85, s29, 320
    s_and_b32 s86, s29, 1
    s_lshl_b32 s87, s86, 6
    s_add_u32 s87, s87, s85
    s_add_u32 s40, s16, s87
    s_addc_u32 s41, s17, 0
    s_sub_u32 s42, 7340032, s87
    s_mov_b32 s43, 0x20000
    s_add_u32 s44, s18, s87
    s_addc_u32 s45, s19, 0
    s_sub_u32 s46, 7340032, s87
    s_mov_b32 s47, 0x20000
    s_xor_b32 s86, s86, 1
    s_lshl_b32 s86, s86, 8
    s_add_u32 s87, s86, s85
    s_cmp_lt_u32 s4, 2
    s_cselect_b32 s88, s16, s18
    s_cselect_b32 s89, s17, s19
    s_add_u32 s48, s88, s87
    s_addc_u32 s49, s89, 0
    s_sub_u32 s50, 7340032, s87
    s_mov_b32 s51, 0x20000
    s_and_b32 s77, s28, 3
    s_bitcmp1_b32 s28, 3
    s_cselect_b32 s91, 4, 0
    s_add_u32 s77, s77, s91
    s_mul_i32 s77, s77, 917504
    s_add_u32 s77, s77, 0x38000
    s_add_u32 m0, s79, 135168
    s_add_u32 s72, s72, 128
    s_and_b32 s78, s72, 0x7ff
    buffer_load_dwordx4 v20, s[36:39], s78 offen lds
    s_add_u32 m0, s79, 136192
    s_nop 0
    buffer_load_dwordx4 v21, s[36:39], s78 offen lds
    s_add_u32 m0, s79, 137216
    s_add_u32 s78, s78, 32768
    buffer_load_dwordx4 v20, s[36:39], s78 offen lds
    s_add_u32 m0, s79, 138240
    s_nop 0
    buffer_load_dwordx4 v21, s[36:39], s78 offen lds
    s_add_u32 m0, s33, 57344
    s_add_u32 s77, s77, 229376
    s_cmp_eq_u32 s77, 7340032
    s_cselect_b32 s77, 0, s77
    buffer_load_dwordx4 v22, s[40:43], s77 offen offset:0 lds
    s_add_u32 m0, s33, 61312
    s_nop 0
    buffer_load_dwordx4 v22, s[40:43], s77 offen offset:128 lds
    s_add_u32 m0, s33, 65536
    s_nop 0
    buffer_load_dwordx4 v22, s[44:47], s77 offen offset:0 lds
    s_add_u32 m0, s33, 69504
    s_nop 0
    buffer_load_dwordx4 v22, s[44:47], s77 offen offset:128 lds
    s_add_u32 m0, s33, 73728
    s_nop 0
    buffer_load_dwordx4 v9, s[48:51], s77 offen lds
    s_lshl_b32 s84, s28, 7
    s_lshl_b32 s85, s29, 3
    s_add_u32 s84, s84, s85
    s_lshl1_add_u32 s84, s4, s84
    s_lshl_b32 s90, s84, 3
    s_lshl_b32 s84, s84, 11
    v_lshl_add_u32 v86, v1, 4, s84
    v_and_b32 v70, 1, v67
    v_lshlrev_b32 v70, 4, v70
    v_mov_b32 v71, 0x3f80
    v_lshlrev_b32 v70, v70, v71
    v_lshrrev_b32 v71, 1, v67
    v_cmp_eq_u32 vcc, 0, v71
    s_nop 1
    v_cndmask_b32 v144, 0, v70, vcc
    v_cmp_eq_u32 vcc, 1, v71
    s_nop 1
    v_cndmask_b32 v145, 0, v70, vcc
    v_cmp_eq_u32 vcc, 2, v71
    s_nop 1
    v_cndmask_b32 v146, 0, v70, vcc
    v_cmp_eq_u32 vcc, 3, v71
    s_nop 1
    v_cndmask_b32 v147, 0, v70, vcc
    s_lshl_b32 s91, s4, 12
    s_add_u32 s91, s91, 16384
    v_lshlrev_b32 v70, 1, v64
    v_xor_b32 v71, v69, v70
    v_lshl_add_u32 v71, v71, 4, s91
    v_and_b32 v148, 4, v70
    v_add_u32 v70, v70, v148
    v_and_b32 v148, 1, v68
    v_add_u32 v70, v70, v148
    v_lshl_add_u32 v148, v70, 7, v71
    s_lshl_b32 s91, s5, 11
    s_add_u32 s91, s91, 32768
    v_and_b32 v70, 2, v64
    v_xor_b32 v70, v66, v70
    v_lshl_add_u32 v70, v70, 4, s91
    v_lshrrev_b32 v71, 2, v1
    v_lshl_add_u32 v149, v71, 6, v70
    s_lshl2_add_u32 s91, s2, s4
    s_lshl_b32 s52, s91, 9
    s_lshr_b32 s92, s91, 2
    s_mul_i32 s92, s92, 7168
    s_and_b32 s91, s91, 3
    s_lshl_b32 s91, s91, 9
    s_add_u32 s92, s92, s91
    s_add_u32 s53, s92, 5120
    s_waitcnt vmcnt(9)
    s_barrier
    s_and_b32 s91, s28, 4
    s_cmp_eq_u32 s91, 0
    s_cbranch_scc0 L_cr0
    ds_read_b128 v[112:115], v148 offset:0
    ds_read_b128 v[116:119], v148 offset:512
    ds_read_b128 v[120:123], v148 offset:2048
    ds_read_b128 v[124:127], v148 offset:2560
    ds_read_b128 v[128:131], v149 offset:0
    ds_read_b128 v[132:135], v149 offset:1024
L_cr0:
    s_add_u32 m0, s33, 77824
    s_add_u32 s77, s77, 229376
    buffer_load_dwordx4 v22, s[40:43], s77 offen offset:0 lds
    s_add_u32 m0, s33, 81792
    s_nop 0
    buffer_load_dwordx4 v22, s[40:43], s77 offen offset:128 lds
    s_add_u32 m0, s33, 86016
    s_nop 0
    buffer_load_dwordx4 v22, s[44:47], s77 offen offset:0 lds
    s_add_u32 m0, s33, 89984
    s_nop 0
    buffer_load_dwordx4 v22, s[44:47], s77 offen offset:128 lds
    s_add_u32 m0, s33, 94208
    s_nop 0
    buffer_load_dwordx4 v9, s[48:51], s77 offen lds
    s_add_u32 m0, s79, 98304
    s_add_u32 s72, s72, 128
    s_and_b32 s78, s72, 0x7ff
    buffer_load_dwordx4 v20, s[36:39], s78 offen lds
    s_add_u32 m0, s79, 99328
    s_nop 0
    buffer_load_dwordx4 v21, s[36:39], s78 offen lds
    s_and_b32 s91, s28, 4
    s_cmp_eq_u32 s91, 0
    s_cbranch_scc0 L_cm0
    s_waitcnt lgkmcnt(0)
    s_setprio 2
    v_mfma_f32_16x16x32_bf16 v[136:139], v[144:147], v[112:115], 0
    v_mfma_f32_16x16x32_bf16 v[140:143], v[144:147], v[128:131], 0
    v_mfma_f32_16x16x32_bf16 v[136:139], v[144:147], v[116:119], v[136:139]
    v_mfma_f32_16x16x32_bf16 v[140:143], v[144:147], v[132:135], v[140:143]
    v_mfma_f32_16x16x32_bf16 v[136:139], v[144:147], v[120:123], v[136:139]
    v_mfma_f32_16x16x32_bf16 v[136:139], v[144:147], v[124:127], v[136:139]
    s_setprio 0
L_cm0:
    s_waitcnt vmcnt(16)
    s_barrier
    s_and_b32 s91, s28, 4
    s_cmp_eq_u32 s91, 0
    s_cbranch_scc0 L_cr1
    ds_read_b128 v[112:115], v148 offset:20480
    ds_read_b128 v[116:119], v148 offset:20992
    ds_read_b128 v[120:123], v148 offset:22528
    ds_read_b128 v[124:127], v148 offset:23040
    ds_read_b128 v[128:131], v149 offset:20480
    ds_read_b128 v[132:135], v149 offset:21504
L_cr1:
    s_add_u32 m0, s79, 100352
    s_add_u32 s78, s78, 32768
    buffer_load_dwordx4 v20, s[36:39], s78 offen lds
    s_add_u32 m0, s79, 101376
    s_nop 0
    buffer_load_dwordx4 v21, s[36:39], s78 offen lds
    s_add_u32 m0, s33, 16384
    s_add_u32 s77, s77, 229376
    s_cmp_eq_u32 s77, 7340032
    s_cselect_b32 s77, 0, s77
    buffer_load_dwordx4 v22, s[40:43], s77 offen offset:0 lds
    s_add_u32 m0, s33, 20352
    s_nop 0
    buffer_load_dwordx4 v22, s[40:43], s77 offen offset:128 lds
    s_add_u32 m0, s33, 24576
    s_nop 0
    buffer_load_dwordx4 v22, s[44:47], s77 offen offset:0 lds
    s_add_u32 m0, s33, 28544
    s_nop 0
    buffer_load_dwordx4 v22, s[44:47], s77 offen offset:128 lds
    s_add_u32 m0, s33, 32768
    s_nop 0
    buffer_load_dwordx4 v9, s[48:51], s77 offen lds
    s_and_b32 s91, s28, 4
    s_cmp_eq_u32 s91, 0
    s_cbranch_scc0 L_cm1
    s_waitcnt lgkmcnt(0)
    s_setprio 2
    v_mfma_f32_16x16x32_bf16 v[136:139], v[144:147], v[112:115], v[136:139]
    v_mfma_f32_16x16x32_bf16 v[140:143], v[144:147], v[128:131], v[140:143]
    v_mfma_f32_16x16x32_bf16 v[136:139], v[144:147], v[116:119], v[136:139]
    v_mfma_f32_16x16x32_bf16 v[140:143], v[144:147], v[132:135], v[140:143]
    v_mfma_f32_16x16x32_bf16 v[136:139], v[144:147], v[120:123], v[136:139]
    v_mfma_f32_16x16x32_bf16 v[136:139], v[144:147], v[124:127], v[136:139]
    s_setprio 0
L_cm1:
    s_waitcnt vmcnt(14)
    s_barrier
    s_and_b32 s91, s28, 4
    s_cmp_eq_u32 s91, 4
    s_cbranch_scc0 L_cr2
    ds_read_b128 v[112:115], v148 offset:40960
    ds_read_b128 v[116:119], v148 offset:41472
    ds_read_b128 v[120:123], v148 offset:43008
    ds_read_b128 v[124:127], v148 offset:43520
    ds_read_b128 v[128:131], v149 offset:40960
    ds_read_b128 v[132:135], v149 offset:41984
L_cr2:
    global_load_dwordx4 v[24:27], v86, s[8:9] offset:0
    global_load_dwordx4 v[32:35], v86, s[8:9] offset:2048
    global_load_dwordx4 v[28:31], v86, s[8:9] offset:1024
    global_load_dwordx4 v[36:39], v86, s[8:9] offset:3072
    s_add_u32 m0, s79, 116736
    s_add_u32 s72, s72, 128
    s_and_b32 s78, s72, 0x7ff
    buffer_load_dwordx4 v20, s[36:39], s78 offen lds
    s_add_u32 m0, s79, 117760
    s_nop 0
    buffer_load_dwordx4 v21, s[36:39], s78 offen lds
    s_add_u32 m0, s33, 36864
    s_add_u32 s77, s77, 229376
    buffer_load_dwordx4 v22, s[40:43], s77 offen offset:0 lds
    s_add_u32 m0, s33, 40832
    s_nop 0
    buffer_load_dwordx4 v22, s[40:43], s77 offen offset:128 lds
    s_add_u32 m0, s33, 45056
    s_nop 0
    buffer_load_dwordx4 v22, s[44:47], s77 offen offset:0 lds
    s_add_u32 m0, s33, 49024
    s_nop 0
    buffer_load_dwordx4 v22, s[44:47], s77 offen offset:128 lds
    s_add_u32 m0, s33, 53248
    s_nop 0
    buffer_load_dwordx4 v9, s[48:51], s77 offen lds
    s_and_b32 s91, s28, 4
    s_cmp_eq_u32 s91, 4
    s_cbranch_scc0 L_cm2
    s_waitcnt lgkmcnt(0)
    s_setprio 2
    v_mfma_f32_16x16x32_bf16 v[136:139], v[144:147], v[112:115], 0
    v_mfma_f32_16x16x32_bf16 v[140:143], v[144:147], v[128:131], 0
    v_mfma_f32_16x16x32_bf16 v[136:139], v[144:147], v[116:119], v[136:139]
    v_mfma_f32_16x16x32_bf16 v[140:143], v[144:147], v[132:135], v[140:143]
    v_mfma_f32_16x16x32_bf16 v[136:139], v[144:147], v[120:123], v[136:139]
    v_mfma_f32_16x16x32_bf16 v[136:139], v[144:147], v[124:127], v[136:139]
    s_setprio 0
L_cm2:
    s_waitcnt vmcnt(20)
    s_barrier
    s_and_b32 s91, s28, 4
    s_cmp_eq_u32 s91, 4
    s_cbranch_scc0 L_cr3
    ds_read_b128 v[112:115], v148 offset:61440
    ds_read_b128 v[116:119], v148 offset:61952
    ds_read_b128 v[120:123], v148 offset:63488
    ds_read_b128 v[124:127], v148 offset:64000
    ds_read_b128 v[128:131], v149 offset:61440
    ds_read_b128 v[132:135], v149 offset:62464
L_cr3:
    s_add_u32 m0, s79, 118784
    s_add_u32 s78, s78, 32768
    buffer_load_dwordx4 v20, s[36:39], s78 offen lds
    s_add_u32 m0, s79, 119808
    s_nop 0
    buffer_load_dwordx4 v21, s[36:39], s78 offen lds
    s_add_u32 m0, s33, 57344
    s_add_u32 s77, s77, 229376
    s_cmp_eq_u32 s77, 7340032
    s_cselect_b32 s77, 0, s77
    buffer_load_dwordx4 v22, s[40:43], s77 offen offset:0 lds
    s_add_u32 m0, s33, 61312
    s_nop 0
    buffer_load_dwordx4 v22, s[40:43], s77 offen offset:128 lds
    s_add_u32 m0, s33, 65536
    s_nop 0
    buffer_load_dwordx4 v22, s[44:47], s77 offen offset:0 lds
    s_add_u32 m0, s33, 69504
    s_nop 0
    buffer_load_dwordx4 v22, s[44:47], s77 offen offset:128 lds
    s_add_u32 m0, s33, 73728
    s_nop 0
    buffer_load_dwordx4 v9, s[48:51], s77 offen lds
    s_and_b32 s91, s28, 4
    s_cmp_eq_u32 s91, 4
    s_cbranch_scc0 L_cm3
    s_waitcnt lgkmcnt(0)
    s_setprio 2
    v_mfma_f32_16x16x32_bf16 v[136:139], v[144:147], v[112:115], v[136:139]
    v_mfma_f32_16x16x32_bf16 v[140:143], v[144:147], v[128:131], v[140:143]
    v_mfma_f32_16x16x32_bf16 v[136:139], v[144:147], v[116:119], v[136:139]
    v_mfma_f32_16x16x32_bf16 v[140:143], v[144:147], v[132:135], v[140:143]
    v_mfma_f32_16x16x32_bf16 v[136:139], v[144:147], v[120:123], v[136:139]
    v_mfma_f32_16x16x32_bf16 v[136:139], v[144:147], v[124:127], v[136:139]
    s_setprio 0
L_cm3:
    s_waitcnt vmcnt(18)
    s_barrier
    s_add_u32 m0, s79, 135168
    s_add_u32 s72, s72, 128
    s_and_b32 s78, s72, 0x7ff
    buffer_load_dwordx4 v20, s[36:39], s78 offen lds
    s_add_u32 m0, s79, 136192
    s_nop 0
    buffer_load_dwordx4 v21, s[36:39], s78 offen lds
    s_add_u32 m0, s33, 77824
    s_add_u32 s77, s77, 229376
    buffer_load_dwordx4 v22, s[40:43], s77 offen offset:0 lds
    s_add_u32 m0, s33, 81792
    s_nop 0
    buffer_load_dwordx4 v22, s[40:43], s77 offen offset:128 lds
    s_add_u32 m0, s33, 86016
    s_nop 0
    buffer_load_dwordx4 v22, s[44:47], s77 offen offset:0 lds
    s_add_u32 m0, s33, 89984
    s_nop 0
    buffer_load_dwordx4 v22, s[44:47], s77 offen offset:128 lds
    s_add_u32 m0, s33, 94208
    s_nop 0
    buffer_load_dwordx4 v9, s[48:51], s77 offen lds
    v_add_f32_dpp v136, v136, v136 row_ror:8 row_mask:0xf bank_mask:0xf
    v_add_f32_dpp v137, v137, v137 row_ror:8 row_mask:0xf bank_mask:0xf
    v_add_f32_dpp v138, v138, v138 row_ror:8 row_mask:0xf bank_mask:0xf
    v_add_f32_dpp v139, v139, v139 row_ror:8 row_mask:0xf bank_mask:0xf
    v_add_f32_dpp v140, v140, v140 row_ror:8 row_mask:0xf bank_mask:0xf
    v_add_f32_dpp v141, v141, v141 row_ror:8 row_mask:0xf bank_mask:0xf
    v_add_f32_dpp v142, v142, v142 row_ror:8 row_mask:0xf bank_mask:0xf
    v_add_f32_dpp v143, v143, v143 row_ror:8 row_mask:0xf bank_mask:0xf
    v_add_f32_dpp v140, v140, v140 row_ror:4 row_mask:0xf bank_mask:0xf
    v_add_f32_dpp v141, v141, v141 row_ror:4 row_mask:0xf bank_mask:0xf
    v_add_f32_dpp v142, v142, v142 row_ror:4 row_mask:0xf bank_mask:0xf
    v_add_f32_dpp v143, v143, v143 row_ror:4 row_mask:0xf bank_mask:0xf
    s_lshl_b32 s91, s29, 4
    s_add_u32 s91, s91, s28
    s_mul_i32 s91, s91, 1280
    s_mul_i32 s92, s5, 640
    s_add_u32 s91, s91, s92
    s_add_u32 s91, s91, 0x1e10000
    s_lshl_b32 s92, s6, 8
    v_and_b32 v112, 8, v1
    v_cmp_eq_u32 vcc, 0, v112
    v_mov_b32 v112, s92
    v_mov_b32 v113, 256
    v_cndmask_b32 v112, v113, v112, vcc
    v_cndmask_b32 v136, v140, v136, vcc
    v_cndmask_b32 v137, v141, v137, vcc
    v_cndmask_b32 v138, v142, v138, vcc
    v_cndmask_b32 v139, v143, v139, vcc
    v_and_b32 v113, 15, v1
    v_lshl_add_u32 v112, v113, 5, v112
    v_and_b32 v113, 16, v1
    v_add3_u32 v112, v112, v113, s91
    s_mov_b64 exec, 0x0fff0fff
    global_store_dwordx4 v112, v[136:139], s[26:27] sc1
    s_mov_b64 exec, -1
L_pad6:
    s_cbranch_execz L_vret0
    s_load_dword s94, s[10:11], s52 offset:0x0
    s_load_dword s94, s[10:11], s52 offset:0x40
    s_load_dword s94, s[10:11], s52 offset:0x80
    s_load_dword s94, s[10:11], s52 offset:0xc0
    s_load_dword s94, s[10:11], s52 offset:0x100
    s_waitcnt vmcnt(15)
    s_barrier
    s_add_u32 m0, s79, 137216
    s_add_u32 s78, s78, 32768
    buffer_load_dwordx4 v20, s[36:39], s78 offen lds
    s_waitcnt vmcnt(23)
    v_lshlrev_b32 v40, 16, v24
    v_and_b32 v41, 0xffff0000, v24
    v_lshlrev_b32 v42, 16, v25
    v_and_b32 v43, 0xffff0000, v25
    v_lshlrev_b32 v44, 16, v26
    v_and_b32 v45, 0xffff0000, v26
    v_lshlrev_b32 v46, 16, v27
    v_and_b32 v47, 0xffff0000, v27
    s_add_u32 m0, s79, 138240
    s_nop 0
    buffer_load_dwordx4 v21, s[36:39], s78 offen lds
    v_lshlrev_b32 v48, 16, v28
    v_and_b32 v49, 0xffff0000, v28
    v_lshlrev_b32 v50, 16, v29
    v_and_b32 v51, 0xffff0000, v29
    v_lshlrev_b32 v52, 16, v30
    v_and_b32 v53, 0xffff0000, v30
    v_lshlrev_b32 v54, 16, v31
    v_and_b32 v55, 0xffff0000, v31
    s_add_u32 m0, s33, 16384
    s_add_u32 s77, s77, 229376
    s_cmp_eq_u32 s77, 7340032
    s_cselect_b32 s77, 0, s77
    buffer_load_dwordx4 v22, s[40:43], s77 offen offset:0 lds
    v_lshlrev_b32 v56, 16, v32
    v_and_b32 v57, 0xffff0000, v32
    v_lshlrev_b32 v58, 16, v33
    v_and_b32 v59, 0xffff0000, v33
    v_lshlrev_b32 v60, 16, v34
    v_and_b32 v61, 0xffff0000, v34
    v_lshlrev_b32 v62, 16, v35
    v_and_b32 v63, 0xffff0000, v35
    s_add_u32 m0, s33, 20352
    s_nop 0
    buffer_load_dwordx4 v22, s[40:43], s77 offen offset:128 lds
    v_lshlrev_b32 v64, 16, v36
    v_and_b32 v65, 0xffff0000, v36
    v_lshlrev_b32 v66, 16, v37
    v_and_b32 v67, 0xffff0000, v37
    v_lshlrev_b32 v68, 16, v38
    v_and_b32 v69, 0xffff0000, v38
    v_lshlrev_b32 v70, 16, v39
    v_and_b32 v71, 0xffff0000, v39
    s_add_u32 m0, s33, 24576
    s_nop 0
    buffer_load_dwordx4 v22, s[44:47], s77 offen offset:0 lds
    v_add_f32 v72, v40, v41
    v_add_f32 v74, v56, v57
    v_add_f32 v72, v72, v42
    v_add_f32 v74, v74, v58
    v_add_f32 v72, v72, v43
    v_add_f32 v74, v74, v59
    v_add_f32 v72, v72, v44
    v_add_f32 v74, v74, v60
    s_add_u32 m0, s33, 28544
    s_nop 0
    buffer_load_dwordx4 v22, s[44:47], s77 offen offset:128 lds
    s_add_u32 m0, s33, 32768
    s_nop 0
    buffer_load_dwordx4 v9, s[48:51], s77 offen lds
    v_add_f32 v72, v72, v45
    v_add_f32 v74, v74, v61
    v_add_f32 v72, v72, v46
    v_add_f32 v74, v74, v62
    v_add_f32 v72, v72, v47
    v_add_f32 v74, v74, v63
    v_add_f32 v72, v72, v48
    v_add_f32 v74, v74, v64
    s_load_dword s94, s[10:11], s52 offset:0x140
    s_load_dword s94, s[10:11], s52 offset:0x180
    s_load_dword s94, s[10:11], s52 offset:0x1c0
    s_load_dword s94, s[16:17], s53 offset:0x0
    s_load_dword s94, s[16:17], s53 offset:0x40
    s_waitcnt vmcnt(15)
    s_barrier
    s_add_u32 m0, s79, 98304
    s_add_u32 s72, s72, 128
    s_and_b32 s78, s72, 0x7ff
    buffer_load_dwordx4 v20, s[36:39], s78 offen lds
    v_add_f32 v72, v72, v49
    v_add_f32 v74, v74, v65
    v_add_f32 v72, v72, v50
    v_add_f32 v74, v74, v66
    v_add_f32 v72, v72, v51
    v_add_f32 v74, v74, v67
    v_add_f32 v72, v72, v52
    v_add_f32 v74, v74, v68
    s_add_u32 m0, s79, 99328
    s_nop 0
    buffer_load_dwordx4 v21, s[36:39], s78 offen lds
    v_add_f32 v72, v72, v53
    v_add_f32 v74, v74, v69
    v_add_f32 v72, v72, v54
    v_add_f32 v74, v74, v70
    v_add_f32 v72, v72, v55
    v_add_f32 v74, v74, v71
    s_nop 0
    v_add_f32_dpp v72, v72, v72 quad_perm:[1,0,3,2] row_mask:0xf bank_mask:0xf
    v_add_f32_dpp v74, v74, v74 quad_perm:[1,0,3,2] row_mask:0xf bank_mask:0xf
    s_add_u32 m0, s33, 36864
    s_add_u32 s77, s77, 229376
    buffer_load_dwordx4 v22, s[40:43], s77 offen offset:0 lds
    s_nop 0
    v_add_f32_dpp v72, v72, v72 quad_perm:[2,3,0,1] row_mask:0xf bank_mask:0xf
    v_add_f32_dpp v74, v74, v74 quad_perm:[2,3,0,1] row_mask:0xf bank_mask:0xf
    s_nop 0
    v_add_f32_dpp v72, v72, v72 row_half_mirror row_mask:0xf bank_mask:0xf
    v_add_f32_dpp v74, v74, v74 row_half_mirror row_mask:0xf bank_mask:0xf
    s_nop 0
    v_add_f32_dpp v72, v72, v72 row_mirror row_mask:0xf bank_mask:0xf
    v_add_f32_dpp v74, v74, v74 row_mirror row_mask:0xf bank_mask:0xf
    v_mov_b32 v78, v72
    s_add_u32 m0, s33, 40832
    s_nop 0
    buffer_load_dwordx4 v22, s[40:43], s77 offen offset:128 lds
    v_mov_b32 v79, v74
    s_nop 0
    v_permlane16_swap_b32 v72, v78
    v_permlane16_swap_b32 v74, v79
    v_add_f32 v72, v72, v78
    v_add_f32 v74, v74, v79
    v_mov_b32 v78, v72
    v_mov_b32 v79, v74
    s_nop 0
    v_permlane32_swap_b32 v72, v78
    s_add_u32 m0, s33, 45056
    s_nop 0
    buffer_load_dwordx4 v22, s[44:47], s77 offen offset:0 lds
    s_add_u32 m0, s33, 49024
    s_nop 0
    buffer_load_dwordx4 v22, s[44:47], s77 offen offset:128 lds
    v_permlane32_swap_b32 v74, v79
    v_add_f32 v72, v72, v78
    v_add_f32 v74, v74, v79
    v_mul_f32 v72, 0x3a800000, v72
    v_mul_f32 v74, 0x3a800000, v74
    v_sub_f32 v78, v40, v72
    v_sub_f32 v79, v56, v74
    v_mul_f32 v73, v78, v78
    s_add_u32 m0, s33, 53248
    s_nop 0
    buffer_load_dwordx4 v9, s[48:51], s77 offen lds
    v_mul_f32 v75, v79, v79
    v_sub_f32 v78, v41, v72
    v_sub_f32 v79, v57, v74
    v_fmac_f32 v73, v78, v78
    v_fmac_f32 v75, v79, v79
    v_sub_f32 v78, v42, v72
    v_sub_f32 v79, v58, v74
    v_fmac_f32 v73, v78, v78
    s_load_dword s94, s[16:17], s53 offset:0x80
    s_load_dword s94, s[16:17], s53 offset:0xc0
    s_load_dword s94, s[16:17], s53 offset:0x100
    s_load_dword s94, s[16:17], s53 offset:0x140
    s_load_dword s94, s[16:17], s53 offset:0x180
    s_waitcnt vmcnt(15)
    s_barrier
    s_add_u32 m0, s79, 100352
    s_add_u32 s78, s78, 32768
    buffer_load_dwordx4 v20, s[36:39], s78 offen lds
    v_fmac_f32 v75, v79, v79
    v_sub_f32 v78, v43, v72
    v_sub_f32 v79, v59, v74
    v_fmac_f32 v73, v78, v78
    v_fmac_f32 v75, v79, v79
    v_sub_f32 v78, v44, v72
    v_sub_f32 v79, v60, v74
    v_fmac_f32 v73, v78, v78
    s_add_u32 m0, s79, 101376
    s_nop 0
    buffer_load_dwordx4 v21, s[36:39], s78 offen lds
    v_fmac_f32 v75, v79, v79
    v_sub_f32 v78, v45, v72
    v_sub_f32 v79, v61, v74
    v_fmac_f32 v73, v78, v78
    v_fmac_f32 v75, v79, v79
    v_sub_f32 v78, v46, v72
    v_sub_f32 v79, v62, v74
    v_fmac_f32 v73, v78, v78
    s_add_u32 m0, s33, 57344
    s_add_u32 s77, s77, 229376
    s_cmp_eq_u32 s77, 7340032
    s_cselect_b32 s77, 0, s77
    buffer_load_dwordx4 v22, s[40:43], s77 offen offset:0 lds
    v_fmac_f32 v75, v79, v79
    v_sub_f32 v78, v47, v72
    v_sub_f32 v79, v63, v74
    v_fmac_f32 v73, v78, v78
    v_fmac_f32 v75, v79, v79
    v_sub_f32 v78, v48, v72
    v_sub_f32 v79, v64, v74
    v_fmac_f32 v73, v78, v78
    s_add_u32 m0, s33, 61312
    s_nop 0
    buffer_load_dwordx4 v22, s[40:43], s77 offen offset:128 lds
    v_fmac_f32 v75, v79, v79
    v_sub_f32 v78, v49, v72
    v_sub_f32 v79, v65, v74
    v_fmac_f32 v73, v78, v78
    v_fmac_f32 v75, v79, v79
    v_sub_f32 v78, v50, v72
    v_sub_f32 v79, v66, v74
    v_fmac_f32 v73, v78, v78
    s_add_u32 m0, s33, 65536
    s_nop 0
    buffer_load_dwordx4 v22, s[44:47], s77 offen offset:0 lds
    v_fmac_f32 v75, v79, v79
    v_sub_f32 v78, v51, v72
    v_sub_f32 v79, v67, v74
    v_fmac_f32 v73, v78, v78
    v_fmac_f32 v75, v79, v79
    v_sub_f32 v78, v52, v72
    v_sub_f32 v79, v68, v74
    v_fmac_f32 v73, v78, v78
    s_add_u32 m0, s33, 69504
    s_nop 0
    buffer_load_dwordx4 v22, s[44:47], s77 offen offset:128 lds
    s_add_u32 m0, s33, 73728
    s_nop 0
    buffer_load_dwordx4 v9, s[48:51], s77 offen lds
    v_fmac_f32 v75, v79, v79
    v_sub_f32 v78, v53, v72
    v_sub_f32 v79, v69, v74
    v_fmac_f32 v73, v78, v78
    v_fmac_f32 v75, v79, v79
    v_sub_f32 v78, v54, v72
    v_sub_f32 v79, v70, v74
    v_fmac_f32 v73, v78, v78
    s_load_dword s94, s[16:17], s53 offset:0x1c0
    s_load_dword s94, s[18:19], s53 offset:0x0
    s_load_dword s94, s[18:19], s53 offset:0x40
    s_load_dword s94, s[18:19], s53 offset:0x80
    s_load_dword s94, s[18:19], s53 offset:0xc0
    s_waitcnt vmcnt(14)
    s_barrier
    s_add_u32 m0, s79, 116736
    s_add_u32 s72, s72, 128
    s_and_b32 s78, s72, 0x7ff
    buffer_load_dwordx4 v20, s[36:39], s78 offen lds
    v_fmac_f32 v75, v79, v79
    v_sub_f32 v78, v55, v72
    v_sub_f32 v79, v71, v74
    v_fmac_f32 v73, v78, v78
    v_fmac_f32 v75, v79, v79
    s_nop 0
    v_add_f32_dpp v73, v73, v73 quad_perm:[1,0,3,2] row_mask:0xf bank_mask:0xf
    v_add_f32_dpp v75, v75, v75 quad_perm:[1,0,3,2] row_mask:0xf bank_mask:0xf
    s_nop 0
    v_add_f32_dpp v73, v73, v73 quad_perm:[2,3,0,1] row_mask:0xf bank_mask:0xf
    s_add_u32 m0, s79, 117760
    s_nop 0
    buffer_load_dwordx4 v21, s[36:39], s78 offen lds
    v_add_f32_dpp v75, v75, v75 quad_perm:[2,3,0,1] row_mask:0xf bank_mask:0xf
    s_nop 0
    v_add_f32_dpp v73, v73, v73 row_half_mirror row_mask:0xf bank_mask:0xf
    v_add_f32_dpp v75, v75, v75 row_half_mirror row_mask:0xf bank_mask:0xf
    s_nop 0
    v_add_f32_dpp v73, v73, v73 row_mirror row_mask:0xf bank_mask:0xf
    v_add_f32_dpp v75, v75, v75 row_mirror row_mask:0xf bank_mask:0xf
    v_mov_b32 v78, v73
    v_mov_b32 v79, v75
    s_add_u32 m0, s33, 77824
    s_add_u32 s77, s77, 229376
    buffer_load_dwordx4 v22, s[40:43], s77 offen offset:0 lds
    s_nop 0
    v_permlane16_swap_b32 v73, v78
    v_permlane16_swap_b32 v75, v79
    v_add_f32 v73, v73, v78
    v_add_f32 v75, v75, v79
    v_mov_b32 v78, v73
    v_mov_b32 v79, v75
    s_nop 0
    v_permlane32_swap_b32 v73, v78
    s_add_u32 m0, s33, 81792
    s_nop 0
    buffer_load_dwordx4 v22, s[40:43], s77 offen offset:128 lds
    v_permlane32_swap_b32 v75, v79
    v_add_f32 v73, v73, v78
    v_add_f32 v75, v75, v79
    v_mul_f32 v73, 0x3a800000, v73
    v_mul_f32 v75, 0x3a800000, v75
    v_cvt_pk_bf16_f32 v72, v72, v72
    v_lshlrev_b32 v72, 16, v72
    v_cvt_pk_bf16_f32 v73, v73, v73
    s_add_u32 m0, s33, 86016
    s_nop 0
    buffer_load_dwordx4 v22, s[44:47], s77 offen offset:0 lds
    s_add_u32 m0, s33, 89984
    s_nop 0
    buffer_load_dwordx4 v22, s[44:47], s77 offen offset:128 lds
    v_lshlrev_b32 v73, 16, v73
    v_add_f32 v73, 0x3727c5ac, v73
    v_cvt_pk_bf16_f32 v73, v73, v73
    v_lshlrev_b32 v73, 16, v73
    v_sqrt_f32 v73, v73
    v_cvt_pk_bf16_f32 v74, v74, v74
    v_lshlrev_b32 v74, 16, v74
    s_add_u32 m0, s33, 94208
    s_nop 0
    buffer_load_dwordx4 v9, s[48:51], s77 offen lds
    v_cvt_pk_bf16_f32 v75, v75, v75
    v_lshlrev_b32 v75, 16, v75
    v_add_f32 v75, 0x3727c5ac, v75
    v_cvt_pk_bf16_f32 v75, v75, v75
    v_lshlrev_b32 v75, 16, v75
    v_sqrt_f32 v75, v75
    s_nop 0
    v_cvt_pk_bf16_f32 v73, v73, v73
    s_load_dword s94, s[18:19], s53 offset:0x100
    s_load_dword s94, s[18:19], s53 offset:0x140
    s_load_dword s94, s[18:19], s53 offset:0x180
    s_load_dword s94, s[18:19], s53 offset:0x1c0
    s_load_dword s94, s[10:11], s52 offset:0x80000
    s_waitcnt vmcnt(14)
    s_barrier
    s_add_u32 m0, s79, 118784
    s_add_u32 s78, s78, 32768
    buffer_load_dwordx4 v20, s[36:39], s78 offen lds
    v_lshlrev_b32 v73, 16, v73
    v_rcp_f32 v76, v73
    s_nop 0
    v_cvt_pk_bf16_f32 v75, v75, v75
    v_lshlrev_b32 v75, 16, v75
    v_rcp_f32 v77, v75
    s_nop 0
    v_fma_f32 v78, -v73, v76, 1.0
    s_add_u32 m0, s79, 119808
    s_nop 0
    buffer_load_dwordx4 v21, s[36:39], s78 offen lds
    v_fma_f32 v76, v78, v76, v76
    s_nop 0
    v_fma_f32 v79, -v75, v77, 1.0
    v_fma_f32 v77, v79, v77, v77
    v_sub_f32 v80, v40, v72
    v_sub_f32 v81, v41, v72
    v_cvt_pk_bf16_f32 v80, v80, v81
    v_and_b32 v81, 0xffff0000, v80
    v_lshlrev_b32 v80, 16, v80
    s_add_u32 m0, s33, 16384
    s_add_u32 s77, s77, 229376
    s_cmp_eq_u32 s77, 7340032
    s_cselect_b32 s77, 0, s77
    buffer_load_dwordx4 v22, s[40:43], s77 offen offset:0 lds
    v_mul_f32 v80, v80, v76
    v_mul_f32 v81, v81, v76
    v_cvt_pk_bf16_f32 v24, v80, v81
    v_sub_f32 v80, v42, v72
    v_sub_f32 v81, v43, v72
    v_cvt_pk_bf16_f32 v80, v80, v81
    v_and_b32 v81, 0xffff0000, v80
    v_lshlrev_b32 v80, 16, v80
    s_add_u32 m0, s33, 20352
    s_nop 0
    buffer_load_dwordx4 v22, s[40:43], s77 offen offset:128 lds
    v_mul_f32 v80, v80, v76
    v_mul_f32 v81, v81, v76
    v_cvt_pk_bf16_f32 v25, v80, v81
    v_sub_f32 v80, v44, v72
    v_sub_f32 v81, v45, v72
    v_cvt_pk_bf16_f32 v80, v80, v81
    v_and_b32 v81, 0xffff0000, v80
    v_lshlrev_b32 v80, 16, v80
    s_add_u32 m0, s33, 24576
    s_nop 0
    buffer_load_dwordx4 v22, s[44:47], s77 offen offset:0 lds
    s_add_u32 m0, s33, 28544
    s_nop 0
    buffer_load_dwordx4 v22, s[44:47], s77 offen offset:128 lds
    v_mul_f32 v80, v80, v76
    v_mul_f32 v81, v81, v76
    v_cvt_pk_bf16_f32 v26, v80, v81
    v_sub_f32 v80, v46, v72
    v_sub_f32 v81, v47, v72
    v_cvt_pk_bf16_f32 v80, v80, v81
    v_and_b32 v81, 0xffff0000, v80
    v_lshlrev_b32 v80, 16, v80
    s_add_u32 m0, s33, 32768
    s_nop 0
    buffer_load_dwordx4 v9, s[48:51], s77 offen lds
    v_mul_f32 v80, v80, v76
    v_mul_f32 v81, v81, v76
    v_cvt_pk_bf16_f32 v27, v80, v81
    v_sub_f32 v80, v48, v72
    v_sub_f32 v81, v49, v72
    v_cvt_pk_bf16_f32 v80, v80, v81
    v_and_b32 v81, 0xffff0000, v80
    v_lshlrev_b32 v80, 16, v80
    s_load_dword s94, s[10:11], s52 offset:0x80040
    s_load_dword s94, s[10:11], s52 offset:0x80080
    s_load_dword s94, s[10:11], s52 offset:0x800c0
    s_load_dword s94, s[10:11], s52 offset:0x80100
    s_load_dword s94, s[10:11], s52 offset:0x80140
    s_waitcnt vmcnt(14)
    s_barrier
    s_add_u32 m0, s79, 135168
    s_add_u32 s72, s72, 128
    s_and_b32 s78, s72, 0x7ff
    buffer_load_dwordx4 v20, s[36:39], s78 offen lds
    v_mul_f32 v80, v80, v76
    v_mul_f32 v81, v81, v76
    v_cvt_pk_bf16_f32 v28, v80, v81
    v_sub_f32 v80, v50, v72
    v_sub_f32 v81, v51, v72
    v_cvt_pk_bf16_f32 v80, v80, v81
    v_and_b32 v81, 0xffff0000, v80
    v_lshlrev_b32 v80, 16, v80
    s_add_u32 m0, s79, 136192
    s_nop 0
    buffer_load_dwordx4 v21, s[36:39], s78 offen lds
    v_mul_f32 v80, v80, v76
    v_mul_f32 v81, v81, v76
    v_cvt_pk_bf16_f32 v29, v80, v81
    v_sub_f32 v80, v52, v72
    v_sub_f32 v81, v53, v72
    v_cvt_pk_bf16_f32 v80, v80, v81
    v_and_b32 v81, 0xffff0000, v80
    v_lshlrev_b32 v80, 16, v80
    s_add_u32 m0, s33, 36864
    s_add_u32 s77, s77, 229376
    buffer_load_dwordx4 v22, s[40:43], s77 offen offset:0 lds
    v_mul_f32 v80, v80, v76
    v_mul_f32 v81, v81, v76
    v_cvt_pk_bf16_f32 v30, v80, v81
    v_sub_f32 v80, v54, v72
    v_sub_f32 v81, v55, v72
    v_cvt_pk_bf16_f32 v80, v80, v81
    v_and_b32 v81, 0xffff0000, v80
    v_lshlrev_b32 v80, 16, v80
    s_add_u32 m0, s33, 40832
    s_nop 0
    buffer_load_dwordx4 v22, s[40:43], s77 offen offset:128 lds
    v_mul_f32 v80, v80, v76
    v_mul_f32 v81, v81, v76
    v_cvt_pk_bf16_f32 v31, v80, v81
    v_sub_f32 v80, v56, v74
    v_sub_f32 v81, v57, v74
    v_cvt_pk_bf16_f32 v80, v80, v81
    v_and_b32 v81, 0xffff0000, v80
    v_lshlrev_b32 v80, 16, v80
    s_add_u32 m0, s33, 45056
    s_nop 0
    buffer_load_dwordx4 v22, s[44:47], s77 offen offset:0 lds
    v_mul_f32 v80, v80, v77
    v_mul_f32 v81, v81, v77
    v_cvt_pk_bf16_f32 v32, v80, v81
    v_sub_f32 v80, v58, v74
    v_sub_f32 v81, v59, v74
    v_cvt_pk_bf16_f32 v80, v80, v81
    v_and_b32 v81, 0xffff0000, v80
    v_lshlrev_b32 v80, 16, v80
    s_add_u32 m0, s33, 49024
    s_nop 0
    buffer_load_dwordx4 v22, s[44:47], s77 offen offset:128 lds
    s_add_u32 m0, s33, 53248
    s_nop 0
    buffer_load_dwordx4 v9, s[48:51], s77 offen lds
    v_mul_f32 v80, v80, v77
    v_mul_f32 v81, v81, v77
    v_cvt_pk_bf16_f32 v33, v80, v81
    v_sub_f32 v80, v60, v74
    v_sub_f32 v81, v61, v74
    v_cvt_pk_bf16_f32 v80, v80, v81
    v_and_b32 v81, 0xffff0000, v80
    v_lshlrev_b32 v80, 16, v80
    s_load_dword s94, s[10:11], s52 offset:0x80180
    s_load_dword s94, s[10:11], s52 offset:0x801c0
    s_add_u32 s52, s52, 0x100000
    s_load_dword s94, s[10:11], s52 offset:0x0
    s_load_dword s94, s[10:11], s52 offset:0x40
    s_load_dword s94, s[10:11], s52 offset:0x80
    s_waitcnt vmcnt(14)
    s_barrier
    s_add_u32 m0, s79, 137216
    s_add_u32 s78, s78, 32768
    buffer_load_dwordx4 v20, s[36:39], s78 offen lds
    v_mul_f32 v80, v80, v77
    v_mul_f32 v81, v81, v77
    v_cvt_pk_bf16_f32 v34, v80, v81
    v_sub_f32 v80, v62, v74
    v_sub_f32 v81, v63, v74
    v_cvt_pk_bf16_f32 v80, v80, v81
    v_and_b32 v81, 0xffff0000, v80
    v_lshlrev_b32 v80, 16, v80
    s_add_u32 m0, s79, 138240
    s_nop 0
    buffer_load_dwordx4 v21, s[36:39], s78 offen lds
    v_mul_f32 v80, v80, v77
    v_mul_f32 v81, v81, v77
    v_cvt_pk_bf16_f32 v35, v80, v81
    v_sub_f32 v80, v64, v74
    v_sub_f32 v81, v65, v74
    v_cvt_pk_bf16_f32 v80, v80, v81
    v_and_b32 v81, 0xffff0000, v80
    v_lshlrev_b32 v80, 16, v80
    s_add_u32 m0, s33, 57344
    s_add_u32 s77, s77, 229376
    s_cmp_eq_u32 s77, 7340032
    s_cselect_b32 s77, 0, s77
    buffer_load_dwordx4 v22, s[40:43], s77 offen offset:0 lds
    v_mul_f32 v80, v80, v77
    v_mul_f32 v81, v81, v77
    v_cvt_pk_bf16_f32 v36, v80, v81
    v_sub_f32 v80, v66, v74
    v_sub_f32 v81, v67, v74
    v_cvt_pk_bf16_f32 v80, v80, v81
    v_and_b32 v81, 0xffff0000, v80
    v_lshlrev_b32 v80, 16, v80
    s_add_u32 m0, s33, 61312
    s_nop 0
    buffer_load_dwordx4 v22, s[40:43], s77 offen offset:128 lds
    v_mul_f32 v80, v80, v77
    v_mul_f32 v81, v81, v77
    v_cvt_pk_bf16_f32 v37, v80, v81
    v_sub_f32 v80, v68, v74
    v_sub_f32 v81, v69, v74
    v_cvt_pk_bf16_f32 v80, v80, v81
    v_and_b32 v81, 0xffff0000, v80
    v_lshlrev_b32 v80, 16, v80
    s_add_u32 m0, s33, 65536
    s_nop 0
    buffer_load_dwordx4 v22, s[44:47], s77 offen offset:0 lds
    v_mul_f32 v80, v80, v77
    v_mul_f32 v81, v81, v77
    v_cvt_pk_bf16_f32 v38, v80, v81
    v_sub_f32 v80, v70, v74
    v_sub_f32 v81, v71, v74
    v_cvt_pk_bf16_f32 v80, v80, v81
    v_and_b32 v81, 0xffff0000, v80
    v_lshlrev_b32 v80, 16, v80
    s_add_u32 m0, s33, 69504
    s_nop 0
    buffer_load_dwordx4 v22, s[44:47], s77 offen offset:128 lds
    s_add_u32 m0, s33, 73728
    s_nop 0
    buffer_load_dwordx4 v9, s[48:51], s77 offen lds
    v_mul_f32 v80, v80, v77
    v_mul_f32 v81, v81, v77
    v_cvt_pk_bf16_f32 v39, v80, v81
    s_add_u32 s90, s90, 0x1e00000
    v_mov_b32 v7, s90
    s_mov_b64 exec, 1
    global_store_dwordx4 v7, v[72:75], s[26:27] sc1
    s_mov_b64 exec, -1
    v_lshrrev_b32 v64, 4, v1
    v_bfe_u32 v65, v1, 2, 2
    v_and_b32 v66, 3, v1
    v_and_b32 v67, 15, v1
    v_lshrrev_b32 v68, 3, v1
    v_and_b32 v69, 7, v1
    s_lshl_b32 s85, s6, 2
    s_lshl_b32 s86, s5, 1
    s_or_b32 s85, s85, s86
    v_lshl_add_u32 v70, v64, 3, v65
    v_lshlrev_b32 v70, 7, v70
    s_load_dword s94, s[10:11], s52 offset:0xc0
    s_load_dword s94, s[10:11], s52 offset:0x100
    s_load_dword s94, s[10:11], s52 offset:0x140
    s_load_dword s94, s[10:11], s52 offset:0x180
    s_load_dword s94, s[10:11], s52 offset:0x1c0
    global_store_dwordx4 v86, v[24:27], s[26:27] offset:0 sc1
    s_waitcnt vmcnt(16)
    s_barrier
    s_add_u32 m0, s79, 98304
    s_add_u32 s72, s72, 128
    s_and_b32 s78, s72, 0x7ff
    buffer_load_dwordx4 v20, s[36:39], s78 offen lds
    v_and_b32 v71, 1, v66
    v_lshl_add_u32 v70, v71, 3, v70
    v_add_u32 v70, 16384, v70
    v_and_b32 v71, 2, v65
    v_and_b32 v72, 1, v64
    v_lshl_add_u32 v71, v72, 2, v71
    v_lshrrev_b32 v72, 1, v66
    v_xor_b32 v71, v71, v72
    s_add_u32 m0, s79, 99328
    s_nop 0
    buffer_load_dwordx4 v21, s[36:39], s78 offen lds
    v_xor_b32 v71, s85, v71
    v_xor_b32 v72, 0, v71
    v_lshl_add_u32 v4, v72, 4, v70
    v_add_u32 v6, 40960, v4
    v_xor_b32 v72, 2, v71
    v_lshl_add_u32 v5, v72, 4, v70
    v_add_u32 v7, 40960, v5
    v_lshrrev_b32 v70, 1, v67
    s_add_u32 m0, s33, 77824
    s_add_u32 s77, s77, 229376
    buffer_load_dwordx4 v22, s[40:43], s77 offen offset:0 lds
    v_xor_b32 v70, v70, v64
    v_lshlrev_b32 v70, 4, v70
    v_lshl_add_u32 v70, v67, 7, v70
    s_lshl_b32 s85, s5, 13
    v_add_u32 v16, s85, v70
    v_xor_b32 v17, 64, v16
    s_sub_u32 s95, 16384, s85
    s_mov_b32 s80, 135168
    s_lshl_b32 s86, s28, 7
    s_sub_u32 s86, s86, 16
    s_max_i32 s86, s86, 0
    s_lshl_b32 s87, s4, 2
    v_add_u32 v71, s87, v68
    s_add_u32 m0, s33, 81792
    s_nop 0
    buffer_load_dwordx4 v22, s[40:43], s77 offen offset:128 lds
    v_lshrrev_b32 v70, 1, v71
    v_and_b32 v70, 7, v70
    v_xor_b32 v70, v70, v69
    v_lshlrev_b32 v70, 4, v70
    v_add_u32 v71, s86, v71
    v_lshl_add_u32 v3, v71, 11, v70
    s_lshl_b32 s81, s4, 9
    s_lshl_b32 s85, s4, 3
    s_and_b32 s86, s4, 1
    s_lshl_b32 s86, s86, 2
    v_and_b32 v70, 2, v68
    s_add_u32 m0, s33, 86016
    s_nop 0
    buffer_load_dwordx4 v22, s[44:47], s77 offen offset:0 lds
    v_xor_b32 v70, v70, v69
    v_xor_b32 v70, s86, v70
    v_add_u32 v71, s85, v68
    v_mul_u32_u24 v71, 6144, v71
    v_lshl_add_u32 v23, v70, 4, v71
    s_lshl_b32 s85, s4, 12
    v_lshl_add_u32 v10, v1, 4, s85
    s_lshl_b32 s85, s4, 4
    v_and_b32 v70, 2, v68
    v_xor_b32 v70, v70, v69
    s_add_u32 m0, s33, 89984
    s_nop 0
    buffer_load_dwordx4 v22, s[44:47], s77 offen offset:128 lds
    s_add_u32 m0, s33, 94208
    s_nop 0
    buffer_load_dwordx4 v9, s[48:51], s77 offen lds
    v_xor_b32 v70, 0, v70
    v_add_u32 v71, s85, v68
    v_mul_u32_u24 v71, 2048, v71
    v_lshl_add_u32 v11, v70, 4, v71
    s_add_u32 s85, s85, 8
    v_and_b32 v70, 2, v68
    v_xor_b32 v70, v70, v69
    v_xor_b32 v70, 4, v70
    v_add_u32 v71, s85, v68
    s_load_dword s94, s[10:11], s52 offset:0x80000
    s_load_dword s94, s[10:11], s52 offset:0x80040
    s_load_dword s94, s[10:11], s52 offset:0x80080
    s_load_dword s94, s[10:11], s52 offset:0x800c0
    s_load_dword s94, s[10:11], s52 offset:0x80100
    global_store_dwordx4 v86, v[28:31], s[26:27] offset:1024 sc1
    v_mov_b32 v87, 0
    s_mov_b64 exec, 1
    global_load_dwordx2 v[18:19], v87, s[24:25] sc1
    s_mov_b64 exec, -1
    s_waitcnt vmcnt(18)
    s_barrier
    s_add_u32 m0, s79, 100352
    s_add_u32 s78, s78, 32768
    buffer_load_dwordx4 v20, s[36:39], s78 offen lds
    v_mul_u32_u24 v71, 2048, v71
    v_lshl_add_u32 v12, v70, 4, v71
    s_lshl_b32 s85, s31, 8
    s_lshl_b32 s86, s32, 7
    s_add_u32 s86, s85, s86
    s_xor_b32 s87, s86, 128
    s_add_u32 s60, s20, s86
    s_addc_u32 s61, s21, 0
    s_sub_u32 s62, 7340032, s86
    s_mov_b32 s63, 0x20000
    s_add_u32 s64, s20, s87
    s_addc_u32 s65, s21, 0
    s_sub_u32 s66, 7340032, s87
    s_mov_b32 s67, 0x20000
    s_add_u32 s56, s26, 0x400000
    s_addc_u32 s57, s27, 0
    s_mov_b32 s58, 0xe00000
    s_mov_b32 s59, 0x20000
    s_mul_i32 s82, s30, 917504
    s_mul_i32 s85, s32, 327680
    s_add_u32 s82, s82, s85
    s_mul_i32 s83, s32, 2621440
    s_mul_i32 s85, s32, 10
    s_add_u32 m0, s79, 101376
    s_nop 0
    buffer_load_dwordx4 v21, s[36:39], s78 offen lds
    s_sub_u32 s85, 40, s85
    s_lshl_b32 s14, s85, 13
    s_lshl_b32 s35, s85, 16
    s_add_u32 s83, s83, 1441792
    s_add_u32 s82, s82, 196608
L_pad7:
    s_cbranch_execz L_vret0
    s_lshl_b32 s84, s30, 7
    s_lshl_b32 s85, s5, 6
    s_add_u32 s84, s84, s85
    s_lshl_b32 s84, s84, 11
    s_lshl_b32 s85, s31, 8
    s_add_u32 s84, s84, s85
    s_lshl_b32 s85, s32, 7
    s_add_u32 s84, s84, s85
    s_lshl_b32 s85, s6, 6
    s_add_u32 s84, s84, s85
    v_lshrrev_b32 v70, 2, v1
    v_lshl_add_u32 v71, v66, 4, s84
    v_lshl_add_u32 v13, v70, 11, v71
    v_lshrrev_b32 v72, 4, v1
    s_add_u32 m0, s33, 16384
    s_add_u32 s77, s77, 229376
    s_cmp_eq_u32 s77, 7340032
    s_cselect_b32 s77, 0, s77
    buffer_load_dwordx4 v22, s[40:43], s77 offen offset:0 lds
    v_and_b32 v73, 15, v1
    v_and_b32 v74, 1, v72
    v_xor_b32 v74, s5, v74
    v_lshrrev_b32 v75, 1, v72
    v_lshl_add_u32 v74, v74, 1, v75
    v_lshlrev_b32 v74, 8, v74
    v_lshl_add_u32 v0, v73, 4, v74
    v_lshrrev_b32 v72, 4, v1
    s_add_u32 m0, s33, 20352
    s_nop 0
    buffer_load_dwordx4 v22, s[40:43], s77 offen offset:128 lds
    v_and_b32 v73, 1, v72
    v_lshrrev_b32 v72, 1, v72
    v_lshlrev_b32 v72, 8, v72
    v_lshl_add_u32 v72, v73, 10, v72
    v_and_b32 v73, 15, v1
    v_lshl_add_u32 v8, v73, 4, v72
    s_mov_b32 s54, 7332992
    s_mov_b32 s55, 0x20000
    s_mul_i32 s84, s6, 3072
    s_add_u32 s84, s84, 153600
    v_lshl_add_u32 v85, v1, 3, s84
    s_add_u32 m0, s33, 24576
    s_nop 0
    buffer_load_dwordx4 v22, s[44:47], s77 offen offset:0 lds
    s_add_u32 m0, s33, 28544
    s_nop 0
    buffer_load_dwordx4 v22, s[44:47], s77 offen offset:128 lds
    s_mul_i32 s84, s28, 112
    s_lshl1_add_u32 s85, s29, s6
    s_add_u32 s86, s85, 2
    s_and_b32 s86, s86, 31
    s_add_u32 s84, s84, s86
    s_add_u32 s84, s84, 80
    s_lshl_b32 s84, s84, 13
    s_lshl_b32 s86, s5, 12
    s_add_u32 s84, s84, s86
    s_add_u32 s84, s84, 0x400000
    s_lshl_b32 s87, s5, 9
    s_add_u32 s73, s84, s87
    s_xor_b32 s87, s87, 512
    s_add_u32 s74, s84, s87
    s_lshl_b32 s84, s28, 5
    s_add_u32 s84, s84, s85
    s_lshl_b32 s84, s84, 13
    s_add_u32 s84, s84, s86
    s_add_u32 s75, s84, 0x1200000
    v_mov_b32 v84, 0xc0135761
    v_mov_b32 v152, 0
    v_mov_b32 v153, 0
    s_add_u32 m0, s33, 32768
    s_nop 0
    buffer_load_dwordx4 v9, s[48:51], s77 offen lds
    v_mov_b32 v154, 0
    v_mov_b32 v155, 0
    v_mov_b32 v156, 0
    v_mov_b32 v157, 0
    v_mov_b32 v158, 0
    v_mov_b32 v159, 0
    v_mov_b32 v160, 0
    v_mov_b32 v161, 0
    s_load_dword s94, s[10:11], s52 offset:0x80140
    s_load_dword s94, s[10:11], s52 offset:0x80180
    s_load_dword s94, s[10:11], s52 offset:0x801c0
    s_add_u32 s53, s53, 0x1c0000
    s_load_dword s94, s[16:17], s53 offset:0x0
    s_load_dword s94, s[16:17], s53 offset:0x40
    global_store_dwordx4 v86, v[32:35], s[26:27] offset:2048 sc1
    s_waitcnt vmcnt(19)
    s_barrier
    s_add_u32 m0, s79, 116736
    s_add_u32 s72, s72, 128
    s_and_b32 s78, s72, 0x7ff
    buffer_load_dwordx4 v20, s[36:39], s78 offen lds
    v_mov_b32 v162, 0
    v_mov_b32 v163, 0
    v_mov_b32 v164, 0
    v_mov_b32 v165, 0
    v_mov_b32 v166, 0
    v_mov_b32 v167, 0
    v_mov_b32 v168, 0
    v_mov_b32 v169, 0
    s_add_u32 m0, s79, 117760
    s_nop 0
    buffer_load_dwordx4 v21, s[36:39], s78 offen lds
    v_mov_b32 v170, 0
    v_mov_b32 v171, 0
    v_mov_b32 v172, 0
    v_mov_b32 v173, 0
    v_mov_b32 v174, 0
    v_mov_b32 v175, 0
    v_mov_b32 v176, 0
    v_mov_b32 v177, 0
    s_add_u32 m0, s33, 36864
    s_add_u32 s77, s77, 229376
    buffer_load_dwordx4 v22, s[40:43], s77 offen offset:0 lds
    v_mov_b32 v178, 0
    v_mov_b32 v179, 0
    v_mov_b32 v180, 0
    v_mov_b32 v181, 0
    v_mov_b32 v182, 0
    v_mov_b32 v183, 0
    v_mov_b32 v184, 0
    v_mov_b32 v185, 0
    s_add_u32 m0, s33, 40832
    s_nop 0
    buffer_load_dwordx4 v22, s[40:43], s77 offen offset:128 lds
    v_mov_b32 v186, 0
    v_mov_b32 v187, 0
    v_mov_b32 v188, 0
    v_mov_b32 v189, 0
    v_mov_b32 v190, 0
    v_mov_b32 v191, 0
    v_mov_b32 v192, 0
    v_mov_b32 v193, 0
    s_add_u32 m0, s33, 45056
    s_nop 0
    buffer_load_dwordx4 v22, s[44:47], s77 offen offset:0 lds
    v_mov_b32 v194, 0
    v_mov_b32 v195, 0
    v_mov_b32 v196, 0
    v_mov_b32 v197, 0
    v_mov_b32 v198, 0
    v_mov_b32 v199, 0
    v_mov_b32 v200, 0
    v_mov_b32 v201, 0
    s_add_u32 m0, s33, 49024
    s_nop 0
    buffer_load_dwordx4 v22, s[44:47], s77 offen offset:128 lds
    s_add_u32 m0, s33, 53248
    s_nop 0
    buffer_load_dwordx4 v9, s[48:51], s77 offen lds
    v_mov_b32 v202, 0
    v_mov_b32 v203, 0
    v_mov_b32 v204, 0
    v_mov_b32 v205, 0
    v_mov_b32 v206, 0
    v_mov_b32 v207, 0
    v_mov_b32 v208, 0
    v_mov_b32 v209, 0
    s_load_dword s94, s[16:17], s53 offset:0x80
    s_load_dword s94, s[16:17], s53 offset:0xc0
    s_load_dword s94, s[16:17], s53 offset:0x100
    s_load_dword s94, s[16:17], s53 offset:0x140
    s_load_dword s94, s[16:17], s53 offset:0x180
    global_store_dwordx4 v86, v[36:39], s[26:27] offset:3072 sc1
    s_waitcnt vmcnt(18)
    s_barrier
    s_add_u32 m0, s79, 118784
    s_add_u32 s78, s78, 32768
    buffer_load_dwordx4 v20, s[36:39], s78 offen lds
    v_mov_b32 v210, 0
    v_mov_b32 v211, 0
    v_mov_b32 v212, 0
    v_mov_b32 v213, 0
    v_mov_b32 v214, 0
    v_mov_b32 v215, 0
    v_mov_b32 v216, 0
    v_mov_b32 v217, 0
    s_add_u32 m0, s79, 119808
    s_nop 0
    buffer_load_dwordx4 v21, s[36:39], s78 offen lds
    v_mov_b32 v218, 0
    v_mov_b32 v219, 0
    v_mov_b32 v220, 0
    v_mov_b32 v221, 0
    v_mov_b32 v222, 0
    v_mov_b32 v223, 0
    v_mov_b32 v224, 0
    v_mov_b32 v225, 0
    s_add_u32 m0, s33, 57344
    s_add_u32 s77, s77, 229376
    s_cmp_eq_u32 s77, 7340032
    s_cselect_b32 s77, 0, s77
    buffer_load_dwordx4 v22, s[40:43], s77 offen offset:0 lds
    v_mov_b32 v226, 0
    v_mov_b32 v227, 0
    v_mov_b32 v228, 0
    v_mov_b32 v229, 0
    v_mov_b32 v230, 0
    v_mov_b32 v231, 0
    v_mov_b32 v232, 0
    v_mov_b32 v233, 0
    s_add_u32 m0, s33, 61312
    s_nop 0
    buffer_load_dwordx4 v22, s[40:43], s77 offen offset:128 lds
    v_mov_b32 v234, 0
    v_mov_b32 v235, 0
    v_mov_b32 v236, 0
    v_mov_b32 v237, 0
    v_mov_b32 v238, 0
    v_mov_b32 v239, 0
    v_mov_b32 v240, 0
    v_mov_b32 v241, 0
    s_add_u32 m0, s33, 65536
    s_nop 0
    buffer_load_dwordx4 v22, s[44:47], s77 offen offset:0 lds
    v_mov_b32 v242, 0
    v_mov_b32 v243, 0
    v_mov_b32 v244, 0
    v_mov_b32 v245, 0
    v_mov_b32 v246, 0
    v_mov_b32 v247, 0
    v_mov_b32 v248, 0
    v_mov_b32 v249, 0
    s_add_u32 m0, s33, 69504
    s_nop 0
    buffer_load_dwordx4 v22, s[44:47], s77 offen offset:128 lds
    s_add_u32 m0, s33, 73728
    s_nop 0
    buffer_load_dwordx4 v9, s[48:51], s77 offen lds
    v_mov_b32 v250, 0
    v_mov_b32 v251, 0
    v_mov_b32 v252, 0
    v_mov_b32 v253, 0
    v_mov_b32 v254, 0
    v_mov_b32 v255, 0
    s_load_dword s94, s[16:17], s53 offset:0x1c0
    s_load_dword s94, s[18:19], s53 offset:0x0
    s_load_dword s94, s[18:19], s53 offset:0x40
    s_load_dword s94, s[18:19], s53 offset:0x80
    s_load_dword s94, s[18:19], s53 offset:0xc0
    s_waitcnt vmcnt(16)
    s_barrier
    s_add_u32 m0, s79, 135168
    s_add_u32 s72, s72, 128
    s_and_b32 s78, s72, 0x7ff
    buffer_load_dwordx4 v20, s[36:39], s78 offen lds
    v_mov_b32 v112, 0
    v_mov_b32 v113, 0
    v_mov_b32 v114, 0
    v_mov_b32 v115, 0
    v_mov_b32 v116, 0
    v_mov_b32 v117, 0
    v_mov_b32 v118, 0
    v_mov_b32 v119, 0
    s_add_u32 m0, s79, 136192
    s_nop 0
    buffer_load_dwordx4 v21, s[36:39], s78 offen lds
    v_mov_b32 v120, 0
    v_mov_b32 v121, 0
    v_mov_b32 v122, 0
    v_mov_b32 v123, 0
    v_mov_b32 v124, 0
    v_mov_b32 v125, 0
    v_mov_b32 v126, 0
    v_mov_b32 v127, 0
    s_add_u32 m0, s33, 77824
    s_add_u32 s77, s77, 229376
    buffer_load_dwordx4 v22, s[40:43], s77 offen offset:0 lds
    v_mov_b32 v128, 0
    v_mov_b32 v129, 0
    v_mov_b32 v130, 0
    v_mov_b32 v131, 0
    v_mov_b32 v132, 0
    v_mov_b32 v133, 0
    v_mov_b32 v134, 0
    v_mov_b32 v135, 0
    s_add_u32 m0, s33, 81792
    s_nop 0
    buffer_load_dwordx4 v22, s[40:43], s77 offen offset:128 lds
    v_mov_b32 v136, 0
    v_mov_b32 v137, 0
    v_mov_b32 v138, 0
    v_mov_b32 v139, 0
    v_mov_b32 v140, 0
    v_mov_b32 v141, 0
    v_mov_b32 v142, 0
    v_mov_b32 v143, 0
    s_add_u32 m0, s33, 86016
    s_nop 0
    buffer_load_dwordx4 v22, s[44:47], s77 offen offset:0 lds
    v_mov_b32 v144, 0
    v_mov_b32 v145, 0
    v_mov_b32 v146, 0
    v_mov_b32 v147, 0
    v_mov_b32 v148, 0
    v_mov_b32 v149, 0
    v_mov_b32 v150, 0
    v_mov_b32 v151, 0
    s_add_u32 m0, s33, 89984
    s_nop 0
    buffer_load_dwordx4 v22, s[44:47], s77 offen offset:128 lds
    s_add_u32 m0, s33, 94208
    s_nop 0
    buffer_load_dwordx4 v9, s[48:51], s77 offen lds
    s_load_dword s94, s[18:19], s53 offset:0x100
    s_load_dword s94, s[18:19], s53 offset:0x140
    s_load_dword s94, s[18:19], s53 offset:0x180
    s_load_dword s94, s[18:19], s53 offset:0x1c0
    s_add_u32 s52, s52, 0x100000
    s_load_dword s94, s[10:11], s52 offset:0x0
    s_waitcnt vmcnt(30)
    s_movk_i32 s98, 0x4000
L_tokB_chk:
    v_readfirstlane_b32 s100, v18
    v_readfirstlane_b32 s101, v19
    s_nop 1
    s_cmp_lg_u32 s100, 0
    s_cbranch_scc1 L_tokB_ok
    s_sub_u32 s98, s98, 1
    s_cbranch_scc1 L_tokB_ok
    s_sleep 1
    global_load_dwordx2 v[18:19], v87, s[24:25] sc1
    s_waitcnt vmcnt(0)
    s_branch L_tokB_chk
L_tokB_ok:
    s_waitcnt vmcnt(14)
    s_waitcnt vmcnt(15)
    s_barrier
    s_add_u32 m0, s79, 137216
    s_add_u32 s78, s78, 32768
    buffer_load_dwordx4 v20, s[36:39], s78 offen lds
    s_add_u32 m0, s79, 138240
    s_nop 0
    buffer_load_dwordx4 v21, s[36:39], s78 offen lds
    s_add_u32 m0, s33, 16384
    s_add_u32 s77, s77, 229376
    s_cmp_eq_u32 s77, 7340032
    s_cselect_b32 s77, 0, s77
    buffer_load_dwordx4 v22, s[40:43], s77 offen offset:0 lds
    s_add_u32 m0, s33, 20352
    s_nop 0
    buffer_load_dwordx4 v22, s[40:43], s77 offen offset:128 lds
    s_add_u32 m0, s33, 24576
    s_nop 0
    buffer_load_dwordx4 v22, s[44:47], s77 offen offset:0 lds
    s_add_u32 m0, s33, 28544
    s_nop 0
    buffer_load_dwordx4 v22, s[44:47], s77 offen offset:128 lds
    s_add_u32 m0, s33, 32768
    s_nop 0
    buffer_load_dwordx4 v9, s[48:51], s77 offen lds
    s_load_dword s94, s[10:11], s52 offset:0x40
    s_load_dword s94, s[10:11], s52 offset:0x80
    s_load_dword s94, s[10:11], s52 offset:0xc0
    s_load_dword s94, s[10:11], s52 offset:0x100
    s_load_dword s94, s[10:11], s52 offset:0x140
    s_cmp_lg_u32 s4, 0
    s_cbranch_scc1 L_fLN
    s_lshl_b32 s91, s28, 4
    s_add_u32 s91, s91, s29
    s_lshl_b32 s91, s91, 7
    s_add_u32 s91, s91, 0x1e80000
    v_mov_b32 v24, s91
    v_mov_b32 v26, s100
    v_mov_b32 v27, s101
    s_mov_b64 exec, 1
    global_store_dwordx2 v24, v[26:27], s[26:27] sc1
    s_mov_b64 exec, -1
L_fLN:
    s_waitcnt vmcnt(14)
    s_barrier
    s_mov_b64 exec, 0
    s_cmp_eq_u32 s4, 0
    s_cbranch_scc1 L_pad4
    s_cmp_eq_u32 s4, 1
    s_cbranch_scc1 L_pad10
    s_cmp_eq_u32 s4, 2
    s_cbranch_scc1 L_pad11
    s_cmp_eq_u32 s4, 3
    s_cbranch_scc1 L_pad12
L_vret2:
    s_mov_b64 exec, -1
    s_load_dword s94, s[10:11], s52 offset:0x180
    s_load_dword s94, s[10:11], s52 offset:0x1c0
    s_load_dword s94, s[10:11], s52 offset:0x80000
    s_load_dword s94, s[10:11], s52 offset:0x80040
    s_load_dword s94, s[10:11], s52 offset:0x80080
    s_waitcnt vmcnt(7)
    s_barrier
    s_add_u32 m0, s79, 98304
    s_add_u32 s72, s72, 128
    s_and_b32 s78, s72, 0x7ff
    buffer_load_dwordx4 v20, s[36:39], s78 offen lds
    s_add_u32 m0, s79, 99328
    s_nop 0
    buffer_load_dwordx4 v21, s[36:39], s78 offen lds
    s_add_u32 m0, s33, 36864
    s_add_u32 s77, s77, 229376
    buffer_load_dwordx4 v22, s[40:43], s77 offen offset:0 lds
    s_add_u32 m0, s33, 40832
    s_nop 0
    buffer_load_dwordx4 v22, s[40:43], s77 offen offset:128 lds
    s_add_u32 m0, s33, 45056
    s_nop 0
    buffer_load_dwordx4 v22, s[44:47], s77 offen offset:0 lds
    s_add_u32 m0, s33, 49024
    s_nop 0
    buffer_load_dwordx4 v22, s[44:47], s77 offen offset:128 lds
    s_add_u32 m0, s33, 53248
    s_nop 0
    buffer_load_dwordx4 v9, s[48:51], s77 offen lds
    s_add_u32 m0, s79, 100352
    s_add_u32 s78, s78, 32768
    buffer_load_dwordx4 v20, s[36:39], s78 offen lds
    s_add_u32 m0, s79, 101376
    s_nop 0
    buffer_load_dwordx4 v21, s[36:39], s78 offen lds
    s_add_u32 m0, s33, 57344
    s_add_u32 s77, s77, 229376
    s_cmp_eq_u32 s77, 7340032
    s_cselect_b32 s77, 0, s77
    buffer_load_dwordx4 v22, s[40:43], s77 offen offset:0 lds
    s_load_dword s94, s[10:11], s52 offset:0x800c0
    s_load_dword s94, s[10:11], s52 offset:0x80100
    s_load_dword s94, s[10:11], s52 offset:0x80140
    s_load_dword s94, s[10:11], s52 offset:0x80180
    s_load_dword s94, s[10:11], s52 offset:0x801c0
    s_waitcnt vmcnt(10)
    s_barrier
    s_add_u32 m0, s33, 61312
    s_nop 0
    buffer_load_dwordx4 v22, s[40:43], s77 offen offset:128 lds
    s_add_u32 m0, s33, 65536
    s_nop 0
    buffer_load_dwordx4 v22, s[44:47], s77 offen offset:0 lds
    s_add_u32 m0, s33, 69504
    s_nop 0
    buffer_load_dwordx4 v22, s[44:47], s77 offen offset:128 lds
    s_add_u32 m0, s33, 73728
    s_nop 0
    buffer_load_dwordx4 v9, s[48:51], s77 offen lds
    s_add_u32 m0, s79, 116736
    s_add_u32 s72, s72, 128
    s_and_b32 s78, s72, 0x7ff
    buffer_load_dwordx4 v20, s[36:39], s78 offen lds
    s_add_u32 m0, s79, 117760
    s_nop 0
    buffer_load_dwordx4 v21, s[36:39], s78 offen lds
    s_add_u32 m0, s33, 77824
    s_add_u32 s77, s77, 229376
    buffer_load_dwordx4 v22, s[40:43], s77 offen offset:0 lds
    s_add_u32 m0, s33, 81792
    s_nop 0
    buffer_load_dwordx4 v22, s[40:43], s77 offen offset:128 lds
    s_add_u32 m0, s33, 86016
    s_nop 0
    buffer_load_dwordx4 v22, s[44:47], s77 offen offset:0 lds
    s_add_u32 m0, s33, 89984
    s_nop 0
    buffer_load_dwordx4 v22, s[44:47], s77 offen offset:128 lds
    s_add_u32 s52, s52, 0x100000
    s_load_dword s94, s[10:11], s52 offset:0x0
    s_load_dword s94, s[10:11], s52 offset:0x40
    s_load_dword s94, s[10:11], s52 offset:0x80
    s_load_dword s94, s[10:11], s52 offset:0xc0
    s_load_dword s94, s[10:11], s52 offset:0x100
    s_waitcnt vmcnt(13)
    s_barrier
    s_add_u32 m0, s33, 94208
    s_nop 0
    buffer_load_dwordx4 v9, s[48:51], s77 offen lds
    s_add_u32 m0, s79, 118784
    s_add_u32 s78, s78, 32768
    buffer_load_dwordx4 v20, s[36:39], s78 offen lds
    s_add_u32 m0, s79, 119808
    s_nop 0
    buffer_load_dwordx4 v21, s[36:39], s78 offen lds
    s_add_u32 m0, s33, 16384
    s_add_u32 s77, s77, 229376
    s_cmp_eq_u32 s77, 7340032
    s_cselect_b32 s77, 0, s77
    buffer_load_dwordx4 v22, s[40:43], s77 offen offset:0 lds
    s_add_u32 m0, s33, 20352
    s_nop 0
    buffer_load_dwordx4 v22, s[40:43], s77 offen offset:128 lds
    s_add_u32 m0, s33, 24576
    s_nop 0
    buffer_load_dwordx4 v22, s[44:47], s77 offen offset:0 lds
    s_add_u32 m0, s33, 28544
    s_nop 0
    buffer_load_dwordx4 v22, s[44:47], s77 offen offset:128 lds
    s_add_u32 m0, s33, 32768
    s_nop 0
    buffer_load_dwordx4 v9, s[48:51], s77 offen lds
    s_load_dword s94, s[10:11], s52 offset:0x140
    s_load_dword s94, s[10:11], s52 offset:0x180
    s_load_dword s94, s[10:11], s52 offset:0x1c0
    s_add_u32 s53, s53, 0x1c0000
    s_load_dword s94, s[16:17], s53 offset:0x0
    s_load_dword s94, s[16:17], s53 offset:0x40
    s_waitcnt vmcnt(14)
    s_barrier
    s_add_u32 m0, s79, 135168
    s_add_u32 s72, s72, 128
    s_and_b32 s78, s72, 0x7ff
    buffer_load_dwordx4 v20, s[36:39], s78 offen lds
    s_add_u32 m0, s79, 136192
    s_nop 0
    buffer_load_dwordx4 v21, s[36:39], s78 offen lds
    s_add_u32 m0, s33, 36864
    s_add_u32 s77, s77, 229376
    buffer_load_dwordx4 v22, s[40:43], s77 offen offset:0 lds
    s_add_u32 m0, s33, 40832
    s_nop 0
    buffer_load_dwordx4 v22, s[40:43], s77 offen offset:128 lds
    s_add_u32 m0, s33, 45056
    s_nop 0
    buffer_load_dwordx4 v22, s[44:47], s77 offen offset:0 lds
    s_add_u32 m0, s33, 49024
    s_nop 0
    buffer_load_dwordx4 v22, s[44:47], s77 offen offset:128 lds
    s_add_u32 m0, s33, 53248
    s_nop 0
    buffer_load_dwordx4 v9, s[48:51], s77 offen lds
    s_load_dword s94, s[16:17], s53 offset:0x80
    s_load_dword s94, s[16:17], s53 offset:0xc0
    s_load_dword s94, s[16:17], s53 offset:0x100
    s_load_dword s94, s[16:17], s53 offset:0x140
    s_load_dword s94, s[16:17], s53 offset:0x180
    s_waitcnt vmcnt(14)
    s_barrier
    s_add_u32 m0, s79, 137216
    s_add_u32 s78, s78, 32768
    buffer_load_dwordx4 v20, s[36:39], s78 offen lds
    s_add_u32 m0, s79, 138240
    s_nop 0
    buffer_load_dwordx4 v21, s[36:39], s78 offen lds
    s_add_u32 m0, s33, 57344
    s_add_u32 s77, s77, 229376
    s_cmp_eq_u32 s77, 7340032
    s_cselect_b32 s77, 0, s77
    buffer_load_dwordx4 v22, s[40:43], s77 offen offset:0 lds
    s_add_u32 m0, s33, 61312
    s_nop 0
    buffer_load_dwordx4 v22, s[40:43], s77 offen offset:128 lds
    s_add_u32 m0, s33, 65536
    s_nop 0
    buffer_load_dwordx4 v22, s[44:47], s77 offen offset:0 lds
    s_add_u32 m0, s33, 69504
    s_nop 0
    buffer_load_dwordx4 v22, s[44:47], s77 offen offset:128 lds
    s_add_u32 m0, s33, 73728
    s_nop 0
    buffer_load_dwordx4 v9, s[48:51], s77 offen lds
    s_load_dword s94, s[16:17], s53 offset:0x1c0
    s_load_dword s94, s[18:19], s53 offset:0x0
    s_load_dword s94, s[18:19], s53 offset:0x40
    s_load_dword s94, s[18:19], s53 offset:0x80
    s_load_dword s94, s[18:19], s53 offset:0xc0
    s_sub_u32 s91, s28, s6
    s_max_i32 s91, s91, 0
    s_lshl_b32 s91, s91, 4
    s_cmp_lg_u32 s5, 0
    s_cselect_b32 s91, s29, s91
    s_cselect_b32 s92, 11, 7
    s_lshl_b32 s91, s91, 7
    s_add_u32 s91, s91, 0x1e80000
    v_lshlrev_b32 v87, s92, v1
    v_add_u32 v87, s91, v87
    s_mov_b64 exec, 0xffff
    global_load_dwordx2 v[18:19], v87, s[26:27] sc1
    s_mov_b64 exec, -1
    s_waitcnt vmcnt(15)
    s_barrier
    s_add_u32 m0, s79, 98304
    s_add_u32 s72, s72, 128
    s_and_b32 s78, s72, 0x7ff
    buffer_load_dwordx4 v20, s[36:39], s78 offen lds
    s_add_u32 m0, s79, 99328
    s_nop 0
    buffer_load_dwordx4 v21, s[36:39], s78 offen lds
    s_add_u32 m0, s33, 77824
    s_add_u32 s77, s77, 229376
    buffer_load_dwordx4 v22, s[40:43], s77 offen offset:0 lds
    s_add_u32 m0, s33, 81792
    s_nop 0
    buffer_load_dwordx4 v22, s[40:43], s77 offen offset:128 lds
    s_add_u32 m0, s33, 86016
    s_nop 0
    buffer_load_dwordx4 v22, s[44:47], s77 offen offset:0 lds
    s_add_u32 m0, s33, 89984
    s_nop 0
    buffer_load_dwordx4 v22, s[44:47], s77 offen offset:128 lds
    s_add_u32 m0, s33, 94208
    s_nop 0
    buffer_load_dwordx4 v9, s[48:51], s77 offen lds
    s_load_dword s94, s[18:19], s53 offset:0x100
    s_load_dword s94, s[18:19], s53 offset:0x140
    s_load_dword s94, s[18:19], s53 offset:0x180
    s_load_dword s94, s[18:19], s53 offset:0x1c0
    s_load_dword s94, s[10:11], s52 offset:0x80000
    s_waitcnt vmcnt(7)
    s_mov_b64 exec, 0xffff
    s_movk_i32 s98, 0x4000
L_pLN_chk:
    v_cmp_ne_u64 vcc, s[100:101], v[18:19]
    s_nop 1
    s_cmp_eq_u64 vcc, 0
    s_cbranch_scc1 L_pLN_ok
    s_sub_u32 s98, s98, 1
    s_cbranch_scc1 L_pLN_ok
    s_sleep 1
    global_load_dwordx2 v[18:19], v87, s[26:27] sc1
    s_waitcnt vmcnt(0)
    s_branch L_pLN_chk
L_pLN_ok:
    s_mov_b64 exec, -1
    s_waitcnt vmcnt(15)
    s_barrier
    s_mul_i32 s91, s29, 20480
    s_mul_i32 s92, s4, 320
    s_add_u32 s91, s91, s92
    s_add_u32 s91, s91, 0x1e10000
    v_lshrrev_b32 v24, 2, v1
    v_mul_u32_u24 v24, 1280, v24
    v_and_b32 v25, 3, v1
    v_lshlrev_b32 v25, 4, v25
    v_add3_u32 v24, v24, v25, s91
    global_load_dwordx4 v[88:91], v24, s[26:27] offset:0
    global_load_dwordx4 v[92:95], v24, s[26:27] offset:64
    global_load_dwordx4 v[96:99], v24, s[26:27] offset:128
    global_load_dwordx4 v[100:103], v24, s[26:27] offset:192
    global_load_dwordx4 v[104:107], v24, s[26:27] offset:256
    s_add_u32 s92, s92, 159744
    v_lshrrev_b32 v37, 4, v1
    v_add_u32 v25, s92, v25
    v_lshl_add_u32 v36, v37, 2, v25
    v_lshl_add_u32 v25, v37, 6, v25
    s_lshl_b32 s91, s28, 2
    s_add_u32 s91, s91, s4
    s_lshl_b32 s91, s91, 8
    s_add_u32 s91, s91, 0x1e00000
    v_and_b32 v27, 31, v1
    v_lshl_add_u32 v26, v27, 3, s91
    global_load_dwordx2 v[28:29], v26, s[26:27]
    s_lshl_b32 s91, s4, 9
    s_add_u32 s91, s91, 161024
    v_lshl_add_u32 v27, v27, 4, s91
    s_add_u32 m0, s79, 100352
    s_add_u32 s78, s78, 32768
    buffer_load_dwordx4 v20, s[36:39], s78 offen lds
    s_add_u32 m0, s79, 101376
    s_nop 0
    buffer_load_dwordx4 v21, s[36:39], s78 offen lds
    s_add_u32 m0, s33, 16384
    s_add_u32 s77, s77, 229376
    s_cmp_eq_u32 s77, 7340032
    s_cselect_b32 s77, 0, s77
    buffer_load_dwordx4 v22, s[40:43], s77 offen offset:0 lds
    s_add_u32 m0, s33, 20352
    s_nop 0
    buffer_load_dwordx4 v22, s[40:43], s77 offen offset:128 lds
    s_add_u32 m0, s33, 24576
    s_nop 0
    buffer_load_dwordx4 v22, s[44:47], s77 offen offset:0 lds
    s_add_u32 m0, s33, 28544
    s_nop 0
    buffer_load_dwordx4 v22, s[44:47], s77 offen offset:128 lds
    s_add_u32 m0, s33, 32768
    s_nop 0
    buffer_load_dwordx4 v9, s[48:51], s77 offen lds
    s_load_dword s94, s[10:11], s52 offset:0x80040
    s_load_dword s94, s[10:11], s52 offset:0x80080
    s_load_dword s94, s[10:11], s52 offset:0x800c0
    s_load_dword s94, s[10:11], s52 offset:0x80100
    s_load_dword s94, s[10:11], s52 offset:0x80140
    s_waitcnt vmcnt(21)
    s_barrier
    s_add_u32 m0, s79, 116736
    s_add_u32 s72, s72, 128
    s_and_b32 s78, s72, 0x7ff
    buffer_load_dwordx4 v20, s[36:39], s78 offen lds
    s_add_u32 m0, s79, 117760
    s_nop 0
    buffer_load_dwordx4 v21, s[36:39], s78 offen lds
    s_add_u32 m0, s33, 36864
    s_add_u32 s77, s77, 229376
    buffer_load_dwordx4 v22, s[40:43], s77 offen offset:0 lds
L_pad8:
    s_cbranch_execz L_vret0
    s_add_u32 m0, s33, 40832
    s_nop 0
    buffer_load_dwordx4 v22, s[40:43], s77 offen offset:128 lds
    s_add_u32 m0, s33, 45056
    s_nop 0
    buffer_load_dwordx4 v22, s[44:47], s77 offen offset:0 lds
    s_add_u32 m0, s33, 49024
    s_nop 0
    buffer_load_dwordx4 v22, s[44:47], s77 offen offset:128 lds
    s_add_u32 m0, s33, 53248
    s_nop 0
    buffer_load_dwordx4 v9, s[48:51], s77 offen lds
    s_load_dword s94, s[10:11], s52 offset:0x80180
    s_load_dword s94, s[10:11], s52 offset:0x801c0
    s_add_u32 s52, s52, 0x100000
    s_load_dword s94, s[10:11], s52 offset:0x0
    s_load_dword s94, s[10:11], s52 offset:0x40
    s_load_dword s94, s[10:11], s52 offset:0x80
    s_waitcnt vmcnt(20)
    s_barrier
    s_add_u32 m0, s79, 118784
    s_add_u32 s78, s78, 32768
    buffer_load_dwordx4 v20, s[36:39], s78 offen lds
    s_waitcnt vmcnt(15)
    v_rcp_f32 v30, v29
    v_mul_f32 v32, -1.0, v28
    v_mul_f32 v35, v29, v29
    v_fma_f32 v31, -v29, v30, 1.0
    v_fma_f32 v30, v31, v30, v30
    v_mul_f32 v33, 0xc0135761, v30
    v_mul_f32 v31, v30, v30
    s_add_u32 m0, s79, 119808
    s_nop 0
    buffer_load_dwordx4 v21, s[36:39], s78 offen lds
    v_mul_f32 v31, v31, v30
    v_mul_f32 v34, 0xbdd2d3e8, v31
    ds_write_b128 v27, v[32:35]
    v_permlane16_swap_b32 v88, v92
    v_permlane16_swap_b32 v96, v100
    v_permlane16_swap_b32 v89, v93
    v_permlane16_swap_b32 v97, v101
    v_permlane16_swap_b32 v90, v94
    v_permlane16_swap_b32 v98, v102
    s_add_u32 m0, s33, 57344
    s_add_u32 s77, s77, 229376
    s_cmp_eq_u32 s77, 7340032
    s_cselect_b32 s77, 0, s77
    buffer_load_dwordx4 v22, s[40:43], s77 offen offset:0 lds
    v_permlane16_swap_b32 v91, v95
    v_permlane16_swap_b32 v99, v103
    v_permlane16_swap_b32 v104, v105
    v_permlane16_swap_b32 v106, v107
    v_add_f32 v88, v88, v92
    v_add_f32 v96, v96, v100
    v_add_f32 v89, v89, v93
    v_add_f32 v97, v97, v101
    s_add_u32 m0, s33, 61312
    s_nop 0
    buffer_load_dwordx4 v22, s[40:43], s77 offen offset:128 lds
    v_add_f32 v90, v90, v94
    v_add_f32 v98, v98, v102
    v_add_f32 v91, v91, v95
    v_add_f32 v99, v99, v103
    v_add_f32 v104, v104, v105
    v_add_f32 v106, v106, v107
    s_nop 0
    v_permlane32_swap_b32 v88, v96
    v_permlane32_swap_b32 v89, v97
    s_add_u32 m0, s33, 65536
    s_nop 0
    buffer_load_dwordx4 v22, s[44:47], s77 offen offset:0 lds
    v_permlane32_swap_b32 v90, v98
    v_permlane32_swap_b32 v91, v99
    v_permlane32_swap_b32 v104, v106
    v_add_f32 v88, v88, v96
    v_add_f32 v89, v89, v97
    v_add_f32 v90, v90, v98
    v_add_f32 v91, v91, v99
    v_add_f32 v104, v104, v106
    s_add_u32 m0, s33, 69504
    s_nop 0
    buffer_load_dwordx4 v22, s[44:47], s77 offen offset:128 lds
    s_add_u32 m0, s33, 73728
    s_nop 0
    buffer_load_dwordx4 v9, s[48:51], s77 offen lds
    v_add_f32_dpp v88, v88, v88 row_ror:8 row_mask:0xf bank_mask:0xf
    v_add_f32_dpp v89, v89, v89 row_ror:8 row_mask:0xf bank_mask:0xf
    v_add_f32_dpp v90, v90, v90 row_ror:8 row_mask:0xf bank_mask:0xf
    v_add_f32_dpp v91, v91, v91 row_ror:8 row_mask:0xf bank_mask:0xf
    v_add_f32_dpp v104, v104, v104 row_ror:8 row_mask:0xf bank_mask:0xf
    v_add_f32_dpp v88, v88, v88 row_ror:4 row_mask:0xf bank_mask:0xf
    v_add_f32_dpp v89, v89, v89 row_ror:4 row_mask:0xf bank_mask:0xf
    v_add_f32_dpp v90, v90, v90 row_ror:4 row_mask:0xf bank_mask:0xf
    s_load_dword s94, s[10:11], s52 offset:0xc0
    s_load_dword s94, s[10:11], s52 offset:0x100
    s_load_dword s94, s[10:11], s52 offset:0x140
    s_load_dword s94, s[10:11], s52 offset:0x180
    s_load_dword s94, s[10:11], s52 offset:0x1c0
    s_waitcnt vmcnt(14)
    s_barrier
    s_mov_b32 s36, s26
    s_mov_b32 s37, s27
    s_mov_b32 s38, 0x400000
    s_mov_b32 s39, 0x20000
    s_add_u32 m0, s33, 77824
    s_add_u32 s77, s77, 229376
    buffer_load_dwordx4 v22, s[40:43], s77 offen offset:0 lds
    v_add_f32_dpp v91, v91, v91 row_ror:4 row_mask:0xf bank_mask:0xf
    v_add_f32_dpp v104, v104, v104 row_ror:4 row_mask:0xf bank_mask:0xf
    s_mov_b32 s92, 0x000f000f
    s_mov_b32 s93, s92
    s_mov_b64 exec, s[92:93]
    ds_write_b128 v25, v[88:91]
    ds_write_b32 v36, v104 offset:256
    s_mov_b64 exec, -1
    v_mov_b32 v88, 0
    v_mov_b32 v89, 0
    v_mov_b32 v90, 0
    v_mov_b32 v91, 0
    v_mov_b32 v92, 0
    v_mov_b32 v93, 0
    v_mov_b32 v94, 0
    v_mov_b32 v95, 0
    s_add_u32 m0, s33, 81792
    s_nop 0
    buffer_load_dwordx4 v22, s[40:43], s77 offen offset:128 lds
    s_add_u32 m0, s33, 86016
    s_nop 0
    buffer_load_dwordx4 v22, s[44:47], s77 offen offset:0 lds
    v_mov_b32 v96, 0
    v_mov_b32 v97, 0
    v_mov_b32 v98, 0
    v_mov_b32 v99, 0
    v_mov_b32 v100, 0
    v_mov_b32 v101, 0
    v_mov_b32 v102, 0
    v_mov_b32 v103, 0
    s_add_u32 m0, s33, 89984
    s_nop 0
    buffer_load_dwordx4 v22, s[44:47], s77 offen offset:128 lds
    v_mov_b32 v104, 0
    v_mov_b32 v105, 0
    v_mov_b32 v106, 0
    v_mov_b32 v107, 0
    v_mov_b32 v108, 0
    v_mov_b32 v109, 0
    v_mov_b32 v110, 0
    v_mov_b32 v111, 0
    s_add_u32 m0, s33, 94208
    s_nop 0
    buffer_load_dwordx4 v9, s[48:51], s77 offen lds
    s_add_u32 m0, s79, 135168
    s_mov_b32 s78, 0
    buffer_load_dwordx4 v20, s[36:39], s78 offen sc1 lds
    s_add_u32 m0, s79, 136192
    s_nop 0
    buffer_load_dwordx4 v21, s[36:39], s78 offen sc1 lds
    s_waitcnt vmcnt(14)
    s_barrier
    s_lshl_b32 s85, s29, 7
    s_add_u32 s86, s85, 4096
    s_add_u32 s87, s85, 128
    s_and_b32 s87, s87, 0x7ff
    s_add_u32 s87, s87, 5120
    s_add_u32 s40, s10, s85
    s_addc_u32 s41, s11, 0
    s_add_u32 s44, s10, s86
    s_addc_u32 s45, s11, 0
    s_add_u32 s48, s16, s87
    s_addc_u32 s49, s17, 0
    s_add_u32 s52, s18, s87
    s_addc_u32 s53, s19, 0
    s_sub_u32 s42, 6291456, s85
    s_sub_u32 s46, 6291456, s86
    s_mov_b32 s50, s54
    s_add_u32 m0, s79, 137216
    s_mov_b32 s78, 32768
    buffer_load_dwordx4 v20, s[36:39], s78 offen sc1 lds
    s_add_u32 m0, s79, 138240
    s_nop 0
    buffer_load_dwordx4 v21, s[36:39], s78 offen sc1 lds
    s_add_u32 m0, s81, 151552
    s_mov_b32 s78, 0
    s_mov_b64 exec, 0xffffffff
    buffer_load_dwordx4 v3, s[36:39], s78 offen sc1 lds
    s_mov_b64 exec, -1
    s_add_u32 m0, s33, 16384
    s_mov_b32 s76, 0
    buffer_load_dwordx4 v23, s[40:43], s76 offen offset:0 lds
    s_add_u32 m0, s33, 18432
    s_nop 0
    buffer_load_dwordx4 v23, s[40:43], s76 offen offset:2048 lds
    s_add_u32 m0, s33, 24576
    s_nop 0
    buffer_load_dwordx4 v23, s[44:47], s76 offen offset:0 lds
    s_add_u32 m0, s33, 28672
    s_mov_b32 s77, 0
    buffer_load_dwordx4 v22, s[48:51], s77 offen offset:0 lds
    s_add_u32 m0, s33, 32768
    s_nop 0
    buffer_load_dwordx4 v22, s[52:55], s77 offen offset:0 lds
    s_waitcnt vmcnt(15)
    s_barrier
    s_add_u32 m0, s79, 98304
    s_mov_b32 s78, 128
    buffer_load_dwordx4 v20, s[36:39], s78 offen sc1 lds
    s_add_u32 m0, s79, 99328
    s_nop 0
    buffer_load_dwordx4 v21, s[36:39], s78 offen sc1 lds
    s_add_u32 m0, s33, 36864
    s_mov_b32 s76, 196608
    buffer_load_dwordx4 v23, s[40:43], s76 offen offset:0 lds
    s_add_u32 m0, s33, 38912
    s_nop 0
    buffer_load_dwordx4 v23, s[40:43], s76 offen offset:2048 lds
    s_add_u32 m0, s33, 45056
    s_nop 0
    buffer_load_dwordx4 v23, s[44:47], s76 offen offset:0 lds
    s_add_u32 m0, s33, 49152
    s_mov_b32 s77, 229376
    buffer_load_dwordx4 v22, s[48:51], s77 offen offset:0 lds
    s_add_u32 m0, s33, 53248
    s_nop 0
    buffer_load_dwordx4 v22, s[52:55], s77 offen offset:0 lds
    s_waitcnt vmcnt(17)
    s_barrier
    s_add_u32 m0, s79, 100352
    s_mov_b32 s78, 32896
    buffer_load_dwordx4 v20, s[36:39], s78 offen sc1 lds
    s_add_u32 m0, s79, 101376
    s_nop 0
    buffer_load_dwordx4 v21, s[36:39], s78 offen sc1 lds
    s_add_u32 m0, s81, 114688
    s_mov_b32 s78, 128
    s_mov_b64 exec, 0xffffffff
    buffer_load_dwordx4 v3, s[36:39], s78 offen sc1 lds
    s_mov_b64 exec, -1
    s_add_u32 m0, s33, 57344
    s_mov_b32 s76, 393216
    buffer_load_dwordx4 v23, s[40:43], s76 offen offset:0 lds
    s_add_u32 m0, s33, 59392
    s_nop 0
    buffer_load_dwordx4 v23, s[40:43], s76 offen offset:2048 lds
    s_add_u32 m0, s33, 65536
    s_nop 0
    buffer_load_dwordx4 v23, s[44:47], s76 offen offset:0 lds
    s_add_u32 m0, s33, 69632
    s_mov_b32 s77, 458752
    buffer_load_dwordx4 v22, s[48:51], s77 offen offset:0 lds
    s_add_u32 m0, s33, 73728
    s_nop 0
    buffer_load_dwordx4 v22, s[52:55], s77 offen offset:0 lds
    s_waitcnt lgkmcnt(0)
    s_waitcnt vmcnt(15)
    s_barrier
    s_setprio 1
    v_add_u32 v14, s80, v16
    v_add_u32 v15, s80, v17
    s_add_u32 s84, s80, s95
    v_add_u32 v18, s84, v16
    v_add_u32 v19, s84, v17
    s_add_u32 s80, s80, 18432
    s_cmp_ge_u32 s80, 153600
    s_cselect_b32 s84, 55296, 0
    s_sub_u32 s80, s80, s84
    ds_read_b64_tr_b16 v[64:65], v4 offset:4096
    ds_read_b64_tr_b16 v[66:67], v4 offset:4608
    ds_read_b128 v[24:27], v14 offset:0
    ds_read_b128 v[28:31], v14 offset:2048
    ds_read_b128 v[32:35], v14 offset:4096
    ds_read_b128 v[36:39], v14 offset:6144
    ds_read_b64_tr_b16 v[68:69], v5 offset:4096
    ds_read_b64_tr_b16 v[70:71], v5 offset:4608
    ds_read_b64_tr_b16 v[72:73], v4 offset:8192
    ds_read_b64_tr_b16 v[74:75], v4 offset:8704
    ds_read_b128 v[56:59], v18
    s_mov_b32 s34, 7
.p2align 6
L_p2:
    s_waitcnt lgkmcnt(8)
    v_mfma_f32_16x16x32_bf16 v[88:91], v[64:67], v[24:27], v[88:91]
    ds_read_b64_tr_b16 v[76:77], v5 offset:8192
    s_waitcnt lgkmcnt(8)
    v_mfma_f32_16x16x32_bf16 v[92:95], v[64:67], v[28:31], v[92:95]
    ds_read_b64_tr_b16 v[78:79], v5 offset:8704
    s_waitcnt lgkmcnt(8)
    v_mfma_f32_16x16x32_bf16 v[96:99], v[64:67], v[32:35], v[96:99]
    ds_read_b64_tr_b16 v[80:81], v4 offset:0
    s_waitcnt lgkmcnt(8)
    v_mfma_f32_16x16x32_bf16 v[100:103], v[64:67], v[36:39], v[100:103]
    ds_read_b64_tr_b16 v[82:83], v4 offset:512
    s_waitcnt lgkmcnt(4)
    v_mfma_f32_16x16x32_bf16 v[248:251], v[64:67], v[56:59], v[248:251]
    v_mfma_f32_16x16x32_bf16 v[104:107], v[68:71], v[24:27], v[104:107]
    ds_read_b64_tr_b16 v[64:65], v5 offset:0
    v_mfma_f32_16x16x32_bf16 v[108:111], v[68:71], v[28:31], v[108:111]
    v_mfma_f32_16x16x32_bf16 v[112:115], v[68:71], v[32:35], v[112:115]
    ds_read_b64_tr_b16 v[66:67], v5 offset:512
    v_mfma_f32_16x16x32_bf16 v[116:119], v[68:71], v[36:39], v[116:119]
    v_mfma_f32_16x16x32_bf16 v[120:123], v[24:27], v[72:75], v[120:123]
    ds_read_b64_tr_b16 v[68:69], v4 offset:12288
    v_mfma_f32_16x16x32_bf16 v[124:127], v[28:31], v[72:75], v[124:127]
    v_mfma_f32_16x16x32_bf16 v[128:131], v[32:35], v[72:75], v[128:131]
    ds_read_b64_tr_b16 v[70:71], v4 offset:12800
    v_mfma_f32_16x16x32_bf16 v[132:135], v[36:39], v[72:75], v[132:135]
    v_mfma_f32_16x16x32_bf16 v[252:255], v[56:59], v[72:75], v[252:255]
    s_waitcnt lgkmcnt(6)
    v_mfma_f32_16x16x32_bf16 v[136:139], v[24:27], v[76:79], v[136:139]
    ds_read_b64_tr_b16 v[72:73], v4 offset:16384
    v_mfma_f32_16x16x32_bf16 v[140:143], v[28:31], v[76:79], v[140:143]
    v_mfma_f32_16x16x32_bf16 v[144:147], v[32:35], v[76:79], v[144:147]
    ds_read_b64_tr_b16 v[74:75], v4 offset:16896
    v_mfma_f32_16x16x32_bf16 v[148:151], v[36:39], v[76:79], v[148:151]
    s_waitcnt lgkmcnt(6)
    v_mfma_f32_16x16x32_bf16 v[152:155], v[80:83], v[24:27], v[152:155]
    ds_read_b64_tr_b16 v[76:77], v5 offset:12288
    v_mfma_f32_16x16x32_bf16 v[156:159], v[80:83], v[28:31], v[156:159]
    v_mfma_f32_16x16x32_bf16 v[160:163], v[80:83], v[32:35], v[160:163]
    ds_read_b64_tr_b16 v[78:79], v5 offset:12800
    v_mfma_f32_16x16x32_bf16 v[164:167], v[80:83], v[36:39], v[164:167]
    s_waitcnt lgkmcnt(6)
    v_mfma_f32_16x16x32_bf16 v[168:171], v[64:67], v[24:27], v[168:171]
    ds_read_b64_tr_b16 v[80:81], v5 offset:16384
    v_mfma_f32_16x16x32_bf16 v[172:175], v[64:67], v[28:31], v[172:175]
    v_mfma_f32_16x16x32_bf16 v[176:179], v[64:67], v[32:35], v[176:179]
    ds_read_b64_tr_b16 v[82:83], v5 offset:16896
    v_mfma_f32_16x16x32_bf16 v[180:183], v[64:67], v[36:39], v[180:183]
    s_waitcnt lgkmcnt(6)
    v_mfma_f32_16x16x32_bf16 v[184:187], v[68:71], v[24:27], v[184:187]
    v_mfma_f32_16x16x32_bf16 v[188:191], v[68:71], v[28:31], v[188:191]
    v_mfma_f32_16x16x32_bf16 v[192:195], v[68:71], v[32:35], v[192:195]
    v_mfma_f32_16x16x32_bf16 v[196:199], v[68:71], v[36:39], v[196:199]
    s_waitcnt vmcnt(8) lgkmcnt(0)
    s_barrier
    v_mfma_f32_16x16x32_bf16 v[200:203], v[72:75], v[24:27], v[200:203]
    ds_read_b64_tr_b16 v[64:65], v4 offset:24576
    v_mfma_f32_16x16x32_bf16 v[204:207], v[72:75], v[28:31], v[204:207]
    ds_read_b64_tr_b16 v[66:67], v4 offset:25088
    v_mfma_f32_16x16x32_bf16 v[208:211], v[72:75], v[32:35], v[208:211]
    ds_read_b128 v[40:43], v15 offset:0
    v_mfma_f32_16x16x32_bf16 v[212:215], v[72:75], v[36:39], v[212:215]
    ds_read_b128 v[44:47], v15 offset:2048
    v_mfma_f32_16x16x32_bf16 v[216:219], v[76:79], v[24:27], v[216:219]
    ds_read_b128 v[48:51], v15 offset:4096
    v_mfma_f32_16x16x32_bf16 v[220:223], v[76:79], v[28:31], v[220:223]
    ds_read_b128 v[52:55], v15 offset:6144
    v_mfma_f32_16x16x32_bf16 v[224:227], v[76:79], v[32:35], v[224:227]
    ds_read_b64_tr_b16 v[68:69], v5 offset:24576
    v_mfma_f32_16x16x32_bf16 v[228:231], v[76:79], v[36:39], v[228:231]
    ds_read_b64_tr_b16 v[70:71], v5 offset:25088
    v_mfma_f32_16x16x32_bf16 v[232:235], v[80:83], v[24:27], v[232:235]
    ds_read_b64_tr_b16 v[72:73], v4 offset:28672
    v_mfma_f32_16x16x32_bf16 v[236:239], v[80:83], v[28:31], v[236:239]
    ds_read_b64_tr_b16 v[74:75], v4 offset:29184
    v_mfma_f32_16x16x32_bf16 v[240:243], v[80:83], v[32:35], v[240:243]
    ds_read_b128 v[60:63], v19
    v_mfma_f32_16x16x32_bf16 v[244:247], v[80:83], v[36:39], v[244:247]
    s_waitcnt lgkmcnt(8)
    v_mfma_f32_16x16x32_bf16 v[88:91], v[64:67], v[40:43], v[88:91]
    ds_read_b64_tr_b16 v[76:77], v5 offset:28672
    s_waitcnt lgkmcnt(8)
    v_mfma_f32_16x16x32_bf16 v[92:95], v[64:67], v[44:47], v[92:95]
    ds_read_b64_tr_b16 v[78:79], v5 offset:29184
    s_waitcnt lgkmcnt(8)
    v_mfma_f32_16x16x32_bf16 v[96:99], v[64:67], v[48:51], v[96:99]
    ds_read_b64_tr_b16 v[80:81], v4 offset:20480
    s_waitcnt lgkmcnt(8)
    v_mfma_f32_16x16x32_bf16 v[100:103], v[64:67], v[52:55], v[100:103]
    ds_read_b64_tr_b16 v[82:83], v4 offset:20992
    s_waitcnt lgkmcnt(4)
    v_mfma_f32_16x16x32_bf16 v[248:251], v[64:67], v[60:63], v[248:251]
    v_mfma_f32_16x16x32_bf16 v[104:107], v[68:71], v[40:43], v[104:107]
    ds_read_b64_tr_b16 v[64:65], v5 offset:20480
    v_mfma_f32_16x16x32_bf16 v[108:111], v[68:71], v[44:47], v[108:111]
    v_add_u32 v14, s80, v16
    v_mfma_f32_16x16x32_bf16 v[112:115], v[68:71], v[48:51], v[112:115]
    ds_read_b64_tr_b16 v[66:67], v5 offset:20992
    v_mfma_f32_16x16x32_bf16 v[116:119], v[68:71], v[52:55], v[116:119]
    v_add_u32 v15, s80, v17
    v_mfma_f32_16x16x32_bf16 v[120:123], v[40:43], v[72:75], v[120:123]
    ds_read_b64_tr_b16 v[68:69], v4 offset:32768
    v_mfma_f32_16x16x32_bf16 v[124:127], v[44:47], v[72:75], v[124:127]
    s_add_u32 s84, s80, s95
    v_mfma_f32_16x16x32_bf16 v[128:131], v[48:51], v[72:75], v[128:131]
    ds_read_b64_tr_b16 v[70:71], v4 offset:33280
    v_mfma_f32_16x16x32_bf16 v[132:135], v[52:55], v[72:75], v[132:135]
    v_add_u32 v18, s84, v16
    v_mfma_f32_16x16x32_bf16 v[252:255], v[60:63], v[72:75], v[252:255]
    s_waitcnt lgkmcnt(6)
    v_mfma_f32_16x16x32_bf16 v[136:139], v[40:43], v[76:79], v[136:139]
    ds_read_b64_tr_b16 v[72:73], v4 offset:36864
    v_mfma_f32_16x16x32_bf16 v[140:143], v[44:47], v[76:79], v[140:143]
    v_add_u32 v19, s84, v17
    v_mfma_f32_16x16x32_bf16 v[144:147], v[48:51], v[76:79], v[144:147]
    ds_read_b64_tr_b16 v[74:75], v4 offset:37376
    v_mfma_f32_16x16x32_bf16 v[148:151], v[52:55], v[76:79], v[148:151]
    s_add_u32 s80, s80, 18432
    s_waitcnt lgkmcnt(6)
    v_mfma_f32_16x16x32_bf16 v[152:155], v[80:83], v[40:43], v[152:155]
    ds_read_b64_tr_b16 v[76:77], v5 offset:32768
    v_mfma_f32_16x16x32_bf16 v[156:159], v[80:83], v[44:47], v[156:159]
    s_cmp_ge_u32 s80, 153600
    s_cselect_b32 s84, 55296, 0
    v_mfma_f32_16x16x32_bf16 v[160:163], v[80:83], v[48:51], v[160:163]
    ds_read_b64_tr_b16 v[78:79], v5 offset:33280
    v_mfma_f32_16x16x32_bf16 v[164:167], v[80:83], v[52:55], v[164:167]
    s_sub_u32 s80, s80, s84
    s_waitcnt lgkmcnt(6)
    v_mfma_f32_16x16x32_bf16 v[168:171], v[64:67], v[40:43], v[168:171]
    ds_read_b64_tr_b16 v[80:81], v5 offset:36864
    v_mfma_f32_16x16x32_bf16 v[172:175], v[64:67], v[44:47], v[172:175]
    v_mfma_f32_16x16x32_bf16 v[176:179], v[64:67], v[48:51], v[176:179]
    ds_read_b64_tr_b16 v[82:83], v5 offset:37376
    v_mfma_f32_16x16x32_bf16 v[180:183], v[64:67], v[52:55], v[180:183]
    s_waitcnt lgkmcnt(6)
    v_mfma_f32_16x16x32_bf16 v[184:187], v[68:71], v[40:43], v[184:187]
    v_mfma_f32_16x16x32_bf16 v[188:191], v[68:71], v[44:47], v[188:191]
    v_mfma_f32_16x16x32_bf16 v[192:195], v[68:71], v[48:51], v[192:195]
    v_mfma_f32_16x16x32_bf16 v[196:199], v[68:71], v[52:55], v[196:199]
    s_waitcnt vmcnt(0) lgkmcnt(0)
    s_barrier
    v_mfma_f32_16x16x32_bf16 v[200:203], v[72:75], v[40:43], v[200:203]
    ds_read_b64_tr_b16 v[64:65], v6 offset:4096
    v_mfma_f32_16x16x32_bf16 v[204:207], v[72:75], v[44:47], v[204:207]
    ds_read_b64_tr_b16 v[66:67], v6 offset:4608
    v_mfma_f32_16x16x32_bf16 v[208:211], v[72:75], v[48:51], v[208:211]
    ds_read_b128 v[24:27], v14 offset:0
    v_mfma_f32_16x16x32_bf16 v[212:215], v[72:75], v[52:55], v[212:215]
    ds_read_b128 v[28:31], v14 offset:2048
    v_mfma_f32_16x16x32_bf16 v[216:219], v[76:79], v[40:43], v[216:219]
    ds_read_b128 v[32:35], v14 offset:4096
    v_mfma_f32_16x16x32_bf16 v[220:223], v[76:79], v[44:47], v[220:223]
    ds_read_b128 v[36:39], v14 offset:6144
    v_mfma_f32_16x16x32_bf16 v[224:227], v[76:79], v[48:51], v[224:227]
    ds_read_b64_tr_b16 v[68:69], v7 offset:4096
    v_mfma_f32_16x16x32_bf16 v[228:231], v[76:79], v[52:55], v[228:231]
    ds_read_b64_tr_b16 v[70:71], v7 offset:4608
    v_mfma_f32_16x16x32_bf16 v[232:235], v[80:83], v[40:43], v[232:235]
    ds_read_b64_tr_b16 v[72:73], v6 offset:8192
    v_mfma_f32_16x16x32_bf16 v[236:239], v[80:83], v[44:47], v[236:239]
    ds_read_b64_tr_b16 v[74:75], v6 offset:8704
    v_mfma_f32_16x16x32_bf16 v[240:243], v[80:83], v[48:51], v[240:243]
    ds_read_b128 v[56:59], v18
    v_mfma_f32_16x16x32_bf16 v[244:247], v[80:83], v[52:55], v[244:247]
    s_waitcnt lgkmcnt(8)
    v_mfma_f32_16x16x32_bf16 v[88:91], v[64:67], v[24:27], v[88:91]
    ds_read_b64_tr_b16 v[76:77], v7 offset:8192
    s_waitcnt lgkmcnt(8)
    v_mfma_f32_16x16x32_bf16 v[92:95], v[64:67], v[28:31], v[92:95]
    ds_read_b64_tr_b16 v[78:79], v7 offset:8704
    s_waitcnt lgkmcnt(8)
    v_mfma_f32_16x16x32_bf16 v[96:99], v[64:67], v[32:35], v[96:99]
    ds_read_b64_tr_b16 v[80:81], v6 offset:0
    s_waitcnt lgkmcnt(8)
    v_mfma_f32_16x16x32_bf16 v[100:103], v[64:67], v[36:39], v[100:103]
    ds_read_b64_tr_b16 v[82:83], v6 offset:512
    s_waitcnt lgkmcnt(4)
    v_mfma_f32_16x16x32_bf16 v[248:251], v[64:67], v[56:59], v[248:251]
    v_mfma_f32_16x16x32_bf16 v[104:107], v[68:71], v[24:27], v[104:107]
    ds_read_b64_tr_b16 v[64:65], v7 offset:0
    v_mfma_f32_16x16x32_bf16 v[108:111], v[68:71], v[28:31], v[108:111]
    v_mfma_f32_16x16x32_bf16 v[112:115], v[68:71], v[32:35], v[112:115]
    ds_read_b64_tr_b16 v[66:67], v7 offset:512
    v_mfma_f32_16x16x32_bf16 v[116:119], v[68:71], v[36:39], v[116:119]
    v_mfma_f32_16x16x32_bf16 v[120:123], v[24:27], v[72:75], v[120:123]
    ds_read_b64_tr_b16 v[68:69], v6 offset:12288
    v_mfma_f32_16x16x32_bf16 v[124:127], v[28:31], v[72:75], v[124:127]
    v_mfma_f32_16x16x32_bf16 v[128:131], v[32:35], v[72:75], v[128:131]
    ds_read_b64_tr_b16 v[70:71], v6 offset:12800
    v_mfma_f32_16x16x32_bf16 v[132:135], v[36:39], v[72:75], v[132:135]
    v_mfma_f32_16x16x32_bf16 v[252:255], v[56:59], v[72:75], v[252:255]
    s_waitcnt lgkmcnt(6)
    v_mfma_f32_16x16x32_bf16 v[136:139], v[24:27], v[76:79], v[136:139]
    ds_read_b64_tr_b16 v[72:73], v6 offset:16384
    v_mfma_f32_16x16x32_bf16 v[140:143], v[28:31], v[76:79], v[140:143]
    v_mfma_f32_16x16x32_bf16 v[144:147], v[32:35], v[76:79], v[144:147]
    ds_read_b64_tr_b16 v[74:75], v6 offset:16896
    v_mfma_f32_16x16x32_bf16 v[148:151], v[36:39], v[76:79], v[148:151]
    s_waitcnt lgkmcnt(6)
    v_mfma_f32_16x16x32_bf16 v[152:155], v[80:83], v[24:27], v[152:155]
    ds_read_b64_tr_b16 v[76:77], v7 offset:12288
    v_mfma_f32_16x16x32_bf16 v[156:159], v[80:83], v[28:31], v[156:159]
    v_mfma_f32_16x16x32_bf16 v[160:163], v[80:83], v[32:35], v[160:163]
    ds_read_b64_tr_b16 v[78:79], v7 offset:12800
    v_mfma_f32_16x16x32_bf16 v[164:167], v[80:83], v[36:39], v[164:167]
    s_waitcnt lgkmcnt(6)
    v_mfma_f32_16x16x32_bf16 v[168:171], v[64:67], v[24:27], v[168:171]
    ds_read_b64_tr_b16 v[80:81], v7 offset:16384
    v_mfma_f32_16x16x32_bf16 v[172:175], v[64:67], v[28:31], v[172:175]
    v_mfma_f32_16x16x32_bf16 v[176:179], v[64:67], v[32:35], v[176:179]
    ds_read_b64_tr_b16 v[82:83], v7 offset:16896
    v_mfma_f32_16x16x32_bf16 v[180:183], v[64:67], v[36:39], v[180:183]
    s_waitcnt lgkmcnt(6)
    v_mfma_f32_16x16x32_bf16 v[184:187], v[68:71], v[24:27], v[184:187]
    v_mfma_f32_16x16x32_bf16 v[188:191], v[68:71], v[28:31], v[188:191]
    v_mfma_f32_16x16x32_bf16 v[192:195], v[68:71], v[32:35], v[192:195]
    v_mfma_f32_16x16x32_bf16 v[196:199], v[68:71], v[36:39], v[196:199]
    s_waitcnt lgkmcnt(0)
    s_barrier
    v_mfma_f32_16x16x32_bf16 v[200:203], v[72:75], v[24:27], v[200:203]
    ds_read_b64_tr_b16 v[64:65], v6 offset:24576
    v_mfma_f32_16x16x32_bf16 v[204:207], v[72:75], v[28:31], v[204:207]
    ds_read_b64_tr_b16 v[66:67], v6 offset:25088
    v_mfma_f32_16x16x32_bf16 v[208:211], v[72:75], v[32:35], v[208:211]
    ds_read_b128 v[40:43], v15 offset:0
    v_mfma_f32_16x16x32_bf16 v[212:215], v[72:75], v[36:39], v[212:215]
    ds_read_b128 v[44:47], v15 offset:2048
    v_mfma_f32_16x16x32_bf16 v[216:219], v[76:79], v[24:27], v[216:219]
    ds_read_b128 v[48:51], v15 offset:4096
    v_mfma_f32_16x16x32_bf16 v[220:223], v[76:79], v[28:31], v[220:223]
    ds_read_b128 v[52:55], v15 offset:6144
    v_mfma_f32_16x16x32_bf16 v[224:227], v[76:79], v[32:35], v[224:227]
    ds_read_b64_tr_b16 v[68:69], v7 offset:24576
    v_mfma_f32_16x16x32_bf16 v[228:231], v[76:79], v[36:39], v[228:231]
    ds_read_b64_tr_b16 v[70:71], v7 offset:25088
    v_mfma_f32_16x16x32_bf16 v[232:235], v[80:83], v[24:27], v[232:235]
    ds_read_b64_tr_b16 v[72:73], v6 offset:28672
    v_mfma_f32_16x16x32_bf16 v[236:239], v[80:83], v[28:31], v[236:239]
    ds_read_b64_tr_b16 v[74:75], v6 offset:29184
    v_mfma_f32_16x16x32_bf16 v[240:243], v[80:83], v[32:35], v[240:243]
    ds_read_b128 v[60:63], v19
    v_mfma_f32_16x16x32_bf16 v[244:247], v[80:83], v[36:39], v[244:247]
    s_waitcnt lgkmcnt(8)
    v_mfma_f32_16x16x32_bf16 v[88:91], v[64:67], v[40:43], v[88:91]
    ds_read_b64_tr_b16 v[76:77], v7 offset:28672
    s_waitcnt lgkmcnt(8)
    v_mfma_f32_16x16x32_bf16 v[92:95], v[64:67], v[44:47], v[92:95]
    ds_read_b64_tr_b16 v[78:79], v7 offset:29184
    s_waitcnt lgkmcnt(8)
    v_mfma_f32_16x16x32_bf16 v[96:99], v[64:67], v[48:51], v[96:99]
    ds_read_b64_tr_b16 v[80:81], v6 offset:20480
    s_waitcnt lgkmcnt(8)
    v_mfma_f32_16x16x32_bf16 v[100:103], v[64:67], v[52:55], v[100:103]
    ds_read_b64_tr_b16 v[82:83], v6 offset:20992
    s_waitcnt lgkmcnt(4)
    v_mfma_f32_16x16x32_bf16 v[248:251], v[64:67], v[60:63], v[248:251]
    v_mfma_f32_16x16x32_bf16 v[104:107], v[68:71], v[40:43], v[104:107]
    ds_read_b64_tr_b16 v[64:65], v7 offset:20480
    v_mfma_f32_16x16x32_bf16 v[108:111], v[68:71], v[44:47], v[108:111]
    v_add_u32 v14, s80, v16
    v_mfma_f32_16x16x32_bf16 v[112:115], v[68:71], v[48:51], v[112:115]
    ds_read_b64_tr_b16 v[66:67], v7 offset:20992
    v_mfma_f32_16x16x32_bf16 v[116:119], v[68:71], v[52:55], v[116:119]
    v_add_u32 v15, s80, v17
    v_mfma_f32_16x16x32_bf16 v[120:123], v[40:43], v[72:75], v[120:123]
    ds_read_b64_tr_b16 v[68:69], v6 offset:32768
    v_mfma_f32_16x16x32_bf16 v[124:127], v[44:47], v[72:75], v[124:127]
    s_add_u32 s84, s80, s95
    v_mfma_f32_16x16x32_bf16 v[128:131], v[48:51], v[72:75], v[128:131]
    ds_read_b64_tr_b16 v[70:71], v6 offset:33280
    v_mfma_f32_16x16x32_bf16 v[132:135], v[52:55], v[72:75], v[132:135]
    v_add_u32 v18, s84, v16
    v_mfma_f32_16x16x32_bf16 v[252:255], v[60:63], v[72:75], v[252:255]
    s_waitcnt lgkmcnt(6)
    v_mfma_f32_16x16x32_bf16 v[136:139], v[40:43], v[76:79], v[136:139]
    ds_read_b64_tr_b16 v[72:73], v6 offset:36864
    v_mfma_f32_16x16x32_bf16 v[140:143], v[44:47], v[76:79], v[140:143]
    v_add_u32 v19, s84, v17
    v_mfma_f32_16x16x32_bf16 v[144:147], v[48:51], v[76:79], v[144:147]
    ds_read_b64_tr_b16 v[74:75], v6 offset:37376
    v_mfma_f32_16x16x32_bf16 v[148:151], v[52:55], v[76:79], v[148:151]
    s_add_u32 s80, s80, 18432
    s_waitcnt lgkmcnt(6)
    v_mfma_f32_16x16x32_bf16 v[152:155], v[80:83], v[40:43], v[152:155]
    ds_read_b64_tr_b16 v[76:77], v7 offset:32768
    v_mfma_f32_16x16x32_bf16 v[156:159], v[80:83], v[44:47], v[156:159]
    s_cmp_ge_u32 s80, 153600
    s_cselect_b32 s84, 55296, 0
    v_mfma_f32_16x16x32_bf16 v[160:163], v[80:83], v[48:51], v[160:163]
    ds_read_b64_tr_b16 v[78:79], v7 offset:33280
    v_mfma_f32_16x16x32_bf16 v[164:167], v[80:83], v[52:55], v[164:167]
    s_sub_u32 s80, s80, s84
    s_waitcnt lgkmcnt(6)
    v_mfma_f32_16x16x32_bf16 v[168:171], v[64:67], v[40:43], v[168:171]
    ds_read_b64_tr_b16 v[80:81], v7 offset:36864
    v_mfma_f32_16x16x32_bf16 v[172:175], v[64:67], v[44:47], v[172:175]
    v_mfma_f32_16x16x32_bf16 v[176:179], v[64:67], v[48:51], v[176:179]
    ds_read_b64_tr_b16 v[82:83], v7 offset:37376
    v_mfma_f32_16x16x32_bf16 v[180:183], v[64:67], v[52:55], v[180:183]
    s_waitcnt lgkmcnt(6)
    v_mfma_f32_16x16x32_bf16 v[184:187], v[68:71], v[40:43], v[184:187]
    v_mfma_f32_16x16x32_bf16 v[188:191], v[68:71], v[44:47], v[188:191]
    v_mfma_f32_16x16x32_bf16 v[192:195], v[68:71], v[48:51], v[192:195]
    v_mfma_f32_16x16x32_bf16 v[196:199], v[68:71], v[52:55], v[196:199]
    s_waitcnt lgkmcnt(0)
    s_barrier
    v_mfma_f32_16x16x32_bf16 v[200:203], v[72:75], v[40:43], v[200:203]
    ds_read_b64_tr_b16 v[64:65], v4 offset:4096
    v_mfma_f32_16x16x32_bf16 v[204:207], v[72:75], v[44:47], v[204:207]
    ds_read_b64_tr_b16 v[66:67], v4 offset:4608
    v_mfma_f32_16x16x32_bf16 v[208:211], v[72:75], v[48:51], v[208:211]
    ds_read_b128 v[24:27], v14 offset:0
    v_mfma_f32_16x16x32_bf16 v[212:215], v[72:75], v[52:55], v[212:215]
    ds_read_b128 v[28:31], v14 offset:2048
    v_mfma_f32_16x16x32_bf16 v[216:219], v[76:79], v[40:43], v[216:219]
    ds_read_b128 v[32:35], v14 offset:4096
    v_mfma_f32_16x16x32_bf16 v[220:223], v[76:79], v[44:47], v[220:223]
    ds_read_b128 v[36:39], v14 offset:6144
    v_mfma_f32_16x16x32_bf16 v[224:227], v[76:79], v[48:51], v[224:227]
    ds_read_b64_tr_b16 v[68:69], v5 offset:4096
    v_mfma_f32_16x16x32_bf16 v[228:231], v[76:79], v[52:55], v[228:231]
    ds_read_b64_tr_b16 v[70:71], v5 offset:4608
    v_mfma_f32_16x16x32_bf16 v[232:235], v[80:83], v[40:43], v[232:235]
L_pad9:
    s_cbranch_execz L_vret1
    ds_read_b64_tr_b16 v[72:73], v4 offset:8192
    v_mfma_f32_16x16x32_bf16 v[236:239], v[80:83], v[44:47], v[236:239]
    ds_read_b64_tr_b16 v[74:75], v4 offset:8704
    v_mfma_f32_16x16x32_bf16 v[240:243], v[80:83], v[48:51], v[240:243]
    ds_read_b128 v[56:59], v18
    v_mfma_f32_16x16x32_bf16 v[244:247], v[80:83], v[52:55], v[244:247]
    s_sub_u32 s34, s34, 1
    s_cmp_lg_u32 s34, 0
    s_cbranch_scc1 L_p2
    s_waitcnt lgkmcnt(8)
    v_mfma_f32_16x16x32_bf16 v[88:91], v[64:67], v[24:27], v[88:91]
    ds_read_b64_tr_b16 v[76:77], v5 offset:8192
    s_waitcnt lgkmcnt(8)
    v_mfma_f32_16x16x32_bf16 v[92:95], v[64:67], v[28:31], v[92:95]
    ds_read_b64_tr_b16 v[78:79], v5 offset:8704
    s_waitcnt lgkmcnt(8)
    v_mfma_f32_16x16x32_bf16 v[96:99], v[64:67], v[32:35], v[96:99]
    ds_read_b64_tr_b16 v[80:81], v4 offset:0
    s_waitcnt lgkmcnt(8)
    v_mfma_f32_16x16x32_bf16 v[100:103], v[64:67], v[36:39], v[100:103]
    ds_read_b64_tr_b16 v[82:83], v4 offset:512
    s_waitcnt lgkmcnt(4)
    v_mfma_f32_16x16x32_bf16 v[248:251], v[64:67], v[56:59], v[248:251]
    v_mfma_f32_16x16x32_bf16 v[104:107], v[68:71], v[24:27], v[104:107]
    ds_read_b64_tr_b16 v[64:65], v5 offset:0
    v_mfma_f32_16x16x32_bf16 v[108:111], v[68:71], v[28:31], v[108:111]
    v_mfma_f32_16x16x32_bf16 v[112:115], v[68:71], v[32:35], v[112:115]
    ds_read_b64_tr_b16 v[66:67], v5 offset:512
    v_mfma_f32_16x16x32_bf16 v[116:119], v[68:71], v[36:39], v[116:119]
    v_mfma_f32_16x16x32_bf16 v[120:123], v[24:27], v[72:75], v[120:123]
    ds_read_b64_tr_b16 v[68:69], v4 offset:12288
    v_mfma_f32_16x16x32_bf16 v[124:127], v[28:31], v[72:75], v[124:127]
    v_mfma_f32_16x16x32_bf16 v[128:131], v[32:35], v[72:75], v[128:131]
    ds_read_b64_tr_b16 v[70:71], v4 offset:12800
    v_mfma_f32_16x16x32_bf16 v[132:135], v[36:39], v[72:75], v[132:135]
    v_mfma_f32_16x16x32_bf16 v[252:255], v[56:59], v[72:75], v[252:255]
    s_waitcnt lgkmcnt(6)
    v_mfma_f32_16x16x32_bf16 v[136:139], v[24:27], v[76:79], v[136:139]
    ds_read_b64_tr_b16 v[72:73], v4 offset:16384
    v_mfma_f32_16x16x32_bf16 v[140:143], v[28:31], v[76:79], v[140:143]
    v_mfma_f32_16x16x32_bf16 v[144:147], v[32:35], v[76:79], v[144:147]
    ds_read_b64_tr_b16 v[74:75], v4 offset:16896
    v_mfma_f32_16x16x32_bf16 v[148:151], v[36:39], v[76:79], v[148:151]
    s_waitcnt lgkmcnt(6)
    v_mfma_f32_16x16x32_bf16 v[152:155], v[80:83], v[24:27], v[152:155]
    ds_read_b64_tr_b16 v[76:77], v5 offset:12288
    v_mfma_f32_16x16x32_bf16 v[156:159], v[80:83], v[28:31], v[156:159]
    v_mfma_f32_16x16x32_bf16 v[160:163], v[80:83], v[32:35], v[160:163]
    ds_read_b64_tr_b16 v[78:79], v5 offset:12800
    v_mfma_f32_16x16x32_bf16 v[164:167], v[80:83], v[36:39], v[164:167]
    s_waitcnt lgkmcnt(6)
    v_mfma_f32_16x16x32_bf16 v[168:171], v[64:67], v[24:27], v[168:171]
    ds_read_b64_tr_b16 v[80:81], v5 offset:16384
    v_mfma_f32_16x16x32_bf16 v[172:175], v[64:67], v[28:31], v[172:175]
    v_mfma_f32_16x16x32_bf16 v[176:179], v[64:67], v[32:35], v[176:179]
    ds_read_b64_tr_b16 v[82:83], v5 offset:16896
    v_mfma_f32_16x16x32_bf16 v[180:183], v[64:67], v[36:39], v[180:183]
    s_waitcnt lgkmcnt(6)
    v_mfma_f32_16x16x32_bf16 v[184:187], v[68:71], v[24:27], v[184:187]
    v_mfma_f32_16x16x32_bf16 v[188:191], v[68:71], v[28:31], v[188:191]
    v_mfma_f32_16x16x32_bf16 v[192:195], v[68:71], v[32:35], v[192:195]
    v_mfma_f32_16x16x32_bf16 v[196:199], v[68:71], v[36:39], v[196:199]
    s_waitcnt lgkmcnt(0)
    s_barrier
    v_mfma_f32_16x16x32_bf16 v[200:203], v[72:75], v[24:27], v[200:203]
    ds_read_b64_tr_b16 v[64:65], v4 offset:24576
    v_mfma_f32_16x16x32_bf16 v[204:207], v[72:75], v[28:31], v[204:207]
    ds_read_b64_tr_b16 v[66:67], v4 offset:25088
    v_mfma_f32_16x16x32_bf16 v[208:211], v[72:75], v[32:35], v[208:211]
    ds_read_b128 v[40:43], v15 offset:0
    v_mfma_f32_16x16x32_bf16 v[212:215], v[72:75], v[36:39], v[212:215]
    ds_read_b128 v[44:47], v15 offset:2048
    v_mfma_f32_16x16x32_bf16 v[216:219], v[76:79], v[24:27], v[216:219]
    ds_read_b128 v[48:51], v15 offset:4096
    v_mfma_f32_16x16x32_bf16 v[220:223], v[76:79], v[28:31], v[220:223]
    ds_read_b128 v[52:55], v15 offset:6144
    v_mfma_f32_16x16x32_bf16 v[224:227], v[76:79], v[32:35], v[224:227]
    ds_read_b64_tr_b16 v[68:69], v5 offset:24576
    v_mfma_f32_16x16x32_bf16 v[228:231], v[76:79], v[36:39], v[228:231]
    ds_read_b64_tr_b16 v[70:71], v5 offset:25088
    v_mfma_f32_16x16x32_bf16 v[232:235], v[80:83], v[24:27], v[232:235]
    ds_read_b64_tr_b16 v[72:73], v4 offset:28672
    v_mfma_f32_16x16x32_bf16 v[236:239], v[80:83], v[28:31], v[236:239]
    ds_read_b64_tr_b16 v[74:75], v4 offset:29184
    v_mfma_f32_16x16x32_bf16 v[240:243], v[80:83], v[32:35], v[240:243]
    ds_read_b128 v[60:63], v19
    v_mfma_f32_16x16x32_bf16 v[244:247], v[80:83], v[36:39], v[244:247]
    s_waitcnt lgkmcnt(8)
    v_mfma_f32_16x16x32_bf16 v[88:91], v[64:67], v[40:43], v[88:91]
    ds_read_b64_tr_b16 v[76:77], v5 offset:28672
    s_waitcnt lgkmcnt(8)
    v_mfma_f32_16x16x32_bf16 v[92:95], v[64:67], v[44:47], v[92:95]
    ds_read_b64_tr_b16 v[78:79], v5 offset:29184
    s_waitcnt lgkmcnt(8)
    v_mfma_f32_16x16x32_bf16 v[96:99], v[64:67], v[48:51], v[96:99]
    ds_read_b64_tr_b16 v[80:81], v4 offset:20480
    s_waitcnt lgkmcnt(8)
    v_mfma_f32_16x16x32_bf16 v[100:103], v[64:67], v[52:55], v[100:103]
    ds_read_b64_tr_b16 v[82:83], v4 offset:20992
    s_waitcnt lgkmcnt(4)
    v_mfma_f32_16x16x32_bf16 v[248:251], v[64:67], v[60:63], v[248:251]
    v_mfma_f32_16x16x32_bf16 v[104:107], v[68:71], v[40:43], v[104:107]
    ds_read_b64_tr_b16 v[64:65], v5 offset:20480
    v_mfma_f32_16x16x32_bf16 v[108:111], v[68:71], v[44:47], v[108:111]
    v_add_u32 v14, s80, v16
    v_mfma_f32_16x16x32_bf16 v[112:115], v[68:71], v[48:51], v[112:115]
    ds_read_b64_tr_b16 v[66:67], v5 offset:20992
    v_mfma_f32_16x16x32_bf16 v[116:119], v[68:71], v[52:55], v[116:119]
    v_add_u32 v15, s80, v17
    v_mfma_f32_16x16x32_bf16 v[120:123], v[40:43], v[72:75], v[120:123]
    ds_read_b64_tr_b16 v[68:69], v4 offset:32768
    v_mfma_f32_16x16x32_bf16 v[124:127], v[44:47], v[72:75], v[124:127]
    s_add_u32 s84, s80, s95
    v_mfma_f32_16x16x32_bf16 v[128:131], v[48:51], v[72:75], v[128:131]
    ds_read_b64_tr_b16 v[70:71], v4 offset:33280
    v_mfma_f32_16x16x32_bf16 v[132:135], v[52:55], v[72:75], v[132:135]
    v_add_u32 v18, s84, v16
    v_mfma_f32_16x16x32_bf16 v[252:255], v[60:63], v[72:75], v[252:255]
    s_waitcnt lgkmcnt(6)
    v_mfma_f32_16x16x32_bf16 v[136:139], v[40:43], v[76:79], v[136:139]
    ds_read_b64_tr_b16 v[72:73], v4 offset:36864
    v_mfma_f32_16x16x32_bf16 v[140:143], v[44:47], v[76:79], v[140:143]
    v_add_u32 v19, s84, v17
    v_mfma_f32_16x16x32_bf16 v[144:147], v[48:51], v[76:79], v[144:147]
    ds_read_b64_tr_b16 v[74:75], v4 offset:37376
    v_mfma_f32_16x16x32_bf16 v[148:151], v[52:55], v[76:79], v[148:151]
    s_add_u32 s80, s80, 18432
    s_waitcnt lgkmcnt(6)
    v_mfma_f32_16x16x32_bf16 v[152:155], v[80:83], v[40:43], v[152:155]
    ds_read_b64_tr_b16 v[76:77], v5 offset:32768
    v_mfma_f32_16x16x32_bf16 v[156:159], v[80:83], v[44:47], v[156:159]
    s_cmp_ge_u32 s80, 153600
    s_cselect_b32 s84, 55296, 0
    v_mfma_f32_16x16x32_bf16 v[160:163], v[80:83], v[48:51], v[160:163]
    ds_read_b64_tr_b16 v[78:79], v5 offset:33280
    v_mfma_f32_16x16x32_bf16 v[164:167], v[80:83], v[52:55], v[164:167]
    s_sub_u32 s80, s80, s84
    s_waitcnt lgkmcnt(6)
    v_mfma_f32_16x16x32_bf16 v[168:171], v[64:67], v[40:43], v[168:171]
    ds_read_b64_tr_b16 v[80:81], v5 offset:36864
    v_mfma_f32_16x16x32_bf16 v[172:175], v[64:67], v[44:47], v[172:175]
    v_mfma_f32_16x16x32_bf16 v[176:179], v[64:67], v[48:51], v[176:179]
    ds_read_b64_tr_b16 v[82:83], v5 offset:37376
    v_mfma_f32_16x16x32_bf16 v[180:183], v[64:67], v[52:55], v[180:183]
    s_waitcnt lgkmcnt(6)
    v_mfma_f32_16x16x32_bf16 v[184:187], v[68:71], v[40:43], v[184:187]
    v_mfma_f32_16x16x32_bf16 v[188:191], v[68:71], v[44:47], v[188:191]
    v_mfma_f32_16x16x32_bf16 v[192:195], v[68:71], v[48:51], v[192:195]
    v_mfma_f32_16x16x32_bf16 v[196:199], v[68:71], v[52:55], v[196:199]
    s_waitcnt lgkmcnt(0)
    s_barrier
    v_mfma_f32_16x16x32_bf16 v[200:203], v[72:75], v[40:43], v[200:203]
    ds_read_b64_tr_b16 v[64:65], v6 offset:4096
    v_mfma_f32_16x16x32_bf16 v[204:207], v[72:75], v[44:47], v[204:207]
    ds_read_b64_tr_b16 v[66:67], v6 offset:4608
    v_mfma_f32_16x16x32_bf16 v[208:211], v[72:75], v[48:51], v[208:211]
    ds_read_b128 v[24:27], v14 offset:0
    v_mfma_f32_16x16x32_bf16 v[212:215], v[72:75], v[52:55], v[212:215]
    ds_read_b128 v[28:31], v14 offset:2048
    v_mfma_f32_16x16x32_bf16 v[216:219], v[76:79], v[40:43], v[216:219]
    ds_read_b128 v[32:35], v14 offset:4096
    v_mfma_f32_16x16x32_bf16 v[220:223], v[76:79], v[44:47], v[220:223]
    ds_read_b128 v[36:39], v14 offset:6144
    v_mfma_f32_16x16x32_bf16 v[224:227], v[76:79], v[48:51], v[224:227]
    ds_read_b64_tr_b16 v[68:69], v7 offset:4096
    v_mfma_f32_16x16x32_bf16 v[228:231], v[76:79], v[52:55], v[228:231]
    ds_read_b64_tr_b16 v[70:71], v7 offset:4608
    v_mfma_f32_16x16x32_bf16 v[232:235], v[80:83], v[40:43], v[232:235]
    ds_read_b64_tr_b16 v[72:73], v6 offset:8192
    v_mfma_f32_16x16x32_bf16 v[236:239], v[80:83], v[44:47], v[236:239]
    ds_read_b64_tr_b16 v[74:75], v6 offset:8704
    v_mfma_f32_16x16x32_bf16 v[240:243], v[80:83], v[48:51], v[240:243]
    ds_read_b128 v[56:59], v18
    v_mfma_f32_16x16x32_bf16 v[244:247], v[80:83], v[52:55], v[244:247]
    s_waitcnt lgkmcnt(8)
    v_mfma_f32_16x16x32_bf16 v[88:91], v[64:67], v[24:27], v[88:91]
    ds_read_b64_tr_b16 v[76:77], v7 offset:8192
    s_waitcnt lgkmcnt(8)
    v_mfma_f32_16x16x32_bf16 v[92:95], v[64:67], v[28:31], v[92:95]
    ds_read_b64_tr_b16 v[78:79], v7 offset:8704
    s_waitcnt lgkmcnt(8)
    v_mfma_f32_16x16x32_bf16 v[96:99], v[64:67], v[32:35], v[96:99]
    ds_read_b64_tr_b16 v[80:81], v6 offset:0
    s_waitcnt lgkmcnt(8)
    v_mfma_f32_16x16x32_bf16 v[100:103], v[64:67], v[36:39], v[100:103]
    ds_read_b64_tr_b16 v[82:83], v6 offset:512
    s_waitcnt lgkmcnt(4)
    v_mfma_f32_16x16x32_bf16 v[248:251], v[64:67], v[56:59], v[248:251]
    v_mfma_f32_16x16x32_bf16 v[104:107], v[68:71], v[24:27], v[104:107]
    ds_read_b64_tr_b16 v[64:65], v7 offset:0
    v_mfma_f32_16x16x32_bf16 v[108:111], v[68:71], v[28:31], v[108:111]
    v_mfma_f32_16x16x32_bf16 v[112:115], v[68:71], v[32:35], v[112:115]
    ds_read_b64_tr_b16 v[66:67], v7 offset:512
    v_mfma_f32_16x16x32_bf16 v[116:119], v[68:71], v[36:39], v[116:119]
    v_mfma_f32_16x16x32_bf16 v[120:123], v[24:27], v[72:75], v[120:123]
    ds_read_b64_tr_b16 v[68:69], v6 offset:12288
    v_mfma_f32_16x16x32_bf16 v[124:127], v[28:31], v[72:75], v[124:127]
    v_mfma_f32_16x16x32_bf16 v[128:131], v[32:35], v[72:75], v[128:131]
    ds_read_b64_tr_b16 v[70:71], v6 offset:12800
    v_mfma_f32_16x16x32_bf16 v[132:135], v[36:39], v[72:75], v[132:135]
    v_mfma_f32_16x16x32_bf16 v[252:255], v[56:59], v[72:75], v[252:255]
    s_waitcnt lgkmcnt(6)
    v_mfma_f32_16x16x32_bf16 v[136:139], v[24:27], v[76:79], v[136:139]
    ds_read_b64_tr_b16 v[72:73], v6 offset:16384
    v_mfma_f32_16x16x32_bf16 v[140:143], v[28:31], v[76:79], v[140:143]
    v_mfma_f32_16x16x32_bf16 v[144:147], v[32:35], v[76:79], v[144:147]
    ds_read_b64_tr_b16 v[74:75], v6 offset:16896
    v_mfma_f32_16x16x32_bf16 v[148:151], v[36:39], v[76:79], v[148:151]
    s_waitcnt lgkmcnt(6)
    v_mfma_f32_16x16x32_bf16 v[152:155], v[80:83], v[24:27], v[152:155]
    ds_read_b64_tr_b16 v[76:77], v7 offset:12288
    v_mfma_f32_16x16x32_bf16 v[156:159], v[80:83], v[28:31], v[156:159]
    v_mfma_f32_16x16x32_bf16 v[160:163], v[80:83], v[32:35], v[160:163]
    ds_read_b64_tr_b16 v[78:79], v7 offset:12800
    v_mfma_f32_16x16x32_bf16 v[164:167], v[80:83], v[36:39], v[164:167]
    s_waitcnt lgkmcnt(6)
    v_mfma_f32_16x16x32_bf16 v[168:171], v[64:67], v[24:27], v[168:171]
    ds_read_b64_tr_b16 v[80:81], v7 offset:16384
    v_mfma_f32_16x16x32_bf16 v[172:175], v[64:67], v[28:31], v[172:175]
    v_mfma_f32_16x16x32_bf16 v[176:179], v[64:67], v[32:35], v[176:179]
    ds_read_b64_tr_b16 v[82:83], v7 offset:16896
    v_mfma_f32_16x16x32_bf16 v[180:183], v[64:67], v[36:39], v[180:183]
    s_waitcnt lgkmcnt(6)
    v_mfma_f32_16x16x32_bf16 v[184:187], v[68:71], v[24:27], v[184:187]
    v_mfma_f32_16x16x32_bf16 v[188:191], v[68:71], v[28:31], v[188:191]
    v_mfma_f32_16x16x32_bf16 v[192:195], v[68:71], v[32:35], v[192:195]
    v_mfma_f32_16x16x32_bf16 v[196:199], v[68:71], v[36:39], v[196:199]
    s_waitcnt lgkmcnt(0)
    s_barrier
    v_mfma_f32_16x16x32_bf16 v[200:203], v[72:75], v[24:27], v[200:203]
    ds_read_b64_tr_b16 v[64:65], v6 offset:24576
    v_mfma_f32_16x16x32_bf16 v[204:207], v[72:75], v[28:31], v[204:207]
    ds_read_b64_tr_b16 v[66:67], v6 offset:25088
    v_mfma_f32_16x16x32_bf16 v[208:211], v[72:75], v[32:35], v[208:211]
    ds_read_b128 v[40:43], v15 offset:0
    v_mfma_f32_16x16x32_bf16 v[212:215], v[72:75], v[36:39], v[212:215]
    ds_read_b128 v[44:47], v15 offset:2048
    v_mfma_f32_16x16x32_bf16 v[216:219], v[76:79], v[24:27], v[216:219]
    ds_read_b128 v[48:51], v15 offset:4096
    v_mfma_f32_16x16x32_bf16 v[220:223], v[76:79], v[28:31], v[220:223]
    ds_read_b128 v[52:55], v15 offset:6144
    v_mfma_f32_16x16x32_bf16 v[224:227], v[76:79], v[32:35], v[224:227]
    ds_read_b64_tr_b16 v[68:69], v7 offset:24576
    v_mfma_f32_16x16x32_bf16 v[228:231], v[76:79], v[36:39], v[228:231]
    ds_read_b64_tr_b16 v[70:71], v7 offset:25088
    v_mfma_f32_16x16x32_bf16 v[232:235], v[80:83], v[24:27], v[232:235]
    ds_read_b64_tr_b16 v[72:73], v6 offset:28672
    v_mfma_f32_16x16x32_bf16 v[236:239], v[80:83], v[28:31], v[236:239]
    ds_read_b64_tr_b16 v[74:75], v6 offset:29184
    v_mfma_f32_16x16x32_bf16 v[240:243], v[80:83], v[32:35], v[240:243]
    ds_read_b128 v[60:63], v19
    v_mfma_f32_16x16x32_bf16 v[244:247], v[80:83], v[36:39], v[244:247]
    s_waitcnt lgkmcnt(8)
    v_mfma_f32_16x16x32_bf16 v[88:91], v[64:67], v[40:43], v[88:91]
    ds_read_b64_tr_b16 v[76:77], v7 offset:28672
    s_waitcnt lgkmcnt(8)
    v_mfma_f32_16x16x32_bf16 v[92:95], v[64:67], v[44:47], v[92:95]
    ds_read_b64_tr_b16 v[78:79], v7 offset:29184
    s_waitcnt lgkmcnt(8)
    v_mfma_f32_16x16x32_bf16 v[96:99], v[64:67], v[48:51], v[96:99]
    ds_read_b64_tr_b16 v[80:81], v6 offset:20480
    s_waitcnt lgkmcnt(8)
    v_mfma_f32_16x16x32_bf16 v[100:103], v[64:67], v[52:55], v[100:103]
    ds_read_b64_tr_b16 v[82:83], v6 offset:20992
    s_waitcnt lgkmcnt(4)
    v_mfma_f32_16x16x32_bf16 v[248:251], v[64:67], v[60:63], v[248:251]
    v_mfma_f32_16x16x32_bf16 v[104:107], v[68:71], v[40:43], v[104:107]
    ds_read_b64_tr_b16 v[64:65], v7 offset:20480
    v_mfma_f32_16x16x32_bf16 v[108:111], v[68:71], v[44:47], v[108:111]
    v_mfma_f32_16x16x32_bf16 v[112:115], v[68:71], v[48:51], v[112:115]
    ds_read_b64_tr_b16 v[66:67], v7 offset:20992
    v_mfma_f32_16x16x32_bf16 v[116:119], v[68:71], v[52:55], v[116:119]
    v_mfma_f32_16x16x32_bf16 v[120:123], v[40:43], v[72:75], v[120:123]
    ds_read_b64_tr_b16 v[68:69], v6 offset:32768
    v_mfma_f32_16x16x32_bf16 v[124:127], v[44:47], v[72:75], v[124:127]
    v_mfma_f32_16x16x32_bf16 v[128:131], v[48:51], v[72:75], v[128:131]
    ds_read_b64_tr_b16 v[70:71], v6 offset:33280
    v_mfma_f32_16x16x32_bf16 v[132:135], v[52:55], v[72:75], v[132:135]
    v_mfma_f32_16x16x32_bf16 v[252:255], v[60:63], v[72:75], v[252:255]
    s_waitcnt lgkmcnt(6)
    v_mfma_f32_16x16x32_bf16 v[136:139], v[40:43], v[76:79], v[136:139]
    ds_read_b64_tr_b16 v[72:73], v6 offset:36864
    v_mfma_f32_16x16x32_bf16 v[140:143], v[44:47], v[76:79], v[140:143]
    v_mfma_f32_16x16x32_bf16 v[144:147], v[48:51], v[76:79], v[144:147]
    ds_read_b64_tr_b16 v[74:75], v6 offset:37376
    v_mfma_f32_16x16x32_bf16 v[148:151], v[52:55], v[76:79], v[148:151]
    s_waitcnt lgkmcnt(6)
    v_mfma_f32_16x16x32_bf16 v[152:155], v[80:83], v[40:43], v[152:155]
    ds_read_b64_tr_b16 v[76:77], v7 offset:32768
    v_mfma_f32_16x16x32_bf16 v[156:159], v[80:83], v[44:47], v[156:159]
    v_mfma_f32_16x16x32_bf16 v[160:163], v[80:83], v[48:51], v[160:163]
    ds_read_b64_tr_b16 v[78:79], v7 offset:33280
    v_mfma_f32_16x16x32_bf16 v[164:167], v[80:83], v[52:55], v[164:167]
    s_waitcnt lgkmcnt(6)
    v_mfma_f32_16x16x32_bf16 v[168:171], v[64:67], v[40:43], v[168:171]
    ds_read_b64_tr_b16 v[80:81], v7 offset:36864
    v_mfma_f32_16x16x32_bf16 v[172:175], v[64:67], v[44:47], v[172:175]
    v_mfma_f32_16x16x32_bf16 v[176:179], v[64:67], v[48:51], v[176:179]
    ds_read_b64_tr_b16 v[82:83], v7 offset:37376
    v_mfma_f32_16x16x32_bf16 v[180:183], v[64:67], v[52:55], v[180:183]
    s_waitcnt lgkmcnt(6)
    v_mfma_f32_16x16x32_bf16 v[184:187], v[68:71], v[40:43], v[184:187]
    v_mfma_f32_16x16x32_bf16 v[188:191], v[68:71], v[44:47], v[188:191]
    v_mfma_f32_16x16x32_bf16 v[192:195], v[68:71], v[48:51], v[192:195]
    v_mfma_f32_16x16x32_bf16 v[196:199], v[68:71], v[52:55], v[196:199]
    s_waitcnt lgkmcnt(0)
    s_barrier
    v_mfma_f32_16x16x32_bf16 v[200:203], v[72:75], v[40:43], v[200:203]
    v_mfma_f32_16x16x32_bf16 v[204:207], v[72:75], v[44:47], v[204:207]
    v_mfma_f32_16x16x32_bf16 v[208:211], v[72:75], v[48:51], v[208:211]
    v_mfma_f32_16x16x32_bf16 v[212:215], v[72:75], v[52:55], v[212:215]
    v_mfma_f32_16x16x32_bf16 v[216:219], v[76:79], v[40:43], v[216:219]
    v_mfma_f32_16x16x32_bf16 v[220:223], v[76:79], v[44:47], v[220:223]
    v_mfma_f32_16x16x32_bf16 v[224:227], v[76:79], v[48:51], v[224:227]
    v_mfma_f32_16x16x32_bf16 v[228:231], v[76:79], v[52:55], v[228:231]
    v_mfma_f32_16x16x32_bf16 v[232:235], v[80:83], v[40:43], v[232:235]
    v_mfma_f32_16x16x32_bf16 v[236:239], v[80:83], v[44:47], v[236:239]
    v_mfma_f32_16x16x32_bf16 v[240:243], v[80:83], v[48:51], v[240:243]
    v_mfma_f32_16x16x32_bf16 v[244:247], v[80:83], v[52:55], v[244:247]
    s_setprio 0
    s_mov_b32 s76, 0xbdd2d3e8
    v_cvt_pk_bf16_f32 v100, v100, v101
    v_cvt_pk_bf16_f32 v101, v102, v103
    v_cvt_pk_bf16_f32 v102, v116, v117
    v_cvt_pk_bf16_f32 v103, v118, v119
    v_cvt_pk_bf16_f32 v32, v132, v133
    v_cvt_pk_bf16_f32 v33, v134, v135
    v_cvt_pk_bf16_f32 v42, v148, v149
    v_cvt_pk_bf16_f32 v43, v150, v151
    v_cvt_pk_bf16_f32 v44, v248, v249
    v_cvt_pk_bf16_f32 v45, v250, v251
    v_cvt_pk_bf16_f32 v24, v252, v253
    v_cvt_pk_bf16_f32 v25, v254, v255
    s_cmp_lg_u32 s5, 0
    s_cbranch_scc1 L_hx1
    ds_write_b64 v85, v[100:101]
    ds_write_b64 v85, v[102:103] offset:512
    ds_write_b64 v85, v[32:33] offset:1024
    ds_write_b64 v85, v[42:43] offset:1536
    s_branch L_hx2
L_hx1:
    ds_write_b64 v85, v[44:45] offset:2048
    ds_write_b64 v85, v[24:25] offset:2560
L_hx2:
    s_waitcnt lgkmcnt(0)
    v_mul_f32 v80, v184, v184
    v_mul_f32 v81, v185, v185
    v_mul_f32 v82, v186, v186
    v_mul_f32 v83, v187, v187
    v_fma_f32 v80, v80, s76, v84
    v_fma_f32 v81, v81, s76, v84
    v_fma_f32 v82, v82, s76, v84
    v_fma_f32 v83, v83, s76, v84
    v_mul_f32 v80, v80, v184
    v_mul_f32 v81, v81, v185
    v_mul_f32 v82, v82, v186
    v_mul_f32 v83, v83, v187
    v_exp_f32 v80, v80
    v_mul_f32 v184, v184, v200
    v_exp_f32 v81, v81
    v_mul_f32 v185, v185, v201
    v_exp_f32 v82, v82
    v_mul_f32 v186, v186, v202
    v_exp_f32 v83, v83
    v_mul_f32 v187, v187, v203
    v_add_f32 v80, 1.0, v80
    v_add_f32 v81, 1.0, v81
    v_add_f32 v82, 1.0, v82
    v_add_f32 v83, 1.0, v83
    v_rcp_f32 v80, v80
    v_rcp_f32 v81, v81
    v_rcp_f32 v82, v82
    v_rcp_f32 v83, v83
    s_nop 0
    v_mul_f32 v184, v184, v80
    v_mul_f32 v185, v185, v81
    v_mul_f32 v186, v186, v82
    v_mul_f32 v187, v187, v83
    v_cvt_pk_bf16_f32 v184, v184, v185
    v_cvt_pk_bf16_f32 v185, v186, v187
    v_mul_f32 v80, v188, v188
    v_mul_f32 v81, v189, v189
    v_mul_f32 v82, v190, v190
    v_mul_f32 v83, v191, v191
    v_fma_f32 v80, v80, s76, v84
    v_fma_f32 v81, v81, s76, v84
    v_fma_f32 v82, v82, s76, v84
    v_fma_f32 v83, v83, s76, v84
    v_mul_f32 v80, v80, v188
    v_mul_f32 v81, v81, v189
    v_mul_f32 v82, v82, v190
    v_mul_f32 v83, v83, v191
    v_exp_f32 v80, v80
    v_mul_f32 v188, v188, v204
    v_exp_f32 v81, v81
    v_mul_f32 v189, v189, v205
    v_exp_f32 v82, v82
    v_mul_f32 v190, v190, v206
    v_exp_f32 v83, v83
    v_mul_f32 v191, v191, v207
    v_add_f32 v80, 1.0, v80
    v_add_f32 v81, 1.0, v81
    v_add_f32 v82, 1.0, v82
    v_add_f32 v83, 1.0, v83
    v_rcp_f32 v80, v80
    v_rcp_f32 v81, v81
    v_rcp_f32 v82, v82
    s_barrier
    s_cmp_lg_u32 s5, 0
    s_cbranch_scc1 L_hx3
    ds_read_b64 v[46:47], v85 offset:2048
    ds_read_b64 v[34:35], v85 offset:2560
    s_branch L_hx4
L_hx3:
    ds_read_b64 v[44:45], v85 offset:512
    ds_read_b64 v[46:47], v85
    ds_read_b64 v[24:25], v85 offset:1536
    ds_read_b64 v[34:35], v85 offset:1024
L_hx4:
    v_rcp_f32 v83, v83
    s_nop 0
    v_mul_f32 v188, v188, v80
    v_mul_f32 v189, v189, v81
    v_mul_f32 v190, v190, v82
    v_mul_f32 v191, v191, v83
    v_cvt_pk_bf16_f32 v186, v188, v189
    v_cvt_pk_bf16_f32 v187, v190, v191
    s_nop 1
    v_permlane16_swap_b32 v184, v186
    v_permlane16_swap_b32 v185, v187
    buffer_store_dwordx4 v[184:187], v8, s[68:71], s73 offen offset:0 sc1
    v_mul_f32 v80, v192, v192
    v_mul_f32 v81, v193, v193
    v_mul_f32 v82, v194, v194
    v_mul_f32 v83, v195, v195
    v_fma_f32 v80, v80, s76, v84
    v_fma_f32 v81, v81, s76, v84
    v_fma_f32 v82, v82, s76, v84
    v_fma_f32 v83, v83, s76, v84
    v_mul_f32 v80, v80, v192
    v_mul_f32 v81, v81, v193
    v_mul_f32 v82, v82, v194
    v_mul_f32 v83, v83, v195
    v_exp_f32 v80, v80
    v_mul_f32 v192, v192, v208
    v_exp_f32 v81, v81
    v_mul_f32 v193, v193, v209
    v_exp_f32 v82, v82
    v_mul_f32 v194, v194, v210
    v_exp_f32 v83, v83
    v_mul_f32 v195, v195, v211
    v_add_f32 v80, 1.0, v80
    v_add_f32 v81, 1.0, v81
    v_add_f32 v82, 1.0, v82
    v_add_f32 v83, 1.0, v83
    v_rcp_f32 v80, v80
    v_rcp_f32 v81, v81
    v_rcp_f32 v82, v82
    v_rcp_f32 v83, v83
    s_nop 0
    v_mul_f32 v192, v192, v80
    v_mul_f32 v193, v193, v81
    v_mul_f32 v194, v194, v82
    v_mul_f32 v195, v195, v83
    v_cvt_pk_bf16_f32 v192, v192, v193
    v_cvt_pk_bf16_f32 v193, v194, v195
    v_mul_f32 v80, v196, v196
    v_mul_f32 v81, v197, v197
    v_mul_f32 v82, v198, v198
    v_mul_f32 v83, v199, v199
    v_fma_f32 v80, v80, s76, v84
    v_fma_f32 v81, v81, s76, v84
    v_fma_f32 v82, v82, s76, v84
    v_fma_f32 v83, v83, s76, v84
    v_mul_f32 v80, v80, v196
    v_mul_f32 v81, v81, v197
    v_mul_f32 v82, v82, v198
    v_mul_f32 v83, v83, v199
    v_exp_f32 v80, v80
    v_mul_f32 v196, v196, v212
    v_exp_f32 v81, v81
    v_mul_f32 v197, v197, v213
    v_exp_f32 v82, v82
    v_mul_f32 v198, v198, v214
    v_exp_f32 v83, v83
    v_mul_f32 v199, v199, v215
    v_add_f32 v80, 1.0, v80
    s_barrier
    s_waitcnt lgkmcnt(0)
    v_add_f32 v81, 1.0, v81
    v_add_f32 v82, 1.0, v82
    v_add_f32 v83, 1.0, v83
    v_rcp_f32 v80, v80
    v_rcp_f32 v81, v81
    v_rcp_f32 v82, v82
    v_rcp_f32 v83, v83
    s_nop 0
    v_mul_f32 v196, v196, v80
    v_mul_f32 v197, v197, v81
    v_mul_f32 v198, v198, v82
    v_mul_f32 v199, v199, v83
    v_cvt_pk_bf16_f32 v194, v196, v197
    v_cvt_pk_bf16_f32 v195, v198, v199
    s_nop 1
    v_permlane16_swap_b32 v192, v194
    v_permlane16_swap_b32 v193, v195
    buffer_store_dwordx4 v[192:195], v8, s[68:71], s73 offen offset:2048 sc1
    v_mul_f32 v80, v216, v216
    v_mul_f32 v81, v217, v217
    v_mul_f32 v82, v218, v218
    v_mul_f32 v83, v219, v219
    v_fma_f32 v80, v80, s76, v84
    v_fma_f32 v81, v81, s76, v84
    v_fma_f32 v82, v82, s76, v84
    v_fma_f32 v83, v83, s76, v84
    v_mul_f32 v80, v80, v216
    v_mul_f32 v81, v81, v217
    v_mul_f32 v82, v82, v218
    v_mul_f32 v83, v83, v219
    v_exp_f32 v80, v80
    v_mul_f32 v216, v216, v232
    v_exp_f32 v81, v81
    v_mul_f32 v217, v217, v233
    v_exp_f32 v82, v82
    v_mul_f32 v218, v218, v234
    v_exp_f32 v83, v83
    v_mul_f32 v219, v219, v235
    v_add_f32 v80, 1.0, v80
    v_add_f32 v81, 1.0, v81
    v_add_f32 v82, 1.0, v82
    v_add_f32 v83, 1.0, v83
    v_rcp_f32 v80, v80
    v_rcp_f32 v81, v81
    v_rcp_f32 v82, v82
    v_rcp_f32 v83, v83
    s_nop 0
    v_mul_f32 v216, v216, v80
    v_mul_f32 v217, v217, v81
    v_mul_f32 v218, v218, v82
    v_mul_f32 v219, v219, v83
    v_cvt_pk_bf16_f32 v216, v216, v217
    v_cvt_pk_bf16_f32 v217, v218, v219
    v_mul_f32 v80, v220, v220
    v_mul_f32 v81, v221, v221
    v_mul_f32 v82, v222, v222
    v_mul_f32 v83, v223, v223
    v_fma_f32 v80, v80, s76, v84
    v_fma_f32 v81, v81, s76, v84
    v_fma_f32 v82, v82, s76, v84
    v_fma_f32 v83, v83, s76, v84
    v_mul_f32 v80, v80, v220
    v_mul_f32 v81, v81, v221
    v_mul_f32 v82, v82, v222
    v_mul_f32 v83, v83, v223
    v_exp_f32 v80, v80
    v_mul_f32 v220, v220, v236
    v_exp_f32 v81, v81
    s_lshl2_add_u32 s91, s2, s4
    s_lshl_b32 s39, s91, 9
    s_lshr_b32 s92, s91, 2
    s_mul_i32 s92, s92, 7168
    s_and_b32 s91, s91, 3
    s_lshl_b32 s91, s91, 9
    s_add_u32 s92, s92, s91
    s_add_u32 s34, s92, 5120
    s_add_u32 s39, s39, 0x200000
    s_load_dword s94, s[20:21], s39 offset:0x0
    s_load_dword s94, s[20:21], s39 offset:0x40
    s_load_dword s94, s[20:21], s39 offset:0x80
    s_load_dword s94, s[20:21], s39 offset:0xc0
    s_barrier
    v_mul_f32 v221, v221, v237
    v_exp_f32 v82, v82
    v_mul_f32 v222, v222, v238
    v_exp_f32 v83, v83
    v_mul_f32 v223, v223, v239
    v_add_f32 v80, 1.0, v80
    v_add_f32 v81, 1.0, v81
    v_add_f32 v82, 1.0, v82
    v_add_f32 v83, 1.0, v83
    v_rcp_f32 v80, v80
    v_rcp_f32 v81, v81
    v_rcp_f32 v82, v82
    v_rcp_f32 v83, v83
    s_nop 0
    v_mul_f32 v220, v220, v80
    v_mul_f32 v221, v221, v81
    v_mul_f32 v222, v222, v82
    v_mul_f32 v223, v223, v83
    v_cvt_pk_bf16_f32 v218, v220, v221
    v_cvt_pk_bf16_f32 v219, v222, v223
    s_nop 1
    v_permlane16_swap_b32 v216, v218
    v_permlane16_swap_b32 v217, v219
    buffer_store_dwordx4 v[216:219], v8, s[68:71], s74 offen offset:0 sc1
    v_mul_f32 v80, v224, v224
    v_mul_f32 v81, v225, v225
    v_mul_f32 v82, v226, v226
    v_mul_f32 v83, v227, v227
    v_fma_f32 v80, v80, s76, v84
    v_fma_f32 v81, v81, s76, v84
    v_fma_f32 v82, v82, s76, v84
    v_fma_f32 v83, v83, s76, v84
    v_mul_f32 v80, v80, v224
    v_mul_f32 v81, v81, v225
    v_mul_f32 v82, v82, v226
    v_mul_f32 v83, v83, v227
    v_exp_f32 v80, v80
    v_mul_f32 v224, v224, v240
    v_exp_f32 v81, v81
    v_mul_f32 v225, v225, v241
    v_exp_f32 v82, v82
    v_mul_f32 v226, v226, v242
    v_exp_f32 v83, v83
    v_mul_f32 v227, v227, v243
    v_add_f32 v80, 1.0, v80
    v_add_f32 v81, 1.0, v81
    v_add_f32 v82, 1.0, v82
    v_add_f32 v83, 1.0, v83
    v_rcp_f32 v80, v80
    v_rcp_f32 v81, v81
    v_rcp_f32 v82, v82
    v_rcp_f32 v83, v83
    s_nop 0
    v_mul_f32 v224, v224, v80
    v_mul_f32 v225, v225, v81
    v_mul_f32 v226, v226, v82
    v_mul_f32 v227, v227, v83
    v_cvt_pk_bf16_f32 v224, v224, v225
    v_cvt_pk_bf16_f32 v225, v226, v227
    v_mul_f32 v80, v228, v228
    v_mul_f32 v81, v229, v229
    v_mul_f32 v82, v230, v230
    v_mul_f32 v83, v231, v231
    v_fma_f32 v80, v80, s76, v84
    v_fma_f32 v81, v81, s76, v84
    v_fma_f32 v82, v82, s76, v84
    v_fma_f32 v83, v83, s76, v84
    s_load_dword s94, s[20:21], s39 offset:0x100
    s_load_dword s94, s[20:21], s39 offset:0x140
    s_load_dword s94, s[20:21], s39 offset:0x180
    s_load_dword s94, s[20:21], s39 offset:0x1c0
    s_barrier
    v_mul_f32 v80, v80, v228
    v_mul_f32 v81, v81, v229
    v_mul_f32 v82, v82, v230
    v_mul_f32 v83, v83, v231
    v_exp_f32 v80, v80
    v_mul_f32 v228, v228, v244
    v_exp_f32 v81, v81
    v_mul_f32 v229, v229, v245
    v_exp_f32 v82, v82
    v_mul_f32 v230, v230, v246
    v_exp_f32 v83, v83
    v_mul_f32 v231, v231, v247
    v_add_f32 v80, 1.0, v80
    v_add_f32 v81, 1.0, v81
    v_add_f32 v82, 1.0, v82
    v_add_f32 v83, 1.0, v83
    v_rcp_f32 v80, v80
    v_rcp_f32 v81, v81
    v_rcp_f32 v82, v82
    v_rcp_f32 v83, v83
    s_nop 0
    v_mul_f32 v228, v228, v80
    v_mul_f32 v229, v229, v81
    v_mul_f32 v230, v230, v82
    v_mul_f32 v231, v231, v83
    v_cvt_pk_bf16_f32 v226, v228, v229
    v_cvt_pk_bf16_f32 v227, v230, v231
    s_nop 1
    v_permlane16_swap_b32 v224, v226
    v_permlane16_swap_b32 v225, v227
    buffer_store_dwordx4 v[224:227], v8, s[68:71], s74 offen offset:2048 sc1
L_pad10:
    s_cbranch_execz L_vret2
    v_lshrrev_b32 v64, 4, v1
    v_and_b32 v66, 14, v1
    v_lshlrev_b32 v64, 2, v64
    v_sub_u32 v64, v66, v64
    v_and_b32 v65, 1, v1
    v_cmp_le_i32 s[40:41], 0, v64
    v_cmp_le_i32 s[42:43], 2, v64
    v_mul_u32_u24 v66, 0x202, v65
    s_mov_b32 s80, 0x01000c0c
    v_lshl_add_u32 v66, v66, 16, s80
    v_add_u32 v67, 0x04040000, v66
    v_cndmask_b32 v76, v66, v67, s[40:41]
    v_cndmask_b32 v77, v66, v67, s[42:43]
    v_lshlrev_b32 v65, 4, v65
    v_mov_b32 v68, 0x0c0c0c0c
    v_mov_b32 v66, 0xc0c0100
    v_alignbit_b32 v66, v66, v66, v65
    v_cndmask_b32 v78, v66, v68, s[40:41]
    v_cndmask_b32 v86, v68, v66, s[40:41]
    v_mov_b32 v66, 0xc0c0302
    v_alignbit_b32 v66, v66, v66, v65
    v_cndmask_b32 v79, v66, v68, s[42:43]
    v_cndmask_b32 v87, v68, v66, s[42:43]
    s_or_b32 s80, s28, s5
    s_cmp_eq_u32 s80, 0
    s_cselect_b64 s[80:81], 0, -1
    s_or_b64 s[40:41], s[40:41], s[80:81]
    s_or_b64 s[42:43], s[42:43], s[80:81]
    v_mov_b32 v7, 0xce6e6b28
    s_mov_b32 s77, 0x3e3504f3
    s_mov_b32 s78, 0x3fb8aa3b
    v_cvt_pk_bf16_f32 v88, v88, v89
    v_cvt_pk_bf16_f32 v89, v90, v91
    v_cvt_pk_bf16_f32 v90, v104, v105
    v_cvt_pk_bf16_f32 v91, v106, v107
    v_cvt_pk_bf16_f32 v152, v152, v153
    v_cvt_pk_bf16_f32 v153, v154, v155
    v_cvt_pk_bf16_f32 v154, v168, v169
    v_cvt_pk_bf16_f32 v155, v170, v171
    v_cvt_pk_bf16_f32 v92, v92, v93
    v_cvt_pk_bf16_f32 v93, v94, v95
    v_cvt_pk_bf16_f32 v94, v108, v109
    v_cvt_pk_bf16_f32 v95, v110, v111
    v_cvt_pk_bf16_f32 v156, v156, v157
    v_cvt_pk_bf16_f32 v157, v158, v159
    v_cvt_pk_bf16_f32 v158, v172, v173
    v_cvt_pk_bf16_f32 v159, v174, v175
    s_add_u32 s39, s39, 0x280000
    s_load_dword s94, s[20:21], s39 offset:0x0
    s_load_dword s94, s[20:21], s39 offset:0x40
    s_load_dword s94, s[20:21], s39 offset:0x80
    s_load_dword s94, s[20:21], s39 offset:0xc0
    s_barrier
    s_setprio 3
    v_mfma_f32_16x16x32_bf16 v[48:51], v[44:47], v[152:155], 0
    v_mfma_f32_16x16x32_bf16 v[52:55], v[88:91], v[152:155], 0
    s_setprio 0
    v_cvt_pk_bf16_f32 v96, v96, v97
    v_cvt_pk_bf16_f32 v97, v98, v99
    v_cvt_pk_bf16_f32 v98, v112, v113
    v_cvt_pk_bf16_f32 v99, v114, v115
    v_cvt_pk_bf16_f32 v160, v160, v161
    v_cvt_pk_bf16_f32 v161, v162, v163
    v_cvt_pk_bf16_f32 v162, v176, v177
    v_cvt_pk_bf16_f32 v163, v178, v179
    s_setprio 3
    v_mfma_f32_16x16x32_bf16 v[56:59], v[88:91], v[156:159], 0
    v_mfma_f32_16x16x32_bf16 v[60:63], v[92:95], v[156:159], 0
    s_setprio 0
    v_cvt_pk_bf16_f32 v48, v48, v49
    v_cvt_pk_bf16_f32 v49, v50, v51
    v_cvt_pk_bf16_f32 v50, v52, v53
    v_cvt_pk_bf16_f32 v51, v54, v55
    v_perm_b32 v64, v50, v48, v76
    v_perm_b32 v65, v51, v49, v77
    v_mul_f32 v64, s77, v64
    v_mul_f32 v65, s77, v65
    v_cvt_pk_bf16_f32 v65, v64, v65
    v_lshlrev_b32 v64, 16, v65
    v_and_b32 v65, 0xffff0000, v65
    v_cndmask_b32 v64, v7, v64, s[40:41]
    v_cndmask_b32 v65, v7, v65, s[42:43]
    v_max_f32 v72, v64, v65
    v_cvt_pk_bf16_f32 v164, v164, v165
    v_cvt_pk_bf16_f32 v165, v166, v167
    v_cvt_pk_bf16_f32 v166, v180, v181
    v_cvt_pk_bf16_f32 v167, v182, v183
    s_setprio 3
    v_mfma_f32_16x16x32_bf16 v[48:51], v[92:95], v[160:163], 0
    v_mfma_f32_16x16x32_bf16 v[52:55], v[96:99], v[160:163], 0
    s_setprio 0
    v_cvt_pk_bf16_f32 v56, v56, v57
    v_cvt_pk_bf16_f32 v57, v58, v59
    v_cvt_pk_bf16_f32 v58, v60, v61
    v_cvt_pk_bf16_f32 v59, v62, v63
    v_perm_b32 v66, v58, v56, v76
    v_perm_b32 v67, v59, v57, v77
    v_mul_f32 v66, s77, v66
    v_mul_f32 v67, s77, v67
    v_cvt_pk_bf16_f32 v67, v66, v67
    v_lshlrev_b32 v66, 16, v67
    v_and_b32 v67, 0xffff0000, v67
    v_max_f32 v73, v66, v67
    s_setprio 3
    v_mfma_f32_16x16x32_bf16 v[56:59], v[96:99], v[164:167], 0
    v_mfma_f32_16x16x32_bf16 v[60:63], v[100:103], v[164:167], 0
    s_setprio 0
    v_cvt_pk_bf16_f32 v26, v120, v121
    v_cvt_pk_bf16_f32 v27, v122, v123
    v_cvt_pk_bf16_f32 v36, v136, v137
    v_cvt_pk_bf16_f32 v37, v138, v139
    s_load_dword s94, s[20:21], s39 offset:0x100
    s_load_dword s94, s[20:21], s39 offset:0x140
    s_load_dword s94, s[20:21], s39 offset:0x180
    s_load_dword s94, s[20:21], s39 offset:0x1c0
    s_barrier
    v_cvt_pk_bf16_f32 v28, v124, v125
    v_cvt_pk_bf16_f32 v29, v126, v127
    v_cvt_pk_bf16_f32 v38, v140, v141
    v_cvt_pk_bf16_f32 v39, v142, v143
    v_cvt_pk_bf16_f32 v30, v128, v129
    v_cvt_pk_bf16_f32 v31, v130, v131
    v_cvt_pk_bf16_f32 v40, v144, v145
    v_cvt_pk_bf16_f32 v41, v146, v147
    v_cvt_pk_bf16_f32 v48, v48, v49
    v_cvt_pk_bf16_f32 v49, v50, v51
    v_cvt_pk_bf16_f32 v50, v52, v53
    v_cvt_pk_bf16_f32 v51, v54, v55
    v_perm_b32 v68, v50, v48, v76
    v_perm_b32 v69, v51, v49, v77
    v_mul_f32 v68, s77, v68
    v_mul_f32 v69, s77, v69
    v_cvt_pk_bf16_f32 v69, v68, v69
    v_lshlrev_b32 v68, 16, v69
    v_and_b32 v69, 0xffff0000, v69
    v_max_f32 v74, v68, v69
    v_cvt_pk_bf16_f32 v56, v56, v57
    v_cvt_pk_bf16_f32 v57, v58, v59
    v_cvt_pk_bf16_f32 v58, v60, v61
    v_cvt_pk_bf16_f32 v59, v62, v63
    v_perm_b32 v70, v58, v56, v76
    v_perm_b32 v71, v59, v57, v77
    v_mul_f32 v70, s77, v70
    v_mul_f32 v71, s77, v71
    v_cvt_pk_bf16_f32 v71, v70, v71
    v_lshlrev_b32 v70, 16, v71
    v_and_b32 v71, 0xffff0000, v71
    v_max_f32 v75, v70, v71
    v_permlane32_swap_b32 v72, v73
    v_max_f32 v72, v72, v73
    v_permlane32_swap_b32 v74, v75
    v_max_f32 v74, v74, v75
    s_nop 1
    v_permlane16_swap_b32 v72, v74
    v_max_f32 v72, v72, v74
    v_mov_b32 v74, v72
    s_nop 1
    v_permlane16_swap_b32 v72, v74
    v_mov_b32 v73, v72
    v_mov_b32 v75, v74
    s_nop 0
    v_permlane32_swap_b32 v72, v73
    v_permlane32_swap_b32 v74, v75
    v_sub_f32 v64, v64, v72
    v_sub_f32 v65, v65, v72
    v_sub_f32 v66, v66, v73
    v_sub_f32 v67, v67, v73
    v_sub_f32 v68, v68, v74
    v_sub_f32 v69, v69, v74
    v_sub_f32 v70, v70, v75
    v_sub_f32 v71, v71, v75
    v_mul_f32 v64, s78, v64
    v_mul_f32 v65, s78, v65
    v_mul_f32 v66, s78, v66
    v_mul_f32 v67, s78, v67
    v_mul_f32 v68, s78, v68
    v_mul_f32 v69, s78, v69
    v_mul_f32 v70, s78, v70
    v_mul_f32 v71, s78, v71
    v_exp_f32 v64, v64
    v_exp_f32 v65, v65
    v_exp_f32 v66, v66
    v_exp_f32 v67, v67
    v_exp_f32 v68, v68
    v_exp_f32 v69, v69
    v_exp_f32 v70, v70
    v_exp_f32 v71, v71
    v_add_f32 v72, v64, v65
    v_add_f32 v73, v66, v67
    s_load_dword s94, s[20:21], s39 offset:0x80000
    s_load_dword s94, s[20:21], s39 offset:0x80040
    s_load_dword s94, s[20:21], s39 offset:0x80080
    s_load_dword s94, s[20:21], s39 offset:0x800c0
    s_lshl4_add_u32 s91, s28, s29
    s_lshl_b32 s91, s91, 7
    s_add_u32 s92, s91, 0x1ea8000
    s_xor_b32 s91, s91, 17408
    s_add_u32 s91, s91, 0x1ea8000
    v_mov_b32 v23, s92
    v_writelane_b32 v23, s91, 1
    s_mov_b64 exec, 3
    global_load_dwordx3 v[20:22], v23, s[26:27] sc1
    s_mov_b64 exec, -1
    s_barrier
    v_add_f32 v74, v68, v69
    v_add_f32 v75, v70, v71
    v_permlane32_swap_b32 v72, v73
    v_add_f32 v72, v72, v73
    v_permlane32_swap_b32 v74, v75
    v_add_f32 v74, v74, v75
    s_nop 1
    v_permlane16_swap_b32 v72, v74
    v_add_f32 v72, v72, v74
    v_rcp_f32 v72, v72
    s_nop 0
    v_mov_b32 v74, v72
    s_nop 1
    v_permlane16_swap_b32 v72, v74
    v_mov_b32 v73, v72
    v_mov_b32 v75, v74
    s_nop 0
    v_permlane32_swap_b32 v72, v73
    v_permlane32_swap_b32 v74, v75
    v_mul_f32 v64, v64, v72
    v_mul_f32 v65, v65, v72
    v_mul_f32 v66, v66, v73
    v_mul_f32 v67, v67, v73
    v_mul_f32 v68, v68, v74
    v_mul_f32 v69, v69, v74
    v_mul_f32 v70, v70, v75
    v_mul_f32 v71, v71, v75
    v_cvt_pk_bf16_f32 v72, v64, v65
    v_cvt_pk_bf16_f32 v73, v66, v67
    v_cvt_pk_bf16_f32 v74, v68, v69
    v_cvt_pk_bf16_f32 v75, v70, v71
    v_perm_b32 v152, v72, v72, v78
    v_perm_b32 v153, v72, v72, v79
    v_perm_b32 v154, v72, v72, v86
    v_perm_b32 v155, v72, v72, v87
    v_perm_b32 v156, v73, v73, v78
    v_perm_b32 v157, v73, v73, v79
    v_perm_b32 v158, v73, v73, v86
    v_perm_b32 v159, v73, v73, v87
    s_setprio 3
    v_mfma_f32_16x16x32_bf16 v[48:51], v[24:27], v[152:155], 0
    v_mfma_f32_16x16x32_bf16 v[52:55], v[34:37], v[152:155], 0
    s_setprio 0
    v_perm_b32 v160, v74, v74, v78
    v_perm_b32 v161, v74, v74, v79
    v_perm_b32 v162, v74, v74, v86
    v_perm_b32 v163, v74, v74, v87
    s_setprio 3
    v_mfma_f32_16x16x32_bf16 v[56:59], v[26:29], v[156:159], 0
    v_mfma_f32_16x16x32_bf16 v[60:63], v[36:39], v[156:159], 0
    s_setprio 0
    v_perm_b32 v164, v75, v75, v78
    v_perm_b32 v165, v75, v75, v79
    v_perm_b32 v166, v75, v75, v86
    v_perm_b32 v167, v75, v75, v87
    v_cvt_pk_bf16_f32 v168, v48, v49
    v_cvt_pk_bf16_f32 v169, v50, v51
    v_cvt_pk_bf16_f32 v170, v52, v53
    v_cvt_pk_bf16_f32 v171, v54, v55
    s_setprio 3
    v_mfma_f32_16x16x32_bf16 v[48:51], v[28:31], v[160:163], 0
    v_mfma_f32_16x16x32_bf16 v[52:55], v[38:41], v[160:163], 0
    s_load_dword s94, s[20:21], s39 offset:0x80100
    s_load_dword s94, s[20:21], s39 offset:0x80140
    s_load_dword s94, s[20:21], s39 offset:0x80180
    s_load_dword s94, s[20:21], s39 offset:0x801c0
    s_waitcnt vmcnt(1)
    s_barrier
    s_lshl1_add_u32 m0, s33, 81920
    s_nop 0
    buffer_load_dwordx4 v11, s[60:63], s83 offen lds
    s_setprio 0
    v_cvt_pk_bf16_f32 v172, v56, v57
    v_cvt_pk_bf16_f32 v173, v58, v59
    v_cvt_pk_bf16_f32 v174, v60, v61
    v_cvt_pk_bf16_f32 v175, v62, v63
    s_setprio 3
    v_mfma_f32_16x16x32_bf16 v[56:59], v[30:33], v[164:167], 0
    v_mfma_f32_16x16x32_bf16 v[60:63], v[40:43], v[164:167], 0
    s_setprio 0
    v_permlane16_swap_b32 v168, v170
    v_permlane16_swap_b32 v169, v171
    buffer_store_dwordx4 v[168:171], v0, s[68:71], s75 offen offset:0 sc1
    v_permlane16_swap_b32 v172, v174
    v_permlane16_swap_b32 v173, v175
    buffer_store_dwordx4 v[172:175], v0, s[68:71], s75 offen offset:1024 sc1
    v_cvt_pk_bf16_f32 v176, v48, v49
    v_cvt_pk_bf16_f32 v177, v50, v51
    v_cvt_pk_bf16_f32 v178, v52, v53
    v_cvt_pk_bf16_f32 v179, v54, v55
    v_cvt_pk_bf16_f32 v180, v56, v57
    v_cvt_pk_bf16_f32 v181, v58, v59
    v_cvt_pk_bf16_f32 v182, v60, v61
    v_cvt_pk_bf16_f32 v183, v62, v63
    v_permlane16_swap_b32 v176, v178
    v_permlane16_swap_b32 v177, v179
    buffer_store_dwordx4 v[176:179], v0, s[68:71], s75 offen offset:2048 sc1
    v_permlane16_swap_b32 v180, v182
    v_permlane16_swap_b32 v181, v183
    buffer_store_dwordx4 v[180:183], v0, s[68:71], s75 offen offset:3072 sc1
    s_lshl1_add_u32 m0, s33, 82944
    s_nop 0
    buffer_load_dwordx4 v12, s[60:63], s83 offen lds
    v_lshrrev_b32 v64, 4, v1
    v_bfe_u32 v65, v1, 2, 2
    v_and_b32 v66, 3, v1
    v_and_b32 v67, 15, v1
    v_lshrrev_b32 v68, 3, v1
    v_and_b32 v69, 7, v1
    s_lshl_b32 s85, s6, 2
    v_lshl_add_u32 v70, v64, 3, v65
    v_lshlrev_b32 v70, 7, v70
    s_lshl1_add_u32 m0, s33, 90112
    s_nop 0
    buffer_load_dwordx4 v11, s[64:67], s83 offen lds
    v_and_b32 v71, 1, v66
    v_lshl_add_u32 v70, v71, 3, v70
    v_add_u32 v70, 0, v70
    v_and_b32 v71, 2, v65
    v_and_b32 v72, 1, v64
    v_lshl_add_u32 v71, v72, 2, v71
    v_lshrrev_b32 v72, 1, v66
    v_xor_b32 v71, v71, v72
    v_xor_b32 v71, s85, v71
    v_xor_b32 v72, 0, v71
    v_lshl_add_u32 v80, v72, 4, v70
    v_add_u32 v82, 49152, v80
    v_add_u32 v84, 98304, v80
    v_xor_b32 v72, 2, v71
    v_lshl_add_u32 v81, v72, 4, v70
    v_add_u32 v83, 49152, v81
    s_lshl1_add_u32 m0, s33, 91136
    s_nop 0
    buffer_load_dwordx4 v12, s[64:67], s83 offen lds
    s_add_u32 s83, s83, 131072
    v_add_u32 v85, 98304, v81
    s_lshl_b32 s85, s5, 12
    v_lshl_add_u32 v48, v1, 4, s85
    v_add_u32 v49, 49152, v48
    v_add_u32 v50, 98304, v48
    v_mov_b32 v88, 0
    v_mov_b32 v89, 0
    v_mov_b32 v90, 0
    v_mov_b32 v91, 0
    v_mov_b32 v92, 0
    v_mov_b32 v93, 0
    v_mov_b32 v94, 0
    v_mov_b32 v95, 0
    v_mov_b32 v96, 0
    v_mov_b32 v97, 0
    v_mov_b32 v98, 0
    v_mov_b32 v99, 0
    v_mov_b32 v100, 0
    v_mov_b32 v101, 0
    v_mov_b32 v102, 0
    v_mov_b32 v103, 0
    v_mov_b32 v104, 0
    v_mov_b32 v105, 0
    v_mov_b32 v106, 0
    v_mov_b32 v107, 0
    s_add_u32 s39, s39, 0x180000
    s_load_dword s94, s[20:21], s39 offset:0x0
    s_load_dword s94, s[20:21], s39 offset:0x40
    s_load_dword s94, s[20:21], s39 offset:0x80
    s_load_dword s94, s[20:21], s39 offset:0xc0
    s_cmp_lg_u32 s4, 0
    s_cbranch_scc1 L_fH2
    s_lshl_b32 s91, s28, 4
    s_add_u32 s91, s91, s29
    s_lshl_b32 s91, s91, 7
    s_add_u32 s91, s91, 0x1e90000
    v_mov_b32 v16, s91
    v_mov_b32 v18, s100
    v_mov_b32 v19, s101
    s_mov_b64 exec, 1
    global_store_dwordx2 v16, v[18:19], s[26:27] sc1
    s_mov_b64 exec, -1
L_fH2:
    s_waitcnt vmcnt(8)
    s_mov_b64 exec, 3
    s_movk_i32 s98, 0x4000
L_pT_chk:
    v_cmp_ne_u64 vcc, s[100:101], v[20:21]
    s_nop 1
    s_cmp_eq_u64 vcc, 0
    s_cbranch_scc1 L_pT_ok
    s_sub_u32 s98, s98, 1
    s_cbranch_scc1 L_pT_ok
    s_sleep 1
    global_load_dwordx3 v[20:22], v23, s[26:27] sc1
    s_waitcnt vmcnt(0)
    s_branch L_pT_chk
L_pT_ok:
    s_mov_b64 exec, -1
    v_readlane_b32 s90, v22, 0
    v_readlane_b32 s91, v22, 1
    s_nop 1
    s_sub_u32 s90, s91, s90
    s_abs_i32 s91, s90
    s_min_u32 s91, s91, 0x1000
    s_add_u32 s91, s91, 35
    s_mul_i32 s91, s91, 937
    s_lshr_b32 s91, s91, 16
    s_min_u32 s91, s91, 4
    s_sub_u32 s92, 0, s91
    s_cmp_lt_i32 s90, 0
    s_cselect_b32 s91, s92, s91
    s_add_u32 s50, s91, 4
    s_and_b32 s91, s91, 3
    s_mov_b32 s46, 0x58458458
    s_mov_b32 s47, 0x4584584
    s_cmp_eq_u32 s91, 1
    s_cselect_b32 s46, 0xc22c22c4, s46
    s_cselect_b32 s47, 0x22c22c22, s47
    s_cmp_eq_u32 s91, 2
    s_cselect_b32 s46, 0x116222c4, s46
    s_cselect_b32 s47, 0x16116116, s47
    s_cmp_eq_u32 s91, 3
    s_cselect_b32 s46, 0x116222c4, s46
    s_cselect_b32 s47, 0x308b08b1, s47
    s_movk_i32 s44, 0x4000
    s_mov_b32 s45, 131072
    s_barrier
    s_lshl_b32 s48, s46, 15
    s_and_b32 s48, s48, 0x38000
    s_lshr_b64 s[46:47], s[46:47], 3
    s_lshl2_add_u32 m0, s33, s48
    s_lshl1_add_u32 s49, s33, s48
    buffer_load_dwordx4 v10, s[56:59], s82 offen offset:0 sc1 lds
    v_mov_b32 v108, 0
    v_mov_b32 v109, 0
    v_mov_b32 v110, 0
    v_mov_b32 v111, 0
    v_mov_b32 v112, 0
    v_mov_b32 v113, 0
    v_mov_b32 v114, 0
    v_mov_b32 v115, 0
    v_mov_b32 v116, 0
    v_mov_b32 v117, 0
    v_mov_b32 v118, 0
    v_mov_b32 v119, 0
    s_lshl_b32 s84, s4, 12
    s_add_u32 s84, s84, 147456
    v_lshl_add_u32 v3, v1, 3, s84
    v_lshrrev_b32 v70, 1, v64
    v_xor_b32 v70, v70, v65
    v_lshl_add_u32 v70, v70, 4, s84
    buffer_load_dwordx4 v10, s[56:59], s82 offen offset:1024 sc1 lds
    v_lshl_add_u32 v70, v67, 6, v70
    v_and_b32 v71, 1, v64
    v_lshl_add_u32 v14, v71, 3, v70
    v_xor_b32 v15, 32, v14
    v_xor_b32 v70, v66, v64
    v_lshl_add_u32 v70, v70, 4, s84
    v_lshrrev_b32 v71, 2, v1
    v_lshl_add_u32 v17, v71, 6, v70
    buffer_load_dwordx4 v10, s[56:59], s82 offen offset:2048 sc1 lds
    s_mov_b32 s72, s8
    s_mov_b32 s73, s9
    s_mov_b32 s74, 0x400000
    s_mov_b32 s75, 0x20000
    buffer_load_dwordx4 v10, s[56:59], s82 offen offset:3072 sc1 lds
    s_add_u32 s82, s82, s44
    s_add_u32 m0, s49, 16384
    s_nop 0
    buffer_load_dwordx4 v11, s[60:63], s83 offen lds
    s_add_u32 m0, s49, 17408
    s_nop 0
    buffer_load_dwordx4 v12, s[60:63], s83 offen lds
    s_add_u32 m0, s49, 24576
    s_nop 0
    buffer_load_dwordx4 v11, s[64:67], s83 offen lds
    s_add_u32 m0, s49, 25600
    s_nop 0
    buffer_load_dwordx4 v12, s[64:67], s83 offen lds
    s_add_u32 s83, s83, s45
    s_load_dword s94, s[20:21], s39 offset:0x100
    s_load_dword s94, s[20:21], s39 offset:0x140
    s_load_dword s94, s[20:21], s39 offset:0x180
    s_load_dword s94, s[20:21], s39 offset:0x1c0
    s_barrier
    s_lshl_b32 s48, s46, 15
    s_and_b32 s48, s48, 0x38000
    s_lshr_b64 s[46:47], s[46:47], 3
    s_lshl2_add_u32 m0, s33, s48
    s_lshl1_add_u32 s49, s33, s48
    buffer_load_dwordx4 v10, s[56:59], s82 offen offset:0 sc1 lds
    buffer_load_dwordx4 v10, s[56:59], s82 offen offset:1024 sc1 lds
    buffer_load_dwordx4 v10, s[56:59], s82 offen offset:2048 sc1 lds
    buffer_load_dwordx4 v10, s[56:59], s82 offen offset:3072 sc1 lds
    s_add_u32 s82, s82, s44
    s_add_u32 m0, s49, 16384
    s_nop 0
    buffer_load_dwordx4 v11, s[60:63], s83 offen lds
    s_add_u32 m0, s49, 17408
    s_nop 0
    buffer_load_dwordx4 v12, s[60:63], s83 offen lds
    s_add_u32 m0, s49, 24576
    s_nop 0
    buffer_load_dwordx4 v11, s[64:67], s83 offen lds
    s_add_u32 m0, s49, 25600
    s_nop 0
    buffer_load_dwordx4 v12, s[64:67], s83 offen lds
    s_add_u32 s83, s83, s45
    s_add_u32 s39, s39, 0xfff80000
    s_load_dword s94, s[20:21], s39 offset:0x0
    s_load_dword s94, s[20:21], s39 offset:0x40
    s_load_dword s94, s[20:21], s39 offset:0x80
    s_load_dword s94, s[20:21], s39 offset:0xc0
    s_waitcnt vmcnt(16)
    s_barrier
    s_lshl_b32 s48, s46, 15
    s_and_b32 s48, s48, 0x38000
    s_lshr_b64 s[46:47], s[46:47], 3
    s_lshl2_add_u32 m0, s33, s48
    s_lshl1_add_u32 s49, s33, s48
    buffer_load_dwordx4 v10, s[56:59], s82 offen offset:0 sc1 lds
    buffer_load_dwordx4 v10, s[56:59], s82 offen offset:1024 sc1 lds
    buffer_load_dwordx4 v10, s[56:59], s82 offen offset:2048 sc1 lds
    buffer_load_dwordx4 v10, s[56:59], s82 offen offset:3072 sc1 lds
    s_add_u32 s82, s82, s44
    s_add_u32 m0, s49, 16384
    s_nop 0
    buffer_load_dwordx4 v11, s[60:63], s83 offen lds
    s_add_u32 m0, s49, 17408
    s_nop 0
    buffer_load_dwordx4 v12, s[60:63], s83 offen lds
    s_add_u32 m0, s49, 24576
    s_nop 0
    buffer_load_dwordx4 v11, s[64:67], s83 offen lds
    s_add_u32 m0, s49, 25600
    s_nop 0
    buffer_load_dwordx4 v12, s[64:67], s83 offen lds
    s_add_u32 s83, s83, s45
    s_load_dword s94, s[20:21], s39 offset:0x100
    s_load_dword s94, s[20:21], s39 offset:0x140
    s_load_dword s94, s[20:21], s39 offset:0x180
    s_load_dword s94, s[20:21], s39 offset:0x1c0
    s_waitcnt vmcnt(16)
    s_barrier
    s_lshl_b32 s48, s46, 15
    s_and_b32 s48, s48, 0x38000
    s_lshr_b64 s[46:47], s[46:47], 3
    s_lshl2_add_u32 m0, s33, s48
    s_lshl1_add_u32 s49, s33, s48
    buffer_load_dwordx4 v10, s[56:59], s82 offen offset:0 sc1 lds
    buffer_load_dwordx4 v10, s[56:59], s82 offen offset:1024 sc1 lds
    buffer_load_dwordx4 v10, s[56:59], s82 offen offset:2048 sc1 lds
    buffer_load_dwordx4 v10, s[56:59], s82 offen offset:3072 sc1 lds
    s_add_u32 s82, s82, s44
    s_add_u32 m0, s49, 16384
    s_nop 0
    buffer_load_dwordx4 v11, s[60:63], s83 offen lds
    s_add_u32 m0, s49, 17408
    s_nop 0
    buffer_load_dwordx4 v12, s[60:63], s83 offen lds
    s_add_u32 m0, s49, 24576
    s_nop 0
    buffer_load_dwordx4 v11, s[64:67], s83 offen lds
    s_add_u32 m0, s49, 25600
    s_nop 0
    buffer_load_dwordx4 v12, s[64:67], s83 offen lds
    s_add_u32 s83, s83, s45
    s_add_u32 s39, s39, 0x100000
    s_load_dword s94, s[20:21], s39 offset:0x0
    s_load_dword s94, s[20:21], s39 offset:0x40
    s_load_dword s94, s[20:21], s39 offset:0x80
    s_load_dword s94, s[20:21], s39 offset:0xc0
    s_waitcnt vmcnt(16)
    s_barrier
    s_lshl_b32 s48, s46, 15
    s_and_b32 s48, s48, 0x38000
    s_lshr_b64 s[46:47], s[46:47], 3
    s_lshl2_add_u32 m0, s33, s48
    s_lshl1_add_u32 s49, s33, s48
    buffer_load_dwordx4 v10, s[56:59], s82 offen offset:0 sc1 lds
    buffer_load_dwordx4 v10, s[56:59], s82 offen offset:1024 sc1 lds
    buffer_load_dwordx4 v10, s[56:59], s82 offen offset:2048 sc1 lds
    buffer_load_dwordx4 v10, s[56:59], s82 offen offset:3072 sc1 lds
    s_add_u32 s82, s82, s44
    s_add_u32 m0, s49, 16384
    s_nop 0
    buffer_load_dwordx4 v11, s[60:63], s83 offen lds
    s_add_u32 m0, s49, 17408
    s_nop 0
    buffer_load_dwordx4 v12, s[60:63], s83 offen lds
    s_add_u32 m0, s49, 24576
    s_nop 0
    buffer_load_dwordx4 v11, s[64:67], s83 offen lds
    s_add_u32 m0, s49, 25600
    s_nop 0
    buffer_load_dwordx4 v12, s[64:67], s83 offen lds
    s_add_u32 s83, s83, s45
    s_load_dword s94, s[20:21], s39 offset:0x100
    s_load_dword s94, s[20:21], s39 offset:0x140
    s_load_dword s94, s[20:21], s39 offset:0x180
    s_load_dword s94, s[20:21], s39 offset:0x1c0
    s_waitcnt vmcnt(43)
    s_waitcnt vmcnt(16)
    s_barrier
    s_lshl_b32 s48, s46, 15
    s_and_b32 s48, s48, 0x38000
    s_lshr_b64 s[46:47], s[46:47], 3
    s_lshl2_add_u32 m0, s33, s48
    s_lshl1_add_u32 s49, s33, s48
    buffer_load_dwordx4 v10, s[56:59], s82 offen offset:0 sc1 lds
    buffer_load_dwordx4 v10, s[56:59], s82 offen offset:1024 sc1 lds
    buffer_load_dwordx4 v10, s[56:59], s82 offen offset:2048 sc1 lds
    buffer_load_dwordx4 v10, s[56:59], s82 offen offset:3072 sc1 lds
    s_add_u32 s82, s82, s44
    s_add_u32 m0, s49, 16384
    s_nop 0
    buffer_load_dwordx4 v11, s[60:63], s83 offen lds
    s_add_u32 m0, s49, 17408
    s_nop 0
    buffer_load_dwordx4 v12, s[60:63], s83 offen lds
    s_add_u32 m0, s49, 24576
    s_nop 0
    buffer_load_dwordx4 v11, s[64:67], s83 offen lds
    s_add_u32 m0, s49, 25600
    s_nop 0
    buffer_load_dwordx4 v12, s[64:67], s83 offen lds
    s_add_u32 s83, s83, s45
    s_add_u32 s39, s39, 0xff980000
    s_load_dword s94, s[12:13], s39 offset:0x0
    s_load_dword s94, s[12:13], s39 offset:0x40
    s_load_dword s94, s[12:13], s39 offset:0x80
    s_load_dword s94, s[12:13], s39 offset:0xc0
    s_lshl2_add_u32 s91, s30, s4
    s_lshl_b32 s91, s91, 9
    s_add_u32 s91, s91, 0x1e90000
    v_lshl_add_u32 v20, v1, 7, s91
    s_mov_b64 exec, 15
    global_load_dwordx2 v[22:23], v20, s[26:27] sc1
    s_mov_b64 exec, -1
    s_cmp_lg_u32 s4, 0
    s_cbranch_scc1 L_fO
    s_lshl_b32 s91, s28, 4
    s_add_u32 s91, s91, s29
    s_lshl_b32 s91, s91, 7
    s_add_u32 s91, s91, 0x1e98000
    v_mov_b32 v16, s91
    v_mov_b32 v18, s100
    v_mov_b32 v19, s101
    s_mov_b64 exec, 1
    global_store_dwordx2 v16, v[18:19], s[26:27] sc1
    s_mov_b64 exec, -1
L_fO:
    s_waitcnt vmcnt(17)
    s_barrier
    s_lshl_b32 s48, s46, 15
    s_and_b32 s48, s48, 0x38000
    s_lshr_b64 s[46:47], s[46:47], 3
    s_lshl2_add_u32 m0, s33, s48
    s_lshl1_add_u32 s49, s33, s48
    buffer_load_dwordx4 v10, s[56:59], s82 offen offset:0 sc1 lds
    buffer_load_dwordx4 v10, s[56:59], s82 offen offset:1024 sc1 lds
    buffer_load_dwordx4 v10, s[56:59], s82 offen offset:2048 sc1 lds
    buffer_load_dwordx4 v10, s[56:59], s82 offen offset:3072 sc1 lds
    s_add_u32 s82, s82, s44
    s_add_u32 m0, s49, 16384
    s_nop 0
    buffer_load_dwordx4 v11, s[60:63], s83 offen lds
    s_add_u32 m0, s49, 17408
    s_nop 0
    buffer_load_dwordx4 v12, s[60:63], s83 offen lds
    s_add_u32 m0, s49, 24576
    s_nop 0
    buffer_load_dwordx4 v11, s[64:67], s83 offen lds
    s_add_u32 m0, s49, 25600
    s_nop 0
    buffer_load_dwordx4 v12, s[64:67], s83 offen lds
    s_add_u32 s83, s83, s45
    s_load_dword s94, s[12:13], s39 offset:0x100
L_pad11:
    s_cbranch_execz L_vret2
    s_load_dword s94, s[12:13], s39 offset:0x140
    s_load_dword s94, s[12:13], s39 offset:0x180
    s_load_dword s94, s[12:13], s39 offset:0x1c0
    s_waitcnt vmcnt(17)
    s_barrier
    s_lshl_b32 s48, s46, 15
    s_and_b32 s48, s48, 0x38000
    s_lshr_b64 s[46:47], s[46:47], 3
    s_lshl2_add_u32 m0, s33, s48
    s_lshl1_add_u32 s49, s33, s48
    buffer_load_dwordx4 v10, s[56:59], s82 offen offset:0 sc1 lds
    buffer_load_dwordx4 v10, s[56:59], s82 offen offset:1024 sc1 lds
    buffer_load_dwordx4 v10, s[56:59], s82 offen offset:2048 sc1 lds
    buffer_load_dwordx4 v10, s[56:59], s82 offen offset:3072 sc1 lds
    s_add_u32 s82, s82, s44
    s_add_u32 m0, s49, 16384
    s_nop 0
    buffer_load_dwordx4 v11, s[60:63], s83 offen lds
    s_add_u32 m0, s49, 17408
    s_nop 0
    buffer_load_dwordx4 v12, s[60:63], s83 offen lds
    s_add_u32 m0, s49, 24576
    s_nop 0
    buffer_load_dwordx4 v11, s[64:67], s83 offen lds
    s_add_u32 m0, s49, 25600
    s_nop 0
    buffer_load_dwordx4 v12, s[64:67], s83 offen lds
    s_add_u32 s83, s83, s45
    s_load_dword s94, s[12:13], s39 offset:0x80000
    s_load_dword s94, s[12:13], s39 offset:0x80040
    s_load_dword s94, s[12:13], s39 offset:0x80080
    s_load_dword s94, s[12:13], s39 offset:0x800c0
    s_waitcnt vmcnt(16)
    s_mov_b64 exec, 15
    s_movk_i32 s98, 0x4000
L_pH2_chk:
    v_cmp_ne_u64 vcc, s[100:101], v[22:23]
    s_nop 1
    s_cmp_eq_u64 vcc, 0
    s_cbranch_scc1 L_pH2_ok
    s_sub_u32 s98, s98, 1
    s_cbranch_scc1 L_pH2_ok
    s_sleep 1
    global_load_dwordx2 v[22:23], v20, s[26:27] sc1
    s_waitcnt vmcnt(0)
    s_branch L_pH2_chk
L_pH2_ok:
    s_mov_b64 exec, -1
    s_add_u32 s82, s82, s14
    s_add_u32 s83, s83, s35
    s_cmp_lg_u32 s32, 0
    s_cselect_b32 s44, 0xffffc000, s44
    s_lshl_b32 s45, s44, 3
    s_waitcnt vmcnt(17)
    s_barrier
    s_cmp_eq_u32 s50, 0
    s_cbranch_scc1 L_bl_end
L_bl:
    s_lshl_b32 s48, s46, 15
    s_and_b32 s48, s48, 0x38000
    s_lshr_b64 s[46:47], s[46:47], 3
    s_lshl2_add_u32 m0, s33, s48
    s_lshl1_add_u32 s49, s33, s48
    buffer_load_dwordx4 v10, s[56:59], s82 offen offset:0 sc1 lds
    buffer_load_dwordx4 v10, s[56:59], s82 offen offset:1024 sc1 lds
    buffer_load_dwordx4 v10, s[56:59], s82 offen offset:2048 sc1 lds
    buffer_load_dwordx4 v10, s[56:59], s82 offen offset:3072 sc1 lds
    s_add_u32 s82, s82, s44
    s_add_u32 m0, s49, 16384
    s_nop 0
    buffer_load_dwordx4 v11, s[60:63], s83 offen lds
    s_add_u32 m0, s49, 17408
    s_nop 0
    buffer_load_dwordx4 v12, s[60:63], s83 offen lds
    s_add_u32 m0, s49, 24576
    s_nop 0
    buffer_load_dwordx4 v11, s[64:67], s83 offen lds
    s_add_u32 m0, s49, 25600
    s_nop 0
    buffer_load_dwordx4 v12, s[64:67], s83 offen lds
    s_add_u32 s83, s83, s45
    s_sub_u32 s50, s50, 1
    s_cmp_lg_u32 s50, 0
    s_waitcnt vmcnt(16)
    s_barrier
    s_cbranch_scc1 L_bl
L_bl_end:
    s_lshl_b32 m0, s33, 2
    s_nop 0
    buffer_load_dwordx4 v10, s[56:59], s82 offen offset:0 sc1 lds
    buffer_load_dwordx4 v10, s[56:59], s82 offen offset:1024 sc1 lds
    buffer_load_dwordx4 v10, s[56:59], s82 offen offset:2048 sc1 lds
    buffer_load_dwordx4 v10, s[56:59], s82 offen offset:3072 sc1 lds
    s_add_u32 s82, s82, s44
    s_lshl1_add_u32 m0, s33, 16384
    s_nop 0
    buffer_load_dwordx4 v11, s[60:63], s83 offen lds
    s_lshl1_add_u32 m0, s33, 17408
    s_nop 0
    buffer_load_dwordx4 v12, s[60:63], s83 offen lds
    s_lshl1_add_u32 m0, s33, 24576
    s_nop 0
    buffer_load_dwordx4 v11, s[64:67], s83 offen lds
    s_lshl1_add_u32 m0, s33, 25600
    s_nop 0
    buffer_load_dwordx4 v12, s[64:67], s83 offen lds
    s_add_u32 s83, s83, s45
    s_load_dword s94, s[12:13], s39 offset:0x80100
    s_load_dword s94, s[12:13], s39 offset:0x80140
    s_load_dword s94, s[12:13], s39 offset:0x80180
    s_load_dword s94, s[12:13], s39 offset:0x801c0
    s_waitcnt vmcnt(16)
    s_barrier
    s_lshl2_add_u32 m0, s33, 98304
    s_nop 0
    buffer_load_dwordx4 v10, s[56:59], s82 offen offset:0 sc1 lds
    buffer_load_dwordx4 v10, s[56:59], s82 offen offset:1024 sc1 lds
    buffer_load_dwordx4 v10, s[56:59], s82 offen offset:2048 sc1 lds
    buffer_load_dwordx4 v10, s[56:59], s82 offen offset:3072 sc1 lds
    s_add_u32 s82, s82, s44
    s_lshl1_add_u32 m0, s33, 114688
    s_nop 0
    buffer_load_dwordx4 v11, s[60:63], s83 offen lds
    s_lshl1_add_u32 m0, s33, 115712
    s_nop 0
    buffer_load_dwordx4 v12, s[60:63], s83 offen lds
    s_lshl1_add_u32 m0, s33, 122880
    s_nop 0
    buffer_load_dwordx4 v11, s[64:67], s83 offen lds
    s_lshl1_add_u32 m0, s33, 123904
    s_nop 0
    buffer_load_dwordx4 v12, s[64:67], s83 offen lds
    s_add_u32 s83, s83, s45
    s_add_u32 s39, s39, 0x100000
    s_load_dword s94, s[12:13], s39 offset:0x0
    s_load_dword s94, s[12:13], s39 offset:0x40
    s_load_dword s94, s[12:13], s39 offset:0x80
    s_load_dword s94, s[12:13], s39 offset:0xc0
    s_lshl2_add_u32 s91, s30, s4
    s_lshl_b32 s91, s91, 9
    s_add_u32 s91, s91, 0x1e98000
    v_lshl_add_u32 v20, v1, 7, s91
    s_mov_b64 exec, 15
    global_load_dwordx2 v[22:23], v20, s[26:27] sc1
    s_mov_b64 exec, -1
    s_waitcnt vmcnt(17)
    s_barrier
    s_lshl2_add_u32 m0, s33, 32768
    s_nop 0
    buffer_load_dwordx4 v10, s[56:59], s82 offen offset:0 sc1 lds
    buffer_load_dwordx4 v10, s[56:59], s82 offen offset:1024 sc1 lds
    buffer_load_dwordx4 v10, s[56:59], s82 offen offset:2048 sc1 lds
    buffer_load_dwordx4 v10, s[56:59], s82 offen offset:3072 sc1 lds
    s_add_u32 s82, s82, s44
    s_lshl1_add_u32 m0, s33, 49152
    s_nop 0
    buffer_load_dwordx4 v11, s[60:63], s83 offen lds
    s_lshl1_add_u32 m0, s33, 50176
    s_nop 0
    buffer_load_dwordx4 v12, s[60:63], s83 offen lds
    s_lshl1_add_u32 m0, s33, 57344
    s_nop 0
    buffer_load_dwordx4 v11, s[64:67], s83 offen lds
    s_lshl1_add_u32 m0, s33, 58368
    s_nop 0
    buffer_load_dwordx4 v12, s[64:67], s83 offen lds
    s_add_u32 s83, s83, s45
    s_load_dword s94, s[12:13], s39 offset:0x100
    s_load_dword s94, s[12:13], s39 offset:0x140
    s_load_dword s94, s[12:13], s39 offset:0x180
    s_load_dword s94, s[12:13], s39 offset:0x1c0
    s_waitcnt vmcnt(17)
    s_barrier
    s_lshl2_add_u32 m0, s33, 65536
    s_nop 0
    buffer_load_dwordx4 v10, s[56:59], s82 offen offset:0 sc1 lds
    buffer_load_dwordx4 v10, s[56:59], s82 offen offset:1024 sc1 lds
    buffer_load_dwordx4 v10, s[56:59], s82 offen offset:2048 sc1 lds
    buffer_load_dwordx4 v10, s[56:59], s82 offen offset:3072 sc1 lds
    s_add_u32 s82, s82, s44
    s_lshl1_add_u32 m0, s33, 81920
    s_nop 0
    buffer_load_dwordx4 v11, s[60:63], s83 offen lds
    s_lshl1_add_u32 m0, s33, 82944
    s_nop 0
    buffer_load_dwordx4 v12, s[60:63], s83 offen lds
    s_lshl1_add_u32 m0, s33, 90112
    s_nop 0
    buffer_load_dwordx4 v11, s[64:67], s83 offen lds
    s_lshl1_add_u32 m0, s33, 91136
    s_nop 0
    buffer_load_dwordx4 v12, s[64:67], s83 offen lds
    s_add_u32 s83, s83, s45
    s_load_dword s94, s[12:13], s39 offset:0x80000
    s_load_dword s94, s[12:13], s39 offset:0x80040
    s_load_dword s94, s[12:13], s39 offset:0x80080
    s_load_dword s94, s[12:13], s39 offset:0x800c0
    s_waitcnt vmcnt(16)
    s_mov_b64 exec, 15
    s_movk_i32 s98, 0x4000
L_pO_chk:
    v_cmp_ne_u64 vcc, s[100:101], v[22:23]
    s_nop 1
    s_cmp_eq_u64 vcc, 0
    s_cbranch_scc1 L_pO_ok
    s_sub_u32 s98, s98, 1
    s_cbranch_scc1 L_pO_ok
    s_sleep 1
    global_load_dwordx2 v[22:23], v20, s[26:27] sc1
    s_waitcnt vmcnt(0)
    s_branch L_pO_chk
L_pO_ok:
    s_mov_b64 exec, -1
    s_waitcnt vmcnt(17)
    s_barrier
    s_lshl_b32 s85, s31, 8
    s_lshl_b32 s86, s32, 7
    s_add_u32 s86, s85, s86
    s_xor_b32 s87, s86, 128
    s_add_u32 s60, s12, s86
    s_addc_u32 s61, s13, 0
    s_sub_u32 s62, 2097152, s86
    s_mov_b32 s63, 0x20000
    s_add_u32 s56, s26, 0x1200000
    s_addc_u32 s57, s27, 0
    s_mov_b32 s58, 0x400000
    s_mov_b32 s59, 0x20000
    s_lshl_b32 s82, s30, 18
    s_mov_b32 s83, 0
    s_lshl_b32 m0, s33, 2
    s_nop 0
    buffer_load_dwordx4 v10, s[56:59], s82 offen offset:0 sc1 lds
    buffer_load_dwordx4 v10, s[56:59], s82 offen offset:1024 sc1 lds
    buffer_load_dwordx4 v10, s[56:59], s82 offen offset:2048 sc1 lds
    buffer_load_dwordx4 v10, s[56:59], s82 offen offset:3072 sc1 lds
    s_add_u32 s82, s82, 16384
    s_lshl1_add_u32 m0, s33, 16384
    s_nop 0
    buffer_load_dwordx4 v11, s[60:63], s83 offen lds
    s_lshl1_add_u32 m0, s33, 17408
    s_nop 0
    buffer_load_dwordx4 v12, s[60:63], s83 offen lds
    s_add_u32 s83, s83, 131072
    s_load_dword s94, s[12:13], s39 offset:0x80100
    s_load_dword s94, s[12:13], s39 offset:0x80140
    s_load_dword s94, s[12:13], s39 offset:0x80180
    s_load_dword s94, s[12:13], s39 offset:0x801c0
    s_waitcnt vmcnt(14)
    s_barrier
    s_lshl2_add_u32 m0, s33, 98304
    s_nop 0
    buffer_load_dwordx4 v10, s[56:59], s82 offen offset:0 sc1 lds
    buffer_load_dwordx4 v10, s[56:59], s82 offen offset:1024 sc1 lds
    buffer_load_dwordx4 v10, s[56:59], s82 offen offset:2048 sc1 lds
    buffer_load_dwordx4 v10, s[56:59], s82 offen offset:3072 sc1 lds
    s_add_u32 s82, s82, 16384
    s_lshl1_add_u32 m0, s33, 114688
    s_nop 0
    buffer_load_dwordx4 v11, s[60:63], s83 offen lds
    s_lshl1_add_u32 m0, s33, 115712
    s_nop 0
    buffer_load_dwordx4 v12, s[60:63], s83 offen lds
    s_add_u32 s83, s83, 131072
    s_lshl2_add_u32 m0, s33, 122880
    s_nop 0
    buffer_load_dwordx4 v10, s[56:59], s82 offen offset:0 sc1 lds
    buffer_load_dwordx4 v10, s[56:59], s82 offen offset:1024 sc1 lds
    buffer_load_dwordx4 v10, s[56:59], s82 offen offset:2048 sc1 lds
    buffer_load_dwordx4 v10, s[56:59], s82 offen offset:3072 sc1 lds
    s_add_u32 s82, s82, 16384
    s_lshl1_add_u32 m0, s33, 139264
    s_nop 0
    buffer_load_dwordx4 v11, s[60:63], s83 offen lds
    s_lshl1_add_u32 m0, s33, 140288
    s_nop 0
    buffer_load_dwordx4 v12, s[60:63], s83 offen lds
    s_add_u32 s83, s83, 131072
    s_waitcnt vmcnt(18)
    s_barrier
    s_lshl2_add_u32 m0, s33, 24576
    s_nop 0
    buffer_load_dwordx4 v10, s[56:59], s82 offen offset:0 sc1 lds
    buffer_load_dwordx4 v10, s[56:59], s82 offen offset:1024 sc1 lds
    buffer_load_dwordx4 v10, s[56:59], s82 offen offset:2048 sc1 lds
    buffer_load_dwordx4 v10, s[56:59], s82 offen offset:3072 sc1 lds
    s_add_u32 s82, s82, 16384
    s_lshl1_add_u32 m0, s33, 40960
    s_nop 0
    buffer_load_dwordx4 v11, s[60:63], s83 offen lds
    s_lshl1_add_u32 m0, s33, 41984
    s_nop 0
    buffer_load_dwordx4 v12, s[60:63], s83 offen lds
    s_add_u32 s83, s83, 131072
    s_waitcnt vmcnt(18)
    s_barrier
    s_setprio 1
    ds_read_b64_tr_b16 v[40:41], v80 offset:16384
    ds_read_b64_tr_b16 v[42:43], v80 offset:16896
    ds_read_b128 v[24:27], v48 offset:0
    ds_read_b128 v[28:31], v48 offset:1024
    ds_read_b128 v[32:35], v48 offset:2048
    ds_read_b128 v[36:39], v48 offset:3072
    ds_read_b64_tr_b16 v[44:45], v81 offset:16384
    ds_read_b64_tr_b16 v[46:47], v81 offset:16896
    s_waitcnt lgkmcnt(5)
    v_mfma_f32_16x16x32_bf16 v[88:91], v[40:43], v[24:27], v[88:91]
    ds_read_b64_tr_b16 v[72:73], v80 offset:20480
    ds_read_b64_tr_b16 v[74:75], v80 offset:20992
    s_lshl2_add_u32 m0, s33, 49152
    s_waitcnt lgkmcnt(6)
    v_mfma_f32_16x16x32_bf16 v[92:95], v[40:43], v[28:31], v[92:95]
    buffer_load_dwordx4 v10, s[56:59], s82 offen offset:0 sc1 lds
    ds_read_b128 v[56:59], v48 offset:8192
    ds_read_b128 v[60:63], v48 offset:9216
    s_waitcnt lgkmcnt(7)
    v_mfma_f32_16x16x32_bf16 v[96:99], v[40:43], v[32:35], v[96:99]
    ds_read_b128 v[64:67], v48 offset:10240
    ds_read_b128 v[68:71], v48 offset:11264
    s_waitcnt lgkmcnt(8)
    v_mfma_f32_16x16x32_bf16 v[100:103], v[40:43], v[36:39], v[100:103]
    ds_read_b64_tr_b16 v[76:77], v81 offset:20480
    ds_read_b64_tr_b16 v[78:79], v81 offset:20992
    s_waitcnt lgkmcnt(8)
    v_mfma_f32_16x16x32_bf16 v[104:107], v[44:47], v[24:27], v[104:107]
    buffer_load_dwordx4 v10, s[56:59], s82 offen offset:1024 sc1 lds
    v_mfma_f32_16x16x32_bf16 v[108:111], v[44:47], v[28:31], v[108:111]
    v_mfma_f32_16x16x32_bf16 v[112:115], v[44:47], v[32:35], v[112:115]
    v_mfma_f32_16x16x32_bf16 v[116:119], v[44:47], v[36:39], v[116:119]
    s_waitcnt vmcnt(14) lgkmcnt(0)
    s_barrier
    v_mfma_f32_16x16x32_bf16 v[88:91], v[72:75], v[56:59], v[88:91]
    ds_read_b64_tr_b16 v[40:41], v84 offset:16384
    ds_read_b64_tr_b16 v[42:43], v84 offset:16896
    v_mfma_f32_16x16x32_bf16 v[92:95], v[72:75], v[60:63], v[92:95]
    buffer_load_dwordx4 v10, s[56:59], s82 offen offset:2048 sc1 lds
    ds_read_b128 v[24:27], v50 offset:0
    ds_read_b128 v[28:31], v50 offset:1024
    v_mfma_f32_16x16x32_bf16 v[96:99], v[72:75], v[64:67], v[96:99]
    ds_read_b128 v[32:35], v50 offset:2048
    v_mfma_f32_16x16x32_bf16 v[100:103], v[72:75], v[68:71], v[100:103]
    ds_read_b128 v[36:39], v50 offset:3072
    ds_read_b64_tr_b16 v[44:45], v85 offset:16384
    v_mfma_f32_16x16x32_bf16 v[104:107], v[76:79], v[56:59], v[104:107]
    buffer_load_dwordx4 v10, s[56:59], s82 offen offset:3072 sc1 lds
    s_add_u32 s82, s82, 16384
    ds_read_b64_tr_b16 v[46:47], v85 offset:16896
    v_mfma_f32_16x16x32_bf16 v[108:111], v[76:79], v[60:63], v[108:111]
    v_mfma_f32_16x16x32_bf16 v[112:115], v[76:79], v[64:67], v[112:115]
    v_mfma_f32_16x16x32_bf16 v[116:119], v[76:79], v[68:71], v[116:119]
    s_waitcnt lgkmcnt(5)
    v_mfma_f32_16x16x32_bf16 v[88:91], v[40:43], v[24:27], v[88:91]
    ds_read_b64_tr_b16 v[72:73], v84 offset:20480
    ds_read_b64_tr_b16 v[74:75], v84 offset:20992
    s_lshl1_add_u32 m0, s33, 65536
    s_waitcnt lgkmcnt(6)
    v_mfma_f32_16x16x32_bf16 v[92:95], v[40:43], v[28:31], v[92:95]
    buffer_load_dwordx4 v11, s[60:63], s83 offen lds
    ds_read_b128 v[56:59], v50 offset:8192
    ds_read_b128 v[60:63], v50 offset:9216
    s_waitcnt lgkmcnt(7)
    v_mfma_f32_16x16x32_bf16 v[96:99], v[40:43], v[32:35], v[96:99]
    ds_read_b128 v[64:67], v50 offset:10240
    ds_read_b128 v[68:71], v50 offset:11264
    s_waitcnt lgkmcnt(8)
    v_mfma_f32_16x16x32_bf16 v[100:103], v[40:43], v[36:39], v[100:103]
    ds_read_b64_tr_b16 v[76:77], v85 offset:20480
    ds_read_b64_tr_b16 v[78:79], v85 offset:20992
    s_lshl1_add_u32 m0, s33, 66560
    s_waitcnt lgkmcnt(8)
    v_mfma_f32_16x16x32_bf16 v[104:107], v[44:47], v[24:27], v[104:107]
    buffer_load_dwordx4 v12, s[60:63], s83 offen lds
    s_add_u32 s83, s83, 131072
    v_mfma_f32_16x16x32_bf16 v[108:111], v[44:47], v[28:31], v[108:111]
    v_mfma_f32_16x16x32_bf16 v[112:115], v[44:47], v[32:35], v[112:115]
    v_mfma_f32_16x16x32_bf16 v[116:119], v[44:47], v[36:39], v[116:119]
    s_waitcnt vmcnt(12) lgkmcnt(0)
    s_barrier
    v_mfma_f32_16x16x32_bf16 v[88:91], v[72:75], v[56:59], v[88:91]
    ds_read_b64_tr_b16 v[40:41], v84 offset:40960
    ds_read_b64_tr_b16 v[42:43], v84 offset:41472
    s_lshl2_add_u32 m0, s33, 73728
    v_mfma_f32_16x16x32_bf16 v[92:95], v[72:75], v[60:63], v[92:95]
    buffer_load_dwordx4 v10, s[56:59], s82 offen offset:0 sc1 lds
    ds_read_b128 v[24:27], v50 offset:24576
    ds_read_b128 v[28:31], v50 offset:25600
    v_mfma_f32_16x16x32_bf16 v[96:99], v[72:75], v[64:67], v[96:99]
    ds_read_b128 v[32:35], v50 offset:26624
    v_mfma_f32_16x16x32_bf16 v[100:103], v[72:75], v[68:71], v[100:103]
    ds_read_b128 v[36:39], v50 offset:27648
    ds_read_b64_tr_b16 v[44:45], v85 offset:40960
    v_mfma_f32_16x16x32_bf16 v[104:107], v[76:79], v[56:59], v[104:107]
    buffer_load_dwordx4 v10, s[56:59], s82 offen offset:1024 sc1 lds
    ds_read_b64_tr_b16 v[46:47], v85 offset:41472
    v_mfma_f32_16x16x32_bf16 v[108:111], v[76:79], v[60:63], v[108:111]
    v_mfma_f32_16x16x32_bf16 v[112:115], v[76:79], v[64:67], v[112:115]
    v_mfma_f32_16x16x32_bf16 v[116:119], v[76:79], v[68:71], v[116:119]
    s_waitcnt lgkmcnt(5)
    v_mfma_f32_16x16x32_bf16 v[88:91], v[40:43], v[24:27], v[88:91]
    ds_read_b64_tr_b16 v[72:73], v84 offset:45056
    ds_read_b64_tr_b16 v[74:75], v84 offset:45568
    s_waitcnt lgkmcnt(6)
    v_mfma_f32_16x16x32_bf16 v[92:95], v[40:43], v[28:31], v[92:95]
    buffer_load_dwordx4 v10, s[56:59], s82 offen offset:2048 sc1 lds
    ds_read_b128 v[56:59], v50 offset:32768
    ds_read_b128 v[60:63], v50 offset:33792
    s_waitcnt lgkmcnt(7)
    v_mfma_f32_16x16x32_bf16 v[96:99], v[40:43], v[32:35], v[96:99]
    ds_read_b128 v[64:67], v50 offset:34816
    ds_read_b128 v[68:71], v50 offset:35840
    s_waitcnt lgkmcnt(8)
    v_mfma_f32_16x16x32_bf16 v[100:103], v[40:43], v[36:39], v[100:103]
    ds_read_b64_tr_b16 v[76:77], v85 offset:45056
    ds_read_b64_tr_b16 v[78:79], v85 offset:45568
    s_waitcnt lgkmcnt(8)
    v_mfma_f32_16x16x32_bf16 v[104:107], v[44:47], v[24:27], v[104:107]
    buffer_load_dwordx4 v10, s[56:59], s82 offen offset:3072 sc1 lds
    s_add_u32 s82, s82, 16384
    v_mfma_f32_16x16x32_bf16 v[108:111], v[44:47], v[28:31], v[108:111]
    v_mfma_f32_16x16x32_bf16 v[112:115], v[44:47], v[32:35], v[112:115]
    v_mfma_f32_16x16x32_bf16 v[116:119], v[44:47], v[36:39], v[116:119]
    s_waitcnt vmcnt(10) lgkmcnt(0)
    s_barrier
    v_mfma_f32_16x16x32_bf16 v[88:91], v[72:75], v[56:59], v[88:91]
    ds_read_b64_tr_b16 v[40:41], v80 offset:40960
    ds_read_b64_tr_b16 v[42:43], v80 offset:41472
    s_lshl1_add_u32 m0, s33, 90112
    v_mfma_f32_16x16x32_bf16 v[92:95], v[72:75], v[60:63], v[92:95]
    buffer_load_dwordx4 v11, s[60:63], s83 offen lds
    ds_read_b128 v[24:27], v48 offset:24576
    ds_read_b128 v[28:31], v48 offset:25600
    v_mfma_f32_16x16x32_bf16 v[96:99], v[72:75], v[64:67], v[96:99]
    ds_read_b128 v[32:35], v48 offset:26624
    v_mfma_f32_16x16x32_bf16 v[100:103], v[72:75], v[68:71], v[100:103]
    ds_read_b128 v[36:39], v48 offset:27648
    ds_read_b64_tr_b16 v[44:45], v81 offset:40960
    s_lshl1_add_u32 m0, s33, 91136
    v_mfma_f32_16x16x32_bf16 v[104:107], v[76:79], v[56:59], v[104:107]
    buffer_load_dwordx4 v12, s[60:63], s83 offen lds
    s_add_u32 s83, s83, 131072
    ds_read_b64_tr_b16 v[46:47], v81 offset:41472
    v_mfma_f32_16x16x32_bf16 v[108:111], v[76:79], v[60:63], v[108:111]
    v_mfma_f32_16x16x32_bf16 v[112:115], v[76:79], v[64:67], v[112:115]
    v_mfma_f32_16x16x32_bf16 v[116:119], v[76:79], v[68:71], v[116:119]
    s_waitcnt lgkmcnt(5)
    v_mfma_f32_16x16x32_bf16 v[88:91], v[40:43], v[24:27], v[88:91]
    ds_read_b64_tr_b16 v[72:73], v80 offset:45056
    ds_read_b64_tr_b16 v[74:75], v80 offset:45568
    s_lshl_b32 m0, s33, 2
    s_waitcnt lgkmcnt(6)
    v_mfma_f32_16x16x32_bf16 v[92:95], v[40:43], v[28:31], v[92:95]
    buffer_load_dwordx4 v10, s[56:59], s82 offen offset:0 sc1 lds
    ds_read_b128 v[56:59], v48 offset:32768
    ds_read_b128 v[60:63], v48 offset:33792
    s_waitcnt lgkmcnt(7)
    v_mfma_f32_16x16x32_bf16 v[96:99], v[40:43], v[32:35], v[96:99]
    ds_read_b128 v[64:67], v48 offset:34816
    ds_read_b128 v[68:71], v48 offset:35840
    s_waitcnt lgkmcnt(8)
    v_mfma_f32_16x16x32_bf16 v[100:103], v[40:43], v[36:39], v[100:103]
    buffer_load_dwordx4 v10, s[56:59], s82 offen offset:1024 sc1 lds
    ds_read_b64_tr_b16 v[76:77], v81 offset:45056
    ds_read_b64_tr_b16 v[78:79], v81 offset:45568
    s_waitcnt lgkmcnt(8)
    v_mfma_f32_16x16x32_bf16 v[104:107], v[44:47], v[24:27], v[104:107]
    v_mfma_f32_16x16x32_bf16 v[108:111], v[44:47], v[28:31], v[108:111]
    buffer_load_dwordx4 v10, s[56:59], s82 offen offset:2048 sc1 lds
    v_mfma_f32_16x16x32_bf16 v[112:115], v[44:47], v[32:35], v[112:115]
    v_mfma_f32_16x16x32_bf16 v[116:119], v[44:47], v[36:39], v[116:119]
    s_waitcnt vmcnt(9) lgkmcnt(0)
    s_barrier
    v_mfma_f32_16x16x32_bf16 v[88:91], v[72:75], v[56:59], v[88:91]
    ds_read_b64_tr_b16 v[40:41], v82 offset:16384
    ds_read_b64_tr_b16 v[42:43], v82 offset:16896
    v_mfma_f32_16x16x32_bf16 v[92:95], v[72:75], v[60:63], v[92:95]
    buffer_load_dwordx4 v10, s[56:59], s82 offen offset:3072 sc1 lds
    s_add_u32 s82, s82, 16384
    ds_read_b128 v[24:27], v49 offset:0
    ds_read_b128 v[28:31], v49 offset:1024
    v_mfma_f32_16x16x32_bf16 v[96:99], v[72:75], v[64:67], v[96:99]
    ds_read_b128 v[32:35], v49 offset:2048
    s_lshl1_add_u32 m0, s33, 16384
    v_mfma_f32_16x16x32_bf16 v[100:103], v[72:75], v[68:71], v[100:103]
    buffer_load_dwordx4 v11, s[60:63], s83 offen lds
    ds_read_b128 v[36:39], v49 offset:3072
    ds_read_b64_tr_b16 v[44:45], v83 offset:16384
    v_mfma_f32_16x16x32_bf16 v[104:107], v[76:79], v[56:59], v[104:107]
    ds_read_b64_tr_b16 v[46:47], v83 offset:16896
    s_lshl1_add_u32 m0, s33, 17408
    v_mfma_f32_16x16x32_bf16 v[108:111], v[76:79], v[60:63], v[108:111]
    buffer_load_dwordx4 v12, s[60:63], s83 offen lds
    s_add_u32 s83, s83, 131072
    v_mfma_f32_16x16x32_bf16 v[112:115], v[76:79], v[64:67], v[112:115]
    v_mfma_f32_16x16x32_bf16 v[116:119], v[76:79], v[68:71], v[116:119]
    s_waitcnt lgkmcnt(5)
    v_mfma_f32_16x16x32_bf16 v[88:91], v[40:43], v[24:27], v[88:91]
    ds_read_b64_tr_b16 v[72:73], v82 offset:20480
    ds_read_b64_tr_b16 v[74:75], v82 offset:20992
    s_lshl2_add_u32 m0, s33, 98304
    s_waitcnt lgkmcnt(6)
    v_mfma_f32_16x16x32_bf16 v[92:95], v[40:43], v[28:31], v[92:95]
    buffer_load_dwordx4 v10, s[56:59], s82 offen offset:0 sc1 lds
    ds_read_b128 v[56:59], v49 offset:8192
    ds_read_b128 v[60:63], v49 offset:9216
    s_waitcnt lgkmcnt(7)
    v_mfma_f32_16x16x32_bf16 v[96:99], v[40:43], v[32:35], v[96:99]
    ds_read_b128 v[64:67], v49 offset:10240
    ds_read_b128 v[68:71], v49 offset:11264
    s_waitcnt lgkmcnt(8)
    v_mfma_f32_16x16x32_bf16 v[100:103], v[40:43], v[36:39], v[100:103]
    buffer_load_dwordx4 v10, s[56:59], s82 offen offset:1024 sc1 lds
    ds_read_b64_tr_b16 v[76:77], v83 offset:20480
    ds_read_b64_tr_b16 v[78:79], v83 offset:20992
    s_waitcnt lgkmcnt(8)
    v_mfma_f32_16x16x32_bf16 v[104:107], v[44:47], v[24:27], v[104:107]
    v_mfma_f32_16x16x32_bf16 v[108:111], v[44:47], v[28:31], v[108:111]
    buffer_load_dwordx4 v10, s[56:59], s82 offen offset:2048 sc1 lds
    v_mfma_f32_16x16x32_bf16 v[112:115], v[44:47], v[32:35], v[112:115]
    v_mfma_f32_16x16x32_bf16 v[116:119], v[44:47], v[36:39], v[116:119]
    s_waitcnt vmcnt(9) lgkmcnt(0)
    s_barrier
    v_mfma_f32_16x16x32_bf16 v[88:91], v[72:75], v[56:59], v[88:91]
    ds_read_b64_tr_b16 v[40:41], v82 offset:40960
    ds_read_b64_tr_b16 v[42:43], v82 offset:41472
    v_mfma_f32_16x16x32_bf16 v[92:95], v[72:75], v[60:63], v[92:95]
    buffer_load_dwordx4 v10, s[56:59], s82 offen offset:3072 sc1 lds
    s_add_u32 s82, s82, 16384
    ds_read_b128 v[24:27], v49 offset:24576
    ds_read_b128 v[28:31], v49 offset:25600
    v_mfma_f32_16x16x32_bf16 v[96:99], v[72:75], v[64:67], v[96:99]
    ds_read_b128 v[32:35], v49 offset:26624
    s_lshl1_add_u32 m0, s33, 114688
    v_mfma_f32_16x16x32_bf16 v[100:103], v[72:75], v[68:71], v[100:103]
    buffer_load_dwordx4 v11, s[60:63], s83 offen lds
    ds_read_b128 v[36:39], v49 offset:27648
    ds_read_b64_tr_b16 v[44:45], v83 offset:40960
    v_mfma_f32_16x16x32_bf16 v[104:107], v[76:79], v[56:59], v[104:107]
    ds_read_b64_tr_b16 v[46:47], v83 offset:41472
    s_lshl1_add_u32 m0, s33, 115712
    v_mfma_f32_16x16x32_bf16 v[108:111], v[76:79], v[60:63], v[108:111]
    buffer_load_dwordx4 v12, s[60:63], s83 offen lds
    s_add_u32 s83, s83, 131072
    v_mfma_f32_16x16x32_bf16 v[112:115], v[76:79], v[64:67], v[112:115]
    v_mfma_f32_16x16x32_bf16 v[116:119], v[76:79], v[68:71], v[116:119]
    s_waitcnt lgkmcnt(5)
    v_mfma_f32_16x16x32_bf16 v[88:91], v[40:43], v[24:27], v[88:91]
    ds_read_b64_tr_b16 v[72:73], v82 offset:45056
    ds_read_b64_tr_b16 v[74:75], v82 offset:45568
    s_lshl2_add_u32 m0, s33, 122880
    s_waitcnt lgkmcnt(6)
    v_mfma_f32_16x16x32_bf16 v[92:95], v[40:43], v[28:31], v[92:95]
    buffer_load_dwordx4 v10, s[56:59], s82 offen offset:0 sc1 lds
    ds_read_b128 v[56:59], v49 offset:32768
    ds_read_b128 v[60:63], v49 offset:33792
    s_waitcnt lgkmcnt(7)
    v_mfma_f32_16x16x32_bf16 v[96:99], v[40:43], v[32:35], v[96:99]
    ds_read_b128 v[64:67], v49 offset:34816
    ds_read_b128 v[68:71], v49 offset:35840
    s_waitcnt lgkmcnt(8)
    v_mfma_f32_16x16x32_bf16 v[100:103], v[40:43], v[36:39], v[100:103]
    buffer_load_dwordx4 v10, s[56:59], s82 offen offset:1024 sc1 lds
    ds_read_b64_tr_b16 v[76:77], v83 offset:45056
    ds_read_b64_tr_b16 v[78:79], v83 offset:45568
    s_waitcnt lgkmcnt(8)
    v_mfma_f32_16x16x32_bf16 v[104:107], v[44:47], v[24:27], v[104:107]
    v_mfma_f32_16x16x32_bf16 v[108:111], v[44:47], v[28:31], v[108:111]
    buffer_load_dwordx4 v10, s[56:59], s82 offen offset:2048 sc1 lds
    v_mfma_f32_16x16x32_bf16 v[112:115], v[44:47], v[32:35], v[112:115]
    v_mfma_f32_16x16x32_bf16 v[116:119], v[44:47], v[36:39], v[116:119]
    s_waitcnt vmcnt(9) lgkmcnt(0)
    s_barrier
    v_mfma_f32_16x16x32_bf16 v[88:91], v[72:75], v[56:59], v[88:91]
    ds_read_b64_tr_b16 v[40:41], v80 offset:16384
    ds_read_b64_tr_b16 v[42:43], v80 offset:16896
    v_mfma_f32_16x16x32_bf16 v[92:95], v[72:75], v[60:63], v[92:95]
    buffer_load_dwordx4 v10, s[56:59], s82 offen offset:3072 sc1 lds
    s_add_u32 s82, s82, 16384
    ds_read_b128 v[24:27], v48 offset:0
    ds_read_b128 v[28:31], v48 offset:1024
    v_mfma_f32_16x16x32_bf16 v[96:99], v[72:75], v[64:67], v[96:99]
    ds_read_b128 v[32:35], v48 offset:2048
    s_lshl1_add_u32 m0, s33, 139264
    v_mfma_f32_16x16x32_bf16 v[100:103], v[72:75], v[68:71], v[100:103]
    buffer_load_dwordx4 v11, s[60:63], s83 offen lds
    ds_read_b128 v[36:39], v48 offset:3072
    ds_read_b64_tr_b16 v[44:45], v81 offset:16384
    v_mfma_f32_16x16x32_bf16 v[104:107], v[76:79], v[56:59], v[104:107]
    ds_read_b64_tr_b16 v[46:47], v81 offset:16896
    s_lshl1_add_u32 m0, s33, 140288
    v_mfma_f32_16x16x32_bf16 v[108:111], v[76:79], v[60:63], v[108:111]
    buffer_load_dwordx4 v12, s[60:63], s83 offen lds
    s_add_u32 s83, s83, 131072
    v_mfma_f32_16x16x32_bf16 v[112:115], v[76:79], v[64:67], v[112:115]
    v_mfma_f32_16x16x32_bf16 v[116:119], v[76:79], v[68:71], v[116:119]
    s_waitcnt lgkmcnt(5)
    v_mfma_f32_16x16x32_bf16 v[88:91], v[40:43], v[24:27], v[88:91]
    ds_read_b64_tr_b16 v[72:73], v80 offset:20480
    ds_read_b64_tr_b16 v[74:75], v80 offset:20992
    s_lshl2_add_u32 m0, s33, 24576
    s_waitcnt lgkmcnt(6)
    v_mfma_f32_16x16x32_bf16 v[92:95], v[40:43], v[28:31], v[92:95]
    buffer_load_dwordx4 v10, s[56:59], s82 offen offset:0 sc1 lds
    ds_read_b128 v[56:59], v48 offset:8192
    ds_read_b128 v[60:63], v48 offset:9216
    s_waitcnt lgkmcnt(7)
    v_mfma_f32_16x16x32_bf16 v[96:99], v[40:43], v[32:35], v[96:99]
    ds_read_b128 v[64:67], v48 offset:10240
L_pad12:
    s_cbranch_execz L_vret2
    ds_read_b128 v[68:71], v48 offset:11264
    s_waitcnt lgkmcnt(8)
    v_mfma_f32_16x16x32_bf16 v[100:103], v[40:43], v[36:39], v[100:103]
    buffer_load_dwordx4 v10, s[56:59], s82 offen offset:1024 sc1 lds
    ds_read_b64_tr_b16 v[76:77], v81 offset:20480
    ds_read_b64_tr_b16 v[78:79], v81 offset:20992
    s_waitcnt lgkmcnt(8)
    v_mfma_f32_16x16x32_bf16 v[104:107], v[44:47], v[24:27], v[104:107]
    v_mfma_f32_16x16x32_bf16 v[108:111], v[44:47], v[28:31], v[108:111]
    buffer_load_dwordx4 v10, s[56:59], s82 offen offset:2048 sc1 lds
    v_mfma_f32_16x16x32_bf16 v[112:115], v[44:47], v[32:35], v[112:115]
    v_mfma_f32_16x16x32_bf16 v[116:119], v[44:47], v[36:39], v[116:119]
    s_waitcnt vmcnt(9) lgkmcnt(0)
    s_barrier
    v_mfma_f32_16x16x32_bf16 v[88:91], v[72:75], v[56:59], v[88:91]
    ds_read_b64_tr_b16 v[40:41], v84 offset:16384
    ds_read_b64_tr_b16 v[42:43], v84 offset:16896
    v_mfma_f32_16x16x32_bf16 v[92:95], v[72:75], v[60:63], v[92:95]
    buffer_load_dwordx4 v10, s[56:59], s82 offen offset:3072 sc1 lds
    s_add_u32 s82, s82, 16384
    ds_read_b128 v[24:27], v50 offset:0
    ds_read_b128 v[28:31], v50 offset:1024
    v_mfma_f32_16x16x32_bf16 v[96:99], v[72:75], v[64:67], v[96:99]
    ds_read_b128 v[32:35], v50 offset:2048
    s_lshl1_add_u32 m0, s33, 40960
    v_mfma_f32_16x16x32_bf16 v[100:103], v[72:75], v[68:71], v[100:103]
    buffer_load_dwordx4 v11, s[60:63], s83 offen lds
    ds_read_b128 v[36:39], v50 offset:3072
    ds_read_b64_tr_b16 v[44:45], v85 offset:16384
    v_mfma_f32_16x16x32_bf16 v[104:107], v[76:79], v[56:59], v[104:107]
    ds_read_b64_tr_b16 v[46:47], v85 offset:16896
    s_lshl1_add_u32 m0, s33, 41984
    v_mfma_f32_16x16x32_bf16 v[108:111], v[76:79], v[60:63], v[108:111]
    buffer_load_dwordx4 v12, s[60:63], s83 offen lds
    s_add_u32 s83, s83, 131072
    v_mfma_f32_16x16x32_bf16 v[112:115], v[76:79], v[64:67], v[112:115]
    v_mfma_f32_16x16x32_bf16 v[116:119], v[76:79], v[68:71], v[116:119]
    s_waitcnt lgkmcnt(5)
    v_mfma_f32_16x16x32_bf16 v[88:91], v[40:43], v[24:27], v[88:91]
    ds_read_b64_tr_b16 v[72:73], v84 offset:20480
    ds_read_b64_tr_b16 v[74:75], v84 offset:20992
    s_lshl2_add_u32 m0, s33, 49152
    s_waitcnt lgkmcnt(6)
    v_mfma_f32_16x16x32_bf16 v[92:95], v[40:43], v[28:31], v[92:95]
    buffer_load_dwordx4 v10, s[56:59], s82 offen offset:0 sc1 lds
    ds_read_b128 v[56:59], v50 offset:8192
    ds_read_b128 v[60:63], v50 offset:9216
    s_waitcnt lgkmcnt(7)
    v_mfma_f32_16x16x32_bf16 v[96:99], v[40:43], v[32:35], v[96:99]
    ds_read_b128 v[64:67], v50 offset:10240
    ds_read_b128 v[68:71], v50 offset:11264
    s_waitcnt lgkmcnt(8)
    v_mfma_f32_16x16x32_bf16 v[100:103], v[40:43], v[36:39], v[100:103]
    buffer_load_dwordx4 v10, s[56:59], s82 offen offset:1024 sc1 lds
    ds_read_b64_tr_b16 v[76:77], v85 offset:20480
    ds_read_b64_tr_b16 v[78:79], v85 offset:20992
    s_waitcnt lgkmcnt(8)
    v_mfma_f32_16x16x32_bf16 v[104:107], v[44:47], v[24:27], v[104:107]
    v_mfma_f32_16x16x32_bf16 v[108:111], v[44:47], v[28:31], v[108:111]
    buffer_load_dwordx4 v10, s[56:59], s82 offen offset:2048 sc1 lds
    v_mfma_f32_16x16x32_bf16 v[112:115], v[44:47], v[32:35], v[112:115]
    v_mfma_f32_16x16x32_bf16 v[116:119], v[44:47], v[36:39], v[116:119]
    s_waitcnt vmcnt(9) lgkmcnt(0)
    s_barrier
    v_mfma_f32_16x16x32_bf16 v[88:91], v[72:75], v[56:59], v[88:91]
    ds_read_b64_tr_b16 v[40:41], v84 offset:40960
    ds_read_b64_tr_b16 v[42:43], v84 offset:41472
    v_mfma_f32_16x16x32_bf16 v[92:95], v[72:75], v[60:63], v[92:95]
    buffer_load_dwordx4 v10, s[56:59], s82 offen offset:3072 sc1 lds
    s_add_u32 s82, s82, 16384
    ds_read_b128 v[24:27], v50 offset:24576
    ds_read_b128 v[28:31], v50 offset:25600
    v_mfma_f32_16x16x32_bf16 v[96:99], v[72:75], v[64:67], v[96:99]
    ds_read_b128 v[32:35], v50 offset:26624
    s_lshl1_add_u32 m0, s33, 65536
    v_mfma_f32_16x16x32_bf16 v[100:103], v[72:75], v[68:71], v[100:103]
    buffer_load_dwordx4 v11, s[60:63], s83 offen lds
    ds_read_b128 v[36:39], v50 offset:27648
    ds_read_b64_tr_b16 v[44:45], v85 offset:40960
    v_mfma_f32_16x16x32_bf16 v[104:107], v[76:79], v[56:59], v[104:107]
    ds_read_b64_tr_b16 v[46:47], v85 offset:41472
    s_lshl1_add_u32 m0, s33, 66560
    v_mfma_f32_16x16x32_bf16 v[108:111], v[76:79], v[60:63], v[108:111]
    buffer_load_dwordx4 v12, s[60:63], s83 offen lds
    s_add_u32 s83, s83, 131072
    v_mfma_f32_16x16x32_bf16 v[112:115], v[76:79], v[64:67], v[112:115]
    v_mfma_f32_16x16x32_bf16 v[116:119], v[76:79], v[68:71], v[116:119]
    s_waitcnt lgkmcnt(5)
    v_mfma_f32_16x16x32_bf16 v[88:91], v[40:43], v[24:27], v[88:91]
    ds_read_b64_tr_b16 v[72:73], v84 offset:45056
    ds_read_b64_tr_b16 v[74:75], v84 offset:45568
    s_lshl2_add_u32 m0, s33, 73728
    s_waitcnt lgkmcnt(6)
    v_mfma_f32_16x16x32_bf16 v[92:95], v[40:43], v[28:31], v[92:95]
    buffer_load_dwordx4 v10, s[56:59], s82 offen offset:0 sc1 lds
    ds_read_b128 v[56:59], v50 offset:32768
    ds_read_b128 v[60:63], v50 offset:33792
    s_waitcnt lgkmcnt(7)
    v_mfma_f32_16x16x32_bf16 v[96:99], v[40:43], v[32:35], v[96:99]
    ds_read_b128 v[64:67], v50 offset:34816
    ds_read_b128 v[68:71], v50 offset:35840
    s_waitcnt lgkmcnt(8)
    v_mfma_f32_16x16x32_bf16 v[100:103], v[40:43], v[36:39], v[100:103]
    buffer_load_dwordx4 v10, s[56:59], s82 offen offset:1024 sc1 lds
    ds_read_b64_tr_b16 v[76:77], v85 offset:45056
    ds_read_b64_tr_b16 v[78:79], v85 offset:45568
    s_waitcnt lgkmcnt(8)
    v_mfma_f32_16x16x32_bf16 v[104:107], v[44:47], v[24:27], v[104:107]
    v_mfma_f32_16x16x32_bf16 v[108:111], v[44:47], v[28:31], v[108:111]
    buffer_load_dwordx4 v10, s[56:59], s82 offen offset:2048 sc1 lds
    v_mfma_f32_16x16x32_bf16 v[112:115], v[44:47], v[32:35], v[112:115]
    v_mfma_f32_16x16x32_bf16 v[116:119], v[44:47], v[36:39], v[116:119]
    s_waitcnt vmcnt(9) lgkmcnt(0)
    s_barrier
    v_mfma_f32_16x16x32_bf16 v[88:91], v[72:75], v[56:59], v[88:91]
    ds_read_b64_tr_b16 v[40:41], v80 offset:40960
    ds_read_b64_tr_b16 v[42:43], v80 offset:41472
    v_mfma_f32_16x16x32_bf16 v[92:95], v[72:75], v[60:63], v[92:95]
    buffer_load_dwordx4 v10, s[56:59], s82 offen offset:3072 sc1 lds
    s_add_u32 s82, s82, 16384
    ds_read_b128 v[24:27], v48 offset:24576
    ds_read_b128 v[28:31], v48 offset:25600
    v_mfma_f32_16x16x32_bf16 v[96:99], v[72:75], v[64:67], v[96:99]
    ds_read_b128 v[32:35], v48 offset:26624
    s_lshl1_add_u32 m0, s33, 90112
    v_mfma_f32_16x16x32_bf16 v[100:103], v[72:75], v[68:71], v[100:103]
    buffer_load_dwordx4 v11, s[60:63], s83 offen lds
    ds_read_b128 v[36:39], v48 offset:27648
    ds_read_b64_tr_b16 v[44:45], v81 offset:40960
    v_mfma_f32_16x16x32_bf16 v[104:107], v[76:79], v[56:59], v[104:107]
    ds_read_b64_tr_b16 v[46:47], v81 offset:41472
    s_lshl1_add_u32 m0, s33, 91136
    v_mfma_f32_16x16x32_bf16 v[108:111], v[76:79], v[60:63], v[108:111]
    buffer_load_dwordx4 v12, s[60:63], s83 offen lds
    s_add_u32 s83, s83, 131072
    v_mfma_f32_16x16x32_bf16 v[112:115], v[76:79], v[64:67], v[112:115]
    v_mfma_f32_16x16x32_bf16 v[116:119], v[76:79], v[68:71], v[116:119]
    s_waitcnt lgkmcnt(5)
    v_mfma_f32_16x16x32_bf16 v[88:91], v[40:43], v[24:27], v[88:91]
    ds_read_b64_tr_b16 v[72:73], v80 offset:45056
    ds_read_b64_tr_b16 v[74:75], v80 offset:45568
    s_lshl_b32 m0, s33, 2
    s_waitcnt lgkmcnt(6)
    v_mfma_f32_16x16x32_bf16 v[92:95], v[40:43], v[28:31], v[92:95]
    buffer_load_dwordx4 v10, s[56:59], s82 offen offset:0 sc1 lds
    ds_read_b128 v[56:59], v48 offset:32768
    ds_read_b128 v[60:63], v48 offset:33792
    s_waitcnt lgkmcnt(7)
    v_mfma_f32_16x16x32_bf16 v[96:99], v[40:43], v[32:35], v[96:99]
    ds_read_b128 v[64:67], v48 offset:34816
    ds_read_b128 v[68:71], v48 offset:35840
    s_waitcnt lgkmcnt(8)
    v_mfma_f32_16x16x32_bf16 v[100:103], v[40:43], v[36:39], v[100:103]
    buffer_load_dwordx4 v10, s[56:59], s82 offen offset:1024 sc1 lds
    ds_read_b64_tr_b16 v[76:77], v81 offset:45056
    ds_read_b64_tr_b16 v[78:79], v81 offset:45568
    s_waitcnt lgkmcnt(8)
    v_mfma_f32_16x16x32_bf16 v[104:107], v[44:47], v[24:27], v[104:107]
    v_mfma_f32_16x16x32_bf16 v[108:111], v[44:47], v[28:31], v[108:111]
    buffer_load_dwordx4 v10, s[56:59], s82 offen offset:2048 sc1 lds
    v_mfma_f32_16x16x32_bf16 v[112:115], v[44:47], v[32:35], v[112:115]
    v_mfma_f32_16x16x32_bf16 v[116:119], v[44:47], v[36:39], v[116:119]
    s_waitcnt vmcnt(9) lgkmcnt(0)
    s_barrier
    v_mfma_f32_16x16x32_bf16 v[88:91], v[72:75], v[56:59], v[88:91]
    ds_read_b64_tr_b16 v[40:41], v82 offset:16384
    ds_read_b64_tr_b16 v[42:43], v82 offset:16896
    v_mfma_f32_16x16x32_bf16 v[92:95], v[72:75], v[60:63], v[92:95]
    buffer_load_dwordx4 v10, s[56:59], s82 offen offset:3072 sc1 lds
    s_add_u32 s82, s82, 16384
    ds_read_b128 v[24:27], v49 offset:0
    ds_read_b128 v[28:31], v49 offset:1024
    v_mfma_f32_16x16x32_bf16 v[96:99], v[72:75], v[64:67], v[96:99]
    ds_read_b128 v[32:35], v49 offset:2048
    s_lshl1_add_u32 m0, s33, 16384
    v_mfma_f32_16x16x32_bf16 v[100:103], v[72:75], v[68:71], v[100:103]
    buffer_load_dwordx4 v11, s[60:63], s83 offen lds
    ds_read_b128 v[36:39], v49 offset:3072
    ds_read_b64_tr_b16 v[44:45], v83 offset:16384
    v_mfma_f32_16x16x32_bf16 v[104:107], v[76:79], v[56:59], v[104:107]
    ds_read_b64_tr_b16 v[46:47], v83 offset:16896
    s_lshl1_add_u32 m0, s33, 17408
    v_mfma_f32_16x16x32_bf16 v[108:111], v[76:79], v[60:63], v[108:111]
    buffer_load_dwordx4 v12, s[60:63], s83 offen lds
    s_add_u32 s83, s83, 131072
    v_mfma_f32_16x16x32_bf16 v[112:115], v[76:79], v[64:67], v[112:115]
    v_mfma_f32_16x16x32_bf16 v[116:119], v[76:79], v[68:71], v[116:119]
    s_waitcnt lgkmcnt(5)
    v_mfma_f32_16x16x32_bf16 v[88:91], v[40:43], v[24:27], v[88:91]
    ds_read_b64_tr_b16 v[72:73], v82 offset:20480
    ds_read_b64_tr_b16 v[74:75], v82 offset:20992
    s_lshl2_add_u32 m0, s33, 98304
    s_waitcnt lgkmcnt(6)
    v_mfma_f32_16x16x32_bf16 v[92:95], v[40:43], v[28:31], v[92:95]
    buffer_load_dwordx4 v10, s[56:59], s82 offen offset:0 sc1 lds
    ds_read_b128 v[56:59], v49 offset:8192
    ds_read_b128 v[60:63], v49 offset:9216
    s_waitcnt lgkmcnt(7)
    v_mfma_f32_16x16x32_bf16 v[96:99], v[40:43], v[32:35], v[96:99]
    ds_read_b128 v[64:67], v49 offset:10240
    ds_read_b128 v[68:71], v49 offset:11264
    s_waitcnt lgkmcnt(8)
    v_mfma_f32_16x16x32_bf16 v[100:103], v[40:43], v[36:39], v[100:103]
    buffer_load_dwordx4 v10, s[56:59], s82 offen offset:1024 sc1 lds
    ds_read_b64_tr_b16 v[76:77], v83 offset:20480
    ds_read_b64_tr_b16 v[78:79], v83 offset:20992
    s_waitcnt lgkmcnt(8)
    v_mfma_f32_16x16x32_bf16 v[104:107], v[44:47], v[24:27], v[104:107]
    v_mfma_f32_16x16x32_bf16 v[108:111], v[44:47], v[28:31], v[108:111]
    buffer_load_dwordx4 v10, s[56:59], s82 offen offset:2048 sc1 lds
    v_mfma_f32_16x16x32_bf16 v[112:115], v[44:47], v[32:35], v[112:115]
    v_mfma_f32_16x16x32_bf16 v[116:119], v[44:47], v[36:39], v[116:119]
    s_waitcnt vmcnt(9) lgkmcnt(0)
    s_barrier
    v_mfma_f32_16x16x32_bf16 v[88:91], v[72:75], v[56:59], v[88:91]
    ds_read_b64_tr_b16 v[40:41], v82 offset:40960
    ds_read_b64_tr_b16 v[42:43], v82 offset:41472
    v_mfma_f32_16x16x32_bf16 v[92:95], v[72:75], v[60:63], v[92:95]
    buffer_load_dwordx4 v10, s[56:59], s82 offen offset:3072 sc1 lds
    s_add_u32 s82, s82, 16384
    ds_read_b128 v[24:27], v49 offset:24576
    ds_read_b128 v[28:31], v49 offset:25600
    v_mfma_f32_16x16x32_bf16 v[96:99], v[72:75], v[64:67], v[96:99]
    ds_read_b128 v[32:35], v49 offset:26624
    s_lshl1_add_u32 m0, s33, 114688
    v_mfma_f32_16x16x32_bf16 v[100:103], v[72:75], v[68:71], v[100:103]
    buffer_load_dwordx4 v11, s[60:63], s83 offen lds
    ds_read_b128 v[36:39], v49 offset:27648
    ds_read_b64_tr_b16 v[44:45], v83 offset:40960
    v_mfma_f32_16x16x32_bf16 v[104:107], v[76:79], v[56:59], v[104:107]
    ds_read_b64_tr_b16 v[46:47], v83 offset:41472
    s_lshl1_add_u32 m0, s33, 115712
    v_mfma_f32_16x16x32_bf16 v[108:111], v[76:79], v[60:63], v[108:111]
    buffer_load_dwordx4 v12, s[60:63], s83 offen lds
    s_add_u32 s83, s83, 131072
    v_mfma_f32_16x16x32_bf16 v[112:115], v[76:79], v[64:67], v[112:115]
    v_mfma_f32_16x16x32_bf16 v[116:119], v[76:79], v[68:71], v[116:119]
    s_waitcnt lgkmcnt(5)
    v_mfma_f32_16x16x32_bf16 v[88:91], v[40:43], v[24:27], v[88:91]
    ds_read_b64_tr_b16 v[72:73], v82 offset:45056
    ds_read_b64_tr_b16 v[74:75], v82 offset:45568
    s_lshl2_add_u32 m0, s33, 122880
    s_waitcnt lgkmcnt(6)
    v_mfma_f32_16x16x32_bf16 v[92:95], v[40:43], v[28:31], v[92:95]
    buffer_load_dwordx4 v10, s[56:59], s82 offen offset:0 sc1 lds
    ds_read_b128 v[56:59], v49 offset:32768
    ds_read_b128 v[60:63], v49 offset:33792
    s_waitcnt lgkmcnt(7)
    v_mfma_f32_16x16x32_bf16 v[96:99], v[40:43], v[32:35], v[96:99]
    ds_read_b128 v[64:67], v49 offset:34816
    ds_read_b128 v[68:71], v49 offset:35840
    s_waitcnt lgkmcnt(8)
    v_mfma_f32_16x16x32_bf16 v[100:103], v[40:43], v[36:39], v[100:103]
    buffer_load_dwordx4 v10, s[56:59], s82 offen offset:1024 sc1 lds
    ds_read_b64_tr_b16 v[76:77], v83 offset:45056
    ds_read_b64_tr_b16 v[78:79], v83 offset:45568
    s_waitcnt lgkmcnt(8)
    v_mfma_f32_16x16x32_bf16 v[104:107], v[44:47], v[24:27], v[104:107]
    v_mfma_f32_16x16x32_bf16 v[108:111], v[44:47], v[28:31], v[108:111]
    buffer_load_dwordx4 v10, s[56:59], s82 offen offset:2048 sc1 lds
    v_mfma_f32_16x16x32_bf16 v[112:115], v[44:47], v[32:35], v[112:115]
    v_mfma_f32_16x16x32_bf16 v[116:119], v[44:47], v[36:39], v[116:119]
    s_waitcnt vmcnt(9) lgkmcnt(0)
    s_barrier
    v_mfma_f32_16x16x32_bf16 v[88:91], v[72:75], v[56:59], v[88:91]
    ds_read_b64_tr_b16 v[40:41], v80 offset:16384
    ds_read_b64_tr_b16 v[42:43], v80 offset:16896
    v_mfma_f32_16x16x32_bf16 v[92:95], v[72:75], v[60:63], v[92:95]
    buffer_load_dwordx4 v10, s[56:59], s82 offen offset:3072 sc1 lds
    s_add_u32 s82, s82, 16384
    ds_read_b128 v[24:27], v48 offset:0
    ds_read_b128 v[28:31], v48 offset:1024
    v_mfma_f32_16x16x32_bf16 v[96:99], v[72:75], v[64:67], v[96:99]
    ds_read_b128 v[32:35], v48 offset:2048
    s_lshl1_add_u32 m0, s33, 139264
    v_mfma_f32_16x16x32_bf16 v[100:103], v[72:75], v[68:71], v[100:103]
    buffer_load_dwordx4 v11, s[60:63], s83 offen lds
    ds_read_b128 v[36:39], v48 offset:3072
    ds_read_b64_tr_b16 v[44:45], v81 offset:16384
    v_mfma_f32_16x16x32_bf16 v[104:107], v[76:79], v[56:59], v[104:107]
    ds_read_b64_tr_b16 v[46:47], v81 offset:16896
    s_lshl1_add_u32 m0, s33, 140288
    v_mfma_f32_16x16x32_bf16 v[108:111], v[76:79], v[60:63], v[108:111]
    buffer_load_dwordx4 v12, s[60:63], s83 offen lds
    s_add_u32 s83, s83, 131072
    v_mfma_f32_16x16x32_bf16 v[112:115], v[76:79], v[64:67], v[112:115]
    v_mfma_f32_16x16x32_bf16 v[116:119], v[76:79], v[68:71], v[116:119]
    s_waitcnt lgkmcnt(5)
    v_mfma_f32_16x16x32_bf16 v[88:91], v[40:43], v[24:27], v[88:91]
    ds_read_b64_tr_b16 v[72:73], v80 offset:20480
    ds_read_b64_tr_b16 v[74:75], v80 offset:20992
    s_lshl2_add_u32 m0, s33, 24576
    s_waitcnt lgkmcnt(6)
    v_mfma_f32_16x16x32_bf16 v[92:95], v[40:43], v[28:31], v[92:95]
    buffer_load_dwordx4 v10, s[56:59], s82 offen offset:0 sc1 lds
    ds_read_b128 v[56:59], v48 offset:8192
    ds_read_b128 v[60:63], v48 offset:9216
    s_waitcnt lgkmcnt(7)
    v_mfma_f32_16x16x32_bf16 v[96:99], v[40:43], v[32:35], v[96:99]
    ds_read_b128 v[64:67], v48 offset:10240
    ds_read_b128 v[68:71], v48 offset:11264
    s_waitcnt lgkmcnt(8)
    v_mfma_f32_16x16x32_bf16 v[100:103], v[40:43], v[36:39], v[100:103]
    buffer_load_dwordx4 v10, s[56:59], s82 offen offset:1024 sc1 lds
    ds_read_b64_tr_b16 v[76:77], v81 offset:20480
    ds_read_b64_tr_b16 v[78:79], v81 offset:20992
    s_waitcnt lgkmcnt(8)
    v_mfma_f32_16x16x32_bf16 v[104:107], v[44:47], v[24:27], v[104:107]
    v_mfma_f32_16x16x32_bf16 v[108:111], v[44:47], v[28:31], v[108:111]
    buffer_load_dwordx4 v10, s[56:59], s82 offen offset:2048 sc1 lds
    v_mfma_f32_16x16x32_bf16 v[112:115], v[44:47], v[32:35], v[112:115]
    v_mfma_f32_16x16x32_bf16 v[116:119], v[44:47], v[36:39], v[116:119]
    s_waitcnt vmcnt(9) lgkmcnt(0)
    s_barrier
    v_mfma_f32_16x16x32_bf16 v[88:91], v[72:75], v[56:59], v[88:91]
    ds_read_b64_tr_b16 v[40:41], v84 offset:16384
    ds_read_b64_tr_b16 v[42:43], v84 offset:16896
    v_mfma_f32_16x16x32_bf16 v[92:95], v[72:75], v[60:63], v[92:95]
    buffer_load_dwordx4 v10, s[56:59], s82 offen offset:3072 sc1 lds
    s_add_u32 s82, s82, 16384
    ds_read_b128 v[24:27], v50 offset:0
    ds_read_b128 v[28:31], v50 offset:1024
    v_mfma_f32_16x16x32_bf16 v[96:99], v[72:75], v[64:67], v[96:99]
    ds_read_b128 v[32:35], v50 offset:2048
    s_lshl1_add_u32 m0, s33, 40960
    v_mfma_f32_16x16x32_bf16 v[100:103], v[72:75], v[68:71], v[100:103]
    buffer_load_dwordx4 v11, s[60:63], s83 offen lds
    ds_read_b128 v[36:39], v50 offset:3072
    ds_read_b64_tr_b16 v[44:45], v85 offset:16384
    v_mfma_f32_16x16x32_bf16 v[104:107], v[76:79], v[56:59], v[104:107]
    ds_read_b64_tr_b16 v[46:47], v85 offset:16896
    s_lshl1_add_u32 m0, s33, 41984
    v_mfma_f32_16x16x32_bf16 v[108:111], v[76:79], v[60:63], v[108:111]
    buffer_load_dwordx4 v12, s[60:63], s83 offen lds
    s_add_u32 s83, s83, 131072
    v_mfma_f32_16x16x32_bf16 v[112:115], v[76:79], v[64:67], v[112:115]
    v_mfma_f32_16x16x32_bf16 v[116:119], v[76:79], v[68:71], v[116:119]
    s_waitcnt lgkmcnt(5)
    v_mfma_f32_16x16x32_bf16 v[88:91], v[40:43], v[24:27], v[88:91]
    ds_read_b64_tr_b16 v[72:73], v84 offset:20480
    ds_read_b64_tr_b16 v[74:75], v84 offset:20992
    s_waitcnt lgkmcnt(6)
    v_mfma_f32_16x16x32_bf16 v[92:95], v[40:43], v[28:31], v[92:95]
    ds_read_b128 v[56:59], v50 offset:8192
    ds_read_b128 v[60:63], v50 offset:9216
    s_waitcnt lgkmcnt(7)
    v_mfma_f32_16x16x32_bf16 v[96:99], v[40:43], v[32:35], v[96:99]
    ds_read_b128 v[64:67], v50 offset:10240
    ds_read_b128 v[68:71], v50 offset:11264
    s_waitcnt lgkmcnt(8)
    v_mfma_f32_16x16x32_bf16 v[100:103], v[40:43], v[36:39], v[100:103]
    ds_read_b64_tr_b16 v[76:77], v85 offset:20480
    ds_read_b64_tr_b16 v[78:79], v85 offset:20992
    s_mov_b32 s84, 0
    s_waitcnt lgkmcnt(8)
    v_mfma_f32_16x16x32_bf16 v[104:107], v[44:47], v[24:27], v[104:107]
    buffer_load_dwordx4 v[120:123], v13, s[72:75], s84 offen
    v_mfma_f32_16x16x32_bf16 v[108:111], v[44:47], v[28:31], v[108:111]
    v_mfma_f32_16x16x32_bf16 v[112:115], v[44:47], v[32:35], v[112:115]
    s_mov_b32 s84, 32768
    v_mfma_f32_16x16x32_bf16 v[116:119], v[44:47], v[36:39], v[116:119]
    buffer_load_dwordx4 v[124:127], v13, s[72:75], s84 offen
    s_waitcnt vmcnt(8) lgkmcnt(0)
    s_barrier
    v_mfma_f32_16x16x32_bf16 v[88:91], v[72:75], v[56:59], v[88:91]
    ds_read_b64_tr_b16 v[40:41], v84 offset:40960
    ds_read_b64_tr_b16 v[42:43], v84 offset:41472
    v_mfma_f32_16x16x32_bf16 v[92:95], v[72:75], v[60:63], v[92:95]
    ds_read_b128 v[24:27], v50 offset:24576
    ds_read_b128 v[28:31], v50 offset:25600
    v_mfma_f32_16x16x32_bf16 v[96:99], v[72:75], v[64:67], v[96:99]
    ds_read_b128 v[32:35], v50 offset:26624
    v_mfma_f32_16x16x32_bf16 v[100:103], v[72:75], v[68:71], v[100:103]
    ds_read_b128 v[36:39], v50 offset:27648
    ds_read_b64_tr_b16 v[44:45], v85 offset:40960
    s_mov_b32 s84, 65536
    v_mfma_f32_16x16x32_bf16 v[104:107], v[76:79], v[56:59], v[104:107]
    ds_read_b64_tr_b16 v[46:47], v85 offset:41472
    buffer_load_dwordx4 v[128:131], v13, s[72:75], s84 offen
    v_mfma_f32_16x16x32_bf16 v[108:111], v[76:79], v[60:63], v[108:111]
    v_mfma_f32_16x16x32_bf16 v[112:115], v[76:79], v[64:67], v[112:115]
    s_mov_b32 s84, 98304
    v_mfma_f32_16x16x32_bf16 v[116:119], v[76:79], v[68:71], v[116:119]
    buffer_load_dwordx4 v[132:135], v13, s[72:75], s84 offen
    s_waitcnt lgkmcnt(5)
    v_mfma_f32_16x16x32_bf16 v[88:91], v[40:43], v[24:27], v[88:91]
    ds_read_b64_tr_b16 v[72:73], v84 offset:45056
    ds_read_b64_tr_b16 v[74:75], v84 offset:45568
    s_waitcnt lgkmcnt(6)
    v_mfma_f32_16x16x32_bf16 v[92:95], v[40:43], v[28:31], v[92:95]
    ds_read_b128 v[56:59], v50 offset:32768
    ds_read_b128 v[60:63], v50 offset:33792
    s_waitcnt lgkmcnt(7)
    v_mfma_f32_16x16x32_bf16 v[96:99], v[40:43], v[32:35], v[96:99]
    ds_read_b128 v[64:67], v50 offset:34816
    ds_read_b128 v[68:71], v50 offset:35840
    s_waitcnt lgkmcnt(8)
    v_mfma_f32_16x16x32_bf16 v[100:103], v[40:43], v[36:39], v[100:103]
    ds_read_b64_tr_b16 v[76:77], v85 offset:45056
    ds_read_b64_tr_b16 v[78:79], v85 offset:45568
    s_waitcnt lgkmcnt(8)
    v_mfma_f32_16x16x32_bf16 v[104:107], v[44:47], v[24:27], v[104:107]
    v_mfma_f32_16x16x32_bf16 v[108:111], v[44:47], v[28:31], v[108:111]
    v_mfma_f32_16x16x32_bf16 v[112:115], v[44:47], v[32:35], v[112:115]
    v_mfma_f32_16x16x32_bf16 v[116:119], v[44:47], v[36:39], v[116:119]
    s_waitcnt vmcnt(4) lgkmcnt(0)
    s_barrier
    v_mfma_f32_16x16x32_bf16 v[88:91], v[72:75], v[56:59], v[88:91]
    ds_read_b64_tr_b16 v[40:41], v80 offset:40960
    ds_read_b64_tr_b16 v[42:43], v80 offset:41472
    v_mfma_f32_16x16x32_bf16 v[92:95], v[72:75], v[60:63], v[92:95]
    ds_read_b128 v[24:27], v48 offset:24576
    ds_read_b128 v[28:31], v48 offset:25600
    v_mfma_f32_16x16x32_bf16 v[96:99], v[72:75], v[64:67], v[96:99]
    ds_read_b128 v[32:35], v48 offset:26624
    v_mfma_f32_16x16x32_bf16 v[100:103], v[72:75], v[68:71], v[100:103]
    ds_read_b128 v[36:39], v48 offset:27648
    ds_read_b64_tr_b16 v[44:45], v81 offset:40960
    v_mfma_f32_16x16x32_bf16 v[104:107], v[76:79], v[56:59], v[104:107]
    ds_read_b64_tr_b16 v[46:47], v81 offset:41472
    v_mfma_f32_16x16x32_bf16 v[108:111], v[76:79], v[60:63], v[108:111]
    ds_read_b64 v[168:169], v3 offset:0
    ds_read_b64 v[170:171], v3 offset:512
    ds_read_b64 v[172:173], v3 offset:1024
    v_mfma_f32_16x16x32_bf16 v[112:115], v[76:79], v[64:67], v[112:115]
    ds_read_b64 v[174:175], v3 offset:1536
    ds_read_b64 v[176:177], v3 offset:2048
    ds_read_b64 v[178:179], v3 offset:2560
    v_mfma_f32_16x16x32_bf16 v[116:119], v[76:79], v[68:71], v[116:119]
    ds_read_b64 v[180:181], v3 offset:3072
    ds_read_b64 v[182:183], v3 offset:3584
    s_waitcnt lgkmcnt(13)
    v_mfma_f32_16x16x32_bf16 v[88:91], v[40:43], v[24:27], v[88:91]
    ds_read_b64_tr_b16 v[72:73], v80 offset:45056
    ds_read_b64_tr_b16 v[74:75], v80 offset:45568
    s_waitcnt lgkmcnt(14)
    v_mfma_f32_16x16x32_bf16 v[92:95], v[40:43], v[28:31], v[92:95]
    ds_read_b128 v[56:59], v48 offset:32768
    ds_read_b128 v[60:63], v48 offset:33792
    s_waitcnt lgkmcnt(15)
    v_mfma_f32_16x16x32_bf16 v[96:99], v[40:43], v[32:35], v[96:99]
    ds_read_b128 v[64:67], v48 offset:34816
    ds_read_b128 v[68:71], v48 offset:35840
    s_waitcnt lgkmcnt(15)
    v_mfma_f32_16x16x32_bf16 v[100:103], v[40:43], v[36:39], v[100:103]
    ds_read_b64_tr_b16 v[76:77], v81 offset:45056
    ds_read_b64_tr_b16 v[78:79], v81 offset:45568
    s_waitcnt lgkmcnt(15)
    v_mfma_f32_16x16x32_bf16 v[104:107], v[44:47], v[24:27], v[104:107]
    v_lshlrev_b32 v184, 16, v168
    v_and_b32 v185, 0xffff0000, v168
    v_mfma_f32_16x16x32_bf16 v[108:111], v[44:47], v[28:31], v[108:111]
    v_lshlrev_b32 v186, 16, v169
    v_and_b32 v187, 0xffff0000, v169
    v_mfma_f32_16x16x32_bf16 v[112:115], v[44:47], v[32:35], v[112:115]
    s_waitcnt lgkmcnt(14)
    v_lshlrev_b32 v188, 16, v170
    v_and_b32 v189, 0xffff0000, v170
    v_mfma_f32_16x16x32_bf16 v[116:119], v[44:47], v[36:39], v[116:119]
    v_lshlrev_b32 v190, 16, v171
    v_and_b32 v191, 0xffff0000, v171
    s_waitcnt lgkmcnt(5)
    v_mfma_f32_16x16x32_bf16 v[88:91], v[72:75], v[56:59], v[88:91]
    v_lshlrev_b32 v192, 16, v172
    v_and_b32 v193, 0xffff0000, v172
    s_waitcnt lgkmcnt(4)
    v_mfma_f32_16x16x32_bf16 v[92:95], v[72:75], v[60:63], v[92:95]
    v_lshlrev_b32 v194, 16, v173
    v_and_b32 v195, 0xffff0000, v173
    s_waitcnt lgkmcnt(3)
    v_mfma_f32_16x16x32_bf16 v[96:99], v[72:75], v[64:67], v[96:99]
    v_lshlrev_b32 v196, 16, v174
    v_and_b32 v197, 0xffff0000, v174
    s_waitcnt lgkmcnt(2)
    v_mfma_f32_16x16x32_bf16 v[100:103], v[72:75], v[68:71], v[100:103]
    v_lshlrev_b32 v198, 16, v175
    v_and_b32 v199, 0xffff0000, v175
    s_waitcnt lgkmcnt(0)
    v_mfma_f32_16x16x32_bf16 v[104:107], v[76:79], v[56:59], v[104:107]
    s_mov_b32 s72, s22
    v_lshlrev_b32 v200, 16, v176
    v_and_b32 v201, 0xffff0000, v176
    v_mfma_f32_16x16x32_bf16 v[108:111], v[76:79], v[60:63], v[108:111]
    s_mov_b32 s73, s23
    v_lshlrev_b32 v202, 16, v177
    v_and_b32 v203, 0xffff0000, v177
    v_mfma_f32_16x16x32_bf16 v[112:115], v[76:79], v[64:67], v[112:115]
    s_mov_b32 s74, 0x400000
    v_lshlrev_b32 v204, 16, v178
    v_and_b32 v205, 0xffff0000, v178
    v_mfma_f32_16x16x32_bf16 v[116:119], v[76:79], v[68:71], v[116:119]
    s_mov_b32 s75, 0x20000
    v_lshlrev_b32 v206, 16, v179
    v_and_b32 v207, 0xffff0000, v179
    v_lshlrev_b32 v208, 16, v180
    v_and_b32 v209, 0xffff0000, v180
    v_lshlrev_b32 v210, 16, v181
    v_and_b32 v211, 0xffff0000, v181
    v_lshlrev_b32 v212, 16, v182
    v_and_b32 v213, 0xffff0000, v182
    v_lshlrev_b32 v214, 16, v183
    v_and_b32 v215, 0xffff0000, v183
    v_cvt_pk_bf16_f32 v40, v88, v89
    v_cvt_pk_bf16_f32 v41, v90, v91
    v_lshlrev_b32 v88, 16, v40
    v_and_b32 v89, 0xffff0000, v40
    v_lshlrev_b32 v90, 16, v41
    v_and_b32 v91, 0xffff0000, v41
    v_cvt_pk_bf16_f32 v42, v104, v105
    v_cvt_pk_bf16_f32 v43, v106, v107
    v_lshlrev_b32 v104, 16, v42
    v_and_b32 v105, 0xffff0000, v42
    v_lshlrev_b32 v106, 16, v43
    v_and_b32 v107, 0xffff0000, v43
    v_pk_mul_f32 v[88:89], v[88:89], v[184:185]
    v_pk_mul_f32 v[90:91], v[90:91], v[186:187]
    v_pk_mul_f32 v[104:105], v[104:105], v[200:201]
    v_pk_mul_f32 v[106:107], v[106:107], v[202:203]
    v_cvt_pk_bf16_f32 v88, v88, v89
    v_cvt_pk_bf16_f32 v89, v90, v91
    ds_write_b64 v14, v[88:89] offset:0
    v_cvt_pk_bf16_f32 v104, v104, v105
    v_cvt_pk_bf16_f32 v105, v106, v107
    ds_write_b64 v15, v[104:105] offset:0
    ds_read_b128 v[48:51], v17 offset:0
    v_cvt_pk_bf16_f32 v40, v92, v93
    v_cvt_pk_bf16_f32 v41, v94, v95
    v_lshlrev_b32 v92, 16, v40
    v_and_b32 v93, 0xffff0000, v40
    v_lshlrev_b32 v94, 16, v41
    v_and_b32 v95, 0xffff0000, v41
    v_cvt_pk_bf16_f32 v42, v108, v109
    v_cvt_pk_bf16_f32 v43, v110, v111
    v_lshlrev_b32 v108, 16, v42
    v_and_b32 v109, 0xffff0000, v42
    v_lshlrev_b32 v110, 16, v43
    v_and_b32 v111, 0xffff0000, v43
    v_pk_mul_f32 v[92:93], v[92:93], v[188:189]
    v_pk_mul_f32 v[94:95], v[94:95], v[190:191]
    v_pk_mul_f32 v[108:109], v[108:109], v[204:205]
    v_pk_mul_f32 v[110:111], v[110:111], v[206:207]
    v_cvt_pk_bf16_f32 v92, v92, v93
    v_cvt_pk_bf16_f32 v93, v94, v95
    ds_write_b64 v14, v[92:93] offset:1024
    v_cvt_pk_bf16_f32 v108, v108, v109
    v_cvt_pk_bf16_f32 v109, v110, v111
    ds_write_b64 v15, v[108:109] offset:1024
    ds_read_b128 v[52:55], v17 offset:1024
    s_waitcnt vmcnt(0)
    v_lshlrev_b32 v136, 16, v120
    v_and_b32 v137, 0xffff0000, v120
    v_lshlrev_b32 v138, 16, v121
    v_and_b32 v139, 0xffff0000, v121
    v_lshlrev_b32 v140, 16, v122
    v_and_b32 v141, 0xffff0000, v122
    v_lshlrev_b32 v142, 16, v123
    v_and_b32 v143, 0xffff0000, v123
    s_waitcnt lgkmcnt(3)
    v_lshlrev_b32 v24, 16, v48
    v_and_b32 v25, 0xffff0000, v48
    v_lshlrev_b32 v26, 16, v49
    v_and_b32 v27, 0xffff0000, v49
    v_lshlrev_b32 v28, 16, v50
    v_and_b32 v29, 0xffff0000, v50
    v_lshlrev_b32 v30, 16, v51
    v_and_b32 v31, 0xffff0000, v51
L_pad13:
    s_cbranch_execz L_vret3
    v_pk_add_f32 v[24:25], v[24:25], v[136:137]
    v_pk_add_f32 v[26:27], v[26:27], v[138:139]
    v_pk_add_f32 v[28:29], v[28:29], v[140:141]
    v_pk_add_f32 v[30:31], v[30:31], v[142:143]
    v_cvt_pk_bf16_f32 v48, v24, v25
    v_cvt_pk_bf16_f32 v49, v26, v27
    v_cvt_pk_bf16_f32 v50, v28, v29
    v_cvt_pk_bf16_f32 v51, v30, v31
    s_mov_b32 s84, 0
    buffer_store_dwordx4 v[48:51], v13, s[72:75], s84 offen
    v_cvt_pk_bf16_f32 v40, v96, v97
    v_cvt_pk_bf16_f32 v41, v98, v99
    v_lshlrev_b32 v96, 16, v40
    v_and_b32 v97, 0xffff0000, v40
    v_lshlrev_b32 v98, 16, v41
    v_and_b32 v99, 0xffff0000, v41
    v_cvt_pk_bf16_f32 v42, v112, v113
    v_cvt_pk_bf16_f32 v43, v114, v115
    v_lshlrev_b32 v112, 16, v42
    v_and_b32 v113, 0xffff0000, v42
    v_lshlrev_b32 v114, 16, v43
    v_and_b32 v115, 0xffff0000, v43
    v_pk_mul_f32 v[96:97], v[96:97], v[192:193]
    v_pk_mul_f32 v[98:99], v[98:99], v[194:195]
    v_pk_mul_f32 v[112:113], v[112:113], v[208:209]
    v_pk_mul_f32 v[114:115], v[114:115], v[210:211]
    v_cvt_pk_bf16_f32 v96, v96, v97
    v_cvt_pk_bf16_f32 v97, v98, v99
    ds_write_b64 v14, v[96:97] offset:2048
    v_cvt_pk_bf16_f32 v112, v112, v113
    v_cvt_pk_bf16_f32 v113, v114, v115
    ds_write_b64 v15, v[112:113] offset:2048
    ds_read_b128 v[56:59], v17 offset:2048
    v_lshlrev_b32 v144, 16, v124
    v_and_b32 v145, 0xffff0000, v124
    v_lshlrev_b32 v146, 16, v125
    v_and_b32 v147, 0xffff0000, v125
    v_lshlrev_b32 v148, 16, v126
    v_and_b32 v149, 0xffff0000, v126
    v_lshlrev_b32 v150, 16, v127
    v_and_b32 v151, 0xffff0000, v127
    s_waitcnt lgkmcnt(3)
    v_lshlrev_b32 v24, 16, v52
    v_and_b32 v25, 0xffff0000, v52
    v_lshlrev_b32 v26, 16, v53
    v_and_b32 v27, 0xffff0000, v53
    v_lshlrev_b32 v28, 16, v54
    v_and_b32 v29, 0xffff0000, v54
    v_lshlrev_b32 v30, 16, v55
    v_and_b32 v31, 0xffff0000, v55
    v_pk_add_f32 v[24:25], v[24:25], v[144:145]
    v_pk_add_f32 v[26:27], v[26:27], v[146:147]
    v_pk_add_f32 v[28:29], v[28:29], v[148:149]
    v_pk_add_f32 v[30:31], v[30:31], v[150:151]
    v_cvt_pk_bf16_f32 v52, v24, v25
    v_cvt_pk_bf16_f32 v53, v26, v27
    v_cvt_pk_bf16_f32 v54, v28, v29
    v_cvt_pk_bf16_f32 v55, v30, v31
    s_mov_b32 s84, 32768
    buffer_store_dwordx4 v[52:55], v13, s[72:75], s84 offen
    v_cvt_pk_bf16_f32 v40, v100, v101
    v_cvt_pk_bf16_f32 v41, v102, v103
    v_lshlrev_b32 v100, 16, v40
    v_and_b32 v101, 0xffff0000, v40
    v_lshlrev_b32 v102, 16, v41
    v_and_b32 v103, 0xffff0000, v41
    v_cvt_pk_bf16_f32 v42, v116, v117
    v_cvt_pk_bf16_f32 v43, v118, v119
    v_lshlrev_b32 v116, 16, v42
    v_and_b32 v117, 0xffff0000, v42
    v_lshlrev_b32 v118, 16, v43
    v_and_b32 v119, 0xffff0000, v43
    v_pk_mul_f32 v[100:101], v[100:101], v[196:197]
    v_pk_mul_f32 v[102:103], v[102:103], v[198:199]
    v_pk_mul_f32 v[116:117], v[116:117], v[212:213]
    v_pk_mul_f32 v[118:119], v[118:119], v[214:215]
    v_cvt_pk_bf16_f32 v100, v100, v101
    v_cvt_pk_bf16_f32 v101, v102, v103
    ds_write_b64 v14, v[100:101] offset:3072
    v_cvt_pk_bf16_f32 v116, v116, v117
    v_cvt_pk_bf16_f32 v117, v118, v119
    ds_write_b64 v15, v[116:117] offset:3072
    ds_read_b128 v[60:63], v17 offset:3072
    v_lshlrev_b32 v152, 16, v128
    v_and_b32 v153, 0xffff0000, v128
    v_lshlrev_b32 v154, 16, v129
    v_and_b32 v155, 0xffff0000, v129
    v_lshlrev_b32 v156, 16, v130
    v_and_b32 v157, 0xffff0000, v130
    v_lshlrev_b32 v158, 16, v131
    v_and_b32 v159, 0xffff0000, v131
    s_waitcnt lgkmcnt(3)
    v_lshlrev_b32 v24, 16, v56
    v_and_b32 v25, 0xffff0000, v56
    v_lshlrev_b32 v26, 16, v57
    v_and_b32 v27, 0xffff0000, v57
    v_lshlrev_b32 v28, 16, v58
    v_and_b32 v29, 0xffff0000, v58
    v_lshlrev_b32 v30, 16, v59
    v_and_b32 v31, 0xffff0000, v59
    v_pk_add_f32 v[24:25], v[24:25], v[152:153]
    v_pk_add_f32 v[26:27], v[26:27], v[154:155]
    v_pk_add_f32 v[28:29], v[28:29], v[156:157]
    v_pk_add_f32 v[30:31], v[30:31], v[158:159]
    v_cvt_pk_bf16_f32 v56, v24, v25
    v_cvt_pk_bf16_f32 v57, v26, v27
    v_cvt_pk_bf16_f32 v58, v28, v29
    v_cvt_pk_bf16_f32 v59, v30, v31
    s_mov_b32 s84, 65536
    buffer_store_dwordx4 v[56:59], v13, s[72:75], s84 offen
    v_lshlrev_b32 v160, 16, v132
    v_and_b32 v161, 0xffff0000, v132
    v_lshlrev_b32 v162, 16, v133
    v_and_b32 v163, 0xffff0000, v133
    v_lshlrev_b32 v164, 16, v134
    v_and_b32 v165, 0xffff0000, v134
    v_lshlrev_b32 v166, 16, v135
    v_and_b32 v167, 0xffff0000, v135
    s_waitcnt lgkmcnt(0)
    v_lshlrev_b32 v24, 16, v60
    v_and_b32 v25, 0xffff0000, v60
    v_lshlrev_b32 v26, 16, v61
    v_and_b32 v27, 0xffff0000, v61
    v_lshlrev_b32 v28, 16, v62
    v_and_b32 v29, 0xffff0000, v62
    v_lshlrev_b32 v30, 16, v63
    v_and_b32 v31, 0xffff0000, v63
    v_pk_add_f32 v[24:25], v[24:25], v[160:161]
    v_pk_add_f32 v[26:27], v[26:27], v[162:163]
    v_pk_add_f32 v[28:29], v[28:29], v[164:165]
    v_pk_add_f32 v[30:31], v[30:31], v[166:167]
    v_cvt_pk_bf16_f32 v60, v24, v25
    v_cvt_pk_bf16_f32 v61, v26, v27
    v_cvt_pk_bf16_f32 v62, v28, v29
    v_cvt_pk_bf16_f32 v63, v30, v31
    s_mov_b32 s84, 98304
    buffer_store_dwordx4 v[60:63], v13, s[72:75], s84 offen
L_fin:
L_end:
    s_endpgm
L_code_end:
.section .rodata,"a"
.p2align 6
.amdhsa_kernel recurrent_scan__sliding_local_dilated__glu_gated_geglu__prompt_kernel
  .amdhsa_next_free_vgpr 256
  .amdhsa_next_free_sgpr 102
  .amdhsa_accum_offset 256
  .amdhsa_group_segment_fixed_size 0
  .amdhsa_kernarg_size 80
  .amdhsa_user_sgpr_count 2
  .amdhsa_user_sgpr_kernarg_segment_ptr 1
  .amdhsa_system_sgpr_workgroup_id_x 1
.end_amdhsa_kernel
```

```asm
; @launch grid=(256,1,1) block=(512,1,1) lds=163840
.amdgcn_target "amdgcn-amd-amdhsa--gfx950"
.text
.globl recurrent_scan__sliding_local_dilated__glu_gated_geglu__prompt_kernel
.p2align 12
.p2align 8
.type recurrent_scan__sliding_local_dilated__glu_gated_geglu__prompt_kernel,@function
recurrent_scan__sliding_local_dilated__glu_gated_geglu__prompt_kernel:
    s_cmp_ge_u32 s2, 256
    s_cbranch_scc1 L_end
    s_load_dwordx4 s[8:11], s[0:1], 0
    s_load_dwordx2 s[12:13], s[0:1], 16
    s_load_dwordx4 s[16:19], s[0:1], 32
    s_load_dwordx4 s[20:23], s[0:1], 48
    s_load_dwordx4 s[24:27], s[0:1], 64
    v_lshrrev_b32 v3, 6, v0
    v_and_b32 v1, 63, v0
    v_readfirstlane_b32 s3, v3
    s_and_b32 s84, s2, 7
    s_lshr_b32 s85, s2, 3
    s_mov_b32 s15, s85
    s_and_b32 s32, s84, 1
    s_lshl_b32 s86, s32, 3
    s_and_b32 s87, s85, 7
    s_add_u32 s28, s86, s87
    s_lshr_b32 s86, s84, 1
    s_lshl_b32 s86, s86, 2
    s_lshr_b32 s87, s85, 3
    s_add_u32 s29, s86, s87
    s_lshl_b32 s87, s32, 3
    s_xor_b32 s86, s86, s87
    s_and_b32 s87, s85, 3
    s_add_u32 s30, s86, s87
    s_lshr_b32 s31, s85, 2
    s_and_b32 s4, s3, 3
    s_lshr_b32 s5, s4, 1
    s_and_b32 s6, s4, 1
    s_lshr_b32 s7, s3, 2
    s_lshl_b32 s33, s4, 10
    s_mov_b64 exec, 0
    s_cmp_eq_u32 s3, 5
    s_cbranch_scc1 L_fan5
    s_cmp_eq_u32 s3, 6
    s_cbranch_scc1 L_fan6
    s_cmp_eq_u32 s3, 7
    s_cbranch_scc1 L_fan7
    s_cmp_lg_u32 s7, 0
    s_cbranch_scc1 L_teamB
L_teamA:
    s_mov_b64 exec, -1
    v_lshrrev_b32 v64, 4, v1
    v_bfe_u32 v65, v1, 2, 2
    v_and_b32 v66, 3, v1
    v_and_b32 v67, 15, v1
    v_lshrrev_b32 v68, 3, v1
    v_and_b32 v69, 7, v1
    s_lshl_b32 s85, s28, 7
    s_lshl_b32 s86, s4, 5
    s_add_u32 s86, s85, s86
    v_add_u32 v71, s86, v68
    v_xor_b32 v70, v69, v64
    v_lshlrev_b32 v70, 4, v70
    v_lshl_add_u32 v20, v71, 11, v70
    v_xor_b32 v21, 64, v20
    v_add_u32 v21, 16384, v21
    s_lshl_b32 s79, s4, 12
    s_and_b32 s72, s28, 3
    s_bitcmp1_b32 s28, 3
    s_cselect_b32 s91, 4, 0
    s_add_u32 s72, s72, s91
    s_mul_i32 s72, s72, 256
    s_sub_u32 s72, s72, 128
    s_lshl_b32 s85, s4, 3
    s_and_b32 s86, s4, 1
    s_lshl_b32 s86, s86, 2
    v_and_b32 v70, 2, v68
    v_xor_b32 v70, v70, v69
    v_xor_b32 v70, s86, v70
    v_add_u32 v71, s85, v68
    v_mul_u32_u24 v71, 7168, v71
    v_lshl_add_u32 v22, v70, 4, v71
    v_lshrrev_b32 v71, 2, v1
    s_lshl_b32 s86, s86, 2
    v_add_u32 v71, s86, v71
    v_mul_u32_u24 v71, 7168, v71
    v_and_b32 v70, 2, v64
    v_xor_b32 v70, v70, v66
    v_lshl_add_u32 v76, v70, 4, v71
    s_and_b32 s77, s28, 3
    s_bitcmp1_b32 s28, 3
    s_cselect_b32 s91, 4, 0
    s_add_u32 s77, s77, s91
    s_mul_i32 s77, s77, 917504
    s_add_u32 s77, s77, 0xfffc8000
    s_waitcnt lgkmcnt(0)
    s_mov_b32 s36, s8
    s_mov_b32 s37, s9
    s_mov_b32 s38, 0x400000
    s_mov_b32 s39, 0x20000
    s_add_u32 m0, s79, 116736
    s_add_u32 s72, s72, 128
    s_and_b32 s78, s72, 0x7ff
    buffer_load_dwordx4 v20, s[36:39], s78 offen lds
    s_add_u32 m0, s79, 117760
    s_nop 0
    buffer_load_dwordx4 v21, s[36:39], s78 offen lds
    s_add_u32 m0, s79, 118784
    s_add_u32 s78, s78, 32768
    buffer_load_dwordx4 v20, s[36:39], s78 offen lds
    s_add_u32 m0, s79, 119808
    s_nop 0
    buffer_load_dwordx4 v21, s[36:39], s78 offen lds
    s_mul_i32 s85, s29, 320
    s_and_b32 s86, s29, 1
    s_lshl_b32 s87, s86, 6
    s_add_u32 s87, s87, s85
    s_add_u32 s40, s16, s87
    s_addc_u32 s41, s17, 0
    s_sub_u32 s42, 7340032, s87
    s_mov_b32 s43, 0x20000
    s_add_u32 s44, s18, s87
    s_addc_u32 s45, s19, 0
    s_sub_u32 s46, 7340032, s87
    s_mov_b32 s47, 0x20000
    s_xor_b32 s86, s86, 1
    s_lshl_b32 s86, s86, 8
    s_add_u32 s87, s86, s85
    s_cmp_lt_u32 s4, 2
    s_cselect_b32 s88, s16, s18
    s_cselect_b32 s89, s17, s19
    s_add_u32 s48, s88, s87
    s_addc_u32 s49, s89, 0
    s_sub_u32 s50, 7340032, s87
    s_mov_b32 s51, 0x20000
    s_add_u32 m0, s33, 16384
    s_add_u32 s77, s77, 229376
    buffer_load_dwordx4 v22, s[40:43], s77 offen offset:0 lds
    s_add_u32 m0, s33, 20352
    s_nop 0
    buffer_load_dwordx4 v22, s[40:43], s77 offen offset:128 lds
    s_add_u32 m0, s33, 24576
    s_nop 0
    buffer_load_dwordx4 v22, s[44:47], s77 offen offset:0 lds
    s_add_u32 m0, s33, 28544
    s_nop 0
    buffer_load_dwordx4 v22, s[44:47], s77 offen offset:128 lds
    s_add_u32 m0, s33, 32768
    s_nop 0
    buffer_load_dwordx4 v76, s[48:51], s77 offen lds
    s_add_u32 m0, s33, 36864
    s_add_u32 s77, s77, 229376
    buffer_load_dwordx4 v22, s[40:43], s77 offen offset:0 lds
    s_add_u32 m0, s33, 40832
    s_nop 0
    buffer_load_dwordx4 v22, s[40:43], s77 offen offset:128 lds
    s_add_u32 m0, s33, 45056
    s_nop 0
    buffer_load_dwordx4 v22, s[44:47], s77 offen offset:0 lds
    s_add_u32 m0, s33, 49024
    s_nop 0
    buffer_load_dwordx4 v22, s[44:47], s77 offen offset:128 lds
    s_add_u32 m0, s33, 53248
    s_nop 0
    buffer_load_dwordx4 v76, s[48:51], s77 offen lds
    s_mov_b32 s68, s26
    s_mov_b32 s69, s27
    s_mov_b32 s70, 0x10000000
    s_mov_b32 s71, 0x20000
    s_getpc_b64 s[92:93]
L_pc:
    s_lshl2_add_u32 s91, s15, s4
    s_lshl_b32 s91, s91, 9
    s_min_u32 s91, s91, L_code_end - L_pc - 512
    s_load_dword s94, s[92:93], s91 offset:0
    s_load_dword s94, s[92:93], s91 offset:64
    s_load_dword s94, s[92:93], s91 offset:128
    s_load_dword s94, s[92:93], s91 offset:192
    s_load_dword s94, s[92:93], s91 offset:256
    s_load_dword s94, s[92:93], s91 offset:320
    s_load_dword s94, s[92:93], s91 offset:384
    s_load_dword s94, s[92:93], s91 offset:448
    v_lshrrev_b32 v64, 4, v1
    v_bfe_u32 v65, v1, 2, 2
    v_and_b32 v66, 3, v1
    v_and_b32 v67, 15, v1
    v_lshrrev_b32 v68, 3, v1
    v_and_b32 v69, 7, v1
    s_lshl_b32 s85, s6, 12
    s_add_u32 s85, s85, 16384
    v_lshl_add_u32 v70, v64, 3, v65
    v_lshlrev_b32 v70, 7, v70
    v_and_b32 v71, 1, v66
    v_lshl_add_u32 v70, v71, 3, v70
    v_add_u32 v70, s85, v70
    v_and_b32 v71, 2, v65
    v_and_b32 v72, 1, v64
    v_lshl_add_u32 v71, v72, 2, v71
    v_lshrrev_b32 v72, 1, v66
    v_xor_b32 v71, v71, v72
    v_xor_b32 v72, 0, v71
    v_lshl_add_u32 v4, v72, 4, v70
    v_add_u32 v9, 40960, v4
    v_xor_b32 v72, 2, v71
    v_lshl_add_u32 v5, v72, 4, v70
    v_add_u32 v10, 40960, v5
    v_xor_b32 v72, 4, v71
    v_lshl_add_u32 v6, v72, 4, v70
    v_add_u32 v11, 40960, v6
    v_xor_b32 v72, 6, v71
    v_lshl_add_u32 v7, v72, 4, v70
    v_add_u32 v12, 40960, v7
    v_lshl_add_u32 v70, v64, 3, v65
    v_lshlrev_b32 v70, 6, v70
    v_and_b32 v71, 1, v66
    v_lshl_add_u32 v70, v71, 3, v70
    v_and_b32 v71, 1, v64
    v_xor_b32 v71, s6, v71
    v_lshl_add_u32 v70, v71, 5, v70
    v_lshrrev_b32 v71, 1, v66
    v_lshl_add_u32 v70, v71, 4, v70
    v_add_u32 v8, 16384, v70
    v_add_u32 v13, 57344, v70
    v_lshrrev_b32 v70, 1, v67
    v_xor_b32 v70, v70, v64
    v_lshlrev_b32 v70, 4, v70
    v_lshl_add_u32 v70, v67, 7, v70
    s_lshl_b32 s85, s5, 13
    v_add_u32 v16, s85, v70
    v_xor_b32 v17, 64, v16
    s_mov_b32 s80, 116736
    s_lshl_b32 s86, s28, 7
    s_sub_u32 s86, s86, 16
    s_max_i32 s86, s86, 0
    s_lshl_b32 s87, s4, 2
    v_add_u32 v71, s87, v68
    v_lshrrev_b32 v70, 1, v71
    v_and_b32 v70, 7, v70
    v_xor_b32 v70, v70, v69
    v_lshlrev_b32 v70, 4, v70
    v_add_u32 v71, s86, v71
    v_lshl_add_u32 v3, v71, 11, v70
    s_lshl_b32 s81, s4, 9
    s_lshl_b32 s85, s4, 3
    s_and_b32 s86, s4, 1
    s_lshl_b32 s86, s86, 2
    v_and_b32 v70, 2, v68
    v_xor_b32 v70, v70, v69
    v_xor_b32 v70, s86, v70
    v_add_u32 v71, s85, v68
    v_mul_u32_u24 v71, 6144, v71
    v_lshl_add_u32 v23, v70, 4, v71
    s_lshl_b32 s85, s6, 2
    v_lshl_add_u32 v70, v64, 3, v65
    v_lshlrev_b32 v70, 7, v70
    v_and_b32 v71, 1, v66
    v_lshl_add_u32 v70, v71, 3, v70
    v_add_u32 v70, 0, v70
    v_and_b32 v71, 2, v65
    v_and_b32 v72, 1, v64
    v_lshl_add_u32 v71, v72, 2, v71
    v_lshrrev_b32 v72, 1, v66
    v_xor_b32 v71, v71, v72
    v_xor_b32 v71, s85, v71
    v_xor_b32 v72, 0, v71
    v_lshl_add_u32 v250, v72, 4, v70
    v_add_u32 v252, 65536, v250
    v_xor_b32 v72, 2, v71
    v_lshl_add_u32 v251, v72, 4, v70
    v_add_u32 v253, 65536, v251
    s_lshl_b32 s85, s5, 12
    v_lshl_add_u32 v248, v1, 4, s85
    v_add_u32 v249, 65536, v248
    s_lshl_b32 s85, s4, 12
    v_lshl_add_u32 v18, v1, 4, s85
    s_lshl_b32 s85, s4, 4
    v_and_b32 v70, 2, v68
    v_xor_b32 v70, v70, v69
    v_xor_b32 v70, 0, v70
    v_add_u32 v71, s85, v68
    v_mul_u32_u24 v71, 2048, v71
    v_lshl_add_u32 v254, v70, 4, v71
    s_add_u32 s85, s85, 8
    v_and_b32 v70, 2, v68
    v_xor_b32 v70, v70, v69
    v_xor_b32 v70, 4, v70
    v_add_u32 v71, s85, v68
    v_mul_u32_u24 v71, 2048, v71
    v_lshl_add_u32 v255, v70, 4, v71
    s_lshl_b32 s85, s31, 8
    s_lshl_b32 s86, s32, 7
    s_add_u32 s86, s85, s86
    s_xor_b32 s87, s86, 128
    s_lshr_b32 s91, s31, 2
    s_lshl1_add_u32 s91, s91, s32
    s_lshl_b32 s91, s91, 13
    s_add_u32 s91, s91, 0x2000000
    s_xor_b32 s85, s91, 8192
    s_and_b32 s92, s31, 3
    s_cmp_eq_u32 s92, 1
    s_cselect_b32 s86, s91, s86
    s_cselect_b32 s87, s85, s87
    s_cselect_b32 s91, 0x2a00000, 0
    s_cselect_b32 s92, s26, s20
    s_cselect_b32 s93, s27, s21
    s_max_u32 s91, s91, 7340032
    s_add_u32 s60, s92, s86
    s_addc_u32 s61, s93, 0
    s_sub_u32 s62, s91, s86
    s_mov_b32 s63, 0x20000
    s_add_u32 s64, s92, s87
    s_addc_u32 s65, s93, 0
    s_sub_u32 s66, s91, s87
    s_mov_b32 s67, 0x20000
    s_add_u32 s56, s26, 0x400000
    s_addc_u32 s57, s27, 0
    s_mov_b32 s58, 0xe00000
    s_mov_b32 s59, 0x20000
    s_mul_i32 s82, s30, 917504
    s_mul_i32 s85, s32, 327680
    s_add_u32 s82, s82, s85
    s_mul_i32 s83, s32, 2621440
    s_mul_i32 s85, s32, 10
    s_sub_u32 s85, 40, s85
    s_lshl_b32 s14, s85, 13
    s_lshl_b32 s35, s85, 16
    s_and_b32 s85, s31, 3
    s_cmp_eq_u32 s85, 1
    s_cselect_b64 vcc, -1, 0
    s_lshl_b32 s85, s4, 11
    v_lshl_add_u32 v70, v1, 4, s85
    v_add_u32 v71, 1024, v70
    v_cndmask_b32 v254, v254, v70, vcc
    v_cndmask_b32 v255, v255, v71, vcc
    v_lshrrev_b32 v78, 4, v1
    v_and_b32 v79, 1, v78
    v_lshrrev_b32 v78, 1, v78
    v_lshlrev_b32 v78, 8, v78
    v_lshl_add_u32 v78, v79, 10, v78
    v_and_b32 v79, 15, v1
    v_lshl_add_u32 v19, v79, 4, v78
    s_mul_i32 s84, s28, 112
    s_mul_i32 s85, s29, 5
    s_add_u32 s84, s84, s85
    s_lshl_b32 s84, s84, 13
    s_lshl_b32 s85, s5, 12
    s_add_u32 s84, s84, s85
    s_add_u32 s84, s84, 0x400000
    s_and_b32 s85, s29, 1
    s_lshl1_add_u32 s86, s6, s85
    s_lshl_b32 s86, s86, 13
    s_add_u32 s72, s84, s86
    s_add_u32 s73, s72, 8192
    s_xor_b32 s85, s85, 1
    s_lshl_b32 s85, s85, 15
    s_add_u32 s84, s84, s85
    s_lshl_b32 s85, s6, 9
    s_add_u32 s74, s84, s85
    s_lshl2_add_u32 s91, s2, s4
    s_lshl_b32 s75, s91, 9
    s_lshr_b32 s92, s91, 2
    s_mul_i32 s92, s92, 7168
    s_and_b32 s91, s91, 3
    s_lshl_b32 s91, s91, 9
    s_add_u32 s92, s92, s91
    s_add_u32 s99, s92, 5120
    s_mov_b32 s36, s26
    s_mov_b32 s37, s27
    s_mov_b32 s38, 0x400000
    s_mov_b32 s39, 0x20000
    s_lshl_b32 s85, s29, 7
    s_add_u32 s40, s10, s85
    s_addc_u32 s41, s11, 0
    s_sub_u32 s42, 6291456, s85
    s_mov_b32 s43, 0x20000
    s_add_u32 s86, s85, 4096
    s_add_u32 s44, s10, s86
    s_addc_u32 s45, s11, 0
    s_sub_u32 s46, 6291456, s86
    s_mov_b32 s47, 0x20000
    s_add_u32 s86, s85, 128
    s_and_b32 s86, s86, 0x7ff
    s_add_u32 s86, s86, 5120
    s_add_u32 s48, s16, s86
    s_addc_u32 s49, s17, 0
    s_sub_u32 s50, 7340032, s86
    s_mov_b32 s51, 0x20000
    s_add_u32 s52, s18, s86
    s_addc_u32 s53, s19, 0
    s_sub_u32 s54, 7340032, s86
    s_mov_b32 s55, 0x20000
    s_mov_b64 exec, 0
    s_cmp_eq_u32 s4, 0
    s_cbranch_scc1 L_pad6
    s_cmp_eq_u32 s4, 1
    s_cbranch_scc1 L_pad7
    s_cmp_eq_u32 s4, 2
    s_cbranch_scc1 L_pad0
    s_cmp_eq_u32 s4, 3
    s_cbranch_scc1 L_pad8
L_vret0:
    s_mov_b64 exec, -1
    s_mov_b64 exec, 0
    s_cmp_eq_u32 s4, 0
    s_cbranch_scc1 L_pad9
    s_cmp_eq_u32 s4, 1
    s_cbranch_scc1 L_pad1
    s_cmp_eq_u32 s4, 2
    s_cbranch_scc1 L_pad2
    s_cmp_eq_u32 s4, 3
    s_cbranch_scc1 L_pad3
L_vret1:
    s_mov_b64 exec, -1
    s_setprio 1
    s_waitcnt vmcnt(5)
    s_barrier
    v_add_u32 v14, s80, v16
    v_add_u32 v15, s80, v17
    s_add_u32 s80, s80, 18432
    s_cmp_ge_u32 s80, 153600
    s_cselect_b32 s84, 55296, 0
    s_sub_u32 s80, s80, s84
    ds_read_b64_tr_b16 v[64:65], v4 offset:0
    ds_read_b64_tr_b16 v[66:67], v4 offset:512
    ds_read_b128 v[24:27], v14 offset:0
    ds_read_b128 v[28:31], v14 offset:2048
    ds_read_b128 v[32:35], v14 offset:4096
    ds_read_b128 v[36:39], v14 offset:6144
    ds_read_b64_tr_b16 v[68:69], v4 offset:8192
    ds_read_b64_tr_b16 v[70:71], v4 offset:8704
    ds_read_b64_tr_b16 v[72:73], v5 offset:0
    ds_read_b64_tr_b16 v[74:75], v5 offset:512
    s_waitcnt lgkmcnt(7)
    v_mfma_f32_16x16x32_bf16 v[88:91], v[64:67], v[24:27], 0
    ds_read_b64_tr_b16 v[76:77], v5 offset:8192
    s_waitcnt lgkmcnt(7)
    v_mfma_f32_16x16x32_bf16 v[92:95], v[64:67], v[28:31], 0
    ds_read_b64_tr_b16 v[78:79], v5 offset:8704
    s_waitcnt lgkmcnt(7)
    v_mfma_f32_16x16x32_bf16 v[96:99], v[64:67], v[32:35], 0
    ds_read_b64_tr_b16 v[80:81], v6 offset:0
    s_waitcnt lgkmcnt(7)
    v_mfma_f32_16x16x32_bf16 v[100:103], v[64:67], v[36:39], 0
    ds_read_b64_tr_b16 v[82:83], v6 offset:512
    s_waitcnt lgkmcnt(6)
    v_mfma_f32_16x16x32_bf16 v[104:107], v[68:71], v[24:27], 0
    ds_read_b64_tr_b16 v[64:65], v6 offset:8192
    v_mfma_f32_16x16x32_bf16 v[108:111], v[68:71], v[28:31], 0
    v_mfma_f32_16x16x32_bf16 v[112:115], v[68:71], v[32:35], 0
    ds_read_b64_tr_b16 v[66:67], v6 offset:8704
    v_mfma_f32_16x16x32_bf16 v[116:119], v[68:71], v[36:39], 0
    s_waitcnt lgkmcnt(6)
    v_mfma_f32_16x16x32_bf16 v[120:123], v[72:75], v[24:27], 0
    ds_read_b64_tr_b16 v[68:69], v7 offset:0
    v_mfma_f32_16x16x32_bf16 v[124:127], v[72:75], v[28:31], 0
    v_mfma_f32_16x16x32_bf16 v[128:131], v[72:75], v[32:35], 0
    ds_read_b64_tr_b16 v[70:71], v7 offset:512
    v_mfma_f32_16x16x32_bf16 v[132:135], v[72:75], v[36:39], 0
    s_waitcnt lgkmcnt(6)
    v_mfma_f32_16x16x32_bf16 v[136:139], v[76:79], v[24:27], 0
    ds_read_b64_tr_b16 v[72:73], v7 offset:8192
    v_mfma_f32_16x16x32_bf16 v[140:143], v[76:79], v[28:31], 0
    v_mfma_f32_16x16x32_bf16 v[144:147], v[76:79], v[32:35], 0
    ds_read_b64_tr_b16 v[74:75], v7 offset:8704
    v_mfma_f32_16x16x32_bf16 v[148:151], v[76:79], v[36:39], 0
    s_waitcnt lgkmcnt(6)
    v_mfma_f32_16x16x32_bf16 v[152:155], v[80:83], v[24:27], 0
    ds_read_b64_tr_b16 v[76:77], v8 offset:16384
    v_mfma_f32_16x16x32_bf16 v[156:159], v[80:83], v[28:31], 0
    v_mfma_f32_16x16x32_bf16 v[160:163], v[80:83], v[32:35], 0
    ds_read_b64_tr_b16 v[78:79], v8 offset:16640
    v_mfma_f32_16x16x32_bf16 v[164:167], v[80:83], v[36:39], 0
    s_waitcnt lgkmcnt(6)
    v_mfma_f32_16x16x32_bf16 v[168:171], v[64:67], v[24:27], 0
    ds_read_b64_tr_b16 v[80:81], v8 offset:18432
    v_mfma_f32_16x16x32_bf16 v[172:175], v[64:67], v[28:31], 0
    v_mfma_f32_16x16x32_bf16 v[176:179], v[64:67], v[32:35], 0
    ds_read_b64_tr_b16 v[82:83], v8 offset:18688
    v_mfma_f32_16x16x32_bf16 v[180:183], v[64:67], v[36:39], 0
    s_waitcnt lgkmcnt(6)
    v_mfma_f32_16x16x32_bf16 v[184:187], v[68:71], v[24:27], 0
    v_mfma_f32_16x16x32_bf16 v[188:191], v[68:71], v[28:31], 0
    v_mfma_f32_16x16x32_bf16 v[192:195], v[68:71], v[32:35], 0
    v_mfma_f32_16x16x32_bf16 v[196:199], v[68:71], v[36:39], 0
    s_waitcnt vmcnt(0) lgkmcnt(0)
    s_barrier
    v_mfma_f32_16x16x32_bf16 v[200:203], v[72:75], v[24:27], 0
    ds_read_b64_tr_b16 v[64:65], v4 offset:20480
    v_mfma_f32_16x16x32_bf16 v[204:207], v[72:75], v[28:31], 0
    ds_read_b64_tr_b16 v[66:67], v4 offset:20992
    v_mfma_f32_16x16x32_bf16 v[208:211], v[72:75], v[32:35], 0
    ds_read_b128 v[40:43], v15 offset:0
    v_mfma_f32_16x16x32_bf16 v[212:215], v[72:75], v[36:39], 0
    ds_read_b128 v[44:47], v15 offset:2048
    v_mfma_f32_16x16x32_bf16 v[216:219], v[76:79], v[24:27], 0
    ds_read_b128 v[48:51], v15 offset:4096
    v_mfma_f32_16x16x32_bf16 v[220:223], v[76:79], v[28:31], 0
    ds_read_b128 v[52:55], v15 offset:6144
    v_mfma_f32_16x16x32_bf16 v[224:227], v[76:79], v[32:35], 0
    ds_read_b64_tr_b16 v[68:69], v4 offset:28672
    v_mfma_f32_16x16x32_bf16 v[228:231], v[76:79], v[36:39], 0
    ds_read_b64_tr_b16 v[70:71], v4 offset:29184
    v_mfma_f32_16x16x32_bf16 v[232:235], v[80:83], v[24:27], 0
    ds_read_b64_tr_b16 v[72:73], v5 offset:20480
    v_mfma_f32_16x16x32_bf16 v[236:239], v[80:83], v[28:31], 0
    v_mfma_f32_16x16x32_bf16 v[240:243], v[80:83], v[32:35], 0
    ds_read_b64_tr_b16 v[74:75], v5 offset:20992
    v_mfma_f32_16x16x32_bf16 v[244:247], v[80:83], v[36:39], 0
    s_waitcnt lgkmcnt(7)
    v_mfma_f32_16x16x32_bf16 v[88:91], v[64:67], v[40:43], v[88:91]
    ds_read_b64_tr_b16 v[76:77], v5 offset:28672
    s_waitcnt lgkmcnt(7)
    v_mfma_f32_16x16x32_bf16 v[92:95], v[64:67], v[44:47], v[92:95]
    ds_read_b64_tr_b16 v[78:79], v5 offset:29184
    s_waitcnt lgkmcnt(7)
    v_mfma_f32_16x16x32_bf16 v[96:99], v[64:67], v[48:51], v[96:99]
    ds_read_b64_tr_b16 v[80:81], v6 offset:20480
    s_waitcnt lgkmcnt(7)
    v_mfma_f32_16x16x32_bf16 v[100:103], v[64:67], v[52:55], v[100:103]
    ds_read_b64_tr_b16 v[82:83], v6 offset:20992
    s_waitcnt lgkmcnt(6)
    v_mfma_f32_16x16x32_bf16 v[104:107], v[68:71], v[40:43], v[104:107]
    ds_read_b64_tr_b16 v[64:65], v6 offset:28672
    v_mfma_f32_16x16x32_bf16 v[108:111], v[68:71], v[44:47], v[108:111]
    v_add_u32 v14, s80, v16
    v_mfma_f32_16x16x32_bf16 v[112:115], v[68:71], v[48:51], v[112:115]
    ds_read_b64_tr_b16 v[66:67], v6 offset:29184
    v_mfma_f32_16x16x32_bf16 v[116:119], v[68:71], v[52:55], v[116:119]
    v_add_u32 v15, s80, v17
    s_waitcnt lgkmcnt(6)
    v_mfma_f32_16x16x32_bf16 v[120:123], v[72:75], v[40:43], v[120:123]
    ds_read_b64_tr_b16 v[68:69], v7 offset:20480
    v_mfma_f32_16x16x32_bf16 v[124:127], v[72:75], v[44:47], v[124:127]
    s_add_u32 s80, s80, 18432
    v_mfma_f32_16x16x32_bf16 v[128:131], v[72:75], v[48:51], v[128:131]
    ds_read_b64_tr_b16 v[70:71], v7 offset:20992
    v_mfma_f32_16x16x32_bf16 v[132:135], v[72:75], v[52:55], v[132:135]
    s_cmp_ge_u32 s80, 153600
    s_cselect_b32 s84, 55296, 0
    s_waitcnt lgkmcnt(6)
    v_mfma_f32_16x16x32_bf16 v[136:139], v[76:79], v[40:43], v[136:139]
    ds_read_b64_tr_b16 v[72:73], v7 offset:28672
    v_mfma_f32_16x16x32_bf16 v[140:143], v[76:79], v[44:47], v[140:143]
    s_sub_u32 s80, s80, s84
    v_mfma_f32_16x16x32_bf16 v[144:147], v[76:79], v[48:51], v[144:147]
    ds_read_b64_tr_b16 v[74:75], v7 offset:29184
    v_mfma_f32_16x16x32_bf16 v[148:151], v[76:79], v[52:55], v[148:151]
    s_waitcnt lgkmcnt(6)
    v_mfma_f32_16x16x32_bf16 v[152:155], v[80:83], v[40:43], v[152:155]
    ds_read_b64_tr_b16 v[76:77], v8 offset:36864
    v_mfma_f32_16x16x32_bf16 v[156:159], v[80:83], v[44:47], v[156:159]
    v_mfma_f32_16x16x32_bf16 v[160:163], v[80:83], v[48:51], v[160:163]
    ds_read_b64_tr_b16 v[78:79], v8 offset:37120
    v_mfma_f32_16x16x32_bf16 v[164:167], v[80:83], v[52:55], v[164:167]
    s_waitcnt lgkmcnt(6)
    v_mfma_f32_16x16x32_bf16 v[168:171], v[64:67], v[40:43], v[168:171]
    ds_read_b64_tr_b16 v[80:81], v8 offset:38912
    v_mfma_f32_16x16x32_bf16 v[172:175], v[64:67], v[44:47], v[172:175]
    v_mfma_f32_16x16x32_bf16 v[176:179], v[64:67], v[48:51], v[176:179]
    ds_read_b64_tr_b16 v[82:83], v8 offset:39168
    v_mfma_f32_16x16x32_bf16 v[180:183], v[64:67], v[52:55], v[180:183]
    s_waitcnt lgkmcnt(6)
    v_mfma_f32_16x16x32_bf16 v[184:187], v[68:71], v[40:43], v[184:187]
    v_mfma_f32_16x16x32_bf16 v[188:191], v[68:71], v[44:47], v[188:191]
    v_mfma_f32_16x16x32_bf16 v[192:195], v[68:71], v[48:51], v[192:195]
    v_mfma_f32_16x16x32_bf16 v[196:199], v[68:71], v[52:55], v[196:199]
    s_waitcnt lgkmcnt(0)
    s_barrier
    v_mfma_f32_16x16x32_bf16 v[200:203], v[72:75], v[40:43], v[200:203]
    ds_read_b64_tr_b16 v[64:65], v9 offset:0
    v_mfma_f32_16x16x32_bf16 v[204:207], v[72:75], v[44:47], v[204:207]
    ds_read_b64_tr_b16 v[66:67], v9 offset:512
    v_mfma_f32_16x16x32_bf16 v[208:211], v[72:75], v[48:51], v[208:211]
    ds_read_b128 v[24:27], v14 offset:0
    v_mfma_f32_16x16x32_bf16 v[212:215], v[72:75], v[52:55], v[212:215]
    ds_read_b128 v[28:31], v14 offset:2048
    v_mfma_f32_16x16x32_bf16 v[216:219], v[76:79], v[40:43], v[216:219]
    ds_read_b128 v[32:35], v14 offset:4096
    v_mfma_f32_16x16x32_bf16 v[220:223], v[76:79], v[44:47], v[220:223]
    ds_read_b128 v[36:39], v14 offset:6144
    v_mfma_f32_16x16x32_bf16 v[224:227], v[76:79], v[48:51], v[224:227]
    ds_read_b64_tr_b16 v[68:69], v9 offset:8192
    v_mfma_f32_16x16x32_bf16 v[228:231], v[76:79], v[52:55], v[228:231]
    ds_read_b64_tr_b16 v[70:71], v9 offset:8704
    v_mfma_f32_16x16x32_bf16 v[232:235], v[80:83], v[40:43], v[232:235]
    ds_read_b64_tr_b16 v[72:73], v10 offset:0
    v_mfma_f32_16x16x32_bf16 v[236:239], v[80:83], v[44:47], v[236:239]
    v_mfma_f32_16x16x32_bf16 v[240:243], v[80:83], v[48:51], v[240:243]
    ds_read_b64_tr_b16 v[74:75], v10 offset:512
    v_mfma_f32_16x16x32_bf16 v[244:247], v[80:83], v[52:55], v[244:247]
    s_waitcnt lgkmcnt(7)
    v_mfma_f32_16x16x32_bf16 v[88:91], v[64:67], v[24:27], v[88:91]
    ds_read_b64_tr_b16 v[76:77], v10 offset:8192
    s_waitcnt lgkmcnt(7)
    v_mfma_f32_16x16x32_bf16 v[92:95], v[64:67], v[28:31], v[92:95]
    ds_read_b64_tr_b16 v[78:79], v10 offset:8704
    s_waitcnt lgkmcnt(7)
    v_mfma_f32_16x16x32_bf16 v[96:99], v[64:67], v[32:35], v[96:99]
    ds_read_b64_tr_b16 v[80:81], v11 offset:0
    s_waitcnt lgkmcnt(7)
    v_mfma_f32_16x16x32_bf16 v[100:103], v[64:67], v[36:39], v[100:103]
    ds_read_b64_tr_b16 v[82:83], v11 offset:512
    s_waitcnt lgkmcnt(6)
    v_mfma_f32_16x16x32_bf16 v[104:107], v[68:71], v[24:27], v[104:107]
    ds_read_b64_tr_b16 v[64:65], v11 offset:8192
    v_mfma_f32_16x16x32_bf16 v[108:111], v[68:71], v[28:31], v[108:111]
    v_mfma_f32_16x16x32_bf16 v[112:115], v[68:71], v[32:35], v[112:115]
    ds_read_b64_tr_b16 v[66:67], v11 offset:8704
    v_mfma_f32_16x16x32_bf16 v[116:119], v[68:71], v[36:39], v[116:119]
    s_waitcnt lgkmcnt(6)
    v_mfma_f32_16x16x32_bf16 v[120:123], v[72:75], v[24:27], v[120:123]
    ds_read_b64_tr_b16 v[68:69], v12 offset:0
    v_mfma_f32_16x16x32_bf16 v[124:127], v[72:75], v[28:31], v[124:127]
    v_mfma_f32_16x16x32_bf16 v[128:131], v[72:75], v[32:35], v[128:131]
    ds_read_b64_tr_b16 v[70:71], v12 offset:512
    v_mfma_f32_16x16x32_bf16 v[132:135], v[72:75], v[36:39], v[132:135]
    s_waitcnt lgkmcnt(6)
    v_mfma_f32_16x16x32_bf16 v[136:139], v[76:79], v[24:27], v[136:139]
    ds_read_b64_tr_b16 v[72:73], v12 offset:8192
    v_mfma_f32_16x16x32_bf16 v[140:143], v[76:79], v[28:31], v[140:143]
    v_mfma_f32_16x16x32_bf16 v[144:147], v[76:79], v[32:35], v[144:147]
    ds_read_b64_tr_b16 v[74:75], v12 offset:8704
    v_mfma_f32_16x16x32_bf16 v[148:151], v[76:79], v[36:39], v[148:151]
    s_waitcnt lgkmcnt(6)
    v_mfma_f32_16x16x32_bf16 v[152:155], v[80:83], v[24:27], v[152:155]
    ds_read_b64_tr_b16 v[76:77], v13 offset:16384
    v_mfma_f32_16x16x32_bf16 v[156:159], v[80:83], v[28:31], v[156:159]
    v_mfma_f32_16x16x32_bf16 v[160:163], v[80:83], v[32:35], v[160:163]
    ds_read_b64_tr_b16 v[78:79], v13 offset:16640
    v_mfma_f32_16x16x32_bf16 v[164:167], v[80:83], v[36:39], v[164:167]
    s_waitcnt lgkmcnt(6)
    v_mfma_f32_16x16x32_bf16 v[168:171], v[64:67], v[24:27], v[168:171]
    ds_read_b64_tr_b16 v[80:81], v13 offset:18432
    v_mfma_f32_16x16x32_bf16 v[172:175], v[64:67], v[28:31], v[172:175]
    v_mfma_f32_16x16x32_bf16 v[176:179], v[64:67], v[32:35], v[176:179]
    ds_read_b64_tr_b16 v[82:83], v13 offset:18688
    v_mfma_f32_16x16x32_bf16 v[180:183], v[64:67], v[36:39], v[180:183]
    s_waitcnt lgkmcnt(6)
    v_mfma_f32_16x16x32_bf16 v[184:187], v[68:71], v[24:27], v[184:187]
    v_mfma_f32_16x16x32_bf16 v[188:191], v[68:71], v[28:31], v[188:191]
    v_mfma_f32_16x16x32_bf16 v[192:195], v[68:71], v[32:35], v[192:195]
    v_mfma_f32_16x16x32_bf16 v[196:199], v[68:71], v[36:39], v[196:199]
    s_waitcnt lgkmcnt(0)
    s_barrier
    v_mfma_f32_16x16x32_bf16 v[200:203], v[72:75], v[24:27], v[200:203]
    ds_read_b64_tr_b16 v[64:65], v9 offset:20480
    v_mfma_f32_16x16x32_bf16 v[204:207], v[72:75], v[28:31], v[204:207]
    ds_read_b64_tr_b16 v[66:67], v9 offset:20992
    v_mfma_f32_16x16x32_bf16 v[208:211], v[72:75], v[32:35], v[208:211]
    ds_read_b128 v[40:43], v15 offset:0
    v_mfma_f32_16x16x32_bf16 v[212:215], v[72:75], v[36:39], v[212:215]
    ds_read_b128 v[44:47], v15 offset:2048
    v_mfma_f32_16x16x32_bf16 v[216:219], v[76:79], v[24:27], v[216:219]
    ds_read_b128 v[48:51], v15 offset:4096
    v_mfma_f32_16x16x32_bf16 v[220:223], v[76:79], v[28:31], v[220:223]
    ds_read_b128 v[52:55], v15 offset:6144
    v_mfma_f32_16x16x32_bf16 v[224:227], v[76:79], v[32:35], v[224:227]
    ds_read_b64_tr_b16 v[68:69], v9 offset:28672
    v_mfma_f32_16x16x32_bf16 v[228:231], v[76:79], v[36:39], v[228:231]
    ds_read_b64_tr_b16 v[70:71], v9 offset:29184
    v_mfma_f32_16x16x32_bf16 v[232:235], v[80:83], v[24:27], v[232:235]
    ds_read_b64_tr_b16 v[72:73], v10 offset:20480
    v_mfma_f32_16x16x32_bf16 v[236:239], v[80:83], v[28:31], v[236:239]
    v_mfma_f32_16x16x32_bf16 v[240:243], v[80:83], v[32:35], v[240:243]
    ds_read_b64_tr_b16 v[74:75], v10 offset:20992
    v_mfma_f32_16x16x32_bf16 v[244:247], v[80:83], v[36:39], v[244:247]
    s_waitcnt lgkmcnt(7)
    v_mfma_f32_16x16x32_bf16 v[88:91], v[64:67], v[40:43], v[88:91]
    ds_read_b64_tr_b16 v[76:77], v10 offset:28672
    s_waitcnt lgkmcnt(7)
    v_mfma_f32_16x16x32_bf16 v[92:95], v[64:67], v[44:47], v[92:95]
    ds_read_b64_tr_b16 v[78:79], v10 offset:29184
    s_waitcnt lgkmcnt(7)
    v_mfma_f32_16x16x32_bf16 v[96:99], v[64:67], v[48:51], v[96:99]
    ds_read_b64_tr_b16 v[80:81], v11 offset:20480
    s_waitcnt lgkmcnt(7)
    v_mfma_f32_16x16x32_bf16 v[100:103], v[64:67], v[52:55], v[100:103]
    ds_read_b64_tr_b16 v[82:83], v11 offset:20992
    s_waitcnt lgkmcnt(6)
    v_mfma_f32_16x16x32_bf16 v[104:107], v[68:71], v[40:43], v[104:107]
    ds_read_b64_tr_b16 v[64:65], v11 offset:28672
    v_mfma_f32_16x16x32_bf16 v[108:111], v[68:71], v[44:47], v[108:111]
    v_add_u32 v14, s80, v16
    v_mfma_f32_16x16x32_bf16 v[112:115], v[68:71], v[48:51], v[112:115]
    ds_read_b64_tr_b16 v[66:67], v11 offset:29184
    v_mfma_f32_16x16x32_bf16 v[116:119], v[68:71], v[52:55], v[116:119]
    v_add_u32 v15, s80, v17
    s_waitcnt lgkmcnt(6)
    v_mfma_f32_16x16x32_bf16 v[120:123], v[72:75], v[40:43], v[120:123]
    ds_read_b64_tr_b16 v[68:69], v12 offset:20480
    v_mfma_f32_16x16x32_bf16 v[124:127], v[72:75], v[44:47], v[124:127]
    s_add_u32 s80, s80, 18432
    v_mfma_f32_16x16x32_bf16 v[128:131], v[72:75], v[48:51], v[128:131]
    ds_read_b64_tr_b16 v[70:71], v12 offset:20992
    v_mfma_f32_16x16x32_bf16 v[132:135], v[72:75], v[52:55], v[132:135]
    s_cmp_ge_u32 s80, 153600
    s_cselect_b32 s84, 55296, 0
    s_waitcnt lgkmcnt(6)
    v_mfma_f32_16x16x32_bf16 v[136:139], v[76:79], v[40:43], v[136:139]
    ds_read_b64_tr_b16 v[72:73], v12 offset:28672
    v_mfma_f32_16x16x32_bf16 v[140:143], v[76:79], v[44:47], v[140:143]
    s_sub_u32 s80, s80, s84
    v_mfma_f32_16x16x32_bf16 v[144:147], v[76:79], v[48:51], v[144:147]
    ds_read_b64_tr_b16 v[74:75], v12 offset:29184
    v_mfma_f32_16x16x32_bf16 v[148:151], v[76:79], v[52:55], v[148:151]
    s_waitcnt lgkmcnt(6)
    v_mfma_f32_16x16x32_bf16 v[152:155], v[80:83], v[40:43], v[152:155]
    ds_read_b64_tr_b16 v[76:77], v13 offset:36864
    v_mfma_f32_16x16x32_bf16 v[156:159], v[80:83], v[44:47], v[156:159]
    v_mfma_f32_16x16x32_bf16 v[160:163], v[80:83], v[48:51], v[160:163]
    ds_read_b64_tr_b16 v[78:79], v13 offset:37120
    v_mfma_f32_16x16x32_bf16 v[164:167], v[80:83], v[52:55], v[164:167]
    s_waitcnt lgkmcnt(6)
    v_mfma_f32_16x16x32_bf16 v[168:171], v[64:67], v[40:43], v[168:171]
    ds_read_b64_tr_b16 v[80:81], v13 offset:38912
    v_mfma_f32_16x16x32_bf16 v[172:175], v[64:67], v[44:47], v[172:175]
    v_mfma_f32_16x16x32_bf16 v[176:179], v[64:67], v[48:51], v[176:179]
    ds_read_b64_tr_b16 v[82:83], v13 offset:39168
    v_mfma_f32_16x16x32_bf16 v[180:183], v[64:67], v[52:55], v[180:183]
    s_waitcnt lgkmcnt(6)
    v_mfma_f32_16x16x32_bf16 v[184:187], v[68:71], v[40:43], v[184:187]
    v_mfma_f32_16x16x32_bf16 v[188:191], v[68:71], v[44:47], v[188:191]
    v_mfma_f32_16x16x32_bf16 v[192:195], v[68:71], v[48:51], v[192:195]
    v_mfma_f32_16x16x32_bf16 v[196:199], v[68:71], v[52:55], v[196:199]
    s_waitcnt lgkmcnt(0)
    s_barrier
    v_mfma_f32_16x16x32_bf16 v[200:203], v[72:75], v[40:43], v[200:203]
    ds_read_b64_tr_b16 v[64:65], v4 offset:0
    v_mfma_f32_16x16x32_bf16 v[204:207], v[72:75], v[44:47], v[204:207]
    ds_read_b64_tr_b16 v[66:67], v4 offset:512
    v_mfma_f32_16x16x32_bf16 v[208:211], v[72:75], v[48:51], v[208:211]
    ds_read_b128 v[24:27], v14 offset:0
    v_mfma_f32_16x16x32_bf16 v[212:215], v[72:75], v[52:55], v[212:215]
    ds_read_b128 v[28:31], v14 offset:2048
    v_mfma_f32_16x16x32_bf16 v[216:219], v[76:79], v[40:43], v[216:219]
    ds_read_b128 v[32:35], v14 offset:4096
    v_mfma_f32_16x16x32_bf16 v[220:223], v[76:79], v[44:47], v[220:223]
    ds_read_b128 v[36:39], v14 offset:6144
    v_mfma_f32_16x16x32_bf16 v[224:227], v[76:79], v[48:51], v[224:227]
    ds_read_b64_tr_b16 v[68:69], v4 offset:8192
    v_mfma_f32_16x16x32_bf16 v[228:231], v[76:79], v[52:55], v[228:231]
    ds_read_b64_tr_b16 v[70:71], v4 offset:8704
    v_mfma_f32_16x16x32_bf16 v[232:235], v[80:83], v[40:43], v[232:235]
    ds_read_b64_tr_b16 v[72:73], v5 offset:0
    v_mfma_f32_16x16x32_bf16 v[236:239], v[80:83], v[44:47], v[236:239]
    v_mfma_f32_16x16x32_bf16 v[240:243], v[80:83], v[48:51], v[240:243]
    ds_read_b64_tr_b16 v[74:75], v5 offset:512
    v_mfma_f32_16x16x32_bf16 v[244:247], v[80:83], v[52:55], v[244:247]
    s_or_b32 s91, s2, s4
    s_cbranch_scc1 L_notok
    s_memrealtime s[92:93]
    v_mov_b32 v60, 0
    s_waitcnt lgkmcnt(0)
    s_or_b32 s92, s92, 1
    v_mov_b32 v62, s92
    v_mov_b32 v63, s93
    s_mov_b64 exec, 1
    global_store_dwordx2 v60, v[62:63], s[24:25] sc1
    s_mov_b64 exec, -1
L_notok:
    s_mov_b32 s34, 6
.p2align 6
L_p1:
    s_waitcnt lgkmcnt(7)
    v_mfma_f32_16x16x32_bf16 v[88:91], v[64:67], v[24:27], v[88:91]
    ds_read_b64_tr_b16 v[76:77], v5 offset:8192
    s_waitcnt lgkmcnt(7)
    v_mfma_f32_16x16x32_bf16 v[92:95], v[64:67], v[28:31], v[92:95]
    ds_read_b64_tr_b16 v[78:79], v5 offset:8704
    s_waitcnt lgkmcnt(7)
    v_mfma_f32_16x16x32_bf16 v[96:99], v[64:67], v[32:35], v[96:99]
    ds_read_b64_tr_b16 v[80:81], v6 offset:0
    s_waitcnt lgkmcnt(7)
    v_mfma_f32_16x16x32_bf16 v[100:103], v[64:67], v[36:39], v[100:103]
    ds_read_b64_tr_b16 v[82:83], v6 offset:512
    s_waitcnt lgkmcnt(6)
    v_mfma_f32_16x16x32_bf16 v[104:107], v[68:71], v[24:27], v[104:107]
    ds_read_b64_tr_b16 v[64:65], v6 offset:8192
    v_mfma_f32_16x16x32_bf16 v[108:111], v[68:71], v[28:31], v[108:111]
    v_mfma_f32_16x16x32_bf16 v[112:115], v[68:71], v[32:35], v[112:115]
    ds_read_b64_tr_b16 v[66:67], v6 offset:8704
    v_mfma_f32_16x16x32_bf16 v[116:119], v[68:71], v[36:39], v[116:119]
    s_waitcnt lgkmcnt(6)
    v_mfma_f32_16x16x32_bf16 v[120:123], v[72:75], v[24:27], v[120:123]
    ds_read_b64_tr_b16 v[68:69], v7 offset:0
    v_mfma_f32_16x16x32_bf16 v[124:127], v[72:75], v[28:31], v[124:127]
    v_mfma_f32_16x16x32_bf16 v[128:131], v[72:75], v[32:35], v[128:131]
    ds_read_b64_tr_b16 v[70:71], v7 offset:512
    v_mfma_f32_16x16x32_bf16 v[132:135], v[72:75], v[36:39], v[132:135]
    s_waitcnt lgkmcnt(6)
    v_mfma_f32_16x16x32_bf16 v[136:139], v[76:79], v[24:27], v[136:139]
    ds_read_b64_tr_b16 v[72:73], v7 offset:8192
    v_mfma_f32_16x16x32_bf16 v[140:143], v[76:79], v[28:31], v[140:143]
    v_mfma_f32_16x16x32_bf16 v[144:147], v[76:79], v[32:35], v[144:147]
    ds_read_b64_tr_b16 v[74:75], v7 offset:8704
    v_mfma_f32_16x16x32_bf16 v[148:151], v[76:79], v[36:39], v[148:151]
    s_waitcnt lgkmcnt(6)
    v_mfma_f32_16x16x32_bf16 v[152:155], v[80:83], v[24:27], v[152:155]
    ds_read_b64_tr_b16 v[76:77], v8 offset:16384
    v_mfma_f32_16x16x32_bf16 v[156:159], v[80:83], v[28:31], v[156:159]
    v_mfma_f32_16x16x32_bf16 v[160:163], v[80:83], v[32:35], v[160:163]
    ds_read_b64_tr_b16 v[78:79], v8 offset:16640
    v_mfma_f32_16x16x32_bf16 v[164:167], v[80:83], v[36:39], v[164:167]
    s_waitcnt lgkmcnt(6)
    v_mfma_f32_16x16x32_bf16 v[168:171], v[64:67], v[24:27], v[168:171]
    ds_read_b64_tr_b16 v[80:81], v8 offset:18432
    v_mfma_f32_16x16x32_bf16 v[172:175], v[64:67], v[28:31], v[172:175]
    v_mfma_f32_16x16x32_bf16 v[176:179], v[64:67], v[32:35], v[176:179]
    ds_read_b64_tr_b16 v[82:83], v8 offset:18688
    v_mfma_f32_16x16x32_bf16 v[180:183], v[64:67], v[36:39], v[180:183]
    s_waitcnt lgkmcnt(6)
    v_mfma_f32_16x16x32_bf16 v[184:187], v[68:71], v[24:27], v[184:187]
    v_mfma_f32_16x16x32_bf16 v[188:191], v[68:71], v[28:31], v[188:191]
    v_mfma_f32_16x16x32_bf16 v[192:195], v[68:71], v[32:35], v[192:195]
    v_mfma_f32_16x16x32_bf16 v[196:199], v[68:71], v[36:39], v[196:199]
    s_waitcnt lgkmcnt(0)
    s_barrier
    v_mfma_f32_16x16x32_bf16 v[200:203], v[72:75], v[24:27], v[200:203]
    ds_read_b64_tr_b16 v[64:65], v4 offset:20480
    v_mfma_f32_16x16x32_bf16 v[204:207], v[72:75], v[28:31], v[204:207]
    ds_read_b64_tr_b16 v[66:67], v4 offset:20992
    v_mfma_f32_16x16x32_bf16 v[208:211], v[72:75], v[32:35], v[208:211]
    ds_read_b128 v[40:43], v15 offset:0
    v_mfma_f32_16x16x32_bf16 v[212:215], v[72:75], v[36:39], v[212:215]
    ds_read_b128 v[44:47], v15 offset:2048
    v_mfma_f32_16x16x32_bf16 v[216:219], v[76:79], v[24:27], v[216:219]
    ds_read_b128 v[48:51], v15 offset:4096
    v_mfma_f32_16x16x32_bf16 v[220:223], v[76:79], v[28:31], v[220:223]
    ds_read_b128 v[52:55], v15 offset:6144
    v_mfma_f32_16x16x32_bf16 v[224:227], v[76:79], v[32:35], v[224:227]
    ds_read_b64_tr_b16 v[68:69], v4 offset:28672
    v_mfma_f32_16x16x32_bf16 v[228:231], v[76:79], v[36:39], v[228:231]
    ds_read_b64_tr_b16 v[70:71], v4 offset:29184
    v_mfma_f32_16x16x32_bf16 v[232:235], v[80:83], v[24:27], v[232:235]
    ds_read_b64_tr_b16 v[72:73], v5 offset:20480
    v_mfma_f32_16x16x32_bf16 v[236:239], v[80:83], v[28:31], v[236:239]
    v_mfma_f32_16x16x32_bf16 v[240:243], v[80:83], v[32:35], v[240:243]
    ds_read_b64_tr_b16 v[74:75], v5 offset:20992
    v_mfma_f32_16x16x32_bf16 v[244:247], v[80:83], v[36:39], v[244:247]
    s_waitcnt lgkmcnt(7)
    v_mfma_f32_16x16x32_bf16 v[88:91], v[64:67], v[40:43], v[88:91]
    ds_read_b64_tr_b16 v[76:77], v5 offset:28672
    s_waitcnt lgkmcnt(7)
    v_mfma_f32_16x16x32_bf16 v[92:95], v[64:67], v[44:47], v[92:95]
    ds_read_b64_tr_b16 v[78:79], v5 offset:29184
    s_waitcnt lgkmcnt(7)
    v_mfma_f32_16x16x32_bf16 v[96:99], v[64:67], v[48:51], v[96:99]
    ds_read_b64_tr_b16 v[80:81], v6 offset:20480
    s_waitcnt lgkmcnt(7)
    v_mfma_f32_16x16x32_bf16 v[100:103], v[64:67], v[52:55], v[100:103]
    ds_read_b64_tr_b16 v[82:83], v6 offset:20992
    s_waitcnt lgkmcnt(6)
    v_mfma_f32_16x16x32_bf16 v[104:107], v[68:71], v[40:43], v[104:107]
    ds_read_b64_tr_b16 v[64:65], v6 offset:28672
    v_mfma_f32_16x16x32_bf16 v[108:111], v[68:71], v[44:47], v[108:111]
    v_add_u32 v14, s80, v16
    v_mfma_f32_16x16x32_bf16 v[112:115], v[68:71], v[48:51], v[112:115]
    ds_read_b64_tr_b16 v[66:67], v6 offset:29184
    v_mfma_f32_16x16x32_bf16 v[116:119], v[68:71], v[52:55], v[116:119]
    v_add_u32 v15, s80, v17
    s_waitcnt lgkmcnt(6)
    v_mfma_f32_16x16x32_bf16 v[120:123], v[72:75], v[40:43], v[120:123]
    ds_read_b64_tr_b16 v[68:69], v7 offset:20480
    v_mfma_f32_16x16x32_bf16 v[124:127], v[72:75], v[44:47], v[124:127]
    s_add_u32 s80, s80, 18432
    v_mfma_f32_16x16x32_bf16 v[128:131], v[72:75], v[48:51], v[128:131]
    ds_read_b64_tr_b16 v[70:71], v7 offset:20992
    v_mfma_f32_16x16x32_bf16 v[132:135], v[72:75], v[52:55], v[132:135]
    s_cmp_ge_u32 s80, 153600
    s_cselect_b32 s84, 55296, 0
    s_waitcnt lgkmcnt(6)
    v_mfma_f32_16x16x32_bf16 v[136:139], v[76:79], v[40:43], v[136:139]
    ds_read_b64_tr_b16 v[72:73], v7 offset:28672
    v_mfma_f32_16x16x32_bf16 v[140:143], v[76:79], v[44:47], v[140:143]
    s_sub_u32 s80, s80, s84
    v_mfma_f32_16x16x32_bf16 v[144:147], v[76:79], v[48:51], v[144:147]
    ds_read_b64_tr_b16 v[74:75], v7 offset:29184
    v_mfma_f32_16x16x32_bf16 v[148:151], v[76:79], v[52:55], v[148:151]
    s_waitcnt lgkmcnt(6)
    v_mfma_f32_16x16x32_bf16 v[152:155], v[80:83], v[40:43], v[152:155]
    ds_read_b64_tr_b16 v[76:77], v8 offset:36864
    v_mfma_f32_16x16x32_bf16 v[156:159], v[80:83], v[44:47], v[156:159]
    v_mfma_f32_16x16x32_bf16 v[160:163], v[80:83], v[48:51], v[160:163]
    ds_read_b64_tr_b16 v[78:79], v8 offset:37120
    v_mfma_f32_16x16x32_bf16 v[164:167], v[80:83], v[52:55], v[164:167]
    s_waitcnt lgkmcnt(6)
    v_mfma_f32_16x16x32_bf16 v[168:171], v[64:67], v[40:43], v[168:171]
    ds_read_b64_tr_b16 v[80:81], v8 offset:38912
    v_mfma_f32_16x16x32_bf16 v[172:175], v[64:67], v[44:47], v[172:175]
    v_mfma_f32_16x16x32_bf16 v[176:179], v[64:67], v[48:51], v[176:179]
    ds_read_b64_tr_b16 v[82:83], v8 offset:39168
    v_mfma_f32_16x16x32_bf16 v[180:183], v[64:67], v[52:55], v[180:183]
    s_waitcnt lgkmcnt(6)
    v_mfma_f32_16x16x32_bf16 v[184:187], v[68:71], v[40:43], v[184:187]
    v_mfma_f32_16x16x32_bf16 v[188:191], v[68:71], v[44:47], v[188:191]
    v_mfma_f32_16x16x32_bf16 v[192:195], v[68:71], v[48:51], v[192:195]
    v_mfma_f32_16x16x32_bf16 v[196:199], v[68:71], v[52:55], v[196:199]
    s_waitcnt lgkmcnt(0)
    s_barrier
    v_mfma_f32_16x16x32_bf16 v[200:203], v[72:75], v[40:43], v[200:203]
    ds_read_b64_tr_b16 v[64:65], v9 offset:0
    v_mfma_f32_16x16x32_bf16 v[204:207], v[72:75], v[44:47], v[204:207]
    ds_read_b64_tr_b16 v[66:67], v9 offset:512
    v_mfma_f32_16x16x32_bf16 v[208:211], v[72:75], v[48:51], v[208:211]
    ds_read_b128 v[24:27], v14 offset:0
    v_mfma_f32_16x16x32_bf16 v[212:215], v[72:75], v[52:55], v[212:215]
    ds_read_b128 v[28:31], v14 offset:2048
    v_mfma_f32_16x16x32_bf16 v[216:219], v[76:79], v[40:43], v[216:219]
    ds_read_b128 v[32:35], v14 offset:4096
    v_mfma_f32_16x16x32_bf16 v[220:223], v[76:79], v[44:47], v[220:223]
    ds_read_b128 v[36:39], v14 offset:6144
    v_mfma_f32_16x16x32_bf16 v[224:227], v[76:79], v[48:51], v[224:227]
    ds_read_b64_tr_b16 v[68:69], v9 offset:8192
    v_mfma_f32_16x16x32_bf16 v[228:231], v[76:79], v[52:55], v[228:231]
    ds_read_b64_tr_b16 v[70:71], v9 offset:8704
    v_mfma_f32_16x16x32_bf16 v[232:235], v[80:83], v[40:43], v[232:235]
    ds_read_b64_tr_b16 v[72:73], v10 offset:0
    v_mfma_f32_16x16x32_bf16 v[236:239], v[80:83], v[44:47], v[236:239]
    v_mfma_f32_16x16x32_bf16 v[240:243], v[80:83], v[48:51], v[240:243]
    ds_read_b64_tr_b16 v[74:75], v10 offset:512
    v_mfma_f32_16x16x32_bf16 v[244:247], v[80:83], v[52:55], v[244:247]
    s_waitcnt lgkmcnt(7)
    v_mfma_f32_16x16x32_bf16 v[88:91], v[64:67], v[24:27], v[88:91]
    ds_read_b64_tr_b16 v[76:77], v10 offset:8192
    s_waitcnt lgkmcnt(7)
    v_mfma_f32_16x16x32_bf16 v[92:95], v[64:67], v[28:31], v[92:95]
    ds_read_b64_tr_b16 v[78:79], v10 offset:8704
    s_waitcnt lgkmcnt(7)
    v_mfma_f32_16x16x32_bf16 v[96:99], v[64:67], v[32:35], v[96:99]
    ds_read_b64_tr_b16 v[80:81], v11 offset:0
    s_waitcnt lgkmcnt(7)
    v_mfma_f32_16x16x32_bf16 v[100:103], v[64:67], v[36:39], v[100:103]
    ds_read_b64_tr_b16 v[82:83], v11 offset:512
    s_waitcnt lgkmcnt(6)
    v_mfma_f32_16x16x32_bf16 v[104:107], v[68:71], v[24:27], v[104:107]
    ds_read_b64_tr_b16 v[64:65], v11 offset:8192
    v_mfma_f32_16x16x32_bf16 v[108:111], v[68:71], v[28:31], v[108:111]
    v_mfma_f32_16x16x32_bf16 v[112:115], v[68:71], v[32:35], v[112:115]
    ds_read_b64_tr_b16 v[66:67], v11 offset:8704
    v_mfma_f32_16x16x32_bf16 v[116:119], v[68:71], v[36:39], v[116:119]
    s_waitcnt lgkmcnt(6)
    v_mfma_f32_16x16x32_bf16 v[120:123], v[72:75], v[24:27], v[120:123]
    ds_read_b64_tr_b16 v[68:69], v12 offset:0
    v_mfma_f32_16x16x32_bf16 v[124:127], v[72:75], v[28:31], v[124:127]
    v_mfma_f32_16x16x32_bf16 v[128:131], v[72:75], v[32:35], v[128:131]
    ds_read_b64_tr_b16 v[70:71], v12 offset:512
    v_mfma_f32_16x16x32_bf16 v[132:135], v[72:75], v[36:39], v[132:135]
    s_waitcnt lgkmcnt(6)
    v_mfma_f32_16x16x32_bf16 v[136:139], v[76:79], v[24:27], v[136:139]
    ds_read_b64_tr_b16 v[72:73], v12 offset:8192
    v_mfma_f32_16x16x32_bf16 v[140:143], v[76:79], v[28:31], v[140:143]
    v_mfma_f32_16x16x32_bf16 v[144:147], v[76:79], v[32:35], v[144:147]
    ds_read_b64_tr_b16 v[74:75], v12 offset:8704
    v_mfma_f32_16x16x32_bf16 v[148:151], v[76:79], v[36:39], v[148:151]
    s_waitcnt lgkmcnt(6)
    v_mfma_f32_16x16x32_bf16 v[152:155], v[80:83], v[24:27], v[152:155]
    ds_read_b64_tr_b16 v[76:77], v13 offset:16384
    v_mfma_f32_16x16x32_bf16 v[156:159], v[80:83], v[28:31], v[156:159]
    v_mfma_f32_16x16x32_bf16 v[160:163], v[80:83], v[32:35], v[160:163]
    ds_read_b64_tr_b16 v[78:79], v13 offset:16640
    v_mfma_f32_16x16x32_bf16 v[164:167], v[80:83], v[36:39], v[164:167]
    s_waitcnt lgkmcnt(6)
    v_mfma_f32_16x16x32_bf16 v[168:171], v[64:67], v[24:27], v[168:171]
    ds_read_b64_tr_b16 v[80:81], v13 offset:18432
    v_mfma_f32_16x16x32_bf16 v[172:175], v[64:67], v[28:31], v[172:175]
    v_mfma_f32_16x16x32_bf16 v[176:179], v[64:67], v[32:35], v[176:179]
    ds_read_b64_tr_b16 v[82:83], v13 offset:18688
    v_mfma_f32_16x16x32_bf16 v[180:183], v[64:67], v[36:39], v[180:183]
    s_waitcnt lgkmcnt(6)
    v_mfma_f32_16x16x32_bf16 v[184:187], v[68:71], v[24:27], v[184:187]
    v_mfma_f32_16x16x32_bf16 v[188:191], v[68:71], v[28:31], v[188:191]
    v_mfma_f32_16x16x32_bf16 v[192:195], v[68:71], v[32:35], v[192:195]
    v_mfma_f32_16x16x32_bf16 v[196:199], v[68:71], v[36:39], v[196:199]
    s_waitcnt lgkmcnt(0)
    s_barrier
    v_mfma_f32_16x16x32_bf16 v[200:203], v[72:75], v[24:27], v[200:203]
    ds_read_b64_tr_b16 v[64:65], v9 offset:20480
    v_mfma_f32_16x16x32_bf16 v[204:207], v[72:75], v[28:31], v[204:207]
    ds_read_b64_tr_b16 v[66:67], v9 offset:20992
    v_mfma_f32_16x16x32_bf16 v[208:211], v[72:75], v[32:35], v[208:211]
    ds_read_b128 v[40:43], v15 offset:0
    v_mfma_f32_16x16x32_bf16 v[212:215], v[72:75], v[36:39], v[212:215]
    ds_read_b128 v[44:47], v15 offset:2048
    v_mfma_f32_16x16x32_bf16 v[216:219], v[76:79], v[24:27], v[216:219]
    ds_read_b128 v[48:51], v15 offset:4096
    v_mfma_f32_16x16x32_bf16 v[220:223], v[76:79], v[28:31], v[220:223]
    ds_read_b128 v[52:55], v15 offset:6144
    v_mfma_f32_16x16x32_bf16 v[224:227], v[76:79], v[32:35], v[224:227]
    ds_read_b64_tr_b16 v[68:69], v9 offset:28672
    v_mfma_f32_16x16x32_bf16 v[228:231], v[76:79], v[36:39], v[228:231]
    ds_read_b64_tr_b16 v[70:71], v9 offset:29184
    v_mfma_f32_16x16x32_bf16 v[232:235], v[80:83], v[24:27], v[232:235]
    ds_read_b64_tr_b16 v[72:73], v10 offset:20480
    v_mfma_f32_16x16x32_bf16 v[236:239], v[80:83], v[28:31], v[236:239]
    v_mfma_f32_16x16x32_bf16 v[240:243], v[80:83], v[32:35], v[240:243]
    ds_read_b64_tr_b16 v[74:75], v10 offset:20992
    v_mfma_f32_16x16x32_bf16 v[244:247], v[80:83], v[36:39], v[244:247]
    s_waitcnt lgkmcnt(7)
    v_mfma_f32_16x16x32_bf16 v[88:91], v[64:67], v[40:43], v[88:91]
    ds_read_b64_tr_b16 v[76:77], v10 offset:28672
    s_waitcnt lgkmcnt(7)
    v_mfma_f32_16x16x32_bf16 v[92:95], v[64:67], v[44:47], v[92:95]
    ds_read_b64_tr_b16 v[78:79], v10 offset:29184
    s_waitcnt lgkmcnt(7)
    v_mfma_f32_16x16x32_bf16 v[96:99], v[64:67], v[48:51], v[96:99]
    ds_read_b64_tr_b16 v[80:81], v11 offset:20480
    s_waitcnt lgkmcnt(7)
    v_mfma_f32_16x16x32_bf16 v[100:103], v[64:67], v[52:55], v[100:103]
    ds_read_b64_tr_b16 v[82:83], v11 offset:20992
    s_waitcnt lgkmcnt(6)
    v_mfma_f32_16x16x32_bf16 v[104:107], v[68:71], v[40:43], v[104:107]
    ds_read_b64_tr_b16 v[64:65], v11 offset:28672
    v_mfma_f32_16x16x32_bf16 v[108:111], v[68:71], v[44:47], v[108:111]
    v_add_u32 v14, s80, v16
    v_mfma_f32_16x16x32_bf16 v[112:115], v[68:71], v[48:51], v[112:115]
    ds_read_b64_tr_b16 v[66:67], v11 offset:29184
    v_mfma_f32_16x16x32_bf16 v[116:119], v[68:71], v[52:55], v[116:119]
    v_add_u32 v15, s80, v17
    s_waitcnt lgkmcnt(6)
    v_mfma_f32_16x16x32_bf16 v[120:123], v[72:75], v[40:43], v[120:123]
    ds_read_b64_tr_b16 v[68:69], v12 offset:20480
    v_mfma_f32_16x16x32_bf16 v[124:127], v[72:75], v[44:47], v[124:127]
    s_add_u32 s80, s80, 18432
    v_mfma_f32_16x16x32_bf16 v[128:131], v[72:75], v[48:51], v[128:131]
    ds_read_b64_tr_b16 v[70:71], v12 offset:20992
    v_mfma_f32_16x16x32_bf16 v[132:135], v[72:75], v[52:55], v[132:135]
    s_cmp_ge_u32 s80, 153600
    s_cselect_b32 s84, 55296, 0
    s_waitcnt lgkmcnt(6)
    v_mfma_f32_16x16x32_bf16 v[136:139], v[76:79], v[40:43], v[136:139]
    ds_read_b64_tr_b16 v[72:73], v12 offset:28672
    v_mfma_f32_16x16x32_bf16 v[140:143], v[76:79], v[44:47], v[140:143]
    s_sub_u32 s80, s80, s84
    v_mfma_f32_16x16x32_bf16 v[144:147], v[76:79], v[48:51], v[144:147]
    ds_read_b64_tr_b16 v[74:75], v12 offset:29184
    v_mfma_f32_16x16x32_bf16 v[148:151], v[76:79], v[52:55], v[148:151]
    s_waitcnt lgkmcnt(6)
    v_mfma_f32_16x16x32_bf16 v[152:155], v[80:83], v[40:43], v[152:155]
    ds_read_b64_tr_b16 v[76:77], v13 offset:36864
    v_mfma_f32_16x16x32_bf16 v[156:159], v[80:83], v[44:47], v[156:159]
    v_mfma_f32_16x16x32_bf16 v[160:163], v[80:83], v[48:51], v[160:163]
    ds_read_b64_tr_b16 v[78:79], v13 offset:37120
    v_mfma_f32_16x16x32_bf16 v[164:167], v[80:83], v[52:55], v[164:167]
    s_waitcnt lgkmcnt(6)
    v_mfma_f32_16x16x32_bf16 v[168:171], v[64:67], v[40:43], v[168:171]
    ds_read_b64_tr_b16 v[80:81], v13 offset:38912
    v_mfma_f32_16x16x32_bf16 v[172:175], v[64:67], v[44:47], v[172:175]
    v_mfma_f32_16x16x32_bf16 v[176:179], v[64:67], v[48:51], v[176:179]
    ds_read_b64_tr_b16 v[82:83], v13 offset:39168
    v_mfma_f32_16x16x32_bf16 v[180:183], v[64:67], v[52:55], v[180:183]
    s_waitcnt lgkmcnt(6)
    v_mfma_f32_16x16x32_bf16 v[184:187], v[68:71], v[40:43], v[184:187]
    v_mfma_f32_16x16x32_bf16 v[188:191], v[68:71], v[44:47], v[188:191]
    v_mfma_f32_16x16x32_bf16 v[192:195], v[68:71], v[48:51], v[192:195]
    v_mfma_f32_16x16x32_bf16 v[196:199], v[68:71], v[52:55], v[196:199]
    s_waitcnt lgkmcnt(0)
    s_barrier
    v_mfma_f32_16x16x32_bf16 v[200:203], v[72:75], v[40:43], v[200:203]
    ds_read_b64_tr_b16 v[64:65], v4 offset:0
    v_mfma_f32_16x16x32_bf16 v[204:207], v[72:75], v[44:47], v[204:207]
    ds_read_b64_tr_b16 v[66:67], v4 offset:512
    v_mfma_f32_16x16x32_bf16 v[208:211], v[72:75], v[48:51], v[208:211]
    ds_read_b128 v[24:27], v14 offset:0
    v_mfma_f32_16x16x32_bf16 v[212:215], v[72:75], v[52:55], v[212:215]
    ds_read_b128 v[28:31], v14 offset:2048
    v_mfma_f32_16x16x32_bf16 v[216:219], v[76:79], v[40:43], v[216:219]
    ds_read_b128 v[32:35], v14 offset:4096
    v_mfma_f32_16x16x32_bf16 v[220:223], v[76:79], v[44:47], v[220:223]
    ds_read_b128 v[36:39], v14 offset:6144
    v_mfma_f32_16x16x32_bf16 v[224:227], v[76:79], v[48:51], v[224:227]
    ds_read_b64_tr_b16 v[68:69], v4 offset:8192
    v_mfma_f32_16x16x32_bf16 v[228:231], v[76:79], v[52:55], v[228:231]
    ds_read_b64_tr_b16 v[70:71], v4 offset:8704
    v_mfma_f32_16x16x32_bf16 v[232:235], v[80:83], v[40:43], v[232:235]
    ds_read_b64_tr_b16 v[72:73], v5 offset:0
    v_mfma_f32_16x16x32_bf16 v[236:239], v[80:83], v[44:47], v[236:239]
    v_mfma_f32_16x16x32_bf16 v[240:243], v[80:83], v[48:51], v[240:243]
    ds_read_b64_tr_b16 v[74:75], v5 offset:512
    v_mfma_f32_16x16x32_bf16 v[244:247], v[80:83], v[52:55], v[244:247]
    s_sub_u32 s34, s34, 1
    s_cmp_lg_u32 s34, 0
    s_cbranch_scc1 L_p1
    s_waitcnt lgkmcnt(7)
    v_mfma_f32_16x16x32_bf16 v[88:91], v[64:67], v[24:27], v[88:91]
    ds_read_b64_tr_b16 v[76:77], v5 offset:8192
    s_waitcnt lgkmcnt(7)
    v_mfma_f32_16x16x32_bf16 v[92:95], v[64:67], v[28:31], v[92:95]
    ds_read_b64_tr_b16 v[78:79], v5 offset:8704
    s_waitcnt lgkmcnt(7)
    v_mfma_f32_16x16x32_bf16 v[96:99], v[64:67], v[32:35], v[96:99]
    ds_read_b64_tr_b16 v[80:81], v6 offset:0
    s_waitcnt lgkmcnt(7)
    v_mfma_f32_16x16x32_bf16 v[100:103], v[64:67], v[36:39], v[100:103]
    ds_read_b64_tr_b16 v[82:83], v6 offset:512
    s_waitcnt lgkmcnt(6)
    v_mfma_f32_16x16x32_bf16 v[104:107], v[68:71], v[24:27], v[104:107]
    ds_read_b64_tr_b16 v[64:65], v6 offset:8192
    v_mfma_f32_16x16x32_bf16 v[108:111], v[68:71], v[28:31], v[108:111]
    v_mfma_f32_16x16x32_bf16 v[112:115], v[68:71], v[32:35], v[112:115]
    ds_read_b64_tr_b16 v[66:67], v6 offset:8704
    v_mfma_f32_16x16x32_bf16 v[116:119], v[68:71], v[36:39], v[116:119]
    s_waitcnt lgkmcnt(6)
    v_mfma_f32_16x16x32_bf16 v[120:123], v[72:75], v[24:27], v[120:123]
    ds_read_b64_tr_b16 v[68:69], v7 offset:0
    v_mfma_f32_16x16x32_bf16 v[124:127], v[72:75], v[28:31], v[124:127]
    v_mfma_f32_16x16x32_bf16 v[128:131], v[72:75], v[32:35], v[128:131]
    ds_read_b64_tr_b16 v[70:71], v7 offset:512
    v_mfma_f32_16x16x32_bf16 v[132:135], v[72:75], v[36:39], v[132:135]
    s_waitcnt lgkmcnt(6)
    v_mfma_f32_16x16x32_bf16 v[136:139], v[76:79], v[24:27], v[136:139]
    ds_read_b64_tr_b16 v[72:73], v7 offset:8192
    v_mfma_f32_16x16x32_bf16 v[140:143], v[76:79], v[28:31], v[140:143]
    v_mfma_f32_16x16x32_bf16 v[144:147], v[76:79], v[32:35], v[144:147]
    ds_read_b64_tr_b16 v[74:75], v7 offset:8704
    v_mfma_f32_16x16x32_bf16 v[148:151], v[76:79], v[36:39], v[148:151]
    s_waitcnt lgkmcnt(6)
    v_mfma_f32_16x16x32_bf16 v[152:155], v[80:83], v[24:27], v[152:155]
    ds_read_b64_tr_b16 v[76:77], v8 offset:16384
    v_mfma_f32_16x16x32_bf16 v[156:159], v[80:83], v[28:31], v[156:159]
    v_mfma_f32_16x16x32_bf16 v[160:163], v[80:83], v[32:35], v[160:163]
    ds_read_b64_tr_b16 v[78:79], v8 offset:16640
    v_mfma_f32_16x16x32_bf16 v[164:167], v[80:83], v[36:39], v[164:167]
    s_waitcnt lgkmcnt(6)
    v_mfma_f32_16x16x32_bf16 v[168:171], v[64:67], v[24:27], v[168:171]
    ds_read_b64_tr_b16 v[80:81], v8 offset:18432
    v_mfma_f32_16x16x32_bf16 v[172:175], v[64:67], v[28:31], v[172:175]
    v_mfma_f32_16x16x32_bf16 v[176:179], v[64:67], v[32:35], v[176:179]
    ds_read_b64_tr_b16 v[82:83], v8 offset:18688
    v_mfma_f32_16x16x32_bf16 v[180:183], v[64:67], v[36:39], v[180:183]
    s_waitcnt lgkmcnt(6)
    v_mfma_f32_16x16x32_bf16 v[184:187], v[68:71], v[24:27], v[184:187]
    v_mfma_f32_16x16x32_bf16 v[188:191], v[68:71], v[28:31], v[188:191]
    v_mfma_f32_16x16x32_bf16 v[192:195], v[68:71], v[32:35], v[192:195]
    v_mfma_f32_16x16x32_bf16 v[196:199], v[68:71], v[36:39], v[196:199]
    s_waitcnt lgkmcnt(0)
    s_barrier
    v_mfma_f32_16x16x32_bf16 v[200:203], v[72:75], v[24:27], v[200:203]
    ds_read_b64_tr_b16 v[64:65], v4 offset:20480
    v_mfma_f32_16x16x32_bf16 v[204:207], v[72:75], v[28:31], v[204:207]
    ds_read_b64_tr_b16 v[66:67], v4 offset:20992
    v_mfma_f32_16x16x32_bf16 v[208:211], v[72:75], v[32:35], v[208:211]
    ds_read_b128 v[40:43], v15 offset:0
L_pad0:
    s_cbranch_execz L_vret0
    v_mfma_f32_16x16x32_bf16 v[212:215], v[72:75], v[36:39], v[212:215]
    ds_read_b128 v[44:47], v15 offset:2048
    v_mfma_f32_16x16x32_bf16 v[216:219], v[76:79], v[24:27], v[216:219]
    ds_read_b128 v[48:51], v15 offset:4096
    v_mfma_f32_16x16x32_bf16 v[220:223], v[76:79], v[28:31], v[220:223]
    ds_read_b128 v[52:55], v15 offset:6144
    v_mfma_f32_16x16x32_bf16 v[224:227], v[76:79], v[32:35], v[224:227]
    ds_read_b64_tr_b16 v[68:69], v4 offset:28672
    v_mfma_f32_16x16x32_bf16 v[228:231], v[76:79], v[36:39], v[228:231]
    ds_read_b64_tr_b16 v[70:71], v4 offset:29184
    v_mfma_f32_16x16x32_bf16 v[232:235], v[80:83], v[24:27], v[232:235]
    ds_read_b64_tr_b16 v[72:73], v5 offset:20480
    v_mfma_f32_16x16x32_bf16 v[236:239], v[80:83], v[28:31], v[236:239]
    v_mfma_f32_16x16x32_bf16 v[240:243], v[80:83], v[32:35], v[240:243]
    ds_read_b64_tr_b16 v[74:75], v5 offset:20992
    v_mfma_f32_16x16x32_bf16 v[244:247], v[80:83], v[36:39], v[244:247]
    s_waitcnt lgkmcnt(7)
    v_mfma_f32_16x16x32_bf16 v[88:91], v[64:67], v[40:43], v[88:91]
    ds_read_b64_tr_b16 v[76:77], v5 offset:28672
    s_waitcnt lgkmcnt(7)
    v_mfma_f32_16x16x32_bf16 v[92:95], v[64:67], v[44:47], v[92:95]
    ds_read_b64_tr_b16 v[78:79], v5 offset:29184
    s_waitcnt lgkmcnt(7)
    v_mfma_f32_16x16x32_bf16 v[96:99], v[64:67], v[48:51], v[96:99]
    ds_read_b64_tr_b16 v[80:81], v6 offset:20480
    s_waitcnt lgkmcnt(7)
    v_mfma_f32_16x16x32_bf16 v[100:103], v[64:67], v[52:55], v[100:103]
    ds_read_b64_tr_b16 v[82:83], v6 offset:20992
    s_waitcnt lgkmcnt(6)
    v_mfma_f32_16x16x32_bf16 v[104:107], v[68:71], v[40:43], v[104:107]
    ds_read_b64_tr_b16 v[64:65], v6 offset:28672
    v_mfma_f32_16x16x32_bf16 v[108:111], v[68:71], v[44:47], v[108:111]
    v_add_u32 v14, s80, v16
    v_mfma_f32_16x16x32_bf16 v[112:115], v[68:71], v[48:51], v[112:115]
    ds_read_b64_tr_b16 v[66:67], v6 offset:29184
    v_mfma_f32_16x16x32_bf16 v[116:119], v[68:71], v[52:55], v[116:119]
    v_add_u32 v15, s80, v17
    s_waitcnt lgkmcnt(6)
    v_mfma_f32_16x16x32_bf16 v[120:123], v[72:75], v[40:43], v[120:123]
    ds_read_b64_tr_b16 v[68:69], v7 offset:20480
    v_mfma_f32_16x16x32_bf16 v[124:127], v[72:75], v[44:47], v[124:127]
    s_add_u32 s80, s80, 18432
    v_mfma_f32_16x16x32_bf16 v[128:131], v[72:75], v[48:51], v[128:131]
    ds_read_b64_tr_b16 v[70:71], v7 offset:20992
    v_mfma_f32_16x16x32_bf16 v[132:135], v[72:75], v[52:55], v[132:135]
    s_cmp_ge_u32 s80, 153600
    s_cselect_b32 s84, 55296, 0
    s_waitcnt lgkmcnt(6)
    v_mfma_f32_16x16x32_bf16 v[136:139], v[76:79], v[40:43], v[136:139]
    ds_read_b64_tr_b16 v[72:73], v7 offset:28672
    v_mfma_f32_16x16x32_bf16 v[140:143], v[76:79], v[44:47], v[140:143]
    s_sub_u32 s80, s80, s84
    v_mfma_f32_16x16x32_bf16 v[144:147], v[76:79], v[48:51], v[144:147]
    ds_read_b64_tr_b16 v[74:75], v7 offset:29184
    v_mfma_f32_16x16x32_bf16 v[148:151], v[76:79], v[52:55], v[148:151]
    s_waitcnt lgkmcnt(6)
    v_mfma_f32_16x16x32_bf16 v[152:155], v[80:83], v[40:43], v[152:155]
    ds_read_b64_tr_b16 v[76:77], v8 offset:36864
    v_mfma_f32_16x16x32_bf16 v[156:159], v[80:83], v[44:47], v[156:159]
    v_mfma_f32_16x16x32_bf16 v[160:163], v[80:83], v[48:51], v[160:163]
    ds_read_b64_tr_b16 v[78:79], v8 offset:37120
    v_mfma_f32_16x16x32_bf16 v[164:167], v[80:83], v[52:55], v[164:167]
    s_waitcnt lgkmcnt(6)
    v_mfma_f32_16x16x32_bf16 v[168:171], v[64:67], v[40:43], v[168:171]
    ds_read_b64_tr_b16 v[80:81], v8 offset:38912
    v_mfma_f32_16x16x32_bf16 v[172:175], v[64:67], v[44:47], v[172:175]
    v_mfma_f32_16x16x32_bf16 v[176:179], v[64:67], v[48:51], v[176:179]
    ds_read_b64_tr_b16 v[82:83], v8 offset:39168
    v_mfma_f32_16x16x32_bf16 v[180:183], v[64:67], v[52:55], v[180:183]
    s_waitcnt lgkmcnt(6)
    v_mfma_f32_16x16x32_bf16 v[184:187], v[68:71], v[40:43], v[184:187]
    v_mfma_f32_16x16x32_bf16 v[188:191], v[68:71], v[44:47], v[188:191]
    v_mfma_f32_16x16x32_bf16 v[192:195], v[68:71], v[48:51], v[192:195]
    v_mfma_f32_16x16x32_bf16 v[196:199], v[68:71], v[52:55], v[196:199]
    s_waitcnt lgkmcnt(0)
    s_barrier
    v_mfma_f32_16x16x32_bf16 v[200:203], v[72:75], v[40:43], v[200:203]
    ds_read_b64_tr_b16 v[64:65], v9 offset:0
    v_mfma_f32_16x16x32_bf16 v[204:207], v[72:75], v[44:47], v[204:207]
    ds_read_b64_tr_b16 v[66:67], v9 offset:512
    v_mfma_f32_16x16x32_bf16 v[208:211], v[72:75], v[48:51], v[208:211]
    ds_read_b128 v[24:27], v14 offset:0
    v_mfma_f32_16x16x32_bf16 v[212:215], v[72:75], v[52:55], v[212:215]
    ds_read_b128 v[28:31], v14 offset:2048
    v_mfma_f32_16x16x32_bf16 v[216:219], v[76:79], v[40:43], v[216:219]
    ds_read_b128 v[32:35], v14 offset:4096
    v_mfma_f32_16x16x32_bf16 v[220:223], v[76:79], v[44:47], v[220:223]
    ds_read_b128 v[36:39], v14 offset:6144
    v_mfma_f32_16x16x32_bf16 v[224:227], v[76:79], v[48:51], v[224:227]
    ds_read_b64_tr_b16 v[68:69], v9 offset:8192
    v_mfma_f32_16x16x32_bf16 v[228:231], v[76:79], v[52:55], v[228:231]
    ds_read_b64_tr_b16 v[70:71], v9 offset:8704
    v_mfma_f32_16x16x32_bf16 v[232:235], v[80:83], v[40:43], v[232:235]
    ds_read_b64_tr_b16 v[72:73], v10 offset:0
    v_mfma_f32_16x16x32_bf16 v[236:239], v[80:83], v[44:47], v[236:239]
    v_mfma_f32_16x16x32_bf16 v[240:243], v[80:83], v[48:51], v[240:243]
    ds_read_b64_tr_b16 v[74:75], v10 offset:512
    v_mfma_f32_16x16x32_bf16 v[244:247], v[80:83], v[52:55], v[244:247]
    s_waitcnt lgkmcnt(7)
    v_mfma_f32_16x16x32_bf16 v[88:91], v[64:67], v[24:27], v[88:91]
    ds_read_b64_tr_b16 v[76:77], v10 offset:8192
    s_waitcnt lgkmcnt(7)
    v_mfma_f32_16x16x32_bf16 v[92:95], v[64:67], v[28:31], v[92:95]
    ds_read_b64_tr_b16 v[78:79], v10 offset:8704
    s_waitcnt lgkmcnt(7)
    v_mfma_f32_16x16x32_bf16 v[96:99], v[64:67], v[32:35], v[96:99]
    ds_read_b64_tr_b16 v[80:81], v11 offset:0
    s_waitcnt lgkmcnt(7)
    v_mfma_f32_16x16x32_bf16 v[100:103], v[64:67], v[36:39], v[100:103]
    ds_read_b64_tr_b16 v[82:83], v11 offset:512
    s_waitcnt lgkmcnt(6)
    v_mfma_f32_16x16x32_bf16 v[104:107], v[68:71], v[24:27], v[104:107]
    ds_read_b64_tr_b16 v[64:65], v11 offset:8192
    v_mfma_f32_16x16x32_bf16 v[108:111], v[68:71], v[28:31], v[108:111]
    v_mfma_f32_16x16x32_bf16 v[112:115], v[68:71], v[32:35], v[112:115]
    ds_read_b64_tr_b16 v[66:67], v11 offset:8704
    v_mfma_f32_16x16x32_bf16 v[116:119], v[68:71], v[36:39], v[116:119]
    s_waitcnt lgkmcnt(6)
    v_mfma_f32_16x16x32_bf16 v[120:123], v[72:75], v[24:27], v[120:123]
    ds_read_b64_tr_b16 v[68:69], v12 offset:0
    v_mfma_f32_16x16x32_bf16 v[124:127], v[72:75], v[28:31], v[124:127]
    v_mfma_f32_16x16x32_bf16 v[128:131], v[72:75], v[32:35], v[128:131]
    ds_read_b64_tr_b16 v[70:71], v12 offset:512
    v_mfma_f32_16x16x32_bf16 v[132:135], v[72:75], v[36:39], v[132:135]
    s_waitcnt lgkmcnt(6)
    v_mfma_f32_16x16x32_bf16 v[136:139], v[76:79], v[24:27], v[136:139]
    ds_read_b64_tr_b16 v[72:73], v12 offset:8192
    v_mfma_f32_16x16x32_bf16 v[140:143], v[76:79], v[28:31], v[140:143]
    v_mfma_f32_16x16x32_bf16 v[144:147], v[76:79], v[32:35], v[144:147]
    ds_read_b64_tr_b16 v[74:75], v12 offset:8704
    v_mfma_f32_16x16x32_bf16 v[148:151], v[76:79], v[36:39], v[148:151]
    s_waitcnt lgkmcnt(6)
    v_mfma_f32_16x16x32_bf16 v[152:155], v[80:83], v[24:27], v[152:155]
    ds_read_b64_tr_b16 v[76:77], v13 offset:16384
    v_mfma_f32_16x16x32_bf16 v[156:159], v[80:83], v[28:31], v[156:159]
    v_mfma_f32_16x16x32_bf16 v[160:163], v[80:83], v[32:35], v[160:163]
    ds_read_b64_tr_b16 v[78:79], v13 offset:16640
    v_mfma_f32_16x16x32_bf16 v[164:167], v[80:83], v[36:39], v[164:167]
    s_waitcnt lgkmcnt(6)
    v_mfma_f32_16x16x32_bf16 v[168:171], v[64:67], v[24:27], v[168:171]
    ds_read_b64_tr_b16 v[80:81], v13 offset:18432
    v_mfma_f32_16x16x32_bf16 v[172:175], v[64:67], v[28:31], v[172:175]
    v_mfma_f32_16x16x32_bf16 v[176:179], v[64:67], v[32:35], v[176:179]
    ds_read_b64_tr_b16 v[82:83], v13 offset:18688
    v_mfma_f32_16x16x32_bf16 v[180:183], v[64:67], v[36:39], v[180:183]
    s_waitcnt lgkmcnt(6)
    v_mfma_f32_16x16x32_bf16 v[184:187], v[68:71], v[24:27], v[184:187]
    v_mfma_f32_16x16x32_bf16 v[188:191], v[68:71], v[28:31], v[188:191]
    v_mfma_f32_16x16x32_bf16 v[192:195], v[68:71], v[32:35], v[192:195]
    v_mfma_f32_16x16x32_bf16 v[196:199], v[68:71], v[36:39], v[196:199]
    s_waitcnt lgkmcnt(0)
    s_barrier
    v_mfma_f32_16x16x32_bf16 v[200:203], v[72:75], v[24:27], v[200:203]
    ds_read_b64_tr_b16 v[64:65], v9 offset:20480
    v_mfma_f32_16x16x32_bf16 v[204:207], v[72:75], v[28:31], v[204:207]
    ds_read_b64_tr_b16 v[66:67], v9 offset:20992
    v_mfma_f32_16x16x32_bf16 v[208:211], v[72:75], v[32:35], v[208:211]
    ds_read_b128 v[40:43], v15 offset:0
    v_mfma_f32_16x16x32_bf16 v[212:215], v[72:75], v[36:39], v[212:215]
    ds_read_b128 v[44:47], v15 offset:2048
    v_mfma_f32_16x16x32_bf16 v[216:219], v[76:79], v[24:27], v[216:219]
    ds_read_b128 v[48:51], v15 offset:4096
    v_mfma_f32_16x16x32_bf16 v[220:223], v[76:79], v[28:31], v[220:223]
    ds_read_b128 v[52:55], v15 offset:6144
    v_mfma_f32_16x16x32_bf16 v[224:227], v[76:79], v[32:35], v[224:227]
    ds_read_b64_tr_b16 v[68:69], v9 offset:28672
    v_mfma_f32_16x16x32_bf16 v[228:231], v[76:79], v[36:39], v[228:231]
    ds_read_b64_tr_b16 v[70:71], v9 offset:29184
    v_mfma_f32_16x16x32_bf16 v[232:235], v[80:83], v[24:27], v[232:235]
    ds_read_b64_tr_b16 v[72:73], v10 offset:20480
    v_mfma_f32_16x16x32_bf16 v[236:239], v[80:83], v[28:31], v[236:239]
    v_mfma_f32_16x16x32_bf16 v[240:243], v[80:83], v[32:35], v[240:243]
    ds_read_b64_tr_b16 v[74:75], v10 offset:20992
    v_mfma_f32_16x16x32_bf16 v[244:247], v[80:83], v[36:39], v[244:247]
    s_waitcnt lgkmcnt(7)
    v_mfma_f32_16x16x32_bf16 v[88:91], v[64:67], v[40:43], v[88:91]
    ds_read_b64_tr_b16 v[76:77], v10 offset:28672
    s_waitcnt lgkmcnt(7)
    v_mfma_f32_16x16x32_bf16 v[92:95], v[64:67], v[44:47], v[92:95]
    ds_read_b64_tr_b16 v[78:79], v10 offset:29184
    s_waitcnt lgkmcnt(7)
    v_mfma_f32_16x16x32_bf16 v[96:99], v[64:67], v[48:51], v[96:99]
    ds_read_b64_tr_b16 v[80:81], v11 offset:20480
    s_waitcnt lgkmcnt(7)
    v_mfma_f32_16x16x32_bf16 v[100:103], v[64:67], v[52:55], v[100:103]
    ds_read_b64_tr_b16 v[82:83], v11 offset:20992
    s_waitcnt lgkmcnt(6)
    v_mfma_f32_16x16x32_bf16 v[104:107], v[68:71], v[40:43], v[104:107]
    ds_read_b64_tr_b16 v[64:65], v11 offset:28672
    v_mfma_f32_16x16x32_bf16 v[108:111], v[68:71], v[44:47], v[108:111]
    v_mfma_f32_16x16x32_bf16 v[112:115], v[68:71], v[48:51], v[112:115]
    ds_read_b64_tr_b16 v[66:67], v11 offset:29184
    v_mfma_f32_16x16x32_bf16 v[116:119], v[68:71], v[52:55], v[116:119]
    s_waitcnt lgkmcnt(6)
    v_mfma_f32_16x16x32_bf16 v[120:123], v[72:75], v[40:43], v[120:123]
    ds_read_b64_tr_b16 v[68:69], v12 offset:20480
    v_mfma_f32_16x16x32_bf16 v[124:127], v[72:75], v[44:47], v[124:127]
    v_mfma_f32_16x16x32_bf16 v[128:131], v[72:75], v[48:51], v[128:131]
    ds_read_b64_tr_b16 v[70:71], v12 offset:20992
    v_mfma_f32_16x16x32_bf16 v[132:135], v[72:75], v[52:55], v[132:135]
    s_waitcnt lgkmcnt(6)
    v_mfma_f32_16x16x32_bf16 v[136:139], v[76:79], v[40:43], v[136:139]
    ds_read_b64_tr_b16 v[72:73], v12 offset:28672
    v_mfma_f32_16x16x32_bf16 v[140:143], v[76:79], v[44:47], v[140:143]
    v_mfma_f32_16x16x32_bf16 v[144:147], v[76:79], v[48:51], v[144:147]
    ds_read_b64_tr_b16 v[74:75], v12 offset:29184
    v_mfma_f32_16x16x32_bf16 v[148:151], v[76:79], v[52:55], v[148:151]
    s_waitcnt lgkmcnt(6)
    v_mfma_f32_16x16x32_bf16 v[152:155], v[80:83], v[40:43], v[152:155]
    ds_read_b64_tr_b16 v[76:77], v13 offset:36864
    v_mfma_f32_16x16x32_bf16 v[156:159], v[80:83], v[44:47], v[156:159]
    v_mfma_f32_16x16x32_bf16 v[160:163], v[80:83], v[48:51], v[160:163]
    ds_read_b64_tr_b16 v[78:79], v13 offset:37120
    v_mfma_f32_16x16x32_bf16 v[164:167], v[80:83], v[52:55], v[164:167]
    s_waitcnt lgkmcnt(6)
    v_mfma_f32_16x16x32_bf16 v[168:171], v[64:67], v[40:43], v[168:171]
    ds_read_b64_tr_b16 v[80:81], v13 offset:38912
    v_mfma_f32_16x16x32_bf16 v[172:175], v[64:67], v[44:47], v[172:175]
    v_mfma_f32_16x16x32_bf16 v[176:179], v[64:67], v[48:51], v[176:179]
    ds_read_b64_tr_b16 v[82:83], v13 offset:39168
    v_mfma_f32_16x16x32_bf16 v[180:183], v[64:67], v[52:55], v[180:183]
    s_waitcnt lgkmcnt(6)
    v_mfma_f32_16x16x32_bf16 v[184:187], v[68:71], v[40:43], v[184:187]
    v_mfma_f32_16x16x32_bf16 v[188:191], v[68:71], v[44:47], v[188:191]
    v_mfma_f32_16x16x32_bf16 v[192:195], v[68:71], v[48:51], v[192:195]
    v_mfma_f32_16x16x32_bf16 v[196:199], v[68:71], v[52:55], v[196:199]
    s_waitcnt lgkmcnt(0)
    s_barrier
    v_mfma_f32_16x16x32_bf16 v[200:203], v[72:75], v[40:43], v[200:203]
    v_mfma_f32_16x16x32_bf16 v[204:207], v[72:75], v[44:47], v[204:207]
    v_mfma_f32_16x16x32_bf16 v[208:211], v[72:75], v[48:51], v[208:211]
    v_mfma_f32_16x16x32_bf16 v[212:215], v[72:75], v[52:55], v[212:215]
    v_mfma_f32_16x16x32_bf16 v[216:219], v[76:79], v[40:43], v[216:219]
    v_mfma_f32_16x16x32_bf16 v[220:223], v[76:79], v[44:47], v[220:223]
    v_mfma_f32_16x16x32_bf16 v[224:227], v[76:79], v[48:51], v[224:227]
    v_mfma_f32_16x16x32_bf16 v[228:231], v[76:79], v[52:55], v[228:231]
    v_mfma_f32_16x16x32_bf16 v[232:235], v[80:83], v[40:43], v[232:235]
    v_mfma_f32_16x16x32_bf16 v[236:239], v[80:83], v[44:47], v[236:239]
    v_mfma_f32_16x16x32_bf16 v[240:243], v[80:83], v[48:51], v[240:243]
    v_mfma_f32_16x16x32_bf16 v[244:247], v[80:83], v[52:55], v[244:247]
    s_setprio 0
    s_lshl_b32 s84, s5, 10
    s_add_u32 s84, s84, 161024
    v_and_b32 v16, 15, v1
    v_lshl_add_u32 v16, v16, 4, s84
    ds_read_b128 v[64:67], v16 offset:0
    ds_read_b128 v[68:71], v16 offset:256
    ds_read_b128 v[72:75], v16 offset:512
    ds_read_b128 v[76:79], v16 offset:768
    v_and_b32 v17, 48, v1
    s_lshl_b32 s84, s6, 8
    s_add_u32 s84, s84, 159744
    v_add_u32 v16, s84, v17
    s_lshl_b32 s84, s6, 6
    s_add_u32 s84, s84, 159744
    v_add_u32 v17, s84, v17
    ds_read_b128 v[24:27], v16 offset:0
    ds_read_b128 v[28:31], v16 offset:640
    ds_read_b128 v[32:35], v16 offset:64
    ds_read_b128 v[36:39], v16 offset:704
    ds_read_b128 v[40:43], v16 offset:128
    ds_read_b128 v[44:47], v16 offset:768
    ds_read_b128 v[48:51], v16 offset:192
    ds_read_b128 v[52:55], v16 offset:832
    ds_read_b128 v[56:59], v17 offset:512
    ds_read_b128 v[60:63], v17 offset:1152
    s_memrealtime s[92:93]
    s_memtime s[90:91]
    s_add_u32 m0, s79, 116736
    s_mov_b32 s78, 256
    buffer_load_dwordx4 v20, s[36:39], s78 offen sc1 lds
    s_waitcnt lgkmcnt(0)
    s_mov_b32 s34, s92
    s_mov_b32 s35, s90
    v_fmac_f32 v88, v24, v64
    v_fmac_f32 v89, v25, v64
    v_fmac_f32 v90, v26, v64
    v_fmac_f32 v91, v27, v64
    v_fmac_f32 v104, v28, v64
    v_fmac_f32 v105, v29, v64
    v_fmac_f32 v106, v30, v64
    v_fmac_f32 v107, v31, v64
    s_add_u32 m0, s79, 117760
    s_nop 0
    buffer_load_dwordx4 v21, s[36:39], s78 offen sc1 lds
    v_mul_f32 v80, v88, v88
    v_mul_f32 v81, v89, v89
    v_mul_f32 v82, v90, v90
    v_mul_f32 v83, v91, v91
    v_fma_f32 v80, v80, v66, v65
    v_fma_f32 v81, v81, v66, v65
    v_fma_f32 v82, v82, v66, v65
    v_fma_f32 v83, v83, v66, v65
    s_add_u32 m0, s33, 77824
    s_mov_b32 s76, 589824
    buffer_load_dwordx4 v23, s[40:43], s76 offen offset:0 lds
    v_mul_f32 v80, v80, v88
    v_mul_f32 v81, v81, v89
    v_mul_f32 v82, v82, v90
    v_mul_f32 v83, v83, v91
    v_exp_f32 v80, v80
    v_mul_f32 v88, v88, v104
    v_exp_f32 v81, v81
    s_add_u32 m0, s33, 79872
    s_nop 0
    buffer_load_dwordx4 v23, s[40:43], s76 offen offset:2048 lds
    v_mul_f32 v89, v89, v105
    v_exp_f32 v82, v82
    v_mul_f32 v90, v90, v106
    v_exp_f32 v83, v83
    v_mul_f32 v91, v91, v107
    v_fma_f32 v80, v80, v67, v67
    s_add_u32 m0, s33, 86016
    s_nop 0
    buffer_load_dwordx4 v23, s[44:47], s76 offen offset:0 lds
    v_fma_f32 v81, v81, v67, v67
    v_fma_f32 v82, v82, v67, v67
    v_fma_f32 v83, v83, v67, v67
    v_rcp_f32 v80, v80
    v_rcp_f32 v81, v81
    v_rcp_f32 v82, v82
    s_add_u32 m0, s33, 90112
    s_mov_b32 s77, 688128
    buffer_load_dwordx4 v22, s[48:51], s77 offen offset:0 lds
    v_rcp_f32 v83, v83
    s_nop 0
    v_mul_f32 v88, v88, v80
    v_mul_f32 v89, v89, v81
    v_mul_f32 v90, v90, v82
    v_mul_f32 v91, v91, v83
    v_cvt_pk_bf16_f32 v88, v88, v89
    v_cvt_pk_bf16_f32 v89, v90, v91
    s_add_u32 m0, s33, 94208
    s_nop 0
    buffer_load_dwordx4 v22, s[52:55], s77 offen offset:0 lds
    s_barrier
    s_add_u32 m0, s79, 118784
    s_mov_b32 s78, 33024
    buffer_load_dwordx4 v20, s[36:39], s78 offen sc1 lds
    v_fmac_f32 v92, v24, v68
    v_fmac_f32 v93, v25, v68
    v_fmac_f32 v94, v26, v68
    v_fmac_f32 v95, v27, v68
    v_fmac_f32 v108, v28, v68
    v_fmac_f32 v109, v29, v68
    v_fmac_f32 v110, v30, v68
    v_fmac_f32 v111, v31, v68
    s_add_u32 m0, s79, 119808
    s_nop 0
    buffer_load_dwordx4 v21, s[36:39], s78 offen sc1 lds
    v_mul_f32 v80, v92, v92
    v_mul_f32 v81, v93, v93
    v_mul_f32 v82, v94, v94
    v_mul_f32 v83, v95, v95
    v_fma_f32 v80, v80, v70, v69
    v_fma_f32 v81, v81, v70, v69
    v_fma_f32 v82, v82, v70, v69
    v_fma_f32 v83, v83, v70, v69
    s_add_u32 m0, s81, 133120
    s_mov_b32 s78, 256
    s_mov_b64 exec, 0xffffffff
    buffer_load_dwordx4 v3, s[36:39], s78 offen sc1 lds
    s_mov_b64 exec, -1
    v_mul_f32 v80, v80, v92
    v_mul_f32 v81, v81, v93
    v_mul_f32 v82, v82, v94
    v_mul_f32 v83, v83, v95
    v_exp_f32 v80, v80
    v_mul_f32 v92, v92, v108
    v_exp_f32 v81, v81
    s_add_u32 m0, s33, 16384
    s_mov_b32 s76, 786432
    buffer_load_dwordx4 v23, s[40:43], s76 offen offset:0 lds
    s_add_u32 m0, s33, 18432
    s_nop 0
    buffer_load_dwordx4 v23, s[40:43], s76 offen offset:2048 lds
    v_mul_f32 v93, v93, v109
    v_exp_f32 v82, v82
    v_mul_f32 v94, v94, v110
    v_exp_f32 v83, v83
    v_mul_f32 v95, v95, v111
    v_fma_f32 v80, v80, v71, v71
    s_add_u32 m0, s33, 24576
    s_nop 0
    buffer_load_dwordx4 v23, s[44:47], s76 offen offset:0 lds
    v_fma_f32 v81, v81, v71, v71
    v_fma_f32 v82, v82, v71, v71
    v_fma_f32 v83, v83, v71, v71
    v_rcp_f32 v80, v80
    v_rcp_f32 v81, v81
    v_rcp_f32 v82, v82
    s_add_u32 m0, s33, 28672
    s_mov_b32 s77, 917504
    buffer_load_dwordx4 v22, s[48:51], s77 offen offset:0 lds
    v_rcp_f32 v83, v83
    s_nop 0
    v_mul_f32 v92, v92, v80
    v_mul_f32 v93, v93, v81
    v_mul_f32 v94, v94, v82
    v_mul_f32 v95, v95, v83
    v_cvt_pk_bf16_f32 v90, v92, v93
    v_cvt_pk_bf16_f32 v91, v94, v95
    s_add_u32 m0, s33, 32768
    s_nop 0
    buffer_load_dwordx4 v22, s[52:55], s77 offen offset:0 lds
    s_add_u32 s75, s75, 0x300000
    s_load_dword s94, s[10:11], s75 offset:0x0
    s_load_dword s94, s[10:11], s75 offset:0x40
    s_load_dword s94, s[10:11], s75 offset:0x80
    s_load_dword s94, s[10:11], s75 offset:0xc0
    s_load_dword s94, s[10:11], s75 offset:0x100
    v_mov_b32 v5, 0
    s_mov_b64 exec, 1
    global_load_dwordx2 v[6:7], v5, s[24:25] sc1
    s_mov_b64 exec, -1
    s_barrier
    s_add_u32 m0, s79, 135168
    s_mov_b32 s78, 384
    buffer_load_dwordx4 v20, s[36:39], s78 offen sc1 lds
    s_nop 1
    v_permlane16_swap_b32 v88, v90
    v_permlane16_swap_b32 v89, v91
    v_fmac_f32 v96, v24, v72
    v_fmac_f32 v97, v25, v72
    v_fmac_f32 v98, v26, v72
    v_fmac_f32 v99, v27, v72
    v_fmac_f32 v112, v28, v72
    v_fmac_f32 v113, v29, v72
    v_fmac_f32 v114, v30, v72
    v_fmac_f32 v115, v31, v72
    s_add_u32 m0, s79, 136192
    s_nop 0
    buffer_load_dwordx4 v21, s[36:39], s78 offen sc1 lds
    v_mul_f32 v80, v96, v96
    v_mul_f32 v81, v97, v97
    v_mul_f32 v82, v98, v98
    v_mul_f32 v83, v99, v99
    v_fma_f32 v80, v80, v74, v73
    v_fma_f32 v81, v81, v74, v73
    v_fma_f32 v82, v82, v74, v73
    v_fma_f32 v83, v83, v74, v73
    s_add_u32 m0, s33, 36864
    s_mov_b32 s76, 983040
    buffer_load_dwordx4 v23, s[40:43], s76 offen offset:0 lds
    v_mul_f32 v80, v80, v96
    v_mul_f32 v81, v81, v97
    v_mul_f32 v82, v82, v98
    v_mul_f32 v83, v83, v99
    v_exp_f32 v80, v80
    v_mul_f32 v96, v96, v112
    v_exp_f32 v81, v81
    s_add_u32 m0, s33, 38912
    s_nop 0
    buffer_load_dwordx4 v23, s[40:43], s76 offen offset:2048 lds
    s_add_u32 m0, s33, 45056
    s_nop 0
    buffer_load_dwordx4 v23, s[44:47], s76 offen offset:0 lds
    v_mul_f32 v97, v97, v113
    v_exp_f32 v82, v82
    v_mul_f32 v98, v98, v114
    v_exp_f32 v83, v83
    v_mul_f32 v99, v99, v115
    v_fma_f32 v80, v80, v75, v75
    s_add_u32 m0, s33, 49152
    s_mov_b32 s77, 1146880
    buffer_load_dwordx4 v22, s[48:51], s77 offen offset:0 lds
    v_fma_f32 v81, v81, v75, v75
    v_fma_f32 v82, v82, v75, v75
    v_fma_f32 v83, v83, v75, v75
    v_rcp_f32 v80, v80
    v_rcp_f32 v81, v81
    v_rcp_f32 v82, v82
    s_add_u32 m0, s33, 53248
    s_nop 0
    buffer_load_dwordx4 v22, s[52:55], s77 offen offset:0 lds
    v_rcp_f32 v83, v83
    s_nop 0
    v_mul_f32 v96, v96, v80
    v_mul_f32 v97, v97, v81
    v_mul_f32 v98, v98, v82
    v_mul_f32 v99, v99, v83
    v_cvt_pk_bf16_f32 v96, v96, v97
    v_cvt_pk_bf16_f32 v97, v98, v99
    buffer_store_dwordx4 v[88:91], v19, s[68:71], s72 offen offset:0 sc1
    s_load_dword s94, s[10:11], s75 offset:0x140
    s_load_dword s94, s[10:11], s75 offset:0x180
    s_load_dword s94, s[10:11], s75 offset:0x1c0
    s_add_u32 s99, s99, 0x380000
    s_load_dword s94, s[16:17], s99 offset:0x0
    s_load_dword s94, s[16:17], s99 offset:0x40
    s_waitcnt vmcnt(17)
    s_barrier
    s_add_u32 m0, s79, 137216
    s_mov_b32 s78, 33152
    buffer_load_dwordx4 v20, s[36:39], s78 offen sc1 lds
    v_fmac_f32 v100, v24, v76
    v_fmac_f32 v101, v25, v76
    v_fmac_f32 v102, v26, v76
    v_fmac_f32 v103, v27, v76
    v_fmac_f32 v116, v28, v76
    v_fmac_f32 v117, v29, v76
    v_fmac_f32 v118, v30, v76
    v_fmac_f32 v119, v31, v76
    s_add_u32 m0, s79, 138240
    s_nop 0
    buffer_load_dwordx4 v21, s[36:39], s78 offen sc1 lds
    v_mul_f32 v80, v100, v100
    v_mul_f32 v81, v101, v101
    v_mul_f32 v82, v102, v102
    v_mul_f32 v83, v103, v103
    v_fma_f32 v80, v80, v78, v77
    v_fma_f32 v81, v81, v78, v77
    v_fma_f32 v82, v82, v78, v77
    v_fma_f32 v83, v83, v78, v77
    s_add_u32 m0, s81, 151552
    s_mov_b32 s78, 384
    s_mov_b64 exec, 0xffffffff
    buffer_load_dwordx4 v3, s[36:39], s78 offen sc1 lds
    s_mov_b64 exec, -1
    v_mul_f32 v80, v80, v100
    v_mul_f32 v81, v81, v101
    v_mul_f32 v82, v82, v102
    v_mul_f32 v83, v83, v103
    v_exp_f32 v80, v80
    v_mul_f32 v100, v100, v116
    v_exp_f32 v81, v81
    s_add_u32 m0, s33, 57344
    s_mov_b32 s76, 1179648
    buffer_load_dwordx4 v23, s[40:43], s76 offen offset:0 lds
    s_add_u32 m0, s33, 59392
    s_nop 0
    buffer_load_dwordx4 v23, s[40:43], s76 offen offset:2048 lds
    v_mul_f32 v101, v101, v117
    v_exp_f32 v82, v82
    v_mul_f32 v102, v102, v118
    v_exp_f32 v83, v83
    v_mul_f32 v103, v103, v119
    v_fma_f32 v80, v80, v79, v79
    s_add_u32 m0, s33, 65536
    s_nop 0
    buffer_load_dwordx4 v23, s[44:47], s76 offen offset:0 lds
    v_fma_f32 v81, v81, v79, v79
    v_fma_f32 v82, v82, v79, v79
    v_fma_f32 v83, v83, v79, v79
    v_rcp_f32 v80, v80
    v_rcp_f32 v81, v81
    v_rcp_f32 v82, v82
    s_add_u32 m0, s33, 69632
    s_mov_b32 s77, 1376256
    buffer_load_dwordx4 v22, s[48:51], s77 offen offset:0 lds
    v_rcp_f32 v83, v83
    s_nop 0
    v_mul_f32 v100, v100, v80
    v_mul_f32 v101, v101, v81
    v_mul_f32 v102, v102, v82
    v_mul_f32 v103, v103, v83
    v_cvt_pk_bf16_f32 v98, v100, v101
    v_cvt_pk_bf16_f32 v99, v102, v103
    s_add_u32 m0, s33, 73728
    s_nop 0
    buffer_load_dwordx4 v22, s[52:55], s77 offen offset:0 lds
    s_load_dword s94, s[16:17], s99 offset:0x80
    s_load_dword s94, s[16:17], s99 offset:0xc0
    s_load_dword s94, s[16:17], s99 offset:0x100
    s_load_dword s94, s[16:17], s99 offset:0x140
    s_load_dword s94, s[16:17], s99 offset:0x180
    s_waitcnt vmcnt(17)
    s_barrier
    s_add_u32 m0, s79, 98304
    s_mov_b32 s78, 512
    buffer_load_dwordx4 v20, s[36:39], s78 offen sc1 lds
    s_nop 1
    v_permlane16_swap_b32 v96, v98
    v_permlane16_swap_b32 v97, v99
    v_fmac_f32 v120, v32, v64
    v_fmac_f32 v121, v33, v64
    v_fmac_f32 v122, v34, v64
    v_fmac_f32 v123, v35, v64
    v_fmac_f32 v136, v36, v64
    v_fmac_f32 v137, v37, v64
    v_fmac_f32 v138, v38, v64
    v_fmac_f32 v139, v39, v64
    s_add_u32 m0, s79, 99328
    s_nop 0
    buffer_load_dwordx4 v21, s[36:39], s78 offen sc1 lds
    v_mul_f32 v80, v120, v120
    v_mul_f32 v81, v121, v121
    v_mul_f32 v82, v122, v122
    v_mul_f32 v83, v123, v123
    v_fma_f32 v80, v80, v66, v65
    v_fma_f32 v81, v81, v66, v65
    v_fma_f32 v82, v82, v66, v65
    v_fma_f32 v83, v83, v66, v65
    s_add_u32 m0, s33, 77824
    s_mov_b32 s76, 1376256
    buffer_load_dwordx4 v23, s[40:43], s76 offen offset:0 lds
    v_mul_f32 v80, v80, v120
    v_mul_f32 v81, v81, v121
    v_mul_f32 v82, v82, v122
    v_mul_f32 v83, v83, v123
    v_exp_f32 v80, v80
    v_mul_f32 v120, v120, v136
    v_exp_f32 v81, v81
    s_add_u32 m0, s33, 79872
    s_nop 0
    buffer_load_dwordx4 v23, s[40:43], s76 offen offset:2048 lds
    s_add_u32 m0, s33, 86016
    s_nop 0
    buffer_load_dwordx4 v23, s[44:47], s76 offen offset:0 lds
    v_mul_f32 v121, v121, v137
    v_exp_f32 v82, v82
    v_mul_f32 v122, v122, v138
    v_exp_f32 v83, v83
    v_mul_f32 v123, v123, v139
    v_fma_f32 v80, v80, v67, v67
    s_add_u32 m0, s33, 90112
    s_mov_b32 s77, 1605632
    buffer_load_dwordx4 v22, s[48:51], s77 offen offset:0 lds
    v_fma_f32 v81, v81, v67, v67
    v_fma_f32 v82, v82, v67, v67
    v_fma_f32 v83, v83, v67, v67
    v_rcp_f32 v80, v80
    v_rcp_f32 v81, v81
    v_rcp_f32 v82, v82
    s_add_u32 m0, s33, 94208
    s_nop 0
    buffer_load_dwordx4 v22, s[52:55], s77 offen offset:0 lds
    v_rcp_f32 v83, v83
    s_nop 0
    v_mul_f32 v120, v120, v80
    v_mul_f32 v121, v121, v81
    v_mul_f32 v122, v122, v82
    v_mul_f32 v123, v123, v83
    v_cvt_pk_bf16_f32 v120, v120, v121
    v_cvt_pk_bf16_f32 v121, v122, v123
    buffer_store_dwordx4 v[96:99], v19, s[68:71], s72 offen offset:2048 sc1
    s_load_dword s94, s[16:17], s99 offset:0x1c0
L_pad1:
    s_cbranch_execz L_vret1
    s_load_dword s94, s[18:19], s99 offset:0x0
    s_load_dword s94, s[18:19], s99 offset:0x40
    s_load_dword s94, s[18:19], s99 offset:0x80
    s_load_dword s94, s[18:19], s99 offset:0xc0
    s_waitcnt vmcnt(17)
    s_barrier
    s_add_u32 m0, s79, 100352
    s_mov_b32 s78, 33280
    buffer_load_dwordx4 v20, s[36:39], s78 offen sc1 lds
    v_fmac_f32 v124, v32, v68
    v_fmac_f32 v125, v33, v68
    v_fmac_f32 v126, v34, v68
    v_fmac_f32 v127, v35, v68
    v_fmac_f32 v140, v36, v68
    v_fmac_f32 v141, v37, v68
    v_fmac_f32 v142, v38, v68
    v_fmac_f32 v143, v39, v68
    s_add_u32 m0, s79, 101376
    s_nop 0
    buffer_load_dwordx4 v21, s[36:39], s78 offen sc1 lds
    v_mul_f32 v80, v124, v124
    v_mul_f32 v81, v125, v125
    v_mul_f32 v82, v126, v126
    v_mul_f32 v83, v127, v127
    v_fma_f32 v80, v80, v70, v69
    v_fma_f32 v81, v81, v70, v69
    v_fma_f32 v82, v82, v70, v69
    v_fma_f32 v83, v83, v70, v69
    s_add_u32 m0, s81, 114688
    s_mov_b32 s78, 512
    s_mov_b64 exec, 0xffffffff
    buffer_load_dwordx4 v3, s[36:39], s78 offen sc1 lds
    s_mov_b64 exec, -1
    v_mul_f32 v80, v80, v124
    v_mul_f32 v81, v81, v125
    v_mul_f32 v82, v82, v126
    v_mul_f32 v83, v83, v127
    v_exp_f32 v80, v80
    v_mul_f32 v124, v124, v140
    v_exp_f32 v81, v81
    s_add_u32 m0, s33, 16384
    s_mov_b32 s76, 1572864
    buffer_load_dwordx4 v23, s[40:43], s76 offen offset:0 lds
    s_add_u32 m0, s33, 18432
    s_nop 0
    buffer_load_dwordx4 v23, s[40:43], s76 offen offset:2048 lds
    v_mul_f32 v125, v125, v141
    v_exp_f32 v82, v82
    v_mul_f32 v126, v126, v142
    v_exp_f32 v83, v83
    v_mul_f32 v127, v127, v143
    v_fma_f32 v80, v80, v71, v71
    s_add_u32 m0, s33, 24576
    s_nop 0
    buffer_load_dwordx4 v23, s[44:47], s76 offen offset:0 lds
    v_fma_f32 v81, v81, v71, v71
    v_fma_f32 v82, v82, v71, v71
    v_fma_f32 v83, v83, v71, v71
    v_rcp_f32 v80, v80
    v_rcp_f32 v81, v81
    v_rcp_f32 v82, v82
    s_add_u32 m0, s33, 28672
    s_mov_b32 s77, 1835008
    buffer_load_dwordx4 v22, s[48:51], s77 offen offset:0 lds
    v_rcp_f32 v83, v83
    s_nop 0
    v_mul_f32 v124, v124, v80
    v_mul_f32 v125, v125, v81
    v_mul_f32 v126, v126, v82
    v_mul_f32 v127, v127, v83
    v_cvt_pk_bf16_f32 v122, v124, v125
    v_cvt_pk_bf16_f32 v123, v126, v127
    s_add_u32 m0, s33, 32768
    s_nop 0
    buffer_load_dwordx4 v22, s[52:55], s77 offen offset:0 lds
    s_load_dword s94, s[18:19], s99 offset:0x100
    s_load_dword s94, s[18:19], s99 offset:0x140
    s_load_dword s94, s[18:19], s99 offset:0x180
    s_load_dword s94, s[18:19], s99 offset:0x1c0
    s_load_dword s94, s[10:11], s75 offset:0x80000
    s_waitcnt vmcnt(16)
    s_barrier
    s_add_u32 m0, s79, 116736
    s_mov_b32 s78, 640
    buffer_load_dwordx4 v20, s[36:39], s78 offen sc1 lds
    s_nop 1
    v_permlane16_swap_b32 v120, v122
    v_permlane16_swap_b32 v121, v123
    v_fmac_f32 v128, v32, v72
    v_fmac_f32 v129, v33, v72
    v_fmac_f32 v130, v34, v72
    v_fmac_f32 v131, v35, v72
    v_fmac_f32 v144, v36, v72
    v_fmac_f32 v145, v37, v72
    v_fmac_f32 v146, v38, v72
    v_fmac_f32 v147, v39, v72
    s_add_u32 m0, s79, 117760
    s_nop 0
    buffer_load_dwordx4 v21, s[36:39], s78 offen sc1 lds
    v_mul_f32 v80, v128, v128
    v_mul_f32 v81, v129, v129
    v_mul_f32 v82, v130, v130
    v_mul_f32 v83, v131, v131
    v_fma_f32 v80, v80, v74, v73
    v_fma_f32 v81, v81, v74, v73
    v_fma_f32 v82, v82, v74, v73
    v_fma_f32 v83, v83, v74, v73
    s_add_u32 m0, s33, 36864
    s_mov_b32 s76, 1769472
    buffer_load_dwordx4 v23, s[40:43], s76 offen offset:0 lds
    v_mul_f32 v80, v80, v128
    v_mul_f32 v81, v81, v129
    v_mul_f32 v82, v82, v130
    v_mul_f32 v83, v83, v131
    v_exp_f32 v80, v80
    v_mul_f32 v128, v128, v144
    v_exp_f32 v81, v81
    s_add_u32 m0, s33, 38912
    s_nop 0
    buffer_load_dwordx4 v23, s[40:43], s76 offen offset:2048 lds
    s_add_u32 m0, s33, 45056
    s_nop 0
    buffer_load_dwordx4 v23, s[44:47], s76 offen offset:0 lds
    v_mul_f32 v129, v129, v145
    v_exp_f32 v82, v82
    v_mul_f32 v130, v130, v146
    v_exp_f32 v83, v83
    v_mul_f32 v131, v131, v147
    v_fma_f32 v80, v80, v75, v75
    s_add_u32 m0, s33, 49152
    s_mov_b32 s77, 2064384
    buffer_load_dwordx4 v22, s[48:51], s77 offen offset:0 lds
    v_fma_f32 v81, v81, v75, v75
    v_fma_f32 v82, v82, v75, v75
    v_fma_f32 v83, v83, v75, v75
    v_rcp_f32 v80, v80
    v_rcp_f32 v81, v81
    v_rcp_f32 v82, v82
    s_add_u32 m0, s33, 53248
    s_nop 0
    buffer_load_dwordx4 v22, s[52:55], s77 offen offset:0 lds
    v_rcp_f32 v83, v83
    s_nop 0
    v_mul_f32 v128, v128, v80
    v_mul_f32 v129, v129, v81
    v_mul_f32 v130, v130, v82
    v_mul_f32 v131, v131, v83
    v_cvt_pk_bf16_f32 v128, v128, v129
    v_cvt_pk_bf16_f32 v129, v130, v131
    buffer_store_dwordx4 v[120:123], v19, s[68:71], s72 offen offset:512 sc1
    s_load_dword s94, s[10:11], s75 offset:0x80040
    s_load_dword s94, s[10:11], s75 offset:0x80080
    s_load_dword s94, s[10:11], s75 offset:0x800c0
    s_load_dword s94, s[10:11], s75 offset:0x80100
    s_load_dword s94, s[10:11], s75 offset:0x80140
    s_waitcnt vmcnt(17)
    s_barrier
    s_add_u32 m0, s79, 118784
    s_mov_b32 s78, 33408
    buffer_load_dwordx4 v20, s[36:39], s78 offen sc1 lds
    v_fmac_f32 v132, v32, v76
    v_fmac_f32 v133, v33, v76
    v_fmac_f32 v134, v34, v76
    v_fmac_f32 v135, v35, v76
    v_fmac_f32 v148, v36, v76
    v_fmac_f32 v149, v37, v76
    v_fmac_f32 v150, v38, v76
    v_fmac_f32 v151, v39, v76
    s_add_u32 m0, s79, 119808
    s_nop 0
    buffer_load_dwordx4 v21, s[36:39], s78 offen sc1 lds
    v_mul_f32 v80, v132, v132
    v_mul_f32 v81, v133, v133
    v_mul_f32 v82, v134, v134
    v_mul_f32 v83, v135, v135
    v_fma_f32 v80, v80, v78, v77
    v_fma_f32 v81, v81, v78, v77
    v_fma_f32 v82, v82, v78, v77
    v_fma_f32 v83, v83, v78, v77
    s_add_u32 m0, s81, 133120
    s_mov_b32 s78, 640
    s_mov_b64 exec, 0xffffffff
    buffer_load_dwordx4 v3, s[36:39], s78 offen sc1 lds
    s_mov_b64 exec, -1
    v_mul_f32 v80, v80, v132
    v_mul_f32 v81, v81, v133
    v_mul_f32 v82, v82, v134
    v_mul_f32 v83, v83, v135
    v_exp_f32 v80, v80
    v_mul_f32 v132, v132, v148
    v_exp_f32 v81, v81
    s_add_u32 m0, s33, 57344
    s_mov_b32 s76, 1966080
    buffer_load_dwordx4 v23, s[40:43], s76 offen offset:0 lds
    s_add_u32 m0, s33, 59392
    s_nop 0
    buffer_load_dwordx4 v23, s[40:43], s76 offen offset:2048 lds
    v_mul_f32 v133, v133, v149
    v_exp_f32 v82, v82
    v_mul_f32 v134, v134, v150
    v_exp_f32 v83, v83
    v_mul_f32 v135, v135, v151
    v_fma_f32 v80, v80, v79, v79
    s_add_u32 m0, s33, 65536
    s_nop 0
    buffer_load_dwordx4 v23, s[44:47], s76 offen offset:0 lds
    v_fma_f32 v81, v81, v79, v79
    v_fma_f32 v82, v82, v79, v79
    v_fma_f32 v83, v83, v79, v79
    v_rcp_f32 v80, v80
    v_rcp_f32 v81, v81
    v_rcp_f32 v82, v82
    s_add_u32 m0, s33, 69632
    s_mov_b32 s77, 2293760
    buffer_load_dwordx4 v22, s[48:51], s77 offen offset:0 lds
    v_rcp_f32 v83, v83
    s_nop 0
    v_mul_f32 v132, v132, v80
    v_mul_f32 v133, v133, v81
    v_mul_f32 v134, v134, v82
    v_mul_f32 v135, v135, v83
    v_cvt_pk_bf16_f32 v130, v132, v133
    v_cvt_pk_bf16_f32 v131, v134, v135
    s_add_u32 m0, s33, 73728
    s_nop 0
    buffer_load_dwordx4 v22, s[52:55], s77 offen offset:0 lds
    s_load_dword s94, s[10:11], s75 offset:0x80180
    s_load_dword s94, s[10:11], s75 offset:0x801c0
    s_add_u32 s75, s75, 0x100000
    s_load_dword s94, s[10:11], s75 offset:0x0
    s_load_dword s94, s[10:11], s75 offset:0x40
    s_load_dword s94, s[10:11], s75 offset:0x80
    s_waitcnt vmcnt(16)
    s_barrier
    s_add_u32 m0, s79, 135168
    s_mov_b32 s78, 768
    buffer_load_dwordx4 v20, s[36:39], s78 offen sc1 lds
    s_nop 1
    v_permlane16_swap_b32 v128, v130
    v_permlane16_swap_b32 v129, v131
    v_fmac_f32 v152, v40, v64
    v_fmac_f32 v153, v41, v64
    v_fmac_f32 v154, v42, v64
    v_fmac_f32 v155, v43, v64
    v_fmac_f32 v168, v44, v64
    v_fmac_f32 v169, v45, v64
    v_fmac_f32 v170, v46, v64
    v_fmac_f32 v171, v47, v64
    s_add_u32 m0, s79, 136192
    s_nop 0
    buffer_load_dwordx4 v21, s[36:39], s78 offen sc1 lds
    v_mul_f32 v80, v152, v152
    v_mul_f32 v81, v153, v153
    v_mul_f32 v82, v154, v154
    v_mul_f32 v83, v155, v155
    v_fma_f32 v80, v80, v66, v65
    v_fma_f32 v81, v81, v66, v65
    v_fma_f32 v82, v82, v66, v65
    v_fma_f32 v83, v83, v66, v65
    s_add_u32 m0, s33, 77824
    s_mov_b32 s76, 2162688
    buffer_load_dwordx4 v23, s[40:43], s76 offen offset:0 lds
    v_mul_f32 v80, v80, v152
    v_mul_f32 v81, v81, v153
    v_mul_f32 v82, v82, v154
    v_mul_f32 v83, v83, v155
    v_exp_f32 v80, v80
    v_mul_f32 v152, v152, v168
    v_exp_f32 v81, v81
    s_add_u32 m0, s33, 79872
    s_nop 0
    buffer_load_dwordx4 v23, s[40:43], s76 offen offset:2048 lds
    s_add_u32 m0, s33, 86016
    s_nop 0
    buffer_load_dwordx4 v23, s[44:47], s76 offen offset:0 lds
    v_mul_f32 v153, v153, v169
    v_exp_f32 v82, v82
    v_mul_f32 v154, v154, v170
    v_exp_f32 v83, v83
    v_mul_f32 v155, v155, v171
    v_fma_f32 v80, v80, v67, v67
    s_add_u32 m0, s33, 90112
    s_mov_b32 s77, 2523136
    buffer_load_dwordx4 v22, s[48:51], s77 offen offset:0 lds
    v_fma_f32 v81, v81, v67, v67
    v_fma_f32 v82, v82, v67, v67
    v_fma_f32 v83, v83, v67, v67
    v_rcp_f32 v80, v80
    v_rcp_f32 v81, v81
    v_rcp_f32 v82, v82
    s_add_u32 m0, s33, 94208
    s_nop 0
    buffer_load_dwordx4 v22, s[52:55], s77 offen offset:0 lds
    v_rcp_f32 v83, v83
    s_nop 0
    v_mul_f32 v152, v152, v80
    v_mul_f32 v153, v153, v81
    v_mul_f32 v154, v154, v82
    v_mul_f32 v155, v155, v83
    v_cvt_pk_bf16_f32 v152, v152, v153
    v_cvt_pk_bf16_f32 v153, v154, v155
    buffer_store_dwordx4 v[128:131], v19, s[68:71], s72 offen offset:2560 sc1
    s_load_dword s94, s[10:11], s75 offset:0xc0
    s_load_dword s94, s[10:11], s75 offset:0x100
    s_load_dword s94, s[10:11], s75 offset:0x140
    s_load_dword s94, s[10:11], s75 offset:0x180
    s_load_dword s94, s[10:11], s75 offset:0x1c0
    s_waitcnt vmcnt(56)
    s_movk_i32 s98, 0x4000
L_tokA_chk:
    v_readfirstlane_b32 s100, v6
    v_readfirstlane_b32 s101, v7
    s_nop 1
    s_cmp_lg_u32 s100, 0
    s_cbranch_scc1 L_tokA_ok
    s_sub_u32 s98, s98, 1
    s_cbranch_scc1 L_tokA_ok
    s_sleep 1
    global_load_dwordx2 v[6:7], v5, s[24:25] sc1
    s_waitcnt vmcnt(0)
    s_branch L_tokA_chk
L_tokA_ok:
    s_waitcnt vmcnt(17)
    s_barrier
    s_add_u32 m0, s79, 137216
    s_mov_b32 s78, 33536
    buffer_load_dwordx4 v20, s[36:39], s78 offen sc1 lds
    v_fmac_f32 v156, v40, v68
    v_fmac_f32 v157, v41, v68
    v_fmac_f32 v158, v42, v68
    v_fmac_f32 v159, v43, v68
    v_fmac_f32 v172, v44, v68
    v_fmac_f32 v173, v45, v68
    v_fmac_f32 v174, v46, v68
    v_fmac_f32 v175, v47, v68
    s_add_u32 m0, s79, 138240
    s_nop 0
    buffer_load_dwordx4 v21, s[36:39], s78 offen sc1 lds
    v_mul_f32 v80, v156, v156
    v_mul_f32 v81, v157, v157
    v_mul_f32 v82, v158, v158
    v_mul_f32 v83, v159, v159
    v_fma_f32 v80, v80, v70, v69
    v_fma_f32 v81, v81, v70, v69
    v_fma_f32 v82, v82, v70, v69
    v_fma_f32 v83, v83, v70, v69
    s_add_u32 m0, s81, 151552
    s_mov_b32 s78, 768
    s_mov_b64 exec, 0xffffffff
    buffer_load_dwordx4 v3, s[36:39], s78 offen sc1 lds
    s_mov_b64 exec, -1
    v_mul_f32 v80, v80, v156
    v_mul_f32 v81, v81, v157
    v_mul_f32 v82, v82, v158
    v_mul_f32 v83, v83, v159
    v_exp_f32 v80, v80
    v_mul_f32 v156, v156, v172
    v_exp_f32 v81, v81
    s_add_u32 m0, s33, 16384
    s_mov_b32 s76, 2359296
    buffer_load_dwordx4 v23, s[40:43], s76 offen offset:0 lds
    s_add_u32 m0, s33, 18432
    s_nop 0
    buffer_load_dwordx4 v23, s[40:43], s76 offen offset:2048 lds
    v_mul_f32 v157, v157, v173
    v_exp_f32 v82, v82
    v_mul_f32 v158, v158, v174
    v_exp_f32 v83, v83
    v_mul_f32 v159, v159, v175
    v_fma_f32 v80, v80, v71, v71
    s_add_u32 m0, s33, 24576
    s_nop 0
    buffer_load_dwordx4 v23, s[44:47], s76 offen offset:0 lds
    v_fma_f32 v81, v81, v71, v71
    v_fma_f32 v82, v82, v71, v71
    v_fma_f32 v83, v83, v71, v71
    v_rcp_f32 v80, v80
    v_rcp_f32 v81, v81
    v_rcp_f32 v82, v82
    s_add_u32 m0, s33, 28672
    s_mov_b32 s77, 2752512
    buffer_load_dwordx4 v22, s[48:51], s77 offen offset:0 lds
    v_rcp_f32 v83, v83
    s_nop 0
    v_mul_f32 v156, v156, v80
    v_mul_f32 v157, v157, v81
    v_mul_f32 v158, v158, v82
    v_mul_f32 v159, v159, v83
    v_cvt_pk_bf16_f32 v154, v156, v157
    v_cvt_pk_bf16_f32 v155, v158, v159
    s_add_u32 m0, s33, 32768
    s_nop 0
    buffer_load_dwordx4 v22, s[52:55], s77 offen offset:0 lds
    s_load_dword s94, s[10:11], s75 offset:0x80000
    s_load_dword s94, s[10:11], s75 offset:0x80040
    s_load_dword s94, s[10:11], s75 offset:0x80080
    s_load_dword s94, s[10:11], s75 offset:0x800c0
    s_load_dword s94, s[10:11], s75 offset:0x80100
    s_waitcnt vmcnt(16)
    s_barrier
    s_add_u32 m0, s79, 98304
    s_mov_b32 s78, 896
    buffer_load_dwordx4 v20, s[36:39], s78 offen sc1 lds
    s_nop 1
    v_permlane16_swap_b32 v152, v154
    v_permlane16_swap_b32 v153, v155
    v_fmac_f32 v160, v40, v72
    v_fmac_f32 v161, v41, v72
    v_fmac_f32 v162, v42, v72
    v_fmac_f32 v163, v43, v72
    v_fmac_f32 v176, v44, v72
    v_fmac_f32 v177, v45, v72
    v_fmac_f32 v178, v46, v72
    v_fmac_f32 v179, v47, v72
    s_add_u32 m0, s79, 99328
    s_nop 0
    buffer_load_dwordx4 v21, s[36:39], s78 offen sc1 lds
    v_mul_f32 v80, v160, v160
    v_mul_f32 v81, v161, v161
    v_mul_f32 v82, v162, v162
    v_mul_f32 v83, v163, v163
    v_fma_f32 v80, v80, v74, v73
    v_fma_f32 v81, v81, v74, v73
    v_fma_f32 v82, v82, v74, v73
    v_fma_f32 v83, v83, v74, v73
    s_add_u32 m0, s33, 36864
    s_mov_b32 s76, 2555904
    buffer_load_dwordx4 v23, s[40:43], s76 offen offset:0 lds
    v_mul_f32 v80, v80, v160
    v_mul_f32 v81, v81, v161
    v_mul_f32 v82, v82, v162
    v_mul_f32 v83, v83, v163
    v_exp_f32 v80, v80
    v_mul_f32 v160, v160, v176
    v_exp_f32 v81, v81
    s_add_u32 m0, s33, 38912
    s_nop 0
    buffer_load_dwordx4 v23, s[40:43], s76 offen offset:2048 lds
    s_add_u32 m0, s33, 45056
    s_nop 0
    buffer_load_dwordx4 v23, s[44:47], s76 offen offset:0 lds
    v_mul_f32 v161, v161, v177
    v_exp_f32 v82, v82
    v_mul_f32 v162, v162, v178
    v_exp_f32 v83, v83
    v_mul_f32 v163, v163, v179
    v_fma_f32 v80, v80, v75, v75
    s_add_u32 m0, s33, 49152
    s_mov_b32 s77, 2981888
    buffer_load_dwordx4 v22, s[48:51], s77 offen offset:0 lds
    v_fma_f32 v81, v81, v75, v75
    v_fma_f32 v82, v82, v75, v75
    v_fma_f32 v83, v83, v75, v75
    v_rcp_f32 v80, v80
    v_rcp_f32 v81, v81
    v_rcp_f32 v82, v82
    s_add_u32 m0, s33, 53248
    s_nop 0
    buffer_load_dwordx4 v22, s[52:55], s77 offen offset:0 lds
    v_rcp_f32 v83, v83
    s_nop 0
    v_mul_f32 v160, v160, v80
    v_mul_f32 v161, v161, v81
    v_mul_f32 v162, v162, v82
    v_mul_f32 v163, v163, v83
    v_cvt_pk_bf16_f32 v160, v160, v161
    v_cvt_pk_bf16_f32 v161, v162, v163
    buffer_store_dwordx4 v[152:155], v19, s[68:71], s73 offen offset:0 sc1
    s_load_dword s94, s[10:11], s75 offset:0x80140
    s_load_dword s94, s[10:11], s75 offset:0x80180
    s_load_dword s94, s[10:11], s75 offset:0x801c0
    s_add_u32 s99, s99, 0x1c0000
    s_load_dword s94, s[16:17], s99 offset:0x0
    s_load_dword s94, s[16:17], s99 offset:0x40
    s_waitcnt vmcnt(17)
    s_barrier
    s_add_u32 m0, s79, 100352
    s_mov_b32 s78, 33664
    buffer_load_dwordx4 v20, s[36:39], s78 offen sc1 lds
    v_fmac_f32 v164, v40, v76
    v_fmac_f32 v165, v41, v76
    v_fmac_f32 v166, v42, v76
    v_fmac_f32 v167, v43, v76
    v_fmac_f32 v180, v44, v76
    v_fmac_f32 v181, v45, v76
    v_fmac_f32 v182, v46, v76
    v_fmac_f32 v183, v47, v76
    s_add_u32 m0, s79, 101376
    s_nop 0
    buffer_load_dwordx4 v21, s[36:39], s78 offen sc1 lds
    v_mul_f32 v80, v164, v164
    v_mul_f32 v81, v165, v165
    v_mul_f32 v82, v166, v166
    v_mul_f32 v83, v167, v167
    v_fma_f32 v80, v80, v78, v77
    v_fma_f32 v81, v81, v78, v77
    v_fma_f32 v82, v82, v78, v77
    v_fma_f32 v83, v83, v78, v77
    s_add_u32 m0, s81, 114688
    s_mov_b32 s78, 896
    s_mov_b64 exec, 0xffffffff
    buffer_load_dwordx4 v3, s[36:39], s78 offen sc1 lds
    s_mov_b64 exec, -1
    v_mul_f32 v80, v80, v164
    v_mul_f32 v81, v81, v165
    v_mul_f32 v82, v82, v166
    v_mul_f32 v83, v83, v167
    v_exp_f32 v80, v80
    v_mul_f32 v164, v164, v180
    v_exp_f32 v81, v81
    s_add_u32 m0, s33, 57344
    s_mov_b32 s76, 2752512
    buffer_load_dwordx4 v23, s[40:43], s76 offen offset:0 lds
    s_add_u32 m0, s33, 59392
    s_nop 0
    buffer_load_dwordx4 v23, s[40:43], s76 offen offset:2048 lds
    v_mul_f32 v165, v165, v181
    v_exp_f32 v82, v82
    v_mul_f32 v166, v166, v182
    v_exp_f32 v83, v83
    v_mul_f32 v167, v167, v183
    v_fma_f32 v80, v80, v79, v79
    s_add_u32 m0, s33, 65536
    s_nop 0
    buffer_load_dwordx4 v23, s[44:47], s76 offen offset:0 lds
    v_fma_f32 v81, v81, v79, v79
    v_fma_f32 v82, v82, v79, v79
    v_fma_f32 v83, v83, v79, v79
    v_rcp_f32 v80, v80
    v_rcp_f32 v81, v81
    v_rcp_f32 v82, v82
    s_add_u32 m0, s33, 69632
    s_mov_b32 s77, 3211264
    buffer_load_dwordx4 v22, s[48:51], s77 offen offset:0 lds
    v_rcp_f32 v83, v83
    s_nop 0
    v_mul_f32 v164, v164, v80
    v_mul_f32 v165, v165, v81
    v_mul_f32 v166, v166, v82
    v_mul_f32 v167, v167, v83
    v_cvt_pk_bf16_f32 v162, v164, v165
    v_cvt_pk_bf16_f32 v163, v166, v167
    s_add_u32 m0, s33, 73728
    s_nop 0
    buffer_load_dwordx4 v22, s[52:55], s77 offen offset:0 lds
    s_load_dword s94, s[16:17], s99 offset:0x80
    s_load_dword s94, s[16:17], s99 offset:0xc0
    s_load_dword s94, s[16:17], s99 offset:0x100
    s_load_dword s94, s[16:17], s99 offset:0x140
    s_load_dword s94, s[16:17], s99 offset:0x180
    s_waitcnt vmcnt(16)
    s_barrier
    s_add_u32 m0, s79, 116736
    s_mov_b32 s78, 1024
    buffer_load_dwordx4 v20, s[36:39], s78 offen sc1 lds
    s_nop 1
    v_permlane16_swap_b32 v160, v162
    v_permlane16_swap_b32 v161, v163
    v_fmac_f32 v184, v48, v64
    v_fmac_f32 v185, v49, v64
    v_fmac_f32 v186, v50, v64
    v_fmac_f32 v187, v51, v64
    v_fmac_f32 v200, v52, v64
    v_fmac_f32 v201, v53, v64
    v_fmac_f32 v202, v54, v64
    v_fmac_f32 v203, v55, v64
    s_add_u32 m0, s79, 117760
    s_nop 0
    buffer_load_dwordx4 v21, s[36:39], s78 offen sc1 lds
    v_mul_f32 v80, v184, v184
    v_mul_f32 v81, v185, v185
    v_mul_f32 v82, v186, v186
    v_mul_f32 v83, v187, v187
    v_fma_f32 v80, v80, v66, v65
    v_fma_f32 v81, v81, v66, v65
    v_fma_f32 v82, v82, v66, v65
    v_fma_f32 v83, v83, v66, v65
    s_add_u32 m0, s33, 77824
    s_mov_b32 s76, 2949120
    buffer_load_dwordx4 v23, s[40:43], s76 offen offset:0 lds
    v_mul_f32 v80, v80, v184
    v_mul_f32 v81, v81, v185
    v_mul_f32 v82, v82, v186
    v_mul_f32 v83, v83, v187
    v_exp_f32 v80, v80
    v_mul_f32 v184, v184, v200
    v_exp_f32 v81, v81
    s_add_u32 m0, s33, 79872
    s_nop 0
    buffer_load_dwordx4 v23, s[40:43], s76 offen offset:2048 lds
    s_add_u32 m0, s33, 86016
    s_nop 0
    buffer_load_dwordx4 v23, s[44:47], s76 offen offset:0 lds
    v_mul_f32 v185, v185, v201
    v_exp_f32 v82, v82
    v_mul_f32 v186, v186, v202
    v_exp_f32 v83, v83
    v_mul_f32 v187, v187, v203
    v_fma_f32 v80, v80, v67, v67
    s_add_u32 m0, s33, 90112
    s_mov_b32 s77, 3440640
    buffer_load_dwordx4 v22, s[48:51], s77 offen offset:0 lds
    v_fma_f32 v81, v81, v67, v67
    v_fma_f32 v82, v82, v67, v67
    v_fma_f32 v83, v83, v67, v67
    v_rcp_f32 v80, v80
    v_rcp_f32 v81, v81
    v_rcp_f32 v82, v82
    s_add_u32 m0, s33, 94208
    s_nop 0
    buffer_load_dwordx4 v22, s[52:55], s77 offen offset:0 lds
    v_rcp_f32 v83, v83
    s_nop 0
    v_mul_f32 v184, v184, v80
    v_mul_f32 v185, v185, v81
    v_mul_f32 v186, v186, v82
    v_mul_f32 v187, v187, v83
    v_cvt_pk_bf16_f32 v184, v184, v185
    v_cvt_pk_bf16_f32 v185, v186, v187
    buffer_store_dwordx4 v[160:163], v19, s[68:71], s73 offen offset:2048 sc1
    s_load_dword s94, s[16:17], s99 offset:0x1c0
    s_load_dword s94, s[18:19], s99 offset:0x0
    s_load_dword s94, s[18:19], s99 offset:0x40
    s_load_dword s94, s[18:19], s99 offset:0x80
    s_load_dword s94, s[18:19], s99 offset:0xc0
    s_waitcnt vmcnt(17)
    s_barrier
    s_add_u32 m0, s79, 118784
    s_mov_b32 s78, 33792
    buffer_load_dwordx4 v20, s[36:39], s78 offen sc1 lds
    v_fmac_f32 v188, v48, v68
    v_fmac_f32 v189, v49, v68
    v_fmac_f32 v190, v50, v68
    v_fmac_f32 v191, v51, v68
    v_fmac_f32 v204, v52, v68
    v_fmac_f32 v205, v53, v68
    v_fmac_f32 v206, v54, v68
    v_fmac_f32 v207, v55, v68
    s_add_u32 m0, s79, 119808
    s_nop 0
    buffer_load_dwordx4 v21, s[36:39], s78 offen sc1 lds
    v_mul_f32 v80, v188, v188
    v_mul_f32 v81, v189, v189
    v_mul_f32 v82, v190, v190
    v_mul_f32 v83, v191, v191
    v_fma_f32 v80, v80, v70, v69
    v_fma_f32 v81, v81, v70, v69
    v_fma_f32 v82, v82, v70, v69
    v_fma_f32 v83, v83, v70, v69
    s_add_u32 m0, s81, 133120
    s_mov_b32 s78, 1024
    s_mov_b64 exec, 0xffffffff
    buffer_load_dwordx4 v3, s[36:39], s78 offen sc1 lds
    s_mov_b64 exec, -1
    v_mul_f32 v80, v80, v188
    v_mul_f32 v81, v81, v189
    v_mul_f32 v82, v82, v190
    v_mul_f32 v83, v83, v191
    v_exp_f32 v80, v80
    v_mul_f32 v188, v188, v204
    v_exp_f32 v81, v81
    s_add_u32 m0, s33, 16384
    s_mov_b32 s76, 3145728
    buffer_load_dwordx4 v23, s[40:43], s76 offen offset:0 lds
    s_add_u32 m0, s33, 18432
    s_nop 0
    buffer_load_dwordx4 v23, s[40:43], s76 offen offset:2048 lds
    v_mul_f32 v189, v189, v205
    v_exp_f32 v82, v82
    v_mul_f32 v190, v190, v206
    v_exp_f32 v83, v83
    v_mul_f32 v191, v191, v207
    v_fma_f32 v80, v80, v71, v71
    s_add_u32 m0, s33, 24576
    s_nop 0
    buffer_load_dwordx4 v23, s[44:47], s76 offen offset:0 lds
    v_fma_f32 v81, v81, v71, v71
    v_fma_f32 v82, v82, v71, v71
    v_fma_f32 v83, v83, v71, v71
    v_rcp_f32 v80, v80
    v_rcp_f32 v81, v81
    v_rcp_f32 v82, v82
    s_add_u32 m0, s33, 28672
    s_mov_b32 s77, 3670016
    buffer_load_dwordx4 v22, s[48:51], s77 offen offset:0 lds
    v_rcp_f32 v83, v83
    s_nop 0
    v_mul_f32 v188, v188, v80
    v_mul_f32 v189, v189, v81
    v_mul_f32 v190, v190, v82
    v_mul_f32 v191, v191, v83
    v_cvt_pk_bf16_f32 v186, v188, v189
    v_cvt_pk_bf16_f32 v187, v190, v191
    s_add_u32 m0, s33, 32768
    s_nop 0
    buffer_load_dwordx4 v22, s[52:55], s77 offen offset:0 lds
    s_load_dword s94, s[18:19], s99 offset:0x100
    s_load_dword s94, s[18:19], s99 offset:0x140
    s_load_dword s94, s[18:19], s99 offset:0x180
    s_load_dword s94, s[18:19], s99 offset:0x1c0
    s_add_u32 s75, s75, 0x100000
    s_load_dword s94, s[10:11], s75 offset:0x0
    s_waitcnt vmcnt(16)
    s_barrier
    s_add_u32 m0, s79, 135168
L_pad2:
    s_cbranch_execz L_vret1
    s_mov_b32 s78, 1152
    buffer_load_dwordx4 v20, s[36:39], s78 offen sc1 lds
    s_nop 1
    v_permlane16_swap_b32 v184, v186
    v_permlane16_swap_b32 v185, v187
    v_fmac_f32 v192, v48, v72
    v_fmac_f32 v193, v49, v72
    v_fmac_f32 v194, v50, v72
    v_fmac_f32 v195, v51, v72
    v_fmac_f32 v208, v52, v72
    v_fmac_f32 v209, v53, v72
    v_fmac_f32 v210, v54, v72
    v_fmac_f32 v211, v55, v72
    s_add_u32 m0, s79, 136192
    s_nop 0
    buffer_load_dwordx4 v21, s[36:39], s78 offen sc1 lds
    v_mul_f32 v80, v192, v192
    v_mul_f32 v81, v193, v193
    v_mul_f32 v82, v194, v194
    v_mul_f32 v83, v195, v195
    v_fma_f32 v80, v80, v74, v73
    v_fma_f32 v81, v81, v74, v73
    v_fma_f32 v82, v82, v74, v73
    v_fma_f32 v83, v83, v74, v73
    s_add_u32 m0, s33, 36864
    s_mov_b32 s76, 3342336
    buffer_load_dwordx4 v23, s[40:43], s76 offen offset:0 lds
    v_mul_f32 v80, v80, v192
    v_mul_f32 v81, v81, v193
    v_mul_f32 v82, v82, v194
    v_mul_f32 v83, v83, v195
    v_exp_f32 v80, v80
    v_mul_f32 v192, v192, v208
    v_exp_f32 v81, v81
    s_add_u32 m0, s33, 38912
    s_nop 0
    buffer_load_dwordx4 v23, s[40:43], s76 offen offset:2048 lds
    s_add_u32 m0, s33, 45056
    s_nop 0
    buffer_load_dwordx4 v23, s[44:47], s76 offen offset:0 lds
    v_mul_f32 v193, v193, v209
    v_exp_f32 v82, v82
    v_mul_f32 v194, v194, v210
    v_exp_f32 v83, v83
    v_mul_f32 v195, v195, v211
    v_fma_f32 v80, v80, v75, v75
    s_add_u32 m0, s33, 49152
    s_mov_b32 s77, 3899392
    buffer_load_dwordx4 v22, s[48:51], s77 offen offset:0 lds
    v_fma_f32 v81, v81, v75, v75
    v_fma_f32 v82, v82, v75, v75
    v_fma_f32 v83, v83, v75, v75
    v_rcp_f32 v80, v80
    v_rcp_f32 v81, v81
    v_rcp_f32 v82, v82
    s_add_u32 m0, s33, 53248
    s_nop 0
    buffer_load_dwordx4 v22, s[52:55], s77 offen offset:0 lds
    v_rcp_f32 v83, v83
    s_nop 0
    v_mul_f32 v192, v192, v80
    v_mul_f32 v193, v193, v81
    v_mul_f32 v194, v194, v82
    v_mul_f32 v195, v195, v83
    v_cvt_pk_bf16_f32 v192, v192, v193
    v_cvt_pk_bf16_f32 v193, v194, v195
    buffer_store_dwordx4 v[184:187], v19, s[68:71], s73 offen offset:512 sc1
    s_load_dword s94, s[10:11], s75 offset:0x40
    s_load_dword s94, s[10:11], s75 offset:0x80
    s_load_dword s94, s[10:11], s75 offset:0xc0
    s_load_dword s94, s[10:11], s75 offset:0x100
    s_load_dword s94, s[10:11], s75 offset:0x140
    s_waitcnt vmcnt(17)
    s_barrier
    s_add_u32 m0, s79, 137216
    s_mov_b32 s78, 33920
    buffer_load_dwordx4 v20, s[36:39], s78 offen sc1 lds
    v_fmac_f32 v196, v48, v76
    v_fmac_f32 v197, v49, v76
    v_fmac_f32 v198, v50, v76
    v_fmac_f32 v199, v51, v76
    v_fmac_f32 v212, v52, v76
    v_fmac_f32 v213, v53, v76
    v_fmac_f32 v214, v54, v76
    v_fmac_f32 v215, v55, v76
    s_add_u32 m0, s79, 138240
    s_nop 0
    buffer_load_dwordx4 v21, s[36:39], s78 offen sc1 lds
    v_mul_f32 v80, v196, v196
    v_mul_f32 v81, v197, v197
    v_mul_f32 v82, v198, v198
    v_mul_f32 v83, v199, v199
    v_fma_f32 v80, v80, v78, v77
    v_fma_f32 v81, v81, v78, v77
    v_fma_f32 v82, v82, v78, v77
    v_fma_f32 v83, v83, v78, v77
    s_add_u32 m0, s81, 151552
    s_mov_b32 s78, 1152
    s_mov_b64 exec, 0xffffffff
    buffer_load_dwordx4 v3, s[36:39], s78 offen sc1 lds
    s_mov_b64 exec, -1
    v_mul_f32 v80, v80, v196
    v_mul_f32 v81, v81, v197
    v_mul_f32 v82, v82, v198
    v_mul_f32 v83, v83, v199
    v_exp_f32 v80, v80
    v_mul_f32 v196, v196, v212
    v_exp_f32 v81, v81
    s_add_u32 m0, s33, 57344
    s_mov_b32 s76, 3538944
    buffer_load_dwordx4 v23, s[40:43], s76 offen offset:0 lds
    s_add_u32 m0, s33, 59392
    s_nop 0
    buffer_load_dwordx4 v23, s[40:43], s76 offen offset:2048 lds
    v_mul_f32 v197, v197, v213
    v_exp_f32 v82, v82
    v_mul_f32 v198, v198, v214
    v_exp_f32 v83, v83
    v_mul_f32 v199, v199, v215
    v_fma_f32 v80, v80, v79, v79
    s_add_u32 m0, s33, 65536
    s_nop 0
    buffer_load_dwordx4 v23, s[44:47], s76 offen offset:0 lds
    v_fma_f32 v81, v81, v79, v79
    v_fma_f32 v82, v82, v79, v79
    v_fma_f32 v83, v83, v79, v79
    v_rcp_f32 v80, v80
    v_rcp_f32 v81, v81
    v_rcp_f32 v82, v82
    s_add_u32 m0, s33, 69632
    s_mov_b32 s77, 4128768
    buffer_load_dwordx4 v22, s[48:51], s77 offen offset:0 lds
    v_rcp_f32 v83, v83
    s_nop 0
    v_mul_f32 v196, v196, v80
    v_mul_f32 v197, v197, v81
    v_mul_f32 v198, v198, v82
    v_mul_f32 v199, v199, v83
    v_cvt_pk_bf16_f32 v194, v196, v197
    v_cvt_pk_bf16_f32 v195, v198, v199
    s_add_u32 m0, s33, 73728
    s_nop 0
    buffer_load_dwordx4 v22, s[52:55], s77 offen offset:0 lds
    s_load_dword s94, s[10:11], s75 offset:0x180
    s_load_dword s94, s[10:11], s75 offset:0x1c0
    s_load_dword s94, s[10:11], s75 offset:0x80000
    s_load_dword s94, s[10:11], s75 offset:0x80040
    s_load_dword s94, s[10:11], s75 offset:0x80080
    s_waitcnt vmcnt(16)
    s_barrier
    s_add_u32 m0, s79, 98304
    s_mov_b32 s78, 1280
    buffer_load_dwordx4 v20, s[36:39], s78 offen sc1 lds
    s_nop 1
    v_permlane16_swap_b32 v192, v194
    v_permlane16_swap_b32 v193, v195
    v_fmac_f32 v216, v56, v64
    v_fmac_f32 v217, v57, v64
    v_fmac_f32 v218, v58, v64
    v_fmac_f32 v219, v59, v64
    v_fmac_f32 v232, v60, v64
    v_fmac_f32 v233, v61, v64
    v_fmac_f32 v234, v62, v64
    v_fmac_f32 v235, v63, v64
    s_add_u32 m0, s79, 99328
    s_nop 0
    buffer_load_dwordx4 v21, s[36:39], s78 offen sc1 lds
    v_mul_f32 v80, v216, v216
    v_mul_f32 v81, v217, v217
    v_mul_f32 v82, v218, v218
    v_mul_f32 v83, v219, v219
    v_fma_f32 v80, v80, v66, v65
    v_fma_f32 v81, v81, v66, v65
    v_fma_f32 v82, v82, v66, v65
    v_fma_f32 v83, v83, v66, v65
    s_add_u32 m0, s33, 77824
    s_mov_b32 s76, 3735552
    buffer_load_dwordx4 v23, s[40:43], s76 offen offset:0 lds
    v_mul_f32 v80, v80, v216
    v_mul_f32 v81, v81, v217
    v_mul_f32 v82, v82, v218
    v_mul_f32 v83, v83, v219
    v_exp_f32 v80, v80
    v_mul_f32 v216, v216, v232
    v_exp_f32 v81, v81
    s_add_u32 m0, s33, 79872
    s_nop 0
    buffer_load_dwordx4 v23, s[40:43], s76 offen offset:2048 lds
    s_add_u32 m0, s33, 86016
    s_nop 0
    buffer_load_dwordx4 v23, s[44:47], s76 offen offset:0 lds
    v_mul_f32 v217, v217, v233
    v_exp_f32 v82, v82
    v_mul_f32 v218, v218, v234
    v_exp_f32 v83, v83
    v_mul_f32 v219, v219, v235
    v_fma_f32 v80, v80, v67, v67
    s_add_u32 m0, s33, 90112
    s_mov_b32 s77, 4358144
    buffer_load_dwordx4 v22, s[48:51], s77 offen offset:0 lds
    v_fma_f32 v81, v81, v67, v67
    v_fma_f32 v82, v82, v67, v67
    v_fma_f32 v83, v83, v67, v67
    v_rcp_f32 v80, v80
    v_rcp_f32 v81, v81
    v_rcp_f32 v82, v82
    s_add_u32 m0, s33, 94208
    s_nop 0
    buffer_load_dwordx4 v22, s[52:55], s77 offen offset:0 lds
    v_rcp_f32 v83, v83
    s_nop 0
    v_mul_f32 v216, v216, v80
    v_mul_f32 v217, v217, v81
    v_mul_f32 v218, v218, v82
    v_mul_f32 v219, v219, v83
    v_cvt_pk_bf16_f32 v216, v216, v217
    v_cvt_pk_bf16_f32 v217, v218, v219
    buffer_store_dwordx4 v[192:195], v19, s[68:71], s73 offen offset:2560 sc1
    s_load_dword s94, s[10:11], s75 offset:0x800c0
    s_load_dword s94, s[10:11], s75 offset:0x80100
    s_load_dword s94, s[10:11], s75 offset:0x80140
    s_load_dword s94, s[10:11], s75 offset:0x80180
    s_load_dword s94, s[10:11], s75 offset:0x801c0
    s_waitcnt vmcnt(17)
    s_barrier
    s_add_u32 m0, s79, 100352
    s_mov_b32 s78, 34048
    buffer_load_dwordx4 v20, s[36:39], s78 offen sc1 lds
    v_fmac_f32 v220, v56, v68
    v_fmac_f32 v221, v57, v68
    v_fmac_f32 v222, v58, v68
    v_fmac_f32 v223, v59, v68
    v_fmac_f32 v236, v60, v68
    v_fmac_f32 v237, v61, v68
    v_fmac_f32 v238, v62, v68
    v_fmac_f32 v239, v63, v68
    s_add_u32 m0, s79, 101376
    s_nop 0
    buffer_load_dwordx4 v21, s[36:39], s78 offen sc1 lds
    v_mul_f32 v80, v220, v220
    v_mul_f32 v81, v221, v221
    v_mul_f32 v82, v222, v222
    v_mul_f32 v83, v223, v223
    v_fma_f32 v80, v80, v70, v69
    v_fma_f32 v81, v81, v70, v69
    v_fma_f32 v82, v82, v70, v69
    v_fma_f32 v83, v83, v70, v69
    s_add_u32 m0, s81, 114688
    s_mov_b32 s78, 1280
    s_mov_b64 exec, 0xffffffff
    buffer_load_dwordx4 v3, s[36:39], s78 offen sc1 lds
    s_mov_b64 exec, -1
    v_mul_f32 v80, v80, v220
    v_mul_f32 v81, v81, v221
    v_mul_f32 v82, v82, v222
    v_mul_f32 v83, v83, v223
    v_exp_f32 v80, v80
    v_mul_f32 v220, v220, v236
    v_exp_f32 v81, v81
    s_add_u32 m0, s33, 16384
    s_mov_b32 s76, 3932160
    buffer_load_dwordx4 v23, s[40:43], s76 offen offset:0 lds
    s_add_u32 m0, s33, 18432
    s_nop 0
    buffer_load_dwordx4 v23, s[40:43], s76 offen offset:2048 lds
    v_mul_f32 v221, v221, v237
    v_exp_f32 v82, v82
    v_mul_f32 v222, v222, v238
    v_exp_f32 v83, v83
    v_mul_f32 v223, v223, v239
    v_fma_f32 v80, v80, v71, v71
    s_add_u32 m0, s33, 24576
    s_nop 0
    buffer_load_dwordx4 v23, s[44:47], s76 offen offset:0 lds
    v_fma_f32 v81, v81, v71, v71
    v_fma_f32 v82, v82, v71, v71
    v_fma_f32 v83, v83, v71, v71
    v_rcp_f32 v80, v80
    v_rcp_f32 v81, v81
    v_rcp_f32 v82, v82
    s_add_u32 m0, s33, 28672
    s_mov_b32 s77, 4587520
    buffer_load_dwordx4 v22, s[48:51], s77 offen offset:0 lds
    v_rcp_f32 v83, v83
    s_nop 0
    v_mul_f32 v220, v220, v80
    v_mul_f32 v221, v221, v81
    v_mul_f32 v222, v222, v82
    v_mul_f32 v223, v223, v83
    v_cvt_pk_bf16_f32 v218, v220, v221
    v_cvt_pk_bf16_f32 v219, v222, v223
    s_add_u32 m0, s33, 32768
    s_nop 0
    buffer_load_dwordx4 v22, s[52:55], s77 offen offset:0 lds
    s_add_u32 s75, s75, 0xffb00000
    s_load_dword s94, s[20:21], s75 offset:0x0
    s_load_dword s94, s[20:21], s75 offset:0x40
    s_load_dword s94, s[20:21], s75 offset:0x80
    s_load_dword s94, s[20:21], s75 offset:0xc0
    s_load_dword s94, s[20:21], s75 offset:0x100
    s_waitcnt vmcnt(16)
    s_barrier
    s_add_u32 m0, s79, 116736
    s_mov_b32 s78, 1408
    buffer_load_dwordx4 v20, s[36:39], s78 offen sc1 lds
    s_nop 1
    v_permlane16_swap_b32 v216, v218
    v_permlane16_swap_b32 v217, v219
    v_fmac_f32 v224, v56, v72
    v_fmac_f32 v225, v57, v72
    v_fmac_f32 v226, v58, v72
    v_fmac_f32 v227, v59, v72
    v_fmac_f32 v240, v60, v72
    v_fmac_f32 v241, v61, v72
    v_fmac_f32 v242, v62, v72
    v_fmac_f32 v243, v63, v72
    s_add_u32 m0, s79, 117760
    s_nop 0
    buffer_load_dwordx4 v21, s[36:39], s78 offen sc1 lds
    v_mul_f32 v80, v224, v224
    v_mul_f32 v81, v225, v225
    v_mul_f32 v82, v226, v226
    v_mul_f32 v83, v227, v227
    v_fma_f32 v80, v80, v74, v73
    v_fma_f32 v81, v81, v74, v73
    v_fma_f32 v82, v82, v74, v73
    v_fma_f32 v83, v83, v74, v73
    s_add_u32 m0, s33, 36864
    s_mov_b32 s76, 4128768
    buffer_load_dwordx4 v23, s[40:43], s76 offen offset:0 lds
    v_mul_f32 v80, v80, v224
    v_mul_f32 v81, v81, v225
    v_mul_f32 v82, v82, v226
    v_mul_f32 v83, v83, v227
    v_exp_f32 v80, v80
    v_mul_f32 v224, v224, v240
    v_exp_f32 v81, v81
    s_add_u32 m0, s33, 38912
    s_nop 0
    buffer_load_dwordx4 v23, s[40:43], s76 offen offset:2048 lds
    s_add_u32 m0, s33, 45056
    s_nop 0
    buffer_load_dwordx4 v23, s[44:47], s76 offen offset:0 lds
    v_mul_f32 v225, v225, v241
    v_exp_f32 v82, v82
    v_mul_f32 v226, v226, v242
    v_exp_f32 v83, v83
    v_mul_f32 v227, v227, v243
    v_fma_f32 v80, v80, v75, v75
    s_add_u32 m0, s33, 49152
    s_mov_b32 s77, 4816896
    buffer_load_dwordx4 v22, s[48:51], s77 offen offset:0 lds
    v_fma_f32 v81, v81, v75, v75
    v_fma_f32 v82, v82, v75, v75
    v_fma_f32 v83, v83, v75, v75
    v_rcp_f32 v80, v80
    v_rcp_f32 v81, v81
    v_rcp_f32 v82, v82
    s_add_u32 m0, s33, 53248
    s_nop 0
    buffer_load_dwordx4 v22, s[52:55], s77 offen offset:0 lds
    v_rcp_f32 v83, v83
    s_nop 0
    v_mul_f32 v224, v224, v80
    v_mul_f32 v225, v225, v81
    v_mul_f32 v226, v226, v82
    v_mul_f32 v227, v227, v83
    v_cvt_pk_bf16_f32 v224, v224, v225
    v_cvt_pk_bf16_f32 v225, v226, v227
    buffer_store_dwordx4 v[216:219], v19, s[68:71], s74 offen offset:0 sc1
    s_load_dword s94, s[20:21], s75 offset:0x140
    s_load_dword s94, s[20:21], s75 offset:0x180
    s_load_dword s94, s[20:21], s75 offset:0x1c0
    s_add_u32 s75, s75, 0x280000
    s_load_dword s94, s[20:21], s75 offset:0x0
    s_load_dword s94, s[20:21], s75 offset:0x40
    s_waitcnt vmcnt(17)
    s_barrier
    s_add_u32 m0, s79, 118784
    s_mov_b32 s78, 34176
    buffer_load_dwordx4 v20, s[36:39], s78 offen sc1 lds
    v_fmac_f32 v228, v56, v76
    v_fmac_f32 v229, v57, v76
    v_fmac_f32 v230, v58, v76
    v_fmac_f32 v231, v59, v76
    v_fmac_f32 v244, v60, v76
    v_fmac_f32 v245, v61, v76
    v_fmac_f32 v246, v62, v76
    v_fmac_f32 v247, v63, v76
    s_add_u32 m0, s79, 119808
    s_nop 0
    buffer_load_dwordx4 v21, s[36:39], s78 offen sc1 lds
    v_mul_f32 v80, v228, v228
    v_mul_f32 v81, v229, v229
    v_mul_f32 v82, v230, v230
    v_mul_f32 v83, v231, v231
    v_fma_f32 v80, v80, v78, v77
    v_fma_f32 v81, v81, v78, v77
    v_fma_f32 v82, v82, v78, v77
    v_fma_f32 v83, v83, v78, v77
    s_add_u32 m0, s81, 133120
    s_mov_b32 s78, 1408
    s_mov_b64 exec, 0xffffffff
    buffer_load_dwordx4 v3, s[36:39], s78 offen sc1 lds
    s_mov_b64 exec, -1
    v_mul_f32 v80, v80, v228
    v_mul_f32 v81, v81, v229
    v_mul_f32 v82, v82, v230
    v_mul_f32 v83, v83, v231
    v_exp_f32 v80, v80
    v_mul_f32 v228, v228, v244
    v_exp_f32 v81, v81
    s_add_u32 m0, s33, 57344
    s_mov_b32 s76, 4325376
    buffer_load_dwordx4 v23, s[40:43], s76 offen offset:0 lds
    s_add_u32 m0, s33, 59392
    s_nop 0
    buffer_load_dwordx4 v23, s[40:43], s76 offen offset:2048 lds
    v_mul_f32 v229, v229, v245
    v_exp_f32 v82, v82
    v_mul_f32 v230, v230, v246
    v_exp_f32 v83, v83
    v_mul_f32 v231, v231, v247
    v_fma_f32 v80, v80, v79, v79
    s_add_u32 m0, s33, 65536
    s_nop 0
    buffer_load_dwordx4 v23, s[44:47], s76 offen offset:0 lds
    v_fma_f32 v81, v81, v79, v79
    v_fma_f32 v82, v82, v79, v79
    v_fma_f32 v83, v83, v79, v79
    v_rcp_f32 v80, v80
    v_rcp_f32 v81, v81
    v_rcp_f32 v82, v82
    s_add_u32 m0, s33, 69632
    s_mov_b32 s77, 5046272
    buffer_load_dwordx4 v22, s[48:51], s77 offen offset:0 lds
    v_rcp_f32 v83, v83
    s_nop 0
    v_mul_f32 v228, v228, v80
    v_mul_f32 v229, v229, v81
    v_mul_f32 v230, v230, v82
    v_mul_f32 v231, v231, v83
    v_cvt_pk_bf16_f32 v226, v228, v229
    v_cvt_pk_bf16_f32 v227, v230, v231
    s_add_u32 m0, s33, 73728
    s_nop 0
    buffer_load_dwordx4 v22, s[52:55], s77 offen offset:0 lds
    s_load_dword s94, s[20:21], s75 offset:0x80
    s_load_dword s94, s[20:21], s75 offset:0xc0
    s_load_dword s94, s[20:21], s75 offset:0x100
    s_load_dword s94, s[20:21], s75 offset:0x140
    s_load_dword s94, s[20:21], s75 offset:0x180
    s_lshl_b32 s91, s4, 6
    s_add_u32 s91, s91, s29
    s_lshl_b32 s91, s91, 7
    s_add_u32 s91, s91, 0x1eb0000
    v_lshl_add_u32 v13, v1, 11, s91
    s_mov_b64 exec, 15
    global_load_dwordx2 v[14:15], v13, s[26:27] sc1
    s_mov_b64 exec, -1
    s_waitcnt vmcnt(17)
    s_barrier
    s_add_u32 m0, s79, 135168
    s_mov_b32 s78, 1536
    buffer_load_dwordx4 v20, s[36:39], s78 offen sc1 lds
    s_nop 1
    v_permlane16_swap_b32 v224, v226
    v_permlane16_swap_b32 v225, v227
    s_add_u32 m0, s79, 136192
    s_nop 0
    buffer_load_dwordx4 v21, s[36:39], s78 offen sc1 lds
    s_add_u32 m0, s33, 77824
    s_mov_b32 s76, 4521984
    buffer_load_dwordx4 v23, s[40:43], s76 offen offset:0 lds
    s_add_u32 m0, s33, 79872
    s_nop 0
    buffer_load_dwordx4 v23, s[40:43], s76 offen offset:2048 lds
    s_add_u32 m0, s33, 86016
    s_nop 0
    buffer_load_dwordx4 v23, s[44:47], s76 offen offset:0 lds
    s_add_u32 m0, s33, 90112
    s_mov_b32 s77, 5275648
    buffer_load_dwordx4 v22, s[48:51], s77 offen offset:0 lds
    s_add_u32 m0, s33, 94208
    s_nop 0
    buffer_load_dwordx4 v22, s[52:55], s77 offen offset:0 lds
    buffer_store_dwordx4 v[224:227], v19, s[68:71], s74 offen offset:2048 sc1
    s_load_dword s94, s[20:21], s75 offset:0x1c0
    s_add_u32 s75, s75, 0xffe00000
    s_load_dword s94, s[20:21], s75 offset:0x0
    s_load_dword s94, s[20:21], s75 offset:0x40
    s_load_dword s94, s[20:21], s75 offset:0x80
    s_load_dword s94, s[20:21], s75 offset:0xc0
    s_waitcnt vmcnt(18)
    s_barrier
    s_add_u32 m0, s79, 137216
    s_mov_b32 s78, 34304
    buffer_load_dwordx4 v20, s[36:39], s78 offen sc1 lds
    s_add_u32 m0, s79, 138240
    s_nop 0
    buffer_load_dwordx4 v21, s[36:39], s78 offen sc1 lds
    s_add_u32 m0, s81, 151552
    s_mov_b32 s78, 1536
    s_mov_b64 exec, 0xffffffff
    buffer_load_dwordx4 v3, s[36:39], s78 offen sc1 lds
    s_mov_b64 exec, -1
    s_add_u32 m0, s33, 16384
    s_mov_b32 s76, 4718592
    buffer_load_dwordx4 v23, s[40:43], s76 offen offset:0 lds
    s_add_u32 m0, s33, 18432
    s_nop 0
    buffer_load_dwordx4 v23, s[40:43], s76 offen offset:2048 lds
    s_add_u32 m0, s33, 24576
    s_nop 0
    buffer_load_dwordx4 v23, s[44:47], s76 offen offset:0 lds
    s_add_u32 m0, s33, 28672
    s_mov_b32 s77, 5505024
    buffer_load_dwordx4 v22, s[48:51], s77 offen offset:0 lds
    s_add_u32 m0, s33, 32768
    s_nop 0
    buffer_load_dwordx4 v22, s[52:55], s77 offen offset:0 lds
    s_load_dword s94, s[20:21], s75 offset:0x100
    s_load_dword s94, s[20:21], s75 offset:0x140
    s_load_dword s94, s[20:21], s75 offset:0x180
    s_load_dword s94, s[20:21], s75 offset:0x1c0
    s_add_u32 s75, s75, 0x280000
    s_load_dword s94, s[20:21], s75 offset:0x0
    s_waitcnt vmcnt(16)
    s_mov_b64 exec, 15
    s_movk_i32 s98, 0x4000
L_pC_chk:
    v_cmp_ne_u64 vcc, s[100:101], v[14:15]
    s_nop 1
    s_cmp_eq_u64 vcc, 0
    s_cbranch_scc1 L_pC_ok
    s_sub_u32 s98, s98, 1
    s_cbranch_scc1 L_pC_ok
    s_sleep 1
    global_load_dwordx2 v[14:15], v13, s[26:27] sc1
    s_waitcnt vmcnt(0)
    s_branch L_pC_chk
L_pC_ok:
    s_mov_b64 exec, -1
    s_waitcnt vmcnt(17)
    s_barrier
    s_mov_b64 exec, 0
    s_cmp_eq_u32 s4, 0
    s_cbranch_scc1 L_pad12
L_vret3:
    s_mov_b64 exec, -1
    s_load_dword s94, s[20:21], s75 offset:0x40
    s_load_dword s94, s[20:21], s75 offset:0x80
    s_load_dword s94, s[20:21], s75 offset:0xc0
    s_load_dword s94, s[20:21], s75 offset:0x100
    s_load_dword s94, s[20:21], s75 offset:0x140
    s_waitcnt vmcnt(9)
    s_barrier
    s_add_u32 m0, s79, 98304
    s_mov_b32 s78, 1664
    buffer_load_dwordx4 v20, s[36:39], s78 offen sc1 lds
    s_add_u32 m0, s79, 99328
    s_nop 0
    buffer_load_dwordx4 v21, s[36:39], s78 offen sc1 lds
    s_add_u32 m0, s33, 36864
    s_mov_b32 s76, 4915200
    buffer_load_dwordx4 v23, s[40:43], s76 offen offset:0 lds
    s_add_u32 m0, s33, 38912
    s_nop 0
    buffer_load_dwordx4 v23, s[40:43], s76 offen offset:2048 lds
    s_add_u32 m0, s33, 45056
    s_nop 0
    buffer_load_dwordx4 v23, s[44:47], s76 offen offset:0 lds
    s_add_u32 m0, s33, 49152
    s_mov_b32 s77, 5734400
    buffer_load_dwordx4 v22, s[48:51], s77 offen offset:0 lds
    s_add_u32 m0, s33, 53248
    s_nop 0
    buffer_load_dwordx4 v22, s[52:55], s77 offen offset:0 lds
    s_add_u32 m0, s79, 100352
    s_mov_b32 s78, 34432
    buffer_load_dwordx4 v20, s[36:39], s78 offen sc1 lds
    s_add_u32 m0, s79, 101376
    s_nop 0
    buffer_load_dwordx4 v21, s[36:39], s78 offen sc1 lds
    s_load_dword s94, s[20:21], s75 offset:0x180
    s_load_dword s94, s[20:21], s75 offset:0x1c0
    s_add_u32 s75, s75, 0xffe00000
    s_load_dword s94, s[20:21], s75 offset:0x0
    s_load_dword s94, s[20:21], s75 offset:0x40
    s_load_dword s94, s[20:21], s75 offset:0x80
    s_waitcnt vmcnt(17)
    s_waitcnt vmcnt(9)
    s_barrier
    s_add_u32 m0, s81, 114688
    s_mov_b32 s78, 1664
    s_mov_b64 exec, 0xffffffff
    buffer_load_dwordx4 v3, s[36:39], s78 offen sc1 lds
    s_mov_b64 exec, -1
    s_add_u32 m0, s33, 57344
    s_mov_b32 s76, 5111808
    buffer_load_dwordx4 v23, s[40:43], s76 offen offset:0 lds
    s_add_u32 m0, s33, 59392
    s_nop 0
    buffer_load_dwordx4 v23, s[40:43], s76 offen offset:2048 lds
    s_add_u32 m0, s33, 65536
    s_nop 0
    buffer_load_dwordx4 v23, s[44:47], s76 offen offset:0 lds
    s_add_u32 m0, s33, 69632
    s_mov_b32 s77, 5963776
    buffer_load_dwordx4 v22, s[48:51], s77 offen offset:0 lds
    s_add_u32 m0, s33, 73728
    s_nop 0
    buffer_load_dwordx4 v22, s[52:55], s77 offen offset:0 lds
    s_add_u32 m0, s79, 116736
    s_mov_b32 s78, 1792
    buffer_load_dwordx4 v20, s[36:39], s78 offen sc1 lds
    s_add_u32 m0, s79, 117760
    s_nop 0
    buffer_load_dwordx4 v21, s[36:39], s78 offen sc1 lds
    s_add_u32 m0, s33, 77824
    s_mov_b32 s76, 5308416
    buffer_load_dwordx4 v23, s[40:43], s76 offen offset:0 lds
    s_load_dword s94, s[20:21], s75 offset:0xc0
    s_load_dword s94, s[20:21], s75 offset:0x100
    s_load_dword s94, s[20:21], s75 offset:0x140
    s_load_dword s94, s[20:21], s75 offset:0x180
    s_load_dword s94, s[20:21], s75 offset:0x1c0
    s_cmp_lg_u32 s4, 0
    s_cbranch_scc1 L_fH1
    s_lshl_b32 s91, s28, 4
    s_add_u32 s91, s91, s29
    s_lshl_b32 s91, s91, 7
    s_add_u32 s91, s91, 0x1e88000
    v_mov_b32 v12, s91
    v_mov_b32 v14, s100
    v_mov_b32 v15, s101
    s_mov_b64 exec, 1
    global_store_dwordx2 v12, v[14:15], s[26:27] sc1
    s_mov_b64 exec, -1
L_fH1:
    s_waitcnt vmcnt(11)
    s_barrier
    s_add_u32 m0, s33, 79872
    s_nop 0
    buffer_load_dwordx4 v23, s[40:43], s76 offen offset:2048 lds
    s_add_u32 m0, s33, 86016
    s_nop 0
    buffer_load_dwordx4 v23, s[44:47], s76 offen offset:0 lds
    s_add_u32 m0, s33, 90112
    s_mov_b32 s77, 6193152
    buffer_load_dwordx4 v22, s[48:51], s77 offen offset:0 lds
    s_add_u32 m0, s33, 94208
    s_nop 0
    buffer_load_dwordx4 v22, s[52:55], s77 offen offset:0 lds
    s_add_u32 m0, s79, 118784
    s_mov_b32 s78, 34560
    buffer_load_dwordx4 v20, s[36:39], s78 offen sc1 lds
    s_add_u32 m0, s79, 119808
    s_nop 0
    buffer_load_dwordx4 v21, s[36:39], s78 offen sc1 lds
    s_add_u32 m0, s81, 133120
    s_mov_b32 s78, 1792
    s_mov_b64 exec, 0xffffffff
    buffer_load_dwordx4 v3, s[36:39], s78 offen sc1 lds
    s_mov_b64 exec, -1
    s_add_u32 m0, s33, 16384
    s_mov_b32 s76, 5505024
    buffer_load_dwordx4 v23, s[40:43], s76 offen offset:0 lds
    s_add_u32 m0, s33, 18432
    s_nop 0
    buffer_load_dwordx4 v23, s[40:43], s76 offen offset:2048 lds
    s_add_u32 s75, s75, 0x280000
    s_load_dword s94, s[20:21], s75 offset:0x0
    s_load_dword s94, s[20:21], s75 offset:0x40
L_pad3:
    s_cbranch_execz L_vret1
    s_load_dword s94, s[20:21], s75 offset:0x80
    s_load_dword s94, s[20:21], s75 offset:0xc0
    s_load_dword s94, s[20:21], s75 offset:0x100
    s_waitcnt vmcnt(12)
    s_barrier
    s_add_u32 m0, s33, 24576
    s_nop 0
    buffer_load_dwordx4 v23, s[44:47], s76 offen offset:0 lds
    s_add_u32 m0, s33, 28672
    s_mov_b32 s77, 6422528
    buffer_load_dwordx4 v22, s[48:51], s77 offen offset:0 lds
    s_add_u32 m0, s33, 32768
    s_nop 0
    buffer_load_dwordx4 v22, s[52:55], s77 offen offset:0 lds
    s_add_u32 m0, s79, 135168
    s_mov_b32 s78, 1920
    buffer_load_dwordx4 v20, s[36:39], s78 offen sc1 lds
    s_add_u32 m0, s79, 136192
    s_nop 0
    buffer_load_dwordx4 v21, s[36:39], s78 offen sc1 lds
    s_add_u32 m0, s33, 36864
    s_mov_b32 s76, 5701632
    buffer_load_dwordx4 v23, s[40:43], s76 offen offset:0 lds
    s_add_u32 m0, s33, 38912
    s_nop 0
    buffer_load_dwordx4 v23, s[40:43], s76 offen offset:2048 lds
    s_add_u32 m0, s33, 45056
    s_nop 0
    buffer_load_dwordx4 v23, s[44:47], s76 offen offset:0 lds
    s_add_u32 m0, s33, 49152
    s_mov_b32 s77, 6651904
    buffer_load_dwordx4 v22, s[48:51], s77 offen offset:0 lds
    s_add_u32 m0, s33, 53248
    s_nop 0
    buffer_load_dwordx4 v22, s[52:55], s77 offen offset:0 lds
    s_load_dword s94, s[20:21], s75 offset:0x140
    s_load_dword s94, s[20:21], s75 offset:0x180
    s_load_dword s94, s[20:21], s75 offset:0x1c0
    s_add_u32 s75, s75, 0xffe00000
    s_load_dword s94, s[20:21], s75 offset:0x0
    s_load_dword s94, s[20:21], s75 offset:0x40
    s_waitcnt vmcnt(15)
    s_barrier
    s_add_u32 m0, s79, 137216
    s_mov_b32 s78, 34688
    buffer_load_dwordx4 v20, s[36:39], s78 offen sc1 lds
    s_add_u32 m0, s79, 138240
    s_nop 0
    buffer_load_dwordx4 v21, s[36:39], s78 offen sc1 lds
    s_add_u32 m0, s81, 151552
    s_mov_b32 s78, 1920
    s_mov_b64 exec, 0xffffffff
    buffer_load_dwordx4 v3, s[36:39], s78 offen sc1 lds
    s_mov_b64 exec, -1
    s_add_u32 m0, s33, 57344
    s_mov_b32 s76, 5898240
    buffer_load_dwordx4 v23, s[40:43], s76 offen offset:0 lds
    s_add_u32 m0, s33, 59392
    s_nop 0
    buffer_load_dwordx4 v23, s[40:43], s76 offen offset:2048 lds
    s_add_u32 m0, s33, 65536
    s_nop 0
    buffer_load_dwordx4 v23, s[44:47], s76 offen offset:0 lds
    s_add_u32 m0, s33, 69632
    s_mov_b32 s77, 6881280
    buffer_load_dwordx4 v22, s[48:51], s77 offen offset:0 lds
    s_add_u32 m0, s33, 73728
    s_nop 0
    buffer_load_dwordx4 v22, s[52:55], s77 offen offset:0 lds
    s_lshl2_add_u32 s91, s30, s4
    s_lshl_b32 s91, s91, 9
    s_add_u32 s91, s91, 0x1e88000
    v_lshl_add_u32 v13, v1, 7, s91
    s_mov_b64 exec, 15
    global_load_dwordx2 v[14:15], v13, s[26:27] sc1
    s_mov_b64 exec, -1
    s_waitcnt vmcnt(16)
    s_barrier
    s_add_u32 m0, s33, 77824
    s_mov_b32 s76, 6094848
    buffer_load_dwordx4 v23, s[40:43], s76 offen offset:0 lds
    s_add_u32 m0, s33, 79872
    s_nop 0
    buffer_load_dwordx4 v23, s[40:43], s76 offen offset:2048 lds
    s_add_u32 m0, s33, 86016
    s_nop 0
    buffer_load_dwordx4 v23, s[44:47], s76 offen offset:0 lds
    s_add_u32 m0, s33, 90112
    s_mov_b32 s77, 7110656
    buffer_load_dwordx4 v22, s[48:51], s77 offen offset:0 lds
    s_add_u32 m0, s33, 94208
    s_nop 0
    buffer_load_dwordx4 v22, s[52:55], s77 offen offset:0 lds
    s_waitcnt vmcnt(5)
    s_mov_b64 exec, 15
    s_movk_i32 s98, 0x4000
L_pH1_chk:
    v_cmp_ne_u64 vcc, s[100:101], v[14:15]
    s_nop 1
    s_cmp_eq_u64 vcc, 0
    s_cbranch_scc1 L_pH1_ok
    s_sub_u32 s98, s98, 1
    s_cbranch_scc1 L_pH1_ok
    s_sleep 1
    global_load_dwordx2 v[14:15], v13, s[26:27] sc1
    s_waitcnt vmcnt(0)
    s_branch L_pH1_chk
L_pH1_ok:
    s_mov_b64 exec, -1
    s_waitcnt vmcnt(14)
    s_barrier
    s_mov_b32 s40, s34
    s_mov_b32 s42, s35
    s_memrealtime s[44:45]
    s_memtime s[46:47]
    s_lshl4_add_u32 s91, s28, s29
    s_lshl_b32 s91, s91, 7
    s_add_u32 s92, s91, 0x1ea8000
    s_xor_b32 s91, s91, 17408
    s_add_u32 s91, s91, 0x1ea8000
    v_mov_b32 v239, s92
    v_writelane_b32 v239, s91, 1
    s_lshl_b32 m0, s33, 2
    s_nop 0
    buffer_load_dwordx4 v18, s[56:59], s82 offen offset:0 sc1 lds
    buffer_load_dwordx4 v18, s[56:59], s82 offen offset:1024 sc1 lds
    buffer_load_dwordx4 v18, s[56:59], s82 offen offset:2048 sc1 lds
    buffer_load_dwordx4 v18, s[56:59], s82 offen offset:3072 sc1 lds
    s_add_u32 s82, s82, 16384
    s_lshl1_add_u32 m0, s33, 16384
    s_nop 0
    buffer_load_dwordx4 v254, s[60:63], s83 offen lds
    s_lshl1_add_u32 m0, s33, 17408
    s_nop 0
    buffer_load_dwordx4 v255, s[60:63], s83 offen lds
    s_lshl1_add_u32 m0, s33, 24576
    s_nop 0
    buffer_load_dwordx4 v254, s[64:67], s83 offen lds
    s_lshl1_add_u32 m0, s33, 25600
    s_nop 0
    buffer_load_dwordx4 v255, s[64:67], s83 offen lds
    s_add_u32 s83, s83, 131072
    s_lshl_b32 s84, s2, 15
    s_lshl_b32 s85, s4, 13
    s_add_u32 s84, s84, s85
    s_add_u32 s36, s84, 0x1600000
    s_add_u32 s37, s36, 4096
    s_xor_b32 s84, s84, 163840
    s_add_u32 s38, s84, 0x1600000
    s_add_u32 s39, s38, 4096
    v_lshlrev_b32 v4, 4, v1
    s_lshl_b32 s84, s4, 12
    s_add_u32 s84, s84, 147456
    v_lshl_add_u32 v5, v1, 3, s84
    v_lshlrev_b32 v6, 2, v1
    s_waitcnt vmcnt(14)
    s_barrier
    s_lshl2_add_u32 m0, s33, 98304
    s_nop 0
    buffer_load_dwordx4 v18, s[56:59], s82 offen offset:0 sc1 lds
    buffer_load_dwordx4 v18, s[56:59], s82 offen offset:1024 sc1 lds
    buffer_load_dwordx4 v18, s[56:59], s82 offen offset:2048 sc1 lds
    buffer_load_dwordx4 v18, s[56:59], s82 offen offset:3072 sc1 lds
    s_add_u32 s82, s82, 16384
    s_lshl1_add_u32 m0, s33, 114688
    s_nop 0
    buffer_load_dwordx4 v254, s[60:63], s83 offen lds
    s_lshl1_add_u32 m0, s33, 115712
    s_nop 0
    buffer_load_dwordx4 v255, s[60:63], s83 offen lds
    s_lshl1_add_u32 m0, s33, 122880
    s_nop 0
    buffer_load_dwordx4 v254, s[64:67], s83 offen lds
    s_lshl1_add_u32 m0, s33, 123904
    s_nop 0
    buffer_load_dwordx4 v255, s[64:67], s83 offen lds
    s_add_u32 s83, s83, 131072
    s_waitcnt lgkmcnt(0)
    s_sub_u32 s40, s44, s40
    s_sub_u32 s42, s46, s42
    v_cvt_f32_u32 v8, s42
    v_cvt_f32_u32 v9, s40
    v_rcp_f32 v8, v8
    v_mul_f32 v9, 0x463b8000, v9
    v_mul_f32 v8, v8, v9
    v_cvt_u32_f32 v10, v8
    v_add_u32 v10, s44, v10
    v_mov_b32 v8, s100
    v_mov_b32 v9, s101
    s_cmp_eq_u32 s4, 0
    s_cselect_b64 exec, 1, 0
    s_cbranch_execz L_tp
    global_store_dwordx3 v239, v[8:10], s[26:27] sc1
L_tp:
    s_mov_b64 exec, -1
    s_waitcnt vmcnt(16)
    s_barrier
    s_lshl2_add_u32 m0, s33, 32768
    s_nop 0
    buffer_load_dwordx4 v18, s[56:59], s82 offen offset:0 sc1 lds
    buffer_load_dwordx4 v18, s[56:59], s82 offen offset:1024 sc1 lds
    buffer_load_dwordx4 v18, s[56:59], s82 offen offset:2048 sc1 lds
    buffer_load_dwordx4 v18, s[56:59], s82 offen offset:3072 sc1 lds
    s_add_u32 s82, s82, 16384
    s_lshl1_add_u32 m0, s33, 49152
    s_nop 0
    buffer_load_dwordx4 v254, s[60:63], s83 offen lds
    s_lshl1_add_u32 m0, s33, 50176
    s_nop 0
    buffer_load_dwordx4 v255, s[60:63], s83 offen lds
    s_lshl1_add_u32 m0, s33, 57344
    s_nop 0
    buffer_load_dwordx4 v254, s[64:67], s83 offen lds
    s_lshl1_add_u32 m0, s33, 58368
    s_nop 0
    buffer_load_dwordx4 v255, s[64:67], s83 offen lds
    s_add_u32 s83, s83, 131072
    s_waitcnt vmcnt(16)
    s_barrier
    s_setprio 1
    ds_read_b64_tr_b16 v[40:41], v250 offset:16384
    ds_read_b64_tr_b16 v[42:43], v250 offset:16896
    ds_read_b128 v[24:27], v248 offset:0
    ds_read_b128 v[28:31], v248 offset:1024
    ds_read_b128 v[32:35], v248 offset:2048
    ds_read_b128 v[36:39], v248 offset:3072
    ds_read_b64_tr_b16 v[44:45], v251 offset:16384
    ds_read_b64_tr_b16 v[46:47], v251 offset:16896
    ds_read_b64_tr_b16 v[48:49], v250 offset:24576
    ds_read_b64_tr_b16 v[50:51], v250 offset:25088
    ds_read_b64_tr_b16 v[52:53], v251 offset:24576
    ds_read_b64_tr_b16 v[54:55], v251 offset:25088
    s_lshl2_add_u32 m0, s33, 65536
    s_nop 0
    buffer_load_dwordx4 v18, s[56:59], s82 offen offset:0 sc1 lds
    buffer_load_dwordx4 v18, s[56:59], s82 offen offset:1024 sc1 lds
    buffer_load_dwordx4 v18, s[56:59], s82 offen offset:2048 sc1 lds
    buffer_load_dwordx4 v18, s[56:59], s82 offen offset:3072 sc1 lds
    s_add_u32 s82, s82, 16384
    s_waitcnt lgkmcnt(9)
    v_mfma_f32_16x16x32_bf16 v[88:91], v[40:43], v[24:27], 0
    ds_read_b64_tr_b16 v[72:73], v250 offset:20480
    ds_read_b64_tr_b16 v[74:75], v250 offset:20992
    s_waitcnt lgkmcnt(10)
    v_mfma_f32_16x16x32_bf16 v[92:95], v[40:43], v[28:31], 0
    ds_read_b128 v[56:59], v248 offset:8192
    s_lshl1_add_u32 m0, s33, 81920
    s_waitcnt lgkmcnt(10)
    v_mfma_f32_16x16x32_bf16 v[96:99], v[40:43], v[32:35], 0
    ds_read_b128 v[60:63], v248 offset:9216
    ds_read_b128 v[64:67], v248 offset:10240
    s_waitcnt lgkmcnt(11)
    v_mfma_f32_16x16x32_bf16 v[100:103], v[40:43], v[36:39], 0
    ds_read_b128 v[68:71], v248 offset:11264
    buffer_load_dwordx4 v254, s[60:63], s83 offen lds
    s_waitcnt lgkmcnt(10)
    v_mfma_f32_16x16x32_bf16 v[104:107], v[44:47], v[24:27], 0
    ds_read_b64_tr_b16 v[76:77], v251 offset:20480
    ds_read_b64_tr_b16 v[78:79], v251 offset:20992
    v_mfma_f32_16x16x32_bf16 v[108:111], v[44:47], v[28:31], 0
    ds_read_b64_tr_b16 v[80:81], v250 offset:28672
    s_lshl1_add_u32 m0, s33, 82944
    v_mfma_f32_16x16x32_bf16 v[112:115], v[44:47], v[32:35], 0
    ds_read_b64_tr_b16 v[82:83], v250 offset:29184
    ds_read_b64_tr_b16 v[84:85], v251 offset:28672
    v_mfma_f32_16x16x32_bf16 v[116:119], v[44:47], v[36:39], 0
    ds_read_b64_tr_b16 v[86:87], v251 offset:29184
    buffer_load_dwordx4 v255, s[60:63], s83 offen lds
    s_waitcnt lgkmcnt(14)
    v_mfma_f32_16x16x32_bf16 v[120:123], v[48:51], v[24:27], 0
    v_mfma_f32_16x16x32_bf16 v[124:127], v[48:51], v[28:31], 0
    s_lshl1_add_u32 m0, s33, 90112
    v_mfma_f32_16x16x32_bf16 v[128:131], v[48:51], v[32:35], 0
    v_mfma_f32_16x16x32_bf16 v[132:135], v[48:51], v[36:39], 0
    buffer_load_dwordx4 v254, s[64:67], s83 offen lds
    s_waitcnt lgkmcnt(12)
    v_mfma_f32_16x16x32_bf16 v[136:139], v[52:55], v[24:27], 0
    v_mfma_f32_16x16x32_bf16 v[140:143], v[52:55], v[28:31], 0
    s_lshl1_add_u32 m0, s33, 91136
    v_mfma_f32_16x16x32_bf16 v[144:147], v[52:55], v[32:35], 0
    v_mfma_f32_16x16x32_bf16 v[148:151], v[52:55], v[36:39], 0
    buffer_load_dwordx4 v255, s[64:67], s83 offen lds
    s_add_u32 s83, s83, 131072
    s_waitcnt vmcnt(16) lgkmcnt(0)
    s_barrier
    v_mfma_f32_16x16x32_bf16 v[88:91], v[72:75], v[56:59], v[88:91]
    ds_read_b64_tr_b16 v[40:41], v252 offset:49152
    ds_read_b64_tr_b16 v[42:43], v252 offset:49664
    v_mfma_f32_16x16x32_bf16 v[92:95], v[72:75], v[60:63], v[92:95]
    ds_read_b128 v[24:27], v249 offset:32768
    s_lshl_b32 m0, s33, 2
    v_mfma_f32_16x16x32_bf16 v[96:99], v[72:75], v[64:67], v[96:99]
    ds_read_b128 v[28:31], v249 offset:33792
    v_mfma_f32_16x16x32_bf16 v[100:103], v[72:75], v[68:71], v[100:103]
    ds_read_b128 v[32:35], v249 offset:34816
    buffer_load_dwordx4 v18, s[56:59], s82 offen offset:0 sc1 lds
    v_mfma_f32_16x16x32_bf16 v[104:107], v[76:79], v[56:59], v[104:107]
    ds_read_b128 v[36:39], v249 offset:35840
    v_mfma_f32_16x16x32_bf16 v[108:111], v[76:79], v[60:63], v[108:111]
    ds_read_b64_tr_b16 v[44:45], v253 offset:49152
    ds_read_b64_tr_b16 v[46:47], v253 offset:49664
    v_mfma_f32_16x16x32_bf16 v[112:115], v[76:79], v[64:67], v[112:115]
    ds_read_b64_tr_b16 v[48:49], v252 offset:57344
    v_mfma_f32_16x16x32_bf16 v[116:119], v[76:79], v[68:71], v[116:119]
    ds_read_b64_tr_b16 v[50:51], v252 offset:57856
    buffer_load_dwordx4 v18, s[56:59], s82 offen offset:1024 sc1 lds
    v_mfma_f32_16x16x32_bf16 v[120:123], v[80:83], v[56:59], v[120:123]
    ds_read_b64_tr_b16 v[52:53], v253 offset:57344
    v_mfma_f32_16x16x32_bf16 v[124:127], v[80:83], v[60:63], v[124:127]
    ds_read_b64_tr_b16 v[54:55], v253 offset:57856
    v_mfma_f32_16x16x32_bf16 v[128:131], v[80:83], v[64:67], v[128:131]
    v_mfma_f32_16x16x32_bf16 v[132:135], v[80:83], v[68:71], v[132:135]
    buffer_load_dwordx4 v18, s[56:59], s82 offen offset:2048 sc1 lds
    v_mfma_f32_16x16x32_bf16 v[136:139], v[84:87], v[56:59], v[136:139]
    v_mfma_f32_16x16x32_bf16 v[140:143], v[84:87], v[60:63], v[140:143]
    v_mfma_f32_16x16x32_bf16 v[144:147], v[84:87], v[64:67], v[144:147]
    v_mfma_f32_16x16x32_bf16 v[148:151], v[84:87], v[68:71], v[148:151]
    buffer_load_dwordx4 v18, s[56:59], s82 offen offset:3072 sc1 lds
    s_add_u32 s82, s82, 16384
    s_waitcnt lgkmcnt(9)
    v_mfma_f32_16x16x32_bf16 v[88:91], v[40:43], v[24:27], v[88:91]
    ds_read_b64_tr_b16 v[72:73], v252 offset:53248
    ds_read_b64_tr_b16 v[74:75], v252 offset:53760
    s_waitcnt lgkmcnt(10)
    v_mfma_f32_16x16x32_bf16 v[92:95], v[40:43], v[28:31], v[92:95]
    ds_read_b128 v[56:59], v249 offset:40960
    s_lshl1_add_u32 m0, s33, 16384
    s_waitcnt lgkmcnt(10)
    v_mfma_f32_16x16x32_bf16 v[96:99], v[40:43], v[32:35], v[96:99]
    ds_read_b128 v[60:63], v249 offset:41984
    ds_read_b128 v[64:67], v249 offset:43008
    s_waitcnt lgkmcnt(11)
    v_mfma_f32_16x16x32_bf16 v[100:103], v[40:43], v[36:39], v[100:103]
    ds_read_b128 v[68:71], v249 offset:44032
    buffer_load_dwordx4 v254, s[60:63], s83 offen lds
    s_waitcnt lgkmcnt(10)
    v_mfma_f32_16x16x32_bf16 v[104:107], v[44:47], v[24:27], v[104:107]
    ds_read_b64_tr_b16 v[76:77], v253 offset:53248
    ds_read_b64_tr_b16 v[78:79], v253 offset:53760
    v_mfma_f32_16x16x32_bf16 v[108:111], v[44:47], v[28:31], v[108:111]
    ds_read_b64_tr_b16 v[80:81], v252 offset:61440
    s_lshl1_add_u32 m0, s33, 17408
    v_mfma_f32_16x16x32_bf16 v[112:115], v[44:47], v[32:35], v[112:115]
    ds_read_b64_tr_b16 v[82:83], v252 offset:61952
    ds_read_b64_tr_b16 v[84:85], v253 offset:61440
    v_mfma_f32_16x16x32_bf16 v[116:119], v[44:47], v[36:39], v[116:119]
    ds_read_b64_tr_b16 v[86:87], v253 offset:61952
    buffer_load_dwordx4 v255, s[60:63], s83 offen lds
    s_waitcnt lgkmcnt(14)
    v_mfma_f32_16x16x32_bf16 v[120:123], v[48:51], v[24:27], v[120:123]
    v_mfma_f32_16x16x32_bf16 v[124:127], v[48:51], v[28:31], v[124:127]
    s_lshl1_add_u32 m0, s33, 24576
    v_mfma_f32_16x16x32_bf16 v[128:131], v[48:51], v[32:35], v[128:131]
    v_mfma_f32_16x16x32_bf16 v[132:135], v[48:51], v[36:39], v[132:135]
    buffer_load_dwordx4 v254, s[64:67], s83 offen lds
    s_waitcnt lgkmcnt(12)
    v_mfma_f32_16x16x32_bf16 v[136:139], v[52:55], v[24:27], v[136:139]
    v_mfma_f32_16x16x32_bf16 v[140:143], v[52:55], v[28:31], v[140:143]
    s_lshl1_add_u32 m0, s33, 25600
    v_mfma_f32_16x16x32_bf16 v[144:147], v[52:55], v[32:35], v[144:147]
    v_mfma_f32_16x16x32_bf16 v[148:151], v[52:55], v[36:39], v[148:151]
    buffer_load_dwordx4 v255, s[64:67], s83 offen lds
    s_add_u32 s83, s83, 131072
    s_waitcnt vmcnt(16) lgkmcnt(0)
    s_barrier
    v_mfma_f32_16x16x32_bf16 v[88:91], v[72:75], v[56:59], v[88:91]
    ds_read_b64_tr_b16 v[40:41], v250 offset:49152
    ds_read_b64_tr_b16 v[42:43], v250 offset:49664
    v_mfma_f32_16x16x32_bf16 v[92:95], v[72:75], v[60:63], v[92:95]
    ds_read_b128 v[24:27], v248 offset:32768
    s_lshl2_add_u32 m0, s33, 98304
    v_mfma_f32_16x16x32_bf16 v[96:99], v[72:75], v[64:67], v[96:99]
    ds_read_b128 v[28:31], v248 offset:33792
    v_mfma_f32_16x16x32_bf16 v[100:103], v[72:75], v[68:71], v[100:103]
    ds_read_b128 v[32:35], v248 offset:34816
    buffer_load_dwordx4 v18, s[56:59], s82 offen offset:0 sc1 lds
    v_mfma_f32_16x16x32_bf16 v[104:107], v[76:79], v[56:59], v[104:107]
    ds_read_b128 v[36:39], v248 offset:35840
    v_mfma_f32_16x16x32_bf16 v[108:111], v[76:79], v[60:63], v[108:111]
    ds_read_b64_tr_b16 v[44:45], v251 offset:49152
    ds_read_b64_tr_b16 v[46:47], v251 offset:49664
    v_mfma_f32_16x16x32_bf16 v[112:115], v[76:79], v[64:67], v[112:115]
    ds_read_b64_tr_b16 v[48:49], v250 offset:57344
    v_mfma_f32_16x16x32_bf16 v[116:119], v[76:79], v[68:71], v[116:119]
    ds_read_b64_tr_b16 v[50:51], v250 offset:57856
    buffer_load_dwordx4 v18, s[56:59], s82 offen offset:1024 sc1 lds
    v_mfma_f32_16x16x32_bf16 v[120:123], v[80:83], v[56:59], v[120:123]
    ds_read_b64_tr_b16 v[52:53], v251 offset:57344
    v_mfma_f32_16x16x32_bf16 v[124:127], v[80:83], v[60:63], v[124:127]
    ds_read_b64_tr_b16 v[54:55], v251 offset:57856
    v_mfma_f32_16x16x32_bf16 v[128:131], v[80:83], v[64:67], v[128:131]
    v_mfma_f32_16x16x32_bf16 v[132:135], v[80:83], v[68:71], v[132:135]
    buffer_load_dwordx4 v18, s[56:59], s82 offen offset:2048 sc1 lds
    v_mfma_f32_16x16x32_bf16 v[136:139], v[84:87], v[56:59], v[136:139]
    v_mfma_f32_16x16x32_bf16 v[140:143], v[84:87], v[60:63], v[140:143]
    v_mfma_f32_16x16x32_bf16 v[144:147], v[84:87], v[64:67], v[144:147]
    v_mfma_f32_16x16x32_bf16 v[148:151], v[84:87], v[68:71], v[148:151]
    buffer_load_dwordx4 v18, s[56:59], s82 offen offset:3072 sc1 lds
    s_add_u32 s82, s82, 16384
    s_waitcnt lgkmcnt(9)
    v_mfma_f32_16x16x32_bf16 v[88:91], v[40:43], v[24:27], v[88:91]
    ds_read_b64_tr_b16 v[72:73], v250 offset:53248
    ds_read_b64_tr_b16 v[74:75], v250 offset:53760
    s_waitcnt lgkmcnt(10)
    v_mfma_f32_16x16x32_bf16 v[92:95], v[40:43], v[28:31], v[92:95]
    ds_read_b128 v[56:59], v248 offset:40960
    s_lshl1_add_u32 m0, s33, 114688
    s_waitcnt lgkmcnt(10)
    v_mfma_f32_16x16x32_bf16 v[96:99], v[40:43], v[32:35], v[96:99]
    ds_read_b128 v[60:63], v248 offset:41984
    ds_read_b128 v[64:67], v248 offset:43008
    s_waitcnt lgkmcnt(11)
    v_mfma_f32_16x16x32_bf16 v[100:103], v[40:43], v[36:39], v[100:103]
    ds_read_b128 v[68:71], v248 offset:44032
    buffer_load_dwordx4 v254, s[60:63], s83 offen lds
    s_waitcnt lgkmcnt(10)
    v_mfma_f32_16x16x32_bf16 v[104:107], v[44:47], v[24:27], v[104:107]
    ds_read_b64_tr_b16 v[76:77], v251 offset:53248
    ds_read_b64_tr_b16 v[78:79], v251 offset:53760
    v_mfma_f32_16x16x32_bf16 v[108:111], v[44:47], v[28:31], v[108:111]
    ds_read_b64_tr_b16 v[80:81], v250 offset:61440
    s_lshl1_add_u32 m0, s33, 115712
    v_mfma_f32_16x16x32_bf16 v[112:115], v[44:47], v[32:35], v[112:115]
    ds_read_b64_tr_b16 v[82:83], v250 offset:61952
    ds_read_b64_tr_b16 v[84:85], v251 offset:61440
    v_mfma_f32_16x16x32_bf16 v[116:119], v[44:47], v[36:39], v[116:119]
    ds_read_b64_tr_b16 v[86:87], v251 offset:61952
    buffer_load_dwordx4 v255, s[60:63], s83 offen lds
    s_waitcnt lgkmcnt(14)
    v_mfma_f32_16x16x32_bf16 v[120:123], v[48:51], v[24:27], v[120:123]
    v_mfma_f32_16x16x32_bf16 v[124:127], v[48:51], v[28:31], v[124:127]
    s_lshl1_add_u32 m0, s33, 122880
    v_mfma_f32_16x16x32_bf16 v[128:131], v[48:51], v[32:35], v[128:131]
    v_mfma_f32_16x16x32_bf16 v[132:135], v[48:51], v[36:39], v[132:135]
    buffer_load_dwordx4 v254, s[64:67], s83 offen lds
    s_waitcnt lgkmcnt(12)
    v_mfma_f32_16x16x32_bf16 v[136:139], v[52:55], v[24:27], v[136:139]
    v_mfma_f32_16x16x32_bf16 v[140:143], v[52:55], v[28:31], v[140:143]
    s_lshl1_add_u32 m0, s33, 123904
    v_mfma_f32_16x16x32_bf16 v[144:147], v[52:55], v[32:35], v[144:147]
    v_mfma_f32_16x16x32_bf16 v[148:151], v[52:55], v[36:39], v[148:151]
    buffer_load_dwordx4 v255, s[64:67], s83 offen lds
    s_add_u32 s83, s83, 131072
    s_waitcnt vmcnt(16) lgkmcnt(0)
    s_barrier
    v_mfma_f32_16x16x32_bf16 v[88:91], v[72:75], v[56:59], v[88:91]
    ds_read_b64_tr_b16 v[40:41], v252 offset:16384
    ds_read_b64_tr_b16 v[42:43], v252 offset:16896
    v_mfma_f32_16x16x32_bf16 v[92:95], v[72:75], v[60:63], v[92:95]
    ds_read_b128 v[24:27], v249 offset:0
    s_lshl2_add_u32 m0, s33, 32768
    v_mfma_f32_16x16x32_bf16 v[96:99], v[72:75], v[64:67], v[96:99]
    ds_read_b128 v[28:31], v249 offset:1024
    v_mfma_f32_16x16x32_bf16 v[100:103], v[72:75], v[68:71], v[100:103]
    ds_read_b128 v[32:35], v249 offset:2048
    buffer_load_dwordx4 v18, s[56:59], s82 offen offset:0 sc1 lds
    v_mfma_f32_16x16x32_bf16 v[104:107], v[76:79], v[56:59], v[104:107]
    ds_read_b128 v[36:39], v249 offset:3072
    v_mfma_f32_16x16x32_bf16 v[108:111], v[76:79], v[60:63], v[108:111]
    ds_read_b64_tr_b16 v[44:45], v253 offset:16384
    ds_read_b64_tr_b16 v[46:47], v253 offset:16896
    v_mfma_f32_16x16x32_bf16 v[112:115], v[76:79], v[64:67], v[112:115]
    ds_read_b64_tr_b16 v[48:49], v252 offset:24576
    v_mfma_f32_16x16x32_bf16 v[116:119], v[76:79], v[68:71], v[116:119]
    ds_read_b64_tr_b16 v[50:51], v252 offset:25088
    buffer_load_dwordx4 v18, s[56:59], s82 offen offset:1024 sc1 lds
    v_mfma_f32_16x16x32_bf16 v[120:123], v[80:83], v[56:59], v[120:123]
    ds_read_b64_tr_b16 v[52:53], v253 offset:24576
    v_mfma_f32_16x16x32_bf16 v[124:127], v[80:83], v[60:63], v[124:127]
    ds_read_b64_tr_b16 v[54:55], v253 offset:25088
    v_mfma_f32_16x16x32_bf16 v[128:131], v[80:83], v[64:67], v[128:131]
    v_mfma_f32_16x16x32_bf16 v[132:135], v[80:83], v[68:71], v[132:135]
    buffer_load_dwordx4 v18, s[56:59], s82 offen offset:2048 sc1 lds
    v_mfma_f32_16x16x32_bf16 v[136:139], v[84:87], v[56:59], v[136:139]
    v_mfma_f32_16x16x32_bf16 v[140:143], v[84:87], v[60:63], v[140:143]
    v_mfma_f32_16x16x32_bf16 v[144:147], v[84:87], v[64:67], v[144:147]
    v_mfma_f32_16x16x32_bf16 v[148:151], v[84:87], v[68:71], v[148:151]
    buffer_load_dwordx4 v18, s[56:59], s82 offen offset:3072 sc1 lds
    s_add_u32 s82, s82, 16384
    s_waitcnt lgkmcnt(9)
    v_mfma_f32_16x16x32_bf16 v[88:91], v[40:43], v[24:27], v[88:91]
    ds_read_b64_tr_b16 v[72:73], v252 offset:20480
    ds_read_b64_tr_b16 v[74:75], v252 offset:20992
    s_waitcnt lgkmcnt(10)
    v_mfma_f32_16x16x32_bf16 v[92:95], v[40:43], v[28:31], v[92:95]
    ds_read_b128 v[56:59], v249 offset:8192
    s_lshl1_add_u32 m0, s33, 49152
    s_waitcnt lgkmcnt(10)
    v_mfma_f32_16x16x32_bf16 v[96:99], v[40:43], v[32:35], v[96:99]
    ds_read_b128 v[60:63], v249 offset:9216
    ds_read_b128 v[64:67], v249 offset:10240
    s_waitcnt lgkmcnt(11)
    v_mfma_f32_16x16x32_bf16 v[100:103], v[40:43], v[36:39], v[100:103]
    ds_read_b128 v[68:71], v249 offset:11264
    buffer_load_dwordx4 v254, s[60:63], s83 offen lds
    s_waitcnt lgkmcnt(10)
    v_mfma_f32_16x16x32_bf16 v[104:107], v[44:47], v[24:27], v[104:107]
    ds_read_b64_tr_b16 v[76:77], v253 offset:20480
    ds_read_b64_tr_b16 v[78:79], v253 offset:20992
    v_mfma_f32_16x16x32_bf16 v[108:111], v[44:47], v[28:31], v[108:111]
    ds_read_b64_tr_b16 v[80:81], v252 offset:28672
    s_lshl1_add_u32 m0, s33, 50176
    v_mfma_f32_16x16x32_bf16 v[112:115], v[44:47], v[32:35], v[112:115]
    ds_read_b64_tr_b16 v[82:83], v252 offset:29184
    ds_read_b64_tr_b16 v[84:85], v253 offset:28672
    v_mfma_f32_16x16x32_bf16 v[116:119], v[44:47], v[36:39], v[116:119]
    ds_read_b64_tr_b16 v[86:87], v253 offset:29184
    buffer_load_dwordx4 v255, s[60:63], s83 offen lds
    s_waitcnt lgkmcnt(14)
    v_mfma_f32_16x16x32_bf16 v[120:123], v[48:51], v[24:27], v[120:123]
    v_mfma_f32_16x16x32_bf16 v[124:127], v[48:51], v[28:31], v[124:127]
    s_lshl1_add_u32 m0, s33, 57344
    v_mfma_f32_16x16x32_bf16 v[128:131], v[48:51], v[32:35], v[128:131]
    v_mfma_f32_16x16x32_bf16 v[132:135], v[48:51], v[36:39], v[132:135]
    buffer_load_dwordx4 v254, s[64:67], s83 offen lds
    s_waitcnt lgkmcnt(12)
    v_mfma_f32_16x16x32_bf16 v[136:139], v[52:55], v[24:27], v[136:139]
    v_mfma_f32_16x16x32_bf16 v[140:143], v[52:55], v[28:31], v[140:143]
    s_lshl1_add_u32 m0, s33, 58368
    v_mfma_f32_16x16x32_bf16 v[144:147], v[52:55], v[32:35], v[144:147]
    v_mfma_f32_16x16x32_bf16 v[148:151], v[52:55], v[36:39], v[148:151]
    buffer_load_dwordx4 v255, s[64:67], s83 offen lds
    s_add_u32 s83, s83, 131072
    s_waitcnt vmcnt(16) lgkmcnt(0)
    s_barrier
    v_mfma_f32_16x16x32_bf16 v[88:91], v[72:75], v[56:59], v[88:91]
    ds_read_b64_tr_b16 v[40:41], v250 offset:16384
    ds_read_b64_tr_b16 v[42:43], v250 offset:16896
    v_mfma_f32_16x16x32_bf16 v[92:95], v[72:75], v[60:63], v[92:95]
    ds_read_b128 v[24:27], v248 offset:0
    s_lshl2_add_u32 m0, s33, 65536
    v_mfma_f32_16x16x32_bf16 v[96:99], v[72:75], v[64:67], v[96:99]
    ds_read_b128 v[28:31], v248 offset:1024
    v_mfma_f32_16x16x32_bf16 v[100:103], v[72:75], v[68:71], v[100:103]
    ds_read_b128 v[32:35], v248 offset:2048
    buffer_load_dwordx4 v18, s[56:59], s82 offen offset:0 sc1 lds
    v_mfma_f32_16x16x32_bf16 v[104:107], v[76:79], v[56:59], v[104:107]
    ds_read_b128 v[36:39], v248 offset:3072
    v_mfma_f32_16x16x32_bf16 v[108:111], v[76:79], v[60:63], v[108:111]
    ds_read_b64_tr_b16 v[44:45], v251 offset:16384
    ds_read_b64_tr_b16 v[46:47], v251 offset:16896
    v_mfma_f32_16x16x32_bf16 v[112:115], v[76:79], v[64:67], v[112:115]
    ds_read_b64_tr_b16 v[48:49], v250 offset:24576
    v_mfma_f32_16x16x32_bf16 v[116:119], v[76:79], v[68:71], v[116:119]
    ds_read_b64_tr_b16 v[50:51], v250 offset:25088
    buffer_load_dwordx4 v18, s[56:59], s82 offen offset:1024 sc1 lds
    v_mfma_f32_16x16x32_bf16 v[120:123], v[80:83], v[56:59], v[120:123]
    ds_read_b64_tr_b16 v[52:53], v251 offset:24576
    v_mfma_f32_16x16x32_bf16 v[124:127], v[80:83], v[60:63], v[124:127]
    ds_read_b64_tr_b16 v[54:55], v251 offset:25088
    v_mfma_f32_16x16x32_bf16 v[128:131], v[80:83], v[64:67], v[128:131]
    v_mfma_f32_16x16x32_bf16 v[132:135], v[80:83], v[68:71], v[132:135]
    buffer_load_dwordx4 v18, s[56:59], s82 offen offset:2048 sc1 lds
    v_mfma_f32_16x16x32_bf16 v[136:139], v[84:87], v[56:59], v[136:139]
    v_mfma_f32_16x16x32_bf16 v[140:143], v[84:87], v[60:63], v[140:143]
    v_mfma_f32_16x16x32_bf16 v[144:147], v[84:87], v[64:67], v[144:147]
    v_mfma_f32_16x16x32_bf16 v[148:151], v[84:87], v[68:71], v[148:151]
    buffer_load_dwordx4 v18, s[56:59], s82 offen offset:3072 sc1 lds
    s_add_u32 s82, s82, 16384
    s_waitcnt lgkmcnt(9)
    v_mfma_f32_16x16x32_bf16 v[88:91], v[40:43], v[24:27], v[88:91]
    ds_read_b64_tr_b16 v[72:73], v250 offset:20480
    ds_read_b64_tr_b16 v[74:75], v250 offset:20992
    s_waitcnt lgkmcnt(10)
    v_mfma_f32_16x16x32_bf16 v[92:95], v[40:43], v[28:31], v[92:95]
    ds_read_b128 v[56:59], v248 offset:8192
    s_lshl1_add_u32 m0, s33, 81920
    s_waitcnt lgkmcnt(10)
    v_mfma_f32_16x16x32_bf16 v[96:99], v[40:43], v[32:35], v[96:99]
    ds_read_b128 v[60:63], v248 offset:9216
    ds_read_b128 v[64:67], v248 offset:10240
    s_waitcnt lgkmcnt(11)
    v_mfma_f32_16x16x32_bf16 v[100:103], v[40:43], v[36:39], v[100:103]
    ds_read_b128 v[68:71], v248 offset:11264
    buffer_load_dwordx4 v254, s[60:63], s83 offen lds
    s_waitcnt lgkmcnt(10)
    v_mfma_f32_16x16x32_bf16 v[104:107], v[44:47], v[24:27], v[104:107]
    ds_read_b64_tr_b16 v[76:77], v251 offset:20480
    ds_read_b64_tr_b16 v[78:79], v251 offset:20992
    v_mfma_f32_16x16x32_bf16 v[108:111], v[44:47], v[28:31], v[108:111]
L_pad4:
    s_cbranch_execz L_vret2
    ds_read_b64_tr_b16 v[80:81], v250 offset:28672
    s_lshl1_add_u32 m0, s33, 82944
    v_mfma_f32_16x16x32_bf16 v[112:115], v[44:47], v[32:35], v[112:115]
    ds_read_b64_tr_b16 v[82:83], v250 offset:29184
    ds_read_b64_tr_b16 v[84:85], v251 offset:28672
    v_mfma_f32_16x16x32_bf16 v[116:119], v[44:47], v[36:39], v[116:119]
    ds_read_b64_tr_b16 v[86:87], v251 offset:29184
    buffer_load_dwordx4 v255, s[60:63], s83 offen lds
    s_waitcnt lgkmcnt(14)
    v_mfma_f32_16x16x32_bf16 v[120:123], v[48:51], v[24:27], v[120:123]
    v_mfma_f32_16x16x32_bf16 v[124:127], v[48:51], v[28:31], v[124:127]
    s_lshl1_add_u32 m0, s33, 90112
    v_mfma_f32_16x16x32_bf16 v[128:131], v[48:51], v[32:35], v[128:131]
    v_mfma_f32_16x16x32_bf16 v[132:135], v[48:51], v[36:39], v[132:135]
    buffer_load_dwordx4 v254, s[64:67], s83 offen lds
    s_waitcnt lgkmcnt(12)
    v_mfma_f32_16x16x32_bf16 v[136:139], v[52:55], v[24:27], v[136:139]
    v_mfma_f32_16x16x32_bf16 v[140:143], v[52:55], v[28:31], v[140:143]
    s_lshl1_add_u32 m0, s33, 91136
    v_mfma_f32_16x16x32_bf16 v[144:147], v[52:55], v[32:35], v[144:147]
    v_mfma_f32_16x16x32_bf16 v[148:151], v[52:55], v[36:39], v[148:151]
    buffer_load_dwordx4 v255, s[64:67], s83 offen lds
    s_add_u32 s83, s83, 131072
    s_waitcnt vmcnt(16) lgkmcnt(0)
    s_barrier
    v_mfma_f32_16x16x32_bf16 v[88:91], v[72:75], v[56:59], v[88:91]
    ds_read_b64_tr_b16 v[40:41], v252 offset:49152
    ds_read_b64_tr_b16 v[42:43], v252 offset:49664
    v_mfma_f32_16x16x32_bf16 v[92:95], v[72:75], v[60:63], v[92:95]
    ds_read_b128 v[24:27], v249 offset:32768
    s_lshl_b32 m0, s33, 2
    v_mfma_f32_16x16x32_bf16 v[96:99], v[72:75], v[64:67], v[96:99]
    ds_read_b128 v[28:31], v249 offset:33792
    v_mfma_f32_16x16x32_bf16 v[100:103], v[72:75], v[68:71], v[100:103]
    ds_read_b128 v[32:35], v249 offset:34816
    buffer_load_dwordx4 v18, s[56:59], s82 offen offset:0 sc1 lds
    v_mfma_f32_16x16x32_bf16 v[104:107], v[76:79], v[56:59], v[104:107]
    ds_read_b128 v[36:39], v249 offset:35840
    v_mfma_f32_16x16x32_bf16 v[108:111], v[76:79], v[60:63], v[108:111]
    ds_read_b64_tr_b16 v[44:45], v253 offset:49152
    ds_read_b64_tr_b16 v[46:47], v253 offset:49664
    v_mfma_f32_16x16x32_bf16 v[112:115], v[76:79], v[64:67], v[112:115]
    ds_read_b64_tr_b16 v[48:49], v252 offset:57344
    v_mfma_f32_16x16x32_bf16 v[116:119], v[76:79], v[68:71], v[116:119]
    ds_read_b64_tr_b16 v[50:51], v252 offset:57856
    buffer_load_dwordx4 v18, s[56:59], s82 offen offset:1024 sc1 lds
    v_mfma_f32_16x16x32_bf16 v[120:123], v[80:83], v[56:59], v[120:123]
    ds_read_b64_tr_b16 v[52:53], v253 offset:57344
    v_mfma_f32_16x16x32_bf16 v[124:127], v[80:83], v[60:63], v[124:127]
    ds_read_b64_tr_b16 v[54:55], v253 offset:57856
    v_mfma_f32_16x16x32_bf16 v[128:131], v[80:83], v[64:67], v[128:131]
    v_mfma_f32_16x16x32_bf16 v[132:135], v[80:83], v[68:71], v[132:135]
    buffer_load_dwordx4 v18, s[56:59], s82 offen offset:2048 sc1 lds
    v_mfma_f32_16x16x32_bf16 v[136:139], v[84:87], v[56:59], v[136:139]
    v_mfma_f32_16x16x32_bf16 v[140:143], v[84:87], v[60:63], v[140:143]
    v_mfma_f32_16x16x32_bf16 v[144:147], v[84:87], v[64:67], v[144:147]
    v_mfma_f32_16x16x32_bf16 v[148:151], v[84:87], v[68:71], v[148:151]
    buffer_load_dwordx4 v18, s[56:59], s82 offen offset:3072 sc1 lds
    s_add_u32 s82, s82, 16384
    s_waitcnt lgkmcnt(9)
    v_mfma_f32_16x16x32_bf16 v[88:91], v[40:43], v[24:27], v[88:91]
    ds_read_b64_tr_b16 v[72:73], v252 offset:53248
    ds_read_b64_tr_b16 v[74:75], v252 offset:53760
    s_waitcnt lgkmcnt(10)
    v_mfma_f32_16x16x32_bf16 v[92:95], v[40:43], v[28:31], v[92:95]
    ds_read_b128 v[56:59], v249 offset:40960
    s_lshl1_add_u32 m0, s33, 16384
    s_waitcnt lgkmcnt(10)
    v_mfma_f32_16x16x32_bf16 v[96:99], v[40:43], v[32:35], v[96:99]
    ds_read_b128 v[60:63], v249 offset:41984
    ds_read_b128 v[64:67], v249 offset:43008
    s_waitcnt lgkmcnt(11)
    v_mfma_f32_16x16x32_bf16 v[100:103], v[40:43], v[36:39], v[100:103]
    ds_read_b128 v[68:71], v249 offset:44032
    buffer_load_dwordx4 v254, s[60:63], s83 offen lds
    s_waitcnt lgkmcnt(10)
    v_mfma_f32_16x16x32_bf16 v[104:107], v[44:47], v[24:27], v[104:107]
    ds_read_b64_tr_b16 v[76:77], v253 offset:53248
    ds_read_b64_tr_b16 v[78:79], v253 offset:53760
    v_mfma_f32_16x16x32_bf16 v[108:111], v[44:47], v[28:31], v[108:111]
    ds_read_b64_tr_b16 v[80:81], v252 offset:61440
    s_lshl1_add_u32 m0, s33, 17408
    v_mfma_f32_16x16x32_bf16 v[112:115], v[44:47], v[32:35], v[112:115]
    ds_read_b64_tr_b16 v[82:83], v252 offset:61952
    ds_read_b64_tr_b16 v[84:85], v253 offset:61440
    v_mfma_f32_16x16x32_bf16 v[116:119], v[44:47], v[36:39], v[116:119]
    ds_read_b64_tr_b16 v[86:87], v253 offset:61952
    buffer_load_dwordx4 v255, s[60:63], s83 offen lds
    s_waitcnt lgkmcnt(14)
    v_mfma_f32_16x16x32_bf16 v[120:123], v[48:51], v[24:27], v[120:123]
    v_mfma_f32_16x16x32_bf16 v[124:127], v[48:51], v[28:31], v[124:127]
    s_lshl1_add_u32 m0, s33, 24576
    v_mfma_f32_16x16x32_bf16 v[128:131], v[48:51], v[32:35], v[128:131]
    v_mfma_f32_16x16x32_bf16 v[132:135], v[48:51], v[36:39], v[132:135]
    buffer_load_dwordx4 v254, s[64:67], s83 offen lds
    s_waitcnt lgkmcnt(12)
    v_mfma_f32_16x16x32_bf16 v[136:139], v[52:55], v[24:27], v[136:139]
    v_mfma_f32_16x16x32_bf16 v[140:143], v[52:55], v[28:31], v[140:143]
    s_lshl1_add_u32 m0, s33, 25600
    v_mfma_f32_16x16x32_bf16 v[144:147], v[52:55], v[32:35], v[144:147]
    v_mfma_f32_16x16x32_bf16 v[148:151], v[52:55], v[36:39], v[148:151]
    buffer_load_dwordx4 v255, s[64:67], s83 offen lds
    s_add_u32 s83, s83, 131072
    s_waitcnt vmcnt(16) lgkmcnt(0)
    s_barrier
    v_mfma_f32_16x16x32_bf16 v[88:91], v[72:75], v[56:59], v[88:91]
    ds_read_b64_tr_b16 v[40:41], v250 offset:49152
    ds_read_b64_tr_b16 v[42:43], v250 offset:49664
    v_mfma_f32_16x16x32_bf16 v[92:95], v[72:75], v[60:63], v[92:95]
    ds_read_b128 v[24:27], v248 offset:32768
    s_lshl2_add_u32 m0, s33, 98304
    v_mfma_f32_16x16x32_bf16 v[96:99], v[72:75], v[64:67], v[96:99]
    ds_read_b128 v[28:31], v248 offset:33792
    v_mfma_f32_16x16x32_bf16 v[100:103], v[72:75], v[68:71], v[100:103]
    ds_read_b128 v[32:35], v248 offset:34816
    buffer_load_dwordx4 v18, s[56:59], s82 offen offset:0 sc1 lds
    v_mfma_f32_16x16x32_bf16 v[104:107], v[76:79], v[56:59], v[104:107]
    ds_read_b128 v[36:39], v248 offset:35840
    v_mfma_f32_16x16x32_bf16 v[108:111], v[76:79], v[60:63], v[108:111]
    ds_read_b64_tr_b16 v[44:45], v251 offset:49152
    ds_read_b64_tr_b16 v[46:47], v251 offset:49664
    v_mfma_f32_16x16x32_bf16 v[112:115], v[76:79], v[64:67], v[112:115]
    ds_read_b64_tr_b16 v[48:49], v250 offset:57344
    v_mfma_f32_16x16x32_bf16 v[116:119], v[76:79], v[68:71], v[116:119]
    ds_read_b64_tr_b16 v[50:51], v250 offset:57856
    buffer_load_dwordx4 v18, s[56:59], s82 offen offset:1024 sc1 lds
    v_mfma_f32_16x16x32_bf16 v[120:123], v[80:83], v[56:59], v[120:123]
    ds_read_b64_tr_b16 v[52:53], v251 offset:57344
    v_mfma_f32_16x16x32_bf16 v[124:127], v[80:83], v[60:63], v[124:127]
    ds_read_b64_tr_b16 v[54:55], v251 offset:57856
    v_mfma_f32_16x16x32_bf16 v[128:131], v[80:83], v[64:67], v[128:131]
    v_mfma_f32_16x16x32_bf16 v[132:135], v[80:83], v[68:71], v[132:135]
    buffer_load_dwordx4 v18, s[56:59], s82 offen offset:2048 sc1 lds
    v_mfma_f32_16x16x32_bf16 v[136:139], v[84:87], v[56:59], v[136:139]
    v_mfma_f32_16x16x32_bf16 v[140:143], v[84:87], v[60:63], v[140:143]
    v_mfma_f32_16x16x32_bf16 v[144:147], v[84:87], v[64:67], v[144:147]
    v_mfma_f32_16x16x32_bf16 v[148:151], v[84:87], v[68:71], v[148:151]
    buffer_load_dwordx4 v18, s[56:59], s82 offen offset:3072 sc1 lds
    s_add_u32 s82, s82, 16384
    s_waitcnt lgkmcnt(9)
    v_mfma_f32_16x16x32_bf16 v[88:91], v[40:43], v[24:27], v[88:91]
    ds_read_b64_tr_b16 v[72:73], v250 offset:53248
    ds_read_b64_tr_b16 v[74:75], v250 offset:53760
    s_waitcnt lgkmcnt(10)
    v_mfma_f32_16x16x32_bf16 v[92:95], v[40:43], v[28:31], v[92:95]
    ds_read_b128 v[56:59], v248 offset:40960
    s_lshl1_add_u32 m0, s33, 114688
    s_waitcnt lgkmcnt(10)
    v_mfma_f32_16x16x32_bf16 v[96:99], v[40:43], v[32:35], v[96:99]
    ds_read_b128 v[60:63], v248 offset:41984
    ds_read_b128 v[64:67], v248 offset:43008
    s_waitcnt lgkmcnt(11)
    v_mfma_f32_16x16x32_bf16 v[100:103], v[40:43], v[36:39], v[100:103]
    ds_read_b128 v[68:71], v248 offset:44032
    buffer_load_dwordx4 v254, s[60:63], s83 offen lds
    s_waitcnt lgkmcnt(10)
    v_mfma_f32_16x16x32_bf16 v[104:107], v[44:47], v[24:27], v[104:107]
    ds_read_b64_tr_b16 v[76:77], v251 offset:53248
    ds_read_b64_tr_b16 v[78:79], v251 offset:53760
    v_mfma_f32_16x16x32_bf16 v[108:111], v[44:47], v[28:31], v[108:111]
    ds_read_b64_tr_b16 v[80:81], v250 offset:61440
    s_lshl1_add_u32 m0, s33, 115712
    v_mfma_f32_16x16x32_bf16 v[112:115], v[44:47], v[32:35], v[112:115]
    ds_read_b64_tr_b16 v[82:83], v250 offset:61952
    ds_read_b64_tr_b16 v[84:85], v251 offset:61440
    v_mfma_f32_16x16x32_bf16 v[116:119], v[44:47], v[36:39], v[116:119]
    ds_read_b64_tr_b16 v[86:87], v251 offset:61952
    buffer_load_dwordx4 v255, s[60:63], s83 offen lds
    s_waitcnt lgkmcnt(14)
    v_mfma_f32_16x16x32_bf16 v[120:123], v[48:51], v[24:27], v[120:123]
    v_mfma_f32_16x16x32_bf16 v[124:127], v[48:51], v[28:31], v[124:127]
    s_lshl1_add_u32 m0, s33, 122880
    v_mfma_f32_16x16x32_bf16 v[128:131], v[48:51], v[32:35], v[128:131]
    v_mfma_f32_16x16x32_bf16 v[132:135], v[48:51], v[36:39], v[132:135]
    buffer_load_dwordx4 v254, s[64:67], s83 offen lds
    s_waitcnt lgkmcnt(12)
    v_mfma_f32_16x16x32_bf16 v[136:139], v[52:55], v[24:27], v[136:139]
    v_mfma_f32_16x16x32_bf16 v[140:143], v[52:55], v[28:31], v[140:143]
    s_lshl1_add_u32 m0, s33, 123904
    v_mfma_f32_16x16x32_bf16 v[144:147], v[52:55], v[32:35], v[144:147]
    v_mfma_f32_16x16x32_bf16 v[148:151], v[52:55], v[36:39], v[148:151]
    buffer_load_dwordx4 v255, s[64:67], s83 offen lds
    s_add_u32 s83, s83, 131072
    s_waitcnt vmcnt(16) lgkmcnt(0)
    s_barrier
    v_mfma_f32_16x16x32_bf16 v[88:91], v[72:75], v[56:59], v[88:91]
    ds_read_b64_tr_b16 v[40:41], v252 offset:16384
    ds_read_b64_tr_b16 v[42:43], v252 offset:16896
    v_mfma_f32_16x16x32_bf16 v[92:95], v[72:75], v[60:63], v[92:95]
    ds_read_b128 v[24:27], v249 offset:0
    s_lshl2_add_u32 m0, s33, 32768
    v_mfma_f32_16x16x32_bf16 v[96:99], v[72:75], v[64:67], v[96:99]
    ds_read_b128 v[28:31], v249 offset:1024
    v_mfma_f32_16x16x32_bf16 v[100:103], v[72:75], v[68:71], v[100:103]
    ds_read_b128 v[32:35], v249 offset:2048
    buffer_load_dwordx4 v18, s[56:59], s82 offen offset:0 sc1 lds
    v_mfma_f32_16x16x32_bf16 v[104:107], v[76:79], v[56:59], v[104:107]
    ds_read_b128 v[36:39], v249 offset:3072
    v_mfma_f32_16x16x32_bf16 v[108:111], v[76:79], v[60:63], v[108:111]
    ds_read_b64_tr_b16 v[44:45], v253 offset:16384
    ds_read_b64_tr_b16 v[46:47], v253 offset:16896
    v_mfma_f32_16x16x32_bf16 v[112:115], v[76:79], v[64:67], v[112:115]
    ds_read_b64_tr_b16 v[48:49], v252 offset:24576
    v_mfma_f32_16x16x32_bf16 v[116:119], v[76:79], v[68:71], v[116:119]
    ds_read_b64_tr_b16 v[50:51], v252 offset:25088
    buffer_load_dwordx4 v18, s[56:59], s82 offen offset:1024 sc1 lds
    v_mfma_f32_16x16x32_bf16 v[120:123], v[80:83], v[56:59], v[120:123]
    ds_read_b64_tr_b16 v[52:53], v253 offset:24576
    v_mfma_f32_16x16x32_bf16 v[124:127], v[80:83], v[60:63], v[124:127]
    ds_read_b64_tr_b16 v[54:55], v253 offset:25088
    v_mfma_f32_16x16x32_bf16 v[128:131], v[80:83], v[64:67], v[128:131]
    v_mfma_f32_16x16x32_bf16 v[132:135], v[80:83], v[68:71], v[132:135]
    buffer_load_dwordx4 v18, s[56:59], s82 offen offset:2048 sc1 lds
    v_mfma_f32_16x16x32_bf16 v[136:139], v[84:87], v[56:59], v[136:139]
    v_mfma_f32_16x16x32_bf16 v[140:143], v[84:87], v[60:63], v[140:143]
    v_mfma_f32_16x16x32_bf16 v[144:147], v[84:87], v[64:67], v[144:147]
    v_mfma_f32_16x16x32_bf16 v[148:151], v[84:87], v[68:71], v[148:151]
    buffer_load_dwordx4 v18, s[56:59], s82 offen offset:3072 sc1 lds
    s_add_u32 s82, s82, 16384
    s_waitcnt lgkmcnt(9)
    v_mfma_f32_16x16x32_bf16 v[88:91], v[40:43], v[24:27], v[88:91]
    ds_read_b64_tr_b16 v[72:73], v252 offset:20480
    ds_read_b64_tr_b16 v[74:75], v252 offset:20992
    s_waitcnt lgkmcnt(10)
    v_mfma_f32_16x16x32_bf16 v[92:95], v[40:43], v[28:31], v[92:95]
    ds_read_b128 v[56:59], v249 offset:8192
    s_lshl1_add_u32 m0, s33, 49152
    s_waitcnt lgkmcnt(10)
    v_mfma_f32_16x16x32_bf16 v[96:99], v[40:43], v[32:35], v[96:99]
    ds_read_b128 v[60:63], v249 offset:9216
    ds_read_b128 v[64:67], v249 offset:10240
    s_waitcnt lgkmcnt(11)
    v_mfma_f32_16x16x32_bf16 v[100:103], v[40:43], v[36:39], v[100:103]
    ds_read_b128 v[68:71], v249 offset:11264
    buffer_load_dwordx4 v254, s[60:63], s83 offen lds
    s_waitcnt lgkmcnt(10)
    v_mfma_f32_16x16x32_bf16 v[104:107], v[44:47], v[24:27], v[104:107]
    ds_read_b64_tr_b16 v[76:77], v253 offset:20480
    ds_read_b64_tr_b16 v[78:79], v253 offset:20992
    v_mfma_f32_16x16x32_bf16 v[108:111], v[44:47], v[28:31], v[108:111]
    ds_read_b64_tr_b16 v[80:81], v252 offset:28672
    s_lshl1_add_u32 m0, s33, 50176
    v_mfma_f32_16x16x32_bf16 v[112:115], v[44:47], v[32:35], v[112:115]
    ds_read_b64_tr_b16 v[82:83], v252 offset:29184
    ds_read_b64_tr_b16 v[84:85], v253 offset:28672
    v_mfma_f32_16x16x32_bf16 v[116:119], v[44:47], v[36:39], v[116:119]
    ds_read_b64_tr_b16 v[86:87], v253 offset:29184
    buffer_load_dwordx4 v255, s[60:63], s83 offen lds
    s_waitcnt lgkmcnt(14)
    v_mfma_f32_16x16x32_bf16 v[120:123], v[48:51], v[24:27], v[120:123]
    v_mfma_f32_16x16x32_bf16 v[124:127], v[48:51], v[28:31], v[124:127]
    s_lshl1_add_u32 m0, s33, 57344
    v_mfma_f32_16x16x32_bf16 v[128:131], v[48:51], v[32:35], v[128:131]
    v_mfma_f32_16x16x32_bf16 v[132:135], v[48:51], v[36:39], v[132:135]
    buffer_load_dwordx4 v254, s[64:67], s83 offen lds
    s_waitcnt lgkmcnt(12)
    v_mfma_f32_16x16x32_bf16 v[136:139], v[52:55], v[24:27], v[136:139]
    v_mfma_f32_16x16x32_bf16 v[140:143], v[52:55], v[28:31], v[140:143]
    s_lshl1_add_u32 m0, s33, 58368
    v_mfma_f32_16x16x32_bf16 v[144:147], v[52:55], v[32:35], v[144:147]
    v_mfma_f32_16x16x32_bf16 v[148:151], v[52:55], v[36:39], v[148:151]
    buffer_load_dwordx4 v255, s[64:67], s83 offen lds
    s_add_u32 s83, s83, 131072
    s_waitcnt vmcnt(16) lgkmcnt(0)
    s_barrier
    v_mfma_f32_16x16x32_bf16 v[88:91], v[72:75], v[56:59], v[88:91]
    ds_read_b64_tr_b16 v[40:41], v250 offset:16384
    ds_read_b64_tr_b16 v[42:43], v250 offset:16896
    v_mfma_f32_16x16x32_bf16 v[92:95], v[72:75], v[60:63], v[92:95]
    ds_read_b128 v[24:27], v248 offset:0
    s_lshl2_add_u32 m0, s33, 65536
    v_mfma_f32_16x16x32_bf16 v[96:99], v[72:75], v[64:67], v[96:99]
    ds_read_b128 v[28:31], v248 offset:1024
    v_mfma_f32_16x16x32_bf16 v[100:103], v[72:75], v[68:71], v[100:103]
    ds_read_b128 v[32:35], v248 offset:2048
    buffer_load_dwordx4 v18, s[56:59], s82 offen offset:0 sc1 lds
    v_mfma_f32_16x16x32_bf16 v[104:107], v[76:79], v[56:59], v[104:107]
    ds_read_b128 v[36:39], v248 offset:3072
    v_mfma_f32_16x16x32_bf16 v[108:111], v[76:79], v[60:63], v[108:111]
    ds_read_b64_tr_b16 v[44:45], v251 offset:16384
    ds_read_b64_tr_b16 v[46:47], v251 offset:16896
    v_mfma_f32_16x16x32_bf16 v[112:115], v[76:79], v[64:67], v[112:115]
    ds_read_b64_tr_b16 v[48:49], v250 offset:24576
    v_mfma_f32_16x16x32_bf16 v[116:119], v[76:79], v[68:71], v[116:119]
    ds_read_b64_tr_b16 v[50:51], v250 offset:25088
    buffer_load_dwordx4 v18, s[56:59], s82 offen offset:1024 sc1 lds
    v_mfma_f32_16x16x32_bf16 v[120:123], v[80:83], v[56:59], v[120:123]
    ds_read_b64_tr_b16 v[52:53], v251 offset:24576
    v_mfma_f32_16x16x32_bf16 v[124:127], v[80:83], v[60:63], v[124:127]
    ds_read_b64_tr_b16 v[54:55], v251 offset:25088
    v_mfma_f32_16x16x32_bf16 v[128:131], v[80:83], v[64:67], v[128:131]
    v_mfma_f32_16x16x32_bf16 v[132:135], v[80:83], v[68:71], v[132:135]
    buffer_load_dwordx4 v18, s[56:59], s82 offen offset:2048 sc1 lds
    v_mfma_f32_16x16x32_bf16 v[136:139], v[84:87], v[56:59], v[136:139]
    v_mfma_f32_16x16x32_bf16 v[140:143], v[84:87], v[60:63], v[140:143]
    v_mfma_f32_16x16x32_bf16 v[144:147], v[84:87], v[64:67], v[144:147]
    v_mfma_f32_16x16x32_bf16 v[148:151], v[84:87], v[68:71], v[148:151]
    buffer_load_dwordx4 v18, s[56:59], s82 offen offset:3072 sc1 lds
    s_add_u32 s82, s82, 16384
    s_waitcnt lgkmcnt(9)
    v_mfma_f32_16x16x32_bf16 v[88:91], v[40:43], v[24:27], v[88:91]
    ds_read_b64_tr_b16 v[72:73], v250 offset:20480
    ds_read_b64_tr_b16 v[74:75], v250 offset:20992
    s_waitcnt lgkmcnt(10)
    v_mfma_f32_16x16x32_bf16 v[92:95], v[40:43], v[28:31], v[92:95]
    ds_read_b128 v[56:59], v248 offset:8192
    s_waitcnt lgkmcnt(10)
    v_mfma_f32_16x16x32_bf16 v[96:99], v[40:43], v[32:35], v[96:99]
    ds_read_b128 v[60:63], v248 offset:9216
    ds_read_b128 v[64:67], v248 offset:10240
    s_waitcnt lgkmcnt(11)
    v_mfma_f32_16x16x32_bf16 v[100:103], v[40:43], v[36:39], v[100:103]
    ds_read_b128 v[68:71], v248 offset:11264
    s_waitcnt lgkmcnt(10)
    v_mfma_f32_16x16x32_bf16 v[104:107], v[44:47], v[24:27], v[104:107]
    ds_read_b64_tr_b16 v[76:77], v251 offset:20480
    ds_read_b64_tr_b16 v[78:79], v251 offset:20992
    v_mfma_f32_16x16x32_bf16 v[108:111], v[44:47], v[28:31], v[108:111]
    ds_read_b64_tr_b16 v[80:81], v250 offset:28672
    v_mfma_f32_16x16x32_bf16 v[112:115], v[44:47], v[32:35], v[112:115]
    ds_read_b64_tr_b16 v[82:83], v250 offset:29184
    ds_read_b64_tr_b16 v[84:85], v251 offset:28672
    v_mfma_f32_16x16x32_bf16 v[116:119], v[44:47], v[36:39], v[116:119]
    ds_read_b64_tr_b16 v[86:87], v251 offset:29184
    s_waitcnt lgkmcnt(14)
    v_mfma_f32_16x16x32_bf16 v[120:123], v[48:51], v[24:27], v[120:123]
    v_mfma_f32_16x16x32_bf16 v[124:127], v[48:51], v[28:31], v[124:127]
    v_mfma_f32_16x16x32_bf16 v[128:131], v[48:51], v[32:35], v[128:131]
    v_mfma_f32_16x16x32_bf16 v[132:135], v[48:51], v[36:39], v[132:135]
    s_waitcnt lgkmcnt(12)
    v_mfma_f32_16x16x32_bf16 v[136:139], v[52:55], v[24:27], v[136:139]
    v_mfma_f32_16x16x32_bf16 v[140:143], v[52:55], v[28:31], v[140:143]
    v_mfma_f32_16x16x32_bf16 v[144:147], v[52:55], v[32:35], v[144:147]
    v_mfma_f32_16x16x32_bf16 v[148:151], v[52:55], v[36:39], v[148:151]
    s_waitcnt vmcnt(12) lgkmcnt(0)
    s_barrier
    v_mfma_f32_16x16x32_bf16 v[88:91], v[72:75], v[56:59], v[88:91]
    ds_read_b64_tr_b16 v[40:41], v252 offset:49152
    ds_read_b64_tr_b16 v[42:43], v252 offset:49664
    v_mfma_f32_16x16x32_bf16 v[92:95], v[72:75], v[60:63], v[92:95]
    ds_read_b128 v[24:27], v249 offset:32768
    v_mfma_f32_16x16x32_bf16 v[96:99], v[72:75], v[64:67], v[96:99]
    ds_read_b128 v[28:31], v249 offset:33792
    v_mfma_f32_16x16x32_bf16 v[100:103], v[72:75], v[68:71], v[100:103]
    ds_read_b128 v[32:35], v249 offset:34816
    v_mfma_f32_16x16x32_bf16 v[104:107], v[76:79], v[56:59], v[104:107]
    ds_read_b128 v[36:39], v249 offset:35840
    v_mfma_f32_16x16x32_bf16 v[108:111], v[76:79], v[60:63], v[108:111]
    ds_read_b64_tr_b16 v[44:45], v253 offset:49152
    ds_read_b64_tr_b16 v[46:47], v253 offset:49664
    v_mfma_f32_16x16x32_bf16 v[112:115], v[76:79], v[64:67], v[112:115]
    ds_read_b64_tr_b16 v[48:49], v252 offset:57344
    v_mfma_f32_16x16x32_bf16 v[116:119], v[76:79], v[68:71], v[116:119]
    ds_read_b64_tr_b16 v[50:51], v252 offset:57856
    v_mfma_f32_16x16x32_bf16 v[120:123], v[80:83], v[56:59], v[120:123]
    ds_read_b64_tr_b16 v[52:53], v253 offset:57344
    v_mfma_f32_16x16x32_bf16 v[124:127], v[80:83], v[60:63], v[124:127]
    ds_read_b64_tr_b16 v[54:55], v253 offset:57856
    v_mfma_f32_16x16x32_bf16 v[128:131], v[80:83], v[64:67], v[128:131]
    v_mfma_f32_16x16x32_bf16 v[132:135], v[80:83], v[68:71], v[132:135]
    v_mfma_f32_16x16x32_bf16 v[136:139], v[84:87], v[56:59], v[136:139]
    s_mov_b64 exec, 3
    global_load_dwordx3 v[236:238], v239, s[26:27] sc1
    s_mov_b64 exec, -1
    v_mfma_f32_16x16x32_bf16 v[140:143], v[84:87], v[60:63], v[140:143]
    v_mfma_f32_16x16x32_bf16 v[144:147], v[84:87], v[64:67], v[144:147]
    v_mfma_f32_16x16x32_bf16 v[148:151], v[84:87], v[68:71], v[148:151]
    s_waitcnt lgkmcnt(9)
    v_mfma_f32_16x16x32_bf16 v[88:91], v[40:43], v[24:27], v[88:91]
    ds_read_b64_tr_b16 v[72:73], v252 offset:53248
    ds_read_b64_tr_b16 v[74:75], v252 offset:53760
    s_waitcnt lgkmcnt(10)
    v_mfma_f32_16x16x32_bf16 v[92:95], v[40:43], v[28:31], v[92:95]
    ds_read_b128 v[56:59], v249 offset:40960
    s_waitcnt lgkmcnt(10)
    v_mfma_f32_16x16x32_bf16 v[96:99], v[40:43], v[32:35], v[96:99]
    ds_read_b128 v[60:63], v249 offset:41984
    ds_read_b128 v[64:67], v249 offset:43008
    s_waitcnt lgkmcnt(11)
    v_mfma_f32_16x16x32_bf16 v[100:103], v[40:43], v[36:39], v[100:103]
    ds_read_b128 v[68:71], v249 offset:44032
    s_waitcnt lgkmcnt(10)
    v_mfma_f32_16x16x32_bf16 v[104:107], v[44:47], v[24:27], v[104:107]
    ds_read_b64_tr_b16 v[76:77], v253 offset:53248
    ds_read_b64_tr_b16 v[78:79], v253 offset:53760
    v_mfma_f32_16x16x32_bf16 v[108:111], v[44:47], v[28:31], v[108:111]
    ds_read_b64_tr_b16 v[80:81], v252 offset:61440
    v_mfma_f32_16x16x32_bf16 v[112:115], v[44:47], v[32:35], v[112:115]
    ds_read_b64_tr_b16 v[82:83], v252 offset:61952
    ds_read_b64_tr_b16 v[84:85], v253 offset:61440
    v_mfma_f32_16x16x32_bf16 v[116:119], v[44:47], v[36:39], v[116:119]
    ds_read_b64_tr_b16 v[86:87], v253 offset:61952
    s_waitcnt lgkmcnt(14)
    v_mfma_f32_16x16x32_bf16 v[120:123], v[48:51], v[24:27], v[120:123]
    v_mfma_f32_16x16x32_bf16 v[124:127], v[48:51], v[28:31], v[124:127]
    v_mfma_f32_16x16x32_bf16 v[128:131], v[48:51], v[32:35], v[128:131]
    v_mfma_f32_16x16x32_bf16 v[132:135], v[48:51], v[36:39], v[132:135]
    s_waitcnt lgkmcnt(12)
    v_mfma_f32_16x16x32_bf16 v[136:139], v[52:55], v[24:27], v[136:139]
    v_mfma_f32_16x16x32_bf16 v[140:143], v[52:55], v[28:31], v[140:143]
    v_mfma_f32_16x16x32_bf16 v[144:147], v[52:55], v[32:35], v[144:147]
    v_mfma_f32_16x16x32_bf16 v[148:151], v[52:55], v[36:39], v[148:151]
    s_waitcnt vmcnt(5) lgkmcnt(0)
    s_barrier
    v_mfma_f32_16x16x32_bf16 v[88:91], v[72:75], v[56:59], v[88:91]
    ds_read_b64_tr_b16 v[40:41], v250 offset:49152
    ds_read_b64_tr_b16 v[42:43], v250 offset:49664
    v_mfma_f32_16x16x32_bf16 v[92:95], v[72:75], v[60:63], v[92:95]
    ds_read_b128 v[24:27], v248 offset:32768
    v_mfma_f32_16x16x32_bf16 v[96:99], v[72:75], v[64:67], v[96:99]
    ds_read_b128 v[28:31], v248 offset:33792
    v_mfma_f32_16x16x32_bf16 v[100:103], v[72:75], v[68:71], v[100:103]
    ds_read_b128 v[32:35], v248 offset:34816
    v_mfma_f32_16x16x32_bf16 v[104:107], v[76:79], v[56:59], v[104:107]
    ds_read_b128 v[36:39], v248 offset:35840
    v_mfma_f32_16x16x32_bf16 v[108:111], v[76:79], v[60:63], v[108:111]
    ds_read_b64_tr_b16 v[44:45], v251 offset:49152
    ds_read_b64_tr_b16 v[46:47], v251 offset:49664
    v_mfma_f32_16x16x32_bf16 v[112:115], v[76:79], v[64:67], v[112:115]
    ds_read_b64_tr_b16 v[48:49], v250 offset:57344
    v_mfma_f32_16x16x32_bf16 v[116:119], v[76:79], v[68:71], v[116:119]
    ds_read_b64_tr_b16 v[50:51], v250 offset:57856
    v_mfma_f32_16x16x32_bf16 v[120:123], v[80:83], v[56:59], v[120:123]
    ds_read_b64_tr_b16 v[52:53], v251 offset:57344
    v_mfma_f32_16x16x32_bf16 v[124:127], v[80:83], v[60:63], v[124:127]
    ds_read_b64_tr_b16 v[54:55], v251 offset:57856
    v_mfma_f32_16x16x32_bf16 v[128:131], v[80:83], v[64:67], v[128:131]
    v_mfma_f32_16x16x32_bf16 v[132:135], v[80:83], v[68:71], v[132:135]
    v_mfma_f32_16x16x32_bf16 v[136:139], v[84:87], v[56:59], v[136:139]
    v_mfma_f32_16x16x32_bf16 v[140:143], v[84:87], v[60:63], v[140:143]
    v_mfma_f32_16x16x32_bf16 v[144:147], v[84:87], v[64:67], v[144:147]
    v_mfma_f32_16x16x32_bf16 v[148:151], v[84:87], v[68:71], v[148:151]
    s_waitcnt lgkmcnt(9)
    v_mfma_f32_16x16x32_bf16 v[88:91], v[40:43], v[24:27], v[88:91]
    ds_read_b64_tr_b16 v[72:73], v250 offset:53248
    ds_read_b64_tr_b16 v[74:75], v250 offset:53760
    s_waitcnt lgkmcnt(10)
    v_mfma_f32_16x16x32_bf16 v[92:95], v[40:43], v[28:31], v[92:95]
    ds_read_b128 v[56:59], v248 offset:40960
    s_waitcnt lgkmcnt(10)
    v_mfma_f32_16x16x32_bf16 v[96:99], v[40:43], v[32:35], v[96:99]
    ds_read_b128 v[60:63], v248 offset:41984
    ds_read_b128 v[64:67], v248 offset:43008
    s_waitcnt lgkmcnt(11)
    v_mfma_f32_16x16x32_bf16 v[100:103], v[40:43], v[36:39], v[100:103]
    ds_read_b128 v[68:71], v248 offset:44032
    s_waitcnt lgkmcnt(10)
    v_mfma_f32_16x16x32_bf16 v[104:107], v[44:47], v[24:27], v[104:107]
    ds_read_b64_tr_b16 v[76:77], v251 offset:53248
    ds_read_b64_tr_b16 v[78:79], v251 offset:53760
    v_mfma_f32_16x16x32_bf16 v[108:111], v[44:47], v[28:31], v[108:111]
    ds_read_b64_tr_b16 v[80:81], v250 offset:61440
    v_mfma_f32_16x16x32_bf16 v[112:115], v[44:47], v[32:35], v[112:115]
    ds_read_b64_tr_b16 v[82:83], v250 offset:61952
    ds_read_b64_tr_b16 v[84:85], v251 offset:61440
    v_mfma_f32_16x16x32_bf16 v[116:119], v[44:47], v[36:39], v[116:119]
    ds_read_b64_tr_b16 v[86:87], v251 offset:61952
    s_waitcnt lgkmcnt(14)
    v_mfma_f32_16x16x32_bf16 v[120:123], v[48:51], v[24:27], v[120:123]
    v_mfma_f32_16x16x32_bf16 v[124:127], v[48:51], v[28:31], v[124:127]
    v_mfma_f32_16x16x32_bf16 v[128:131], v[48:51], v[32:35], v[128:131]
    v_mfma_f32_16x16x32_bf16 v[132:135], v[48:51], v[36:39], v[132:135]
    s_waitcnt lgkmcnt(12)
    v_mfma_f32_16x16x32_bf16 v[136:139], v[52:55], v[24:27], v[136:139]
    v_mfma_f32_16x16x32_bf16 v[140:143], v[52:55], v[28:31], v[140:143]
    v_mfma_f32_16x16x32_bf16 v[144:147], v[52:55], v[32:35], v[144:147]
    v_mfma_f32_16x16x32_bf16 v[148:151], v[52:55], v[36:39], v[148:151]
    s_waitcnt vmcnt(0) lgkmcnt(0)
    s_barrier
    v_mfma_f32_16x16x32_bf16 v[88:91], v[72:75], v[56:59], v[88:91]
    ds_read_b64_tr_b16 v[40:41], v252 offset:16384
    ds_read_b64_tr_b16 v[42:43], v252 offset:16896
    v_readlane_b32 s90, v238, 0
    v_readlane_b32 s91, v238, 1
    v_mfma_f32_16x16x32_bf16 v[92:95], v[72:75], v[60:63], v[92:95]
    ds_read_b128 v[24:27], v249 offset:0
    s_nop 1
    s_sub_u32 s90, s91, s90
    v_mfma_f32_16x16x32_bf16 v[96:99], v[72:75], v[64:67], v[96:99]
    ds_read_b128 v[28:31], v249 offset:1024
    s_abs_i32 s91, s90
    v_mfma_f32_16x16x32_bf16 v[100:103], v[72:75], v[68:71], v[100:103]
    ds_read_b128 v[32:35], v249 offset:2048
    s_min_u32 s91, s91, 0x1000
    s_add_u32 s91, s91, 35
    v_mfma_f32_16x16x32_bf16 v[104:107], v[76:79], v[56:59], v[104:107]
    ds_read_b128 v[36:39], v249 offset:3072
    s_mul_i32 s91, s91, 937
    s_lshr_b32 s91, s91, 16
    v_mfma_f32_16x16x32_bf16 v[108:111], v[76:79], v[60:63], v[108:111]
    ds_read_b64_tr_b16 v[44:45], v253 offset:16384
    ds_read_b64_tr_b16 v[46:47], v253 offset:16896
    s_min_u32 s91, s91, 4
    v_mfma_f32_16x16x32_bf16 v[112:115], v[76:79], v[64:67], v[112:115]
    ds_read_b64_tr_b16 v[48:49], v252 offset:24576
    s_sub_u32 s92, 0, s91
    s_cmp_lt_i32 s90, 0
    v_mfma_f32_16x16x32_bf16 v[116:119], v[76:79], v[68:71], v[116:119]
    ds_read_b64_tr_b16 v[50:51], v252 offset:25088
    s_cselect_b32 s91, s92, s91
    v_mfma_f32_16x16x32_bf16 v[120:123], v[80:83], v[56:59], v[120:123]
    ds_read_b64_tr_b16 v[52:53], v253 offset:24576
    s_add_u32 s34, s91, 16
    s_and_b32 s91, s91, 3
    v_mfma_f32_16x16x32_bf16 v[124:127], v[80:83], v[60:63], v[124:127]
    ds_read_b64_tr_b16 v[54:55], v253 offset:25088
    s_mov_b32 s46, 0x9a69a69a
    s_mov_b32 s47, 0x269a69a6
    v_mfma_f32_16x16x32_bf16 v[128:131], v[80:83], v[64:67], v[128:131]
    s_cmp_eq_u32 s91, 1
    v_mfma_f32_16x16x32_bf16 v[132:135], v[80:83], v[68:71], v[132:135]
    s_cselect_b32 s46, 0xd34d34e6, s46
    s_cselect_b32 s47, 0x34d34d34, s47
    v_mfma_f32_16x16x32_bf16 v[136:139], v[84:87], v[56:59], v[136:139]
    s_cmp_eq_u32 s91, 2
    s_cselect_b32 s46, 0x9a7334e6, s46
    v_mfma_f32_16x16x32_bf16 v[140:143], v[84:87], v[60:63], v[140:143]
    s_cselect_b32 s47, 0x269a69a6, s47
    v_mfma_f32_16x16x32_bf16 v[144:147], v[84:87], v[64:67], v[144:147]
    s_cmp_eq_u32 s91, 3
    s_cselect_b32 s46, 0x9a7334e6, s46
    v_mfma_f32_16x16x32_bf16 v[148:151], v[84:87], v[68:71], v[148:151]
    s_cselect_b32 s47, 0x34d34d39, s47
    s_waitcnt lgkmcnt(9)
    v_mfma_f32_16x16x32_bf16 v[88:91], v[40:43], v[24:27], v[88:91]
    ds_read_b64_tr_b16 v[72:73], v252 offset:20480
    ds_read_b64_tr_b16 v[74:75], v252 offset:20992
    s_waitcnt lgkmcnt(10)
    v_mfma_f32_16x16x32_bf16 v[92:95], v[40:43], v[28:31], v[92:95]
    ds_read_b128 v[56:59], v249 offset:8192
    s_waitcnt lgkmcnt(10)
    v_mfma_f32_16x16x32_bf16 v[96:99], v[40:43], v[32:35], v[96:99]
    ds_read_b128 v[60:63], v249 offset:9216
    ds_read_b128 v[64:67], v249 offset:10240
    s_waitcnt lgkmcnt(11)
    v_mfma_f32_16x16x32_bf16 v[100:103], v[40:43], v[36:39], v[100:103]
    ds_read_b128 v[68:71], v249 offset:11264
    s_waitcnt lgkmcnt(10)
    v_mfma_f32_16x16x32_bf16 v[104:107], v[44:47], v[24:27], v[104:107]
    ds_read_b64_tr_b16 v[76:77], v253 offset:20480
    ds_read_b64_tr_b16 v[78:79], v253 offset:20992
    v_mfma_f32_16x16x32_bf16 v[108:111], v[44:47], v[28:31], v[108:111]
    ds_read_b64_tr_b16 v[80:81], v252 offset:28672
    v_mfma_f32_16x16x32_bf16 v[112:115], v[44:47], v[32:35], v[112:115]
    ds_read_b64_tr_b16 v[82:83], v252 offset:29184
    ds_read_b64_tr_b16 v[84:85], v253 offset:28672
    v_mfma_f32_16x16x32_bf16 v[116:119], v[44:47], v[36:39], v[116:119]
    ds_read_b64_tr_b16 v[86:87], v253 offset:29184
    s_waitcnt lgkmcnt(14)
    v_mfma_f32_16x16x32_bf16 v[120:123], v[48:51], v[24:27], v[120:123]
    v_mfma_f32_16x16x32_bf16 v[124:127], v[48:51], v[28:31], v[124:127]
    s_lshl_b32 s48, s46, 15
L_pad5:
    s_cbranch_execz L_vret2
    s_and_b32 s48, s48, 0x38000
    v_mfma_f32_16x16x32_bf16 v[128:131], v[48:51], v[32:35], v[128:131]
    s_lshr_b64 s[46:47], s[46:47], 3
    v_mfma_f32_16x16x32_bf16 v[132:135], v[48:51], v[36:39], v[132:135]
    v_xor_b32 v252, s48, v252
    s_waitcnt lgkmcnt(12)
    v_mfma_f32_16x16x32_bf16 v[136:139], v[52:55], v[24:27], v[136:139]
    v_xor_b32 v249, s48, v249
    v_mfma_f32_16x16x32_bf16 v[140:143], v[52:55], v[28:31], v[140:143]
    v_xor_b32 v253, s48, v253
    v_mfma_f32_16x16x32_bf16 v[144:147], v[52:55], v[32:35], v[144:147]
    s_sub_u32 s34, s34, 1
    v_mfma_f32_16x16x32_bf16 v[148:151], v[52:55], v[36:39], v[148:151]
.p2align 6
L_dl:
    s_waitcnt lgkmcnt(0)
    s_barrier
    v_mfma_f32_16x16x32_bf16 v[88:91], v[72:75], v[56:59], v[88:91]
    ds_read_b64_tr_b16 v[40:41], v252 offset:16384
    ds_read_b64_tr_b16 v[42:43], v252 offset:16896
    v_mfma_f32_16x16x32_bf16 v[92:95], v[72:75], v[60:63], v[92:95]
    ds_read_b128 v[24:27], v249 offset:0
    v_mfma_f32_16x16x32_bf16 v[96:99], v[72:75], v[64:67], v[96:99]
    ds_read_b128 v[28:31], v249 offset:1024
    v_mfma_f32_16x16x32_bf16 v[100:103], v[72:75], v[68:71], v[100:103]
    ds_read_b128 v[32:35], v249 offset:2048
    v_mfma_f32_16x16x32_bf16 v[104:107], v[76:79], v[56:59], v[104:107]
    ds_read_b128 v[36:39], v249 offset:3072
    v_mfma_f32_16x16x32_bf16 v[108:111], v[76:79], v[60:63], v[108:111]
    ds_read_b64_tr_b16 v[44:45], v253 offset:16384
    ds_read_b64_tr_b16 v[46:47], v253 offset:16896
    v_mfma_f32_16x16x32_bf16 v[112:115], v[76:79], v[64:67], v[112:115]
    ds_read_b64_tr_b16 v[48:49], v252 offset:24576
    v_mfma_f32_16x16x32_bf16 v[116:119], v[76:79], v[68:71], v[116:119]
    ds_read_b64_tr_b16 v[50:51], v252 offset:25088
    v_mfma_f32_16x16x32_bf16 v[120:123], v[80:83], v[56:59], v[120:123]
    ds_read_b64_tr_b16 v[52:53], v253 offset:24576
    v_mfma_f32_16x16x32_bf16 v[124:127], v[80:83], v[60:63], v[124:127]
    ds_read_b64_tr_b16 v[54:55], v253 offset:25088
    v_mfma_f32_16x16x32_bf16 v[128:131], v[80:83], v[64:67], v[128:131]
    v_mfma_f32_16x16x32_bf16 v[132:135], v[80:83], v[68:71], v[132:135]
    v_mfma_f32_16x16x32_bf16 v[136:139], v[84:87], v[56:59], v[136:139]
    v_mfma_f32_16x16x32_bf16 v[140:143], v[84:87], v[60:63], v[140:143]
    v_mfma_f32_16x16x32_bf16 v[144:147], v[84:87], v[64:67], v[144:147]
    v_mfma_f32_16x16x32_bf16 v[148:151], v[84:87], v[68:71], v[148:151]
    s_waitcnt lgkmcnt(9)
    v_mfma_f32_16x16x32_bf16 v[88:91], v[40:43], v[24:27], v[88:91]
    ds_read_b64_tr_b16 v[72:73], v252 offset:20480
    ds_read_b64_tr_b16 v[74:75], v252 offset:20992
    s_waitcnt lgkmcnt(10)
    v_mfma_f32_16x16x32_bf16 v[92:95], v[40:43], v[28:31], v[92:95]
    ds_read_b128 v[56:59], v249 offset:8192
    s_waitcnt lgkmcnt(10)
    v_mfma_f32_16x16x32_bf16 v[96:99], v[40:43], v[32:35], v[96:99]
    ds_read_b128 v[60:63], v249 offset:9216
    ds_read_b128 v[64:67], v249 offset:10240
    s_waitcnt lgkmcnt(11)
    v_mfma_f32_16x16x32_bf16 v[100:103], v[40:43], v[36:39], v[100:103]
    ds_read_b128 v[68:71], v249 offset:11264
    s_waitcnt lgkmcnt(10)
    v_mfma_f32_16x16x32_bf16 v[104:107], v[44:47], v[24:27], v[104:107]
    ds_read_b64_tr_b16 v[76:77], v253 offset:20480
    ds_read_b64_tr_b16 v[78:79], v253 offset:20992
    v_mfma_f32_16x16x32_bf16 v[108:111], v[44:47], v[28:31], v[108:111]
    ds_read_b64_tr_b16 v[80:81], v252 offset:28672
    v_mfma_f32_16x16x32_bf16 v[112:115], v[44:47], v[32:35], v[112:115]
    ds_read_b64_tr_b16 v[82:83], v252 offset:29184
    ds_read_b64_tr_b16 v[84:85], v253 offset:28672
    v_mfma_f32_16x16x32_bf16 v[116:119], v[44:47], v[36:39], v[116:119]
    ds_read_b64_tr_b16 v[86:87], v253 offset:29184
    s_waitcnt lgkmcnt(14)
    v_mfma_f32_16x16x32_bf16 v[120:123], v[48:51], v[24:27], v[120:123]
    v_mfma_f32_16x16x32_bf16 v[124:127], v[48:51], v[28:31], v[124:127]
    s_lshl_b32 s48, s46, 15
    s_and_b32 s48, s48, 0x38000
    v_mfma_f32_16x16x32_bf16 v[128:131], v[48:51], v[32:35], v[128:131]
    s_lshr_b64 s[46:47], s[46:47], 3
    v_mfma_f32_16x16x32_bf16 v[132:135], v[48:51], v[36:39], v[132:135]
    v_xor_b32 v252, s48, v252
    s_waitcnt lgkmcnt(12)
    v_mfma_f32_16x16x32_bf16 v[136:139], v[52:55], v[24:27], v[136:139]
    v_xor_b32 v249, s48, v249
    v_mfma_f32_16x16x32_bf16 v[140:143], v[52:55], v[28:31], v[140:143]
    v_xor_b32 v253, s48, v253
    v_mfma_f32_16x16x32_bf16 v[144:147], v[52:55], v[32:35], v[144:147]
    s_sub_u32 s34, s34, 1
    v_mfma_f32_16x16x32_bf16 v[148:151], v[52:55], v[36:39], v[148:151]
    s_cbranch_scc0 L_dl
    s_waitcnt lgkmcnt(0)
    s_barrier
    v_mfma_f32_16x16x32_bf16 v[88:91], v[72:75], v[56:59], v[88:91]
    v_mfma_f32_16x16x32_bf16 v[92:95], v[72:75], v[60:63], v[92:95]
    v_mfma_f32_16x16x32_bf16 v[96:99], v[72:75], v[64:67], v[96:99]
    v_mfma_f32_16x16x32_bf16 v[100:103], v[72:75], v[68:71], v[100:103]
    v_mfma_f32_16x16x32_bf16 v[104:107], v[76:79], v[56:59], v[104:107]
    v_mfma_f32_16x16x32_bf16 v[108:111], v[76:79], v[60:63], v[108:111]
    v_mfma_f32_16x16x32_bf16 v[112:115], v[76:79], v[64:67], v[112:115]
    v_mfma_f32_16x16x32_bf16 v[116:119], v[76:79], v[68:71], v[116:119]
    v_mfma_f32_16x16x32_bf16 v[120:123], v[80:83], v[56:59], v[120:123]
    v_mfma_f32_16x16x32_bf16 v[124:127], v[80:83], v[60:63], v[124:127]
    v_mfma_f32_16x16x32_bf16 v[128:131], v[80:83], v[64:67], v[128:131]
    v_mfma_f32_16x16x32_bf16 v[132:135], v[80:83], v[68:71], v[132:135]
    v_mfma_f32_16x16x32_bf16 v[136:139], v[84:87], v[56:59], v[136:139]
    v_mfma_f32_16x16x32_bf16 v[140:143], v[84:87], v[60:63], v[140:143]
    v_mfma_f32_16x16x32_bf16 v[144:147], v[84:87], v[64:67], v[144:147]
    v_mfma_f32_16x16x32_bf16 v[148:151], v[84:87], v[68:71], v[148:151]
    s_setprio 0
    s_lshl4_add_u32 s91, s28, s29
    s_xor_b32 s91, s91, 136
    s_lshl_b32 s91, s91, 7
    s_add_u32 s91, s91, 0x1ea0000
    v_mov_b32 v13, s91
    s_nop 7
    v_max_f32_e64 v8, |v120|, |v121|
    v_max_f32_e64 v9, |v128|, |v129|
    v_max_f32_e64 v10, |v136|, |v137|
    v_max_f32_e64 v11, |v144|, |v145|
    v_max3_f32 v8, |v122|, |v123|, v8
    v_max3_f32 v9, |v130|, |v131|, v9
    v_max3_f32 v10, |v138|, |v139|, v10
    v_max3_f32 v11, |v146|, |v147|, v11
    v_max3_f32 v8, |v124|, |v125|, v8
    v_max3_f32 v9, |v132|, |v133|, v9
    v_max3_f32 v10, |v140|, |v141|, v10
    v_max3_f32 v11, |v148|, |v149|, v11
    v_max3_f32 v8, |v126|, |v127|, v8
    v_max3_f32 v9, |v134|, |v135|, v9
    v_max3_f32 v10, |v142|, |v143|, v10
    v_max3_f32 v11, |v150|, |v151|, v11
    v_max3_f32 v8, v8, v9, v10
    v_max_f32 v8, v8, v11
    v_min_f32 v8, 0x7f7fffff, v8
    v_frexp_exp_i32_f32 v8, v8
    v_max_i32 v8, -100, v8
    v_sub_u32 v9, 15, v8
    v_add_u32 v8, -15, v8
    v_ldexp_f32 v9, 1.0, v9
    v_ldexp_f32 v8, 1.0, v8
    buffer_store_dword v8, v6, s[68:71], s37 offen sc1
    v_fma_mixlo_f16 v32, v120, v9, 0
    v_fma_mixlo_f16 v33, v122, v9, 0
    v_fma_mixlo_f16 v34, v124, v9, 0
    v_fma_mixlo_f16 v35, v126, v9, 0
    v_fma_mixhi_f16 v32, v121, v9, 0
    v_fma_mixhi_f16 v33, v123, v9, 0
    v_fma_mixhi_f16 v34, v125, v9, 0
    v_fma_mixhi_f16 v35, v127, v9, 0
    s_nop 0
    buffer_store_dwordx4 v[32:35], v4, s[68:71], s36 offen offset:0 sc1
    v_fma_mixlo_f16 v36, v128, v9, 0
    v_fma_mixlo_f16 v37, v130, v9, 0
    v_fma_mixlo_f16 v38, v132, v9, 0
    v_fma_mixlo_f16 v39, v134, v9, 0
    v_fma_mixhi_f16 v36, v129, v9, 0
    v_fma_mixhi_f16 v37, v131, v9, 0
    v_fma_mixhi_f16 v38, v133, v9, 0
    v_fma_mixhi_f16 v39, v135, v9, 0
    s_nop 0
    buffer_store_dwordx4 v[36:39], v4, s[68:71], s36 offen offset:1024 sc1
    s_barrier
    v_fma_mixlo_f16 v40, v136, v9, 0
    v_fma_mixlo_f16 v41, v138, v9, 0
    v_fma_mixlo_f16 v42, v140, v9, 0
    v_fma_mixlo_f16 v43, v142, v9, 0
    v_fma_mixhi_f16 v40, v137, v9, 0
    v_fma_mixhi_f16 v41, v139, v9, 0
    v_fma_mixhi_f16 v42, v141, v9, 0
    v_fma_mixhi_f16 v43, v143, v9, 0
    s_nop 0
    buffer_store_dwordx4 v[40:43], v4, s[68:71], s36 offen offset:2048 sc1
    v_fma_mixlo_f16 v44, v144, v9, 0
    v_fma_mixlo_f16 v45, v146, v9, 0
    v_fma_mixlo_f16 v46, v148, v9, 0
    v_fma_mixlo_f16 v47, v150, v9, 0
    v_fma_mixhi_f16 v44, v145, v9, 0
    v_fma_mixhi_f16 v45, v147, v9, 0
    v_fma_mixhi_f16 v46, v149, v9, 0
    v_fma_mixhi_f16 v47, v151, v9, 0
    s_nop 0
    buffer_store_dwordx4 v[44:47], v4, s[68:71], s36 offen offset:3072 sc1
    s_barrier
    s_barrier
    s_waitcnt vmcnt(0)
    s_barrier
    s_cmp_lg_u32 s4, 0
    s_cbranch_scc1 L_fP
    s_lshl_b32 s91, s28, 4
    s_add_u32 s91, s91, s29
    s_lshl_b32 s91, s91, 7
    s_add_u32 s91, s91, 0x1ea0000
    v_mov_b32 v16, s91
    v_mov_b32 v18, s100
    v_mov_b32 v19, s101
    s_mov_b64 exec, 1
    global_store_dwordx2 v16, v[18:19], s[26:27] sc1
    s_mov_b64 exec, -1
L_fP:
    s_barrier
    s_mov_b64 exec, 1
    global_load_dwordx2 v[14:15], v13, s[26:27] sc1
    s_mov_b64 exec, -1
    s_barrier
    s_barrier
    s_waitcnt vmcnt(0)
    s_mov_b64 exec, 1
    s_movk_i32 s98, 0x4000
L_pP_chk:
    v_cmp_ne_u64 vcc, s[100:101], v[14:15]
    s_nop 1
    s_cmp_eq_u64 vcc, 0
    s_cbranch_scc1 L_pP_ok
    s_sub_u32 s98, s98, 1
    s_cbranch_scc1 L_pP_ok
    s_sleep 1
    global_load_dwordx2 v[14:15], v13, s[26:27] sc1
    s_waitcnt vmcnt(0)
    s_branch L_pP_chk
L_pP_ok:
    s_mov_b64 exec, -1
    buffer_load_dword v168, v6, s[68:71], s39 offen sc1
    buffer_load_dwordx4 v[152:155], v4, s[68:71], s38 offen offset:0 sc1
    buffer_load_dwordx4 v[156:159], v4, s[68:71], s38 offen offset:1024 sc1
    buffer_load_dwordx4 v[160:163], v4, s[68:71], s38 offen offset:2048 sc1
    buffer_load_dwordx4 v[164:167], v4, s[68:71], s38 offen offset:3072 sc1
    s_barrier
    s_barrier
    s_waitcnt vmcnt(3)
    v_fma_mix_f32 v88, v152, v168, v88 op_sel:[0,0,0] op_sel_hi:[1,0,0]
    v_fma_mix_f32 v89, v152, v168, v89 op_sel:[1,0,0] op_sel_hi:[1,0,0]
    v_fma_mix_f32 v90, v153, v168, v90 op_sel:[0,0,0] op_sel_hi:[1,0,0]
    v_fma_mix_f32 v91, v153, v168, v91 op_sel:[1,0,0] op_sel_hi:[1,0,0]
    v_cvt_pk_bf16_f32 v28, v88, v89
    v_cvt_pk_bf16_f32 v29, v90, v91
    v_lshlrev_b32 v88, 16, v28
    v_and_b32 v89, 0xffff0000, v28
    v_lshlrev_b32 v90, 16, v29
    v_and_b32 v91, 0xffff0000, v29
    v_mul_f32 v24, 0xbfb8aa3b, v88
    v_mul_f32 v25, 0xbfb8aa3b, v89
    v_mul_f32 v26, 0xbfb8aa3b, v90
    v_mul_f32 v27, 0xbfb8aa3b, v91
    v_exp_f32 v24, v24
    v_exp_f32 v25, v25
    v_exp_f32 v26, v26
    v_exp_f32 v27, v27
    s_nop 0
    v_add_f32 v24, 1.0, v24
    v_add_f32 v25, 1.0, v25
    v_add_f32 v26, 1.0, v26
    v_add_f32 v27, 1.0, v27
    v_rcp_f32 v24, v24
    v_rcp_f32 v25, v25
    v_rcp_f32 v26, v26
    v_rcp_f32 v27, v27
    s_nop 0
    v_mul_f32 v24, v24, v88
    v_mul_f32 v25, v25, v89
    v_mul_f32 v26, v26, v90
    v_mul_f32 v27, v27, v91
    v_cvt_pk_bf16_f32 v88, v24, v25
    v_cvt_pk_bf16_f32 v89, v26, v27
    ds_write_b64 v5, v[88:89] offset:0
    v_fma_mix_f32 v92, v154, v168, v92 op_sel:[0,0,0] op_sel_hi:[1,0,0]
    v_fma_mix_f32 v93, v154, v168, v93 op_sel:[1,0,0] op_sel_hi:[1,0,0]
    v_fma_mix_f32 v94, v155, v168, v94 op_sel:[0,0,0] op_sel_hi:[1,0,0]
    v_fma_mix_f32 v95, v155, v168, v95 op_sel:[1,0,0] op_sel_hi:[1,0,0]
    v_cvt_pk_bf16_f32 v28, v92, v93
    v_cvt_pk_bf16_f32 v29, v94, v95
    v_lshlrev_b32 v92, 16, v28
    v_and_b32 v93, 0xffff0000, v28
    v_lshlrev_b32 v94, 16, v29
    v_and_b32 v95, 0xffff0000, v29
    v_mul_f32 v24, 0xbfb8aa3b, v92
    v_mul_f32 v25, 0xbfb8aa3b, v93
    v_mul_f32 v26, 0xbfb8aa3b, v94
    v_mul_f32 v27, 0xbfb8aa3b, v95
    v_exp_f32 v24, v24
    v_exp_f32 v25, v25
    v_exp_f32 v26, v26
    v_exp_f32 v27, v27
    s_nop 0
    v_add_f32 v24, 1.0, v24
    v_add_f32 v25, 1.0, v25
    s_barrier
    v_add_f32 v26, 1.0, v26
    v_add_f32 v27, 1.0, v27
    v_rcp_f32 v24, v24
    v_rcp_f32 v25, v25
    v_rcp_f32 v26, v26
    v_rcp_f32 v27, v27
    s_nop 0
    v_mul_f32 v24, v24, v92
    v_mul_f32 v25, v25, v93
    v_mul_f32 v26, v26, v94
    v_mul_f32 v27, v27, v95
    v_cvt_pk_bf16_f32 v92, v24, v25
    v_cvt_pk_bf16_f32 v93, v26, v27
    ds_write_b64 v5, v[92:93] offset:512
    s_waitcnt vmcnt(2)
    v_fma_mix_f32 v96, v156, v168, v96 op_sel:[0,0,0] op_sel_hi:[1,0,0]
    v_fma_mix_f32 v97, v156, v168, v97 op_sel:[1,0,0] op_sel_hi:[1,0,0]
    v_fma_mix_f32 v98, v157, v168, v98 op_sel:[0,0,0] op_sel_hi:[1,0,0]
    v_fma_mix_f32 v99, v157, v168, v99 op_sel:[1,0,0] op_sel_hi:[1,0,0]
    v_cvt_pk_bf16_f32 v28, v96, v97
    v_cvt_pk_bf16_f32 v29, v98, v99
    v_lshlrev_b32 v96, 16, v28
    v_and_b32 v97, 0xffff0000, v28
    v_lshlrev_b32 v98, 16, v29
    v_and_b32 v99, 0xffff0000, v29
    v_mul_f32 v24, 0xbfb8aa3b, v96
    v_mul_f32 v25, 0xbfb8aa3b, v97
    v_mul_f32 v26, 0xbfb8aa3b, v98
    v_mul_f32 v27, 0xbfb8aa3b, v99
    v_exp_f32 v24, v24
    v_exp_f32 v25, v25
    v_exp_f32 v26, v26
    v_exp_f32 v27, v27
    s_nop 0
    v_add_f32 v24, 1.0, v24
    v_add_f32 v25, 1.0, v25
    v_add_f32 v26, 1.0, v26
    v_add_f32 v27, 1.0, v27
    v_rcp_f32 v24, v24
    v_rcp_f32 v25, v25
    v_rcp_f32 v26, v26
    v_rcp_f32 v27, v27
    s_nop 0
    v_mul_f32 v24, v24, v96
    v_mul_f32 v25, v25, v97
    v_mul_f32 v26, v26, v98
    v_mul_f32 v27, v27, v99
    v_cvt_pk_bf16_f32 v96, v24, v25
    v_cvt_pk_bf16_f32 v97, v26, v27
    ds_write_b64 v5, v[96:97] offset:1024
    s_barrier
    v_fma_mix_f32 v100, v158, v168, v100 op_sel:[0,0,0] op_sel_hi:[1,0,0]
    v_fma_mix_f32 v101, v158, v168, v101 op_sel:[1,0,0] op_sel_hi:[1,0,0]
    v_fma_mix_f32 v102, v159, v168, v102 op_sel:[0,0,0] op_sel_hi:[1,0,0]
    v_fma_mix_f32 v103, v159, v168, v103 op_sel:[1,0,0] op_sel_hi:[1,0,0]
    v_cvt_pk_bf16_f32 v28, v100, v101
    v_cvt_pk_bf16_f32 v29, v102, v103
    v_lshlrev_b32 v100, 16, v28
    v_and_b32 v101, 0xffff0000, v28
    v_lshlrev_b32 v102, 16, v29
    v_and_b32 v103, 0xffff0000, v29
    v_mul_f32 v24, 0xbfb8aa3b, v100
    v_mul_f32 v25, 0xbfb8aa3b, v101
    v_mul_f32 v26, 0xbfb8aa3b, v102
    v_mul_f32 v27, 0xbfb8aa3b, v103
    v_exp_f32 v24, v24
    v_exp_f32 v25, v25
    v_exp_f32 v26, v26
    v_exp_f32 v27, v27
    s_nop 0
    v_add_f32 v24, 1.0, v24
    v_add_f32 v25, 1.0, v25
    v_add_f32 v26, 1.0, v26
    v_add_f32 v27, 1.0, v27
    v_rcp_f32 v24, v24
    v_rcp_f32 v25, v25
    v_rcp_f32 v26, v26
    v_rcp_f32 v27, v27
    s_nop 0
    v_mul_f32 v24, v24, v100
    v_mul_f32 v25, v25, v101
    v_mul_f32 v26, v26, v102
    v_mul_f32 v27, v27, v103
    v_cvt_pk_bf16_f32 v100, v24, v25
    v_cvt_pk_bf16_f32 v101, v26, v27
    ds_write_b64 v5, v[100:101] offset:1536
    s_waitcnt vmcnt(1)
    v_fma_mix_f32 v104, v160, v168, v104 op_sel:[0,0,0] op_sel_hi:[1,0,0]
    v_fma_mix_f32 v105, v160, v168, v105 op_sel:[1,0,0] op_sel_hi:[1,0,0]
    v_fma_mix_f32 v106, v161, v168, v106 op_sel:[0,0,0] op_sel_hi:[1,0,0]
    v_fma_mix_f32 v107, v161, v168, v107 op_sel:[1,0,0] op_sel_hi:[1,0,0]
    v_cvt_pk_bf16_f32 v28, v104, v105
    v_cvt_pk_bf16_f32 v29, v106, v107
    v_lshlrev_b32 v104, 16, v28
    v_and_b32 v105, 0xffff0000, v28
    v_lshlrev_b32 v106, 16, v29
    v_and_b32 v107, 0xffff0000, v29
    v_mul_f32 v24, 0xbfb8aa3b, v104
    v_mul_f32 v25, 0xbfb8aa3b, v105
    v_mul_f32 v26, 0xbfb8aa3b, v106
    v_mul_f32 v27, 0xbfb8aa3b, v107
    v_exp_f32 v24, v24
    v_exp_f32 v25, v25
    v_exp_f32 v26, v26
    v_exp_f32 v27, v27
    s_nop 0
    v_add_f32 v24, 1.0, v24
    v_add_f32 v25, 1.0, v25
    s_barrier
    v_add_f32 v26, 1.0, v26
    v_add_f32 v27, 1.0, v27
    v_rcp_f32 v24, v24
    v_rcp_f32 v25, v25
    v_rcp_f32 v26, v26
    v_rcp_f32 v27, v27
    s_nop 0
    v_mul_f32 v24, v24, v104
    v_mul_f32 v25, v25, v105
    v_mul_f32 v26, v26, v106
    v_mul_f32 v27, v27, v107
    v_cvt_pk_bf16_f32 v104, v24, v25
    v_cvt_pk_bf16_f32 v105, v26, v27
    ds_write_b64 v5, v[104:105] offset:2048
    v_fma_mix_f32 v108, v162, v168, v108 op_sel:[0,0,0] op_sel_hi:[1,0,0]
    v_fma_mix_f32 v109, v162, v168, v109 op_sel:[1,0,0] op_sel_hi:[1,0,0]
    v_fma_mix_f32 v110, v163, v168, v110 op_sel:[0,0,0] op_sel_hi:[1,0,0]
    v_fma_mix_f32 v111, v163, v168, v111 op_sel:[1,0,0] op_sel_hi:[1,0,0]
    v_cvt_pk_bf16_f32 v28, v108, v109
    v_cvt_pk_bf16_f32 v29, v110, v111
    v_lshlrev_b32 v108, 16, v28
    v_and_b32 v109, 0xffff0000, v28
    v_lshlrev_b32 v110, 16, v29
    v_and_b32 v111, 0xffff0000, v29
    v_mul_f32 v24, 0xbfb8aa3b, v108
    v_mul_f32 v25, 0xbfb8aa3b, v109
    v_mul_f32 v26, 0xbfb8aa3b, v110
    v_mul_f32 v27, 0xbfb8aa3b, v111
    v_exp_f32 v24, v24
    v_exp_f32 v25, v25
    v_exp_f32 v26, v26
    v_exp_f32 v27, v27
    s_nop 0
    v_add_f32 v24, 1.0, v24
    v_add_f32 v25, 1.0, v25
    v_add_f32 v26, 1.0, v26
    v_add_f32 v27, 1.0, v27
    v_rcp_f32 v24, v24
    v_rcp_f32 v25, v25
    v_rcp_f32 v26, v26
    v_rcp_f32 v27, v27
    s_nop 0
    v_mul_f32 v24, v24, v108
    v_mul_f32 v25, v25, v109
    v_mul_f32 v26, v26, v110
    v_mul_f32 v27, v27, v111
    v_cvt_pk_bf16_f32 v108, v24, v25
    v_cvt_pk_bf16_f32 v109, v26, v27
    ds_write_b64 v5, v[108:109] offset:2560
    s_barrier
    s_waitcnt vmcnt(0)
    v_fma_mix_f32 v112, v164, v168, v112 op_sel:[0,0,0] op_sel_hi:[1,0,0]
    v_fma_mix_f32 v113, v164, v168, v113 op_sel:[1,0,0] op_sel_hi:[1,0,0]
    v_fma_mix_f32 v114, v165, v168, v114 op_sel:[0,0,0] op_sel_hi:[1,0,0]
    v_fma_mix_f32 v115, v165, v168, v115 op_sel:[1,0,0] op_sel_hi:[1,0,0]
    v_cvt_pk_bf16_f32 v28, v112, v113
    v_cvt_pk_bf16_f32 v29, v114, v115
    v_lshlrev_b32 v112, 16, v28
    v_and_b32 v113, 0xffff0000, v28
    v_lshlrev_b32 v114, 16, v29
    v_and_b32 v115, 0xffff0000, v29
    v_mul_f32 v24, 0xbfb8aa3b, v112
    v_mul_f32 v25, 0xbfb8aa3b, v113
    v_mul_f32 v26, 0xbfb8aa3b, v114
    v_mul_f32 v27, 0xbfb8aa3b, v115
    v_exp_f32 v24, v24
    v_exp_f32 v25, v25
    v_exp_f32 v26, v26
    v_exp_f32 v27, v27
    s_nop 0
    v_add_f32 v24, 1.0, v24
    v_add_f32 v25, 1.0, v25
    v_add_f32 v26, 1.0, v26
    v_add_f32 v27, 1.0, v27
    v_rcp_f32 v24, v24
    v_rcp_f32 v25, v25
    v_rcp_f32 v26, v26
    v_rcp_f32 v27, v27
    s_nop 0
    v_mul_f32 v24, v24, v112
    v_mul_f32 v25, v25, v113
    v_mul_f32 v26, v26, v114
    v_mul_f32 v27, v27, v115
    v_cvt_pk_bf16_f32 v112, v24, v25
    v_cvt_pk_bf16_f32 v113, v26, v27
    ds_write_b64 v5, v[112:113] offset:3072
    v_fma_mix_f32 v116, v166, v168, v116 op_sel:[0,0,0] op_sel_hi:[1,0,0]
    v_fma_mix_f32 v117, v166, v168, v117 op_sel:[1,0,0] op_sel_hi:[1,0,0]
    v_fma_mix_f32 v118, v167, v168, v118 op_sel:[0,0,0] op_sel_hi:[1,0,0]
    v_fma_mix_f32 v119, v167, v168, v119 op_sel:[1,0,0] op_sel_hi:[1,0,0]
    v_cvt_pk_bf16_f32 v28, v116, v117
    v_cvt_pk_bf16_f32 v29, v118, v119
    v_lshlrev_b32 v116, 16, v28
    v_and_b32 v117, 0xffff0000, v28
    v_lshlrev_b32 v118, 16, v29
    v_and_b32 v119, 0xffff0000, v29
    v_mul_f32 v24, 0xbfb8aa3b, v116
    v_mul_f32 v25, 0xbfb8aa3b, v117
    v_mul_f32 v26, 0xbfb8aa3b, v118
    v_mul_f32 v27, 0xbfb8aa3b, v119
    v_exp_f32 v24, v24
    v_exp_f32 v25, v25
    v_exp_f32 v26, v26
    v_exp_f32 v27, v27
    s_nop 0
    v_add_f32 v24, 1.0, v24
    v_add_f32 v25, 1.0, v25
    s_barrier
    v_add_f32 v26, 1.0, v26
    v_add_f32 v27, 1.0, v27
    v_rcp_f32 v24, v24
    v_rcp_f32 v25, v25
    v_rcp_f32 v26, v26
    v_rcp_f32 v27, v27
    s_nop 0
    v_mul_f32 v24, v24, v116
    v_mul_f32 v25, v25, v117
    v_mul_f32 v26, v26, v118
    v_mul_f32 v27, v27, v119
    v_cvt_pk_bf16_f32 v116, v24, v25
    v_cvt_pk_bf16_f32 v117, v26, v27
    ds_write_b64 v5, v[116:117] offset:3584
    s_waitcnt lgkmcnt(0)
    s_barrier
    s_branch L_fin
.p2align 12
L_teamB:
    s_mov_b64 exec, -1
    s_setprio 3
    v_lshrrev_b32 v64, 4, v1
    v_bfe_u32 v65, v1, 2, 2
    v_and_b32 v66, 3, v1
    v_and_b32 v67, 15, v1
    v_lshrrev_b32 v68, 3, v1
    v_and_b32 v69, 7, v1
    s_lshl_b32 s85, s28, 7
    s_lshl_b32 s86, s4, 5
    s_add_u32 s86, s85, s86
    v_add_u32 v71, s86, v68
    v_xor_b32 v70, v69, v64
    v_lshlrev_b32 v70, 4, v70
    v_lshl_add_u32 v20, v71, 11, v70
    v_xor_b32 v21, 64, v20
    v_add_u32 v21, 16384, v21
    s_lshl_b32 s79, s4, 12
    s_and_b32 s72, s28, 3
    s_bitcmp1_b32 s28, 3
    s_cselect_b32 s91, 4, 0
    s_add_u32 s72, s72, s91
    s_mul_i32 s72, s72, 256
    s_waitcnt lgkmcnt(0)
    s_mov_b32 s36, s8
    s_mov_b32 s37, s9
    s_mov_b32 s38, 0x400000
    s_mov_b32 s39, 0x20000
    s_add_u32 m0, s79, 135168
    s_add_u32 s72, s72, 128
    s_and_b32 s78, s72, 0x7ff
    buffer_load_dwordx4 v20, s[36:39], s78 offen lds
    s_add_u32 m0, s79, 136192
    s_nop 0
    buffer_load_dwordx4 v21, s[36:39], s78 offen lds
    s_add_u32 m0, s79, 137216
    s_add_u32 s78, s78, 32768
    buffer_load_dwordx4 v20, s[36:39], s78 offen lds
    s_add_u32 m0, s79, 138240
    s_nop 0
    buffer_load_dwordx4 v21, s[36:39], s78 offen lds
    s_setprio 0
    s_mov_b32 s68, s26
    s_mov_b32 s69, s27
    s_mov_b32 s70, 0x10000000
    s_mov_b32 s71, 0x20000
L_fan5:
    s_cbranch_execz L_teamB
    s_lshl_b32 s85, s4, 3
    s_and_b32 s86, s4, 1
    s_lshl_b32 s86, s86, 2
    v_and_b32 v70, 2, v68
    v_xor_b32 v70, v70, v69
    v_xor_b32 v70, s86, v70
    v_add_u32 v71, s85, v68
    v_mul_u32_u24 v71, 7168, v71
    v_lshl_add_u32 v22, v70, 4, v71
    v_lshrrev_b32 v71, 2, v1
    s_lshl_b32 s86, s86, 2
    v_add_u32 v71, s86, v71
    v_mul_u32_u24 v71, 7168, v71
    v_and_b32 v70, 2, v64
    v_xor_b32 v70, v70, v66
    v_lshl_add_u32 v9, v70, 4, v71
    s_mul_i32 s85, s29, 320
    s_and_b32 s86, s29, 1
    s_lshl_b32 s87, s86, 6
    s_add_u32 s87, s87, s85
    s_add_u32 s40, s16, s87
    s_addc_u32 s41, s17, 0
    s_sub_u32 s42, 7340032, s87
    s_mov_b32 s43, 0x20000
    s_add_u32 s44, s18, s87
    s_addc_u32 s45, s19, 0
    s_sub_u32 s46, 7340032, s87
    s_mov_b32 s47, 0x20000
    s_xor_b32 s86, s86, 1
    s_lshl_b32 s86, s86, 8
    s_add_u32 s87, s86, s85
    s_cmp_lt_u32 s4, 2
    s_cselect_b32 s88, s16, s18
    s_cselect_b32 s89, s17, s19
    s_add_u32 s48, s88, s87
    s_addc_u32 s49, s89, 0
    s_sub_u32 s50, 7340032, s87
    s_mov_b32 s51, 0x20000
    s_and_b32 s77, s28, 3
    s_bitcmp1_b32 s28, 3
    s_cselect_b32 s91, 4, 0
    s_add_u32 s77, s77, s91
    s_mul_i32 s77, s77, 917504
    s_add_u32 s77, s77, 0x38000
    s_add_u32 m0, s33, 57344
    s_add_u32 s77, s77, 229376
    s_cmp_eq_u32 s77, 7340032
    s_cselect_b32 s77, 0, s77
L_fan6:
    s_cbranch_execz L_teamB
    buffer_load_dwordx4 v22, s[40:43], s77 offen offset:0 lds
    s_add_u32 m0, s33, 61312
    s_nop 0
    buffer_load_dwordx4 v22, s[40:43], s77 offen offset:128 lds
    s_add_u32 m0, s33, 65536
    s_nop 0
    buffer_load_dwordx4 v22, s[44:47], s77 offen offset:0 lds
    s_add_u32 m0, s33, 69504
    s_nop 0
    buffer_load_dwordx4 v22, s[44:47], s77 offen offset:128 lds
    s_add_u32 m0, s33, 73728
    s_nop 0
    buffer_load_dwordx4 v9, s[48:51], s77 offen lds
    s_lshl_b32 s84, s28, 7
    s_lshl_b32 s85, s29, 3
    s_add_u32 s84, s84, s85
    s_lshl1_add_u32 s84, s4, s84
    s_lshl_b32 s90, s84, 3
    s_lshl_b32 s84, s84, 11
    v_lshl_add_u32 v86, v1, 4, s84
    v_and_b32 v70, 1, v67
    v_lshlrev_b32 v70, 4, v70
    v_mov_b32 v71, 0x3f80
    v_lshlrev_b32 v70, v70, v71
    v_lshrrev_b32 v71, 1, v67
    v_cmp_eq_u32 vcc, 0, v71
    s_nop 1
    v_cndmask_b32 v144, 0, v70, vcc
    v_cmp_eq_u32 vcc, 1, v71
    s_nop 1
    v_cndmask_b32 v145, 0, v70, vcc
    v_cmp_eq_u32 vcc, 2, v71
    s_nop 1
    v_cndmask_b32 v146, 0, v70, vcc
    v_cmp_eq_u32 vcc, 3, v71
    s_nop 1
    v_cndmask_b32 v147, 0, v70, vcc
    s_lshl_b32 s91, s4, 12
    s_add_u32 s91, s91, 16384
    v_lshlrev_b32 v70, 1, v64
    v_xor_b32 v71, v69, v70
    v_lshl_add_u32 v71, v71, 4, s91
    v_and_b32 v148, 4, v70
    v_add_u32 v70, v70, v148
    v_and_b32 v148, 1, v68
    v_add_u32 v70, v70, v148
    v_lshl_add_u32 v148, v70, 7, v71
    s_lshl_b32 s91, s5, 11
    s_add_u32 s91, s91, 32768
L_fan7:
    s_cbranch_execz L_teamB
    v_and_b32 v70, 2, v64
    v_xor_b32 v70, v66, v70
    v_lshl_add_u32 v70, v70, 4, s91
    v_lshrrev_b32 v71, 2, v1
    v_lshl_add_u32 v149, v71, 6, v70
    s_lshl2_add_u32 s91, s2, s4
    s_lshl_b32 s52, s91, 9
    s_lshr_b32 s92, s91, 2
    s_mul_i32 s92, s92, 7168
    s_and_b32 s91, s91, 3
    s_lshl_b32 s91, s91, 9
    s_add_u32 s92, s92, s91
    s_add_u32 s53, s92, 5120
    s_barrier
    s_and_b32 s91, s28, 4
    s_cmp_eq_u32 s91, 0
    s_cbranch_scc0 L_cr0
    ds_read_b128 v[112:115], v148 offset:0
    ds_read_b128 v[116:119], v148 offset:512
    ds_read_b128 v[120:123], v148 offset:2048
    ds_read_b128 v[124:127], v148 offset:2560
    ds_read_b128 v[128:131], v149 offset:0
    ds_read_b128 v[132:135], v149 offset:1024
L_cr0:
    s_add_u32 m0, s33, 77824
    s_add_u32 s77, s77, 229376
    buffer_load_dwordx4 v22, s[40:43], s77 offen offset:0 lds
    s_add_u32 m0, s33, 81792
    s_nop 0
    buffer_load_dwordx4 v22, s[40:43], s77 offen offset:128 lds
    s_add_u32 m0, s33, 86016
    s_nop 0
    buffer_load_dwordx4 v22, s[44:47], s77 offen offset:0 lds
    s_add_u32 m0, s33, 89984
    s_nop 0
    buffer_load_dwordx4 v22, s[44:47], s77 offen offset:128 lds
    s_add_u32 m0, s33, 94208
    s_nop 0
    buffer_load_dwordx4 v9, s[48:51], s77 offen lds
    s_add_u32 m0, s79, 98304
    s_add_u32 s72, s72, 128
    s_and_b32 s78, s72, 0x7ff
    buffer_load_dwordx4 v20, s[36:39], s78 offen lds
    s_add_u32 m0, s79, 99328
    s_nop 0
    buffer_load_dwordx4 v21, s[36:39], s78 offen lds
    s_and_b32 s91, s28, 4
    s_cmp_eq_u32 s91, 0
    s_cbranch_scc0 L_cm0
    s_waitcnt lgkmcnt(0)
    s_setprio 2
    v_mfma_f32_16x16x32_bf16 v[136:139], v[144:147], v[112:115], 0
    v_mfma_f32_16x16x32_bf16 v[140:143], v[144:147], v[128:131], 0
    v_mfma_f32_16x16x32_bf16 v[136:139], v[144:147], v[116:119], v[136:139]
    v_mfma_f32_16x16x32_bf16 v[140:143], v[144:147], v[132:135], v[140:143]
    v_mfma_f32_16x16x32_bf16 v[136:139], v[144:147], v[120:123], v[136:139]
    v_mfma_f32_16x16x32_bf16 v[136:139], v[144:147], v[124:127], v[136:139]
    s_setprio 0
L_cm0:
    s_barrier
    s_and_b32 s91, s28, 4
    s_cmp_eq_u32 s91, 0
    s_cbranch_scc0 L_cr1
    ds_read_b128 v[112:115], v148 offset:20480
    ds_read_b128 v[116:119], v148 offset:20992
    ds_read_b128 v[120:123], v148 offset:22528
    ds_read_b128 v[124:127], v148 offset:23040
    ds_read_b128 v[128:131], v149 offset:20480
    ds_read_b128 v[132:135], v149 offset:21504
L_cr1:
    s_add_u32 m0, s79, 100352
    s_add_u32 s78, s78, 32768
    buffer_load_dwordx4 v20, s[36:39], s78 offen lds
    s_add_u32 m0, s79, 101376
    s_nop 0
    buffer_load_dwordx4 v21, s[36:39], s78 offen lds
    s_add_u32 m0, s33, 16384
    s_add_u32 s77, s77, 229376
    s_cmp_eq_u32 s77, 7340032
    s_cselect_b32 s77, 0, s77
    buffer_load_dwordx4 v22, s[40:43], s77 offen offset:0 lds
    s_add_u32 m0, s33, 20352
    s_nop 0
    buffer_load_dwordx4 v22, s[40:43], s77 offen offset:128 lds
    s_add_u32 m0, s33, 24576
    s_nop 0
    buffer_load_dwordx4 v22, s[44:47], s77 offen offset:0 lds
    s_add_u32 m0, s33, 28544
    s_nop 0
    buffer_load_dwordx4 v22, s[44:47], s77 offen offset:128 lds
    s_add_u32 m0, s33, 32768
    s_nop 0
    buffer_load_dwordx4 v9, s[48:51], s77 offen lds
    s_and_b32 s91, s28, 4
    s_cmp_eq_u32 s91, 0
    s_cbranch_scc0 L_cm1
    s_waitcnt lgkmcnt(0)
    s_setprio 2
    v_mfma_f32_16x16x32_bf16 v[136:139], v[144:147], v[112:115], v[136:139]
    v_mfma_f32_16x16x32_bf16 v[140:143], v[144:147], v[128:131], v[140:143]
    v_mfma_f32_16x16x32_bf16 v[136:139], v[144:147], v[116:119], v[136:139]
    v_mfma_f32_16x16x32_bf16 v[140:143], v[144:147], v[132:135], v[140:143]
    v_mfma_f32_16x16x32_bf16 v[136:139], v[144:147], v[120:123], v[136:139]
    v_mfma_f32_16x16x32_bf16 v[136:139], v[144:147], v[124:127], v[136:139]
    s_setprio 0
L_cm1:
    s_waitcnt vmcnt(14)
    s_barrier
    s_and_b32 s91, s28, 4
    s_cmp_eq_u32 s91, 4
    s_cbranch_scc0 L_cr2
    ds_read_b128 v[112:115], v148 offset:40960
    ds_read_b128 v[116:119], v148 offset:41472
    ds_read_b128 v[120:123], v148 offset:43008
    ds_read_b128 v[124:127], v148 offset:43520
    ds_read_b128 v[128:131], v149 offset:40960
    ds_read_b128 v[132:135], v149 offset:41984
L_cr2:
    global_load_dwordx4 v[24:27], v86, s[8:9] offset:0
    global_load_dwordx4 v[32:35], v86, s[8:9] offset:2048
    global_load_dwordx4 v[28:31], v86, s[8:9] offset:1024
    global_load_dwordx4 v[36:39], v86, s[8:9] offset:3072
    s_add_u32 m0, s79, 116736
    s_add_u32 s72, s72, 128
    s_and_b32 s78, s72, 0x7ff
    buffer_load_dwordx4 v20, s[36:39], s78 offen lds
    s_add_u32 m0, s79, 117760
    s_nop 0
    buffer_load_dwordx4 v21, s[36:39], s78 offen lds
    s_add_u32 m0, s33, 36864
    s_add_u32 s77, s77, 229376
    buffer_load_dwordx4 v22, s[40:43], s77 offen offset:0 lds
    s_add_u32 m0, s33, 40832
    s_nop 0
    buffer_load_dwordx4 v22, s[40:43], s77 offen offset:128 lds
    s_add_u32 m0, s33, 45056
    s_nop 0
    buffer_load_dwordx4 v22, s[44:47], s77 offen offset:0 lds
    s_add_u32 m0, s33, 49024
    s_nop 0
    buffer_load_dwordx4 v22, s[44:47], s77 offen offset:128 lds
    s_add_u32 m0, s33, 53248
    s_nop 0
    buffer_load_dwordx4 v9, s[48:51], s77 offen lds
    s_and_b32 s91, s28, 4
    s_cmp_eq_u32 s91, 4
    s_cbranch_scc0 L_cm2
    s_waitcnt lgkmcnt(0)
    s_setprio 2
    v_mfma_f32_16x16x32_bf16 v[136:139], v[144:147], v[112:115], 0
    v_mfma_f32_16x16x32_bf16 v[140:143], v[144:147], v[128:131], 0
    v_mfma_f32_16x16x32_bf16 v[136:139], v[144:147], v[116:119], v[136:139]
    v_mfma_f32_16x16x32_bf16 v[140:143], v[144:147], v[132:135], v[140:143]
    v_mfma_f32_16x16x32_bf16 v[136:139], v[144:147], v[120:123], v[136:139]
    v_mfma_f32_16x16x32_bf16 v[136:139], v[144:147], v[124:127], v[136:139]
    s_setprio 0
L_cm2:
    s_waitcnt vmcnt(20)
    s_barrier
    s_and_b32 s91, s28, 4
    s_cmp_eq_u32 s91, 4
    s_cbranch_scc0 L_cr3
    ds_read_b128 v[112:115], v148 offset:61440
    ds_read_b128 v[116:119], v148 offset:61952
    ds_read_b128 v[120:123], v148 offset:63488
    ds_read_b128 v[124:127], v148 offset:64000
    ds_read_b128 v[128:131], v149 offset:61440
    ds_read_b128 v[132:135], v149 offset:62464
L_cr3:
    s_add_u32 m0, s79, 118784
    s_add_u32 s78, s78, 32768
    buffer_load_dwordx4 v20, s[36:39], s78 offen lds
    s_add_u32 m0, s79, 119808
    s_nop 0
    buffer_load_dwordx4 v21, s[36:39], s78 offen lds
    s_add_u32 m0, s33, 57344
    s_add_u32 s77, s77, 229376
    s_cmp_eq_u32 s77, 7340032
    s_cselect_b32 s77, 0, s77
    buffer_load_dwordx4 v22, s[40:43], s77 offen offset:0 lds
    s_add_u32 m0, s33, 61312
    s_nop 0
    buffer_load_dwordx4 v22, s[40:43], s77 offen offset:128 lds
    s_add_u32 m0, s33, 65536
    s_nop 0
    buffer_load_dwordx4 v22, s[44:47], s77 offen offset:0 lds
    s_add_u32 m0, s33, 69504
    s_nop 0
    buffer_load_dwordx4 v22, s[44:47], s77 offen offset:128 lds
    s_add_u32 m0, s33, 73728
    s_nop 0
    buffer_load_dwordx4 v9, s[48:51], s77 offen lds
    s_and_b32 s91, s28, 4
    s_cmp_eq_u32 s91, 4
    s_cbranch_scc0 L_cm3
    s_waitcnt lgkmcnt(0)
    s_setprio 2
    v_mfma_f32_16x16x32_bf16 v[136:139], v[144:147], v[112:115], v[136:139]
    v_mfma_f32_16x16x32_bf16 v[140:143], v[144:147], v[128:131], v[140:143]
    v_mfma_f32_16x16x32_bf16 v[136:139], v[144:147], v[116:119], v[136:139]
    v_mfma_f32_16x16x32_bf16 v[140:143], v[144:147], v[132:135], v[140:143]
    v_mfma_f32_16x16x32_bf16 v[136:139], v[144:147], v[120:123], v[136:139]
    v_mfma_f32_16x16x32_bf16 v[136:139], v[144:147], v[124:127], v[136:139]
    s_setprio 0
L_cm3:
    s_sub_u32 s91, s2, 224
    s_lshl1_add_u32 s91, s91, 1
    s_cmp_ge_u32 s2, 224
    s_cselect_b32 s91, s91, s2
    s_cselect_b32 s88, s12, s20
    s_cselect_b32 s89, s13, s21
    s_cselect_b32 s34, 0x800000, 0
    s_lshr_b32 s92, s91, 2
    s_lshl_b32 s92, s92, 17
    s_add_u32 s34, s34, s92
    s_and_b32 s93, s91, 3
    s_lshl_b32 s93, s93, 13
    s_add_u32 s34, s34, s93
    s_and_b32 s93, s91, 1
    s_lshl_b32 s93, s93, 7
    s_add_u32 s92, s92, s93
    s_and_b32 s93, s91, 2
    s_lshl_b32 s93, s93, 9
    s_add_u32 s92, s92, s93
    s_add_u32 s92, s92, 256
    s_add_u32 s88, s88, s92
    s_addc_u32 s89, s89, 0
    s_lshl_b32 s76, s4, 15
    s_waitcnt vmcnt(18)
    s_barrier
    s_add_u32 m0, s79, 135168
    s_add_u32 s72, s72, 128
    s_and_b32 s78, s72, 0x7ff
    buffer_load_dwordx4 v20, s[36:39], s78 offen lds
    s_add_u32 m0, s79, 136192
    s_nop 0
    buffer_load_dwordx4 v21, s[36:39], s78 offen lds
    s_add_u32 m0, s33, 77824
    s_add_u32 s77, s77, 229376
    buffer_load_dwordx4 v22, s[40:43], s77 offen offset:0 lds
    s_add_u32 m0, s33, 81792
    s_nop 0
    buffer_load_dwordx4 v22, s[40:43], s77 offen offset:128 lds
    s_add_u32 m0, s33, 86016
    s_nop 0
    buffer_load_dwordx4 v22, s[44:47], s77 offen offset:0 lds
    s_add_u32 m0, s33, 89984
    s_nop 0
    buffer_load_dwordx4 v22, s[44:47], s77 offen offset:128 lds
    s_add_u32 m0, s33, 94208
    s_nop 0
    buffer_load_dwordx4 v9, s[48:51], s77 offen lds
    v_add_f32_dpp v136, v136, v136 row_ror:8 row_mask:0xf bank_mask:0xf
    v_add_f32_dpp v137, v137, v137 row_ror:8 row_mask:0xf bank_mask:0xf
    v_add_f32_dpp v138, v138, v138 row_ror:8 row_mask:0xf bank_mask:0xf
    v_add_f32_dpp v139, v139, v139 row_ror:8 row_mask:0xf bank_mask:0xf
    v_add_f32_dpp v140, v140, v140 row_ror:8 row_mask:0xf bank_mask:0xf
    v_add_f32_dpp v141, v141, v141 row_ror:8 row_mask:0xf bank_mask:0xf
    v_add_f32_dpp v142, v142, v142 row_ror:8 row_mask:0xf bank_mask:0xf
    v_add_f32_dpp v143, v143, v143 row_ror:8 row_mask:0xf bank_mask:0xf
    v_add_f32_dpp v140, v140, v140 row_ror:4 row_mask:0xf bank_mask:0xf
    v_add_f32_dpp v141, v141, v141 row_ror:4 row_mask:0xf bank_mask:0xf
    v_add_f32_dpp v142, v142, v142 row_ror:4 row_mask:0xf bank_mask:0xf
    v_add_f32_dpp v143, v143, v143 row_ror:4 row_mask:0xf bank_mask:0xf
    s_lshl_b32 s91, s29, 4
    s_add_u32 s91, s91, s28
    s_mul_i32 s91, s91, 1280
    s_mul_i32 s92, s5, 640
    s_add_u32 s91, s91, s92
    s_add_u32 s91, s91, 0x1e10000
    s_lshl_b32 s92, s6, 8
    v_and_b32 v112, 8, v1
    v_cmp_eq_u32 vcc, 0, v112
    v_mov_b32 v112, s92
    v_mov_b32 v113, 256
    v_cndmask_b32 v112, v113, v112, vcc
    v_cndmask_b32 v136, v140, v136, vcc
    v_cndmask_b32 v137, v141, v137, vcc
    v_cndmask_b32 v138, v142, v138, vcc
    v_cndmask_b32 v139, v143, v139, vcc
    v_and_b32 v113, 15, v1
    v_lshl_add_u32 v112, v113, 5, v112
    v_and_b32 v113, 16, v1
    v_add3_u32 v112, v112, v113, s91
    s_mov_b64 exec, 0x0fff0fff
    global_store_dwordx4 v112, v[136:139], s[26:27] sc1
    s_mov_b64 exec, -1
    s_load_dword s94, s[88:89], s76 offset:0
    s_load_dword s94, s[88:89], s76 offset:64
    s_load_dword s94, s[88:89], s76 offset:2048
    s_load_dword s94, s[88:89], s76 offset:2112
    s_waitcnt vmcnt(15)
    s_barrier
    s_add_u32 m0, s79, 137216
    s_add_u32 s78, s78, 32768
    buffer_load_dwordx4 v20, s[36:39], s78 offen lds
    s_waitcnt vmcnt(23)
    v_lshlrev_b32 v40, 16, v24
    v_and_b32 v41, 0xffff0000, v24
    v_lshlrev_b32 v42, 16, v25
    v_and_b32 v43, 0xffff0000, v25
    v_lshlrev_b32 v44, 16, v26
    v_and_b32 v45, 0xffff0000, v26
    v_lshlrev_b32 v46, 16, v27
    v_and_b32 v47, 0xffff0000, v27
    s_add_u32 m0, s79, 138240
    s_nop 0
    buffer_load_dwordx4 v21, s[36:39], s78 offen lds
    v_lshlrev_b32 v48, 16, v28
    v_and_b32 v49, 0xffff0000, v28
    v_lshlrev_b32 v50, 16, v29
    v_and_b32 v51, 0xffff0000, v29
    v_lshlrev_b32 v52, 16, v30
    v_and_b32 v53, 0xffff0000, v30
    v_lshlrev_b32 v54, 16, v31
    v_and_b32 v55, 0xffff0000, v31
    s_add_u32 m0, s33, 16384
    s_add_u32 s77, s77, 229376
    s_cmp_eq_u32 s77, 7340032
    s_cselect_b32 s77, 0, s77
    buffer_load_dwordx4 v22, s[40:43], s77 offen offset:0 lds
    v_lshlrev_b32 v56, 16, v32
    v_and_b32 v57, 0xffff0000, v32
    v_lshlrev_b32 v58, 16, v33
    v_and_b32 v59, 0xffff0000, v33
    v_lshlrev_b32 v60, 16, v34
    v_and_b32 v61, 0xffff0000, v34
    v_lshlrev_b32 v62, 16, v35
    v_and_b32 v63, 0xffff0000, v35
    s_add_u32 m0, s33, 20352
    s_nop 0
    buffer_load_dwordx4 v22, s[40:43], s77 offen offset:128 lds
    v_lshlrev_b32 v64, 16, v36
    v_and_b32 v65, 0xffff0000, v36
    v_lshlrev_b32 v66, 16, v37
    v_and_b32 v67, 0xffff0000, v37
    v_lshlrev_b32 v68, 16, v38
    v_and_b32 v69, 0xffff0000, v38
    v_lshlrev_b32 v70, 16, v39
    v_and_b32 v71, 0xffff0000, v39
    s_add_u32 m0, s33, 24576
    s_nop 0
    buffer_load_dwordx4 v22, s[44:47], s77 offen offset:0 lds
    v_add_f32 v72, v40, v41
    v_add_f32 v74, v56, v57
    v_add_f32 v72, v72, v42
    v_add_f32 v74, v74, v58
    v_add_f32 v72, v72, v43
    v_add_f32 v74, v74, v59
    v_add_f32 v72, v72, v44
    v_add_f32 v74, v74, v60
    s_add_u32 m0, s33, 28544
    s_nop 0
    buffer_load_dwordx4 v22, s[44:47], s77 offen offset:128 lds
    s_add_u32 m0, s33, 32768
    s_nop 0
    buffer_load_dwordx4 v9, s[48:51], s77 offen lds
    v_add_f32 v72, v72, v45
    v_add_f32 v74, v74, v61
    v_add_f32 v72, v72, v46
    v_add_f32 v74, v74, v62
    v_add_f32 v72, v72, v47
    v_add_f32 v74, v74, v63
    v_add_f32 v72, v72, v48
    v_add_f32 v74, v74, v64
    s_load_dword s94, s[88:89], s76 offset:4096
    s_load_dword s94, s[88:89], s76 offset:4160
    s_load_dword s94, s[88:89], s76 offset:6144
    s_load_dword s94, s[88:89], s76 offset:6208
    s_waitcnt vmcnt(15)
    s_barrier
    s_add_u32 m0, s79, 98304
    s_add_u32 s72, s72, 128
    s_and_b32 s78, s72, 0x7ff
    buffer_load_dwordx4 v20, s[36:39], s78 offen lds
    v_add_f32 v72, v72, v49
    v_add_f32 v74, v74, v65
    v_add_f32 v72, v72, v50
    v_add_f32 v74, v74, v66
    v_add_f32 v72, v72, v51
    v_add_f32 v74, v74, v67
    v_add_f32 v72, v72, v52
    v_add_f32 v74, v74, v68
    s_add_u32 m0, s79, 99328
    s_nop 0
    buffer_load_dwordx4 v21, s[36:39], s78 offen lds
    v_add_f32 v72, v72, v53
    v_add_f32 v74, v74, v69
    v_add_f32 v72, v72, v54
    v_add_f32 v74, v74, v70
    v_add_f32 v72, v72, v55
    v_add_f32 v74, v74, v71
    s_nop 0
    v_add_f32_dpp v72, v72, v72 quad_perm:[1,0,3,2] row_mask:0xf bank_mask:0xf
    v_add_f32_dpp v74, v74, v74 quad_perm:[1,0,3,2] row_mask:0xf bank_mask:0xf
    s_add_u32 m0, s33, 36864
    s_add_u32 s77, s77, 229376
    buffer_load_dwordx4 v22, s[40:43], s77 offen offset:0 lds
    s_nop 0
    v_add_f32_dpp v72, v72, v72 quad_perm:[2,3,0,1] row_mask:0xf bank_mask:0xf
    v_add_f32_dpp v74, v74, v74 quad_perm:[2,3,0,1] row_mask:0xf bank_mask:0xf
    s_nop 0
    v_add_f32_dpp v72, v72, v72 row_half_mirror row_mask:0xf bank_mask:0xf
    v_add_f32_dpp v74, v74, v74 row_half_mirror row_mask:0xf bank_mask:0xf
    s_nop 0
    v_add_f32_dpp v72, v72, v72 row_mirror row_mask:0xf bank_mask:0xf
    v_add_f32_dpp v74, v74, v74 row_mirror row_mask:0xf bank_mask:0xf
    v_mov_b32 v78, v72
    s_add_u32 m0, s33, 40832
    s_nop 0
    buffer_load_dwordx4 v22, s[40:43], s77 offen offset:128 lds
    v_mov_b32 v79, v74
    s_nop 0
    v_permlane16_swap_b32 v72, v78
    v_permlane16_swap_b32 v74, v79
    v_add_f32 v72, v72, v78
    v_add_f32 v74, v74, v79
    v_mov_b32 v78, v72
    v_mov_b32 v79, v74
    s_nop 0
    v_permlane32_swap_b32 v72, v78
    s_add_u32 m0, s33, 45056
    s_nop 0
    buffer_load_dwordx4 v22, s[44:47], s77 offen offset:0 lds
    s_add_u32 m0, s33, 49024
    s_nop 0
    buffer_load_dwordx4 v22, s[44:47], s77 offen offset:128 lds
    v_permlane32_swap_b32 v74, v79
    v_add_f32 v72, v72, v78
    v_add_f32 v74, v74, v79
    v_mul_f32 v72, 0x3a800000, v72
    v_mul_f32 v74, 0x3a800000, v74
    v_sub_f32 v78, v40, v72
    v_sub_f32 v79, v56, v74
    v_mul_f32 v73, v78, v78
    s_add_u32 m0, s33, 53248
    s_nop 0
    buffer_load_dwordx4 v9, s[48:51], s77 offen lds
    v_mul_f32 v75, v79, v79
    v_sub_f32 v78, v41, v72
    v_sub_f32 v79, v57, v74
    v_fmac_f32 v73, v78, v78
    v_fmac_f32 v75, v79, v79
    v_sub_f32 v78, v42, v72
    v_sub_f32 v79, v58, v74
    v_fmac_f32 v73, v78, v78
    s_load_dword s94, s[88:89], s76 offset:8192
    s_load_dword s94, s[88:89], s76 offset:8256
    s_load_dword s94, s[88:89], s76 offset:10240
    s_load_dword s94, s[88:89], s76 offset:10304
    s_waitcnt vmcnt(15)
    s_barrier
    s_add_u32 m0, s79, 100352
    s_add_u32 s78, s78, 32768
    buffer_load_dwordx4 v20, s[36:39], s78 offen lds
    v_fmac_f32 v75, v79, v79
    v_sub_f32 v78, v43, v72
    v_sub_f32 v79, v59, v74
    v_fmac_f32 v73, v78, v78
    v_fmac_f32 v75, v79, v79
    v_sub_f32 v78, v44, v72
    v_sub_f32 v79, v60, v74
    v_fmac_f32 v73, v78, v78
    s_add_u32 m0, s79, 101376
    s_nop 0
    buffer_load_dwordx4 v21, s[36:39], s78 offen lds
    v_fmac_f32 v75, v79, v79
    v_sub_f32 v78, v45, v72
    v_sub_f32 v79, v61, v74
    v_fmac_f32 v73, v78, v78
    v_fmac_f32 v75, v79, v79
    v_sub_f32 v78, v46, v72
    v_sub_f32 v79, v62, v74
    v_fmac_f32 v73, v78, v78
    s_add_u32 m0, s33, 57344
    s_add_u32 s77, s77, 229376
    s_cmp_eq_u32 s77, 7340032
    s_cselect_b32 s77, 0, s77
    buffer_load_dwordx4 v22, s[40:43], s77 offen offset:0 lds
    v_fmac_f32 v75, v79, v79
    v_sub_f32 v78, v47, v72
    v_sub_f32 v79, v63, v74
    v_fmac_f32 v73, v78, v78
    v_fmac_f32 v75, v79, v79
    v_sub_f32 v78, v48, v72
    v_sub_f32 v79, v64, v74
    v_fmac_f32 v73, v78, v78
    s_add_u32 m0, s33, 61312
    s_nop 0
    buffer_load_dwordx4 v22, s[40:43], s77 offen offset:128 lds
    v_fmac_f32 v75, v79, v79
    v_sub_f32 v78, v49, v72
    v_sub_f32 v79, v65, v74
    v_fmac_f32 v73, v78, v78
    v_fmac_f32 v75, v79, v79
    v_sub_f32 v78, v50, v72
    v_sub_f32 v79, v66, v74
    v_fmac_f32 v73, v78, v78
    s_add_u32 m0, s33, 65536
    s_nop 0
    buffer_load_dwordx4 v22, s[44:47], s77 offen offset:0 lds
    v_fmac_f32 v75, v79, v79
    v_sub_f32 v78, v51, v72
    v_sub_f32 v79, v67, v74
    v_fmac_f32 v73, v78, v78
    v_fmac_f32 v75, v79, v79
    v_sub_f32 v78, v52, v72
    v_sub_f32 v79, v68, v74
    v_fmac_f32 v73, v78, v78
    s_add_u32 m0, s33, 69504
    s_nop 0
    buffer_load_dwordx4 v22, s[44:47], s77 offen offset:128 lds
    s_add_u32 m0, s33, 73728
    s_nop 0
    buffer_load_dwordx4 v9, s[48:51], s77 offen lds
    v_fmac_f32 v75, v79, v79
    v_sub_f32 v78, v53, v72
    v_sub_f32 v79, v69, v74
    v_fmac_f32 v73, v78, v78
    v_fmac_f32 v75, v79, v79
    v_sub_f32 v78, v54, v72
    v_sub_f32 v79, v70, v74
    v_fmac_f32 v73, v78, v78
    s_load_dword s94, s[88:89], s76 offset:12288
    s_load_dword s94, s[88:89], s76 offset:12352
    s_load_dword s94, s[88:89], s76 offset:14336
    s_load_dword s94, s[88:89], s76 offset:14400
    s_waitcnt vmcnt(14)
    s_barrier
    s_add_u32 m0, s79, 116736
    s_add_u32 s72, s72, 128
    s_and_b32 s78, s72, 0x7ff
    buffer_load_dwordx4 v20, s[36:39], s78 offen lds
    v_fmac_f32 v75, v79, v79
    v_sub_f32 v78, v55, v72
    v_sub_f32 v79, v71, v74
    v_fmac_f32 v73, v78, v78
    v_fmac_f32 v75, v79, v79
    s_nop 0
    v_add_f32_dpp v73, v73, v73 quad_perm:[1,0,3,2] row_mask:0xf bank_mask:0xf
    v_add_f32_dpp v75, v75, v75 quad_perm:[1,0,3,2] row_mask:0xf bank_mask:0xf
    s_nop 0
    v_add_f32_dpp v73, v73, v73 quad_perm:[2,3,0,1] row_mask:0xf bank_mask:0xf
    s_add_u32 m0, s79, 117760
    s_nop 0
    buffer_load_dwordx4 v21, s[36:39], s78 offen lds
    v_add_f32_dpp v75, v75, v75 quad_perm:[2,3,0,1] row_mask:0xf bank_mask:0xf
    s_nop 0
    v_add_f32_dpp v73, v73, v73 row_half_mirror row_mask:0xf bank_mask:0xf
    v_add_f32_dpp v75, v75, v75 row_half_mirror row_mask:0xf bank_mask:0xf
    s_nop 0
    v_add_f32_dpp v73, v73, v73 row_mirror row_mask:0xf bank_mask:0xf
    v_add_f32_dpp v75, v75, v75 row_mirror row_mask:0xf bank_mask:0xf
    v_mov_b32 v78, v73
    v_mov_b32 v79, v75
    s_add_u32 m0, s33, 77824
    s_add_u32 s77, s77, 229376
    buffer_load_dwordx4 v22, s[40:43], s77 offen offset:0 lds
    s_nop 0
    v_permlane16_swap_b32 v73, v78
    v_permlane16_swap_b32 v75, v79
L_pad6:
    s_cbranch_execz L_vret0
    v_add_f32 v73, v73, v78
    v_add_f32 v75, v75, v79
    v_mov_b32 v78, v73
    v_mov_b32 v79, v75
    s_nop 0
    v_permlane32_swap_b32 v73, v78
    s_add_u32 m0, s33, 81792
    s_nop 0
    buffer_load_dwordx4 v22, s[40:43], s77 offen offset:128 lds
    v_permlane32_swap_b32 v75, v79
    v_add_f32 v73, v73, v78
    v_add_f32 v75, v75, v79
    v_mul_f32 v73, 0x3a800000, v73
    v_mul_f32 v75, 0x3a800000, v75
    v_cvt_pk_bf16_f32 v72, v72, v72
    v_lshlrev_b32 v72, 16, v72
    v_cvt_pk_bf16_f32 v73, v73, v73
    s_add_u32 m0, s33, 86016
    s_nop 0
    buffer_load_dwordx4 v22, s[44:47], s77 offen offset:0 lds
    s_add_u32 m0, s33, 89984
    s_nop 0
    buffer_load_dwordx4 v22, s[44:47], s77 offen offset:128 lds
    v_lshlrev_b32 v73, 16, v73
    v_add_f32 v73, 0x3727c5ac, v73
    v_cvt_pk_bf16_f32 v73, v73, v73
    v_lshlrev_b32 v73, 16, v73
    v_sqrt_f32 v73, v73
    v_cvt_pk_bf16_f32 v74, v74, v74
    v_lshlrev_b32 v74, 16, v74
    s_add_u32 m0, s33, 94208
    s_nop 0
    buffer_load_dwordx4 v9, s[48:51], s77 offen lds
    v_cvt_pk_bf16_f32 v75, v75, v75
    v_lshlrev_b32 v75, 16, v75
    v_add_f32 v75, 0x3727c5ac, v75
    v_cvt_pk_bf16_f32 v75, v75, v75
    v_lshlrev_b32 v75, 16, v75
    v_sqrt_f32 v75, v75
    s_nop 0
    v_cvt_pk_bf16_f32 v73, v73, v73
    s_load_dword s94, s[88:89], s76 offset:16384
    s_load_dword s94, s[88:89], s76 offset:16448
    s_load_dword s94, s[88:89], s76 offset:18432
    s_load_dword s94, s[88:89], s76 offset:18496
    s_waitcnt vmcnt(14)
    s_barrier
    s_add_u32 m0, s79, 118784
    s_add_u32 s78, s78, 32768
    buffer_load_dwordx4 v20, s[36:39], s78 offen lds
    v_lshlrev_b32 v73, 16, v73
    v_rcp_f32 v76, v73
    s_nop 0
    v_cvt_pk_bf16_f32 v75, v75, v75
    v_lshlrev_b32 v75, 16, v75
    v_rcp_f32 v77, v75
    s_nop 0
    v_fma_f32 v78, -v73, v76, 1.0
    s_add_u32 m0, s79, 119808
    s_nop 0
    buffer_load_dwordx4 v21, s[36:39], s78 offen lds
    v_fma_f32 v76, v78, v76, v76
    s_nop 0
    v_fma_f32 v79, -v75, v77, 1.0
    v_fma_f32 v77, v79, v77, v77
    v_sub_f32 v80, v40, v72
    v_sub_f32 v81, v41, v72
    v_cvt_pk_bf16_f32 v80, v80, v81
    v_and_b32 v81, 0xffff0000, v80
    v_lshlrev_b32 v80, 16, v80
    s_add_u32 m0, s33, 16384
    s_add_u32 s77, s77, 229376
    s_cmp_eq_u32 s77, 7340032
    s_cselect_b32 s77, 0, s77
    buffer_load_dwordx4 v22, s[40:43], s77 offen offset:0 lds
    v_mul_f32 v80, v80, v76
    v_mul_f32 v81, v81, v76
    v_cvt_pk_bf16_f32 v24, v80, v81
    v_sub_f32 v80, v42, v72
    v_sub_f32 v81, v43, v72
    v_cvt_pk_bf16_f32 v80, v80, v81
    v_and_b32 v81, 0xffff0000, v80
    v_lshlrev_b32 v80, 16, v80
    s_add_u32 m0, s33, 20352
    s_nop 0
    buffer_load_dwordx4 v22, s[40:43], s77 offen offset:128 lds
    v_mul_f32 v80, v80, v76
    v_mul_f32 v81, v81, v76
    v_cvt_pk_bf16_f32 v25, v80, v81
    v_sub_f32 v80, v44, v72
    v_sub_f32 v81, v45, v72
    v_cvt_pk_bf16_f32 v80, v80, v81
    v_and_b32 v81, 0xffff0000, v80
    v_lshlrev_b32 v80, 16, v80
    s_add_u32 m0, s33, 24576
    s_nop 0
    buffer_load_dwordx4 v22, s[44:47], s77 offen offset:0 lds
    s_add_u32 m0, s33, 28544
    s_nop 0
    buffer_load_dwordx4 v22, s[44:47], s77 offen offset:128 lds
    v_mul_f32 v80, v80, v76
    v_mul_f32 v81, v81, v76
    v_cvt_pk_bf16_f32 v26, v80, v81
    v_sub_f32 v80, v46, v72
    v_sub_f32 v81, v47, v72
    v_cvt_pk_bf16_f32 v80, v80, v81
    v_and_b32 v81, 0xffff0000, v80
    v_lshlrev_b32 v80, 16, v80
    s_add_u32 m0, s33, 32768
    s_nop 0
    buffer_load_dwordx4 v9, s[48:51], s77 offen lds
    v_mul_f32 v80, v80, v76
    v_mul_f32 v81, v81, v76
    v_cvt_pk_bf16_f32 v27, v80, v81
    v_sub_f32 v80, v48, v72
    v_sub_f32 v81, v49, v72
    v_cvt_pk_bf16_f32 v80, v80, v81
    v_and_b32 v81, 0xffff0000, v80
    v_lshlrev_b32 v80, 16, v80
    s_load_dword s94, s[88:89], s76 offset:20480
    s_load_dword s94, s[88:89], s76 offset:20544
    s_load_dword s94, s[88:89], s76 offset:22528
    s_load_dword s94, s[88:89], s76 offset:22592
    s_waitcnt vmcnt(14)
    s_barrier
    s_add_u32 m0, s79, 135168
    s_add_u32 s72, s72, 128
    s_and_b32 s78, s72, 0x7ff
    buffer_load_dwordx4 v20, s[36:39], s78 offen lds
    v_mul_f32 v80, v80, v76
    v_mul_f32 v81, v81, v76
    v_cvt_pk_bf16_f32 v28, v80, v81
    v_sub_f32 v80, v50, v72
    v_sub_f32 v81, v51, v72
    v_cvt_pk_bf16_f32 v80, v80, v81
    v_and_b32 v81, 0xffff0000, v80
    v_lshlrev_b32 v80, 16, v80
    s_add_u32 m0, s79, 136192
    s_nop 0
    buffer_load_dwordx4 v21, s[36:39], s78 offen lds
    v_mul_f32 v80, v80, v76
    v_mul_f32 v81, v81, v76
    v_cvt_pk_bf16_f32 v29, v80, v81
    v_sub_f32 v80, v52, v72
    v_sub_f32 v81, v53, v72
    v_cvt_pk_bf16_f32 v80, v80, v81
    v_and_b32 v81, 0xffff0000, v80
    v_lshlrev_b32 v80, 16, v80
    s_add_u32 m0, s33, 36864
    s_add_u32 s77, s77, 229376
    buffer_load_dwordx4 v22, s[40:43], s77 offen offset:0 lds
    v_mul_f32 v80, v80, v76
    v_mul_f32 v81, v81, v76
    v_cvt_pk_bf16_f32 v30, v80, v81
    v_sub_f32 v80, v54, v72
    v_sub_f32 v81, v55, v72
    v_cvt_pk_bf16_f32 v80, v80, v81
    v_and_b32 v81, 0xffff0000, v80
    v_lshlrev_b32 v80, 16, v80
    s_add_u32 m0, s33, 40832
    s_nop 0
    buffer_load_dwordx4 v22, s[40:43], s77 offen offset:128 lds
    v_mul_f32 v80, v80, v76
    v_mul_f32 v81, v81, v76
    v_cvt_pk_bf16_f32 v31, v80, v81
    v_sub_f32 v80, v56, v74
    v_sub_f32 v81, v57, v74
    v_cvt_pk_bf16_f32 v80, v80, v81
    v_and_b32 v81, 0xffff0000, v80
    v_lshlrev_b32 v80, 16, v80
    s_add_u32 m0, s33, 45056
    s_nop 0
    buffer_load_dwordx4 v22, s[44:47], s77 offen offset:0 lds
    v_mul_f32 v80, v80, v77
    v_mul_f32 v81, v81, v77
    v_cvt_pk_bf16_f32 v32, v80, v81
    v_sub_f32 v80, v58, v74
    v_sub_f32 v81, v59, v74
    v_cvt_pk_bf16_f32 v80, v80, v81
    v_and_b32 v81, 0xffff0000, v80
    v_lshlrev_b32 v80, 16, v80
    s_add_u32 m0, s33, 49024
    s_nop 0
    buffer_load_dwordx4 v22, s[44:47], s77 offen offset:128 lds
    s_add_u32 m0, s33, 53248
    s_nop 0
    buffer_load_dwordx4 v9, s[48:51], s77 offen lds
    v_mul_f32 v80, v80, v77
    v_mul_f32 v81, v81, v77
    v_cvt_pk_bf16_f32 v33, v80, v81
    v_sub_f32 v80, v60, v74
    v_sub_f32 v81, v61, v74
    v_cvt_pk_bf16_f32 v80, v80, v81
    v_and_b32 v81, 0xffff0000, v80
    v_lshlrev_b32 v80, 16, v80
    s_load_dword s94, s[88:89], s76 offset:24576
    s_load_dword s94, s[88:89], s76 offset:24640
    s_load_dword s94, s[88:89], s76 offset:26624
    s_load_dword s94, s[88:89], s76 offset:26688
    s_waitcnt vmcnt(14)
    s_barrier
    s_add_u32 m0, s79, 137216
    s_add_u32 s78, s78, 32768
    buffer_load_dwordx4 v20, s[36:39], s78 offen lds
    v_mul_f32 v80, v80, v77
    v_mul_f32 v81, v81, v77
    v_cvt_pk_bf16_f32 v34, v80, v81
    v_sub_f32 v80, v62, v74
    v_sub_f32 v81, v63, v74
    v_cvt_pk_bf16_f32 v80, v80, v81
    v_and_b32 v81, 0xffff0000, v80
    v_lshlrev_b32 v80, 16, v80
    s_add_u32 m0, s79, 138240
    s_nop 0
    buffer_load_dwordx4 v21, s[36:39], s78 offen lds
    v_mul_f32 v80, v80, v77
    v_mul_f32 v81, v81, v77
    v_cvt_pk_bf16_f32 v35, v80, v81
    v_sub_f32 v80, v64, v74
    v_sub_f32 v81, v65, v74
    v_cvt_pk_bf16_f32 v80, v80, v81
    v_and_b32 v81, 0xffff0000, v80
    v_lshlrev_b32 v80, 16, v80
    s_add_u32 m0, s33, 57344
    s_add_u32 s77, s77, 229376
    s_cmp_eq_u32 s77, 7340032
    s_cselect_b32 s77, 0, s77
    buffer_load_dwordx4 v22, s[40:43], s77 offen offset:0 lds
    v_mul_f32 v80, v80, v77
    v_mul_f32 v81, v81, v77
    v_cvt_pk_bf16_f32 v36, v80, v81
    v_sub_f32 v80, v66, v74
    v_sub_f32 v81, v67, v74
    v_cvt_pk_bf16_f32 v80, v80, v81
    v_and_b32 v81, 0xffff0000, v80
    v_lshlrev_b32 v80, 16, v80
    s_add_u32 m0, s33, 61312
    s_nop 0
    buffer_load_dwordx4 v22, s[40:43], s77 offen offset:128 lds
    v_mul_f32 v80, v80, v77
    v_mul_f32 v81, v81, v77
    v_cvt_pk_bf16_f32 v37, v80, v81
    v_sub_f32 v80, v68, v74
    v_sub_f32 v81, v69, v74
    v_cvt_pk_bf16_f32 v80, v80, v81
    v_and_b32 v81, 0xffff0000, v80
    v_lshlrev_b32 v80, 16, v80
    s_add_u32 m0, s33, 65536
    s_nop 0
    buffer_load_dwordx4 v22, s[44:47], s77 offen offset:0 lds
    v_mul_f32 v80, v80, v77
    v_mul_f32 v81, v81, v77
    v_cvt_pk_bf16_f32 v38, v80, v81
    v_sub_f32 v80, v70, v74
    v_sub_f32 v81, v71, v74
    v_cvt_pk_bf16_f32 v80, v80, v81
    v_and_b32 v81, 0xffff0000, v80
    v_lshlrev_b32 v80, 16, v80
    s_add_u32 m0, s33, 69504
    s_nop 0
    buffer_load_dwordx4 v22, s[44:47], s77 offen offset:128 lds
    s_add_u32 m0, s33, 73728
    s_nop 0
    buffer_load_dwordx4 v9, s[48:51], s77 offen lds
    v_mul_f32 v80, v80, v77
    v_mul_f32 v81, v81, v77
    v_cvt_pk_bf16_f32 v39, v80, v81
    s_add_u32 s90, s90, 0x1e00000
    v_mov_b32 v7, s90
    s_mov_b64 exec, 1
    global_store_dwordx4 v7, v[72:75], s[26:27] sc1
    s_mov_b64 exec, -1
    v_lshrrev_b32 v64, 4, v1
    v_bfe_u32 v65, v1, 2, 2
    v_and_b32 v66, 3, v1
    v_and_b32 v67, 15, v1
    v_lshrrev_b32 v68, 3, v1
    v_and_b32 v69, 7, v1
    s_lshl_b32 s85, s6, 2
    s_lshl_b32 s86, s5, 1
    s_or_b32 s85, s85, s86
    v_lshl_add_u32 v70, v64, 3, v65
    v_lshlrev_b32 v70, 7, v70
    global_store_dwordx4 v86, v[24:27], s[26:27] offset:0 sc1
    s_load_dword s94, s[88:89], s76 offset:28672
    s_load_dword s94, s[88:89], s76 offset:28736
    s_load_dword s94, s[88:89], s76 offset:30720
    s_load_dword s94, s[88:89], s76 offset:30784
    s_waitcnt vmcnt(16)
    s_barrier
    s_add_u32 m0, s79, 98304
    s_add_u32 s72, s72, 128
    s_and_b32 s78, s72, 0x7ff
    buffer_load_dwordx4 v20, s[36:39], s78 offen lds
    v_and_b32 v71, 1, v66
    v_lshl_add_u32 v70, v71, 3, v70
    v_add_u32 v70, 16384, v70
    v_and_b32 v71, 2, v65
    v_and_b32 v72, 1, v64
    v_lshl_add_u32 v71, v72, 2, v71
    v_lshrrev_b32 v72, 1, v66
    v_xor_b32 v71, v71, v72
    s_add_u32 m0, s79, 99328
    s_nop 0
    buffer_load_dwordx4 v21, s[36:39], s78 offen lds
    v_xor_b32 v71, s85, v71
    v_xor_b32 v72, 0, v71
    v_lshl_add_u32 v4, v72, 4, v70
    v_add_u32 v6, 40960, v4
    v_xor_b32 v72, 2, v71
    v_lshl_add_u32 v5, v72, 4, v70
    v_add_u32 v7, 40960, v5
    v_lshrrev_b32 v70, 1, v67
    s_add_u32 m0, s33, 77824
    s_add_u32 s77, s77, 229376
    buffer_load_dwordx4 v22, s[40:43], s77 offen offset:0 lds
    v_xor_b32 v70, v70, v64
    v_lshlrev_b32 v70, 4, v70
    v_lshl_add_u32 v70, v67, 7, v70
    s_lshl_b32 s85, s5, 13
    v_add_u32 v16, s85, v70
    v_xor_b32 v17, 64, v16
    s_sub_u32 s95, 16384, s85
    s_mov_b32 s80, 135168
    s_lshl_b32 s86, s28, 7
    s_sub_u32 s86, s86, 16
    s_max_i32 s86, s86, 0
    s_lshl_b32 s87, s4, 2
    v_add_u32 v71, s87, v68
    s_add_u32 m0, s33, 81792
    s_nop 0
    buffer_load_dwordx4 v22, s[40:43], s77 offen offset:128 lds
    v_lshrrev_b32 v70, 1, v71
    v_and_b32 v70, 7, v70
    v_xor_b32 v70, v70, v69
    v_lshlrev_b32 v70, 4, v70
    v_add_u32 v71, s86, v71
    v_lshl_add_u32 v3, v71, 11, v70
    s_lshl_b32 s81, s4, 9
    s_lshl_b32 s85, s4, 3
    s_and_b32 s86, s4, 1
    s_lshl_b32 s86, s86, 2
    v_and_b32 v70, 2, v68
    s_add_u32 m0, s33, 86016
    s_nop 0
    buffer_load_dwordx4 v22, s[44:47], s77 offen offset:0 lds
    v_xor_b32 v70, v70, v69
    v_xor_b32 v70, s86, v70
    v_add_u32 v71, s85, v68
    v_mul_u32_u24 v71, 6144, v71
    v_lshl_add_u32 v23, v70, 4, v71
    s_lshl_b32 s85, s4, 12
    v_lshl_add_u32 v10, v1, 4, s85
    s_lshl_b32 s85, s4, 4
    v_and_b32 v70, 2, v68
    v_xor_b32 v70, v70, v69
    s_add_u32 m0, s33, 89984
    s_nop 0
    buffer_load_dwordx4 v22, s[44:47], s77 offen offset:128 lds
    s_add_u32 m0, s33, 94208
    s_nop 0
    buffer_load_dwordx4 v9, s[48:51], s77 offen lds
    v_xor_b32 v70, 0, v70
    v_add_u32 v71, s85, v68
    v_mul_u32_u24 v71, 2048, v71
    v_lshl_add_u32 v11, v70, 4, v71
    s_add_u32 s85, s85, 8
    v_and_b32 v70, 2, v68
    v_xor_b32 v70, v70, v69
    v_xor_b32 v70, 4, v70
    v_add_u32 v71, s85, v68
    s_load_dword s94, s[10:11], s52 offset:0x0
    s_load_dword s94, s[10:11], s52 offset:0x40
    s_load_dword s94, s[10:11], s52 offset:0x80
    s_load_dword s94, s[10:11], s52 offset:0xc0
    s_load_dword s94, s[10:11], s52 offset:0x100
    global_store_dwordx4 v86, v[28:31], s[26:27] offset:1024 sc1
    v_mov_b32 v87, 0
    s_mov_b64 exec, 1
    global_load_dwordx2 v[18:19], v87, s[24:25] sc1
    s_mov_b64 exec, -1
    s_waitcnt vmcnt(18)
    s_barrier
    s_add_u32 m0, s79, 100352
    s_add_u32 s78, s78, 32768
    buffer_load_dwordx4 v20, s[36:39], s78 offen lds
    v_mul_u32_u24 v71, 2048, v71
    v_lshl_add_u32 v12, v70, 4, v71
    s_lshl_b32 s85, s31, 8
    s_lshl_b32 s86, s32, 7
    s_add_u32 s86, s85, s86
    s_xor_b32 s87, s86, 128
    s_lshr_b32 s91, s31, 2
    s_lshl1_add_u32 s91, s91, s32
    s_lshl_b32 s91, s91, 13
    s_add_u32 s91, s91, 0x2000000
    s_xor_b32 s85, s91, 8192
    s_and_b32 s92, s31, 3
    s_cmp_eq_u32 s92, 1
    s_cselect_b32 s86, s91, s86
    s_cselect_b32 s87, s85, s87
    s_cselect_b32 s91, 0x2a00000, 0
    s_cselect_b32 s92, s26, s20
    s_cselect_b32 s93, s27, s21
    s_max_u32 s91, s91, 7340032
    s_add_u32 s60, s92, s86
    s_addc_u32 s61, s93, 0
    s_sub_u32 s62, s91, s86
    s_mov_b32 s63, 0x20000
    s_add_u32 m0, s79, 101376
    s_nop 0
    buffer_load_dwordx4 v21, s[36:39], s78 offen lds
    s_add_u32 s64, s92, s87
    s_addc_u32 s65, s93, 0
    s_sub_u32 s66, s91, s87
    s_mov_b32 s67, 0x20000
    s_add_u32 s56, s26, 0x400000
    s_addc_u32 s57, s27, 0
    s_mov_b32 s58, 0xe00000
    s_mov_b32 s59, 0x20000
    s_mul_i32 s82, s30, 917504
    s_mul_i32 s85, s32, 327680
    s_add_u32 s82, s82, s85
    s_mul_i32 s83, s32, 2621440
    s_mul_i32 s85, s32, 10
    s_sub_u32 s85, 40, s85
    s_lshl_b32 s14, s85, 13
    s_lshl_b32 s35, s85, 16
    s_add_u32 s83, s83, 1441792
    s_add_u32 s82, s82, 196608
    s_lshl_b32 s84, s30, 7
    s_lshl_b32 s85, s5, 6
    s_add_u32 s84, s84, s85
    s_lshl_b32 s84, s84, 11
    s_lshl_b32 s85, s31, 8
    s_add_u32 s84, s84, s85
    s_lshl_b32 s85, s32, 7
    s_add_u32 s84, s84, s85
    s_lshl_b32 s85, s6, 6
    s_add_u32 m0, s33, 16384
    s_add_u32 s77, s77, 229376
    s_cmp_eq_u32 s77, 7340032
    s_cselect_b32 s77, 0, s77
    buffer_load_dwordx4 v22, s[40:43], s77 offen offset:0 lds
    s_add_u32 s84, s84, s85
    v_lshrrev_b32 v70, 2, v1
    v_lshl_add_u32 v71, v66, 4, s84
    v_lshl_add_u32 v13, v70, 11, v71
    v_lshrrev_b32 v72, 4, v1
    v_and_b32 v73, 15, v1
    v_and_b32 v74, 1, v72
    v_xor_b32 v74, s5, v74
    v_lshrrev_b32 v75, 1, v72
    s_add_u32 m0, s33, 20352
    s_nop 0
    buffer_load_dwordx4 v22, s[40:43], s77 offen offset:128 lds
    v_lshl_add_u32 v74, v74, 1, v75
    v_lshlrev_b32 v74, 8, v74
    v_lshl_add_u32 v0, v73, 4, v74
    v_lshrrev_b32 v72, 4, v1
    v_and_b32 v73, 1, v72
    v_lshrrev_b32 v72, 1, v72
    v_lshlrev_b32 v72, 8, v72
    v_lshl_add_u32 v72, v73, 10, v72
    s_add_u32 m0, s33, 24576
    s_nop 0
    buffer_load_dwordx4 v22, s[44:47], s77 offen offset:0 lds
    v_and_b32 v73, 15, v1
    v_lshl_add_u32 v8, v73, 4, v72
    s_mov_b32 s54, 7332992
    s_mov_b32 s55, 0x20000
    s_mul_i32 s84, s6, 3072
    s_add_u32 s84, s84, 153600
    v_lshl_add_u32 v85, v1, 3, s84
    s_mul_i32 s84, s28, 112
    s_lshl1_add_u32 s85, s29, s6
    s_add_u32 s86, s85, 2
    s_and_b32 s86, s86, 31
    s_add_u32 s84, s84, s86
    s_add_u32 s84, s84, 80
    s_lshl_b32 s84, s84, 13
    s_lshl_b32 s86, s5, 12
    s_add_u32 s84, s84, s86
    s_add_u32 s84, s84, 0x400000
    s_lshl_b32 s87, s5, 9
    s_add_u32 s73, s84, s87
    s_xor_b32 s87, s87, 512
    s_add_u32 m0, s33, 28544
    s_nop 0
    buffer_load_dwordx4 v22, s[44:47], s77 offen offset:128 lds
    s_add_u32 m0, s33, 32768
    s_nop 0
    buffer_load_dwordx4 v9, s[48:51], s77 offen lds
    s_add_u32 s74, s84, s87
    s_lshl_b32 s84, s28, 5
    s_add_u32 s84, s84, s85
    s_lshl_b32 s84, s84, 13
    s_add_u32 s84, s84, s86
    s_add_u32 s75, s84, 0x1200000
    v_mov_b32 v84, 0xc0135761
    v_mov_b32 v152, 0
    v_mov_b32 v153, 0
    v_mov_b32 v154, 0
    v_mov_b32 v155, 0
    v_mov_b32 v156, 0
    v_mov_b32 v157, 0
    s_load_dword s94, s[10:11], s52 offset:0x140
    s_load_dword s94, s[10:11], s52 offset:0x180
    s_load_dword s94, s[10:11], s52 offset:0x1c0
    s_load_dword s94, s[16:17], s53 offset:0x0
    s_load_dword s94, s[16:17], s53 offset:0x40
    global_store_dwordx4 v86, v[32:35], s[26:27] offset:2048 sc1
    s_waitcnt vmcnt(19)
    s_barrier
    s_add_u32 m0, s79, 116736
    s_add_u32 s72, s72, 128
    s_and_b32 s78, s72, 0x7ff
    buffer_load_dwordx4 v20, s[36:39], s78 offen lds
    v_mov_b32 v158, 0
    v_mov_b32 v159, 0
    v_mov_b32 v160, 0
    v_mov_b32 v161, 0
    v_mov_b32 v162, 0
    v_mov_b32 v163, 0
    v_mov_b32 v164, 0
    v_mov_b32 v165, 0
    s_add_u32 m0, s79, 117760
    s_nop 0
    buffer_load_dwordx4 v21, s[36:39], s78 offen lds
    v_mov_b32 v166, 0
    v_mov_b32 v167, 0
    v_mov_b32 v168, 0
    v_mov_b32 v169, 0
    v_mov_b32 v170, 0
    v_mov_b32 v171, 0
    v_mov_b32 v172, 0
    v_mov_b32 v173, 0
    s_add_u32 m0, s33, 36864
    s_add_u32 s77, s77, 229376
    buffer_load_dwordx4 v22, s[40:43], s77 offen offset:0 lds
    v_mov_b32 v174, 0
    v_mov_b32 v175, 0
    v_mov_b32 v176, 0
    v_mov_b32 v177, 0
    v_mov_b32 v178, 0
    v_mov_b32 v179, 0
    v_mov_b32 v180, 0
    v_mov_b32 v181, 0
    s_add_u32 m0, s33, 40832
    s_nop 0
    buffer_load_dwordx4 v22, s[40:43], s77 offen offset:128 lds
    v_mov_b32 v182, 0
    v_mov_b32 v183, 0
    v_mov_b32 v184, 0
    v_mov_b32 v185, 0
    v_mov_b32 v186, 0
    v_mov_b32 v187, 0
    v_mov_b32 v188, 0
    v_mov_b32 v189, 0
    s_add_u32 m0, s33, 45056
    s_nop 0
    buffer_load_dwordx4 v22, s[44:47], s77 offen offset:0 lds
    v_mov_b32 v190, 0
    v_mov_b32 v191, 0
    v_mov_b32 v192, 0
    v_mov_b32 v193, 0
    v_mov_b32 v194, 0
    v_mov_b32 v195, 0
    v_mov_b32 v196, 0
    v_mov_b32 v197, 0
    s_add_u32 m0, s33, 49024
    s_nop 0
    buffer_load_dwordx4 v22, s[44:47], s77 offen offset:128 lds
    s_add_u32 m0, s33, 53248
    s_nop 0
    buffer_load_dwordx4 v9, s[48:51], s77 offen lds
    v_mov_b32 v198, 0
    v_mov_b32 v199, 0
    v_mov_b32 v200, 0
    v_mov_b32 v201, 0
    v_mov_b32 v202, 0
    v_mov_b32 v203, 0
    v_mov_b32 v204, 0
    v_mov_b32 v205, 0
    s_load_dword s94, s[16:17], s53 offset:0x80
    s_load_dword s94, s[16:17], s53 offset:0xc0
    s_load_dword s94, s[16:17], s53 offset:0x100
    s_load_dword s94, s[16:17], s53 offset:0x140
    s_load_dword s94, s[16:17], s53 offset:0x180
    global_store_dwordx4 v86, v[36:39], s[26:27] offset:3072 sc1
    s_waitcnt vmcnt(18)
    s_barrier
    s_add_u32 m0, s79, 118784
    s_add_u32 s78, s78, 32768
    buffer_load_dwordx4 v20, s[36:39], s78 offen lds
    v_mov_b32 v206, 0
    v_mov_b32 v207, 0
    v_mov_b32 v208, 0
    v_mov_b32 v209, 0
    v_mov_b32 v210, 0
    v_mov_b32 v211, 0
    v_mov_b32 v212, 0
    v_mov_b32 v213, 0
    s_add_u32 m0, s79, 119808
    s_nop 0
    buffer_load_dwordx4 v21, s[36:39], s78 offen lds
    v_mov_b32 v214, 0
    v_mov_b32 v215, 0
    v_mov_b32 v216, 0
    v_mov_b32 v217, 0
    v_mov_b32 v218, 0
    v_mov_b32 v219, 0
    v_mov_b32 v220, 0
    v_mov_b32 v221, 0
    s_add_u32 m0, s33, 57344
    s_add_u32 s77, s77, 229376
    s_cmp_eq_u32 s77, 7340032
    s_cselect_b32 s77, 0, s77
    buffer_load_dwordx4 v22, s[40:43], s77 offen offset:0 lds
    v_mov_b32 v222, 0
    v_mov_b32 v223, 0
    v_mov_b32 v224, 0
    v_mov_b32 v225, 0
    v_mov_b32 v226, 0
    v_mov_b32 v227, 0
    v_mov_b32 v228, 0
    v_mov_b32 v229, 0
    s_add_u32 m0, s33, 61312
    s_nop 0
    buffer_load_dwordx4 v22, s[40:43], s77 offen offset:128 lds
    v_mov_b32 v230, 0
    v_mov_b32 v231, 0
    v_mov_b32 v232, 0
    v_mov_b32 v233, 0
    v_mov_b32 v234, 0
    v_mov_b32 v235, 0
    v_mov_b32 v236, 0
    v_mov_b32 v237, 0
    s_add_u32 m0, s33, 65536
    s_nop 0
    buffer_load_dwordx4 v22, s[44:47], s77 offen offset:0 lds
    v_mov_b32 v238, 0
    v_mov_b32 v239, 0
    v_mov_b32 v240, 0
    v_mov_b32 v241, 0
    v_mov_b32 v242, 0
    v_mov_b32 v243, 0
    v_mov_b32 v244, 0
    v_mov_b32 v245, 0
    s_add_u32 m0, s33, 69504
    s_nop 0
    buffer_load_dwordx4 v22, s[44:47], s77 offen offset:128 lds
    s_add_u32 m0, s33, 73728
    s_nop 0
    buffer_load_dwordx4 v9, s[48:51], s77 offen lds
    v_mov_b32 v246, 0
    v_mov_b32 v247, 0
    v_mov_b32 v248, 0
    v_mov_b32 v249, 0
    v_mov_b32 v250, 0
    v_mov_b32 v251, 0
    v_mov_b32 v252, 0
    v_mov_b32 v253, 0
    s_load_dword s94, s[16:17], s53 offset:0x1c0
    s_load_dword s94, s[18:19], s53 offset:0x0
    s_load_dword s94, s[18:19], s53 offset:0x40
    s_load_dword s94, s[18:19], s53 offset:0x80
    s_load_dword s94, s[18:19], s53 offset:0xc0
    s_waitcnt vmcnt(16)
    s_barrier
    s_add_u32 m0, s79, 135168
    s_add_u32 s72, s72, 128
    s_and_b32 s78, s72, 0x7ff
    buffer_load_dwordx4 v20, s[36:39], s78 offen lds
    v_mov_b32 v254, 0
    v_mov_b32 v255, 0
    v_mov_b32 v112, 0
    v_mov_b32 v113, 0
    v_mov_b32 v114, 0
    v_mov_b32 v115, 0
    v_mov_b32 v116, 0
    v_mov_b32 v117, 0
    v_mov_b32 v118, 0
    v_mov_b32 v119, 0
    s_add_u32 m0, s79, 136192
    s_nop 0
    buffer_load_dwordx4 v21, s[36:39], s78 offen lds
    v_mov_b32 v120, 0
    v_mov_b32 v121, 0
    v_mov_b32 v122, 0
    v_mov_b32 v123, 0
    v_mov_b32 v124, 0
    v_mov_b32 v125, 0
    v_mov_b32 v126, 0
    v_mov_b32 v127, 0
    s_add_u32 m0, s33, 77824
    s_add_u32 s77, s77, 229376
    buffer_load_dwordx4 v22, s[40:43], s77 offen offset:0 lds
    v_mov_b32 v128, 0
    v_mov_b32 v129, 0
    v_mov_b32 v130, 0
    v_mov_b32 v131, 0
    v_mov_b32 v132, 0
    v_mov_b32 v133, 0
    v_mov_b32 v134, 0
    v_mov_b32 v135, 0
    s_add_u32 m0, s33, 81792
    s_nop 0
    buffer_load_dwordx4 v22, s[40:43], s77 offen offset:128 lds
    v_mov_b32 v136, 0
    v_mov_b32 v137, 0
    v_mov_b32 v138, 0
    v_mov_b32 v139, 0
    v_mov_b32 v140, 0
    v_mov_b32 v141, 0
    v_mov_b32 v142, 0
    v_mov_b32 v143, 0
    s_add_u32 m0, s33, 86016
    s_nop 0
    buffer_load_dwordx4 v22, s[44:47], s77 offen offset:0 lds
    s_add_u32 m0, s33, 89984
    s_nop 0
    buffer_load_dwordx4 v22, s[44:47], s77 offen offset:128 lds
L_pad7:
    s_cbranch_execz L_vret0
    v_mov_b32 v144, 0
    v_mov_b32 v145, 0
    v_mov_b32 v146, 0
    v_mov_b32 v147, 0
    v_mov_b32 v148, 0
    v_mov_b32 v149, 0
    v_mov_b32 v150, 0
    v_mov_b32 v151, 0
    s_add_u32 m0, s33, 94208
    s_nop 0
    buffer_load_dwordx4 v9, s[48:51], s77 offen lds
    s_load_dword s94, s[18:19], s53 offset:0x100
    s_load_dword s94, s[18:19], s53 offset:0x140
    s_load_dword s94, s[18:19], s53 offset:0x180
    s_load_dword s94, s[18:19], s53 offset:0x1c0
    s_load_dword s94, s[10:11], s52 offset:0x80000
    s_waitcnt vmcnt(30)
    s_movk_i32 s98, 0x4000
L_tokB_chk:
    v_readfirstlane_b32 s100, v18
    v_readfirstlane_b32 s101, v19
    s_nop 1
    s_cmp_lg_u32 s100, 0
    s_cbranch_scc1 L_tokB_ok
    s_sub_u32 s98, s98, 1
    s_cbranch_scc1 L_tokB_ok
    s_sleep 1
    global_load_dwordx2 v[18:19], v87, s[24:25] sc1
    s_waitcnt vmcnt(0)
    s_branch L_tokB_chk
L_tokB_ok:
    s_waitcnt vmcnt(14)
    s_waitcnt vmcnt(15)
    s_barrier
    s_add_u32 m0, s79, 137216
    s_add_u32 s78, s78, 32768
    buffer_load_dwordx4 v20, s[36:39], s78 offen lds
    s_add_u32 m0, s79, 138240
    s_nop 0
    buffer_load_dwordx4 v21, s[36:39], s78 offen lds
    s_add_u32 m0, s33, 16384
    s_add_u32 s77, s77, 229376
    s_cmp_eq_u32 s77, 7340032
    s_cselect_b32 s77, 0, s77
    buffer_load_dwordx4 v22, s[40:43], s77 offen offset:0 lds
    s_add_u32 m0, s33, 20352
    s_nop 0
    buffer_load_dwordx4 v22, s[40:43], s77 offen offset:128 lds
    s_add_u32 m0, s33, 24576
    s_nop 0
    buffer_load_dwordx4 v22, s[44:47], s77 offen offset:0 lds
    s_add_u32 m0, s33, 28544
    s_nop 0
    buffer_load_dwordx4 v22, s[44:47], s77 offen offset:128 lds
    s_add_u32 m0, s33, 32768
    s_nop 0
    buffer_load_dwordx4 v9, s[48:51], s77 offen lds
    s_load_dword s94, s[10:11], s52 offset:0x80040
    s_load_dword s94, s[10:11], s52 offset:0x80080
    s_load_dword s94, s[10:11], s52 offset:0x800c0
    s_load_dword s94, s[10:11], s52 offset:0x80100
    s_load_dword s94, s[10:11], s52 offset:0x80140
    s_cmp_lg_u32 s4, 0
    s_cbranch_scc1 L_fLN
    s_lshl_b32 s91, s28, 4
    s_add_u32 s91, s91, s29
    s_lshl_b32 s91, s91, 7
    s_add_u32 s91, s91, 0x1e80000
    v_mov_b32 v24, s91
    v_mov_b32 v26, s100
    v_mov_b32 v27, s101
    s_mov_b64 exec, 1
    global_store_dwordx2 v24, v[26:27], s[26:27] sc1
    s_mov_b64 exec, -1
L_fLN:
    s_waitcnt vmcnt(14)
    s_barrier
    s_add_u32 m0, s79, 98304
    s_add_u32 s72, s72, 128
    s_and_b32 s78, s72, 0x7ff
    buffer_load_dwordx4 v20, s[36:39], s78 offen lds
    s_add_u32 m0, s79, 99328
    s_nop 0
    buffer_load_dwordx4 v21, s[36:39], s78 offen lds
    s_add_u32 m0, s33, 36864
    s_add_u32 s77, s77, 229376
    buffer_load_dwordx4 v22, s[40:43], s77 offen offset:0 lds
    s_add_u32 m0, s33, 40832
    s_nop 0
    buffer_load_dwordx4 v22, s[40:43], s77 offen offset:128 lds
    s_add_u32 m0, s33, 45056
    s_nop 0
    buffer_load_dwordx4 v22, s[44:47], s77 offen offset:0 lds
    s_add_u32 m0, s33, 49024
    s_nop 0
    buffer_load_dwordx4 v22, s[44:47], s77 offen offset:128 lds
    s_add_u32 m0, s33, 53248
    s_nop 0
    buffer_load_dwordx4 v9, s[48:51], s77 offen lds
    s_load_dword s94, s[10:11], s52 offset:0x80180
    s_load_dword s94, s[10:11], s52 offset:0x801c0
    s_add_u32 s52, s52, 0x100000
    s_load_dword s94, s[10:11], s52 offset:0x0
    s_load_dword s94, s[10:11], s52 offset:0x40
    s_load_dword s94, s[10:11], s52 offset:0x80
    global_load_dwordx4 v[24:27], v11, s[88:89]
    s_waitcnt vmcnt(15)
    s_barrier
    s_add_u32 m0, s79, 100352
    s_add_u32 s78, s78, 32768
    buffer_load_dwordx4 v20, s[36:39], s78 offen lds
    s_add_u32 m0, s79, 101376
    s_nop 0
    buffer_load_dwordx4 v21, s[36:39], s78 offen lds
    s_add_u32 m0, s33, 57344
    s_add_u32 s77, s77, 229376
    s_cmp_eq_u32 s77, 7340032
    s_cselect_b32 s77, 0, s77
    buffer_load_dwordx4 v22, s[40:43], s77 offen offset:0 lds
    s_add_u32 m0, s33, 61312
    s_nop 0
    buffer_load_dwordx4 v22, s[40:43], s77 offen offset:128 lds
    s_add_u32 m0, s33, 65536
    s_nop 0
    buffer_load_dwordx4 v22, s[44:47], s77 offen offset:0 lds
    s_add_u32 m0, s33, 69504
    s_nop 0
    buffer_load_dwordx4 v22, s[44:47], s77 offen offset:128 lds
    s_add_u32 m0, s33, 73728
    s_nop 0
    buffer_load_dwordx4 v9, s[48:51], s77 offen lds
    s_load_dword s94, s[10:11], s52 offset:0xc0
    s_load_dword s94, s[10:11], s52 offset:0x100
    s_load_dword s94, s[10:11], s52 offset:0x140
    s_load_dword s94, s[10:11], s52 offset:0x180
    s_load_dword s94, s[10:11], s52 offset:0x1c0
    global_load_dwordx4 v[28:31], v12, s[88:89]
    s_waitcnt vmcnt(16)
    s_barrier
    s_add_u32 m0, s79, 116736
    s_add_u32 s72, s72, 128
    s_and_b32 s78, s72, 0x7ff
    buffer_load_dwordx4 v20, s[36:39], s78 offen lds
    s_add_u32 m0, s79, 117760
    s_nop 0
    buffer_load_dwordx4 v21, s[36:39], s78 offen lds
    s_add_u32 m0, s33, 77824
    s_add_u32 s77, s77, 229376
    buffer_load_dwordx4 v22, s[40:43], s77 offen offset:0 lds
    s_add_u32 m0, s33, 81792
    s_nop 0
    buffer_load_dwordx4 v22, s[40:43], s77 offen offset:128 lds
    s_add_u32 m0, s33, 86016
    s_nop 0
    buffer_load_dwordx4 v22, s[44:47], s77 offen offset:0 lds
    s_add_u32 m0, s33, 89984
    s_nop 0
    buffer_load_dwordx4 v22, s[44:47], s77 offen offset:128 lds
    s_add_u32 m0, s33, 94208
    s_nop 0
    buffer_load_dwordx4 v9, s[48:51], s77 offen lds
    s_load_dword s94, s[10:11], s52 offset:0x80000
    s_load_dword s94, s[10:11], s52 offset:0x80040
    s_load_dword s94, s[10:11], s52 offset:0x80080
    s_load_dword s94, s[10:11], s52 offset:0x800c0
    s_load_dword s94, s[10:11], s52 offset:0x80100
    s_lshl1_add_u32 s91, s33, s34
    s_add_u32 s91, s91, 0x2000000
    v_lshl_add_u32 v32, v1, 4, s91
    s_and_b32 s85, s31, 3
    s_cmp_eq_u32 s85, 1
    s_cselect_b64 vcc, -1, 0
    s_lshl_b32 s85, s4, 11
    v_lshl_add_u32 v70, v1, 4, s85
    v_add_u32 v71, 1024, v70
    v_cndmask_b32 v11, v11, v70, vcc
    v_cndmask_b32 v12, v12, v71, vcc
    s_waitcnt vmcnt(15)
    global_store_dwordx4 v32, v[24:27], s[26:27] offset:0 sc1
    s_waitcnt vmcnt(17)
    s_barrier
    s_add_u32 m0, s79, 118784
    s_add_u32 s78, s78, 32768
    buffer_load_dwordx4 v20, s[36:39], s78 offen lds
    s_add_u32 m0, s79, 119808
    s_nop 0
    buffer_load_dwordx4 v21, s[36:39], s78 offen lds
    s_add_u32 m0, s33, 16384
    s_add_u32 s77, s77, 229376
    s_cmp_eq_u32 s77, 7340032
    s_cselect_b32 s77, 0, s77
    buffer_load_dwordx4 v22, s[40:43], s77 offen offset:0 lds
    s_add_u32 m0, s33, 20352
    s_nop 0
    buffer_load_dwordx4 v22, s[40:43], s77 offen offset:128 lds
    s_add_u32 m0, s33, 24576
    s_nop 0
    buffer_load_dwordx4 v22, s[44:47], s77 offen offset:0 lds
    s_add_u32 m0, s33, 28544
    s_nop 0
    buffer_load_dwordx4 v22, s[44:47], s77 offen offset:128 lds
    s_add_u32 m0, s33, 32768
    s_nop 0
    buffer_load_dwordx4 v9, s[48:51], s77 offen lds
    s_load_dword s94, s[10:11], s52 offset:0x80140
    s_load_dword s94, s[10:11], s52 offset:0x80180
    s_load_dword s94, s[10:11], s52 offset:0x801c0
    s_add_u32 s53, s53, 0x1c0000
    s_load_dword s94, s[16:17], s53 offset:0x0
    s_load_dword s94, s[16:17], s53 offset:0x40
    s_waitcnt vmcnt(15)
    global_store_dwordx4 v32, v[28:31], s[26:27] offset:1024 sc1
    s_waitcnt vmcnt(17)
    s_barrier
    s_mov_b64 exec, 0
    s_cmp_eq_u32 s4, 0
    s_cbranch_scc1 L_pad4
    s_cmp_eq_u32 s4, 1
    s_cbranch_scc1 L_pad5
    s_cmp_eq_u32 s4, 2
    s_cbranch_scc1 L_pad10
    s_cmp_eq_u32 s4, 3
    s_cbranch_scc1 L_pad11
L_vret2:
    s_mov_b64 exec, -1
    s_load_dword s94, s[16:17], s53 offset:0x80
    s_load_dword s94, s[16:17], s53 offset:0xc0
    s_load_dword s94, s[16:17], s53 offset:0x100
    s_load_dword s94, s[16:17], s53 offset:0x140
    s_load_dword s94, s[16:17], s53 offset:0x180
    s_waitcnt vmcnt(9)
    s_barrier
    s_add_u32 m0, s79, 135168
    s_add_u32 s72, s72, 128
    s_and_b32 s78, s72, 0x7ff
    buffer_load_dwordx4 v20, s[36:39], s78 offen lds
    s_add_u32 m0, s79, 136192
    s_nop 0
    buffer_load_dwordx4 v21, s[36:39], s78 offen lds
    s_add_u32 m0, s33, 36864
    s_add_u32 s77, s77, 229376
    buffer_load_dwordx4 v22, s[40:43], s77 offen offset:0 lds
    s_add_u32 m0, s33, 40832
    s_nop 0
    buffer_load_dwordx4 v22, s[40:43], s77 offen offset:128 lds
    s_add_u32 m0, s33, 45056
    s_nop 0
    buffer_load_dwordx4 v22, s[44:47], s77 offen offset:0 lds
    s_add_u32 m0, s33, 49024
    s_nop 0
    buffer_load_dwordx4 v22, s[44:47], s77 offen offset:128 lds
    s_add_u32 m0, s33, 53248
    s_nop 0
    buffer_load_dwordx4 v9, s[48:51], s77 offen lds
    s_add_u32 m0, s79, 137216
    s_add_u32 s78, s78, 32768
    buffer_load_dwordx4 v20, s[36:39], s78 offen lds
    s_add_u32 m0, s79, 138240
    s_nop 0
    buffer_load_dwordx4 v21, s[36:39], s78 offen lds
    s_add_u32 m0, s33, 57344
    s_add_u32 s77, s77, 229376
    s_cmp_eq_u32 s77, 7340032
    s_cselect_b32 s77, 0, s77
    buffer_load_dwordx4 v22, s[40:43], s77 offen offset:0 lds
    s_load_dword s94, s[16:17], s53 offset:0x1c0
    s_load_dword s94, s[18:19], s53 offset:0x0
    s_load_dword s94, s[18:19], s53 offset:0x40
    s_load_dword s94, s[18:19], s53 offset:0x80
    s_load_dword s94, s[18:19], s53 offset:0xc0
    s_sub_u32 s91, s28, s6
    s_max_i32 s91, s91, 0
    s_lshl_b32 s91, s91, 4
    s_cmp_lg_u32 s5, 0
    s_cselect_b32 s91, s29, s91
    s_cselect_b32 s92, 11, 7
    s_lshl_b32 s91, s91, 7
    s_add_u32 s91, s91, 0x1e80000
    v_lshlrev_b32 v87, s92, v1
    v_add_u32 v87, s91, v87
    s_mov_b64 exec, 0xffff
    global_load_dwordx2 v[18:19], v87, s[26:27] sc1
    s_mov_b64 exec, -1
    s_waitcnt vmcnt(12)
    s_barrier
    s_add_u32 m0, s33, 61312
    s_nop 0
    buffer_load_dwordx4 v22, s[40:43], s77 offen offset:128 lds
    s_add_u32 m0, s33, 65536
    s_nop 0
    buffer_load_dwordx4 v22, s[44:47], s77 offen offset:0 lds
    s_add_u32 m0, s33, 69504
    s_nop 0
    buffer_load_dwordx4 v22, s[44:47], s77 offen offset:128 lds
    s_add_u32 m0, s33, 73728
    s_nop 0
    buffer_load_dwordx4 v9, s[48:51], s77 offen lds
    s_add_u32 m0, s79, 98304
    s_add_u32 s72, s72, 128
    s_and_b32 s78, s72, 0x7ff
    buffer_load_dwordx4 v20, s[36:39], s78 offen lds
    s_add_u32 m0, s79, 99328
    s_nop 0
    buffer_load_dwordx4 v21, s[36:39], s78 offen lds
    s_add_u32 m0, s33, 77824
    s_add_u32 s77, s77, 229376
    buffer_load_dwordx4 v22, s[40:43], s77 offen offset:0 lds
    s_add_u32 m0, s33, 81792
    s_nop 0
    buffer_load_dwordx4 v22, s[40:43], s77 offen offset:128 lds
    s_add_u32 m0, s33, 86016
    s_nop 0
    buffer_load_dwordx4 v22, s[44:47], s77 offen offset:0 lds
    s_add_u32 m0, s33, 89984
    s_nop 0
    buffer_load_dwordx4 v22, s[44:47], s77 offen offset:128 lds
    s_load_dword s94, s[18:19], s53 offset:0x100
    s_load_dword s94, s[18:19], s53 offset:0x140
    s_load_dword s94, s[18:19], s53 offset:0x180
    s_load_dword s94, s[18:19], s53 offset:0x1c0
    s_add_u32 s52, s52, 0x100000
    s_load_dword s94, s[10:11], s52 offset:0x0
    s_waitcnt vmcnt(10)
    s_mov_b64 exec, 0xffff
    s_movk_i32 s98, 0x4000
L_pLN_chk:
    v_cmp_ne_u64 vcc, s[100:101], v[18:19]
    s_nop 1
    s_cmp_eq_u64 vcc, 0
    s_cbranch_scc1 L_pLN_ok
    s_sub_u32 s98, s98, 1
    s_cbranch_scc1 L_pLN_ok
    s_sleep 1
    global_load_dwordx2 v[18:19], v87, s[26:27] sc1
    s_waitcnt vmcnt(0)
    s_branch L_pLN_chk
L_pLN_ok:
    s_mov_b64 exec, -1
    s_waitcnt vmcnt(14)
    s_barrier
    s_mul_i32 s91, s29, 20480
    s_mul_i32 s92, s4, 320
    s_add_u32 s91, s91, s92
    s_add_u32 s91, s91, 0x1e10000
    v_lshrrev_b32 v24, 2, v1
    v_mul_u32_u24 v24, 1280, v24
    v_and_b32 v25, 3, v1
    v_lshlrev_b32 v25, 4, v25
    v_add3_u32 v24, v24, v25, s91
    global_load_dwordx4 v[88:91], v24, s[26:27] offset:0
    global_load_dwordx4 v[92:95], v24, s[26:27] offset:64
    global_load_dwordx4 v[96:99], v24, s[26:27] offset:128
    global_load_dwordx4 v[100:103], v24, s[26:27] offset:192
    global_load_dwordx4 v[104:107], v24, s[26:27] offset:256
    s_add_u32 s92, s92, 159744
    v_lshrrev_b32 v37, 4, v1
    v_add_u32 v25, s92, v25
    v_lshl_add_u32 v36, v37, 2, v25
    v_lshl_add_u32 v25, v37, 6, v25
    s_lshl_b32 s91, s28, 2
    s_add_u32 s91, s91, s4
    s_lshl_b32 s91, s91, 8
    s_add_u32 s91, s91, 0x1e00000
    v_and_b32 v27, 31, v1
    v_lshl_add_u32 v26, v27, 3, s91
    global_load_dwordx2 v[28:29], v26, s[26:27]
    s_lshl_b32 s91, s4, 9
    s_add_u32 s91, s91, 161024
    v_lshl_add_u32 v27, v27, 4, s91
    s_add_u32 m0, s33, 94208
    s_nop 0
    buffer_load_dwordx4 v9, s[48:51], s77 offen lds
    s_add_u32 m0, s79, 100352
    s_add_u32 s78, s78, 32768
    buffer_load_dwordx4 v20, s[36:39], s78 offen lds
    s_add_u32 m0, s79, 101376
    s_nop 0
    buffer_load_dwordx4 v21, s[36:39], s78 offen lds
    s_add_u32 m0, s33, 16384
    s_add_u32 s77, s77, 229376
    s_cmp_eq_u32 s77, 7340032
    s_cselect_b32 s77, 0, s77
    buffer_load_dwordx4 v22, s[40:43], s77 offen offset:0 lds
    s_add_u32 m0, s33, 20352
    s_nop 0
    buffer_load_dwordx4 v22, s[40:43], s77 offen offset:128 lds
    s_add_u32 m0, s33, 24576
    s_nop 0
    buffer_load_dwordx4 v22, s[44:47], s77 offen offset:0 lds
    s_add_u32 m0, s33, 28544
    s_nop 0
    buffer_load_dwordx4 v22, s[44:47], s77 offen offset:128 lds
    s_add_u32 m0, s33, 32768
    s_nop 0
    buffer_load_dwordx4 v9, s[48:51], s77 offen lds
    s_load_dword s94, s[10:11], s52 offset:0x40
    s_load_dword s94, s[10:11], s52 offset:0x80
    s_load_dword s94, s[10:11], s52 offset:0xc0
    s_load_dword s94, s[10:11], s52 offset:0x100
    s_load_dword s94, s[10:11], s52 offset:0x140
    s_waitcnt vmcnt(35)
    s_waitcnt vmcnt(20)
    s_barrier
    s_add_u32 m0, s79, 116736
    s_add_u32 s72, s72, 128
    s_and_b32 s78, s72, 0x7ff
    buffer_load_dwordx4 v20, s[36:39], s78 offen lds
    s_add_u32 m0, s79, 117760
    s_nop 0
    buffer_load_dwordx4 v21, s[36:39], s78 offen lds
    s_add_u32 m0, s33, 36864
    s_add_u32 s77, s77, 229376
    buffer_load_dwordx4 v22, s[40:43], s77 offen offset:0 lds
    s_add_u32 m0, s33, 40832
    s_nop 0
    buffer_load_dwordx4 v22, s[40:43], s77 offen offset:128 lds
    s_add_u32 m0, s33, 45056
    s_nop 0
    buffer_load_dwordx4 v22, s[44:47], s77 offen offset:0 lds
    s_add_u32 m0, s33, 49024
    s_nop 0
    buffer_load_dwordx4 v22, s[44:47], s77 offen offset:128 lds
    s_add_u32 m0, s33, 53248
    s_nop 0
    buffer_load_dwordx4 v9, s[48:51], s77 offen lds
    s_load_dword s94, s[10:11], s52 offset:0x180
    s_load_dword s94, s[10:11], s52 offset:0x1c0
    s_load_dword s94, s[10:11], s52 offset:0x80000
    s_load_dword s94, s[10:11], s52 offset:0x80040
    s_load_dword s94, s[10:11], s52 offset:0x80080
    s_cmp_lg_u32 s4, 0
    s_cbranch_scc1 L_fC
    s_lshl_b32 s91, s28, 4
    s_add_u32 s91, s91, s29
    s_lshl_b32 s91, s91, 7
    s_add_u32 s91, s91, 0x1eb0000
    v_mov_b32 v32, s91
    v_mov_b32 v34, s100
    v_mov_b32 v35, s101
    s_mov_b64 exec, 1
    global_store_dwordx2 v32, v[34:35], s[26:27] sc1
    s_mov_b64 exec, -1
L_fC:
    s_waitcnt vmcnt(14)
    s_barrier
    s_add_u32 m0, s79, 118784
    s_add_u32 s78, s78, 32768
    buffer_load_dwordx4 v20, s[36:39], s78 offen lds
    s_waitcnt vmcnt(16)
    v_rcp_f32 v30, v29
    v_mul_f32 v32, -1.0, v28
    v_mul_f32 v35, v29, v29
    v_fma_f32 v31, -v29, v30, 1.0
    v_fma_f32 v30, v31, v30, v30
    v_mul_f32 v33, 0xc0135761, v30
    v_mul_f32 v31, v30, v30
    s_add_u32 m0, s79, 119808
    s_nop 0
    buffer_load_dwordx4 v21, s[36:39], s78 offen lds
    v_mul_f32 v31, v31, v30
    v_mul_f32 v34, 0xbdd2d3e8, v31
    ds_write_b128 v27, v[32:35]
    v_permlane16_swap_b32 v88, v92
    v_permlane16_swap_b32 v96, v100
    v_permlane16_swap_b32 v89, v93
    v_permlane16_swap_b32 v97, v101
    v_permlane16_swap_b32 v90, v94
    v_permlane16_swap_b32 v98, v102
    s_add_u32 m0, s33, 57344
    s_add_u32 s77, s77, 229376
    s_cmp_eq_u32 s77, 7340032
    s_cselect_b32 s77, 0, s77
    buffer_load_dwordx4 v22, s[40:43], s77 offen offset:0 lds
    v_permlane16_swap_b32 v91, v95
    v_permlane16_swap_b32 v99, v103
    v_permlane16_swap_b32 v104, v105
    v_permlane16_swap_b32 v106, v107
    v_add_f32 v88, v88, v92
    v_add_f32 v96, v96, v100
    v_add_f32 v89, v89, v93
    v_add_f32 v97, v97, v101
    s_add_u32 m0, s33, 61312
    s_nop 0
    buffer_load_dwordx4 v22, s[40:43], s77 offen offset:128 lds
    v_add_f32 v90, v90, v94
    v_add_f32 v98, v98, v102
    v_add_f32 v91, v91, v95
    v_add_f32 v99, v99, v103
    v_add_f32 v104, v104, v105
    v_add_f32 v106, v106, v107
    s_nop 0
    v_permlane32_swap_b32 v88, v96
    v_permlane32_swap_b32 v89, v97
    s_add_u32 m0, s33, 65536
    s_nop 0
    buffer_load_dwordx4 v22, s[44:47], s77 offen offset:0 lds
    v_permlane32_swap_b32 v90, v98
    v_permlane32_swap_b32 v91, v99
    v_permlane32_swap_b32 v104, v106
    v_add_f32 v88, v88, v96
    v_add_f32 v89, v89, v97
    v_add_f32 v90, v90, v98
    v_add_f32 v91, v91, v99
    v_add_f32 v104, v104, v106
    s_add_u32 m0, s33, 69504
    s_nop 0
    buffer_load_dwordx4 v22, s[44:47], s77 offen offset:128 lds
    s_add_u32 m0, s33, 73728
    s_nop 0
    buffer_load_dwordx4 v9, s[48:51], s77 offen lds
    v_add_f32_dpp v88, v88, v88 row_ror:8 row_mask:0xf bank_mask:0xf
    v_add_f32_dpp v89, v89, v89 row_ror:8 row_mask:0xf bank_mask:0xf
    v_add_f32_dpp v90, v90, v90 row_ror:8 row_mask:0xf bank_mask:0xf
    v_add_f32_dpp v91, v91, v91 row_ror:8 row_mask:0xf bank_mask:0xf
    v_add_f32_dpp v104, v104, v104 row_ror:8 row_mask:0xf bank_mask:0xf
    v_add_f32_dpp v88, v88, v88 row_ror:4 row_mask:0xf bank_mask:0xf
    v_add_f32_dpp v89, v89, v89 row_ror:4 row_mask:0xf bank_mask:0xf
    v_add_f32_dpp v90, v90, v90 row_ror:4 row_mask:0xf bank_mask:0xf
    s_load_dword s94, s[10:11], s52 offset:0x800c0
    s_load_dword s94, s[10:11], s52 offset:0x80100
    s_load_dword s94, s[10:11], s52 offset:0x80140
    s_load_dword s94, s[10:11], s52 offset:0x80180
    s_load_dword s94, s[10:11], s52 offset:0x801c0
    s_waitcnt vmcnt(14)
    s_barrier
    s_mov_b32 s36, s26
    s_mov_b32 s37, s27
    s_mov_b32 s38, 0x400000
    s_mov_b32 s39, 0x20000
    s_add_u32 m0, s33, 77824
    s_add_u32 s77, s77, 229376
    buffer_load_dwordx4 v22, s[40:43], s77 offen offset:0 lds
    v_add_f32_dpp v91, v91, v91 row_ror:4 row_mask:0xf bank_mask:0xf
    v_add_f32_dpp v104, v104, v104 row_ror:4 row_mask:0xf bank_mask:0xf
    s_mov_b32 s92, 0x000f000f
    s_mov_b32 s93, s92
    s_mov_b64 exec, s[92:93]
    ds_write_b128 v25, v[88:91]
    ds_write_b32 v36, v104 offset:256
    s_mov_b64 exec, -1
    v_mov_b32 v88, 0
    v_mov_b32 v89, 0
    v_mov_b32 v90, 0
    v_mov_b32 v91, 0
    v_mov_b32 v92, 0
    v_mov_b32 v93, 0
    v_mov_b32 v94, 0
    v_mov_b32 v95, 0
    s_add_u32 m0, s33, 81792
    s_nop 0
    buffer_load_dwordx4 v22, s[40:43], s77 offen offset:128 lds
    s_add_u32 m0, s33, 86016
    s_nop 0
    buffer_load_dwordx4 v22, s[44:47], s77 offen offset:0 lds
    v_mov_b32 v96, 0
    v_mov_b32 v97, 0
    v_mov_b32 v98, 0
    v_mov_b32 v99, 0
    v_mov_b32 v100, 0
    v_mov_b32 v101, 0
    v_mov_b32 v102, 0
    v_mov_b32 v103, 0
    s_add_u32 m0, s33, 89984
    s_nop 0
    buffer_load_dwordx4 v22, s[44:47], s77 offen offset:128 lds
    v_mov_b32 v104, 0
    v_mov_b32 v105, 0
    v_mov_b32 v106, 0
    v_mov_b32 v107, 0
    v_mov_b32 v108, 0
    v_mov_b32 v109, 0
    v_mov_b32 v110, 0
    v_mov_b32 v111, 0
    s_add_u32 m0, s33, 94208
    s_nop 0
    buffer_load_dwordx4 v9, s[48:51], s77 offen lds
    s_add_u32 m0, s79, 135168
    s_mov_b32 s78, 0
    buffer_load_dwordx4 v20, s[36:39], s78 offen sc1 lds
    s_add_u32 m0, s79, 136192
    s_nop 0
    buffer_load_dwordx4 v21, s[36:39], s78 offen sc1 lds
    s_waitcnt vmcnt(14)
    s_barrier
    s_lshl_b32 s85, s29, 7
    s_add_u32 s86, s85, 4096
    s_add_u32 s87, s85, 128
    s_and_b32 s87, s87, 0x7ff
    s_add_u32 s87, s87, 5120
    s_add_u32 s40, s10, s85
    s_addc_u32 s41, s11, 0
    s_add_u32 s44, s10, s86
    s_addc_u32 s45, s11, 0
    s_add_u32 s48, s16, s87
    s_addc_u32 s49, s17, 0
    s_add_u32 s52, s18, s87
    s_addc_u32 s53, s19, 0
    s_sub_u32 s42, 6291456, s85
    s_sub_u32 s46, 6291456, s86
    s_mov_b32 s50, s54
    s_add_u32 m0, s79, 137216
    s_mov_b32 s78, 32768
    buffer_load_dwordx4 v20, s[36:39], s78 offen sc1 lds
    s_add_u32 m0, s79, 138240
    s_nop 0
    buffer_load_dwordx4 v21, s[36:39], s78 offen sc1 lds
    s_add_u32 m0, s81, 151552
    s_mov_b32 s78, 0
    s_mov_b64 exec, 0xffffffff
    buffer_load_dwordx4 v3, s[36:39], s78 offen sc1 lds
    s_mov_b64 exec, -1
    s_add_u32 m0, s33, 16384
    s_mov_b32 s76, 0
    buffer_load_dwordx4 v23, s[40:43], s76 offen offset:0 lds
    s_add_u32 m0, s33, 18432
    s_nop 0
    buffer_load_dwordx4 v23, s[40:43], s76 offen offset:2048 lds
    s_add_u32 m0, s33, 24576
    s_nop 0
    buffer_load_dwordx4 v23, s[44:47], s76 offen offset:0 lds
    s_add_u32 m0, s33, 28672
    s_mov_b32 s77, 0
    buffer_load_dwordx4 v22, s[48:51], s77 offen offset:0 lds
    s_add_u32 m0, s33, 32768
    s_nop 0
    buffer_load_dwordx4 v22, s[52:55], s77 offen offset:0 lds
    s_waitcnt vmcnt(15)
    s_barrier
    s_add_u32 m0, s79, 98304
    s_mov_b32 s78, 128
    buffer_load_dwordx4 v20, s[36:39], s78 offen sc1 lds
    s_add_u32 m0, s79, 99328
    s_nop 0
    buffer_load_dwordx4 v21, s[36:39], s78 offen sc1 lds
    s_add_u32 m0, s33, 36864
    s_mov_b32 s76, 196608
    buffer_load_dwordx4 v23, s[40:43], s76 offen offset:0 lds
    s_add_u32 m0, s33, 38912
    s_nop 0
    buffer_load_dwordx4 v23, s[40:43], s76 offen offset:2048 lds
    s_add_u32 m0, s33, 45056
    s_nop 0
    buffer_load_dwordx4 v23, s[44:47], s76 offen offset:0 lds
    s_add_u32 m0, s33, 49152
    s_mov_b32 s77, 229376
    buffer_load_dwordx4 v22, s[48:51], s77 offen offset:0 lds
    s_add_u32 m0, s33, 53248
    s_nop 0
    buffer_load_dwordx4 v22, s[52:55], s77 offen offset:0 lds
    s_waitcnt vmcnt(17)
    s_barrier
    s_add_u32 m0, s79, 100352
    s_mov_b32 s78, 32896
    buffer_load_dwordx4 v20, s[36:39], s78 offen sc1 lds
    s_add_u32 m0, s79, 101376
    s_nop 0
    buffer_load_dwordx4 v21, s[36:39], s78 offen sc1 lds
    s_add_u32 m0, s81, 114688
    s_mov_b32 s78, 128
L_pad8:
    s_cbranch_execz L_vret0
    s_mov_b64 exec, 0xffffffff
    buffer_load_dwordx4 v3, s[36:39], s78 offen sc1 lds
    s_mov_b64 exec, -1
    s_add_u32 m0, s33, 57344
    s_mov_b32 s76, 393216
    buffer_load_dwordx4 v23, s[40:43], s76 offen offset:0 lds
    s_add_u32 m0, s33, 59392
    s_nop 0
    buffer_load_dwordx4 v23, s[40:43], s76 offen offset:2048 lds
    s_add_u32 m0, s33, 65536
    s_nop 0
    buffer_load_dwordx4 v23, s[44:47], s76 offen offset:0 lds
    s_add_u32 m0, s33, 69632
    s_mov_b32 s77, 458752
    buffer_load_dwordx4 v22, s[48:51], s77 offen offset:0 lds
    s_add_u32 m0, s33, 73728
    s_nop 0
    buffer_load_dwordx4 v22, s[52:55], s77 offen offset:0 lds
    s_waitcnt lgkmcnt(0)
    s_waitcnt vmcnt(15)
    s_barrier
    s_setprio 1
    v_add_u32 v14, s80, v16
    v_add_u32 v15, s80, v17
    s_add_u32 s84, s80, s95
    v_add_u32 v18, s84, v16
    v_add_u32 v19, s84, v17
    s_add_u32 s80, s80, 18432
    s_cmp_ge_u32 s80, 153600
    s_cselect_b32 s84, 55296, 0
    s_sub_u32 s80, s80, s84
    ds_read_b64_tr_b16 v[64:65], v4 offset:4096
    ds_read_b64_tr_b16 v[66:67], v4 offset:4608
    ds_read_b128 v[24:27], v14 offset:0
    ds_read_b128 v[28:31], v14 offset:2048
    ds_read_b128 v[32:35], v14 offset:4096
    ds_read_b128 v[36:39], v14 offset:6144
    ds_read_b64_tr_b16 v[68:69], v5 offset:4096
    ds_read_b64_tr_b16 v[70:71], v5 offset:4608
    ds_read_b64_tr_b16 v[72:73], v4 offset:8192
    ds_read_b64_tr_b16 v[74:75], v4 offset:8704
    ds_read_b128 v[56:59], v18
    s_mov_b32 s34, 7
.p2align 6
L_p2:
    s_waitcnt lgkmcnt(8)
    v_mfma_f32_16x16x32_bf16 v[88:91], v[64:67], v[24:27], v[88:91]
    ds_read_b64_tr_b16 v[76:77], v5 offset:8192
    s_waitcnt lgkmcnt(8)
    v_mfma_f32_16x16x32_bf16 v[92:95], v[64:67], v[28:31], v[92:95]
    ds_read_b64_tr_b16 v[78:79], v5 offset:8704
    s_waitcnt lgkmcnt(8)
    v_mfma_f32_16x16x32_bf16 v[96:99], v[64:67], v[32:35], v[96:99]
    ds_read_b64_tr_b16 v[80:81], v4 offset:0
    s_waitcnt lgkmcnt(8)
    v_mfma_f32_16x16x32_bf16 v[100:103], v[64:67], v[36:39], v[100:103]
    ds_read_b64_tr_b16 v[82:83], v4 offset:512
    s_waitcnt lgkmcnt(4)
    v_mfma_f32_16x16x32_bf16 v[248:251], v[64:67], v[56:59], v[248:251]
    v_mfma_f32_16x16x32_bf16 v[104:107], v[68:71], v[24:27], v[104:107]
    ds_read_b64_tr_b16 v[64:65], v5 offset:0
    v_mfma_f32_16x16x32_bf16 v[108:111], v[68:71], v[28:31], v[108:111]
    v_mfma_f32_16x16x32_bf16 v[112:115], v[68:71], v[32:35], v[112:115]
    ds_read_b64_tr_b16 v[66:67], v5 offset:512
    v_mfma_f32_16x16x32_bf16 v[116:119], v[68:71], v[36:39], v[116:119]
    v_mfma_f32_16x16x32_bf16 v[120:123], v[24:27], v[72:75], v[120:123]
    ds_read_b64_tr_b16 v[68:69], v4 offset:12288
    v_mfma_f32_16x16x32_bf16 v[124:127], v[28:31], v[72:75], v[124:127]
    v_mfma_f32_16x16x32_bf16 v[128:131], v[32:35], v[72:75], v[128:131]
    ds_read_b64_tr_b16 v[70:71], v4 offset:12800
    v_mfma_f32_16x16x32_bf16 v[132:135], v[36:39], v[72:75], v[132:135]
    v_mfma_f32_16x16x32_bf16 v[252:255], v[56:59], v[72:75], v[252:255]
    s_waitcnt lgkmcnt(6)
    v_mfma_f32_16x16x32_bf16 v[136:139], v[24:27], v[76:79], v[136:139]
    ds_read_b64_tr_b16 v[72:73], v4 offset:16384
    v_mfma_f32_16x16x32_bf16 v[140:143], v[28:31], v[76:79], v[140:143]
    v_mfma_f32_16x16x32_bf16 v[144:147], v[32:35], v[76:79], v[144:147]
    ds_read_b64_tr_b16 v[74:75], v4 offset:16896
    v_mfma_f32_16x16x32_bf16 v[148:151], v[36:39], v[76:79], v[148:151]
    s_waitcnt lgkmcnt(6)
    v_mfma_f32_16x16x32_bf16 v[152:155], v[80:83], v[24:27], v[152:155]
    ds_read_b64_tr_b16 v[76:77], v5 offset:12288
    v_mfma_f32_16x16x32_bf16 v[156:159], v[80:83], v[28:31], v[156:159]
    v_mfma_f32_16x16x32_bf16 v[160:163], v[80:83], v[32:35], v[160:163]
    ds_read_b64_tr_b16 v[78:79], v5 offset:12800
    v_mfma_f32_16x16x32_bf16 v[164:167], v[80:83], v[36:39], v[164:167]
    s_waitcnt lgkmcnt(6)
    v_mfma_f32_16x16x32_bf16 v[168:171], v[64:67], v[24:27], v[168:171]
    ds_read_b64_tr_b16 v[80:81], v5 offset:16384
    v_mfma_f32_16x16x32_bf16 v[172:175], v[64:67], v[28:31], v[172:175]
    v_mfma_f32_16x16x32_bf16 v[176:179], v[64:67], v[32:35], v[176:179]
    ds_read_b64_tr_b16 v[82:83], v5 offset:16896
    v_mfma_f32_16x16x32_bf16 v[180:183], v[64:67], v[36:39], v[180:183]
    s_waitcnt lgkmcnt(6)
    v_mfma_f32_16x16x32_bf16 v[184:187], v[68:71], v[24:27], v[184:187]
    v_mfma_f32_16x16x32_bf16 v[188:191], v[68:71], v[28:31], v[188:191]
    v_mfma_f32_16x16x32_bf16 v[192:195], v[68:71], v[32:35], v[192:195]
    v_mfma_f32_16x16x32_bf16 v[196:199], v[68:71], v[36:39], v[196:199]
    s_waitcnt vmcnt(8) lgkmcnt(0)
    s_barrier
    v_mfma_f32_16x16x32_bf16 v[200:203], v[72:75], v[24:27], v[200:203]
    ds_read_b64_tr_b16 v[64:65], v4 offset:24576
    v_mfma_f32_16x16x32_bf16 v[204:207], v[72:75], v[28:31], v[204:207]
    ds_read_b64_tr_b16 v[66:67], v4 offset:25088
    v_mfma_f32_16x16x32_bf16 v[208:211], v[72:75], v[32:35], v[208:211]
    ds_read_b128 v[40:43], v15 offset:0
    v_mfma_f32_16x16x32_bf16 v[212:215], v[72:75], v[36:39], v[212:215]
    ds_read_b128 v[44:47], v15 offset:2048
    v_mfma_f32_16x16x32_bf16 v[216:219], v[76:79], v[24:27], v[216:219]
    ds_read_b128 v[48:51], v15 offset:4096
    v_mfma_f32_16x16x32_bf16 v[220:223], v[76:79], v[28:31], v[220:223]
    ds_read_b128 v[52:55], v15 offset:6144
    v_mfma_f32_16x16x32_bf16 v[224:227], v[76:79], v[32:35], v[224:227]
    ds_read_b64_tr_b16 v[68:69], v5 offset:24576
    v_mfma_f32_16x16x32_bf16 v[228:231], v[76:79], v[36:39], v[228:231]
    ds_read_b64_tr_b16 v[70:71], v5 offset:25088
    v_mfma_f32_16x16x32_bf16 v[232:235], v[80:83], v[24:27], v[232:235]
    ds_read_b64_tr_b16 v[72:73], v4 offset:28672
    v_mfma_f32_16x16x32_bf16 v[236:239], v[80:83], v[28:31], v[236:239]
    ds_read_b64_tr_b16 v[74:75], v4 offset:29184
    v_mfma_f32_16x16x32_bf16 v[240:243], v[80:83], v[32:35], v[240:243]
    ds_read_b128 v[60:63], v19
    v_mfma_f32_16x16x32_bf16 v[244:247], v[80:83], v[36:39], v[244:247]
    s_waitcnt lgkmcnt(8)
    v_mfma_f32_16x16x32_bf16 v[88:91], v[64:67], v[40:43], v[88:91]
    ds_read_b64_tr_b16 v[76:77], v5 offset:28672
    s_waitcnt lgkmcnt(8)
    v_mfma_f32_16x16x32_bf16 v[92:95], v[64:67], v[44:47], v[92:95]
    ds_read_b64_tr_b16 v[78:79], v5 offset:29184
    s_waitcnt lgkmcnt(8)
    v_mfma_f32_16x16x32_bf16 v[96:99], v[64:67], v[48:51], v[96:99]
    ds_read_b64_tr_b16 v[80:81], v4 offset:20480
    s_waitcnt lgkmcnt(8)
    v_mfma_f32_16x16x32_bf16 v[100:103], v[64:67], v[52:55], v[100:103]
    ds_read_b64_tr_b16 v[82:83], v4 offset:20992
    s_waitcnt lgkmcnt(4)
    v_mfma_f32_16x16x32_bf16 v[248:251], v[64:67], v[60:63], v[248:251]
    v_mfma_f32_16x16x32_bf16 v[104:107], v[68:71], v[40:43], v[104:107]
    ds_read_b64_tr_b16 v[64:65], v5 offset:20480
    v_mfma_f32_16x16x32_bf16 v[108:111], v[68:71], v[44:47], v[108:111]
    v_add_u32 v14, s80, v16
    v_mfma_f32_16x16x32_bf16 v[112:115], v[68:71], v[48:51], v[112:115]
    ds_read_b64_tr_b16 v[66:67], v5 offset:20992
    v_mfma_f32_16x16x32_bf16 v[116:119], v[68:71], v[52:55], v[116:119]
    v_add_u32 v15, s80, v17
    v_mfma_f32_16x16x32_bf16 v[120:123], v[40:43], v[72:75], v[120:123]
    ds_read_b64_tr_b16 v[68:69], v4 offset:32768
    v_mfma_f32_16x16x32_bf16 v[124:127], v[44:47], v[72:75], v[124:127]
    s_add_u32 s84, s80, s95
    v_mfma_f32_16x16x32_bf16 v[128:131], v[48:51], v[72:75], v[128:131]
    ds_read_b64_tr_b16 v[70:71], v4 offset:33280
    v_mfma_f32_16x16x32_bf16 v[132:135], v[52:55], v[72:75], v[132:135]
    v_add_u32 v18, s84, v16
    v_mfma_f32_16x16x32_bf16 v[252:255], v[60:63], v[72:75], v[252:255]
    s_waitcnt lgkmcnt(6)
    v_mfma_f32_16x16x32_bf16 v[136:139], v[40:43], v[76:79], v[136:139]
    ds_read_b64_tr_b16 v[72:73], v4 offset:36864
    v_mfma_f32_16x16x32_bf16 v[140:143], v[44:47], v[76:79], v[140:143]
    v_add_u32 v19, s84, v17
    v_mfma_f32_16x16x32_bf16 v[144:147], v[48:51], v[76:79], v[144:147]
    ds_read_b64_tr_b16 v[74:75], v4 offset:37376
    v_mfma_f32_16x16x32_bf16 v[148:151], v[52:55], v[76:79], v[148:151]
    s_add_u32 s80, s80, 18432
    s_waitcnt lgkmcnt(6)
    v_mfma_f32_16x16x32_bf16 v[152:155], v[80:83], v[40:43], v[152:155]
    ds_read_b64_tr_b16 v[76:77], v5 offset:32768
    v_mfma_f32_16x16x32_bf16 v[156:159], v[80:83], v[44:47], v[156:159]
    s_cmp_ge_u32 s80, 153600
    s_cselect_b32 s84, 55296, 0
    v_mfma_f32_16x16x32_bf16 v[160:163], v[80:83], v[48:51], v[160:163]
    ds_read_b64_tr_b16 v[78:79], v5 offset:33280
    v_mfma_f32_16x16x32_bf16 v[164:167], v[80:83], v[52:55], v[164:167]
    s_sub_u32 s80, s80, s84
    s_waitcnt lgkmcnt(6)
    v_mfma_f32_16x16x32_bf16 v[168:171], v[64:67], v[40:43], v[168:171]
    ds_read_b64_tr_b16 v[80:81], v5 offset:36864
    v_mfma_f32_16x16x32_bf16 v[172:175], v[64:67], v[44:47], v[172:175]
    v_mfma_f32_16x16x32_bf16 v[176:179], v[64:67], v[48:51], v[176:179]
    ds_read_b64_tr_b16 v[82:83], v5 offset:37376
    v_mfma_f32_16x16x32_bf16 v[180:183], v[64:67], v[52:55], v[180:183]
    s_waitcnt lgkmcnt(6)
    v_mfma_f32_16x16x32_bf16 v[184:187], v[68:71], v[40:43], v[184:187]
    v_mfma_f32_16x16x32_bf16 v[188:191], v[68:71], v[44:47], v[188:191]
    v_mfma_f32_16x16x32_bf16 v[192:195], v[68:71], v[48:51], v[192:195]
    v_mfma_f32_16x16x32_bf16 v[196:199], v[68:71], v[52:55], v[196:199]
    s_waitcnt vmcnt(0) lgkmcnt(0)
    s_barrier
    v_mfma_f32_16x16x32_bf16 v[200:203], v[72:75], v[40:43], v[200:203]
    ds_read_b64_tr_b16 v[64:65], v6 offset:4096
    v_mfma_f32_16x16x32_bf16 v[204:207], v[72:75], v[44:47], v[204:207]
    ds_read_b64_tr_b16 v[66:67], v6 offset:4608
    v_mfma_f32_16x16x32_bf16 v[208:211], v[72:75], v[48:51], v[208:211]
    ds_read_b128 v[24:27], v14 offset:0
    v_mfma_f32_16x16x32_bf16 v[212:215], v[72:75], v[52:55], v[212:215]
    ds_read_b128 v[28:31], v14 offset:2048
    v_mfma_f32_16x16x32_bf16 v[216:219], v[76:79], v[40:43], v[216:219]
    ds_read_b128 v[32:35], v14 offset:4096
    v_mfma_f32_16x16x32_bf16 v[220:223], v[76:79], v[44:47], v[220:223]
    ds_read_b128 v[36:39], v14 offset:6144
    v_mfma_f32_16x16x32_bf16 v[224:227], v[76:79], v[48:51], v[224:227]
    ds_read_b64_tr_b16 v[68:69], v7 offset:4096
    v_mfma_f32_16x16x32_bf16 v[228:231], v[76:79], v[52:55], v[228:231]
    ds_read_b64_tr_b16 v[70:71], v7 offset:4608
    v_mfma_f32_16x16x32_bf16 v[232:235], v[80:83], v[40:43], v[232:235]
    ds_read_b64_tr_b16 v[72:73], v6 offset:8192
    v_mfma_f32_16x16x32_bf16 v[236:239], v[80:83], v[44:47], v[236:239]
    ds_read_b64_tr_b16 v[74:75], v6 offset:8704
    v_mfma_f32_16x16x32_bf16 v[240:243], v[80:83], v[48:51], v[240:243]
    ds_read_b128 v[56:59], v18
    v_mfma_f32_16x16x32_bf16 v[244:247], v[80:83], v[52:55], v[244:247]
    s_waitcnt lgkmcnt(8)
    v_mfma_f32_16x16x32_bf16 v[88:91], v[64:67], v[24:27], v[88:91]
    ds_read_b64_tr_b16 v[76:77], v7 offset:8192
    s_waitcnt lgkmcnt(8)
    v_mfma_f32_16x16x32_bf16 v[92:95], v[64:67], v[28:31], v[92:95]
    ds_read_b64_tr_b16 v[78:79], v7 offset:8704
    s_waitcnt lgkmcnt(8)
    v_mfma_f32_16x16x32_bf16 v[96:99], v[64:67], v[32:35], v[96:99]
    ds_read_b64_tr_b16 v[80:81], v6 offset:0
    s_waitcnt lgkmcnt(8)
    v_mfma_f32_16x16x32_bf16 v[100:103], v[64:67], v[36:39], v[100:103]
    ds_read_b64_tr_b16 v[82:83], v6 offset:512
    s_waitcnt lgkmcnt(4)
    v_mfma_f32_16x16x32_bf16 v[248:251], v[64:67], v[56:59], v[248:251]
    v_mfma_f32_16x16x32_bf16 v[104:107], v[68:71], v[24:27], v[104:107]
    ds_read_b64_tr_b16 v[64:65], v7 offset:0
    v_mfma_f32_16x16x32_bf16 v[108:111], v[68:71], v[28:31], v[108:111]
    v_mfma_f32_16x16x32_bf16 v[112:115], v[68:71], v[32:35], v[112:115]
    ds_read_b64_tr_b16 v[66:67], v7 offset:512
    v_mfma_f32_16x16x32_bf16 v[116:119], v[68:71], v[36:39], v[116:119]
    v_mfma_f32_16x16x32_bf16 v[120:123], v[24:27], v[72:75], v[120:123]
    ds_read_b64_tr_b16 v[68:69], v6 offset:12288
    v_mfma_f32_16x16x32_bf16 v[124:127], v[28:31], v[72:75], v[124:127]
    v_mfma_f32_16x16x32_bf16 v[128:131], v[32:35], v[72:75], v[128:131]
    ds_read_b64_tr_b16 v[70:71], v6 offset:12800
    v_mfma_f32_16x16x32_bf16 v[132:135], v[36:39], v[72:75], v[132:135]
    v_mfma_f32_16x16x32_bf16 v[252:255], v[56:59], v[72:75], v[252:255]
    s_waitcnt lgkmcnt(6)
    v_mfma_f32_16x16x32_bf16 v[136:139], v[24:27], v[76:79], v[136:139]
    ds_read_b64_tr_b16 v[72:73], v6 offset:16384
    v_mfma_f32_16x16x32_bf16 v[140:143], v[28:31], v[76:79], v[140:143]
    v_mfma_f32_16x16x32_bf16 v[144:147], v[32:35], v[76:79], v[144:147]
    ds_read_b64_tr_b16 v[74:75], v6 offset:16896
    v_mfma_f32_16x16x32_bf16 v[148:151], v[36:39], v[76:79], v[148:151]
    s_waitcnt lgkmcnt(6)
    v_mfma_f32_16x16x32_bf16 v[152:155], v[80:83], v[24:27], v[152:155]
    ds_read_b64_tr_b16 v[76:77], v7 offset:12288
    v_mfma_f32_16x16x32_bf16 v[156:159], v[80:83], v[28:31], v[156:159]
    v_mfma_f32_16x16x32_bf16 v[160:163], v[80:83], v[32:35], v[160:163]
    ds_read_b64_tr_b16 v[78:79], v7 offset:12800
    v_mfma_f32_16x16x32_bf16 v[164:167], v[80:83], v[36:39], v[164:167]
    s_waitcnt lgkmcnt(6)
    v_mfma_f32_16x16x32_bf16 v[168:171], v[64:67], v[24:27], v[168:171]
    ds_read_b64_tr_b16 v[80:81], v7 offset:16384
    v_mfma_f32_16x16x32_bf16 v[172:175], v[64:67], v[28:31], v[172:175]
    v_mfma_f32_16x16x32_bf16 v[176:179], v[64:67], v[32:35], v[176:179]
    ds_read_b64_tr_b16 v[82:83], v7 offset:16896
    v_mfma_f32_16x16x32_bf16 v[180:183], v[64:67], v[36:39], v[180:183]
    s_waitcnt lgkmcnt(6)
    v_mfma_f32_16x16x32_bf16 v[184:187], v[68:71], v[24:27], v[184:187]
    v_mfma_f32_16x16x32_bf16 v[188:191], v[68:71], v[28:31], v[188:191]
    v_mfma_f32_16x16x32_bf16 v[192:195], v[68:71], v[32:35], v[192:195]
    v_mfma_f32_16x16x32_bf16 v[196:199], v[68:71], v[36:39], v[196:199]
    s_waitcnt lgkmcnt(0)
    s_barrier
    v_mfma_f32_16x16x32_bf16 v[200:203], v[72:75], v[24:27], v[200:203]
    ds_read_b64_tr_b16 v[64:65], v6 offset:24576
    v_mfma_f32_16x16x32_bf16 v[204:207], v[72:75], v[28:31], v[204:207]
    ds_read_b64_tr_b16 v[66:67], v6 offset:25088
    v_mfma_f32_16x16x32_bf16 v[208:211], v[72:75], v[32:35], v[208:211]
    ds_read_b128 v[40:43], v15 offset:0
    v_mfma_f32_16x16x32_bf16 v[212:215], v[72:75], v[36:39], v[212:215]
    ds_read_b128 v[44:47], v15 offset:2048
    v_mfma_f32_16x16x32_bf16 v[216:219], v[76:79], v[24:27], v[216:219]
    ds_read_b128 v[48:51], v15 offset:4096
    v_mfma_f32_16x16x32_bf16 v[220:223], v[76:79], v[28:31], v[220:223]
    ds_read_b128 v[52:55], v15 offset:6144
    v_mfma_f32_16x16x32_bf16 v[224:227], v[76:79], v[32:35], v[224:227]
    ds_read_b64_tr_b16 v[68:69], v7 offset:24576
    v_mfma_f32_16x16x32_bf16 v[228:231], v[76:79], v[36:39], v[228:231]
    ds_read_b64_tr_b16 v[70:71], v7 offset:25088
    v_mfma_f32_16x16x32_bf16 v[232:235], v[80:83], v[24:27], v[232:235]
    ds_read_b64_tr_b16 v[72:73], v6 offset:28672
    v_mfma_f32_16x16x32_bf16 v[236:239], v[80:83], v[28:31], v[236:239]
    ds_read_b64_tr_b16 v[74:75], v6 offset:29184
    v_mfma_f32_16x16x32_bf16 v[240:243], v[80:83], v[32:35], v[240:243]
    ds_read_b128 v[60:63], v19
    v_mfma_f32_16x16x32_bf16 v[244:247], v[80:83], v[36:39], v[244:247]
    s_waitcnt lgkmcnt(8)
    v_mfma_f32_16x16x32_bf16 v[88:91], v[64:67], v[40:43], v[88:91]
    ds_read_b64_tr_b16 v[76:77], v7 offset:28672
    s_waitcnt lgkmcnt(8)
    v_mfma_f32_16x16x32_bf16 v[92:95], v[64:67], v[44:47], v[92:95]
    ds_read_b64_tr_b16 v[78:79], v7 offset:29184
    s_waitcnt lgkmcnt(8)
    v_mfma_f32_16x16x32_bf16 v[96:99], v[64:67], v[48:51], v[96:99]
    ds_read_b64_tr_b16 v[80:81], v6 offset:20480
    s_waitcnt lgkmcnt(8)
    v_mfma_f32_16x16x32_bf16 v[100:103], v[64:67], v[52:55], v[100:103]
    ds_read_b64_tr_b16 v[82:83], v6 offset:20992
    s_waitcnt lgkmcnt(4)
    v_mfma_f32_16x16x32_bf16 v[248:251], v[64:67], v[60:63], v[248:251]
    v_mfma_f32_16x16x32_bf16 v[104:107], v[68:71], v[40:43], v[104:107]
    ds_read_b64_tr_b16 v[64:65], v7 offset:20480
    v_mfma_f32_16x16x32_bf16 v[108:111], v[68:71], v[44:47], v[108:111]
    v_add_u32 v14, s80, v16
    v_mfma_f32_16x16x32_bf16 v[112:115], v[68:71], v[48:51], v[112:115]
    ds_read_b64_tr_b16 v[66:67], v7 offset:20992
    v_mfma_f32_16x16x32_bf16 v[116:119], v[68:71], v[52:55], v[116:119]
    v_add_u32 v15, s80, v17
    v_mfma_f32_16x16x32_bf16 v[120:123], v[40:43], v[72:75], v[120:123]
    ds_read_b64_tr_b16 v[68:69], v6 offset:32768
    v_mfma_f32_16x16x32_bf16 v[124:127], v[44:47], v[72:75], v[124:127]
    s_add_u32 s84, s80, s95
    v_mfma_f32_16x16x32_bf16 v[128:131], v[48:51], v[72:75], v[128:131]
    ds_read_b64_tr_b16 v[70:71], v6 offset:33280
    v_mfma_f32_16x16x32_bf16 v[132:135], v[52:55], v[72:75], v[132:135]
    v_add_u32 v18, s84, v16
    v_mfma_f32_16x16x32_bf16 v[252:255], v[60:63], v[72:75], v[252:255]
    s_waitcnt lgkmcnt(6)
    v_mfma_f32_16x16x32_bf16 v[136:139], v[40:43], v[76:79], v[136:139]
    ds_read_b64_tr_b16 v[72:73], v6 offset:36864
    v_mfma_f32_16x16x32_bf16 v[140:143], v[44:47], v[76:79], v[140:143]
    v_add_u32 v19, s84, v17
    v_mfma_f32_16x16x32_bf16 v[144:147], v[48:51], v[76:79], v[144:147]
    ds_read_b64_tr_b16 v[74:75], v6 offset:37376
    v_mfma_f32_16x16x32_bf16 v[148:151], v[52:55], v[76:79], v[148:151]
    s_add_u32 s80, s80, 18432
    s_waitcnt lgkmcnt(6)
    v_mfma_f32_16x16x32_bf16 v[152:155], v[80:83], v[40:43], v[152:155]
    ds_read_b64_tr_b16 v[76:77], v7 offset:32768
    v_mfma_f32_16x16x32_bf16 v[156:159], v[80:83], v[44:47], v[156:159]
    s_cmp_ge_u32 s80, 153600
    s_cselect_b32 s84, 55296, 0
    v_mfma_f32_16x16x32_bf16 v[160:163], v[80:83], v[48:51], v[160:163]
    ds_read_b64_tr_b16 v[78:79], v7 offset:33280
    v_mfma_f32_16x16x32_bf16 v[164:167], v[80:83], v[52:55], v[164:167]
    s_sub_u32 s80, s80, s84
    s_waitcnt lgkmcnt(6)
    v_mfma_f32_16x16x32_bf16 v[168:171], v[64:67], v[40:43], v[168:171]
    ds_read_b64_tr_b16 v[80:81], v7 offset:36864
    v_mfma_f32_16x16x32_bf16 v[172:175], v[64:67], v[44:47], v[172:175]
    v_mfma_f32_16x16x32_bf16 v[176:179], v[64:67], v[48:51], v[176:179]
    ds_read_b64_tr_b16 v[82:83], v7 offset:37376
    v_mfma_f32_16x16x32_bf16 v[180:183], v[64:67], v[52:55], v[180:183]
    s_waitcnt lgkmcnt(6)
    v_mfma_f32_16x16x32_bf16 v[184:187], v[68:71], v[40:43], v[184:187]
    v_mfma_f32_16x16x32_bf16 v[188:191], v[68:71], v[44:47], v[188:191]
    v_mfma_f32_16x16x32_bf16 v[192:195], v[68:71], v[48:51], v[192:195]
    v_mfma_f32_16x16x32_bf16 v[196:199], v[68:71], v[52:55], v[196:199]
    s_waitcnt lgkmcnt(0)
    s_barrier
    v_mfma_f32_16x16x32_bf16 v[200:203], v[72:75], v[40:43], v[200:203]
    ds_read_b64_tr_b16 v[64:65], v4 offset:4096
    v_mfma_f32_16x16x32_bf16 v[204:207], v[72:75], v[44:47], v[204:207]
    ds_read_b64_tr_b16 v[66:67], v4 offset:4608
    v_mfma_f32_16x16x32_bf16 v[208:211], v[72:75], v[48:51], v[208:211]
    ds_read_b128 v[24:27], v14 offset:0
    v_mfma_f32_16x16x32_bf16 v[212:215], v[72:75], v[52:55], v[212:215]
    ds_read_b128 v[28:31], v14 offset:2048
    v_mfma_f32_16x16x32_bf16 v[216:219], v[76:79], v[40:43], v[216:219]
    ds_read_b128 v[32:35], v14 offset:4096
    v_mfma_f32_16x16x32_bf16 v[220:223], v[76:79], v[44:47], v[220:223]
    ds_read_b128 v[36:39], v14 offset:6144
    v_mfma_f32_16x16x32_bf16 v[224:227], v[76:79], v[48:51], v[224:227]
    ds_read_b64_tr_b16 v[68:69], v5 offset:4096
    v_mfma_f32_16x16x32_bf16 v[228:231], v[76:79], v[52:55], v[228:231]
    ds_read_b64_tr_b16 v[70:71], v5 offset:4608
    v_mfma_f32_16x16x32_bf16 v[232:235], v[80:83], v[40:43], v[232:235]
    ds_read_b64_tr_b16 v[72:73], v4 offset:8192
    v_mfma_f32_16x16x32_bf16 v[236:239], v[80:83], v[44:47], v[236:239]
    ds_read_b64_tr_b16 v[74:75], v4 offset:8704
    v_mfma_f32_16x16x32_bf16 v[240:243], v[80:83], v[48:51], v[240:243]
    ds_read_b128 v[56:59], v18
    v_mfma_f32_16x16x32_bf16 v[244:247], v[80:83], v[52:55], v[244:247]
    s_sub_u32 s34, s34, 1
    s_cmp_lg_u32 s34, 0
    s_cbranch_scc1 L_p2
    s_waitcnt lgkmcnt(8)
    v_mfma_f32_16x16x32_bf16 v[88:91], v[64:67], v[24:27], v[88:91]
    ds_read_b64_tr_b16 v[76:77], v5 offset:8192
    s_waitcnt lgkmcnt(8)
    v_mfma_f32_16x16x32_bf16 v[92:95], v[64:67], v[28:31], v[92:95]
    ds_read_b64_tr_b16 v[78:79], v5 offset:8704
    s_waitcnt lgkmcnt(8)
    v_mfma_f32_16x16x32_bf16 v[96:99], v[64:67], v[32:35], v[96:99]
    ds_read_b64_tr_b16 v[80:81], v4 offset:0
    s_waitcnt lgkmcnt(8)
    v_mfma_f32_16x16x32_bf16 v[100:103], v[64:67], v[36:39], v[100:103]
    ds_read_b64_tr_b16 v[82:83], v4 offset:512
    s_waitcnt lgkmcnt(4)
    v_mfma_f32_16x16x32_bf16 v[248:251], v[64:67], v[56:59], v[248:251]
    v_mfma_f32_16x16x32_bf16 v[104:107], v[68:71], v[24:27], v[104:107]
    ds_read_b64_tr_b16 v[64:65], v5 offset:0
    v_mfma_f32_16x16x32_bf16 v[108:111], v[68:71], v[28:31], v[108:111]
    v_mfma_f32_16x16x32_bf16 v[112:115], v[68:71], v[32:35], v[112:115]
    ds_read_b64_tr_b16 v[66:67], v5 offset:512
    v_mfma_f32_16x16x32_bf16 v[116:119], v[68:71], v[36:39], v[116:119]
    v_mfma_f32_16x16x32_bf16 v[120:123], v[24:27], v[72:75], v[120:123]
    ds_read_b64_tr_b16 v[68:69], v4 offset:12288
    v_mfma_f32_16x16x32_bf16 v[124:127], v[28:31], v[72:75], v[124:127]
    v_mfma_f32_16x16x32_bf16 v[128:131], v[32:35], v[72:75], v[128:131]
    ds_read_b64_tr_b16 v[70:71], v4 offset:12800
    v_mfma_f32_16x16x32_bf16 v[132:135], v[36:39], v[72:75], v[132:135]
    v_mfma_f32_16x16x32_bf16 v[252:255], v[56:59], v[72:75], v[252:255]
    s_waitcnt lgkmcnt(6)
    v_mfma_f32_16x16x32_bf16 v[136:139], v[24:27], v[76:79], v[136:139]
    ds_read_b64_tr_b16 v[72:73], v4 offset:16384
    v_mfma_f32_16x16x32_bf16 v[140:143], v[28:31], v[76:79], v[140:143]
    v_mfma_f32_16x16x32_bf16 v[144:147], v[32:35], v[76:79], v[144:147]
    ds_read_b64_tr_b16 v[74:75], v4 offset:16896
    v_mfma_f32_16x16x32_bf16 v[148:151], v[36:39], v[76:79], v[148:151]
    s_waitcnt lgkmcnt(6)
    v_mfma_f32_16x16x32_bf16 v[152:155], v[80:83], v[24:27], v[152:155]
    ds_read_b64_tr_b16 v[76:77], v5 offset:12288
    v_mfma_f32_16x16x32_bf16 v[156:159], v[80:83], v[28:31], v[156:159]
    v_mfma_f32_16x16x32_bf16 v[160:163], v[80:83], v[32:35], v[160:163]
    ds_read_b64_tr_b16 v[78:79], v5 offset:12800
    v_mfma_f32_16x16x32_bf16 v[164:167], v[80:83], v[36:39], v[164:167]
    s_waitcnt lgkmcnt(6)
    v_mfma_f32_16x16x32_bf16 v[168:171], v[64:67], v[24:27], v[168:171]
    ds_read_b64_tr_b16 v[80:81], v5 offset:16384
    v_mfma_f32_16x16x32_bf16 v[172:175], v[64:67], v[28:31], v[172:175]
    v_mfma_f32_16x16x32_bf16 v[176:179], v[64:67], v[32:35], v[176:179]
    ds_read_b64_tr_b16 v[82:83], v5 offset:16896
    v_mfma_f32_16x16x32_bf16 v[180:183], v[64:67], v[36:39], v[180:183]
    s_waitcnt lgkmcnt(6)
    v_mfma_f32_16x16x32_bf16 v[184:187], v[68:71], v[24:27], v[184:187]
    v_mfma_f32_16x16x32_bf16 v[188:191], v[68:71], v[28:31], v[188:191]
    v_mfma_f32_16x16x32_bf16 v[192:195], v[68:71], v[32:35], v[192:195]
    v_mfma_f32_16x16x32_bf16 v[196:199], v[68:71], v[36:39], v[196:199]
    s_waitcnt lgkmcnt(0)
    s_barrier
    v_mfma_f32_16x16x32_bf16 v[200:203], v[72:75], v[24:27], v[200:203]
    ds_read_b64_tr_b16 v[64:65], v4 offset:24576
    v_mfma_f32_16x16x32_bf16 v[204:207], v[72:75], v[28:31], v[204:207]
    ds_read_b64_tr_b16 v[66:67], v4 offset:25088
    v_mfma_f32_16x16x32_bf16 v[208:211], v[72:75], v[32:35], v[208:211]
    ds_read_b128 v[40:43], v15 offset:0
    v_mfma_f32_16x16x32_bf16 v[212:215], v[72:75], v[36:39], v[212:215]
    ds_read_b128 v[44:47], v15 offset:2048
    v_mfma_f32_16x16x32_bf16 v[216:219], v[76:79], v[24:27], v[216:219]
    ds_read_b128 v[48:51], v15 offset:4096
    v_mfma_f32_16x16x32_bf16 v[220:223], v[76:79], v[28:31], v[220:223]
    ds_read_b128 v[52:55], v15 offset:6144
    v_mfma_f32_16x16x32_bf16 v[224:227], v[76:79], v[32:35], v[224:227]
    ds_read_b64_tr_b16 v[68:69], v5 offset:24576
    v_mfma_f32_16x16x32_bf16 v[228:231], v[76:79], v[36:39], v[228:231]
    ds_read_b64_tr_b16 v[70:71], v5 offset:25088
    v_mfma_f32_16x16x32_bf16 v[232:235], v[80:83], v[24:27], v[232:235]
    ds_read_b64_tr_b16 v[72:73], v4 offset:28672
    v_mfma_f32_16x16x32_bf16 v[236:239], v[80:83], v[28:31], v[236:239]
    ds_read_b64_tr_b16 v[74:75], v4 offset:29184
    v_mfma_f32_16x16x32_bf16 v[240:243], v[80:83], v[32:35], v[240:243]
    ds_read_b128 v[60:63], v19
    v_mfma_f32_16x16x32_bf16 v[244:247], v[80:83], v[36:39], v[244:247]
    s_waitcnt lgkmcnt(8)
    v_mfma_f32_16x16x32_bf16 v[88:91], v[64:67], v[40:43], v[88:91]
    ds_read_b64_tr_b16 v[76:77], v5 offset:28672
    s_waitcnt lgkmcnt(8)
    v_mfma_f32_16x16x32_bf16 v[92:95], v[64:67], v[44:47], v[92:95]
    ds_read_b64_tr_b16 v[78:79], v5 offset:29184
    s_waitcnt lgkmcnt(8)
    v_mfma_f32_16x16x32_bf16 v[96:99], v[64:67], v[48:51], v[96:99]
    ds_read_b64_tr_b16 v[80:81], v4 offset:20480
    s_waitcnt lgkmcnt(8)
    v_mfma_f32_16x16x32_bf16 v[100:103], v[64:67], v[52:55], v[100:103]
    ds_read_b64_tr_b16 v[82:83], v4 offset:20992
    s_waitcnt lgkmcnt(4)
    v_mfma_f32_16x16x32_bf16 v[248:251], v[64:67], v[60:63], v[248:251]
    v_mfma_f32_16x16x32_bf16 v[104:107], v[68:71], v[40:43], v[104:107]
    ds_read_b64_tr_b16 v[64:65], v5 offset:20480
    v_mfma_f32_16x16x32_bf16 v[108:111], v[68:71], v[44:47], v[108:111]
    v_add_u32 v14, s80, v16
    v_mfma_f32_16x16x32_bf16 v[112:115], v[68:71], v[48:51], v[112:115]
    ds_read_b64_tr_b16 v[66:67], v5 offset:20992
    v_mfma_f32_16x16x32_bf16 v[116:119], v[68:71], v[52:55], v[116:119]
    v_add_u32 v15, s80, v17
    v_mfma_f32_16x16x32_bf16 v[120:123], v[40:43], v[72:75], v[120:123]
    ds_read_b64_tr_b16 v[68:69], v4 offset:32768
    v_mfma_f32_16x16x32_bf16 v[124:127], v[44:47], v[72:75], v[124:127]
    s_add_u32 s84, s80, s95
    v_mfma_f32_16x16x32_bf16 v[128:131], v[48:51], v[72:75], v[128:131]
    ds_read_b64_tr_b16 v[70:71], v4 offset:33280
    v_mfma_f32_16x16x32_bf16 v[132:135], v[52:55], v[72:75], v[132:135]
    v_add_u32 v18, s84, v16
    v_mfma_f32_16x16x32_bf16 v[252:255], v[60:63], v[72:75], v[252:255]
    s_waitcnt lgkmcnt(6)
    v_mfma_f32_16x16x32_bf16 v[136:139], v[40:43], v[76:79], v[136:139]
    ds_read_b64_tr_b16 v[72:73], v4 offset:36864
    v_mfma_f32_16x16x32_bf16 v[140:143], v[44:47], v[76:79], v[140:143]
    v_add_u32 v19, s84, v17
    v_mfma_f32_16x16x32_bf16 v[144:147], v[48:51], v[76:79], v[144:147]
    ds_read_b64_tr_b16 v[74:75], v4 offset:37376
    v_mfma_f32_16x16x32_bf16 v[148:151], v[52:55], v[76:79], v[148:151]
    s_add_u32 s80, s80, 18432
    s_waitcnt lgkmcnt(6)
    v_mfma_f32_16x16x32_bf16 v[152:155], v[80:83], v[40:43], v[152:155]
    ds_read_b64_tr_b16 v[76:77], v5 offset:32768
    v_mfma_f32_16x16x32_bf16 v[156:159], v[80:83], v[44:47], v[156:159]
    s_cmp_ge_u32 s80, 153600
    s_cselect_b32 s84, 55296, 0
    v_mfma_f32_16x16x32_bf16 v[160:163], v[80:83], v[48:51], v[160:163]
    ds_read_b64_tr_b16 v[78:79], v5 offset:33280
    v_mfma_f32_16x16x32_bf16 v[164:167], v[80:83], v[52:55], v[164:167]
    s_sub_u32 s80, s80, s84
    s_waitcnt lgkmcnt(6)
    v_mfma_f32_16x16x32_bf16 v[168:171], v[64:67], v[40:43], v[168:171]
    ds_read_b64_tr_b16 v[80:81], v5 offset:36864
    v_mfma_f32_16x16x32_bf16 v[172:175], v[64:67], v[44:47], v[172:175]
    v_mfma_f32_16x16x32_bf16 v[176:179], v[64:67], v[48:51], v[176:179]
    ds_read_b64_tr_b16 v[82:83], v5 offset:37376
    v_mfma_f32_16x16x32_bf16 v[180:183], v[64:67], v[52:55], v[180:183]
    s_waitcnt lgkmcnt(6)
    v_mfma_f32_16x16x32_bf16 v[184:187], v[68:71], v[40:43], v[184:187]
    v_mfma_f32_16x16x32_bf16 v[188:191], v[68:71], v[44:47], v[188:191]
    v_mfma_f32_16x16x32_bf16 v[192:195], v[68:71], v[48:51], v[192:195]
    v_mfma_f32_16x16x32_bf16 v[196:199], v[68:71], v[52:55], v[196:199]
    s_waitcnt lgkmcnt(0)
    s_barrier
    v_mfma_f32_16x16x32_bf16 v[200:203], v[72:75], v[40:43], v[200:203]
    ds_read_b64_tr_b16 v[64:65], v6 offset:4096
    v_mfma_f32_16x16x32_bf16 v[204:207], v[72:75], v[44:47], v[204:207]
    ds_read_b64_tr_b16 v[66:67], v6 offset:4608
    v_mfma_f32_16x16x32_bf16 v[208:211], v[72:75], v[48:51], v[208:211]
    ds_read_b128 v[24:27], v14 offset:0
    v_mfma_f32_16x16x32_bf16 v[212:215], v[72:75], v[52:55], v[212:215]
    ds_read_b128 v[28:31], v14 offset:2048
    v_mfma_f32_16x16x32_bf16 v[216:219], v[76:79], v[40:43], v[216:219]
    ds_read_b128 v[32:35], v14 offset:4096
    v_mfma_f32_16x16x32_bf16 v[220:223], v[76:79], v[44:47], v[220:223]
    ds_read_b128 v[36:39], v14 offset:6144
    v_mfma_f32_16x16x32_bf16 v[224:227], v[76:79], v[48:51], v[224:227]
    ds_read_b64_tr_b16 v[68:69], v7 offset:4096
    v_mfma_f32_16x16x32_bf16 v[228:231], v[76:79], v[52:55], v[228:231]
    ds_read_b64_tr_b16 v[70:71], v7 offset:4608
    v_mfma_f32_16x16x32_bf16 v[232:235], v[80:83], v[40:43], v[232:235]
    ds_read_b64_tr_b16 v[72:73], v6 offset:8192
    v_mfma_f32_16x16x32_bf16 v[236:239], v[80:83], v[44:47], v[236:239]
    ds_read_b64_tr_b16 v[74:75], v6 offset:8704
    v_mfma_f32_16x16x32_bf16 v[240:243], v[80:83], v[48:51], v[240:243]
    ds_read_b128 v[56:59], v18
    v_mfma_f32_16x16x32_bf16 v[244:247], v[80:83], v[52:55], v[244:247]
    s_waitcnt lgkmcnt(8)
    v_mfma_f32_16x16x32_bf16 v[88:91], v[64:67], v[24:27], v[88:91]
    ds_read_b64_tr_b16 v[76:77], v7 offset:8192
    s_waitcnt lgkmcnt(8)
    v_mfma_f32_16x16x32_bf16 v[92:95], v[64:67], v[28:31], v[92:95]
    ds_read_b64_tr_b16 v[78:79], v7 offset:8704
    s_waitcnt lgkmcnt(8)
    v_mfma_f32_16x16x32_bf16 v[96:99], v[64:67], v[32:35], v[96:99]
    ds_read_b64_tr_b16 v[80:81], v6 offset:0
    s_waitcnt lgkmcnt(8)
    v_mfma_f32_16x16x32_bf16 v[100:103], v[64:67], v[36:39], v[100:103]
    ds_read_b64_tr_b16 v[82:83], v6 offset:512
    s_waitcnt lgkmcnt(4)
    v_mfma_f32_16x16x32_bf16 v[248:251], v[64:67], v[56:59], v[248:251]
    v_mfma_f32_16x16x32_bf16 v[104:107], v[68:71], v[24:27], v[104:107]
    ds_read_b64_tr_b16 v[64:65], v7 offset:0
    v_mfma_f32_16x16x32_bf16 v[108:111], v[68:71], v[28:31], v[108:111]
    v_mfma_f32_16x16x32_bf16 v[112:115], v[68:71], v[32:35], v[112:115]
    ds_read_b64_tr_b16 v[66:67], v7 offset:512
    v_mfma_f32_16x16x32_bf16 v[116:119], v[68:71], v[36:39], v[116:119]
L_pad9:
    s_cbranch_execz L_vret1
    v_mfma_f32_16x16x32_bf16 v[120:123], v[24:27], v[72:75], v[120:123]
    ds_read_b64_tr_b16 v[68:69], v6 offset:12288
    v_mfma_f32_16x16x32_bf16 v[124:127], v[28:31], v[72:75], v[124:127]
    v_mfma_f32_16x16x32_bf16 v[128:131], v[32:35], v[72:75], v[128:131]
    ds_read_b64_tr_b16 v[70:71], v6 offset:12800
    v_mfma_f32_16x16x32_bf16 v[132:135], v[36:39], v[72:75], v[132:135]
    v_mfma_f32_16x16x32_bf16 v[252:255], v[56:59], v[72:75], v[252:255]
    s_waitcnt lgkmcnt(6)
    v_mfma_f32_16x16x32_bf16 v[136:139], v[24:27], v[76:79], v[136:139]
    ds_read_b64_tr_b16 v[72:73], v6 offset:16384
    v_mfma_f32_16x16x32_bf16 v[140:143], v[28:31], v[76:79], v[140:143]
    v_mfma_f32_16x16x32_bf16 v[144:147], v[32:35], v[76:79], v[144:147]
    ds_read_b64_tr_b16 v[74:75], v6 offset:16896
    v_mfma_f32_16x16x32_bf16 v[148:151], v[36:39], v[76:79], v[148:151]
    s_waitcnt lgkmcnt(6)
    v_mfma_f32_16x16x32_bf16 v[152:155], v[80:83], v[24:27], v[152:155]
    ds_read_b64_tr_b16 v[76:77], v7 offset:12288
    v_mfma_f32_16x16x32_bf16 v[156:159], v[80:83], v[28:31], v[156:159]
    v_mfma_f32_16x16x32_bf16 v[160:163], v[80:83], v[32:35], v[160:163]
    ds_read_b64_tr_b16 v[78:79], v7 offset:12800
    v_mfma_f32_16x16x32_bf16 v[164:167], v[80:83], v[36:39], v[164:167]
    s_waitcnt lgkmcnt(6)
    v_mfma_f32_16x16x32_bf16 v[168:171], v[64:67], v[24:27], v[168:171]
    ds_read_b64_tr_b16 v[80:81], v7 offset:16384
    v_mfma_f32_16x16x32_bf16 v[172:175], v[64:67], v[28:31], v[172:175]
    v_mfma_f32_16x16x32_bf16 v[176:179], v[64:67], v[32:35], v[176:179]
    ds_read_b64_tr_b16 v[82:83], v7 offset:16896
    v_mfma_f32_16x16x32_bf16 v[180:183], v[64:67], v[36:39], v[180:183]
    s_waitcnt lgkmcnt(6)
    v_mfma_f32_16x16x32_bf16 v[184:187], v[68:71], v[24:27], v[184:187]
    v_mfma_f32_16x16x32_bf16 v[188:191], v[68:71], v[28:31], v[188:191]
    v_mfma_f32_16x16x32_bf16 v[192:195], v[68:71], v[32:35], v[192:195]
    v_mfma_f32_16x16x32_bf16 v[196:199], v[68:71], v[36:39], v[196:199]
    s_waitcnt lgkmcnt(0)
    s_barrier
    v_mfma_f32_16x16x32_bf16 v[200:203], v[72:75], v[24:27], v[200:203]
    ds_read_b64_tr_b16 v[64:65], v6 offset:24576
    v_mfma_f32_16x16x32_bf16 v[204:207], v[72:75], v[28:31], v[204:207]
    ds_read_b64_tr_b16 v[66:67], v6 offset:25088
    v_mfma_f32_16x16x32_bf16 v[208:211], v[72:75], v[32:35], v[208:211]
    ds_read_b128 v[40:43], v15 offset:0
    v_mfma_f32_16x16x32_bf16 v[212:215], v[72:75], v[36:39], v[212:215]
    ds_read_b128 v[44:47], v15 offset:2048
    v_mfma_f32_16x16x32_bf16 v[216:219], v[76:79], v[24:27], v[216:219]
    ds_read_b128 v[48:51], v15 offset:4096
    v_mfma_f32_16x16x32_bf16 v[220:223], v[76:79], v[28:31], v[220:223]
    ds_read_b128 v[52:55], v15 offset:6144
    v_mfma_f32_16x16x32_bf16 v[224:227], v[76:79], v[32:35], v[224:227]
    ds_read_b64_tr_b16 v[68:69], v7 offset:24576
    v_mfma_f32_16x16x32_bf16 v[228:231], v[76:79], v[36:39], v[228:231]
    ds_read_b64_tr_b16 v[70:71], v7 offset:25088
    v_mfma_f32_16x16x32_bf16 v[232:235], v[80:83], v[24:27], v[232:235]
    ds_read_b64_tr_b16 v[72:73], v6 offset:28672
    v_mfma_f32_16x16x32_bf16 v[236:239], v[80:83], v[28:31], v[236:239]
    ds_read_b64_tr_b16 v[74:75], v6 offset:29184
    v_mfma_f32_16x16x32_bf16 v[240:243], v[80:83], v[32:35], v[240:243]
    ds_read_b128 v[60:63], v19
    v_mfma_f32_16x16x32_bf16 v[244:247], v[80:83], v[36:39], v[244:247]
    s_waitcnt lgkmcnt(8)
    v_mfma_f32_16x16x32_bf16 v[88:91], v[64:67], v[40:43], v[88:91]
    ds_read_b64_tr_b16 v[76:77], v7 offset:28672
    s_waitcnt lgkmcnt(8)
    v_mfma_f32_16x16x32_bf16 v[92:95], v[64:67], v[44:47], v[92:95]
    ds_read_b64_tr_b16 v[78:79], v7 offset:29184
    s_waitcnt lgkmcnt(8)
    v_mfma_f32_16x16x32_bf16 v[96:99], v[64:67], v[48:51], v[96:99]
    ds_read_b64_tr_b16 v[80:81], v6 offset:20480
    s_waitcnt lgkmcnt(8)
    v_mfma_f32_16x16x32_bf16 v[100:103], v[64:67], v[52:55], v[100:103]
    ds_read_b64_tr_b16 v[82:83], v6 offset:20992
    s_waitcnt lgkmcnt(4)
    v_mfma_f32_16x16x32_bf16 v[248:251], v[64:67], v[60:63], v[248:251]
    v_mfma_f32_16x16x32_bf16 v[104:107], v[68:71], v[40:43], v[104:107]
    ds_read_b64_tr_b16 v[64:65], v7 offset:20480
    v_mfma_f32_16x16x32_bf16 v[108:111], v[68:71], v[44:47], v[108:111]
    v_mfma_f32_16x16x32_bf16 v[112:115], v[68:71], v[48:51], v[112:115]
    ds_read_b64_tr_b16 v[66:67], v7 offset:20992
    v_mfma_f32_16x16x32_bf16 v[116:119], v[68:71], v[52:55], v[116:119]
    v_mfma_f32_16x16x32_bf16 v[120:123], v[40:43], v[72:75], v[120:123]
    ds_read_b64_tr_b16 v[68:69], v6 offset:32768
    v_mfma_f32_16x16x32_bf16 v[124:127], v[44:47], v[72:75], v[124:127]
    v_mfma_f32_16x16x32_bf16 v[128:131], v[48:51], v[72:75], v[128:131]
    ds_read_b64_tr_b16 v[70:71], v6 offset:33280
    v_mfma_f32_16x16x32_bf16 v[132:135], v[52:55], v[72:75], v[132:135]
    v_mfma_f32_16x16x32_bf16 v[252:255], v[60:63], v[72:75], v[252:255]
    s_waitcnt lgkmcnt(6)
    v_mfma_f32_16x16x32_bf16 v[136:139], v[40:43], v[76:79], v[136:139]
    ds_read_b64_tr_b16 v[72:73], v6 offset:36864
    v_mfma_f32_16x16x32_bf16 v[140:143], v[44:47], v[76:79], v[140:143]
    v_mfma_f32_16x16x32_bf16 v[144:147], v[48:51], v[76:79], v[144:147]
    ds_read_b64_tr_b16 v[74:75], v6 offset:37376
    v_mfma_f32_16x16x32_bf16 v[148:151], v[52:55], v[76:79], v[148:151]
    s_waitcnt lgkmcnt(6)
    v_mfma_f32_16x16x32_bf16 v[152:155], v[80:83], v[40:43], v[152:155]
    ds_read_b64_tr_b16 v[76:77], v7 offset:32768
    v_mfma_f32_16x16x32_bf16 v[156:159], v[80:83], v[44:47], v[156:159]
    v_mfma_f32_16x16x32_bf16 v[160:163], v[80:83], v[48:51], v[160:163]
    ds_read_b64_tr_b16 v[78:79], v7 offset:33280
    v_mfma_f32_16x16x32_bf16 v[164:167], v[80:83], v[52:55], v[164:167]
    s_waitcnt lgkmcnt(6)
    v_mfma_f32_16x16x32_bf16 v[168:171], v[64:67], v[40:43], v[168:171]
    ds_read_b64_tr_b16 v[80:81], v7 offset:36864
    v_mfma_f32_16x16x32_bf16 v[172:175], v[64:67], v[44:47], v[172:175]
    v_mfma_f32_16x16x32_bf16 v[176:179], v[64:67], v[48:51], v[176:179]
    ds_read_b64_tr_b16 v[82:83], v7 offset:37376
    v_mfma_f32_16x16x32_bf16 v[180:183], v[64:67], v[52:55], v[180:183]
    s_waitcnt lgkmcnt(6)
    v_mfma_f32_16x16x32_bf16 v[184:187], v[68:71], v[40:43], v[184:187]
    v_mfma_f32_16x16x32_bf16 v[188:191], v[68:71], v[44:47], v[188:191]
    v_mfma_f32_16x16x32_bf16 v[192:195], v[68:71], v[48:51], v[192:195]
    v_mfma_f32_16x16x32_bf16 v[196:199], v[68:71], v[52:55], v[196:199]
    s_waitcnt lgkmcnt(0)
    s_barrier
    v_mfma_f32_16x16x32_bf16 v[200:203], v[72:75], v[40:43], v[200:203]
    v_mfma_f32_16x16x32_bf16 v[204:207], v[72:75], v[44:47], v[204:207]
    v_mfma_f32_16x16x32_bf16 v[208:211], v[72:75], v[48:51], v[208:211]
    v_mfma_f32_16x16x32_bf16 v[212:215], v[72:75], v[52:55], v[212:215]
    v_mfma_f32_16x16x32_bf16 v[216:219], v[76:79], v[40:43], v[216:219]
    v_mfma_f32_16x16x32_bf16 v[220:223], v[76:79], v[44:47], v[220:223]
    v_mfma_f32_16x16x32_bf16 v[224:227], v[76:79], v[48:51], v[224:227]
    v_mfma_f32_16x16x32_bf16 v[228:231], v[76:79], v[52:55], v[228:231]
    v_mfma_f32_16x16x32_bf16 v[232:235], v[80:83], v[40:43], v[232:235]
    v_mfma_f32_16x16x32_bf16 v[236:239], v[80:83], v[44:47], v[236:239]
    v_mfma_f32_16x16x32_bf16 v[240:243], v[80:83], v[48:51], v[240:243]
    v_mfma_f32_16x16x32_bf16 v[244:247], v[80:83], v[52:55], v[244:247]
    s_setprio 0
    s_mov_b32 s76, 0xbdd2d3e8
    v_cvt_pk_bf16_f32 v100, v100, v101
    v_cvt_pk_bf16_f32 v101, v102, v103
    v_cvt_pk_bf16_f32 v102, v116, v117
    v_cvt_pk_bf16_f32 v103, v118, v119
    v_cvt_pk_bf16_f32 v32, v132, v133
    v_cvt_pk_bf16_f32 v33, v134, v135
    v_cvt_pk_bf16_f32 v42, v148, v149
    v_cvt_pk_bf16_f32 v43, v150, v151
    v_cvt_pk_bf16_f32 v44, v248, v249
    v_cvt_pk_bf16_f32 v45, v250, v251
    v_cvt_pk_bf16_f32 v24, v252, v253
    v_cvt_pk_bf16_f32 v25, v254, v255
    s_cmp_lg_u32 s5, 0
    s_cbranch_scc1 L_hx1
    ds_write_b64 v85, v[100:101]
    ds_write_b64 v85, v[102:103] offset:512
    ds_write_b64 v85, v[32:33] offset:1024
    ds_write_b64 v85, v[42:43] offset:1536
    s_branch L_hx2
L_hx1:
    ds_write_b64 v85, v[44:45] offset:2048
    ds_write_b64 v85, v[24:25] offset:2560
L_hx2:
    s_waitcnt lgkmcnt(0)
    v_mul_f32 v80, v184, v184
    v_mul_f32 v81, v185, v185
    v_mul_f32 v82, v186, v186
    v_mul_f32 v83, v187, v187
    v_fma_f32 v80, v80, s76, v84
    v_fma_f32 v81, v81, s76, v84
    v_fma_f32 v82, v82, s76, v84
    v_fma_f32 v83, v83, s76, v84
    v_mul_f32 v80, v80, v184
    v_mul_f32 v81, v81, v185
    v_mul_f32 v82, v82, v186
    v_mul_f32 v83, v83, v187
    v_exp_f32 v80, v80
    v_mul_f32 v184, v184, v200
    v_exp_f32 v81, v81
    v_mul_f32 v185, v185, v201
    v_exp_f32 v82, v82
    v_mul_f32 v186, v186, v202
    v_exp_f32 v83, v83
    v_mul_f32 v187, v187, v203
    v_add_f32 v80, 1.0, v80
    v_add_f32 v81, 1.0, v81
    v_add_f32 v82, 1.0, v82
    v_add_f32 v83, 1.0, v83
    v_rcp_f32 v80, v80
    v_rcp_f32 v81, v81
    v_rcp_f32 v82, v82
    v_rcp_f32 v83, v83
    s_nop 0
    v_mul_f32 v184, v184, v80
    v_mul_f32 v185, v185, v81
    v_mul_f32 v186, v186, v82
    v_mul_f32 v187, v187, v83
    v_cvt_pk_bf16_f32 v184, v184, v185
    v_cvt_pk_bf16_f32 v185, v186, v187
    v_mul_f32 v80, v188, v188
    v_mul_f32 v81, v189, v189
    v_mul_f32 v82, v190, v190
    v_mul_f32 v83, v191, v191
    v_fma_f32 v80, v80, s76, v84
    v_fma_f32 v81, v81, s76, v84
    v_fma_f32 v82, v82, s76, v84
    v_fma_f32 v83, v83, s76, v84
    v_mul_f32 v80, v80, v188
    v_mul_f32 v81, v81, v189
    v_mul_f32 v82, v82, v190
    v_mul_f32 v83, v83, v191
    v_exp_f32 v80, v80
    v_mul_f32 v188, v188, v204
    v_exp_f32 v81, v81
    v_mul_f32 v189, v189, v205
    v_exp_f32 v82, v82
    v_mul_f32 v190, v190, v206
    v_exp_f32 v83, v83
    v_mul_f32 v191, v191, v207
    v_add_f32 v80, 1.0, v80
    v_add_f32 v81, 1.0, v81
    v_add_f32 v82, 1.0, v82
    v_add_f32 v83, 1.0, v83
    v_rcp_f32 v80, v80
    v_rcp_f32 v81, v81
    v_rcp_f32 v82, v82
    s_barrier
    s_cmp_lg_u32 s5, 0
    s_cbranch_scc1 L_hx3
    ds_read_b64 v[46:47], v85 offset:2048
    ds_read_b64 v[34:35], v85 offset:2560
    s_branch L_hx4
L_hx3:
    ds_read_b64 v[44:45], v85 offset:512
    ds_read_b64 v[46:47], v85
    ds_read_b64 v[24:25], v85 offset:1536
    ds_read_b64 v[34:35], v85 offset:1024
L_hx4:
    v_rcp_f32 v83, v83
    s_nop 0
    v_mul_f32 v188, v188, v80
    v_mul_f32 v189, v189, v81
    v_mul_f32 v190, v190, v82
    v_mul_f32 v191, v191, v83
    v_cvt_pk_bf16_f32 v186, v188, v189
    v_cvt_pk_bf16_f32 v187, v190, v191
    s_nop 1
    v_permlane16_swap_b32 v184, v186
    v_permlane16_swap_b32 v185, v187
    buffer_store_dwordx4 v[184:187], v8, s[68:71], s73 offen offset:0 sc1
    v_mul_f32 v80, v192, v192
    v_mul_f32 v81, v193, v193
    v_mul_f32 v82, v194, v194
    v_mul_f32 v83, v195, v195
    v_fma_f32 v80, v80, s76, v84
    v_fma_f32 v81, v81, s76, v84
    v_fma_f32 v82, v82, s76, v84
    v_fma_f32 v83, v83, s76, v84
    v_mul_f32 v80, v80, v192
    v_mul_f32 v81, v81, v193
    v_mul_f32 v82, v82, v194
    v_mul_f32 v83, v83, v195
    v_exp_f32 v80, v80
    v_mul_f32 v192, v192, v208
    v_exp_f32 v81, v81
    v_mul_f32 v193, v193, v209
    v_exp_f32 v82, v82
    v_mul_f32 v194, v194, v210
    v_exp_f32 v83, v83
    v_mul_f32 v195, v195, v211
    v_add_f32 v80, 1.0, v80
    v_add_f32 v81, 1.0, v81
    v_add_f32 v82, 1.0, v82
    v_add_f32 v83, 1.0, v83
    v_rcp_f32 v80, v80
    v_rcp_f32 v81, v81
    v_rcp_f32 v82, v82
    v_rcp_f32 v83, v83
    s_nop 0
    v_mul_f32 v192, v192, v80
    v_mul_f32 v193, v193, v81
    v_mul_f32 v194, v194, v82
    v_mul_f32 v195, v195, v83
    v_cvt_pk_bf16_f32 v192, v192, v193
    v_cvt_pk_bf16_f32 v193, v194, v195
    v_mul_f32 v80, v196, v196
    v_mul_f32 v81, v197, v197
    v_mul_f32 v82, v198, v198
    v_mul_f32 v83, v199, v199
    v_fma_f32 v80, v80, s76, v84
    v_fma_f32 v81, v81, s76, v84
    v_fma_f32 v82, v82, s76, v84
    v_fma_f32 v83, v83, s76, v84
    v_mul_f32 v80, v80, v196
    v_mul_f32 v81, v81, v197
    v_mul_f32 v82, v82, v198
    v_mul_f32 v83, v83, v199
    v_exp_f32 v80, v80
    v_mul_f32 v196, v196, v212
    v_exp_f32 v81, v81
    v_mul_f32 v197, v197, v213
    v_exp_f32 v82, v82
    v_mul_f32 v198, v198, v214
    v_exp_f32 v83, v83
    v_mul_f32 v199, v199, v215
    v_add_f32 v80, 1.0, v80
    s_barrier
    s_waitcnt lgkmcnt(0)
    v_add_f32 v81, 1.0, v81
    v_add_f32 v82, 1.0, v82
    v_add_f32 v83, 1.0, v83
    v_rcp_f32 v80, v80
    v_rcp_f32 v81, v81
    v_rcp_f32 v82, v82
    v_rcp_f32 v83, v83
    s_nop 0
    v_mul_f32 v196, v196, v80
    v_mul_f32 v197, v197, v81
    v_mul_f32 v198, v198, v82
    v_mul_f32 v199, v199, v83
    v_cvt_pk_bf16_f32 v194, v196, v197
    v_cvt_pk_bf16_f32 v195, v198, v199
    s_nop 1
    v_permlane16_swap_b32 v192, v194
    v_permlane16_swap_b32 v193, v195
    buffer_store_dwordx4 v[192:195], v8, s[68:71], s73 offen offset:2048 sc1
    v_mul_f32 v80, v216, v216
    v_mul_f32 v81, v217, v217
    v_mul_f32 v82, v218, v218
    v_mul_f32 v83, v219, v219
    v_fma_f32 v80, v80, s76, v84
    v_fma_f32 v81, v81, s76, v84
    v_fma_f32 v82, v82, s76, v84
    v_fma_f32 v83, v83, s76, v84
    v_mul_f32 v80, v80, v216
    v_mul_f32 v81, v81, v217
    v_mul_f32 v82, v82, v218
    v_mul_f32 v83, v83, v219
    v_exp_f32 v80, v80
    v_mul_f32 v216, v216, v232
    v_exp_f32 v81, v81
    v_mul_f32 v217, v217, v233
    v_exp_f32 v82, v82
    v_mul_f32 v218, v218, v234
    v_exp_f32 v83, v83
    v_mul_f32 v219, v219, v235
    v_add_f32 v80, 1.0, v80
    v_add_f32 v81, 1.0, v81
    v_add_f32 v82, 1.0, v82
    v_add_f32 v83, 1.0, v83
    v_rcp_f32 v80, v80
    v_rcp_f32 v81, v81
    v_rcp_f32 v82, v82
    v_rcp_f32 v83, v83
    s_nop 0
    v_mul_f32 v216, v216, v80
    v_mul_f32 v217, v217, v81
    v_mul_f32 v218, v218, v82
    v_mul_f32 v219, v219, v83
    v_cvt_pk_bf16_f32 v216, v216, v217
    v_cvt_pk_bf16_f32 v217, v218, v219
    v_mul_f32 v80, v220, v220
    v_mul_f32 v81, v221, v221
    v_mul_f32 v82, v222, v222
    v_mul_f32 v83, v223, v223
    v_fma_f32 v80, v80, s76, v84
    v_fma_f32 v81, v81, s76, v84
    v_fma_f32 v82, v82, s76, v84
    v_fma_f32 v83, v83, s76, v84
    v_mul_f32 v80, v80, v220
    v_mul_f32 v81, v81, v221
    v_mul_f32 v82, v82, v222
    v_mul_f32 v83, v83, v223
    v_exp_f32 v80, v80
    v_mul_f32 v220, v220, v236
    v_exp_f32 v81, v81
    s_lshl2_add_u32 s91, s2, s4
    s_lshl_b32 s39, s91, 9
    s_lshr_b32 s92, s91, 2
    s_mul_i32 s92, s92, 7168
    s_and_b32 s91, s91, 3
    s_lshl_b32 s91, s91, 9
    s_add_u32 s92, s92, s91
    s_add_u32 s34, s92, 5120
    s_add_u32 s39, s39, 0x180080
    s_load_dword s94, s[20:21], s39 offset:0x0
    s_load_dword s94, s[20:21], s39 offset:0x40
    s_load_dword s94, s[20:21], s39 offset:0x80
    s_load_dword s94, s[20:21], s39 offset:0xc0
    s_load_dword s94, s[20:21], s39 offset:0x100
    s_barrier
    v_mul_f32 v221, v221, v237
    v_exp_f32 v82, v82
    v_mul_f32 v222, v222, v238
    v_exp_f32 v83, v83
    v_mul_f32 v223, v223, v239
    v_add_f32 v80, 1.0, v80
    v_add_f32 v81, 1.0, v81
    v_add_f32 v82, 1.0, v82
    v_add_f32 v83, 1.0, v83
    v_rcp_f32 v80, v80
    v_rcp_f32 v81, v81
    v_rcp_f32 v82, v82
    v_rcp_f32 v83, v83
    s_nop 0
    v_mul_f32 v220, v220, v80
    v_mul_f32 v221, v221, v81
    v_mul_f32 v222, v222, v82
    v_mul_f32 v223, v223, v83
    v_cvt_pk_bf16_f32 v218, v220, v221
    v_cvt_pk_bf16_f32 v219, v222, v223
    s_nop 1
    v_permlane16_swap_b32 v216, v218
    v_permlane16_swap_b32 v217, v219
    buffer_store_dwordx4 v[216:219], v8, s[68:71], s74 offen offset:0 sc1
    v_mul_f32 v80, v224, v224
    v_mul_f32 v81, v225, v225
    v_mul_f32 v82, v226, v226
    v_mul_f32 v83, v227, v227
    v_fma_f32 v80, v80, s76, v84
    v_fma_f32 v81, v81, s76, v84
    v_fma_f32 v82, v82, s76, v84
    v_fma_f32 v83, v83, s76, v84
    v_mul_f32 v80, v80, v224
    v_mul_f32 v81, v81, v225
    v_mul_f32 v82, v82, v226
    v_mul_f32 v83, v83, v227
    v_exp_f32 v80, v80
    v_mul_f32 v224, v224, v240
    v_exp_f32 v81, v81
    v_mul_f32 v225, v225, v241
    v_exp_f32 v82, v82
    v_mul_f32 v226, v226, v242
    v_exp_f32 v83, v83
    v_mul_f32 v227, v227, v243
    v_add_f32 v80, 1.0, v80
    v_add_f32 v81, 1.0, v81
    v_add_f32 v82, 1.0, v82
    v_add_f32 v83, 1.0, v83
    v_rcp_f32 v80, v80
    v_rcp_f32 v81, v81
    v_rcp_f32 v82, v82
    v_rcp_f32 v83, v83
    s_nop 0
    v_mul_f32 v224, v224, v80
    v_mul_f32 v225, v225, v81
    v_mul_f32 v226, v226, v82
    v_mul_f32 v227, v227, v83
    v_cvt_pk_bf16_f32 v224, v224, v225
    v_cvt_pk_bf16_f32 v225, v226, v227
    v_mul_f32 v80, v228, v228
    v_mul_f32 v81, v229, v229
    v_mul_f32 v82, v230, v230
    v_mul_f32 v83, v231, v231
    v_fma_f32 v80, v80, s76, v84
    v_fma_f32 v81, v81, s76, v84
    v_fma_f32 v82, v82, s76, v84
    v_fma_f32 v83, v83, s76, v84
    s_load_dword s94, s[20:21], s39 offset:0x140
    s_add_u32 s39, s39, 0x27ff80
    s_load_dword s94, s[20:21], s39 offset:0x0
    s_load_dword s94, s[20:21], s39 offset:0x40
    s_load_dword s94, s[20:21], s39 offset:0x80
    s_load_dword s94, s[20:21], s39 offset:0xc0
    s_barrier
    v_mul_f32 v80, v80, v228
    v_mul_f32 v81, v81, v229
    v_mul_f32 v82, v82, v230
    v_mul_f32 v83, v83, v231
    v_exp_f32 v80, v80
    v_mul_f32 v228, v228, v244
    v_exp_f32 v81, v81
    v_mul_f32 v229, v229, v245
    v_exp_f32 v82, v82
    v_mul_f32 v230, v230, v246
    v_exp_f32 v83, v83
    v_mul_f32 v231, v231, v247
    v_add_f32 v80, 1.0, v80
    v_add_f32 v81, 1.0, v81
    v_add_f32 v82, 1.0, v82
    v_add_f32 v83, 1.0, v83
    v_rcp_f32 v80, v80
    v_rcp_f32 v81, v81
    v_rcp_f32 v82, v82
    v_rcp_f32 v83, v83
    s_nop 0
    v_mul_f32 v228, v228, v80
    v_mul_f32 v229, v229, v81
    v_mul_f32 v230, v230, v82
    v_mul_f32 v231, v231, v83
    v_cvt_pk_bf16_f32 v226, v228, v229
    v_cvt_pk_bf16_f32 v227, v230, v231
    s_nop 1
    v_permlane16_swap_b32 v224, v226
    v_permlane16_swap_b32 v225, v227
    buffer_store_dwordx4 v[224:227], v8, s[68:71], s74 offen offset:2048 sc1
    v_lshrrev_b32 v64, 4, v1
    v_and_b32 v66, 14, v1
    v_lshlrev_b32 v64, 2, v64
    v_sub_u32 v64, v66, v64
    v_and_b32 v65, 1, v1
    v_cmp_le_i32 s[40:41], 0, v64
    v_cmp_le_i32 s[42:43], 2, v64
    v_mul_u32_u24 v66, 0x202, v65
    s_mov_b32 s80, 0x01000c0c
    v_lshl_add_u32 v66, v66, 16, s80
    v_add_u32 v67, 0x04040000, v66
    v_cndmask_b32 v76, v66, v67, s[40:41]
    v_cndmask_b32 v77, v66, v67, s[42:43]
    v_lshlrev_b32 v65, 4, v65
    v_mov_b32 v68, 0x0c0c0c0c
    v_mov_b32 v66, 0xc0c0100
    v_alignbit_b32 v66, v66, v66, v65
    v_cndmask_b32 v78, v66, v68, s[40:41]
    v_cndmask_b32 v86, v68, v66, s[40:41]
    v_mov_b32 v66, 0xc0c0302
    v_alignbit_b32 v66, v66, v66, v65
    v_cndmask_b32 v79, v66, v68, s[42:43]
    v_cndmask_b32 v87, v68, v66, s[42:43]
    s_or_b32 s80, s28, s5
    s_cmp_eq_u32 s80, 0
    s_cselect_b64 s[80:81], 0, -1
    s_or_b64 s[40:41], s[40:41], s[80:81]
    s_or_b64 s[42:43], s[42:43], s[80:81]
    v_mov_b32 v7, 0xce6e6b28
    s_mov_b32 s77, 0x3e3504f3
    s_mov_b32 s78, 0x3fb8aa3b
    v_cvt_pk_bf16_f32 v88, v88, v89
    v_cvt_pk_bf16_f32 v89, v90, v91
    v_cvt_pk_bf16_f32 v90, v104, v105
    v_cvt_pk_bf16_f32 v91, v106, v107
    v_cvt_pk_bf16_f32 v152, v152, v153
    v_cvt_pk_bf16_f32 v153, v154, v155
    v_cvt_pk_bf16_f32 v154, v168, v169
    v_cvt_pk_bf16_f32 v155, v170, v171
    v_cvt_pk_bf16_f32 v92, v92, v93
    v_cvt_pk_bf16_f32 v93, v94, v95
    v_cvt_pk_bf16_f32 v94, v108, v109
    v_cvt_pk_bf16_f32 v95, v110, v111
    v_cvt_pk_bf16_f32 v156, v156, v157
    v_cvt_pk_bf16_f32 v157, v158, v159
    v_cvt_pk_bf16_f32 v158, v172, v173
    v_cvt_pk_bf16_f32 v159, v174, v175
    s_load_dword s94, s[20:21], s39 offset:0x100
    s_load_dword s94, s[20:21], s39 offset:0x140
    s_load_dword s94, s[20:21], s39 offset:0x180
    s_load_dword s94, s[20:21], s39 offset:0x1c0
    s_add_u32 s39, s39, 0xffe00000
    s_load_dword s94, s[20:21], s39 offset:0x0
    s_barrier
    s_setprio 3
    v_mfma_f32_16x16x32_bf16 v[48:51], v[44:47], v[152:155], 0
    v_mfma_f32_16x16x32_bf16 v[52:55], v[88:91], v[152:155], 0
    s_setprio 0
    v_cvt_pk_bf16_f32 v96, v96, v97
    v_cvt_pk_bf16_f32 v97, v98, v99
    v_cvt_pk_bf16_f32 v98, v112, v113
    v_cvt_pk_bf16_f32 v99, v114, v115
    v_cvt_pk_bf16_f32 v160, v160, v161
    v_cvt_pk_bf16_f32 v161, v162, v163
    v_cvt_pk_bf16_f32 v162, v176, v177
    v_cvt_pk_bf16_f32 v163, v178, v179
    s_setprio 3
    v_mfma_f32_16x16x32_bf16 v[56:59], v[88:91], v[156:159], 0
    v_mfma_f32_16x16x32_bf16 v[60:63], v[92:95], v[156:159], 0
    s_setprio 0
    v_cvt_pk_bf16_f32 v48, v48, v49
    v_cvt_pk_bf16_f32 v49, v50, v51
    v_cvt_pk_bf16_f32 v50, v52, v53
    v_cvt_pk_bf16_f32 v51, v54, v55
    v_perm_b32 v64, v50, v48, v76
    v_perm_b32 v65, v51, v49, v77
    v_mul_f32 v64, s77, v64
    v_mul_f32 v65, s77, v65
    v_cvt_pk_bf16_f32 v65, v64, v65
    v_lshlrev_b32 v64, 16, v65
    v_and_b32 v65, 0xffff0000, v65
    v_cndmask_b32 v64, v7, v64, s[40:41]
    v_cndmask_b32 v65, v7, v65, s[42:43]
    v_max_f32 v72, v64, v65
    v_cvt_pk_bf16_f32 v164, v164, v165
    v_cvt_pk_bf16_f32 v165, v166, v167
    v_cvt_pk_bf16_f32 v166, v180, v181
    v_cvt_pk_bf16_f32 v167, v182, v183
    s_setprio 3
    v_mfma_f32_16x16x32_bf16 v[48:51], v[92:95], v[160:163], 0
    v_mfma_f32_16x16x32_bf16 v[52:55], v[96:99], v[160:163], 0
    s_setprio 0
    v_cvt_pk_bf16_f32 v56, v56, v57
    v_cvt_pk_bf16_f32 v57, v58, v59
    v_cvt_pk_bf16_f32 v58, v60, v61
    v_cvt_pk_bf16_f32 v59, v62, v63
    v_perm_b32 v66, v58, v56, v76
    v_perm_b32 v67, v59, v57, v77
    v_mul_f32 v66, s77, v66
    v_mul_f32 v67, s77, v67
    v_cvt_pk_bf16_f32 v67, v66, v67
    v_lshlrev_b32 v66, 16, v67
    v_and_b32 v67, 0xffff0000, v67
    v_max_f32 v73, v66, v67
    s_setprio 3
    v_mfma_f32_16x16x32_bf16 v[56:59], v[96:99], v[164:167], 0
    v_mfma_f32_16x16x32_bf16 v[60:63], v[100:103], v[164:167], 0
    s_setprio 0
    v_cvt_pk_bf16_f32 v26, v120, v121
    v_cvt_pk_bf16_f32 v27, v122, v123
    v_cvt_pk_bf16_f32 v36, v136, v137
    v_cvt_pk_bf16_f32 v37, v138, v139
    s_load_dword s94, s[20:21], s39 offset:0x40
    s_load_dword s94, s[20:21], s39 offset:0x80
    s_load_dword s94, s[20:21], s39 offset:0xc0
    s_load_dword s94, s[20:21], s39 offset:0x100
    s_load_dword s94, s[20:21], s39 offset:0x140
    s_barrier
    v_cvt_pk_bf16_f32 v28, v124, v125
    v_cvt_pk_bf16_f32 v29, v126, v127
    v_cvt_pk_bf16_f32 v38, v140, v141
    v_cvt_pk_bf16_f32 v39, v142, v143
    v_cvt_pk_bf16_f32 v30, v128, v129
    v_cvt_pk_bf16_f32 v31, v130, v131
    v_cvt_pk_bf16_f32 v40, v144, v145
    v_cvt_pk_bf16_f32 v41, v146, v147
    v_cvt_pk_bf16_f32 v48, v48, v49
    v_cvt_pk_bf16_f32 v49, v50, v51
    v_cvt_pk_bf16_f32 v50, v52, v53
    v_cvt_pk_bf16_f32 v51, v54, v55
    v_perm_b32 v68, v50, v48, v76
    v_perm_b32 v69, v51, v49, v77
    v_mul_f32 v68, s77, v68
    v_mul_f32 v69, s77, v69
    v_cvt_pk_bf16_f32 v69, v68, v69
    v_lshlrev_b32 v68, 16, v69
    v_and_b32 v69, 0xffff0000, v69
    v_max_f32 v74, v68, v69
    v_cvt_pk_bf16_f32 v56, v56, v57
    v_cvt_pk_bf16_f32 v57, v58, v59
    v_cvt_pk_bf16_f32 v58, v60, v61
    v_cvt_pk_bf16_f32 v59, v62, v63
    v_perm_b32 v70, v58, v56, v76
    v_perm_b32 v71, v59, v57, v77
    v_mul_f32 v70, s77, v70
    v_mul_f32 v71, s77, v71
    v_cvt_pk_bf16_f32 v71, v70, v71
    v_lshlrev_b32 v70, 16, v71
    v_and_b32 v71, 0xffff0000, v71
    v_max_f32 v75, v70, v71
    v_permlane32_swap_b32 v72, v73
    v_max_f32 v72, v72, v73
    v_permlane32_swap_b32 v74, v75
    v_max_f32 v74, v74, v75
    s_nop 1
    v_permlane16_swap_b32 v72, v74
    v_max_f32 v72, v72, v74
    v_mov_b32 v74, v72
    s_nop 1
    v_permlane16_swap_b32 v72, v74
    v_mov_b32 v73, v72
    v_mov_b32 v75, v74
    s_nop 0
    v_permlane32_swap_b32 v72, v73
    v_permlane32_swap_b32 v74, v75
    v_sub_f32 v64, v64, v72
    v_sub_f32 v65, v65, v72
    v_sub_f32 v66, v66, v73
    v_sub_f32 v67, v67, v73
    v_sub_f32 v68, v68, v74
    v_sub_f32 v69, v69, v74
    v_sub_f32 v70, v70, v75
    v_sub_f32 v71, v71, v75
    v_mul_f32 v64, s78, v64
    v_mul_f32 v65, s78, v65
    v_mul_f32 v66, s78, v66
    v_mul_f32 v67, s78, v67
    v_mul_f32 v68, s78, v68
    v_mul_f32 v69, s78, v69
    v_mul_f32 v70, s78, v70
    v_mul_f32 v71, s78, v71
    v_exp_f32 v64, v64
    v_exp_f32 v65, v65
    v_exp_f32 v66, v66
    v_exp_f32 v67, v67
    v_exp_f32 v68, v68
    v_exp_f32 v69, v69
    v_exp_f32 v70, v70
    v_exp_f32 v71, v71
    v_add_f32 v72, v64, v65
    v_add_f32 v73, v66, v67
    s_load_dword s94, s[20:21], s39 offset:0x180
    s_load_dword s94, s[20:21], s39 offset:0x1c0
    s_add_u32 s39, s39, 0x280000
    s_load_dword s94, s[20:21], s39 offset:0x0
    s_load_dword s94, s[20:21], s39 offset:0x40
    s_load_dword s94, s[20:21], s39 offset:0x80
    s_lshl4_add_u32 s91, s28, s29
    s_lshl_b32 s91, s91, 7
    s_add_u32 s92, s91, 0x1ea8000
    s_xor_b32 s91, s91, 17408
    s_add_u32 s91, s91, 0x1ea8000
    v_mov_b32 v23, s92
    v_writelane_b32 v23, s91, 1
    s_mov_b64 exec, 3
    global_load_dwordx3 v[20:22], v23, s[26:27] sc1
    s_mov_b64 exec, -1
    s_barrier
    v_add_f32 v74, v68, v69
    v_add_f32 v75, v70, v71
    v_permlane32_swap_b32 v72, v73
    v_add_f32 v72, v72, v73
    v_permlane32_swap_b32 v74, v75
    v_add_f32 v74, v74, v75
    s_nop 1
    v_permlane16_swap_b32 v72, v74
    v_add_f32 v72, v72, v74
    v_rcp_f32 v72, v72
    s_nop 0
    v_mov_b32 v74, v72
    s_nop 1
L_pad10:
    s_cbranch_execz L_vret2
    v_permlane16_swap_b32 v72, v74
    v_mov_b32 v73, v72
    v_mov_b32 v75, v74
    s_nop 0
    v_permlane32_swap_b32 v72, v73
    v_permlane32_swap_b32 v74, v75
    v_mul_f32 v64, v64, v72
    v_mul_f32 v65, v65, v72
    v_mul_f32 v66, v66, v73
    v_mul_f32 v67, v67, v73
    v_mul_f32 v68, v68, v74
    v_mul_f32 v69, v69, v74
    v_mul_f32 v70, v70, v75
    v_mul_f32 v71, v71, v75
    v_cvt_pk_bf16_f32 v72, v64, v65
    v_cvt_pk_bf16_f32 v73, v66, v67
    v_cvt_pk_bf16_f32 v74, v68, v69
    v_cvt_pk_bf16_f32 v75, v70, v71
    v_perm_b32 v152, v72, v72, v78
    v_perm_b32 v153, v72, v72, v79
    v_perm_b32 v154, v72, v72, v86
    v_perm_b32 v155, v72, v72, v87
    v_perm_b32 v156, v73, v73, v78
    v_perm_b32 v157, v73, v73, v79
    v_perm_b32 v158, v73, v73, v86
    v_perm_b32 v159, v73, v73, v87
    s_setprio 3
    v_mfma_f32_16x16x32_bf16 v[48:51], v[24:27], v[152:155], 0
    v_mfma_f32_16x16x32_bf16 v[52:55], v[34:37], v[152:155], 0
    s_setprio 0
    v_perm_b32 v160, v74, v74, v78
    v_perm_b32 v161, v74, v74, v79
    v_perm_b32 v162, v74, v74, v86
    v_perm_b32 v163, v74, v74, v87
    s_setprio 3
    v_mfma_f32_16x16x32_bf16 v[56:59], v[26:29], v[156:159], 0
    v_mfma_f32_16x16x32_bf16 v[60:63], v[36:39], v[156:159], 0
    s_setprio 0
    v_perm_b32 v164, v75, v75, v78
    v_perm_b32 v165, v75, v75, v79
    v_perm_b32 v166, v75, v75, v86
    v_perm_b32 v167, v75, v75, v87
    v_cvt_pk_bf16_f32 v168, v48, v49
    v_cvt_pk_bf16_f32 v169, v50, v51
    v_cvt_pk_bf16_f32 v170, v52, v53
    v_cvt_pk_bf16_f32 v171, v54, v55
    s_setprio 3
    v_mfma_f32_16x16x32_bf16 v[48:51], v[28:31], v[160:163], 0
    v_mfma_f32_16x16x32_bf16 v[52:55], v[38:41], v[160:163], 0
    s_load_dword s94, s[20:21], s39 offset:0xc0
    s_load_dword s94, s[20:21], s39 offset:0x100
    s_load_dword s94, s[20:21], s39 offset:0x140
    s_load_dword s94, s[20:21], s39 offset:0x180
    s_load_dword s94, s[20:21], s39 offset:0x1c0
    s_waitcnt vmcnt(1)
    s_barrier
    s_lshl1_add_u32 m0, s33, 81920
    s_nop 0
    buffer_load_dwordx4 v11, s[60:63], s83 offen lds
    s_setprio 0
    v_cvt_pk_bf16_f32 v172, v56, v57
    v_cvt_pk_bf16_f32 v173, v58, v59
    v_cvt_pk_bf16_f32 v174, v60, v61
    v_cvt_pk_bf16_f32 v175, v62, v63
    s_setprio 3
    v_mfma_f32_16x16x32_bf16 v[56:59], v[30:33], v[164:167], 0
    v_mfma_f32_16x16x32_bf16 v[60:63], v[40:43], v[164:167], 0
    s_setprio 0
    v_permlane16_swap_b32 v168, v170
    v_permlane16_swap_b32 v169, v171
    buffer_store_dwordx4 v[168:171], v0, s[68:71], s75 offen offset:0 sc1
    v_permlane16_swap_b32 v172, v174
    v_permlane16_swap_b32 v173, v175
    buffer_store_dwordx4 v[172:175], v0, s[68:71], s75 offen offset:1024 sc1
    v_cvt_pk_bf16_f32 v176, v48, v49
    v_cvt_pk_bf16_f32 v177, v50, v51
    v_cvt_pk_bf16_f32 v178, v52, v53
    v_cvt_pk_bf16_f32 v179, v54, v55
    v_cvt_pk_bf16_f32 v180, v56, v57
    v_cvt_pk_bf16_f32 v181, v58, v59
    v_cvt_pk_bf16_f32 v182, v60, v61
    v_cvt_pk_bf16_f32 v183, v62, v63
    v_permlane16_swap_b32 v176, v178
    v_permlane16_swap_b32 v177, v179
    buffer_store_dwordx4 v[176:179], v0, s[68:71], s75 offen offset:2048 sc1
    v_permlane16_swap_b32 v180, v182
    v_permlane16_swap_b32 v181, v183
    buffer_store_dwordx4 v[180:183], v0, s[68:71], s75 offen offset:3072 sc1
    s_lshl1_add_u32 m0, s33, 82944
    s_nop 0
    buffer_load_dwordx4 v12, s[60:63], s83 offen lds
    v_lshrrev_b32 v64, 4, v1
    v_bfe_u32 v65, v1, 2, 2
    v_and_b32 v66, 3, v1
    v_and_b32 v67, 15, v1
    v_lshrrev_b32 v68, 3, v1
    v_and_b32 v69, 7, v1
    s_lshl_b32 s85, s6, 2
    v_lshl_add_u32 v70, v64, 3, v65
    v_lshlrev_b32 v70, 7, v70
    s_lshl1_add_u32 m0, s33, 90112
    s_nop 0
    buffer_load_dwordx4 v11, s[64:67], s83 offen lds
    v_and_b32 v71, 1, v66
    v_lshl_add_u32 v70, v71, 3, v70
    v_add_u32 v70, 0, v70
    v_and_b32 v71, 2, v65
    v_and_b32 v72, 1, v64
    v_lshl_add_u32 v71, v72, 2, v71
    v_lshrrev_b32 v72, 1, v66
    v_xor_b32 v71, v71, v72
    v_xor_b32 v71, s85, v71
    v_xor_b32 v72, 0, v71
    v_lshl_add_u32 v80, v72, 4, v70
    v_add_u32 v82, 49152, v80
    v_add_u32 v84, 98304, v80
    v_xor_b32 v72, 2, v71
    v_lshl_add_u32 v81, v72, 4, v70
    v_add_u32 v83, 49152, v81
    s_lshl1_add_u32 m0, s33, 91136
    s_nop 0
    buffer_load_dwordx4 v12, s[64:67], s83 offen lds
    s_add_u32 s83, s83, 131072
    v_add_u32 v85, 98304, v81
    s_lshl_b32 s85, s5, 12
    v_lshl_add_u32 v48, v1, 4, s85
    v_add_u32 v49, 49152, v48
    v_add_u32 v50, 98304, v48
    v_mov_b32 v88, 0
    v_mov_b32 v89, 0
    v_mov_b32 v90, 0
    v_mov_b32 v91, 0
    v_mov_b32 v92, 0
    v_mov_b32 v93, 0
    v_mov_b32 v94, 0
    v_mov_b32 v95, 0
    v_mov_b32 v96, 0
    v_mov_b32 v97, 0
    v_mov_b32 v98, 0
    v_mov_b32 v99, 0
    v_mov_b32 v100, 0
    v_mov_b32 v101, 0
    v_mov_b32 v102, 0
    v_mov_b32 v103, 0
    v_mov_b32 v104, 0
    v_mov_b32 v105, 0
    v_mov_b32 v106, 0
    v_mov_b32 v107, 0
    s_load_dword s94, s[20:21], s39 offset:0x80000
    s_load_dword s94, s[20:21], s39 offset:0x80040
    s_load_dword s94, s[20:21], s39 offset:0x80080
    s_load_dword s94, s[20:21], s39 offset:0x800c0
    s_load_dword s94, s[20:21], s39 offset:0x80100
    s_cmp_lg_u32 s4, 0
    s_cbranch_scc1 L_fH2
    s_lshl_b32 s91, s28, 4
    s_add_u32 s91, s91, s29
    s_lshl_b32 s91, s91, 7
    s_add_u32 s91, s91, 0x1e90000
    v_mov_b32 v16, s91
    v_mov_b32 v18, s100
    v_mov_b32 v19, s101
    s_mov_b64 exec, 1
    global_store_dwordx2 v16, v[18:19], s[26:27] sc1
    s_mov_b64 exec, -1
L_fH2:
    s_waitcnt vmcnt(8)
    s_mov_b64 exec, 3
    s_movk_i32 s98, 0x4000
L_pT_chk:
    v_cmp_ne_u64 vcc, s[100:101], v[20:21]
    s_nop 1
    s_cmp_eq_u64 vcc, 0
    s_cbranch_scc1 L_pT_ok
    s_sub_u32 s98, s98, 1
    s_cbranch_scc1 L_pT_ok
    s_sleep 1
    global_load_dwordx3 v[20:22], v23, s[26:27] sc1
    s_waitcnt vmcnt(0)
    s_branch L_pT_chk
L_pT_ok:
    s_mov_b64 exec, -1
    v_readlane_b32 s90, v22, 0
    v_readlane_b32 s91, v22, 1
    s_nop 1
    s_sub_u32 s90, s91, s90
    s_abs_i32 s91, s90
    s_min_u32 s91, s91, 0x1000
    s_add_u32 s91, s91, 35
    s_mul_i32 s91, s91, 937
    s_lshr_b32 s91, s91, 16
    s_min_u32 s91, s91, 4
    s_sub_u32 s92, 0, s91
    s_cmp_lt_i32 s90, 0
    s_cselect_b32 s91, s92, s91
    s_add_u32 s50, s91, 4
    s_and_b32 s91, s91, 3
    s_mov_b32 s46, 0x58458458
    s_mov_b32 s47, 0x4584584
    s_cmp_eq_u32 s91, 1
    s_cselect_b32 s46, 0xc22c22c4, s46
    s_cselect_b32 s47, 0x22c22c22, s47
    s_cmp_eq_u32 s91, 2
    s_cselect_b32 s46, 0x116222c4, s46
    s_cselect_b32 s47, 0x16116116, s47
    s_cmp_eq_u32 s91, 3
    s_cselect_b32 s46, 0x116222c4, s46
    s_cselect_b32 s47, 0x308b08b1, s47
    s_movk_i32 s44, 0x4000
    s_mov_b32 s45, 131072
    s_barrier
    s_lshl_b32 s48, s46, 15
    s_and_b32 s48, s48, 0x38000
    s_lshr_b64 s[46:47], s[46:47], 3
    s_lshl2_add_u32 m0, s33, s48
    s_lshl1_add_u32 s49, s33, s48
    buffer_load_dwordx4 v10, s[56:59], s82 offen offset:0 sc1 lds
    v_mov_b32 v108, 0
    v_mov_b32 v109, 0
    v_mov_b32 v110, 0
    v_mov_b32 v111, 0
    v_mov_b32 v112, 0
    v_mov_b32 v113, 0
    v_mov_b32 v114, 0
    v_mov_b32 v115, 0
    v_mov_b32 v116, 0
    v_mov_b32 v117, 0
    v_mov_b32 v118, 0
    v_mov_b32 v119, 0
    s_lshl_b32 s84, s4, 12
    s_add_u32 s84, s84, 147456
    v_lshl_add_u32 v3, v1, 3, s84
    v_lshrrev_b32 v70, 1, v64
    v_xor_b32 v70, v70, v65
    v_lshl_add_u32 v70, v70, 4, s84
    buffer_load_dwordx4 v10, s[56:59], s82 offen offset:1024 sc1 lds
    v_lshl_add_u32 v70, v67, 6, v70
    v_and_b32 v71, 1, v64
    v_lshl_add_u32 v14, v71, 3, v70
    v_xor_b32 v15, 32, v14
    v_xor_b32 v70, v66, v64
    v_lshl_add_u32 v70, v70, 4, s84
    v_lshrrev_b32 v71, 2, v1
    v_lshl_add_u32 v17, v71, 6, v70
    buffer_load_dwordx4 v10, s[56:59], s82 offen offset:2048 sc1 lds
    s_lshl_b32 s85, s4, 12
    v_lshl_add_u32 v72, v1, 4, s85
    s_lshl_b32 s85, s4, 4
    v_and_b32 v70, 2, v68
    v_xor_b32 v70, v70, v69
    v_xor_b32 v70, 0, v70
    v_add_u32 v71, s85, v68
    v_mul_u32_u24 v71, 2048, v71
    v_lshl_add_u32 v4, v70, 4, v71
    s_add_u32 s85, s85, 8
    v_and_b32 v70, 2, v68
    buffer_load_dwordx4 v10, s[56:59], s82 offen offset:3072 sc1 lds
    s_add_u32 s82, s82, s44
    v_xor_b32 v70, v70, v69
    v_xor_b32 v70, 4, v70
    v_add_u32 v71, s85, v68
    v_mul_u32_u24 v71, 2048, v71
    v_lshl_add_u32 v5, v70, 4, v71
    s_and_b32 s85, s31, 3
    s_lshl1_add_u32 s85, s85, s32
    s_cmp_eq_u32 s85, 3
    s_cselect_b64 vcc, -1, 0
    s_lshl_b32 s85, s4, 11
    v_lshl_add_u32 v70, v1, 4, s85
    v_add_u32 v71, 1024, v70
    s_add_u32 m0, s49, 16384
    s_nop 0
    buffer_load_dwordx4 v11, s[60:63], s83 offen lds
    v_cndmask_b32 v4, v4, v70, vcc
    v_cndmask_b32 v5, v5, v71, vcc
    s_mov_b32 s72, s8
    s_mov_b32 s73, s9
    s_mov_b32 s74, 0x400000
    s_mov_b32 s75, 0x20000
    s_add_u32 m0, s49, 17408
    s_nop 0
    buffer_load_dwordx4 v12, s[60:63], s83 offen lds
    s_add_u32 m0, s49, 24576
    s_nop 0
    buffer_load_dwordx4 v11, s[64:67], s83 offen lds
    s_add_u32 m0, s49, 25600
    s_nop 0
    buffer_load_dwordx4 v12, s[64:67], s83 offen lds
    s_add_u32 s83, s83, s45
    s_load_dword s94, s[20:21], s39 offset:0x80140
    s_load_dword s94, s[20:21], s39 offset:0x80180
    s_load_dword s94, s[20:21], s39 offset:0x801c0
    s_add_u32 s39, s39, 0x180000
    s_load_dword s94, s[20:21], s39 offset:0x0
    s_load_dword s94, s[20:21], s39 offset:0x40
    s_barrier
    s_lshl_b32 s48, s46, 15
    s_and_b32 s48, s48, 0x38000
    s_lshr_b64 s[46:47], s[46:47], 3
    s_lshl2_add_u32 m0, s33, s48
    s_lshl1_add_u32 s49, s33, s48
    buffer_load_dwordx4 v10, s[56:59], s82 offen offset:0 sc1 lds
    buffer_load_dwordx4 v10, s[56:59], s82 offen offset:1024 sc1 lds
    buffer_load_dwordx4 v10, s[56:59], s82 offen offset:2048 sc1 lds
    buffer_load_dwordx4 v10, s[56:59], s82 offen offset:3072 sc1 lds
    s_add_u32 s82, s82, s44
    s_add_u32 m0, s49, 16384
    s_nop 0
    buffer_load_dwordx4 v11, s[60:63], s83 offen lds
    s_add_u32 m0, s49, 17408
    s_nop 0
    buffer_load_dwordx4 v12, s[60:63], s83 offen lds
    s_add_u32 m0, s49, 24576
    s_nop 0
    buffer_load_dwordx4 v11, s[64:67], s83 offen lds
    s_add_u32 m0, s49, 25600
    s_nop 0
    buffer_load_dwordx4 v12, s[64:67], s83 offen lds
    s_add_u32 s83, s83, s45
    s_load_dword s94, s[20:21], s39 offset:0x80
    s_load_dword s94, s[20:21], s39 offset:0xc0
    s_load_dword s94, s[20:21], s39 offset:0x100
    s_load_dword s94, s[20:21], s39 offset:0x140
    s_load_dword s94, s[20:21], s39 offset:0x180
    s_waitcnt vmcnt(16)
    s_barrier
    s_lshl_b32 s48, s46, 15
    s_and_b32 s48, s48, 0x38000
    s_lshr_b64 s[46:47], s[46:47], 3
    s_lshl2_add_u32 m0, s33, s48
    s_lshl1_add_u32 s49, s33, s48
    buffer_load_dwordx4 v10, s[56:59], s82 offen offset:0 sc1 lds
    buffer_load_dwordx4 v10, s[56:59], s82 offen offset:1024 sc1 lds
    buffer_load_dwordx4 v10, s[56:59], s82 offen offset:2048 sc1 lds
    buffer_load_dwordx4 v10, s[56:59], s82 offen offset:3072 sc1 lds
    s_add_u32 s82, s82, s44
    s_add_u32 m0, s49, 16384
    s_nop 0
    buffer_load_dwordx4 v11, s[60:63], s83 offen lds
    s_add_u32 m0, s49, 17408
    s_nop 0
    buffer_load_dwordx4 v12, s[60:63], s83 offen lds
    s_add_u32 m0, s49, 24576
    s_nop 0
    buffer_load_dwordx4 v11, s[64:67], s83 offen lds
    s_add_u32 m0, s49, 25600
    s_nop 0
    buffer_load_dwordx4 v12, s[64:67], s83 offen lds
    s_add_u32 s83, s83, s45
    s_load_dword s94, s[20:21], s39 offset:0x1c0
    s_add_u32 s39, s39, 0xfff80000
    s_load_dword s94, s[20:21], s39 offset:0x0
    s_load_dword s94, s[20:21], s39 offset:0x40
    s_load_dword s94, s[20:21], s39 offset:0x80
    s_load_dword s94, s[20:21], s39 offset:0xc0
    s_waitcnt vmcnt(16)
    s_barrier
    s_lshl_b32 s48, s46, 15
    s_and_b32 s48, s48, 0x38000
    s_lshr_b64 s[46:47], s[46:47], 3
    s_lshl2_add_u32 m0, s33, s48
    s_lshl1_add_u32 s49, s33, s48
    buffer_load_dwordx4 v10, s[56:59], s82 offen offset:0 sc1 lds
    buffer_load_dwordx4 v10, s[56:59], s82 offen offset:1024 sc1 lds
    buffer_load_dwordx4 v10, s[56:59], s82 offen offset:2048 sc1 lds
    buffer_load_dwordx4 v10, s[56:59], s82 offen offset:3072 sc1 lds
    s_add_u32 s82, s82, s44
    s_add_u32 m0, s49, 16384
    s_nop 0
    buffer_load_dwordx4 v11, s[60:63], s83 offen lds
    s_add_u32 m0, s49, 17408
    s_nop 0
    buffer_load_dwordx4 v12, s[60:63], s83 offen lds
    s_add_u32 m0, s49, 24576
    s_nop 0
    buffer_load_dwordx4 v11, s[64:67], s83 offen lds
    s_add_u32 m0, s49, 25600
    s_nop 0
    buffer_load_dwordx4 v12, s[64:67], s83 offen lds
    s_add_u32 s83, s83, s45
    s_load_dword s94, s[20:21], s39 offset:0x100
    s_load_dword s94, s[20:21], s39 offset:0x140
    s_load_dword s94, s[20:21], s39 offset:0x180
    s_load_dword s94, s[20:21], s39 offset:0x1c0
    s_add_u32 s39, s39, 0x100000
    s_load_dword s94, s[20:21], s39 offset:0x0
    s_waitcnt vmcnt(16)
    s_barrier
    s_lshl_b32 s48, s46, 15
    s_and_b32 s48, s48, 0x38000
    s_lshr_b64 s[46:47], s[46:47], 3
    s_lshl2_add_u32 m0, s33, s48
    s_lshl1_add_u32 s49, s33, s48
    buffer_load_dwordx4 v10, s[56:59], s82 offen offset:0 sc1 lds
    buffer_load_dwordx4 v10, s[56:59], s82 offen offset:1024 sc1 lds
    buffer_load_dwordx4 v10, s[56:59], s82 offen offset:2048 sc1 lds
    buffer_load_dwordx4 v10, s[56:59], s82 offen offset:3072 sc1 lds
    s_add_u32 s82, s82, s44
    s_add_u32 m0, s49, 16384
    s_nop 0
    buffer_load_dwordx4 v11, s[60:63], s83 offen lds
    s_add_u32 m0, s49, 17408
    s_nop 0
    buffer_load_dwordx4 v12, s[60:63], s83 offen lds
    s_add_u32 m0, s49, 24576
    s_nop 0
    buffer_load_dwordx4 v11, s[64:67], s83 offen lds
    s_add_u32 m0, s49, 25600
    s_nop 0
    buffer_load_dwordx4 v12, s[64:67], s83 offen lds
    s_add_u32 s83, s83, s45
    s_load_dword s94, s[20:21], s39 offset:0x40
    s_load_dword s94, s[20:21], s39 offset:0x80
    s_load_dword s94, s[20:21], s39 offset:0xc0
    s_load_dword s94, s[20:21], s39 offset:0x100
    s_load_dword s94, s[20:21], s39 offset:0x140
    s_waitcnt vmcnt(43)
    s_waitcnt vmcnt(16)
    s_barrier
    s_lshl_b32 s48, s46, 15
    s_and_b32 s48, s48, 0x38000
    s_lshr_b64 s[46:47], s[46:47], 3
    s_lshl2_add_u32 m0, s33, s48
    s_lshl1_add_u32 s49, s33, s48
    buffer_load_dwordx4 v10, s[56:59], s82 offen offset:0 sc1 lds
    buffer_load_dwordx4 v10, s[56:59], s82 offen offset:1024 sc1 lds
    buffer_load_dwordx4 v10, s[56:59], s82 offen offset:2048 sc1 lds
    buffer_load_dwordx4 v10, s[56:59], s82 offen offset:3072 sc1 lds
    s_add_u32 s82, s82, s44
    s_add_u32 m0, s49, 16384
    s_nop 0
    buffer_load_dwordx4 v11, s[60:63], s83 offen lds
    s_add_u32 m0, s49, 17408
    s_nop 0
    buffer_load_dwordx4 v12, s[60:63], s83 offen lds
    s_add_u32 m0, s49, 24576
    s_nop 0
    buffer_load_dwordx4 v11, s[64:67], s83 offen lds
    s_add_u32 m0, s49, 25600
    s_nop 0
    buffer_load_dwordx4 v12, s[64:67], s83 offen lds
    s_add_u32 s83, s83, s45
    s_load_dword s94, s[20:21], s39 offset:0x180
    s_load_dword s94, s[20:21], s39 offset:0x1c0
    s_add_u32 s39, s39, 0xff980000
    s_load_dword s94, s[12:13], s39 offset:0x0
    s_load_dword s94, s[12:13], s39 offset:0x40
    s_load_dword s94, s[12:13], s39 offset:0x80
    s_lshl2_add_u32 s91, s30, s4
    s_lshl_b32 s91, s91, 9
    s_add_u32 s91, s91, 0x1e90000
    v_lshl_add_u32 v20, v1, 7, s91
    s_mov_b64 exec, 15
    global_load_dwordx2 v[22:23], v20, s[26:27] sc1
    s_mov_b64 exec, -1
    s_cmp_lg_u32 s4, 0
    s_cbranch_scc1 L_fO
    s_lshl_b32 s91, s28, 4
    s_add_u32 s91, s91, s29
    s_lshl_b32 s91, s91, 7
    s_add_u32 s91, s91, 0x1e98000
    v_mov_b32 v16, s91
    v_mov_b32 v18, s100
    v_mov_b32 v19, s101
    s_mov_b64 exec, 1
    global_store_dwordx2 v16, v[18:19], s[26:27] sc1
    s_mov_b64 exec, -1
L_fO:
    s_waitcnt vmcnt(17)
    s_barrier
    s_lshl_b32 s48, s46, 15
    s_and_b32 s48, s48, 0x38000
    s_lshr_b64 s[46:47], s[46:47], 3
    s_lshl2_add_u32 m0, s33, s48
    s_lshl1_add_u32 s49, s33, s48
    buffer_load_dwordx4 v10, s[56:59], s82 offen offset:0 sc1 lds
    buffer_load_dwordx4 v10, s[56:59], s82 offen offset:1024 sc1 lds
    buffer_load_dwordx4 v10, s[56:59], s82 offen offset:2048 sc1 lds
    buffer_load_dwordx4 v10, s[56:59], s82 offen offset:3072 sc1 lds
    s_add_u32 s82, s82, s44
    s_add_u32 m0, s49, 16384
    s_nop 0
    buffer_load_dwordx4 v11, s[60:63], s83 offen lds
    s_add_u32 m0, s49, 17408
    s_nop 0
    buffer_load_dwordx4 v12, s[60:63], s83 offen lds
    s_add_u32 m0, s49, 24576
    s_nop 0
    buffer_load_dwordx4 v11, s[64:67], s83 offen lds
    s_add_u32 m0, s49, 25600
    s_nop 0
    buffer_load_dwordx4 v12, s[64:67], s83 offen lds
    s_add_u32 s83, s83, s45
    s_load_dword s94, s[12:13], s39 offset:0xc0
    s_load_dword s94, s[12:13], s39 offset:0x100
    s_load_dword s94, s[12:13], s39 offset:0x140
    s_load_dword s94, s[12:13], s39 offset:0x180
    s_load_dword s94, s[12:13], s39 offset:0x1c0
    s_waitcnt vmcnt(17)
    s_barrier
    s_lshl_b32 s48, s46, 15
    s_and_b32 s48, s48, 0x38000
    s_lshr_b64 s[46:47], s[46:47], 3
    s_lshl2_add_u32 m0, s33, s48
    s_lshl1_add_u32 s49, s33, s48
    buffer_load_dwordx4 v10, s[56:59], s82 offen offset:0 sc1 lds
    buffer_load_dwordx4 v10, s[56:59], s82 offen offset:1024 sc1 lds
    buffer_load_dwordx4 v10, s[56:59], s82 offen offset:2048 sc1 lds
    buffer_load_dwordx4 v10, s[56:59], s82 offen offset:3072 sc1 lds
    s_add_u32 s82, s82, s44
    s_add_u32 m0, s49, 16384
    s_nop 0
    buffer_load_dwordx4 v11, s[60:63], s83 offen lds
    s_add_u32 m0, s49, 17408
    s_nop 0
    buffer_load_dwordx4 v12, s[60:63], s83 offen lds
    s_add_u32 m0, s49, 24576
    s_nop 0
    buffer_load_dwordx4 v11, s[64:67], s83 offen lds
    s_add_u32 m0, s49, 25600
    s_nop 0
    buffer_load_dwordx4 v12, s[64:67], s83 offen lds
    s_add_u32 s83, s83, s45
    s_load_dword s94, s[12:13], s39 offset:0x80000
    s_load_dword s94, s[12:13], s39 offset:0x80040
    s_load_dword s94, s[12:13], s39 offset:0x80080
    s_load_dword s94, s[12:13], s39 offset:0x800c0
    s_load_dword s94, s[12:13], s39 offset:0x80100
    s_waitcnt vmcnt(16)
    s_mov_b64 exec, 15
    s_movk_i32 s98, 0x4000
L_pH2_chk:
    v_cmp_ne_u64 vcc, s[100:101], v[22:23]
    s_nop 1
    s_cmp_eq_u64 vcc, 0
    s_cbranch_scc1 L_pH2_ok
    s_sub_u32 s98, s98, 1
    s_cbranch_scc1 L_pH2_ok
    s_sleep 1
    global_load_dwordx2 v[22:23], v20, s[26:27] sc1
    s_waitcnt vmcnt(0)
    s_branch L_pH2_chk
L_pH2_ok:
    s_mov_b64 exec, -1
    s_add_u32 s82, s82, s14
    s_add_u32 s83, s83, s35
    s_cmp_lg_u32 s32, 0
    s_cselect_b32 s44, 0xffffc000, s44
    s_lshl_b32 s45, s44, 3
    s_waitcnt vmcnt(17)
    s_barrier
    s_cmp_eq_u32 s50, 0
    s_cbranch_scc1 L_bl_end
L_bl:
    s_lshl_b32 s48, s46, 15
    s_and_b32 s48, s48, 0x38000
    s_lshr_b64 s[46:47], s[46:47], 3
    s_lshl2_add_u32 m0, s33, s48
    s_lshl1_add_u32 s49, s33, s48
    buffer_load_dwordx4 v10, s[56:59], s82 offen offset:0 sc1 lds
    buffer_load_dwordx4 v10, s[56:59], s82 offen offset:1024 sc1 lds
    buffer_load_dwordx4 v10, s[56:59], s82 offen offset:2048 sc1 lds
    buffer_load_dwordx4 v10, s[56:59], s82 offen offset:3072 sc1 lds
    s_add_u32 s82, s82, s44
    s_add_u32 m0, s49, 16384
    s_nop 0
    buffer_load_dwordx4 v11, s[60:63], s83 offen lds
    s_add_u32 m0, s49, 17408
    s_nop 0
    buffer_load_dwordx4 v12, s[60:63], s83 offen lds
    s_add_u32 m0, s49, 24576
    s_nop 0
    buffer_load_dwordx4 v11, s[64:67], s83 offen lds
    s_add_u32 m0, s49, 25600
    s_nop 0
    buffer_load_dwordx4 v12, s[64:67], s83 offen lds
    s_add_u32 s83, s83, s45
    s_sub_u32 s50, s50, 1
    s_cmp_lg_u32 s50, 0
    s_waitcnt vmcnt(16)
    s_barrier
    s_cbranch_scc1 L_bl
L_bl_end:
    s_lshl_b32 m0, s33, 2
    s_nop 0
    buffer_load_dwordx4 v10, s[56:59], s82 offen offset:0 sc1 lds
    buffer_load_dwordx4 v10, s[56:59], s82 offen offset:1024 sc1 lds
    buffer_load_dwordx4 v10, s[56:59], s82 offen offset:2048 sc1 lds
    buffer_load_dwordx4 v10, s[56:59], s82 offen offset:3072 sc1 lds
    s_add_u32 s82, s82, s44
    s_lshl1_add_u32 m0, s33, 16384
    s_nop 0
    buffer_load_dwordx4 v11, s[60:63], s83 offen lds
    s_lshl1_add_u32 m0, s33, 17408
    s_nop 0
    buffer_load_dwordx4 v12, s[60:63], s83 offen lds
    s_lshl1_add_u32 m0, s33, 24576
    s_nop 0
    buffer_load_dwordx4 v11, s[64:67], s83 offen lds
    s_lshl1_add_u32 m0, s33, 25600
    s_nop 0
    buffer_load_dwordx4 v12, s[64:67], s83 offen lds
    s_add_u32 s83, s83, s45
    s_load_dword s94, s[12:13], s39 offset:0x80140
    s_load_dword s94, s[12:13], s39 offset:0x80180
    s_load_dword s94, s[12:13], s39 offset:0x801c0
    s_add_u32 s39, s39, 0x100000
    s_load_dword s94, s[12:13], s39 offset:0x0
    s_load_dword s94, s[12:13], s39 offset:0x40
    s_waitcnt vmcnt(16)
    s_barrier
    s_lshl2_add_u32 m0, s33, 98304
    s_nop 0
    buffer_load_dwordx4 v10, s[56:59], s82 offen offset:0 sc1 lds
    buffer_load_dwordx4 v10, s[56:59], s82 offen offset:1024 sc1 lds
    buffer_load_dwordx4 v10, s[56:59], s82 offen offset:2048 sc1 lds
    buffer_load_dwordx4 v10, s[56:59], s82 offen offset:3072 sc1 lds
    s_add_u32 s82, s82, s44
    s_lshl1_add_u32 m0, s33, 114688
    s_nop 0
    buffer_load_dwordx4 v11, s[60:63], s83 offen lds
    s_lshl1_add_u32 m0, s33, 115712
    s_nop 0
    buffer_load_dwordx4 v12, s[60:63], s83 offen lds
    s_lshl1_add_u32 m0, s33, 122880
    s_nop 0
    buffer_load_dwordx4 v11, s[64:67], s83 offen lds
    s_lshl1_add_u32 m0, s33, 123904
    s_nop 0
    buffer_load_dwordx4 v12, s[64:67], s83 offen lds
    s_add_u32 s83, s83, s45
    s_load_dword s94, s[12:13], s39 offset:0x80
    s_load_dword s94, s[12:13], s39 offset:0xc0
    s_load_dword s94, s[12:13], s39 offset:0x100
    s_load_dword s94, s[12:13], s39 offset:0x140
    s_load_dword s94, s[12:13], s39 offset:0x180
    s_lshl2_add_u32 s91, s30, s4
    s_lshl_b32 s91, s91, 9
    s_add_u32 s91, s91, 0x1e98000
    v_lshl_add_u32 v20, v1, 7, s91
    s_mov_b64 exec, 15
    global_load_dwordx2 v[22:23], v20, s[26:27] sc1
    s_mov_b64 exec, -1
    s_waitcnt vmcnt(17)
    s_barrier
    s_lshl2_add_u32 m0, s33, 32768
    s_nop 0
    buffer_load_dwordx4 v10, s[56:59], s82 offen offset:0 sc1 lds
    buffer_load_dwordx4 v10, s[56:59], s82 offen offset:1024 sc1 lds
    buffer_load_dwordx4 v10, s[56:59], s82 offen offset:2048 sc1 lds
    buffer_load_dwordx4 v10, s[56:59], s82 offen offset:3072 sc1 lds
    s_add_u32 s82, s82, s44
    s_lshl1_add_u32 m0, s33, 49152
    s_nop 0
    buffer_load_dwordx4 v11, s[60:63], s83 offen lds
    s_lshl1_add_u32 m0, s33, 50176
    s_nop 0
    buffer_load_dwordx4 v12, s[60:63], s83 offen lds
    s_lshl1_add_u32 m0, s33, 57344
    s_nop 0
    buffer_load_dwordx4 v11, s[64:67], s83 offen lds
    s_lshl1_add_u32 m0, s33, 58368
    s_nop 0
    buffer_load_dwordx4 v12, s[64:67], s83 offen lds
    s_add_u32 s83, s83, s45
    s_load_dword s94, s[12:13], s39 offset:0x1c0
    s_load_dword s94, s[12:13], s39 offset:0x80000
    s_load_dword s94, s[12:13], s39 offset:0x80040
    s_load_dword s94, s[12:13], s39 offset:0x80080
    s_load_dword s94, s[12:13], s39 offset:0x800c0
    s_waitcnt vmcnt(17)
    s_barrier
    s_lshl2_add_u32 m0, s33, 65536
    s_nop 0
    buffer_load_dwordx4 v10, s[56:59], s82 offen offset:0 sc1 lds
    buffer_load_dwordx4 v10, s[56:59], s82 offen offset:1024 sc1 lds
    buffer_load_dwordx4 v10, s[56:59], s82 offen offset:2048 sc1 lds
    buffer_load_dwordx4 v10, s[56:59], s82 offen offset:3072 sc1 lds
    s_add_u32 s82, s82, s44
    s_lshl1_add_u32 m0, s33, 81920
    s_nop 0
    buffer_load_dwordx4 v11, s[60:63], s83 offen lds
    s_lshl1_add_u32 m0, s33, 82944
    s_nop 0
    buffer_load_dwordx4 v12, s[60:63], s83 offen lds
L_pad11:
    s_cbranch_execz L_vret2
    s_lshl1_add_u32 m0, s33, 90112
    s_nop 0
    buffer_load_dwordx4 v11, s[64:67], s83 offen lds
    s_lshl1_add_u32 m0, s33, 91136
    s_nop 0
    buffer_load_dwordx4 v12, s[64:67], s83 offen lds
    s_add_u32 s83, s83, s45
    s_load_dword s94, s[12:13], s39 offset:0x80100
    s_load_dword s94, s[12:13], s39 offset:0x80140
    s_load_dword s94, s[12:13], s39 offset:0x80180
    s_load_dword s94, s[12:13], s39 offset:0x801c0
    s_waitcnt vmcnt(16)
    s_mov_b64 exec, 15
    s_movk_i32 s98, 0x4000
L_pO_chk:
    v_cmp_ne_u64 vcc, s[100:101], v[22:23]
    s_nop 1
    s_cmp_eq_u64 vcc, 0
    s_cbranch_scc1 L_pO_ok
    s_sub_u32 s98, s98, 1
    s_cbranch_scc1 L_pO_ok
    s_sleep 1
    global_load_dwordx2 v[22:23], v20, s[26:27] sc1
    s_waitcnt vmcnt(0)
    s_branch L_pO_chk
L_pO_ok:
    s_mov_b64 exec, -1
    s_waitcnt vmcnt(17)
    s_barrier
    s_lshl_b32 s85, s31, 8
    s_lshl_b32 s86, s32, 7
    s_add_u32 s86, s85, s86
    s_xor_b32 s87, s86, 128
    s_lshr_b32 s91, s31, 2
    s_lshl1_add_u32 s91, s91, s32
    s_lshl_b32 s91, s91, 13
    s_add_u32 s91, s91, 0x2800000
    s_xor_b32 s85, s91, 8192
    s_and_b32 s92, s31, 3
    s_lshl1_add_u32 s92, s92, s32
    s_cmp_eq_u32 s92, 3
    s_cselect_b32 s86, s91, s86
    s_cselect_b32 s87, s85, s87
    s_cselect_b32 s91, 0x2a00000, 0
    s_cselect_b32 s92, s26, s12
    s_cselect_b32 s93, s27, s13
    s_max_u32 s91, s91, 2097152
    s_add_u32 s60, s92, s86
    s_addc_u32 s61, s93, 0
    s_sub_u32 s62, s91, s86
    s_mov_b32 s63, 0x20000
    s_add_u32 s56, s26, 0x1200000
    s_addc_u32 s57, s27, 0
    s_mov_b32 s58, 0x400000
    s_mov_b32 s59, 0x20000
    s_lshl_b32 s82, s30, 18
    s_mov_b32 s83, 0
    s_lshl_b32 m0, s33, 2
    s_nop 0
    buffer_load_dwordx4 v10, s[56:59], s82 offen offset:0 sc1 lds
    buffer_load_dwordx4 v10, s[56:59], s82 offen offset:1024 sc1 lds
    buffer_load_dwordx4 v10, s[56:59], s82 offen offset:2048 sc1 lds
    buffer_load_dwordx4 v10, s[56:59], s82 offen offset:3072 sc1 lds
    s_add_u32 s82, s82, 16384
    s_lshl1_add_u32 m0, s33, 16384
    s_nop 0
    buffer_load_dwordx4 v4, s[60:63], s83 offen lds
    s_lshl1_add_u32 m0, s33, 17408
    s_nop 0
    buffer_load_dwordx4 v5, s[60:63], s83 offen lds
    s_add_u32 s83, s83, 131072
    s_waitcnt vmcnt(14)
    s_barrier
    s_lshl2_add_u32 m0, s33, 98304
    s_nop 0
    buffer_load_dwordx4 v10, s[56:59], s82 offen offset:0 sc1 lds
    buffer_load_dwordx4 v10, s[56:59], s82 offen offset:1024 sc1 lds
    buffer_load_dwordx4 v10, s[56:59], s82 offen offset:2048 sc1 lds
    buffer_load_dwordx4 v10, s[56:59], s82 offen offset:3072 sc1 lds
    s_add_u32 s82, s82, 16384
    s_lshl1_add_u32 m0, s33, 114688
    s_nop 0
    buffer_load_dwordx4 v4, s[60:63], s83 offen lds
    s_lshl1_add_u32 m0, s33, 115712
    s_nop 0
    buffer_load_dwordx4 v5, s[60:63], s83 offen lds
    s_add_u32 s83, s83, 131072
    s_lshl2_add_u32 m0, s33, 122880
    s_nop 0
    buffer_load_dwordx4 v10, s[56:59], s82 offen offset:0 sc1 lds
    buffer_load_dwordx4 v10, s[56:59], s82 offen offset:1024 sc1 lds
    buffer_load_dwordx4 v10, s[56:59], s82 offen offset:2048 sc1 lds
    buffer_load_dwordx4 v10, s[56:59], s82 offen offset:3072 sc1 lds
    s_add_u32 s82, s82, 16384
    s_lshl1_add_u32 m0, s33, 139264
    s_nop 0
    buffer_load_dwordx4 v4, s[60:63], s83 offen lds
    s_lshl1_add_u32 m0, s33, 140288
    s_nop 0
    buffer_load_dwordx4 v5, s[60:63], s83 offen lds
    s_add_u32 s83, s83, 131072
    s_waitcnt vmcnt(18)
    s_barrier
    s_lshl2_add_u32 m0, s33, 24576
    s_nop 0
    buffer_load_dwordx4 v10, s[56:59], s82 offen offset:0 sc1 lds
    buffer_load_dwordx4 v10, s[56:59], s82 offen offset:1024 sc1 lds
    buffer_load_dwordx4 v10, s[56:59], s82 offen offset:2048 sc1 lds
    buffer_load_dwordx4 v10, s[56:59], s82 offen offset:3072 sc1 lds
    s_add_u32 s82, s82, 16384
    s_lshl1_add_u32 m0, s33, 40960
    s_nop 0
    buffer_load_dwordx4 v4, s[60:63], s83 offen lds
    s_lshl1_add_u32 m0, s33, 41984
    s_nop 0
    buffer_load_dwordx4 v5, s[60:63], s83 offen lds
    s_add_u32 s83, s83, 131072
    s_waitcnt vmcnt(18)
    s_barrier
    s_setprio 1
    ds_read_b64_tr_b16 v[40:41], v80 offset:16384
    ds_read_b64_tr_b16 v[42:43], v80 offset:16896
    ds_read_b128 v[24:27], v48 offset:0
    ds_read_b128 v[28:31], v48 offset:1024
    ds_read_b128 v[32:35], v48 offset:2048
    ds_read_b128 v[36:39], v48 offset:3072
    ds_read_b64_tr_b16 v[44:45], v81 offset:16384
    ds_read_b64_tr_b16 v[46:47], v81 offset:16896
    s_waitcnt lgkmcnt(5)
    v_mfma_f32_16x16x32_bf16 v[88:91], v[40:43], v[24:27], v[88:91]
    ds_read_b64_tr_b16 v[72:73], v80 offset:20480
    ds_read_b64_tr_b16 v[74:75], v80 offset:20992
    s_lshl2_add_u32 m0, s33, 49152
    s_waitcnt lgkmcnt(6)
    v_mfma_f32_16x16x32_bf16 v[92:95], v[40:43], v[28:31], v[92:95]
    buffer_load_dwordx4 v10, s[56:59], s82 offen offset:0 sc1 lds
    ds_read_b128 v[56:59], v48 offset:8192
    ds_read_b128 v[60:63], v48 offset:9216
    s_waitcnt lgkmcnt(7)
    v_mfma_f32_16x16x32_bf16 v[96:99], v[40:43], v[32:35], v[96:99]
    ds_read_b128 v[64:67], v48 offset:10240
    ds_read_b128 v[68:71], v48 offset:11264
    s_waitcnt lgkmcnt(8)
    v_mfma_f32_16x16x32_bf16 v[100:103], v[40:43], v[36:39], v[100:103]
    ds_read_b64_tr_b16 v[76:77], v81 offset:20480
    ds_read_b64_tr_b16 v[78:79], v81 offset:20992
    s_waitcnt lgkmcnt(8)
    v_mfma_f32_16x16x32_bf16 v[104:107], v[44:47], v[24:27], v[104:107]
    buffer_load_dwordx4 v10, s[56:59], s82 offen offset:1024 sc1 lds
    v_mfma_f32_16x16x32_bf16 v[108:111], v[44:47], v[28:31], v[108:111]
    v_mfma_f32_16x16x32_bf16 v[112:115], v[44:47], v[32:35], v[112:115]
    v_mfma_f32_16x16x32_bf16 v[116:119], v[44:47], v[36:39], v[116:119]
    s_waitcnt vmcnt(14) lgkmcnt(0)
    s_barrier
    v_mfma_f32_16x16x32_bf16 v[88:91], v[72:75], v[56:59], v[88:91]
    ds_read_b64_tr_b16 v[40:41], v84 offset:16384
    ds_read_b64_tr_b16 v[42:43], v84 offset:16896
    v_mfma_f32_16x16x32_bf16 v[92:95], v[72:75], v[60:63], v[92:95]
    buffer_load_dwordx4 v10, s[56:59], s82 offen offset:2048 sc1 lds
    ds_read_b128 v[24:27], v50 offset:0
    ds_read_b128 v[28:31], v50 offset:1024
    v_mfma_f32_16x16x32_bf16 v[96:99], v[72:75], v[64:67], v[96:99]
    ds_read_b128 v[32:35], v50 offset:2048
    v_mfma_f32_16x16x32_bf16 v[100:103], v[72:75], v[68:71], v[100:103]
    ds_read_b128 v[36:39], v50 offset:3072
    ds_read_b64_tr_b16 v[44:45], v85 offset:16384
    v_mfma_f32_16x16x32_bf16 v[104:107], v[76:79], v[56:59], v[104:107]
    buffer_load_dwordx4 v10, s[56:59], s82 offen offset:3072 sc1 lds
    s_add_u32 s82, s82, 16384
    ds_read_b64_tr_b16 v[46:47], v85 offset:16896
    v_mfma_f32_16x16x32_bf16 v[108:111], v[76:79], v[60:63], v[108:111]
    v_mfma_f32_16x16x32_bf16 v[112:115], v[76:79], v[64:67], v[112:115]
    v_mfma_f32_16x16x32_bf16 v[116:119], v[76:79], v[68:71], v[116:119]
    s_waitcnt lgkmcnt(5)
    v_mfma_f32_16x16x32_bf16 v[88:91], v[40:43], v[24:27], v[88:91]
    ds_read_b64_tr_b16 v[72:73], v84 offset:20480
    ds_read_b64_tr_b16 v[74:75], v84 offset:20992
    s_lshl1_add_u32 m0, s33, 65536
    s_waitcnt lgkmcnt(6)
    v_mfma_f32_16x16x32_bf16 v[92:95], v[40:43], v[28:31], v[92:95]
    buffer_load_dwordx4 v4, s[60:63], s83 offen lds
    ds_read_b128 v[56:59], v50 offset:8192
    ds_read_b128 v[60:63], v50 offset:9216
    s_waitcnt lgkmcnt(7)
    v_mfma_f32_16x16x32_bf16 v[96:99], v[40:43], v[32:35], v[96:99]
    ds_read_b128 v[64:67], v50 offset:10240
    ds_read_b128 v[68:71], v50 offset:11264
    s_waitcnt lgkmcnt(8)
    v_mfma_f32_16x16x32_bf16 v[100:103], v[40:43], v[36:39], v[100:103]
    ds_read_b64_tr_b16 v[76:77], v85 offset:20480
    ds_read_b64_tr_b16 v[78:79], v85 offset:20992
    s_lshl1_add_u32 m0, s33, 66560
    s_waitcnt lgkmcnt(8)
    v_mfma_f32_16x16x32_bf16 v[104:107], v[44:47], v[24:27], v[104:107]
    buffer_load_dwordx4 v5, s[60:63], s83 offen lds
    s_add_u32 s83, s83, 131072
    v_mfma_f32_16x16x32_bf16 v[108:111], v[44:47], v[28:31], v[108:111]
    v_mfma_f32_16x16x32_bf16 v[112:115], v[44:47], v[32:35], v[112:115]
    v_mfma_f32_16x16x32_bf16 v[116:119], v[44:47], v[36:39], v[116:119]
    s_waitcnt vmcnt(12) lgkmcnt(0)
    s_barrier
    v_mfma_f32_16x16x32_bf16 v[88:91], v[72:75], v[56:59], v[88:91]
    ds_read_b64_tr_b16 v[40:41], v84 offset:40960
    ds_read_b64_tr_b16 v[42:43], v84 offset:41472
    s_lshl2_add_u32 m0, s33, 73728
    v_mfma_f32_16x16x32_bf16 v[92:95], v[72:75], v[60:63], v[92:95]
    buffer_load_dwordx4 v10, s[56:59], s82 offen offset:0 sc1 lds
    ds_read_b128 v[24:27], v50 offset:24576
    ds_read_b128 v[28:31], v50 offset:25600
    v_mfma_f32_16x16x32_bf16 v[96:99], v[72:75], v[64:67], v[96:99]
    ds_read_b128 v[32:35], v50 offset:26624
    v_mfma_f32_16x16x32_bf16 v[100:103], v[72:75], v[68:71], v[100:103]
    ds_read_b128 v[36:39], v50 offset:27648
    ds_read_b64_tr_b16 v[44:45], v85 offset:40960
    v_mfma_f32_16x16x32_bf16 v[104:107], v[76:79], v[56:59], v[104:107]
    buffer_load_dwordx4 v10, s[56:59], s82 offen offset:1024 sc1 lds
    ds_read_b64_tr_b16 v[46:47], v85 offset:41472
    v_mfma_f32_16x16x32_bf16 v[108:111], v[76:79], v[60:63], v[108:111]
    v_mfma_f32_16x16x32_bf16 v[112:115], v[76:79], v[64:67], v[112:115]
    v_mfma_f32_16x16x32_bf16 v[116:119], v[76:79], v[68:71], v[116:119]
    s_waitcnt lgkmcnt(5)
    v_mfma_f32_16x16x32_bf16 v[88:91], v[40:43], v[24:27], v[88:91]
    ds_read_b64_tr_b16 v[72:73], v84 offset:45056
    ds_read_b64_tr_b16 v[74:75], v84 offset:45568
    s_waitcnt lgkmcnt(6)
    v_mfma_f32_16x16x32_bf16 v[92:95], v[40:43], v[28:31], v[92:95]
    buffer_load_dwordx4 v10, s[56:59], s82 offen offset:2048 sc1 lds
    ds_read_b128 v[56:59], v50 offset:32768
    ds_read_b128 v[60:63], v50 offset:33792
    s_waitcnt lgkmcnt(7)
    v_mfma_f32_16x16x32_bf16 v[96:99], v[40:43], v[32:35], v[96:99]
    ds_read_b128 v[64:67], v50 offset:34816
    ds_read_b128 v[68:71], v50 offset:35840
    s_waitcnt lgkmcnt(8)
    v_mfma_f32_16x16x32_bf16 v[100:103], v[40:43], v[36:39], v[100:103]
    ds_read_b64_tr_b16 v[76:77], v85 offset:45056
    ds_read_b64_tr_b16 v[78:79], v85 offset:45568
    s_waitcnt lgkmcnt(8)
    v_mfma_f32_16x16x32_bf16 v[104:107], v[44:47], v[24:27], v[104:107]
    buffer_load_dwordx4 v10, s[56:59], s82 offen offset:3072 sc1 lds
    s_add_u32 s82, s82, 16384
    v_mfma_f32_16x16x32_bf16 v[108:111], v[44:47], v[28:31], v[108:111]
    v_mfma_f32_16x16x32_bf16 v[112:115], v[44:47], v[32:35], v[112:115]
    v_mfma_f32_16x16x32_bf16 v[116:119], v[44:47], v[36:39], v[116:119]
    s_waitcnt vmcnt(10) lgkmcnt(0)
    s_barrier
    v_mfma_f32_16x16x32_bf16 v[88:91], v[72:75], v[56:59], v[88:91]
    ds_read_b64_tr_b16 v[40:41], v80 offset:40960
    ds_read_b64_tr_b16 v[42:43], v80 offset:41472
    s_lshl1_add_u32 m0, s33, 90112
    v_mfma_f32_16x16x32_bf16 v[92:95], v[72:75], v[60:63], v[92:95]
    buffer_load_dwordx4 v4, s[60:63], s83 offen lds
    ds_read_b128 v[24:27], v48 offset:24576
    ds_read_b128 v[28:31], v48 offset:25600
    v_mfma_f32_16x16x32_bf16 v[96:99], v[72:75], v[64:67], v[96:99]
    ds_read_b128 v[32:35], v48 offset:26624
    v_mfma_f32_16x16x32_bf16 v[100:103], v[72:75], v[68:71], v[100:103]
    ds_read_b128 v[36:39], v48 offset:27648
    ds_read_b64_tr_b16 v[44:45], v81 offset:40960
    s_lshl1_add_u32 m0, s33, 91136
    v_mfma_f32_16x16x32_bf16 v[104:107], v[76:79], v[56:59], v[104:107]
    buffer_load_dwordx4 v5, s[60:63], s83 offen lds
    s_add_u32 s83, s83, 131072
    ds_read_b64_tr_b16 v[46:47], v81 offset:41472
    v_mfma_f32_16x16x32_bf16 v[108:111], v[76:79], v[60:63], v[108:111]
    v_mfma_f32_16x16x32_bf16 v[112:115], v[76:79], v[64:67], v[112:115]
    v_mfma_f32_16x16x32_bf16 v[116:119], v[76:79], v[68:71], v[116:119]
    s_waitcnt lgkmcnt(5)
    v_mfma_f32_16x16x32_bf16 v[88:91], v[40:43], v[24:27], v[88:91]
    ds_read_b64_tr_b16 v[72:73], v80 offset:45056
    ds_read_b64_tr_b16 v[74:75], v80 offset:45568
    s_lshl_b32 m0, s33, 2
    s_waitcnt lgkmcnt(6)
    v_mfma_f32_16x16x32_bf16 v[92:95], v[40:43], v[28:31], v[92:95]
    buffer_load_dwordx4 v10, s[56:59], s82 offen offset:0 sc1 lds
    ds_read_b128 v[56:59], v48 offset:32768
    ds_read_b128 v[60:63], v48 offset:33792
    s_waitcnt lgkmcnt(7)
    v_mfma_f32_16x16x32_bf16 v[96:99], v[40:43], v[32:35], v[96:99]
    ds_read_b128 v[64:67], v48 offset:34816
    ds_read_b128 v[68:71], v48 offset:35840
    s_waitcnt lgkmcnt(8)
    v_mfma_f32_16x16x32_bf16 v[100:103], v[40:43], v[36:39], v[100:103]
    buffer_load_dwordx4 v10, s[56:59], s82 offen offset:1024 sc1 lds
    ds_read_b64_tr_b16 v[76:77], v81 offset:45056
    ds_read_b64_tr_b16 v[78:79], v81 offset:45568
    s_waitcnt lgkmcnt(8)
    v_mfma_f32_16x16x32_bf16 v[104:107], v[44:47], v[24:27], v[104:107]
    v_mfma_f32_16x16x32_bf16 v[108:111], v[44:47], v[28:31], v[108:111]
    buffer_load_dwordx4 v10, s[56:59], s82 offen offset:2048 sc1 lds
    v_mfma_f32_16x16x32_bf16 v[112:115], v[44:47], v[32:35], v[112:115]
    v_mfma_f32_16x16x32_bf16 v[116:119], v[44:47], v[36:39], v[116:119]
    s_waitcnt vmcnt(9) lgkmcnt(0)
    s_barrier
    v_mfma_f32_16x16x32_bf16 v[88:91], v[72:75], v[56:59], v[88:91]
    ds_read_b64_tr_b16 v[40:41], v82 offset:16384
    ds_read_b64_tr_b16 v[42:43], v82 offset:16896
    v_mfma_f32_16x16x32_bf16 v[92:95], v[72:75], v[60:63], v[92:95]
    buffer_load_dwordx4 v10, s[56:59], s82 offen offset:3072 sc1 lds
    s_add_u32 s82, s82, 16384
    ds_read_b128 v[24:27], v49 offset:0
    ds_read_b128 v[28:31], v49 offset:1024
    v_mfma_f32_16x16x32_bf16 v[96:99], v[72:75], v[64:67], v[96:99]
    ds_read_b128 v[32:35], v49 offset:2048
    s_lshl1_add_u32 m0, s33, 16384
    v_mfma_f32_16x16x32_bf16 v[100:103], v[72:75], v[68:71], v[100:103]
    buffer_load_dwordx4 v4, s[60:63], s83 offen lds
    ds_read_b128 v[36:39], v49 offset:3072
    ds_read_b64_tr_b16 v[44:45], v83 offset:16384
    v_mfma_f32_16x16x32_bf16 v[104:107], v[76:79], v[56:59], v[104:107]
    ds_read_b64_tr_b16 v[46:47], v83 offset:16896
    s_lshl1_add_u32 m0, s33, 17408
    v_mfma_f32_16x16x32_bf16 v[108:111], v[76:79], v[60:63], v[108:111]
    buffer_load_dwordx4 v5, s[60:63], s83 offen lds
    s_add_u32 s83, s83, 131072
    v_mfma_f32_16x16x32_bf16 v[112:115], v[76:79], v[64:67], v[112:115]
    v_mfma_f32_16x16x32_bf16 v[116:119], v[76:79], v[68:71], v[116:119]
    s_waitcnt lgkmcnt(5)
    v_mfma_f32_16x16x32_bf16 v[88:91], v[40:43], v[24:27], v[88:91]
    ds_read_b64_tr_b16 v[72:73], v82 offset:20480
    ds_read_b64_tr_b16 v[74:75], v82 offset:20992
    s_lshl2_add_u32 m0, s33, 98304
    s_waitcnt lgkmcnt(6)
    v_mfma_f32_16x16x32_bf16 v[92:95], v[40:43], v[28:31], v[92:95]
    buffer_load_dwordx4 v10, s[56:59], s82 offen offset:0 sc1 lds
    ds_read_b128 v[56:59], v49 offset:8192
    ds_read_b128 v[60:63], v49 offset:9216
    s_waitcnt lgkmcnt(7)
    v_mfma_f32_16x16x32_bf16 v[96:99], v[40:43], v[32:35], v[96:99]
    ds_read_b128 v[64:67], v49 offset:10240
    ds_read_b128 v[68:71], v49 offset:11264
    s_waitcnt lgkmcnt(8)
    v_mfma_f32_16x16x32_bf16 v[100:103], v[40:43], v[36:39], v[100:103]
    buffer_load_dwordx4 v10, s[56:59], s82 offen offset:1024 sc1 lds
    ds_read_b64_tr_b16 v[76:77], v83 offset:20480
    ds_read_b64_tr_b16 v[78:79], v83 offset:20992
    s_waitcnt lgkmcnt(8)
    v_mfma_f32_16x16x32_bf16 v[104:107], v[44:47], v[24:27], v[104:107]
    v_mfma_f32_16x16x32_bf16 v[108:111], v[44:47], v[28:31], v[108:111]
    buffer_load_dwordx4 v10, s[56:59], s82 offen offset:2048 sc1 lds
    v_mfma_f32_16x16x32_bf16 v[112:115], v[44:47], v[32:35], v[112:115]
    v_mfma_f32_16x16x32_bf16 v[116:119], v[44:47], v[36:39], v[116:119]
    s_waitcnt vmcnt(9) lgkmcnt(0)
    s_barrier
    v_mfma_f32_16x16x32_bf16 v[88:91], v[72:75], v[56:59], v[88:91]
    ds_read_b64_tr_b16 v[40:41], v82 offset:40960
    ds_read_b64_tr_b16 v[42:43], v82 offset:41472
    v_mfma_f32_16x16x32_bf16 v[92:95], v[72:75], v[60:63], v[92:95]
    buffer_load_dwordx4 v10, s[56:59], s82 offen offset:3072 sc1 lds
    s_add_u32 s82, s82, 16384
    ds_read_b128 v[24:27], v49 offset:24576
    ds_read_b128 v[28:31], v49 offset:25600
    v_mfma_f32_16x16x32_bf16 v[96:99], v[72:75], v[64:67], v[96:99]
    ds_read_b128 v[32:35], v49 offset:26624
    s_lshl1_add_u32 m0, s33, 114688
    v_mfma_f32_16x16x32_bf16 v[100:103], v[72:75], v[68:71], v[100:103]
    buffer_load_dwordx4 v4, s[60:63], s83 offen lds
    ds_read_b128 v[36:39], v49 offset:27648
    ds_read_b64_tr_b16 v[44:45], v83 offset:40960
    v_mfma_f32_16x16x32_bf16 v[104:107], v[76:79], v[56:59], v[104:107]
    ds_read_b64_tr_b16 v[46:47], v83 offset:41472
    s_lshl1_add_u32 m0, s33, 115712
    v_mfma_f32_16x16x32_bf16 v[108:111], v[76:79], v[60:63], v[108:111]
    buffer_load_dwordx4 v5, s[60:63], s83 offen lds
    s_add_u32 s83, s83, 131072
    v_mfma_f32_16x16x32_bf16 v[112:115], v[76:79], v[64:67], v[112:115]
    v_mfma_f32_16x16x32_bf16 v[116:119], v[76:79], v[68:71], v[116:119]
    s_waitcnt lgkmcnt(5)
    v_mfma_f32_16x16x32_bf16 v[88:91], v[40:43], v[24:27], v[88:91]
    ds_read_b64_tr_b16 v[72:73], v82 offset:45056
    ds_read_b64_tr_b16 v[74:75], v82 offset:45568
    s_lshl2_add_u32 m0, s33, 122880
    s_waitcnt lgkmcnt(6)
    v_mfma_f32_16x16x32_bf16 v[92:95], v[40:43], v[28:31], v[92:95]
    buffer_load_dwordx4 v10, s[56:59], s82 offen offset:0 sc1 lds
    ds_read_b128 v[56:59], v49 offset:32768
    ds_read_b128 v[60:63], v49 offset:33792
    s_waitcnt lgkmcnt(7)
    v_mfma_f32_16x16x32_bf16 v[96:99], v[40:43], v[32:35], v[96:99]
    ds_read_b128 v[64:67], v49 offset:34816
    ds_read_b128 v[68:71], v49 offset:35840
    s_waitcnt lgkmcnt(8)
    v_mfma_f32_16x16x32_bf16 v[100:103], v[40:43], v[36:39], v[100:103]
    buffer_load_dwordx4 v10, s[56:59], s82 offen offset:1024 sc1 lds
    ds_read_b64_tr_b16 v[76:77], v83 offset:45056
    ds_read_b64_tr_b16 v[78:79], v83 offset:45568
    s_waitcnt lgkmcnt(8)
    v_mfma_f32_16x16x32_bf16 v[104:107], v[44:47], v[24:27], v[104:107]
    v_mfma_f32_16x16x32_bf16 v[108:111], v[44:47], v[28:31], v[108:111]
    buffer_load_dwordx4 v10, s[56:59], s82 offen offset:2048 sc1 lds
    v_mfma_f32_16x16x32_bf16 v[112:115], v[44:47], v[32:35], v[112:115]
    v_mfma_f32_16x16x32_bf16 v[116:119], v[44:47], v[36:39], v[116:119]
    s_waitcnt vmcnt(9) lgkmcnt(0)
    s_barrier
    v_mfma_f32_16x16x32_bf16 v[88:91], v[72:75], v[56:59], v[88:91]
    ds_read_b64_tr_b16 v[40:41], v80 offset:16384
    ds_read_b64_tr_b16 v[42:43], v80 offset:16896
    v_mfma_f32_16x16x32_bf16 v[92:95], v[72:75], v[60:63], v[92:95]
    buffer_load_dwordx4 v10, s[56:59], s82 offen offset:3072 sc1 lds
    s_add_u32 s82, s82, 16384
    ds_read_b128 v[24:27], v48 offset:0
    ds_read_b128 v[28:31], v48 offset:1024
    v_mfma_f32_16x16x32_bf16 v[96:99], v[72:75], v[64:67], v[96:99]
    ds_read_b128 v[32:35], v48 offset:2048
    s_lshl1_add_u32 m0, s33, 139264
    v_mfma_f32_16x16x32_bf16 v[100:103], v[72:75], v[68:71], v[100:103]
    buffer_load_dwordx4 v4, s[60:63], s83 offen lds
    ds_read_b128 v[36:39], v48 offset:3072
    ds_read_b64_tr_b16 v[44:45], v81 offset:16384
    v_mfma_f32_16x16x32_bf16 v[104:107], v[76:79], v[56:59], v[104:107]
    ds_read_b64_tr_b16 v[46:47], v81 offset:16896
    s_lshl1_add_u32 m0, s33, 140288
    v_mfma_f32_16x16x32_bf16 v[108:111], v[76:79], v[60:63], v[108:111]
    buffer_load_dwordx4 v5, s[60:63], s83 offen lds
    s_add_u32 s83, s83, 131072
    v_mfma_f32_16x16x32_bf16 v[112:115], v[76:79], v[64:67], v[112:115]
    v_mfma_f32_16x16x32_bf16 v[116:119], v[76:79], v[68:71], v[116:119]
    s_waitcnt lgkmcnt(5)
    v_mfma_f32_16x16x32_bf16 v[88:91], v[40:43], v[24:27], v[88:91]
    ds_read_b64_tr_b16 v[72:73], v80 offset:20480
    ds_read_b64_tr_b16 v[74:75], v80 offset:20992
    s_lshl2_add_u32 m0, s33, 24576
    s_waitcnt lgkmcnt(6)
    v_mfma_f32_16x16x32_bf16 v[92:95], v[40:43], v[28:31], v[92:95]
    buffer_load_dwordx4 v10, s[56:59], s82 offen offset:0 sc1 lds
    ds_read_b128 v[56:59], v48 offset:8192
    ds_read_b128 v[60:63], v48 offset:9216
    s_waitcnt lgkmcnt(7)
    v_mfma_f32_16x16x32_bf16 v[96:99], v[40:43], v[32:35], v[96:99]
    ds_read_b128 v[64:67], v48 offset:10240
    ds_read_b128 v[68:71], v48 offset:11264
    s_waitcnt lgkmcnt(8)
    v_mfma_f32_16x16x32_bf16 v[100:103], v[40:43], v[36:39], v[100:103]
    buffer_load_dwordx4 v10, s[56:59], s82 offen offset:1024 sc1 lds
    ds_read_b64_tr_b16 v[76:77], v81 offset:20480
    ds_read_b64_tr_b16 v[78:79], v81 offset:20992
    s_waitcnt lgkmcnt(8)
    v_mfma_f32_16x16x32_bf16 v[104:107], v[44:47], v[24:27], v[104:107]
    v_mfma_f32_16x16x32_bf16 v[108:111], v[44:47], v[28:31], v[108:111]
    buffer_load_dwordx4 v10, s[56:59], s82 offen offset:2048 sc1 lds
    v_mfma_f32_16x16x32_bf16 v[112:115], v[44:47], v[32:35], v[112:115]
    v_mfma_f32_16x16x32_bf16 v[116:119], v[44:47], v[36:39], v[116:119]
    s_waitcnt vmcnt(9) lgkmcnt(0)
    s_barrier
    v_mfma_f32_16x16x32_bf16 v[88:91], v[72:75], v[56:59], v[88:91]
    ds_read_b64_tr_b16 v[40:41], v84 offset:16384
    ds_read_b64_tr_b16 v[42:43], v84 offset:16896
    v_mfma_f32_16x16x32_bf16 v[92:95], v[72:75], v[60:63], v[92:95]
    buffer_load_dwordx4 v10, s[56:59], s82 offen offset:3072 sc1 lds
    s_add_u32 s82, s82, 16384
    ds_read_b128 v[24:27], v50 offset:0
    ds_read_b128 v[28:31], v50 offset:1024
    v_mfma_f32_16x16x32_bf16 v[96:99], v[72:75], v[64:67], v[96:99]
    ds_read_b128 v[32:35], v50 offset:2048
    s_lshl1_add_u32 m0, s33, 40960
    v_mfma_f32_16x16x32_bf16 v[100:103], v[72:75], v[68:71], v[100:103]
    buffer_load_dwordx4 v4, s[60:63], s83 offen lds
    ds_read_b128 v[36:39], v50 offset:3072
    ds_read_b64_tr_b16 v[44:45], v85 offset:16384
    v_mfma_f32_16x16x32_bf16 v[104:107], v[76:79], v[56:59], v[104:107]
    ds_read_b64_tr_b16 v[46:47], v85 offset:16896
    s_lshl1_add_u32 m0, s33, 41984
    v_mfma_f32_16x16x32_bf16 v[108:111], v[76:79], v[60:63], v[108:111]
    buffer_load_dwordx4 v5, s[60:63], s83 offen lds
    s_add_u32 s83, s83, 131072
    v_mfma_f32_16x16x32_bf16 v[112:115], v[76:79], v[64:67], v[112:115]
    v_mfma_f32_16x16x32_bf16 v[116:119], v[76:79], v[68:71], v[116:119]
    s_waitcnt lgkmcnt(5)
    v_mfma_f32_16x16x32_bf16 v[88:91], v[40:43], v[24:27], v[88:91]
    ds_read_b64_tr_b16 v[72:73], v84 offset:20480
    ds_read_b64_tr_b16 v[74:75], v84 offset:20992
    s_lshl2_add_u32 m0, s33, 49152
    s_waitcnt lgkmcnt(6)
    v_mfma_f32_16x16x32_bf16 v[92:95], v[40:43], v[28:31], v[92:95]
    buffer_load_dwordx4 v10, s[56:59], s82 offen offset:0 sc1 lds
    ds_read_b128 v[56:59], v50 offset:8192
    ds_read_b128 v[60:63], v50 offset:9216
    s_waitcnt lgkmcnt(7)
    v_mfma_f32_16x16x32_bf16 v[96:99], v[40:43], v[32:35], v[96:99]
    ds_read_b128 v[64:67], v50 offset:10240
    ds_read_b128 v[68:71], v50 offset:11264
    s_waitcnt lgkmcnt(8)
    v_mfma_f32_16x16x32_bf16 v[100:103], v[40:43], v[36:39], v[100:103]
    buffer_load_dwordx4 v10, s[56:59], s82 offen offset:1024 sc1 lds
    ds_read_b64_tr_b16 v[76:77], v85 offset:20480
    ds_read_b64_tr_b16 v[78:79], v85 offset:20992
    s_waitcnt lgkmcnt(8)
    v_mfma_f32_16x16x32_bf16 v[104:107], v[44:47], v[24:27], v[104:107]
    v_mfma_f32_16x16x32_bf16 v[108:111], v[44:47], v[28:31], v[108:111]
    buffer_load_dwordx4 v10, s[56:59], s82 offen offset:2048 sc1 lds
    v_mfma_f32_16x16x32_bf16 v[112:115], v[44:47], v[32:35], v[112:115]
    v_mfma_f32_16x16x32_bf16 v[116:119], v[44:47], v[36:39], v[116:119]
    s_waitcnt vmcnt(9) lgkmcnt(0)
    s_barrier
    v_mfma_f32_16x16x32_bf16 v[88:91], v[72:75], v[56:59], v[88:91]
    ds_read_b64_tr_b16 v[40:41], v84 offset:40960
    ds_read_b64_tr_b16 v[42:43], v84 offset:41472
    v_mfma_f32_16x16x32_bf16 v[92:95], v[72:75], v[60:63], v[92:95]
    buffer_load_dwordx4 v10, s[56:59], s82 offen offset:3072 sc1 lds
    s_add_u32 s82, s82, 16384
    ds_read_b128 v[24:27], v50 offset:24576
    ds_read_b128 v[28:31], v50 offset:25600
    v_mfma_f32_16x16x32_bf16 v[96:99], v[72:75], v[64:67], v[96:99]
    ds_read_b128 v[32:35], v50 offset:26624
    s_lshl1_add_u32 m0, s33, 65536
    v_mfma_f32_16x16x32_bf16 v[100:103], v[72:75], v[68:71], v[100:103]
    buffer_load_dwordx4 v4, s[60:63], s83 offen lds
    ds_read_b128 v[36:39], v50 offset:27648
    ds_read_b64_tr_b16 v[44:45], v85 offset:40960
    v_mfma_f32_16x16x32_bf16 v[104:107], v[76:79], v[56:59], v[104:107]
    ds_read_b64_tr_b16 v[46:47], v85 offset:41472
    s_lshl1_add_u32 m0, s33, 66560
    v_mfma_f32_16x16x32_bf16 v[108:111], v[76:79], v[60:63], v[108:111]
    buffer_load_dwordx4 v5, s[60:63], s83 offen lds
    s_add_u32 s83, s83, 131072
    v_mfma_f32_16x16x32_bf16 v[112:115], v[76:79], v[64:67], v[112:115]
    v_mfma_f32_16x16x32_bf16 v[116:119], v[76:79], v[68:71], v[116:119]
    s_waitcnt lgkmcnt(5)
    v_mfma_f32_16x16x32_bf16 v[88:91], v[40:43], v[24:27], v[88:91]
    ds_read_b64_tr_b16 v[72:73], v84 offset:45056
    ds_read_b64_tr_b16 v[74:75], v84 offset:45568
    s_lshl2_add_u32 m0, s33, 73728
    s_waitcnt lgkmcnt(6)
    v_mfma_f32_16x16x32_bf16 v[92:95], v[40:43], v[28:31], v[92:95]
    buffer_load_dwordx4 v10, s[56:59], s82 offen offset:0 sc1 lds
    ds_read_b128 v[56:59], v50 offset:32768
    ds_read_b128 v[60:63], v50 offset:33792
    s_waitcnt lgkmcnt(7)
    v_mfma_f32_16x16x32_bf16 v[96:99], v[40:43], v[32:35], v[96:99]
    ds_read_b128 v[64:67], v50 offset:34816
    ds_read_b128 v[68:71], v50 offset:35840
    s_waitcnt lgkmcnt(8)
    v_mfma_f32_16x16x32_bf16 v[100:103], v[40:43], v[36:39], v[100:103]
    buffer_load_dwordx4 v10, s[56:59], s82 offen offset:1024 sc1 lds
    ds_read_b64_tr_b16 v[76:77], v85 offset:45056
    ds_read_b64_tr_b16 v[78:79], v85 offset:45568
    s_waitcnt lgkmcnt(8)
    v_mfma_f32_16x16x32_bf16 v[104:107], v[44:47], v[24:27], v[104:107]
    v_mfma_f32_16x16x32_bf16 v[108:111], v[44:47], v[28:31], v[108:111]
    buffer_load_dwordx4 v10, s[56:59], s82 offen offset:2048 sc1 lds
    v_mfma_f32_16x16x32_bf16 v[112:115], v[44:47], v[32:35], v[112:115]
    v_mfma_f32_16x16x32_bf16 v[116:119], v[44:47], v[36:39], v[116:119]
    s_waitcnt vmcnt(9) lgkmcnt(0)
    s_barrier
    v_mfma_f32_16x16x32_bf16 v[88:91], v[72:75], v[56:59], v[88:91]
    ds_read_b64_tr_b16 v[40:41], v80 offset:40960
    ds_read_b64_tr_b16 v[42:43], v80 offset:41472
    v_mfma_f32_16x16x32_bf16 v[92:95], v[72:75], v[60:63], v[92:95]
    buffer_load_dwordx4 v10, s[56:59], s82 offen offset:3072 sc1 lds
    s_add_u32 s82, s82, 16384
    ds_read_b128 v[24:27], v48 offset:24576
    ds_read_b128 v[28:31], v48 offset:25600
    v_mfma_f32_16x16x32_bf16 v[96:99], v[72:75], v[64:67], v[96:99]
    ds_read_b128 v[32:35], v48 offset:26624
    s_lshl1_add_u32 m0, s33, 90112
    v_mfma_f32_16x16x32_bf16 v[100:103], v[72:75], v[68:71], v[100:103]
    buffer_load_dwordx4 v4, s[60:63], s83 offen lds
    ds_read_b128 v[36:39], v48 offset:27648
    ds_read_b64_tr_b16 v[44:45], v81 offset:40960
    v_mfma_f32_16x16x32_bf16 v[104:107], v[76:79], v[56:59], v[104:107]
    ds_read_b64_tr_b16 v[46:47], v81 offset:41472
    s_lshl1_add_u32 m0, s33, 91136
    v_mfma_f32_16x16x32_bf16 v[108:111], v[76:79], v[60:63], v[108:111]
    buffer_load_dwordx4 v5, s[60:63], s83 offen lds
    s_add_u32 s83, s83, 131072
    v_mfma_f32_16x16x32_bf16 v[112:115], v[76:79], v[64:67], v[112:115]
    v_mfma_f32_16x16x32_bf16 v[116:119], v[76:79], v[68:71], v[116:119]
    s_waitcnt lgkmcnt(5)
    v_mfma_f32_16x16x32_bf16 v[88:91], v[40:43], v[24:27], v[88:91]
    ds_read_b64_tr_b16 v[72:73], v80 offset:45056
    ds_read_b64_tr_b16 v[74:75], v80 offset:45568
    s_lshl_b32 m0, s33, 2
    s_waitcnt lgkmcnt(6)
    v_mfma_f32_16x16x32_bf16 v[92:95], v[40:43], v[28:31], v[92:95]
    buffer_load_dwordx4 v10, s[56:59], s82 offen offset:0 sc1 lds
    ds_read_b128 v[56:59], v48 offset:32768
L_pad12:
    s_cbranch_execz L_vret3
    ds_read_b128 v[60:63], v48 offset:33792
    s_waitcnt lgkmcnt(7)
    v_mfma_f32_16x16x32_bf16 v[96:99], v[40:43], v[32:35], v[96:99]
    ds_read_b128 v[64:67], v48 offset:34816
    ds_read_b128 v[68:71], v48 offset:35840
    s_waitcnt lgkmcnt(8)
    v_mfma_f32_16x16x32_bf16 v[100:103], v[40:43], v[36:39], v[100:103]
    buffer_load_dwordx4 v10, s[56:59], s82 offen offset:1024 sc1 lds
    ds_read_b64_tr_b16 v[76:77], v81 offset:45056
    ds_read_b64_tr_b16 v[78:79], v81 offset:45568
    s_waitcnt lgkmcnt(8)
    v_mfma_f32_16x16x32_bf16 v[104:107], v[44:47], v[24:27], v[104:107]
    v_mfma_f32_16x16x32_bf16 v[108:111], v[44:47], v[28:31], v[108:111]
    buffer_load_dwordx4 v10, s[56:59], s82 offen offset:2048 sc1 lds
    v_mfma_f32_16x16x32_bf16 v[112:115], v[44:47], v[32:35], v[112:115]
    v_mfma_f32_16x16x32_bf16 v[116:119], v[44:47], v[36:39], v[116:119]
    s_waitcnt vmcnt(9) lgkmcnt(0)
    s_barrier
    v_mfma_f32_16x16x32_bf16 v[88:91], v[72:75], v[56:59], v[88:91]
    ds_read_b64_tr_b16 v[40:41], v82 offset:16384
    ds_read_b64_tr_b16 v[42:43], v82 offset:16896
    v_mfma_f32_16x16x32_bf16 v[92:95], v[72:75], v[60:63], v[92:95]
    buffer_load_dwordx4 v10, s[56:59], s82 offen offset:3072 sc1 lds
    s_add_u32 s82, s82, 16384
    ds_read_b128 v[24:27], v49 offset:0
    ds_read_b128 v[28:31], v49 offset:1024
    v_mfma_f32_16x16x32_bf16 v[96:99], v[72:75], v[64:67], v[96:99]
    ds_read_b128 v[32:35], v49 offset:2048
    s_lshl1_add_u32 m0, s33, 16384
    v_mfma_f32_16x16x32_bf16 v[100:103], v[72:75], v[68:71], v[100:103]
    buffer_load_dwordx4 v4, s[60:63], s83 offen lds
    ds_read_b128 v[36:39], v49 offset:3072
    ds_read_b64_tr_b16 v[44:45], v83 offset:16384
    v_mfma_f32_16x16x32_bf16 v[104:107], v[76:79], v[56:59], v[104:107]
    ds_read_b64_tr_b16 v[46:47], v83 offset:16896
    s_lshl1_add_u32 m0, s33, 17408
    v_mfma_f32_16x16x32_bf16 v[108:111], v[76:79], v[60:63], v[108:111]
    buffer_load_dwordx4 v5, s[60:63], s83 offen lds
    s_add_u32 s83, s83, 131072
    v_mfma_f32_16x16x32_bf16 v[112:115], v[76:79], v[64:67], v[112:115]
    v_mfma_f32_16x16x32_bf16 v[116:119], v[76:79], v[68:71], v[116:119]
    s_waitcnt lgkmcnt(5)
    v_mfma_f32_16x16x32_bf16 v[88:91], v[40:43], v[24:27], v[88:91]
    ds_read_b64_tr_b16 v[72:73], v82 offset:20480
    ds_read_b64_tr_b16 v[74:75], v82 offset:20992
    s_lshl2_add_u32 m0, s33, 98304
    s_waitcnt lgkmcnt(6)
    v_mfma_f32_16x16x32_bf16 v[92:95], v[40:43], v[28:31], v[92:95]
    buffer_load_dwordx4 v10, s[56:59], s82 offen offset:0 sc1 lds
    ds_read_b128 v[56:59], v49 offset:8192
    ds_read_b128 v[60:63], v49 offset:9216
    s_waitcnt lgkmcnt(7)
    v_mfma_f32_16x16x32_bf16 v[96:99], v[40:43], v[32:35], v[96:99]
    ds_read_b128 v[64:67], v49 offset:10240
    ds_read_b128 v[68:71], v49 offset:11264
    s_waitcnt lgkmcnt(8)
    v_mfma_f32_16x16x32_bf16 v[100:103], v[40:43], v[36:39], v[100:103]
    buffer_load_dwordx4 v10, s[56:59], s82 offen offset:1024 sc1 lds
    ds_read_b64_tr_b16 v[76:77], v83 offset:20480
    ds_read_b64_tr_b16 v[78:79], v83 offset:20992
    s_waitcnt lgkmcnt(8)
    v_mfma_f32_16x16x32_bf16 v[104:107], v[44:47], v[24:27], v[104:107]
    v_mfma_f32_16x16x32_bf16 v[108:111], v[44:47], v[28:31], v[108:111]
    buffer_load_dwordx4 v10, s[56:59], s82 offen offset:2048 sc1 lds
    v_mfma_f32_16x16x32_bf16 v[112:115], v[44:47], v[32:35], v[112:115]
    v_mfma_f32_16x16x32_bf16 v[116:119], v[44:47], v[36:39], v[116:119]
    s_waitcnt vmcnt(9) lgkmcnt(0)
    s_barrier
    v_mfma_f32_16x16x32_bf16 v[88:91], v[72:75], v[56:59], v[88:91]
    ds_read_b64_tr_b16 v[40:41], v82 offset:40960
    ds_read_b64_tr_b16 v[42:43], v82 offset:41472
    v_mfma_f32_16x16x32_bf16 v[92:95], v[72:75], v[60:63], v[92:95]
    buffer_load_dwordx4 v10, s[56:59], s82 offen offset:3072 sc1 lds
    s_add_u32 s82, s82, 16384
    ds_read_b128 v[24:27], v49 offset:24576
    ds_read_b128 v[28:31], v49 offset:25600
    v_mfma_f32_16x16x32_bf16 v[96:99], v[72:75], v[64:67], v[96:99]
    ds_read_b128 v[32:35], v49 offset:26624
    s_lshl1_add_u32 m0, s33, 114688
    v_mfma_f32_16x16x32_bf16 v[100:103], v[72:75], v[68:71], v[100:103]
    buffer_load_dwordx4 v4, s[60:63], s83 offen lds
    ds_read_b128 v[36:39], v49 offset:27648
    ds_read_b64_tr_b16 v[44:45], v83 offset:40960
    v_mfma_f32_16x16x32_bf16 v[104:107], v[76:79], v[56:59], v[104:107]
    ds_read_b64_tr_b16 v[46:47], v83 offset:41472
    s_lshl1_add_u32 m0, s33, 115712
    v_mfma_f32_16x16x32_bf16 v[108:111], v[76:79], v[60:63], v[108:111]
    buffer_load_dwordx4 v5, s[60:63], s83 offen lds
    s_add_u32 s83, s83, 131072
    v_mfma_f32_16x16x32_bf16 v[112:115], v[76:79], v[64:67], v[112:115]
    v_mfma_f32_16x16x32_bf16 v[116:119], v[76:79], v[68:71], v[116:119]
    s_waitcnt lgkmcnt(5)
    v_mfma_f32_16x16x32_bf16 v[88:91], v[40:43], v[24:27], v[88:91]
    ds_read_b64_tr_b16 v[72:73], v82 offset:45056
    ds_read_b64_tr_b16 v[74:75], v82 offset:45568
    s_lshl2_add_u32 m0, s33, 122880
    s_waitcnt lgkmcnt(6)
    v_mfma_f32_16x16x32_bf16 v[92:95], v[40:43], v[28:31], v[92:95]
    buffer_load_dwordx4 v10, s[56:59], s82 offen offset:0 sc1 lds
    ds_read_b128 v[56:59], v49 offset:32768
    ds_read_b128 v[60:63], v49 offset:33792
    s_waitcnt lgkmcnt(7)
    v_mfma_f32_16x16x32_bf16 v[96:99], v[40:43], v[32:35], v[96:99]
    ds_read_b128 v[64:67], v49 offset:34816
    ds_read_b128 v[68:71], v49 offset:35840
    s_waitcnt lgkmcnt(8)
    v_mfma_f32_16x16x32_bf16 v[100:103], v[40:43], v[36:39], v[100:103]
    buffer_load_dwordx4 v10, s[56:59], s82 offen offset:1024 sc1 lds
    ds_read_b64_tr_b16 v[76:77], v83 offset:45056
    ds_read_b64_tr_b16 v[78:79], v83 offset:45568
    s_waitcnt lgkmcnt(8)
    v_mfma_f32_16x16x32_bf16 v[104:107], v[44:47], v[24:27], v[104:107]
    v_mfma_f32_16x16x32_bf16 v[108:111], v[44:47], v[28:31], v[108:111]
    buffer_load_dwordx4 v10, s[56:59], s82 offen offset:2048 sc1 lds
    v_mfma_f32_16x16x32_bf16 v[112:115], v[44:47], v[32:35], v[112:115]
    v_mfma_f32_16x16x32_bf16 v[116:119], v[44:47], v[36:39], v[116:119]
    s_waitcnt vmcnt(9) lgkmcnt(0)
    s_barrier
    v_mfma_f32_16x16x32_bf16 v[88:91], v[72:75], v[56:59], v[88:91]
    ds_read_b64_tr_b16 v[40:41], v80 offset:16384
    ds_read_b64_tr_b16 v[42:43], v80 offset:16896
    v_mfma_f32_16x16x32_bf16 v[92:95], v[72:75], v[60:63], v[92:95]
    buffer_load_dwordx4 v10, s[56:59], s82 offen offset:3072 sc1 lds
    s_add_u32 s82, s82, 16384
    ds_read_b128 v[24:27], v48 offset:0
    ds_read_b128 v[28:31], v48 offset:1024
    v_mfma_f32_16x16x32_bf16 v[96:99], v[72:75], v[64:67], v[96:99]
    ds_read_b128 v[32:35], v48 offset:2048
    s_lshl1_add_u32 m0, s33, 139264
    v_mfma_f32_16x16x32_bf16 v[100:103], v[72:75], v[68:71], v[100:103]
    buffer_load_dwordx4 v4, s[60:63], s83 offen lds
    ds_read_b128 v[36:39], v48 offset:3072
    ds_read_b64_tr_b16 v[44:45], v81 offset:16384
    v_mfma_f32_16x16x32_bf16 v[104:107], v[76:79], v[56:59], v[104:107]
    ds_read_b64_tr_b16 v[46:47], v81 offset:16896
    s_lshl1_add_u32 m0, s33, 140288
    v_mfma_f32_16x16x32_bf16 v[108:111], v[76:79], v[60:63], v[108:111]
    buffer_load_dwordx4 v5, s[60:63], s83 offen lds
    s_add_u32 s83, s83, 131072
    v_mfma_f32_16x16x32_bf16 v[112:115], v[76:79], v[64:67], v[112:115]
    v_mfma_f32_16x16x32_bf16 v[116:119], v[76:79], v[68:71], v[116:119]
    s_waitcnt lgkmcnt(5)
    v_mfma_f32_16x16x32_bf16 v[88:91], v[40:43], v[24:27], v[88:91]
    ds_read_b64_tr_b16 v[72:73], v80 offset:20480
    ds_read_b64_tr_b16 v[74:75], v80 offset:20992
    s_lshl2_add_u32 m0, s33, 24576
    s_waitcnt lgkmcnt(6)
    v_mfma_f32_16x16x32_bf16 v[92:95], v[40:43], v[28:31], v[92:95]
    buffer_load_dwordx4 v10, s[56:59], s82 offen offset:0 sc1 lds
    ds_read_b128 v[56:59], v48 offset:8192
    ds_read_b128 v[60:63], v48 offset:9216
    s_waitcnt lgkmcnt(7)
    v_mfma_f32_16x16x32_bf16 v[96:99], v[40:43], v[32:35], v[96:99]
    ds_read_b128 v[64:67], v48 offset:10240
    ds_read_b128 v[68:71], v48 offset:11264
    s_waitcnt lgkmcnt(8)
    v_mfma_f32_16x16x32_bf16 v[100:103], v[40:43], v[36:39], v[100:103]
    buffer_load_dwordx4 v10, s[56:59], s82 offen offset:1024 sc1 lds
    ds_read_b64_tr_b16 v[76:77], v81 offset:20480
    ds_read_b64_tr_b16 v[78:79], v81 offset:20992
    s_waitcnt lgkmcnt(8)
    v_mfma_f32_16x16x32_bf16 v[104:107], v[44:47], v[24:27], v[104:107]
    v_mfma_f32_16x16x32_bf16 v[108:111], v[44:47], v[28:31], v[108:111]
    buffer_load_dwordx4 v10, s[56:59], s82 offen offset:2048 sc1 lds
    v_mfma_f32_16x16x32_bf16 v[112:115], v[44:47], v[32:35], v[112:115]
    v_mfma_f32_16x16x32_bf16 v[116:119], v[44:47], v[36:39], v[116:119]
    s_waitcnt vmcnt(9) lgkmcnt(0)
    s_barrier
    v_mfma_f32_16x16x32_bf16 v[88:91], v[72:75], v[56:59], v[88:91]
    ds_read_b64_tr_b16 v[40:41], v84 offset:16384
    ds_read_b64_tr_b16 v[42:43], v84 offset:16896
    v_mfma_f32_16x16x32_bf16 v[92:95], v[72:75], v[60:63], v[92:95]
    buffer_load_dwordx4 v10, s[56:59], s82 offen offset:3072 sc1 lds
    s_add_u32 s82, s82, 16384
    ds_read_b128 v[24:27], v50 offset:0
    ds_read_b128 v[28:31], v50 offset:1024
    v_mfma_f32_16x16x32_bf16 v[96:99], v[72:75], v[64:67], v[96:99]
    ds_read_b128 v[32:35], v50 offset:2048
    s_lshl1_add_u32 m0, s33, 40960
    v_mfma_f32_16x16x32_bf16 v[100:103], v[72:75], v[68:71], v[100:103]
    buffer_load_dwordx4 v4, s[60:63], s83 offen lds
    ds_read_b128 v[36:39], v50 offset:3072
    ds_read_b64_tr_b16 v[44:45], v85 offset:16384
    v_mfma_f32_16x16x32_bf16 v[104:107], v[76:79], v[56:59], v[104:107]
    ds_read_b64_tr_b16 v[46:47], v85 offset:16896
    s_lshl1_add_u32 m0, s33, 41984
    v_mfma_f32_16x16x32_bf16 v[108:111], v[76:79], v[60:63], v[108:111]
    buffer_load_dwordx4 v5, s[60:63], s83 offen lds
    s_add_u32 s83, s83, 131072
    v_mfma_f32_16x16x32_bf16 v[112:115], v[76:79], v[64:67], v[112:115]
    v_mfma_f32_16x16x32_bf16 v[116:119], v[76:79], v[68:71], v[116:119]
    s_waitcnt lgkmcnt(5)
    v_mfma_f32_16x16x32_bf16 v[88:91], v[40:43], v[24:27], v[88:91]
    ds_read_b64_tr_b16 v[72:73], v84 offset:20480
    ds_read_b64_tr_b16 v[74:75], v84 offset:20992
    s_waitcnt lgkmcnt(6)
    v_mfma_f32_16x16x32_bf16 v[92:95], v[40:43], v[28:31], v[92:95]
    ds_read_b128 v[56:59], v50 offset:8192
    ds_read_b128 v[60:63], v50 offset:9216
    s_waitcnt lgkmcnt(7)
    v_mfma_f32_16x16x32_bf16 v[96:99], v[40:43], v[32:35], v[96:99]
    ds_read_b128 v[64:67], v50 offset:10240
    ds_read_b128 v[68:71], v50 offset:11264
    s_waitcnt lgkmcnt(8)
    v_mfma_f32_16x16x32_bf16 v[100:103], v[40:43], v[36:39], v[100:103]
    ds_read_b64_tr_b16 v[76:77], v85 offset:20480
    ds_read_b64_tr_b16 v[78:79], v85 offset:20992
    s_mov_b32 s84, 0
    s_waitcnt lgkmcnt(8)
    v_mfma_f32_16x16x32_bf16 v[104:107], v[44:47], v[24:27], v[104:107]
    buffer_load_dwordx4 v[120:123], v13, s[72:75], s84 offen
    v_mfma_f32_16x16x32_bf16 v[108:111], v[44:47], v[28:31], v[108:111]
    v_mfma_f32_16x16x32_bf16 v[112:115], v[44:47], v[32:35], v[112:115]
    s_mov_b32 s84, 32768
    v_mfma_f32_16x16x32_bf16 v[116:119], v[44:47], v[36:39], v[116:119]
    buffer_load_dwordx4 v[124:127], v13, s[72:75], s84 offen
    s_waitcnt vmcnt(8) lgkmcnt(0)
    s_barrier
    v_mfma_f32_16x16x32_bf16 v[88:91], v[72:75], v[56:59], v[88:91]
    ds_read_b64_tr_b16 v[40:41], v84 offset:40960
    ds_read_b64_tr_b16 v[42:43], v84 offset:41472
    v_mfma_f32_16x16x32_bf16 v[92:95], v[72:75], v[60:63], v[92:95]
    ds_read_b128 v[24:27], v50 offset:24576
    ds_read_b128 v[28:31], v50 offset:25600
    v_mfma_f32_16x16x32_bf16 v[96:99], v[72:75], v[64:67], v[96:99]
    ds_read_b128 v[32:35], v50 offset:26624
    v_mfma_f32_16x16x32_bf16 v[100:103], v[72:75], v[68:71], v[100:103]
    ds_read_b128 v[36:39], v50 offset:27648
    ds_read_b64_tr_b16 v[44:45], v85 offset:40960
    s_mov_b32 s84, 65536
    v_mfma_f32_16x16x32_bf16 v[104:107], v[76:79], v[56:59], v[104:107]
    ds_read_b64_tr_b16 v[46:47], v85 offset:41472
    buffer_load_dwordx4 v[128:131], v13, s[72:75], s84 offen
    v_mfma_f32_16x16x32_bf16 v[108:111], v[76:79], v[60:63], v[108:111]
    v_mfma_f32_16x16x32_bf16 v[112:115], v[76:79], v[64:67], v[112:115]
    s_mov_b32 s84, 98304
    v_mfma_f32_16x16x32_bf16 v[116:119], v[76:79], v[68:71], v[116:119]
    buffer_load_dwordx4 v[132:135], v13, s[72:75], s84 offen
    s_waitcnt lgkmcnt(5)
    v_mfma_f32_16x16x32_bf16 v[88:91], v[40:43], v[24:27], v[88:91]
    ds_read_b64_tr_b16 v[72:73], v84 offset:45056
    ds_read_b64_tr_b16 v[74:75], v84 offset:45568
    s_waitcnt lgkmcnt(6)
    v_mfma_f32_16x16x32_bf16 v[92:95], v[40:43], v[28:31], v[92:95]
    ds_read_b128 v[56:59], v50 offset:32768
    ds_read_b128 v[60:63], v50 offset:33792
    s_waitcnt lgkmcnt(7)
    v_mfma_f32_16x16x32_bf16 v[96:99], v[40:43], v[32:35], v[96:99]
    ds_read_b128 v[64:67], v50 offset:34816
    ds_read_b128 v[68:71], v50 offset:35840
    s_waitcnt lgkmcnt(8)
    v_mfma_f32_16x16x32_bf16 v[100:103], v[40:43], v[36:39], v[100:103]
    ds_read_b64_tr_b16 v[76:77], v85 offset:45056
    ds_read_b64_tr_b16 v[78:79], v85 offset:45568
    s_waitcnt lgkmcnt(8)
    v_mfma_f32_16x16x32_bf16 v[104:107], v[44:47], v[24:27], v[104:107]
    v_mfma_f32_16x16x32_bf16 v[108:111], v[44:47], v[28:31], v[108:111]
    v_mfma_f32_16x16x32_bf16 v[112:115], v[44:47], v[32:35], v[112:115]
    v_mfma_f32_16x16x32_bf16 v[116:119], v[44:47], v[36:39], v[116:119]
    s_waitcnt vmcnt(4) lgkmcnt(0)
    s_barrier
    v_mfma_f32_16x16x32_bf16 v[88:91], v[72:75], v[56:59], v[88:91]
    ds_read_b64_tr_b16 v[40:41], v80 offset:40960
    ds_read_b64_tr_b16 v[42:43], v80 offset:41472
    v_mfma_f32_16x16x32_bf16 v[92:95], v[72:75], v[60:63], v[92:95]
    ds_read_b128 v[24:27], v48 offset:24576
    ds_read_b128 v[28:31], v48 offset:25600
    v_mfma_f32_16x16x32_bf16 v[96:99], v[72:75], v[64:67], v[96:99]
    ds_read_b128 v[32:35], v48 offset:26624
    v_mfma_f32_16x16x32_bf16 v[100:103], v[72:75], v[68:71], v[100:103]
    ds_read_b128 v[36:39], v48 offset:27648
    ds_read_b64_tr_b16 v[44:45], v81 offset:40960
    v_mfma_f32_16x16x32_bf16 v[104:107], v[76:79], v[56:59], v[104:107]
    ds_read_b64_tr_b16 v[46:47], v81 offset:41472
    v_mfma_f32_16x16x32_bf16 v[108:111], v[76:79], v[60:63], v[108:111]
    ds_read_b64 v[168:169], v3 offset:0
    ds_read_b64 v[170:171], v3 offset:512
    ds_read_b64 v[172:173], v3 offset:1024
    v_mfma_f32_16x16x32_bf16 v[112:115], v[76:79], v[64:67], v[112:115]
    ds_read_b64 v[174:175], v3 offset:1536
    ds_read_b64 v[176:177], v3 offset:2048
    ds_read_b64 v[178:179], v3 offset:2560
    v_mfma_f32_16x16x32_bf16 v[116:119], v[76:79], v[68:71], v[116:119]
    ds_read_b64 v[180:181], v3 offset:3072
    ds_read_b64 v[182:183], v3 offset:3584
    s_waitcnt lgkmcnt(13)
    v_mfma_f32_16x16x32_bf16 v[88:91], v[40:43], v[24:27], v[88:91]
    ds_read_b64_tr_b16 v[72:73], v80 offset:45056
    ds_read_b64_tr_b16 v[74:75], v80 offset:45568
    s_waitcnt lgkmcnt(14)
    v_mfma_f32_16x16x32_bf16 v[92:95], v[40:43], v[28:31], v[92:95]
    ds_read_b128 v[56:59], v48 offset:32768
    ds_read_b128 v[60:63], v48 offset:33792
    s_waitcnt lgkmcnt(15)
    v_mfma_f32_16x16x32_bf16 v[96:99], v[40:43], v[32:35], v[96:99]
    ds_read_b128 v[64:67], v48 offset:34816
    ds_read_b128 v[68:71], v48 offset:35840
    s_waitcnt lgkmcnt(15)
    v_mfma_f32_16x16x32_bf16 v[100:103], v[40:43], v[36:39], v[100:103]
    ds_read_b64_tr_b16 v[76:77], v81 offset:45056
    ds_read_b64_tr_b16 v[78:79], v81 offset:45568
    s_waitcnt lgkmcnt(15)
    v_mfma_f32_16x16x32_bf16 v[104:107], v[44:47], v[24:27], v[104:107]
    v_lshlrev_b32 v184, 16, v168
    v_and_b32 v185, 0xffff0000, v168
    v_mfma_f32_16x16x32_bf16 v[108:111], v[44:47], v[28:31], v[108:111]
    v_lshlrev_b32 v186, 16, v169
    v_and_b32 v187, 0xffff0000, v169
    v_mfma_f32_16x16x32_bf16 v[112:115], v[44:47], v[32:35], v[112:115]
    s_waitcnt lgkmcnt(14)
    v_lshlrev_b32 v188, 16, v170
    v_and_b32 v189, 0xffff0000, v170
    v_mfma_f32_16x16x32_bf16 v[116:119], v[44:47], v[36:39], v[116:119]
    v_lshlrev_b32 v190, 16, v171
    v_and_b32 v191, 0xffff0000, v171
    s_waitcnt lgkmcnt(5)
    v_mfma_f32_16x16x32_bf16 v[88:91], v[72:75], v[56:59], v[88:91]
    v_lshlrev_b32 v192, 16, v172
    v_and_b32 v193, 0xffff0000, v172
    s_waitcnt lgkmcnt(4)
    v_mfma_f32_16x16x32_bf16 v[92:95], v[72:75], v[60:63], v[92:95]
    v_lshlrev_b32 v194, 16, v173
    v_and_b32 v195, 0xffff0000, v173
    s_waitcnt lgkmcnt(3)
    v_mfma_f32_16x16x32_bf16 v[96:99], v[72:75], v[64:67], v[96:99]
    v_lshlrev_b32 v196, 16, v174
    v_and_b32 v197, 0xffff0000, v174
    s_waitcnt lgkmcnt(2)
    v_mfma_f32_16x16x32_bf16 v[100:103], v[72:75], v[68:71], v[100:103]
    v_lshlrev_b32 v198, 16, v175
    v_and_b32 v199, 0xffff0000, v175
    s_waitcnt lgkmcnt(0)
    v_mfma_f32_16x16x32_bf16 v[104:107], v[76:79], v[56:59], v[104:107]
    s_mov_b32 s72, s22
    v_lshlrev_b32 v200, 16, v176
    v_and_b32 v201, 0xffff0000, v176
    v_mfma_f32_16x16x32_bf16 v[108:111], v[76:79], v[60:63], v[108:111]
    s_mov_b32 s73, s23
    v_lshlrev_b32 v202, 16, v177
    v_and_b32 v203, 0xffff0000, v177
    v_mfma_f32_16x16x32_bf16 v[112:115], v[76:79], v[64:67], v[112:115]
    s_mov_b32 s74, 0x400000
    v_lshlrev_b32 v204, 16, v178
    v_and_b32 v205, 0xffff0000, v178
    v_mfma_f32_16x16x32_bf16 v[116:119], v[76:79], v[68:71], v[116:119]
    s_mov_b32 s75, 0x20000
    v_lshlrev_b32 v206, 16, v179
    v_and_b32 v207, 0xffff0000, v179
    v_lshlrev_b32 v208, 16, v180
    v_and_b32 v209, 0xffff0000, v180
    v_lshlrev_b32 v210, 16, v181
    v_and_b32 v211, 0xffff0000, v181
    v_lshlrev_b32 v212, 16, v182
    v_and_b32 v213, 0xffff0000, v182
    v_lshlrev_b32 v214, 16, v183
    v_and_b32 v215, 0xffff0000, v183
    v_cvt_pk_bf16_f32 v40, v88, v89
    v_cvt_pk_bf16_f32 v41, v90, v91
    v_lshlrev_b32 v88, 16, v40
    v_and_b32 v89, 0xffff0000, v40
    v_lshlrev_b32 v90, 16, v41
    v_and_b32 v91, 0xffff0000, v41
    v_cvt_pk_bf16_f32 v42, v104, v105
    v_cvt_pk_bf16_f32 v43, v106, v107
    v_lshlrev_b32 v104, 16, v42
    v_and_b32 v105, 0xffff0000, v42
    v_lshlrev_b32 v106, 16, v43
    v_and_b32 v107, 0xffff0000, v43
    v_pk_mul_f32 v[88:89], v[88:89], v[184:185]
    v_pk_mul_f32 v[90:91], v[90:91], v[186:187]
    v_pk_mul_f32 v[104:105], v[104:105], v[200:201]
    v_pk_mul_f32 v[106:107], v[106:107], v[202:203]
    v_cvt_pk_bf16_f32 v88, v88, v89
    v_cvt_pk_bf16_f32 v89, v90, v91
    ds_write_b64 v14, v[88:89] offset:0
    v_cvt_pk_bf16_f32 v104, v104, v105
    v_cvt_pk_bf16_f32 v105, v106, v107
    ds_write_b64 v15, v[104:105] offset:0
    ds_read_b128 v[48:51], v17 offset:0
    v_cvt_pk_bf16_f32 v40, v92, v93
    v_cvt_pk_bf16_f32 v41, v94, v95
    v_lshlrev_b32 v92, 16, v40
    v_and_b32 v93, 0xffff0000, v40
    v_lshlrev_b32 v94, 16, v41
    v_and_b32 v95, 0xffff0000, v41
    v_cvt_pk_bf16_f32 v42, v108, v109
    v_cvt_pk_bf16_f32 v43, v110, v111
    v_lshlrev_b32 v108, 16, v42
    v_and_b32 v109, 0xffff0000, v42
    v_lshlrev_b32 v110, 16, v43
    v_and_b32 v111, 0xffff0000, v43
    v_pk_mul_f32 v[92:93], v[92:93], v[188:189]
    v_pk_mul_f32 v[94:95], v[94:95], v[190:191]
    v_pk_mul_f32 v[108:109], v[108:109], v[204:205]
    v_pk_mul_f32 v[110:111], v[110:111], v[206:207]
    v_cvt_pk_bf16_f32 v92, v92, v93
    v_cvt_pk_bf16_f32 v93, v94, v95
    ds_write_b64 v14, v[92:93] offset:1024
    v_cvt_pk_bf16_f32 v108, v108, v109
    v_cvt_pk_bf16_f32 v109, v110, v111
    ds_write_b64 v15, v[108:109] offset:1024
    ds_read_b128 v[52:55], v17 offset:1024
    s_waitcnt vmcnt(0)
    v_lshlrev_b32 v136, 16, v120
    v_and_b32 v137, 0xffff0000, v120
    v_lshlrev_b32 v138, 16, v121
    v_and_b32 v139, 0xffff0000, v121
    v_lshlrev_b32 v140, 16, v122
    v_and_b32 v141, 0xffff0000, v122
    v_lshlrev_b32 v142, 16, v123
    v_and_b32 v143, 0xffff0000, v123
    s_waitcnt lgkmcnt(3)
    v_lshlrev_b32 v24, 16, v48
    v_and_b32 v25, 0xffff0000, v48
    v_lshlrev_b32 v26, 16, v49
    v_and_b32 v27, 0xffff0000, v49
    v_lshlrev_b32 v28, 16, v50
    v_and_b32 v29, 0xffff0000, v50
    v_lshlrev_b32 v30, 16, v51
    v_and_b32 v31, 0xffff0000, v51
    v_pk_add_f32 v[24:25], v[24:25], v[136:137]
    v_pk_add_f32 v[26:27], v[26:27], v[138:139]
    v_pk_add_f32 v[28:29], v[28:29], v[140:141]
    v_pk_add_f32 v[30:31], v[30:31], v[142:143]
    v_cvt_pk_bf16_f32 v48, v24, v25
    v_cvt_pk_bf16_f32 v49, v26, v27
    v_cvt_pk_bf16_f32 v50, v28, v29
    v_cvt_pk_bf16_f32 v51, v30, v31
    s_mov_b32 s84, 0
    buffer_store_dwordx4 v[48:51], v13, s[72:75], s84 offen
    v_cvt_pk_bf16_f32 v40, v96, v97
    v_cvt_pk_bf16_f32 v41, v98, v99
    v_lshlrev_b32 v96, 16, v40
    v_and_b32 v97, 0xffff0000, v40
    v_lshlrev_b32 v98, 16, v41
    v_and_b32 v99, 0xffff0000, v41
    v_cvt_pk_bf16_f32 v42, v112, v113
    v_cvt_pk_bf16_f32 v43, v114, v115
    v_lshlrev_b32 v112, 16, v42
    v_and_b32 v113, 0xffff0000, v42
    v_lshlrev_b32 v114, 16, v43
    v_and_b32 v115, 0xffff0000, v43
    v_pk_mul_f32 v[96:97], v[96:97], v[192:193]
    v_pk_mul_f32 v[98:99], v[98:99], v[194:195]
    v_pk_mul_f32 v[112:113], v[112:113], v[208:209]
    v_pk_mul_f32 v[114:115], v[114:115], v[210:211]
    v_cvt_pk_bf16_f32 v96, v96, v97
    v_cvt_pk_bf16_f32 v97, v98, v99
    ds_write_b64 v14, v[96:97] offset:2048
    v_cvt_pk_bf16_f32 v112, v112, v113
    v_cvt_pk_bf16_f32 v113, v114, v115
    ds_write_b64 v15, v[112:113] offset:2048
    ds_read_b128 v[56:59], v17 offset:2048
    v_lshlrev_b32 v144, 16, v124
    v_and_b32 v145, 0xffff0000, v124
    v_lshlrev_b32 v146, 16, v125
    v_and_b32 v147, 0xffff0000, v125
    v_lshlrev_b32 v148, 16, v126
    v_and_b32 v149, 0xffff0000, v126
    v_lshlrev_b32 v150, 16, v127
    v_and_b32 v151, 0xffff0000, v127
    s_waitcnt lgkmcnt(3)
    v_lshlrev_b32 v24, 16, v52
    v_and_b32 v25, 0xffff0000, v52
    v_lshlrev_b32 v26, 16, v53
    v_and_b32 v27, 0xffff0000, v53
    v_lshlrev_b32 v28, 16, v54
    v_and_b32 v29, 0xffff0000, v54
    v_lshlrev_b32 v30, 16, v55
    v_and_b32 v31, 0xffff0000, v55
    v_pk_add_f32 v[24:25], v[24:25], v[144:145]
    v_pk_add_f32 v[26:27], v[26:27], v[146:147]
    v_pk_add_f32 v[28:29], v[28:29], v[148:149]
    v_pk_add_f32 v[30:31], v[30:31], v[150:151]
    v_cvt_pk_bf16_f32 v52, v24, v25
    v_cvt_pk_bf16_f32 v53, v26, v27
    v_cvt_pk_bf16_f32 v54, v28, v29
    v_cvt_pk_bf16_f32 v55, v30, v31
    s_mov_b32 s84, 32768
    buffer_store_dwordx4 v[52:55], v13, s[72:75], s84 offen
    v_cvt_pk_bf16_f32 v40, v100, v101
    v_cvt_pk_bf16_f32 v41, v102, v103
    v_lshlrev_b32 v100, 16, v40
    v_and_b32 v101, 0xffff0000, v40
    v_lshlrev_b32 v102, 16, v41
    v_and_b32 v103, 0xffff0000, v41
    v_cvt_pk_bf16_f32 v42, v116, v117
    v_cvt_pk_bf16_f32 v43, v118, v119
    v_lshlrev_b32 v116, 16, v42
    v_and_b32 v117, 0xffff0000, v42
    v_lshlrev_b32 v118, 16, v43
    v_and_b32 v119, 0xffff0000, v43
    v_pk_mul_f32 v[100:101], v[100:101], v[196:197]
    v_pk_mul_f32 v[102:103], v[102:103], v[198:199]
    v_pk_mul_f32 v[116:117], v[116:117], v[212:213]
    v_pk_mul_f32 v[118:119], v[118:119], v[214:215]
    v_cvt_pk_bf16_f32 v100, v100, v101
    v_cvt_pk_bf16_f32 v101, v102, v103
    ds_write_b64 v14, v[100:101] offset:3072
    v_cvt_pk_bf16_f32 v116, v116, v117
    v_cvt_pk_bf16_f32 v117, v118, v119
    ds_write_b64 v15, v[116:117] offset:3072
    ds_read_b128 v[60:63], v17 offset:3072
    v_lshlrev_b32 v152, 16, v128
    v_and_b32 v153, 0xffff0000, v128
    v_lshlrev_b32 v154, 16, v129
    v_and_b32 v155, 0xffff0000, v129
    v_lshlrev_b32 v156, 16, v130
    v_and_b32 v157, 0xffff0000, v130
    v_lshlrev_b32 v158, 16, v131
    v_and_b32 v159, 0xffff0000, v131
    s_waitcnt lgkmcnt(3)
    v_lshlrev_b32 v24, 16, v56
    v_and_b32 v25, 0xffff0000, v56
    v_lshlrev_b32 v26, 16, v57
    v_and_b32 v27, 0xffff0000, v57
    v_lshlrev_b32 v28, 16, v58
    v_and_b32 v29, 0xffff0000, v58
    v_lshlrev_b32 v30, 16, v59
    v_and_b32 v31, 0xffff0000, v59
    v_pk_add_f32 v[24:25], v[24:25], v[152:153]
    v_pk_add_f32 v[26:27], v[26:27], v[154:155]
    v_pk_add_f32 v[28:29], v[28:29], v[156:157]
    v_pk_add_f32 v[30:31], v[30:31], v[158:159]
    v_cvt_pk_bf16_f32 v56, v24, v25
    v_cvt_pk_bf16_f32 v57, v26, v27
    v_cvt_pk_bf16_f32 v58, v28, v29
    v_cvt_pk_bf16_f32 v59, v30, v31
    s_mov_b32 s84, 65536
    buffer_store_dwordx4 v[56:59], v13, s[72:75], s84 offen
    v_lshlrev_b32 v160, 16, v132
    v_and_b32 v161, 0xffff0000, v132
    v_lshlrev_b32 v162, 16, v133
    v_and_b32 v163, 0xffff0000, v133
    v_lshlrev_b32 v164, 16, v134
    v_and_b32 v165, 0xffff0000, v134
    v_lshlrev_b32 v166, 16, v135
    v_and_b32 v167, 0xffff0000, v135
    s_waitcnt lgkmcnt(0)
    v_lshlrev_b32 v24, 16, v60
    v_and_b32 v25, 0xffff0000, v60
    v_lshlrev_b32 v26, 16, v61
    v_and_b32 v27, 0xffff0000, v61
    v_lshlrev_b32 v28, 16, v62
    v_and_b32 v29, 0xffff0000, v62
    v_lshlrev_b32 v30, 16, v63
    v_and_b32 v31, 0xffff0000, v63
    v_pk_add_f32 v[24:25], v[24:25], v[160:161]
    v_pk_add_f32 v[26:27], v[26:27], v[162:163]
    v_pk_add_f32 v[28:29], v[28:29], v[164:165]
    v_pk_add_f32 v[30:31], v[30:31], v[166:167]
    v_cvt_pk_bf16_f32 v60, v24, v25
    v_cvt_pk_bf16_f32 v61, v26, v27
    v_cvt_pk_bf16_f32 v62, v28, v29
    v_cvt_pk_bf16_f32 v63, v30, v31
    s_mov_b32 s84, 98304
    buffer_store_dwordx4 v[60:63], v13, s[72:75], s84 offen
L_fin:
L_end:
    s_endpgm
L_code_end:
.section .rodata,"a"
.p2align 6
.amdhsa_kernel recurrent_scan__sliding_local_dilated__glu_gated_geglu__prompt_kernel
  .amdhsa_next_free_vgpr 256
  .amdhsa_next_free_sgpr 102
  .amdhsa_accum_offset 256
  .amdhsa_group_segment_fixed_size 0
  .amdhsa_kernarg_size 80
  .amdhsa_user_sgpr_count 2
  .amdhsa_user_sgpr_kernarg_segment_ptr 1
  .amdhsa_system_sgpr_workgroup_id_x 1
.end_amdhsa_kernel
```

```asm
; @launch grid=(256,1,1) block=(512,1,1) lds=163840
.amdgcn_target "amdgcn-amd-amdhsa--gfx950"
.text
.globl recurrent_scan__sliding_local_dilated__glu_gated_geglu__prompt_kernel
.p2align 12
.p2align 8
.type recurrent_scan__sliding_local_dilated__glu_gated_geglu__prompt_kernel,@function
recurrent_scan__sliding_local_dilated__glu_gated_geglu__prompt_kernel:
    s_cmp_ge_u32 s2, 256
    s_cbranch_scc1 L_end
    s_load_dwordx4 s[8:11], s[0:1], 0
    s_load_dwordx2 s[12:13], s[0:1], 16
    s_load_dwordx4 s[16:19], s[0:1], 32
    s_load_dwordx4 s[20:23], s[0:1], 48
    s_load_dwordx4 s[24:27], s[0:1], 64
    v_lshrrev_b32 v3, 6, v0
    v_and_b32 v1, 63, v0
    v_readfirstlane_b32 s3, v3
    s_and_b32 s84, s2, 7
    s_lshr_b32 s85, s2, 3
    s_mov_b32 s15, s85
    s_and_b32 s32, s84, 1
    s_lshl_b32 s86, s32, 3
    s_and_b32 s87, s85, 7
    s_add_u32 s28, s86, s87
    s_lshr_b32 s86, s84, 1
    s_lshl_b32 s86, s86, 2
    s_lshr_b32 s87, s85, 3
    s_add_u32 s29, s86, s87
    s_lshl_b32 s87, s32, 3
    s_xor_b32 s86, s86, s87
    s_and_b32 s87, s85, 3
    s_add_u32 s30, s86, s87
    s_lshr_b32 s31, s85, 2
    s_and_b32 s4, s3, 3
    s_lshr_b32 s5, s4, 1
    s_and_b32 s6, s4, 1
    s_lshr_b32 s7, s3, 2
    s_lshl_b32 s33, s4, 10
    s_mov_b64 exec, 0
    s_cmp_eq_u32 s3, 5
    s_cbranch_scc1 L_fan5
    s_cmp_eq_u32 s3, 6
    s_cbranch_scc1 L_fan6
    s_cmp_eq_u32 s3, 7
    s_cbranch_scc1 L_fan7
    s_cmp_lg_u32 s7, 0
    s_cbranch_scc1 L_teamB
L_teamA:
    s_mov_b64 exec, -1
    v_lshrrev_b32 v64, 4, v1
    v_bfe_u32 v65, v1, 2, 2
    v_and_b32 v66, 3, v1
    v_and_b32 v67, 15, v1
    v_lshrrev_b32 v68, 3, v1
    v_and_b32 v69, 7, v1
    s_lshl_b32 s85, s28, 7
    s_lshl_b32 s86, s4, 5
    s_add_u32 s86, s85, s86
    v_add_u32 v71, s86, v68
    v_xor_b32 v70, v69, v64
    v_lshlrev_b32 v70, 4, v70
    v_lshl_add_u32 v20, v71, 11, v70
    v_xor_b32 v21, 64, v20
    v_add_u32 v21, 16384, v21
    s_lshl_b32 s79, s4, 12
    s_and_b32 s72, s28, 3
    s_bitcmp1_b32 s28, 3
    s_cselect_b32 s91, 4, 0
    s_add_u32 s72, s72, s91
    s_mul_i32 s72, s72, 256
    s_sub_u32 s72, s72, 128
    s_lshl_b32 s85, s4, 3
    s_and_b32 s86, s4, 1
    s_lshl_b32 s86, s86, 2
    v_and_b32 v70, 2, v68
    v_xor_b32 v70, v70, v69
    v_xor_b32 v70, s86, v70
    v_add_u32 v71, s85, v68
    v_mul_u32_u24 v71, 7168, v71
    v_lshl_add_u32 v22, v70, 4, v71
    v_lshrrev_b32 v71, 2, v1
    s_lshl_b32 s86, s86, 2
    v_add_u32 v71, s86, v71
    v_mul_u32_u24 v71, 7168, v71
    v_and_b32 v70, 2, v64
    v_xor_b32 v70, v70, v66
    v_lshl_add_u32 v76, v70, 4, v71
    s_and_b32 s77, s28, 3
    s_bitcmp1_b32 s28, 3
    s_cselect_b32 s91, 4, 0
    s_add_u32 s77, s77, s91
    s_mul_i32 s77, s77, 917504
    s_add_u32 s77, s77, 0xfffc8000
    s_waitcnt lgkmcnt(0)
    s_mov_b32 s36, s8
    s_mov_b32 s37, s9
    s_mov_b32 s38, 0x400000
    s_mov_b32 s39, 0x20000
    s_add_u32 m0, s79, 116736
    s_add_u32 s72, s72, 128
    s_and_b32 s78, s72, 0x7ff
    buffer_load_dwordx4 v20, s[36:39], s78 offen lds
    s_add_u32 m0, s79, 117760
    s_nop 0
    buffer_load_dwordx4 v21, s[36:39], s78 offen lds
    s_add_u32 m0, s79, 118784
    s_add_u32 s78, s78, 32768
    buffer_load_dwordx4 v20, s[36:39], s78 offen lds
    s_add_u32 m0, s79, 119808
    s_nop 0
    buffer_load_dwordx4 v21, s[36:39], s78 offen lds
    s_mul_i32 s85, s29, 320
    s_and_b32 s86, s29, 1
    s_lshl_b32 s87, s86, 6
    s_add_u32 s87, s87, s85
    s_add_u32 s40, s16, s87
    s_addc_u32 s41, s17, 0
    s_sub_u32 s42, 7340032, s87
    s_mov_b32 s43, 0x20000
    s_add_u32 s44, s18, s87
    s_addc_u32 s45, s19, 0
    s_sub_u32 s46, 7340032, s87
    s_mov_b32 s47, 0x20000
    s_xor_b32 s86, s86, 1
    s_lshl_b32 s86, s86, 8
    s_add_u32 s87, s86, s85
    s_cmp_lt_u32 s4, 2
    s_cselect_b32 s88, s16, s18
    s_cselect_b32 s89, s17, s19
    s_add_u32 s48, s88, s87
    s_addc_u32 s49, s89, 0
    s_sub_u32 s50, 7340032, s87
    s_mov_b32 s51, 0x20000
    s_add_u32 m0, s33, 16384
    s_add_u32 s77, s77, 229376
    buffer_load_dwordx4 v22, s[40:43], s77 offen offset:0 lds
    s_add_u32 m0, s33, 20352
    s_nop 0
    buffer_load_dwordx4 v22, s[40:43], s77 offen offset:128 lds
    s_add_u32 m0, s33, 24576
    s_nop 0
    buffer_load_dwordx4 v22, s[44:47], s77 offen offset:0 lds
    s_add_u32 m0, s33, 28544
    s_nop 0
    buffer_load_dwordx4 v22, s[44:47], s77 offen offset:128 lds
    s_add_u32 m0, s33, 32768
    s_nop 0
    buffer_load_dwordx4 v76, s[48:51], s77 offen lds
    s_add_u32 m0, s33, 36864
    s_add_u32 s77, s77, 229376
    buffer_load_dwordx4 v22, s[40:43], s77 offen offset:0 lds
    s_add_u32 m0, s33, 40832
    s_nop 0
    buffer_load_dwordx4 v22, s[40:43], s77 offen offset:128 lds
    s_add_u32 m0, s33, 45056
    s_nop 0
    buffer_load_dwordx4 v22, s[44:47], s77 offen offset:0 lds
    s_add_u32 m0, s33, 49024
    s_nop 0
    buffer_load_dwordx4 v22, s[44:47], s77 offen offset:128 lds
    s_add_u32 m0, s33, 53248
    s_nop 0
    buffer_load_dwordx4 v76, s[48:51], s77 offen lds
    s_mov_b32 s68, s26
    s_mov_b32 s69, s27
    s_mov_b32 s70, 0x10000000
    s_mov_b32 s71, 0x20000
    s_getpc_b64 s[92:93]
L_pc:
    s_lshl2_add_u32 s91, s15, s4
    s_lshl_b32 s91, s91, 9
    s_min_u32 s91, s91, L_code_end - L_pc - 512
    s_load_dword s94, s[92:93], s91 offset:0
    s_load_dword s94, s[92:93], s91 offset:64
    s_load_dword s94, s[92:93], s91 offset:128
    s_load_dword s94, s[92:93], s91 offset:192
    s_load_dword s94, s[92:93], s91 offset:256
    s_load_dword s94, s[92:93], s91 offset:320
    s_load_dword s94, s[92:93], s91 offset:384
    s_load_dword s94, s[92:93], s91 offset:448
    v_lshrrev_b32 v64, 4, v1
    v_bfe_u32 v65, v1, 2, 2
    v_and_b32 v66, 3, v1
    v_and_b32 v67, 15, v1
    v_lshrrev_b32 v68, 3, v1
    v_and_b32 v69, 7, v1
    s_lshl_b32 s85, s6, 12
    s_add_u32 s85, s85, 16384
    v_lshl_add_u32 v70, v64, 3, v65
    v_lshlrev_b32 v70, 7, v70
    v_and_b32 v71, 1, v66
    v_lshl_add_u32 v70, v71, 3, v70
    v_add_u32 v70, s85, v70
    v_and_b32 v71, 2, v65
    v_and_b32 v72, 1, v64
    v_lshl_add_u32 v71, v72, 2, v71
    v_lshrrev_b32 v72, 1, v66
    v_xor_b32 v71, v71, v72
    v_xor_b32 v72, 0, v71
    v_lshl_add_u32 v4, v72, 4, v70
    v_add_u32 v9, 40960, v4
    v_xor_b32 v72, 2, v71
    v_lshl_add_u32 v5, v72, 4, v70
    v_add_u32 v10, 40960, v5
    v_xor_b32 v72, 4, v71
    v_lshl_add_u32 v6, v72, 4, v70
    v_add_u32 v11, 40960, v6
    v_xor_b32 v72, 6, v71
    v_lshl_add_u32 v7, v72, 4, v70
    v_add_u32 v12, 40960, v7
    v_lshl_add_u32 v70, v64, 3, v65
    v_lshlrev_b32 v70, 6, v70
    v_and_b32 v71, 1, v66
    v_lshl_add_u32 v70, v71, 3, v70
    v_and_b32 v71, 1, v64
    v_xor_b32 v71, s6, v71
    v_lshl_add_u32 v70, v71, 5, v70
    v_lshrrev_b32 v71, 1, v66
    v_lshl_add_u32 v70, v71, 4, v70
    v_add_u32 v8, 16384, v70
    v_add_u32 v13, 57344, v70
    v_lshrrev_b32 v70, 1, v67
    v_xor_b32 v70, v70, v64
    v_lshlrev_b32 v70, 4, v70
    v_lshl_add_u32 v70, v67, 7, v70
    s_lshl_b32 s85, s5, 13
    v_add_u32 v16, s85, v70
    v_xor_b32 v17, 64, v16
    s_mov_b32 s80, 116736
    s_lshl_b32 s86, s28, 7
    s_sub_u32 s86, s86, 16
    s_max_i32 s86, s86, 0
    s_lshl_b32 s87, s4, 2
    v_add_u32 v71, s87, v68
    v_lshrrev_b32 v70, 1, v71
    v_and_b32 v70, 7, v70
    v_xor_b32 v70, v70, v69
    v_lshlrev_b32 v70, 4, v70
    v_add_u32 v71, s86, v71
    v_lshl_add_u32 v3, v71, 11, v70
    s_lshl_b32 s81, s4, 9
    s_lshl_b32 s85, s4, 3
    s_and_b32 s86, s4, 1
    s_lshl_b32 s86, s86, 2
    v_and_b32 v70, 2, v68
    v_xor_b32 v70, v70, v69
    v_xor_b32 v70, s86, v70
    v_add_u32 v71, s85, v68
    v_mul_u32_u24 v71, 6144, v71
    v_lshl_add_u32 v23, v70, 4, v71
    s_lshl_b32 s85, s6, 2
    v_lshl_add_u32 v70, v64, 3, v65
    v_lshlrev_b32 v70, 7, v70
    v_and_b32 v71, 1, v66
    v_lshl_add_u32 v70, v71, 3, v70
    v_add_u32 v70, 0, v70
    v_and_b32 v71, 2, v65
    v_and_b32 v72, 1, v64
    v_lshl_add_u32 v71, v72, 2, v71
    v_lshrrev_b32 v72, 1, v66
    v_xor_b32 v71, v71, v72
    v_xor_b32 v71, s85, v71
    v_xor_b32 v72, 0, v71
    v_lshl_add_u32 v250, v72, 4, v70
    v_add_u32 v252, 65536, v250
    v_xor_b32 v72, 2, v71
    v_lshl_add_u32 v251, v72, 4, v70
    v_add_u32 v253, 65536, v251
    s_lshl_b32 s85, s5, 12
    v_lshl_add_u32 v248, v1, 4, s85
    v_add_u32 v249, 65536, v248
    s_lshl_b32 s85, s4, 12
    v_lshl_add_u32 v18, v1, 4, s85
    s_lshl_b32 s85, s4, 4
    v_and_b32 v70, 2, v68
    v_xor_b32 v70, v70, v69
    v_xor_b32 v70, 0, v70
    v_add_u32 v71, s85, v68
    v_mul_u32_u24 v71, 2048, v71
    v_lshl_add_u32 v254, v70, 4, v71
    s_add_u32 s85, s85, 8
    v_and_b32 v70, 2, v68
    v_xor_b32 v70, v70, v69
    v_xor_b32 v70, 4, v70
    v_add_u32 v71, s85, v68
    v_mul_u32_u24 v71, 2048, v71
    v_lshl_add_u32 v255, v70, 4, v71
    s_lshl_b32 s85, s31, 8
    s_lshl_b32 s86, s32, 7
    s_add_u32 s86, s85, s86
    s_xor_b32 s87, s86, 128
    s_lshr_b32 s91, s31, 2
    s_lshl1_add_u32 s91, s91, s32
    s_lshl_b32 s91, s91, 13
    s_add_u32 s91, s91, 0x2000000
    s_xor_b32 s85, s91, 8192
    s_and_b32 s92, s31, 3
    s_cmp_eq_u32 s92, 1
    s_cselect_b32 s86, s91, s86
    s_cselect_b32 s87, s85, s87
    s_cselect_b32 s91, 0x2a00000, 0
    s_cselect_b32 s92, s26, s20
    s_cselect_b32 s93, s27, s21
    s_max_u32 s91, s91, 7340032
    s_add_u32 s60, s92, s86
    s_addc_u32 s61, s93, 0
    s_sub_u32 s62, s91, s86
    s_mov_b32 s63, 0x20000
    s_add_u32 s64, s92, s87
    s_addc_u32 s65, s93, 0
    s_sub_u32 s66, s91, s87
    s_mov_b32 s67, 0x20000
    s_add_u32 s56, s26, 0x400000
    s_addc_u32 s57, s27, 0
    s_mov_b32 s58, 0xe00000
    s_mov_b32 s59, 0x20000
    s_mul_i32 s82, s30, 917504
    s_mul_i32 s85, s32, 327680
    s_add_u32 s82, s82, s85
    s_mul_i32 s83, s32, 2621440
    s_mul_i32 s85, s32, 10
    s_sub_u32 s85, 40, s85
    s_lshl_b32 s14, s85, 13
    s_lshl_b32 s35, s85, 16
    s_and_b32 s85, s31, 3
    s_cmp_eq_u32 s85, 1
    s_cselect_b64 vcc, -1, 0
    s_lshl_b32 s85, s4, 11
    v_lshl_add_u32 v70, v1, 4, s85
    v_add_u32 v71, 1024, v70
    v_cndmask_b32 v254, v254, v70, vcc
    v_cndmask_b32 v255, v255, v71, vcc
    v_lshrrev_b32 v78, 4, v1
    v_and_b32 v79, 1, v78
    v_lshrrev_b32 v78, 1, v78
    v_lshlrev_b32 v78, 8, v78
    v_lshl_add_u32 v78, v79, 10, v78
    v_and_b32 v79, 15, v1
    v_lshl_add_u32 v19, v79, 4, v78
    s_mul_i32 s84, s28, 112
    s_mul_i32 s85, s29, 5
    s_add_u32 s84, s84, s85
    s_lshl_b32 s84, s84, 13
    s_lshl_b32 s85, s5, 12
    s_add_u32 s84, s84, s85
    s_add_u32 s84, s84, 0x400000
    s_and_b32 s85, s29, 1
    s_lshl1_add_u32 s86, s6, s85
    s_lshl_b32 s86, s86, 13
    s_add_u32 s72, s84, s86
    s_add_u32 s73, s72, 8192
    s_xor_b32 s85, s85, 1
    s_lshl_b32 s85, s85, 15
    s_add_u32 s84, s84, s85
    s_lshl_b32 s85, s6, 9
    s_add_u32 s74, s84, s85
    s_lshl2_add_u32 s91, s2, s4
    s_lshl_b32 s75, s91, 9
    s_lshr_b32 s92, s91, 2
    s_mul_i32 s92, s92, 7168
    s_and_b32 s91, s91, 3
    s_lshl_b32 s91, s91, 9
    s_add_u32 s92, s92, s91
    s_add_u32 s99, s92, 5120
    s_mov_b32 s36, s26
    s_mov_b32 s37, s27
    s_mov_b32 s38, 0x400000
    s_mov_b32 s39, 0x20000
    s_lshl_b32 s85, s29, 7
    s_add_u32 s40, s10, s85
    s_addc_u32 s41, s11, 0
    s_sub_u32 s42, 6291456, s85
    s_mov_b32 s43, 0x20000
    s_add_u32 s86, s85, 4096
    s_add_u32 s44, s10, s86
    s_addc_u32 s45, s11, 0
    s_sub_u32 s46, 6291456, s86
    s_mov_b32 s47, 0x20000
    s_add_u32 s86, s85, 128
    s_and_b32 s86, s86, 0x7ff
    s_add_u32 s86, s86, 5120
    s_add_u32 s48, s16, s86
    s_addc_u32 s49, s17, 0
    s_sub_u32 s50, 7340032, s86
    s_mov_b32 s51, 0x20000
    s_add_u32 s52, s18, s86
    s_addc_u32 s53, s19, 0
    s_sub_u32 s54, 7340032, s86
    s_mov_b32 s55, 0x20000
    s_mov_b64 exec, 0
    s_cmp_eq_u32 s4, 0
    s_cbranch_scc1 L_pad6
    s_cmp_eq_u32 s4, 1
    s_cbranch_scc1 L_pad7
    s_cmp_eq_u32 s4, 2
    s_cbranch_scc1 L_pad0
    s_cmp_eq_u32 s4, 3
    s_cbranch_scc1 L_pad8
L_vret0:
    s_mov_b64 exec, -1
    s_mov_b64 exec, 0
    s_cmp_eq_u32 s4, 0
    s_cbranch_scc1 L_pad9
    s_cmp_eq_u32 s4, 1
    s_cbranch_scc1 L_pad1
    s_cmp_eq_u32 s4, 2
    s_cbranch_scc1 L_pad2
    s_cmp_eq_u32 s4, 3
    s_cbranch_scc1 L_pad3
L_vret1:
    s_mov_b64 exec, -1
    s_setprio 1
    s_waitcnt vmcnt(5)
    s_barrier
    v_add_u32 v14, s80, v16
    v_add_u32 v15, s80, v17
    s_add_u32 s80, s80, 18432
    s_cmp_ge_u32 s80, 153600
    s_cselect_b32 s84, 55296, 0
    s_sub_u32 s80, s80, s84
    ds_read_b64_tr_b16 v[64:65], v4 offset:0
    ds_read_b64_tr_b16 v[66:67], v4 offset:512
    ds_read_b128 v[24:27], v14 offset:0
    ds_read_b128 v[28:31], v14 offset:2048
    ds_read_b128 v[32:35], v14 offset:4096
    ds_read_b128 v[36:39], v14 offset:6144
    ds_read_b64_tr_b16 v[68:69], v4 offset:8192
    ds_read_b64_tr_b16 v[70:71], v4 offset:8704
    ds_read_b64_tr_b16 v[72:73], v5 offset:0
    ds_read_b64_tr_b16 v[74:75], v5 offset:512
    s_waitcnt lgkmcnt(7)
    v_mfma_f32_16x16x32_bf16 v[88:91], v[64:67], v[24:27], 0
    ds_read_b64_tr_b16 v[76:77], v5 offset:8192
    s_waitcnt lgkmcnt(7)
    v_mfma_f32_16x16x32_bf16 v[92:95], v[64:67], v[28:31], 0
    ds_read_b64_tr_b16 v[78:79], v5 offset:8704
    s_waitcnt lgkmcnt(7)
    v_mfma_f32_16x16x32_bf16 v[96:99], v[64:67], v[32:35], 0
    ds_read_b64_tr_b16 v[80:81], v6 offset:0
    s_waitcnt lgkmcnt(7)
    v_mfma_f32_16x16x32_bf16 v[100:103], v[64:67], v[36:39], 0
    ds_read_b64_tr_b16 v[82:83], v6 offset:512
    s_waitcnt lgkmcnt(6)
    v_mfma_f32_16x16x32_bf16 v[104:107], v[68:71], v[24:27], 0
    ds_read_b64_tr_b16 v[64:65], v6 offset:8192
    v_mfma_f32_16x16x32_bf16 v[108:111], v[68:71], v[28:31], 0
    v_mfma_f32_16x16x32_bf16 v[112:115], v[68:71], v[32:35], 0
    ds_read_b64_tr_b16 v[66:67], v6 offset:8704
    v_mfma_f32_16x16x32_bf16 v[116:119], v[68:71], v[36:39], 0
    s_waitcnt lgkmcnt(6)
    v_mfma_f32_16x16x32_bf16 v[120:123], v[72:75], v[24:27], 0
    ds_read_b64_tr_b16 v[68:69], v7 offset:0
    v_mfma_f32_16x16x32_bf16 v[124:127], v[72:75], v[28:31], 0
    v_mfma_f32_16x16x32_bf16 v[128:131], v[72:75], v[32:35], 0
    ds_read_b64_tr_b16 v[70:71], v7 offset:512
    v_mfma_f32_16x16x32_bf16 v[132:135], v[72:75], v[36:39], 0
    s_waitcnt lgkmcnt(6)
    v_mfma_f32_16x16x32_bf16 v[136:139], v[76:79], v[24:27], 0
    ds_read_b64_tr_b16 v[72:73], v7 offset:8192
    v_mfma_f32_16x16x32_bf16 v[140:143], v[76:79], v[28:31], 0
    v_mfma_f32_16x16x32_bf16 v[144:147], v[76:79], v[32:35], 0
    ds_read_b64_tr_b16 v[74:75], v7 offset:8704
    v_mfma_f32_16x16x32_bf16 v[148:151], v[76:79], v[36:39], 0
    s_waitcnt lgkmcnt(6)
    v_mfma_f32_16x16x32_bf16 v[152:155], v[80:83], v[24:27], 0
    ds_read_b64_tr_b16 v[76:77], v8 offset:16384
    v_mfma_f32_16x16x32_bf16 v[156:159], v[80:83], v[28:31], 0
    v_mfma_f32_16x16x32_bf16 v[160:163], v[80:83], v[32:35], 0
    ds_read_b64_tr_b16 v[78:79], v8 offset:16640
    v_mfma_f32_16x16x32_bf16 v[164:167], v[80:83], v[36:39], 0
    s_waitcnt lgkmcnt(6)
    v_mfma_f32_16x16x32_bf16 v[168:171], v[64:67], v[24:27], 0
    ds_read_b64_tr_b16 v[80:81], v8 offset:18432
    v_mfma_f32_16x16x32_bf16 v[172:175], v[64:67], v[28:31], 0
    v_mfma_f32_16x16x32_bf16 v[176:179], v[64:67], v[32:35], 0
    ds_read_b64_tr_b16 v[82:83], v8 offset:18688
    v_mfma_f32_16x16x32_bf16 v[180:183], v[64:67], v[36:39], 0
    s_waitcnt lgkmcnt(6)
    v_mfma_f32_16x16x32_bf16 v[184:187], v[68:71], v[24:27], 0
    v_mfma_f32_16x16x32_bf16 v[188:191], v[68:71], v[28:31], 0
    v_mfma_f32_16x16x32_bf16 v[192:195], v[68:71], v[32:35], 0
    v_mfma_f32_16x16x32_bf16 v[196:199], v[68:71], v[36:39], 0
    s_waitcnt vmcnt(0) lgkmcnt(0)
    s_barrier
    v_mfma_f32_16x16x32_bf16 v[200:203], v[72:75], v[24:27], 0
    ds_read_b64_tr_b16 v[64:65], v4 offset:20480
    v_mfma_f32_16x16x32_bf16 v[204:207], v[72:75], v[28:31], 0
    ds_read_b64_tr_b16 v[66:67], v4 offset:20992
    v_mfma_f32_16x16x32_bf16 v[208:211], v[72:75], v[32:35], 0
    ds_read_b128 v[40:43], v15 offset:0
    v_mfma_f32_16x16x32_bf16 v[212:215], v[72:75], v[36:39], 0
    ds_read_b128 v[44:47], v15 offset:2048
    v_mfma_f32_16x16x32_bf16 v[216:219], v[76:79], v[24:27], 0
    ds_read_b128 v[48:51], v15 offset:4096
    v_mfma_f32_16x16x32_bf16 v[220:223], v[76:79], v[28:31], 0
    ds_read_b128 v[52:55], v15 offset:6144
    v_mfma_f32_16x16x32_bf16 v[224:227], v[76:79], v[32:35], 0
    ds_read_b64_tr_b16 v[68:69], v4 offset:28672
    v_mfma_f32_16x16x32_bf16 v[228:231], v[76:79], v[36:39], 0
    ds_read_b64_tr_b16 v[70:71], v4 offset:29184
    v_mfma_f32_16x16x32_bf16 v[232:235], v[80:83], v[24:27], 0
    ds_read_b64_tr_b16 v[72:73], v5 offset:20480
    v_mfma_f32_16x16x32_bf16 v[236:239], v[80:83], v[28:31], 0
    v_mfma_f32_16x16x32_bf16 v[240:243], v[80:83], v[32:35], 0
    ds_read_b64_tr_b16 v[74:75], v5 offset:20992
    v_mfma_f32_16x16x32_bf16 v[244:247], v[80:83], v[36:39], 0
    s_waitcnt lgkmcnt(7)
    v_mfma_f32_16x16x32_bf16 v[88:91], v[64:67], v[40:43], v[88:91]
    ds_read_b64_tr_b16 v[76:77], v5 offset:28672
    s_waitcnt lgkmcnt(7)
    v_mfma_f32_16x16x32_bf16 v[92:95], v[64:67], v[44:47], v[92:95]
    ds_read_b64_tr_b16 v[78:79], v5 offset:29184
    s_waitcnt lgkmcnt(7)
    v_mfma_f32_16x16x32_bf16 v[96:99], v[64:67], v[48:51], v[96:99]
    ds_read_b64_tr_b16 v[80:81], v6 offset:20480
    s_waitcnt lgkmcnt(7)
    v_mfma_f32_16x16x32_bf16 v[100:103], v[64:67], v[52:55], v[100:103]
    ds_read_b64_tr_b16 v[82:83], v6 offset:20992
    s_waitcnt lgkmcnt(6)
    v_mfma_f32_16x16x32_bf16 v[104:107], v[68:71], v[40:43], v[104:107]
    ds_read_b64_tr_b16 v[64:65], v6 offset:28672
    v_mfma_f32_16x16x32_bf16 v[108:111], v[68:71], v[44:47], v[108:111]
    v_add_u32 v14, s80, v16
    v_mfma_f32_16x16x32_bf16 v[112:115], v[68:71], v[48:51], v[112:115]
    ds_read_b64_tr_b16 v[66:67], v6 offset:29184
    v_mfma_f32_16x16x32_bf16 v[116:119], v[68:71], v[52:55], v[116:119]
    v_add_u32 v15, s80, v17
    s_waitcnt lgkmcnt(6)
    v_mfma_f32_16x16x32_bf16 v[120:123], v[72:75], v[40:43], v[120:123]
    ds_read_b64_tr_b16 v[68:69], v7 offset:20480
    v_mfma_f32_16x16x32_bf16 v[124:127], v[72:75], v[44:47], v[124:127]
    s_add_u32 s80, s80, 18432
    v_mfma_f32_16x16x32_bf16 v[128:131], v[72:75], v[48:51], v[128:131]
    ds_read_b64_tr_b16 v[70:71], v7 offset:20992
    v_mfma_f32_16x16x32_bf16 v[132:135], v[72:75], v[52:55], v[132:135]
    s_cmp_ge_u32 s80, 153600
    s_cselect_b32 s84, 55296, 0
    s_waitcnt lgkmcnt(6)
    v_mfma_f32_16x16x32_bf16 v[136:139], v[76:79], v[40:43], v[136:139]
    ds_read_b64_tr_b16 v[72:73], v7 offset:28672
    v_mfma_f32_16x16x32_bf16 v[140:143], v[76:79], v[44:47], v[140:143]
    s_sub_u32 s80, s80, s84
    v_mfma_f32_16x16x32_bf16 v[144:147], v[76:79], v[48:51], v[144:147]
    ds_read_b64_tr_b16 v[74:75], v7 offset:29184
    v_mfma_f32_16x16x32_bf16 v[148:151], v[76:79], v[52:55], v[148:151]
    s_waitcnt lgkmcnt(6)
    v_mfma_f32_16x16x32_bf16 v[152:155], v[80:83], v[40:43], v[152:155]
    ds_read_b64_tr_b16 v[76:77], v8 offset:36864
    v_mfma_f32_16x16x32_bf16 v[156:159], v[80:83], v[44:47], v[156:159]
    v_mfma_f32_16x16x32_bf16 v[160:163], v[80:83], v[48:51], v[160:163]
    ds_read_b64_tr_b16 v[78:79], v8 offset:37120
    v_mfma_f32_16x16x32_bf16 v[164:167], v[80:83], v[52:55], v[164:167]
    s_waitcnt lgkmcnt(6)
    v_mfma_f32_16x16x32_bf16 v[168:171], v[64:67], v[40:43], v[168:171]
    ds_read_b64_tr_b16 v[80:81], v8 offset:38912
    v_mfma_f32_16x16x32_bf16 v[172:175], v[64:67], v[44:47], v[172:175]
    v_mfma_f32_16x16x32_bf16 v[176:179], v[64:67], v[48:51], v[176:179]
    ds_read_b64_tr_b16 v[82:83], v8 offset:39168
    v_mfma_f32_16x16x32_bf16 v[180:183], v[64:67], v[52:55], v[180:183]
    s_waitcnt lgkmcnt(6)
    v_mfma_f32_16x16x32_bf16 v[184:187], v[68:71], v[40:43], v[184:187]
    v_mfma_f32_16x16x32_bf16 v[188:191], v[68:71], v[44:47], v[188:191]
    v_mfma_f32_16x16x32_bf16 v[192:195], v[68:71], v[48:51], v[192:195]
    v_mfma_f32_16x16x32_bf16 v[196:199], v[68:71], v[52:55], v[196:199]
    s_waitcnt lgkmcnt(0)
    s_barrier
    v_mfma_f32_16x16x32_bf16 v[200:203], v[72:75], v[40:43], v[200:203]
    ds_read_b64_tr_b16 v[64:65], v9 offset:0
    v_mfma_f32_16x16x32_bf16 v[204:207], v[72:75], v[44:47], v[204:207]
    ds_read_b64_tr_b16 v[66:67], v9 offset:512
    v_mfma_f32_16x16x32_bf16 v[208:211], v[72:75], v[48:51], v[208:211]
    ds_read_b128 v[24:27], v14 offset:0
    v_mfma_f32_16x16x32_bf16 v[212:215], v[72:75], v[52:55], v[212:215]
    ds_read_b128 v[28:31], v14 offset:2048
    v_mfma_f32_16x16x32_bf16 v[216:219], v[76:79], v[40:43], v[216:219]
    ds_read_b128 v[32:35], v14 offset:4096
    v_mfma_f32_16x16x32_bf16 v[220:223], v[76:79], v[44:47], v[220:223]
    ds_read_b128 v[36:39], v14 offset:6144
    v_mfma_f32_16x16x32_bf16 v[224:227], v[76:79], v[48:51], v[224:227]
    ds_read_b64_tr_b16 v[68:69], v9 offset:8192
    v_mfma_f32_16x16x32_bf16 v[228:231], v[76:79], v[52:55], v[228:231]
    ds_read_b64_tr_b16 v[70:71], v9 offset:8704
    v_mfma_f32_16x16x32_bf16 v[232:235], v[80:83], v[40:43], v[232:235]
    ds_read_b64_tr_b16 v[72:73], v10 offset:0
    v_mfma_f32_16x16x32_bf16 v[236:239], v[80:83], v[44:47], v[236:239]
    v_mfma_f32_16x16x32_bf16 v[240:243], v[80:83], v[48:51], v[240:243]
    ds_read_b64_tr_b16 v[74:75], v10 offset:512
    v_mfma_f32_16x16x32_bf16 v[244:247], v[80:83], v[52:55], v[244:247]
    s_waitcnt lgkmcnt(7)
    v_mfma_f32_16x16x32_bf16 v[88:91], v[64:67], v[24:27], v[88:91]
    ds_read_b64_tr_b16 v[76:77], v10 offset:8192
    s_waitcnt lgkmcnt(7)
    v_mfma_f32_16x16x32_bf16 v[92:95], v[64:67], v[28:31], v[92:95]
    ds_read_b64_tr_b16 v[78:79], v10 offset:8704
    s_waitcnt lgkmcnt(7)
    v_mfma_f32_16x16x32_bf16 v[96:99], v[64:67], v[32:35], v[96:99]
    ds_read_b64_tr_b16 v[80:81], v11 offset:0
    s_waitcnt lgkmcnt(7)
    v_mfma_f32_16x16x32_bf16 v[100:103], v[64:67], v[36:39], v[100:103]
    ds_read_b64_tr_b16 v[82:83], v11 offset:512
    s_waitcnt lgkmcnt(6)
    v_mfma_f32_16x16x32_bf16 v[104:107], v[68:71], v[24:27], v[104:107]
    ds_read_b64_tr_b16 v[64:65], v11 offset:8192
    v_mfma_f32_16x16x32_bf16 v[108:111], v[68:71], v[28:31], v[108:111]
    v_mfma_f32_16x16x32_bf16 v[112:115], v[68:71], v[32:35], v[112:115]
    ds_read_b64_tr_b16 v[66:67], v11 offset:8704
    v_mfma_f32_16x16x32_bf16 v[116:119], v[68:71], v[36:39], v[116:119]
    s_waitcnt lgkmcnt(6)
    v_mfma_f32_16x16x32_bf16 v[120:123], v[72:75], v[24:27], v[120:123]
    ds_read_b64_tr_b16 v[68:69], v12 offset:0
    v_mfma_f32_16x16x32_bf16 v[124:127], v[72:75], v[28:31], v[124:127]
    v_mfma_f32_16x16x32_bf16 v[128:131], v[72:75], v[32:35], v[128:131]
    ds_read_b64_tr_b16 v[70:71], v12 offset:512
    v_mfma_f32_16x16x32_bf16 v[132:135], v[72:75], v[36:39], v[132:135]
    s_waitcnt lgkmcnt(6)
    v_mfma_f32_16x16x32_bf16 v[136:139], v[76:79], v[24:27], v[136:139]
    ds_read_b64_tr_b16 v[72:73], v12 offset:8192
    v_mfma_f32_16x16x32_bf16 v[140:143], v[76:79], v[28:31], v[140:143]
    v_mfma_f32_16x16x32_bf16 v[144:147], v[76:79], v[32:35], v[144:147]
    ds_read_b64_tr_b16 v[74:75], v12 offset:8704
    v_mfma_f32_16x16x32_bf16 v[148:151], v[76:79], v[36:39], v[148:151]
    s_waitcnt lgkmcnt(6)
    v_mfma_f32_16x16x32_bf16 v[152:155], v[80:83], v[24:27], v[152:155]
    ds_read_b64_tr_b16 v[76:77], v13 offset:16384
    v_mfma_f32_16x16x32_bf16 v[156:159], v[80:83], v[28:31], v[156:159]
    v_mfma_f32_16x16x32_bf16 v[160:163], v[80:83], v[32:35], v[160:163]
    ds_read_b64_tr_b16 v[78:79], v13 offset:16640
    v_mfma_f32_16x16x32_bf16 v[164:167], v[80:83], v[36:39], v[164:167]
    s_waitcnt lgkmcnt(6)
    v_mfma_f32_16x16x32_bf16 v[168:171], v[64:67], v[24:27], v[168:171]
    ds_read_b64_tr_b16 v[80:81], v13 offset:18432
    v_mfma_f32_16x16x32_bf16 v[172:175], v[64:67], v[28:31], v[172:175]
    v_mfma_f32_16x16x32_bf16 v[176:179], v[64:67], v[32:35], v[176:179]
    ds_read_b64_tr_b16 v[82:83], v13 offset:18688
    v_mfma_f32_16x16x32_bf16 v[180:183], v[64:67], v[36:39], v[180:183]
    s_waitcnt lgkmcnt(6)
    v_mfma_f32_16x16x32_bf16 v[184:187], v[68:71], v[24:27], v[184:187]
    v_mfma_f32_16x16x32_bf16 v[188:191], v[68:71], v[28:31], v[188:191]
    v_mfma_f32_16x16x32_bf16 v[192:195], v[68:71], v[32:35], v[192:195]
    v_mfma_f32_16x16x32_bf16 v[196:199], v[68:71], v[36:39], v[196:199]
    s_waitcnt lgkmcnt(0)
    s_barrier
    v_mfma_f32_16x16x32_bf16 v[200:203], v[72:75], v[24:27], v[200:203]
    ds_read_b64_tr_b16 v[64:65], v9 offset:20480
    v_mfma_f32_16x16x32_bf16 v[204:207], v[72:75], v[28:31], v[204:207]
    ds_read_b64_tr_b16 v[66:67], v9 offset:20992
    v_mfma_f32_16x16x32_bf16 v[208:211], v[72:75], v[32:35], v[208:211]
    ds_read_b128 v[40:43], v15 offset:0
    v_mfma_f32_16x16x32_bf16 v[212:215], v[72:75], v[36:39], v[212:215]
    ds_read_b128 v[44:47], v15 offset:2048
    v_mfma_f32_16x16x32_bf16 v[216:219], v[76:79], v[24:27], v[216:219]
    ds_read_b128 v[48:51], v15 offset:4096
    v_mfma_f32_16x16x32_bf16 v[220:223], v[76:79], v[28:31], v[220:223]
    ds_read_b128 v[52:55], v15 offset:6144
    v_mfma_f32_16x16x32_bf16 v[224:227], v[76:79], v[32:35], v[224:227]
    ds_read_b64_tr_b16 v[68:69], v9 offset:28672
    v_mfma_f32_16x16x32_bf16 v[228:231], v[76:79], v[36:39], v[228:231]
    ds_read_b64_tr_b16 v[70:71], v9 offset:29184
    v_mfma_f32_16x16x32_bf16 v[232:235], v[80:83], v[24:27], v[232:235]
    ds_read_b64_tr_b16 v[72:73], v10 offset:20480
    v_mfma_f32_16x16x32_bf16 v[236:239], v[80:83], v[28:31], v[236:239]
    v_mfma_f32_16x16x32_bf16 v[240:243], v[80:83], v[32:35], v[240:243]
    ds_read_b64_tr_b16 v[74:75], v10 offset:20992
    v_mfma_f32_16x16x32_bf16 v[244:247], v[80:83], v[36:39], v[244:247]
    s_waitcnt lgkmcnt(7)
    v_mfma_f32_16x16x32_bf16 v[88:91], v[64:67], v[40:43], v[88:91]
    ds_read_b64_tr_b16 v[76:77], v10 offset:28672
    s_waitcnt lgkmcnt(7)
    v_mfma_f32_16x16x32_bf16 v[92:95], v[64:67], v[44:47], v[92:95]
    ds_read_b64_tr_b16 v[78:79], v10 offset:29184
    s_waitcnt lgkmcnt(7)
    v_mfma_f32_16x16x32_bf16 v[96:99], v[64:67], v[48:51], v[96:99]
    ds_read_b64_tr_b16 v[80:81], v11 offset:20480
    s_waitcnt lgkmcnt(7)
    v_mfma_f32_16x16x32_bf16 v[100:103], v[64:67], v[52:55], v[100:103]
    ds_read_b64_tr_b16 v[82:83], v11 offset:20992
    s_waitcnt lgkmcnt(6)
    v_mfma_f32_16x16x32_bf16 v[104:107], v[68:71], v[40:43], v[104:107]
    ds_read_b64_tr_b16 v[64:65], v11 offset:28672
    v_mfma_f32_16x16x32_bf16 v[108:111], v[68:71], v[44:47], v[108:111]
    v_add_u32 v14, s80, v16
    v_mfma_f32_16x16x32_bf16 v[112:115], v[68:71], v[48:51], v[112:115]
    ds_read_b64_tr_b16 v[66:67], v11 offset:29184
    v_mfma_f32_16x16x32_bf16 v[116:119], v[68:71], v[52:55], v[116:119]
    v_add_u32 v15, s80, v17
    s_waitcnt lgkmcnt(6)
    v_mfma_f32_16x16x32_bf16 v[120:123], v[72:75], v[40:43], v[120:123]
    ds_read_b64_tr_b16 v[68:69], v12 offset:20480
    v_mfma_f32_16x16x32_bf16 v[124:127], v[72:75], v[44:47], v[124:127]
    s_add_u32 s80, s80, 18432
    v_mfma_f32_16x16x32_bf16 v[128:131], v[72:75], v[48:51], v[128:131]
    ds_read_b64_tr_b16 v[70:71], v12 offset:20992
    v_mfma_f32_16x16x32_bf16 v[132:135], v[72:75], v[52:55], v[132:135]
    s_cmp_ge_u32 s80, 153600
    s_cselect_b32 s84, 55296, 0
    s_waitcnt lgkmcnt(6)
    v_mfma_f32_16x16x32_bf16 v[136:139], v[76:79], v[40:43], v[136:139]
    ds_read_b64_tr_b16 v[72:73], v12 offset:28672
    v_mfma_f32_16x16x32_bf16 v[140:143], v[76:79], v[44:47], v[140:143]
    s_sub_u32 s80, s80, s84
    v_mfma_f32_16x16x32_bf16 v[144:147], v[76:79], v[48:51], v[144:147]
    ds_read_b64_tr_b16 v[74:75], v12 offset:29184
    v_mfma_f32_16x16x32_bf16 v[148:151], v[76:79], v[52:55], v[148:151]
    s_waitcnt lgkmcnt(6)
    v_mfma_f32_16x16x32_bf16 v[152:155], v[80:83], v[40:43], v[152:155]
    ds_read_b64_tr_b16 v[76:77], v13 offset:36864
    v_mfma_f32_16x16x32_bf16 v[156:159], v[80:83], v[44:47], v[156:159]
    v_mfma_f32_16x16x32_bf16 v[160:163], v[80:83], v[48:51], v[160:163]
    ds_read_b64_tr_b16 v[78:79], v13 offset:37120
    v_mfma_f32_16x16x32_bf16 v[164:167], v[80:83], v[52:55], v[164:167]
    s_waitcnt lgkmcnt(6)
    v_mfma_f32_16x16x32_bf16 v[168:171], v[64:67], v[40:43], v[168:171]
    ds_read_b64_tr_b16 v[80:81], v13 offset:38912
    v_mfma_f32_16x16x32_bf16 v[172:175], v[64:67], v[44:47], v[172:175]
    v_mfma_f32_16x16x32_bf16 v[176:179], v[64:67], v[48:51], v[176:179]
    ds_read_b64_tr_b16 v[82:83], v13 offset:39168
    v_mfma_f32_16x16x32_bf16 v[180:183], v[64:67], v[52:55], v[180:183]
    s_waitcnt lgkmcnt(6)
    v_mfma_f32_16x16x32_bf16 v[184:187], v[68:71], v[40:43], v[184:187]
    v_mfma_f32_16x16x32_bf16 v[188:191], v[68:71], v[44:47], v[188:191]
    v_mfma_f32_16x16x32_bf16 v[192:195], v[68:71], v[48:51], v[192:195]
    v_mfma_f32_16x16x32_bf16 v[196:199], v[68:71], v[52:55], v[196:199]
    s_waitcnt lgkmcnt(0)
    s_barrier
    v_mfma_f32_16x16x32_bf16 v[200:203], v[72:75], v[40:43], v[200:203]
    ds_read_b64_tr_b16 v[64:65], v4 offset:0
    v_mfma_f32_16x16x32_bf16 v[204:207], v[72:75], v[44:47], v[204:207]
    ds_read_b64_tr_b16 v[66:67], v4 offset:512
    v_mfma_f32_16x16x32_bf16 v[208:211], v[72:75], v[48:51], v[208:211]
    ds_read_b128 v[24:27], v14 offset:0
    v_mfma_f32_16x16x32_bf16 v[212:215], v[72:75], v[52:55], v[212:215]
    ds_read_b128 v[28:31], v14 offset:2048
    v_mfma_f32_16x16x32_bf16 v[216:219], v[76:79], v[40:43], v[216:219]
    ds_read_b128 v[32:35], v14 offset:4096
    v_mfma_f32_16x16x32_bf16 v[220:223], v[76:79], v[44:47], v[220:223]
    ds_read_b128 v[36:39], v14 offset:6144
    v_mfma_f32_16x16x32_bf16 v[224:227], v[76:79], v[48:51], v[224:227]
    ds_read_b64_tr_b16 v[68:69], v4 offset:8192
    v_mfma_f32_16x16x32_bf16 v[228:231], v[76:79], v[52:55], v[228:231]
    ds_read_b64_tr_b16 v[70:71], v4 offset:8704
    v_mfma_f32_16x16x32_bf16 v[232:235], v[80:83], v[40:43], v[232:235]
    ds_read_b64_tr_b16 v[72:73], v5 offset:0
    v_mfma_f32_16x16x32_bf16 v[236:239], v[80:83], v[44:47], v[236:239]
    v_mfma_f32_16x16x32_bf16 v[240:243], v[80:83], v[48:51], v[240:243]
    ds_read_b64_tr_b16 v[74:75], v5 offset:512
    v_mfma_f32_16x16x32_bf16 v[244:247], v[80:83], v[52:55], v[244:247]
    s_or_b32 s91, s2, s4
    s_cbranch_scc1 L_notok
    s_memrealtime s[92:93]
    v_mov_b32 v60, 0
    s_waitcnt lgkmcnt(0)
    s_or_b32 s92, s92, 1
    v_mov_b32 v62, s92
    v_mov_b32 v63, s93
    s_mov_b64 exec, 1
    global_store_dwordx2 v60, v[62:63], s[24:25] sc1
    s_mov_b64 exec, -1
L_notok:
    s_mov_b32 s34, 6
.p2align 6
L_p1:
    s_waitcnt lgkmcnt(7)
    v_mfma_f32_16x16x32_bf16 v[88:91], v[64:67], v[24:27], v[88:91]
    ds_read_b64_tr_b16 v[76:77], v5 offset:8192
    s_waitcnt lgkmcnt(7)
    v_mfma_f32_16x16x32_bf16 v[92:95], v[64:67], v[28:31], v[92:95]
    ds_read_b64_tr_b16 v[78:79], v5 offset:8704
    s_waitcnt lgkmcnt(7)
    v_mfma_f32_16x16x32_bf16 v[96:99], v[64:67], v[32:35], v[96:99]
    ds_read_b64_tr_b16 v[80:81], v6 offset:0
    s_waitcnt lgkmcnt(7)
    v_mfma_f32_16x16x32_bf16 v[100:103], v[64:67], v[36:39], v[100:103]
    ds_read_b64_tr_b16 v[82:83], v6 offset:512
    s_waitcnt lgkmcnt(6)
    v_mfma_f32_16x16x32_bf16 v[104:107], v[68:71], v[24:27], v[104:107]
    ds_read_b64_tr_b16 v[64:65], v6 offset:8192
    v_mfma_f32_16x16x32_bf16 v[108:111], v[68:71], v[28:31], v[108:111]
    v_mfma_f32_16x16x32_bf16 v[112:115], v[68:71], v[32:35], v[112:115]
    ds_read_b64_tr_b16 v[66:67], v6 offset:8704
    v_mfma_f32_16x16x32_bf16 v[116:119], v[68:71], v[36:39], v[116:119]
    s_waitcnt lgkmcnt(6)
    v_mfma_f32_16x16x32_bf16 v[120:123], v[72:75], v[24:27], v[120:123]
    ds_read_b64_tr_b16 v[68:69], v7 offset:0
    v_mfma_f32_16x16x32_bf16 v[124:127], v[72:75], v[28:31], v[124:127]
    v_mfma_f32_16x16x32_bf16 v[128:131], v[72:75], v[32:35], v[128:131]
    ds_read_b64_tr_b16 v[70:71], v7 offset:512
    v_mfma_f32_16x16x32_bf16 v[132:135], v[72:75], v[36:39], v[132:135]
    s_waitcnt lgkmcnt(6)
    v_mfma_f32_16x16x32_bf16 v[136:139], v[76:79], v[24:27], v[136:139]
    ds_read_b64_tr_b16 v[72:73], v7 offset:8192
    v_mfma_f32_16x16x32_bf16 v[140:143], v[76:79], v[28:31], v[140:143]
    v_mfma_f32_16x16x32_bf16 v[144:147], v[76:79], v[32:35], v[144:147]
    ds_read_b64_tr_b16 v[74:75], v7 offset:8704
    v_mfma_f32_16x16x32_bf16 v[148:151], v[76:79], v[36:39], v[148:151]
    s_waitcnt lgkmcnt(6)
    v_mfma_f32_16x16x32_bf16 v[152:155], v[80:83], v[24:27], v[152:155]
    ds_read_b64_tr_b16 v[76:77], v8 offset:16384
    v_mfma_f32_16x16x32_bf16 v[156:159], v[80:83], v[28:31], v[156:159]
    v_mfma_f32_16x16x32_bf16 v[160:163], v[80:83], v[32:35], v[160:163]
    ds_read_b64_tr_b16 v[78:79], v8 offset:16640
    v_mfma_f32_16x16x32_bf16 v[164:167], v[80:83], v[36:39], v[164:167]
    s_waitcnt lgkmcnt(6)
    v_mfma_f32_16x16x32_bf16 v[168:171], v[64:67], v[24:27], v[168:171]
    ds_read_b64_tr_b16 v[80:81], v8 offset:18432
    v_mfma_f32_16x16x32_bf16 v[172:175], v[64:67], v[28:31], v[172:175]
    v_mfma_f32_16x16x32_bf16 v[176:179], v[64:67], v[32:35], v[176:179]
    ds_read_b64_tr_b16 v[82:83], v8 offset:18688
    v_mfma_f32_16x16x32_bf16 v[180:183], v[64:67], v[36:39], v[180:183]
    s_waitcnt lgkmcnt(6)
    v_mfma_f32_16x16x32_bf16 v[184:187], v[68:71], v[24:27], v[184:187]
    v_mfma_f32_16x16x32_bf16 v[188:191], v[68:71], v[28:31], v[188:191]
    v_mfma_f32_16x16x32_bf16 v[192:195], v[68:71], v[32:35], v[192:195]
    v_mfma_f32_16x16x32_bf16 v[196:199], v[68:71], v[36:39], v[196:199]
    s_waitcnt lgkmcnt(0)
    s_barrier
    v_mfma_f32_16x16x32_bf16 v[200:203], v[72:75], v[24:27], v[200:203]
    ds_read_b64_tr_b16 v[64:65], v4 offset:20480
    v_mfma_f32_16x16x32_bf16 v[204:207], v[72:75], v[28:31], v[204:207]
    ds_read_b64_tr_b16 v[66:67], v4 offset:20992
    v_mfma_f32_16x16x32_bf16 v[208:211], v[72:75], v[32:35], v[208:211]
    ds_read_b128 v[40:43], v15 offset:0
    v_mfma_f32_16x16x32_bf16 v[212:215], v[72:75], v[36:39], v[212:215]
    ds_read_b128 v[44:47], v15 offset:2048
    v_mfma_f32_16x16x32_bf16 v[216:219], v[76:79], v[24:27], v[216:219]
    ds_read_b128 v[48:51], v15 offset:4096
    v_mfma_f32_16x16x32_bf16 v[220:223], v[76:79], v[28:31], v[220:223]
    ds_read_b128 v[52:55], v15 offset:6144
    v_mfma_f32_16x16x32_bf16 v[224:227], v[76:79], v[32:35], v[224:227]
    ds_read_b64_tr_b16 v[68:69], v4 offset:28672
    v_mfma_f32_16x16x32_bf16 v[228:231], v[76:79], v[36:39], v[228:231]
    ds_read_b64_tr_b16 v[70:71], v4 offset:29184
    v_mfma_f32_16x16x32_bf16 v[232:235], v[80:83], v[24:27], v[232:235]
    ds_read_b64_tr_b16 v[72:73], v5 offset:20480
    v_mfma_f32_16x16x32_bf16 v[236:239], v[80:83], v[28:31], v[236:239]
    v_mfma_f32_16x16x32_bf16 v[240:243], v[80:83], v[32:35], v[240:243]
    ds_read_b64_tr_b16 v[74:75], v5 offset:20992
    v_mfma_f32_16x16x32_bf16 v[244:247], v[80:83], v[36:39], v[244:247]
    s_waitcnt lgkmcnt(7)
    v_mfma_f32_16x16x32_bf16 v[88:91], v[64:67], v[40:43], v[88:91]
    ds_read_b64_tr_b16 v[76:77], v5 offset:28672
    s_waitcnt lgkmcnt(7)
    v_mfma_f32_16x16x32_bf16 v[92:95], v[64:67], v[44:47], v[92:95]
    ds_read_b64_tr_b16 v[78:79], v5 offset:29184
    s_waitcnt lgkmcnt(7)
    v_mfma_f32_16x16x32_bf16 v[96:99], v[64:67], v[48:51], v[96:99]
    ds_read_b64_tr_b16 v[80:81], v6 offset:20480
    s_waitcnt lgkmcnt(7)
    v_mfma_f32_16x16x32_bf16 v[100:103], v[64:67], v[52:55], v[100:103]
    ds_read_b64_tr_b16 v[82:83], v6 offset:20992
    s_waitcnt lgkmcnt(6)
    v_mfma_f32_16x16x32_bf16 v[104:107], v[68:71], v[40:43], v[104:107]
    ds_read_b64_tr_b16 v[64:65], v6 offset:28672
    v_mfma_f32_16x16x32_bf16 v[108:111], v[68:71], v[44:47], v[108:111]
    v_add_u32 v14, s80, v16
    v_mfma_f32_16x16x32_bf16 v[112:115], v[68:71], v[48:51], v[112:115]
    ds_read_b64_tr_b16 v[66:67], v6 offset:29184
    v_mfma_f32_16x16x32_bf16 v[116:119], v[68:71], v[52:55], v[116:119]
    v_add_u32 v15, s80, v17
    s_waitcnt lgkmcnt(6)
    v_mfma_f32_16x16x32_bf16 v[120:123], v[72:75], v[40:43], v[120:123]
    ds_read_b64_tr_b16 v[68:69], v7 offset:20480
    v_mfma_f32_16x16x32_bf16 v[124:127], v[72:75], v[44:47], v[124:127]
    s_add_u32 s80, s80, 18432
    v_mfma_f32_16x16x32_bf16 v[128:131], v[72:75], v[48:51], v[128:131]
    ds_read_b64_tr_b16 v[70:71], v7 offset:20992
    v_mfma_f32_16x16x32_bf16 v[132:135], v[72:75], v[52:55], v[132:135]
    s_cmp_ge_u32 s80, 153600
    s_cselect_b32 s84, 55296, 0
    s_waitcnt lgkmcnt(6)
    v_mfma_f32_16x16x32_bf16 v[136:139], v[76:79], v[40:43], v[136:139]
    ds_read_b64_tr_b16 v[72:73], v7 offset:28672
    v_mfma_f32_16x16x32_bf16 v[140:143], v[76:79], v[44:47], v[140:143]
    s_sub_u32 s80, s80, s84
    v_mfma_f32_16x16x32_bf16 v[144:147], v[76:79], v[48:51], v[144:147]
    ds_read_b64_tr_b16 v[74:75], v7 offset:29184
    v_mfma_f32_16x16x32_bf16 v[148:151], v[76:79], v[52:55], v[148:151]
    s_waitcnt lgkmcnt(6)
    v_mfma_f32_16x16x32_bf16 v[152:155], v[80:83], v[40:43], v[152:155]
    ds_read_b64_tr_b16 v[76:77], v8 offset:36864
    v_mfma_f32_16x16x32_bf16 v[156:159], v[80:83], v[44:47], v[156:159]
    v_mfma_f32_16x16x32_bf16 v[160:163], v[80:83], v[48:51], v[160:163]
    ds_read_b64_tr_b16 v[78:79], v8 offset:37120
    v_mfma_f32_16x16x32_bf16 v[164:167], v[80:83], v[52:55], v[164:167]
    s_waitcnt lgkmcnt(6)
    v_mfma_f32_16x16x32_bf16 v[168:171], v[64:67], v[40:43], v[168:171]
    ds_read_b64_tr_b16 v[80:81], v8 offset:38912
    v_mfma_f32_16x16x32_bf16 v[172:175], v[64:67], v[44:47], v[172:175]
    v_mfma_f32_16x16x32_bf16 v[176:179], v[64:67], v[48:51], v[176:179]
    ds_read_b64_tr_b16 v[82:83], v8 offset:39168
    v_mfma_f32_16x16x32_bf16 v[180:183], v[64:67], v[52:55], v[180:183]
    s_waitcnt lgkmcnt(6)
    v_mfma_f32_16x16x32_bf16 v[184:187], v[68:71], v[40:43], v[184:187]
    v_mfma_f32_16x16x32_bf16 v[188:191], v[68:71], v[44:47], v[188:191]
    v_mfma_f32_16x16x32_bf16 v[192:195], v[68:71], v[48:51], v[192:195]
    v_mfma_f32_16x16x32_bf16 v[196:199], v[68:71], v[52:55], v[196:199]
    s_waitcnt lgkmcnt(0)
    s_barrier
    v_mfma_f32_16x16x32_bf16 v[200:203], v[72:75], v[40:43], v[200:203]
    ds_read_b64_tr_b16 v[64:65], v9 offset:0
    v_mfma_f32_16x16x32_bf16 v[204:207], v[72:75], v[44:47], v[204:207]
    ds_read_b64_tr_b16 v[66:67], v9 offset:512
    v_mfma_f32_16x16x32_bf16 v[208:211], v[72:75], v[48:51], v[208:211]
    ds_read_b128 v[24:27], v14 offset:0
    v_mfma_f32_16x16x32_bf16 v[212:215], v[72:75], v[52:55], v[212:215]
    ds_read_b128 v[28:31], v14 offset:2048
    v_mfma_f32_16x16x32_bf16 v[216:219], v[76:79], v[40:43], v[216:219]
    ds_read_b128 v[32:35], v14 offset:4096
    v_mfma_f32_16x16x32_bf16 v[220:223], v[76:79], v[44:47], v[220:223]
    ds_read_b128 v[36:39], v14 offset:6144
    v_mfma_f32_16x16x32_bf16 v[224:227], v[76:79], v[48:51], v[224:227]
    ds_read_b64_tr_b16 v[68:69], v9 offset:8192
    v_mfma_f32_16x16x32_bf16 v[228:231], v[76:79], v[52:55], v[228:231]
    ds_read_b64_tr_b16 v[70:71], v9 offset:8704
    v_mfma_f32_16x16x32_bf16 v[232:235], v[80:83], v[40:43], v[232:235]
    ds_read_b64_tr_b16 v[72:73], v10 offset:0
    v_mfma_f32_16x16x32_bf16 v[236:239], v[80:83], v[44:47], v[236:239]
    v_mfma_f32_16x16x32_bf16 v[240:243], v[80:83], v[48:51], v[240:243]
    ds_read_b64_tr_b16 v[74:75], v10 offset:512
    v_mfma_f32_16x16x32_bf16 v[244:247], v[80:83], v[52:55], v[244:247]
    s_waitcnt lgkmcnt(7)
    v_mfma_f32_16x16x32_bf16 v[88:91], v[64:67], v[24:27], v[88:91]
    ds_read_b64_tr_b16 v[76:77], v10 offset:8192
    s_waitcnt lgkmcnt(7)
    v_mfma_f32_16x16x32_bf16 v[92:95], v[64:67], v[28:31], v[92:95]
    ds_read_b64_tr_b16 v[78:79], v10 offset:8704
    s_waitcnt lgkmcnt(7)
    v_mfma_f32_16x16x32_bf16 v[96:99], v[64:67], v[32:35], v[96:99]
    ds_read_b64_tr_b16 v[80:81], v11 offset:0
    s_waitcnt lgkmcnt(7)
    v_mfma_f32_16x16x32_bf16 v[100:103], v[64:67], v[36:39], v[100:103]
    ds_read_b64_tr_b16 v[82:83], v11 offset:512
    s_waitcnt lgkmcnt(6)
    v_mfma_f32_16x16x32_bf16 v[104:107], v[68:71], v[24:27], v[104:107]
    ds_read_b64_tr_b16 v[64:65], v11 offset:8192
    v_mfma_f32_16x16x32_bf16 v[108:111], v[68:71], v[28:31], v[108:111]
    v_mfma_f32_16x16x32_bf16 v[112:115], v[68:71], v[32:35], v[112:115]
    ds_read_b64_tr_b16 v[66:67], v11 offset:8704
    v_mfma_f32_16x16x32_bf16 v[116:119], v[68:71], v[36:39], v[116:119]
    s_waitcnt lgkmcnt(6)
    v_mfma_f32_16x16x32_bf16 v[120:123], v[72:75], v[24:27], v[120:123]
    ds_read_b64_tr_b16 v[68:69], v12 offset:0
    v_mfma_f32_16x16x32_bf16 v[124:127], v[72:75], v[28:31], v[124:127]
    v_mfma_f32_16x16x32_bf16 v[128:131], v[72:75], v[32:35], v[128:131]
    ds_read_b64_tr_b16 v[70:71], v12 offset:512
    v_mfma_f32_16x16x32_bf16 v[132:135], v[72:75], v[36:39], v[132:135]
    s_waitcnt lgkmcnt(6)
    v_mfma_f32_16x16x32_bf16 v[136:139], v[76:79], v[24:27], v[136:139]
    ds_read_b64_tr_b16 v[72:73], v12 offset:8192
    v_mfma_f32_16x16x32_bf16 v[140:143], v[76:79], v[28:31], v[140:143]
    v_mfma_f32_16x16x32_bf16 v[144:147], v[76:79], v[32:35], v[144:147]
    ds_read_b64_tr_b16 v[74:75], v12 offset:8704
    v_mfma_f32_16x16x32_bf16 v[148:151], v[76:79], v[36:39], v[148:151]
    s_waitcnt lgkmcnt(6)
    v_mfma_f32_16x16x32_bf16 v[152:155], v[80:83], v[24:27], v[152:155]
    ds_read_b64_tr_b16 v[76:77], v13 offset:16384
    v_mfma_f32_16x16x32_bf16 v[156:159], v[80:83], v[28:31], v[156:159]
    v_mfma_f32_16x16x32_bf16 v[160:163], v[80:83], v[32:35], v[160:163]
    ds_read_b64_tr_b16 v[78:79], v13 offset:16640
    v_mfma_f32_16x16x32_bf16 v[164:167], v[80:83], v[36:39], v[164:167]
    s_waitcnt lgkmcnt(6)
    v_mfma_f32_16x16x32_bf16 v[168:171], v[64:67], v[24:27], v[168:171]
    ds_read_b64_tr_b16 v[80:81], v13 offset:18432
    v_mfma_f32_16x16x32_bf16 v[172:175], v[64:67], v[28:31], v[172:175]
    v_mfma_f32_16x16x32_bf16 v[176:179], v[64:67], v[32:35], v[176:179]
    ds_read_b64_tr_b16 v[82:83], v13 offset:18688
    v_mfma_f32_16x16x32_bf16 v[180:183], v[64:67], v[36:39], v[180:183]
    s_waitcnt lgkmcnt(6)
    v_mfma_f32_16x16x32_bf16 v[184:187], v[68:71], v[24:27], v[184:187]
    v_mfma_f32_16x16x32_bf16 v[188:191], v[68:71], v[28:31], v[188:191]
    v_mfma_f32_16x16x32_bf16 v[192:195], v[68:71], v[32:35], v[192:195]
    v_mfma_f32_16x16x32_bf16 v[196:199], v[68:71], v[36:39], v[196:199]
    s_waitcnt lgkmcnt(0)
    s_barrier
    v_mfma_f32_16x16x32_bf16 v[200:203], v[72:75], v[24:27], v[200:203]
    ds_read_b64_tr_b16 v[64:65], v9 offset:20480
    v_mfma_f32_16x16x32_bf16 v[204:207], v[72:75], v[28:31], v[204:207]
    ds_read_b64_tr_b16 v[66:67], v9 offset:20992
    v_mfma_f32_16x16x32_bf16 v[208:211], v[72:75], v[32:35], v[208:211]
    ds_read_b128 v[40:43], v15 offset:0
    v_mfma_f32_16x16x32_bf16 v[212:215], v[72:75], v[36:39], v[212:215]
    ds_read_b128 v[44:47], v15 offset:2048
    v_mfma_f32_16x16x32_bf16 v[216:219], v[76:79], v[24:27], v[216:219]
    ds_read_b128 v[48:51], v15 offset:4096
    v_mfma_f32_16x16x32_bf16 v[220:223], v[76:79], v[28:31], v[220:223]
    ds_read_b128 v[52:55], v15 offset:6144
    v_mfma_f32_16x16x32_bf16 v[224:227], v[76:79], v[32:35], v[224:227]
    ds_read_b64_tr_b16 v[68:69], v9 offset:28672
    v_mfma_f32_16x16x32_bf16 v[228:231], v[76:79], v[36:39], v[228:231]
    ds_read_b64_tr_b16 v[70:71], v9 offset:29184
    v_mfma_f32_16x16x32_bf16 v[232:235], v[80:83], v[24:27], v[232:235]
    ds_read_b64_tr_b16 v[72:73], v10 offset:20480
    v_mfma_f32_16x16x32_bf16 v[236:239], v[80:83], v[28:31], v[236:239]
    v_mfma_f32_16x16x32_bf16 v[240:243], v[80:83], v[32:35], v[240:243]
    ds_read_b64_tr_b16 v[74:75], v10 offset:20992
    v_mfma_f32_16x16x32_bf16 v[244:247], v[80:83], v[36:39], v[244:247]
    s_waitcnt lgkmcnt(7)
    v_mfma_f32_16x16x32_bf16 v[88:91], v[64:67], v[40:43], v[88:91]
    ds_read_b64_tr_b16 v[76:77], v10 offset:28672
    s_waitcnt lgkmcnt(7)
    v_mfma_f32_16x16x32_bf16 v[92:95], v[64:67], v[44:47], v[92:95]
    ds_read_b64_tr_b16 v[78:79], v10 offset:29184
    s_waitcnt lgkmcnt(7)
    v_mfma_f32_16x16x32_bf16 v[96:99], v[64:67], v[48:51], v[96:99]
    ds_read_b64_tr_b16 v[80:81], v11 offset:20480
    s_waitcnt lgkmcnt(7)
    v_mfma_f32_16x16x32_bf16 v[100:103], v[64:67], v[52:55], v[100:103]
    ds_read_b64_tr_b16 v[82:83], v11 offset:20992
    s_waitcnt lgkmcnt(6)
    v_mfma_f32_16x16x32_bf16 v[104:107], v[68:71], v[40:43], v[104:107]
    ds_read_b64_tr_b16 v[64:65], v11 offset:28672
    v_mfma_f32_16x16x32_bf16 v[108:111], v[68:71], v[44:47], v[108:111]
    v_add_u32 v14, s80, v16
    v_mfma_f32_16x16x32_bf16 v[112:115], v[68:71], v[48:51], v[112:115]
    ds_read_b64_tr_b16 v[66:67], v11 offset:29184
    v_mfma_f32_16x16x32_bf16 v[116:119], v[68:71], v[52:55], v[116:119]
    v_add_u32 v15, s80, v17
    s_waitcnt lgkmcnt(6)
    v_mfma_f32_16x16x32_bf16 v[120:123], v[72:75], v[40:43], v[120:123]
    ds_read_b64_tr_b16 v[68:69], v12 offset:20480
    v_mfma_f32_16x16x32_bf16 v[124:127], v[72:75], v[44:47], v[124:127]
    s_add_u32 s80, s80, 18432
    v_mfma_f32_16x16x32_bf16 v[128:131], v[72:75], v[48:51], v[128:131]
    ds_read_b64_tr_b16 v[70:71], v12 offset:20992
    v_mfma_f32_16x16x32_bf16 v[132:135], v[72:75], v[52:55], v[132:135]
    s_cmp_ge_u32 s80, 153600
    s_cselect_b32 s84, 55296, 0
    s_waitcnt lgkmcnt(6)
    v_mfma_f32_16x16x32_bf16 v[136:139], v[76:79], v[40:43], v[136:139]
    ds_read_b64_tr_b16 v[72:73], v12 offset:28672
    v_mfma_f32_16x16x32_bf16 v[140:143], v[76:79], v[44:47], v[140:143]
    s_sub_u32 s80, s80, s84
    v_mfma_f32_16x16x32_bf16 v[144:147], v[76:79], v[48:51], v[144:147]
    ds_read_b64_tr_b16 v[74:75], v12 offset:29184
    v_mfma_f32_16x16x32_bf16 v[148:151], v[76:79], v[52:55], v[148:151]
    s_waitcnt lgkmcnt(6)
    v_mfma_f32_16x16x32_bf16 v[152:155], v[80:83], v[40:43], v[152:155]
    ds_read_b64_tr_b16 v[76:77], v13 offset:36864
    v_mfma_f32_16x16x32_bf16 v[156:159], v[80:83], v[44:47], v[156:159]
    v_mfma_f32_16x16x32_bf16 v[160:163], v[80:83], v[48:51], v[160:163]
    ds_read_b64_tr_b16 v[78:79], v13 offset:37120
    v_mfma_f32_16x16x32_bf16 v[164:167], v[80:83], v[52:55], v[164:167]
    s_waitcnt lgkmcnt(6)
    v_mfma_f32_16x16x32_bf16 v[168:171], v[64:67], v[40:43], v[168:171]
    ds_read_b64_tr_b16 v[80:81], v13 offset:38912
    v_mfma_f32_16x16x32_bf16 v[172:175], v[64:67], v[44:47], v[172:175]
    v_mfma_f32_16x16x32_bf16 v[176:179], v[64:67], v[48:51], v[176:179]
    ds_read_b64_tr_b16 v[82:83], v13 offset:39168
    v_mfma_f32_16x16x32_bf16 v[180:183], v[64:67], v[52:55], v[180:183]
    s_waitcnt lgkmcnt(6)
    v_mfma_f32_16x16x32_bf16 v[184:187], v[68:71], v[40:43], v[184:187]
    v_mfma_f32_16x16x32_bf16 v[188:191], v[68:71], v[44:47], v[188:191]
    v_mfma_f32_16x16x32_bf16 v[192:195], v[68:71], v[48:51], v[192:195]
    v_mfma_f32_16x16x32_bf16 v[196:199], v[68:71], v[52:55], v[196:199]
    s_waitcnt lgkmcnt(0)
    s_barrier
    v_mfma_f32_16x16x32_bf16 v[200:203], v[72:75], v[40:43], v[200:203]
    ds_read_b64_tr_b16 v[64:65], v4 offset:0
    v_mfma_f32_16x16x32_bf16 v[204:207], v[72:75], v[44:47], v[204:207]
    ds_read_b64_tr_b16 v[66:67], v4 offset:512
    v_mfma_f32_16x16x32_bf16 v[208:211], v[72:75], v[48:51], v[208:211]
    ds_read_b128 v[24:27], v14 offset:0
    v_mfma_f32_16x16x32_bf16 v[212:215], v[72:75], v[52:55], v[212:215]
    ds_read_b128 v[28:31], v14 offset:2048
    v_mfma_f32_16x16x32_bf16 v[216:219], v[76:79], v[40:43], v[216:219]
    ds_read_b128 v[32:35], v14 offset:4096
    v_mfma_f32_16x16x32_bf16 v[220:223], v[76:79], v[44:47], v[220:223]
    ds_read_b128 v[36:39], v14 offset:6144
    v_mfma_f32_16x16x32_bf16 v[224:227], v[76:79], v[48:51], v[224:227]
    ds_read_b64_tr_b16 v[68:69], v4 offset:8192
    v_mfma_f32_16x16x32_bf16 v[228:231], v[76:79], v[52:55], v[228:231]
    ds_read_b64_tr_b16 v[70:71], v4 offset:8704
    v_mfma_f32_16x16x32_bf16 v[232:235], v[80:83], v[40:43], v[232:235]
    ds_read_b64_tr_b16 v[72:73], v5 offset:0
    v_mfma_f32_16x16x32_bf16 v[236:239], v[80:83], v[44:47], v[236:239]
    v_mfma_f32_16x16x32_bf16 v[240:243], v[80:83], v[48:51], v[240:243]
    ds_read_b64_tr_b16 v[74:75], v5 offset:512
    v_mfma_f32_16x16x32_bf16 v[244:247], v[80:83], v[52:55], v[244:247]
    s_sub_u32 s34, s34, 1
    s_cmp_lg_u32 s34, 0
    s_cbranch_scc1 L_p1
    s_waitcnt lgkmcnt(7)
    v_mfma_f32_16x16x32_bf16 v[88:91], v[64:67], v[24:27], v[88:91]
    ds_read_b64_tr_b16 v[76:77], v5 offset:8192
    s_waitcnt lgkmcnt(7)
    v_mfma_f32_16x16x32_bf16 v[92:95], v[64:67], v[28:31], v[92:95]
    ds_read_b64_tr_b16 v[78:79], v5 offset:8704
    s_waitcnt lgkmcnt(7)
    v_mfma_f32_16x16x32_bf16 v[96:99], v[64:67], v[32:35], v[96:99]
    ds_read_b64_tr_b16 v[80:81], v6 offset:0
    s_waitcnt lgkmcnt(7)
    v_mfma_f32_16x16x32_bf16 v[100:103], v[64:67], v[36:39], v[100:103]
    ds_read_b64_tr_b16 v[82:83], v6 offset:512
    s_waitcnt lgkmcnt(6)
    v_mfma_f32_16x16x32_bf16 v[104:107], v[68:71], v[24:27], v[104:107]
    ds_read_b64_tr_b16 v[64:65], v6 offset:8192
    v_mfma_f32_16x16x32_bf16 v[108:111], v[68:71], v[28:31], v[108:111]
    v_mfma_f32_16x16x32_bf16 v[112:115], v[68:71], v[32:35], v[112:115]
    ds_read_b64_tr_b16 v[66:67], v6 offset:8704
    v_mfma_f32_16x16x32_bf16 v[116:119], v[68:71], v[36:39], v[116:119]
    s_waitcnt lgkmcnt(6)
    v_mfma_f32_16x16x32_bf16 v[120:123], v[72:75], v[24:27], v[120:123]
    ds_read_b64_tr_b16 v[68:69], v7 offset:0
    v_mfma_f32_16x16x32_bf16 v[124:127], v[72:75], v[28:31], v[124:127]
    v_mfma_f32_16x16x32_bf16 v[128:131], v[72:75], v[32:35], v[128:131]
    ds_read_b64_tr_b16 v[70:71], v7 offset:512
    v_mfma_f32_16x16x32_bf16 v[132:135], v[72:75], v[36:39], v[132:135]
    s_waitcnt lgkmcnt(6)
    v_mfma_f32_16x16x32_bf16 v[136:139], v[76:79], v[24:27], v[136:139]
    ds_read_b64_tr_b16 v[72:73], v7 offset:8192
    v_mfma_f32_16x16x32_bf16 v[140:143], v[76:79], v[28:31], v[140:143]
    v_mfma_f32_16x16x32_bf16 v[144:147], v[76:79], v[32:35], v[144:147]
    ds_read_b64_tr_b16 v[74:75], v7 offset:8704
    v_mfma_f32_16x16x32_bf16 v[148:151], v[76:79], v[36:39], v[148:151]
    s_waitcnt lgkmcnt(6)
    v_mfma_f32_16x16x32_bf16 v[152:155], v[80:83], v[24:27], v[152:155]
    ds_read_b64_tr_b16 v[76:77], v8 offset:16384
    v_mfma_f32_16x16x32_bf16 v[156:159], v[80:83], v[28:31], v[156:159]
    v_mfma_f32_16x16x32_bf16 v[160:163], v[80:83], v[32:35], v[160:163]
    ds_read_b64_tr_b16 v[78:79], v8 offset:16640
    v_mfma_f32_16x16x32_bf16 v[164:167], v[80:83], v[36:39], v[164:167]
    s_waitcnt lgkmcnt(6)
    v_mfma_f32_16x16x32_bf16 v[168:171], v[64:67], v[24:27], v[168:171]
    ds_read_b64_tr_b16 v[80:81], v8 offset:18432
    v_mfma_f32_16x16x32_bf16 v[172:175], v[64:67], v[28:31], v[172:175]
    v_mfma_f32_16x16x32_bf16 v[176:179], v[64:67], v[32:35], v[176:179]
    ds_read_b64_tr_b16 v[82:83], v8 offset:18688
    v_mfma_f32_16x16x32_bf16 v[180:183], v[64:67], v[36:39], v[180:183]
    s_waitcnt lgkmcnt(6)
    v_mfma_f32_16x16x32_bf16 v[184:187], v[68:71], v[24:27], v[184:187]
    v_mfma_f32_16x16x32_bf16 v[188:191], v[68:71], v[28:31], v[188:191]
    v_mfma_f32_16x16x32_bf16 v[192:195], v[68:71], v[32:35], v[192:195]
    v_mfma_f32_16x16x32_bf16 v[196:199], v[68:71], v[36:39], v[196:199]
    s_waitcnt lgkmcnt(0)
    s_barrier
    v_mfma_f32_16x16x32_bf16 v[200:203], v[72:75], v[24:27], v[200:203]
    ds_read_b64_tr_b16 v[64:65], v4 offset:20480
    v_mfma_f32_16x16x32_bf16 v[204:207], v[72:75], v[28:31], v[204:207]
    ds_read_b64_tr_b16 v[66:67], v4 offset:20992
    v_mfma_f32_16x16x32_bf16 v[208:211], v[72:75], v[32:35], v[208:211]
    ds_read_b128 v[40:43], v15 offset:0
L_pad0:
    s_cbranch_execz L_vret0
    v_mfma_f32_16x16x32_bf16 v[212:215], v[72:75], v[36:39], v[212:215]
    ds_read_b128 v[44:47], v15 offset:2048
    v_mfma_f32_16x16x32_bf16 v[216:219], v[76:79], v[24:27], v[216:219]
    ds_read_b128 v[48:51], v15 offset:4096
    v_mfma_f32_16x16x32_bf16 v[220:223], v[76:79], v[28:31], v[220:223]
    ds_read_b128 v[52:55], v15 offset:6144
    v_mfma_f32_16x16x32_bf16 v[224:227], v[76:79], v[32:35], v[224:227]
    ds_read_b64_tr_b16 v[68:69], v4 offset:28672
    v_mfma_f32_16x16x32_bf16 v[228:231], v[76:79], v[36:39], v[228:231]
    ds_read_b64_tr_b16 v[70:71], v4 offset:29184
    v_mfma_f32_16x16x32_bf16 v[232:235], v[80:83], v[24:27], v[232:235]
    ds_read_b64_tr_b16 v[72:73], v5 offset:20480
    v_mfma_f32_16x16x32_bf16 v[236:239], v[80:83], v[28:31], v[236:239]
    v_mfma_f32_16x16x32_bf16 v[240:243], v[80:83], v[32:35], v[240:243]
    ds_read_b64_tr_b16 v[74:75], v5 offset:20992
    v_mfma_f32_16x16x32_bf16 v[244:247], v[80:83], v[36:39], v[244:247]
    s_waitcnt lgkmcnt(7)
    v_mfma_f32_16x16x32_bf16 v[88:91], v[64:67], v[40:43], v[88:91]
    ds_read_b64_tr_b16 v[76:77], v5 offset:28672
    s_waitcnt lgkmcnt(7)
    v_mfma_f32_16x16x32_bf16 v[92:95], v[64:67], v[44:47], v[92:95]
    ds_read_b64_tr_b16 v[78:79], v5 offset:29184
    s_waitcnt lgkmcnt(7)
    v_mfma_f32_16x16x32_bf16 v[96:99], v[64:67], v[48:51], v[96:99]
    ds_read_b64_tr_b16 v[80:81], v6 offset:20480
    s_waitcnt lgkmcnt(7)
    v_mfma_f32_16x16x32_bf16 v[100:103], v[64:67], v[52:55], v[100:103]
    ds_read_b64_tr_b16 v[82:83], v6 offset:20992
    s_waitcnt lgkmcnt(6)
    v_mfma_f32_16x16x32_bf16 v[104:107], v[68:71], v[40:43], v[104:107]
    ds_read_b64_tr_b16 v[64:65], v6 offset:28672
    v_mfma_f32_16x16x32_bf16 v[108:111], v[68:71], v[44:47], v[108:111]
    v_add_u32 v14, s80, v16
    v_mfma_f32_16x16x32_bf16 v[112:115], v[68:71], v[48:51], v[112:115]
    ds_read_b64_tr_b16 v[66:67], v6 offset:29184
    v_mfma_f32_16x16x32_bf16 v[116:119], v[68:71], v[52:55], v[116:119]
    v_add_u32 v15, s80, v17
    s_waitcnt lgkmcnt(6)
    v_mfma_f32_16x16x32_bf16 v[120:123], v[72:75], v[40:43], v[120:123]
    ds_read_b64_tr_b16 v[68:69], v7 offset:20480
    v_mfma_f32_16x16x32_bf16 v[124:127], v[72:75], v[44:47], v[124:127]
    s_add_u32 s80, s80, 18432
    v_mfma_f32_16x16x32_bf16 v[128:131], v[72:75], v[48:51], v[128:131]
    ds_read_b64_tr_b16 v[70:71], v7 offset:20992
    v_mfma_f32_16x16x32_bf16 v[132:135], v[72:75], v[52:55], v[132:135]
    s_cmp_ge_u32 s80, 153600
    s_cselect_b32 s84, 55296, 0
    s_waitcnt lgkmcnt(6)
    v_mfma_f32_16x16x32_bf16 v[136:139], v[76:79], v[40:43], v[136:139]
    ds_read_b64_tr_b16 v[72:73], v7 offset:28672
    v_mfma_f32_16x16x32_bf16 v[140:143], v[76:79], v[44:47], v[140:143]
    s_sub_u32 s80, s80, s84
    v_mfma_f32_16x16x32_bf16 v[144:147], v[76:79], v[48:51], v[144:147]
    ds_read_b64_tr_b16 v[74:75], v7 offset:29184
    v_mfma_f32_16x16x32_bf16 v[148:151], v[76:79], v[52:55], v[148:151]
    s_waitcnt lgkmcnt(6)
    v_mfma_f32_16x16x32_bf16 v[152:155], v[80:83], v[40:43], v[152:155]
    ds_read_b64_tr_b16 v[76:77], v8 offset:36864
    v_mfma_f32_16x16x32_bf16 v[156:159], v[80:83], v[44:47], v[156:159]
    v_mfma_f32_16x16x32_bf16 v[160:163], v[80:83], v[48:51], v[160:163]
    ds_read_b64_tr_b16 v[78:79], v8 offset:37120
    v_mfma_f32_16x16x32_bf16 v[164:167], v[80:83], v[52:55], v[164:167]
    s_waitcnt lgkmcnt(6)
    v_mfma_f32_16x16x32_bf16 v[168:171], v[64:67], v[40:43], v[168:171]
    ds_read_b64_tr_b16 v[80:81], v8 offset:38912
    v_mfma_f32_16x16x32_bf16 v[172:175], v[64:67], v[44:47], v[172:175]
    v_mfma_f32_16x16x32_bf16 v[176:179], v[64:67], v[48:51], v[176:179]
    ds_read_b64_tr_b16 v[82:83], v8 offset:39168
    v_mfma_f32_16x16x32_bf16 v[180:183], v[64:67], v[52:55], v[180:183]
    s_waitcnt lgkmcnt(6)
    v_mfma_f32_16x16x32_bf16 v[184:187], v[68:71], v[40:43], v[184:187]
    v_mfma_f32_16x16x32_bf16 v[188:191], v[68:71], v[44:47], v[188:191]
    v_mfma_f32_16x16x32_bf16 v[192:195], v[68:71], v[48:51], v[192:195]
    v_mfma_f32_16x16x32_bf16 v[196:199], v[68:71], v[52:55], v[196:199]
    s_waitcnt lgkmcnt(0)
    s_barrier
    v_mfma_f32_16x16x32_bf16 v[200:203], v[72:75], v[40:43], v[200:203]
    ds_read_b64_tr_b16 v[64:65], v9 offset:0
    v_mfma_f32_16x16x32_bf16 v[204:207], v[72:75], v[44:47], v[204:207]
    ds_read_b64_tr_b16 v[66:67], v9 offset:512
    v_mfma_f32_16x16x32_bf16 v[208:211], v[72:75], v[48:51], v[208:211]
    ds_read_b128 v[24:27], v14 offset:0
    v_mfma_f32_16x16x32_bf16 v[212:215], v[72:75], v[52:55], v[212:215]
    ds_read_b128 v[28:31], v14 offset:2048
    v_mfma_f32_16x16x32_bf16 v[216:219], v[76:79], v[40:43], v[216:219]
    ds_read_b128 v[32:35], v14 offset:4096
    v_mfma_f32_16x16x32_bf16 v[220:223], v[76:79], v[44:47], v[220:223]
    ds_read_b128 v[36:39], v14 offset:6144
    v_mfma_f32_16x16x32_bf16 v[224:227], v[76:79], v[48:51], v[224:227]
    ds_read_b64_tr_b16 v[68:69], v9 offset:8192
    v_mfma_f32_16x16x32_bf16 v[228:231], v[76:79], v[52:55], v[228:231]
    ds_read_b64_tr_b16 v[70:71], v9 offset:8704
    v_mfma_f32_16x16x32_bf16 v[232:235], v[80:83], v[40:43], v[232:235]
    ds_read_b64_tr_b16 v[72:73], v10 offset:0
    v_mfma_f32_16x16x32_bf16 v[236:239], v[80:83], v[44:47], v[236:239]
    v_mfma_f32_16x16x32_bf16 v[240:243], v[80:83], v[48:51], v[240:243]
    ds_read_b64_tr_b16 v[74:75], v10 offset:512
    v_mfma_f32_16x16x32_bf16 v[244:247], v[80:83], v[52:55], v[244:247]
    s_waitcnt lgkmcnt(7)
    v_mfma_f32_16x16x32_bf16 v[88:91], v[64:67], v[24:27], v[88:91]
    ds_read_b64_tr_b16 v[76:77], v10 offset:8192
    s_waitcnt lgkmcnt(7)
    v_mfma_f32_16x16x32_bf16 v[92:95], v[64:67], v[28:31], v[92:95]
    ds_read_b64_tr_b16 v[78:79], v10 offset:8704
    s_waitcnt lgkmcnt(7)
    v_mfma_f32_16x16x32_bf16 v[96:99], v[64:67], v[32:35], v[96:99]
    ds_read_b64_tr_b16 v[80:81], v11 offset:0
    s_waitcnt lgkmcnt(7)
    v_mfma_f32_16x16x32_bf16 v[100:103], v[64:67], v[36:39], v[100:103]
    ds_read_b64_tr_b16 v[82:83], v11 offset:512
    s_waitcnt lgkmcnt(6)
    v_mfma_f32_16x16x32_bf16 v[104:107], v[68:71], v[24:27], v[104:107]
    ds_read_b64_tr_b16 v[64:65], v11 offset:8192
    v_mfma_f32_16x16x32_bf16 v[108:111], v[68:71], v[28:31], v[108:111]
    v_mfma_f32_16x16x32_bf16 v[112:115], v[68:71], v[32:35], v[112:115]
    ds_read_b64_tr_b16 v[66:67], v11 offset:8704
    v_mfma_f32_16x16x32_bf16 v[116:119], v[68:71], v[36:39], v[116:119]
    s_waitcnt lgkmcnt(6)
    v_mfma_f32_16x16x32_bf16 v[120:123], v[72:75], v[24:27], v[120:123]
    ds_read_b64_tr_b16 v[68:69], v12 offset:0
    v_mfma_f32_16x16x32_bf16 v[124:127], v[72:75], v[28:31], v[124:127]
    v_mfma_f32_16x16x32_bf16 v[128:131], v[72:75], v[32:35], v[128:131]
    ds_read_b64_tr_b16 v[70:71], v12 offset:512
    v_mfma_f32_16x16x32_bf16 v[132:135], v[72:75], v[36:39], v[132:135]
    s_waitcnt lgkmcnt(6)
    v_mfma_f32_16x16x32_bf16 v[136:139], v[76:79], v[24:27], v[136:139]
    ds_read_b64_tr_b16 v[72:73], v12 offset:8192
    v_mfma_f32_16x16x32_bf16 v[140:143], v[76:79], v[28:31], v[140:143]
    v_mfma_f32_16x16x32_bf16 v[144:147], v[76:79], v[32:35], v[144:147]
    ds_read_b64_tr_b16 v[74:75], v12 offset:8704
    v_mfma_f32_16x16x32_bf16 v[148:151], v[76:79], v[36:39], v[148:151]
    s_waitcnt lgkmcnt(6)
    v_mfma_f32_16x16x32_bf16 v[152:155], v[80:83], v[24:27], v[152:155]
    ds_read_b64_tr_b16 v[76:77], v13 offset:16384
    v_mfma_f32_16x16x32_bf16 v[156:159], v[80:83], v[28:31], v[156:159]
    v_mfma_f32_16x16x32_bf16 v[160:163], v[80:83], v[32:35], v[160:163]
    ds_read_b64_tr_b16 v[78:79], v13 offset:16640
    v_mfma_f32_16x16x32_bf16 v[164:167], v[80:83], v[36:39], v[164:167]
    s_waitcnt lgkmcnt(6)
    v_mfma_f32_16x16x32_bf16 v[168:171], v[64:67], v[24:27], v[168:171]
    ds_read_b64_tr_b16 v[80:81], v13 offset:18432
    v_mfma_f32_16x16x32_bf16 v[172:175], v[64:67], v[28:31], v[172:175]
    v_mfma_f32_16x16x32_bf16 v[176:179], v[64:67], v[32:35], v[176:179]
    ds_read_b64_tr_b16 v[82:83], v13 offset:18688
    v_mfma_f32_16x16x32_bf16 v[180:183], v[64:67], v[36:39], v[180:183]
    s_waitcnt lgkmcnt(6)
    v_mfma_f32_16x16x32_bf16 v[184:187], v[68:71], v[24:27], v[184:187]
    v_mfma_f32_16x16x32_bf16 v[188:191], v[68:71], v[28:31], v[188:191]
    v_mfma_f32_16x16x32_bf16 v[192:195], v[68:71], v[32:35], v[192:195]
    v_mfma_f32_16x16x32_bf16 v[196:199], v[68:71], v[36:39], v[196:199]
    s_waitcnt lgkmcnt(0)
    s_barrier
    v_mfma_f32_16x16x32_bf16 v[200:203], v[72:75], v[24:27], v[200:203]
    ds_read_b64_tr_b16 v[64:65], v9 offset:20480
    v_mfma_f32_16x16x32_bf16 v[204:207], v[72:75], v[28:31], v[204:207]
    ds_read_b64_tr_b16 v[66:67], v9 offset:20992
    v_mfma_f32_16x16x32_bf16 v[208:211], v[72:75], v[32:35], v[208:211]
    ds_read_b128 v[40:43], v15 offset:0
    v_mfma_f32_16x16x32_bf16 v[212:215], v[72:75], v[36:39], v[212:215]
    ds_read_b128 v[44:47], v15 offset:2048
    v_mfma_f32_16x16x32_bf16 v[216:219], v[76:79], v[24:27], v[216:219]
    ds_read_b128 v[48:51], v15 offset:4096
    v_mfma_f32_16x16x32_bf16 v[220:223], v[76:79], v[28:31], v[220:223]
    ds_read_b128 v[52:55], v15 offset:6144
    v_mfma_f32_16x16x32_bf16 v[224:227], v[76:79], v[32:35], v[224:227]
    ds_read_b64_tr_b16 v[68:69], v9 offset:28672
    v_mfma_f32_16x16x32_bf16 v[228:231], v[76:79], v[36:39], v[228:231]
    ds_read_b64_tr_b16 v[70:71], v9 offset:29184
    v_mfma_f32_16x16x32_bf16 v[232:235], v[80:83], v[24:27], v[232:235]
    ds_read_b64_tr_b16 v[72:73], v10 offset:20480
    v_mfma_f32_16x16x32_bf16 v[236:239], v[80:83], v[28:31], v[236:239]
    v_mfma_f32_16x16x32_bf16 v[240:243], v[80:83], v[32:35], v[240:243]
    ds_read_b64_tr_b16 v[74:75], v10 offset:20992
    v_mfma_f32_16x16x32_bf16 v[244:247], v[80:83], v[36:39], v[244:247]
    s_waitcnt lgkmcnt(7)
    v_mfma_f32_16x16x32_bf16 v[88:91], v[64:67], v[40:43], v[88:91]
    ds_read_b64_tr_b16 v[76:77], v10 offset:28672
    s_waitcnt lgkmcnt(7)
    v_mfma_f32_16x16x32_bf16 v[92:95], v[64:67], v[44:47], v[92:95]
    ds_read_b64_tr_b16 v[78:79], v10 offset:29184
    s_waitcnt lgkmcnt(7)
    v_mfma_f32_16x16x32_bf16 v[96:99], v[64:67], v[48:51], v[96:99]
    ds_read_b64_tr_b16 v[80:81], v11 offset:20480
    s_waitcnt lgkmcnt(7)
    v_mfma_f32_16x16x32_bf16 v[100:103], v[64:67], v[52:55], v[100:103]
    ds_read_b64_tr_b16 v[82:83], v11 offset:20992
    s_waitcnt lgkmcnt(6)
    v_mfma_f32_16x16x32_bf16 v[104:107], v[68:71], v[40:43], v[104:107]
    ds_read_b64_tr_b16 v[64:65], v11 offset:28672
    v_mfma_f32_16x16x32_bf16 v[108:111], v[68:71], v[44:47], v[108:111]
    v_mfma_f32_16x16x32_bf16 v[112:115], v[68:71], v[48:51], v[112:115]
    ds_read_b64_tr_b16 v[66:67], v11 offset:29184
    v_mfma_f32_16x16x32_bf16 v[116:119], v[68:71], v[52:55], v[116:119]
    s_waitcnt lgkmcnt(6)
    v_mfma_f32_16x16x32_bf16 v[120:123], v[72:75], v[40:43], v[120:123]
    ds_read_b64_tr_b16 v[68:69], v12 offset:20480
    v_mfma_f32_16x16x32_bf16 v[124:127], v[72:75], v[44:47], v[124:127]
    v_mfma_f32_16x16x32_bf16 v[128:131], v[72:75], v[48:51], v[128:131]
    ds_read_b64_tr_b16 v[70:71], v12 offset:20992
    v_mfma_f32_16x16x32_bf16 v[132:135], v[72:75], v[52:55], v[132:135]
    s_waitcnt lgkmcnt(6)
    v_mfma_f32_16x16x32_bf16 v[136:139], v[76:79], v[40:43], v[136:139]
    ds_read_b64_tr_b16 v[72:73], v12 offset:28672
    v_mfma_f32_16x16x32_bf16 v[140:143], v[76:79], v[44:47], v[140:143]
    v_mfma_f32_16x16x32_bf16 v[144:147], v[76:79], v[48:51], v[144:147]
    ds_read_b64_tr_b16 v[74:75], v12 offset:29184
    v_mfma_f32_16x16x32_bf16 v[148:151], v[76:79], v[52:55], v[148:151]
    s_waitcnt lgkmcnt(6)
    v_mfma_f32_16x16x32_bf16 v[152:155], v[80:83], v[40:43], v[152:155]
    ds_read_b64_tr_b16 v[76:77], v13 offset:36864
    v_mfma_f32_16x16x32_bf16 v[156:159], v[80:83], v[44:47], v[156:159]
    v_mfma_f32_16x16x32_bf16 v[160:163], v[80:83], v[48:51], v[160:163]
    ds_read_b64_tr_b16 v[78:79], v13 offset:37120
    v_mfma_f32_16x16x32_bf16 v[164:167], v[80:83], v[52:55], v[164:167]
    s_waitcnt lgkmcnt(6)
    v_mfma_f32_16x16x32_bf16 v[168:171], v[64:67], v[40:43], v[168:171]
    ds_read_b64_tr_b16 v[80:81], v13 offset:38912
    v_mfma_f32_16x16x32_bf16 v[172:175], v[64:67], v[44:47], v[172:175]
    v_mfma_f32_16x16x32_bf16 v[176:179], v[64:67], v[48:51], v[176:179]
    ds_read_b64_tr_b16 v[82:83], v13 offset:39168
    v_mfma_f32_16x16x32_bf16 v[180:183], v[64:67], v[52:55], v[180:183]
    s_waitcnt lgkmcnt(6)
    v_mfma_f32_16x16x32_bf16 v[184:187], v[68:71], v[40:43], v[184:187]
    v_mfma_f32_16x16x32_bf16 v[188:191], v[68:71], v[44:47], v[188:191]
    v_mfma_f32_16x16x32_bf16 v[192:195], v[68:71], v[48:51], v[192:195]
    v_mfma_f32_16x16x32_bf16 v[196:199], v[68:71], v[52:55], v[196:199]
    s_waitcnt lgkmcnt(0)
    s_barrier
    v_mfma_f32_16x16x32_bf16 v[200:203], v[72:75], v[40:43], v[200:203]
    v_mfma_f32_16x16x32_bf16 v[204:207], v[72:75], v[44:47], v[204:207]
    v_mfma_f32_16x16x32_bf16 v[208:211], v[72:75], v[48:51], v[208:211]
    v_mfma_f32_16x16x32_bf16 v[212:215], v[72:75], v[52:55], v[212:215]
    v_mfma_f32_16x16x32_bf16 v[216:219], v[76:79], v[40:43], v[216:219]
    v_mfma_f32_16x16x32_bf16 v[220:223], v[76:79], v[44:47], v[220:223]
    v_mfma_f32_16x16x32_bf16 v[224:227], v[76:79], v[48:51], v[224:227]
    v_mfma_f32_16x16x32_bf16 v[228:231], v[76:79], v[52:55], v[228:231]
    v_mfma_f32_16x16x32_bf16 v[232:235], v[80:83], v[40:43], v[232:235]
    v_mfma_f32_16x16x32_bf16 v[236:239], v[80:83], v[44:47], v[236:239]
    v_mfma_f32_16x16x32_bf16 v[240:243], v[80:83], v[48:51], v[240:243]
    v_mfma_f32_16x16x32_bf16 v[244:247], v[80:83], v[52:55], v[244:247]
    s_setprio 0
    s_lshl_b32 s84, s5, 10
    s_add_u32 s84, s84, 161024
    v_and_b32 v16, 15, v1
    v_lshl_add_u32 v16, v16, 4, s84
    ds_read_b128 v[64:67], v16 offset:0
    ds_read_b128 v[68:71], v16 offset:256
    ds_read_b128 v[72:75], v16 offset:512
    ds_read_b128 v[76:79], v16 offset:768
    v_and_b32 v17, 48, v1
    s_lshl_b32 s84, s6, 8
    s_add_u32 s84, s84, 159744
    v_add_u32 v16, s84, v17
    s_lshl_b32 s84, s6, 6
    s_add_u32 s84, s84, 159744
    v_add_u32 v17, s84, v17
    ds_read_b128 v[24:27], v16 offset:0
    ds_read_b128 v[28:31], v16 offset:640
    ds_read_b128 v[32:35], v16 offset:64
    ds_read_b128 v[36:39], v16 offset:704
    ds_read_b128 v[40:43], v16 offset:128
    ds_read_b128 v[44:47], v16 offset:768
    ds_read_b128 v[48:51], v16 offset:192
    ds_read_b128 v[52:55], v16 offset:832
    ds_read_b128 v[56:59], v17 offset:512
    ds_read_b128 v[60:63], v17 offset:1152
    s_memrealtime s[92:93]
    s_memtime s[90:91]
    s_add_u32 m0, s79, 116736
    s_mov_b32 s78, 256
    buffer_load_dwordx4 v20, s[36:39], s78 offen sc1 lds
    s_waitcnt lgkmcnt(0)
    s_mov_b32 s34, s92
    s_mov_b32 s35, s90
    v_fmac_f32 v88, v24, v64
    v_fmac_f32 v89, v25, v64
    v_fmac_f32 v90, v26, v64
    v_fmac_f32 v91, v27, v64
    v_fmac_f32 v104, v28, v64
    v_fmac_f32 v105, v29, v64
    v_fmac_f32 v106, v30, v64
    v_fmac_f32 v107, v31, v64
    s_add_u32 m0, s79, 117760
    s_nop 0
    buffer_load_dwordx4 v21, s[36:39], s78 offen sc1 lds
    v_mul_f32 v80, v88, v88
    v_mul_f32 v81, v89, v89
    v_mul_f32 v82, v90, v90
    v_mul_f32 v83, v91, v91
    v_fma_f32 v80, v80, v66, v65
    v_fma_f32 v81, v81, v66, v65
    v_fma_f32 v82, v82, v66, v65
    v_fma_f32 v83, v83, v66, v65
    s_add_u32 m0, s33, 77824
    s_mov_b32 s76, 589824
    buffer_load_dwordx4 v23, s[40:43], s76 offen offset:0 lds
    v_mul_f32 v80, v80, v88
    v_mul_f32 v81, v81, v89
    v_mul_f32 v82, v82, v90
    v_mul_f32 v83, v83, v91
    v_exp_f32 v80, v80
    v_mul_f32 v88, v88, v104
    v_exp_f32 v81, v81
    s_add_u32 m0, s33, 79872
    s_nop 0
    buffer_load_dwordx4 v23, s[40:43], s76 offen offset:2048 lds
    v_mul_f32 v89, v89, v105
    v_exp_f32 v82, v82
    v_mul_f32 v90, v90, v106
    v_exp_f32 v83, v83
    v_mul_f32 v91, v91, v107
    v_fma_f32 v80, v80, v67, v67
    s_add_u32 m0, s33, 86016
    s_nop 0
    buffer_load_dwordx4 v23, s[44:47], s76 offen offset:0 lds
    v_fma_f32 v81, v81, v67, v67
    v_fma_f32 v82, v82, v67, v67
    v_fma_f32 v83, v83, v67, v67
    v_rcp_f32 v80, v80
    v_rcp_f32 v81, v81
    v_rcp_f32 v82, v82
    s_add_u32 m0, s33, 90112
    s_mov_b32 s77, 688128
    buffer_load_dwordx4 v22, s[48:51], s77 offen offset:0 lds
    v_rcp_f32 v83, v83
    s_nop 0
    v_mul_f32 v88, v88, v80
    v_mul_f32 v89, v89, v81
    v_mul_f32 v90, v90, v82
    v_mul_f32 v91, v91, v83
    v_cvt_pk_bf16_f32 v88, v88, v89
    v_cvt_pk_bf16_f32 v89, v90, v91
    s_add_u32 m0, s33, 94208
    s_nop 0
    buffer_load_dwordx4 v22, s[52:55], s77 offen offset:0 lds
    s_barrier
    s_add_u32 m0, s79, 118784
    s_mov_b32 s78, 33024
    buffer_load_dwordx4 v20, s[36:39], s78 offen sc1 lds
    v_fmac_f32 v92, v24, v68
    v_fmac_f32 v93, v25, v68
    v_fmac_f32 v94, v26, v68
    v_fmac_f32 v95, v27, v68
    v_fmac_f32 v108, v28, v68
    v_fmac_f32 v109, v29, v68
    v_fmac_f32 v110, v30, v68
    v_fmac_f32 v111, v31, v68
    s_add_u32 m0, s79, 119808
    s_nop 0
    buffer_load_dwordx4 v21, s[36:39], s78 offen sc1 lds
    v_mul_f32 v80, v92, v92
    v_mul_f32 v81, v93, v93
    v_mul_f32 v82, v94, v94
    v_mul_f32 v83, v95, v95
    v_fma_f32 v80, v80, v70, v69
    v_fma_f32 v81, v81, v70, v69
    v_fma_f32 v82, v82, v70, v69
    v_fma_f32 v83, v83, v70, v69
    s_add_u32 m0, s81, 133120
    s_mov_b32 s78, 256
    s_mov_b64 exec, 0xffffffff
    buffer_load_dwordx4 v3, s[36:39], s78 offen sc1 lds
    s_mov_b64 exec, -1
    v_mul_f32 v80, v80, v92
    v_mul_f32 v81, v81, v93
    v_mul_f32 v82, v82, v94
    v_mul_f32 v83, v83, v95
    v_exp_f32 v80, v80
    v_mul_f32 v92, v92, v108
    v_exp_f32 v81, v81
    s_add_u32 m0, s33, 16384
    s_mov_b32 s76, 786432
    buffer_load_dwordx4 v23, s[40:43], s76 offen offset:0 lds
    s_add_u32 m0, s33, 18432
    s_nop 0
    buffer_load_dwordx4 v23, s[40:43], s76 offen offset:2048 lds
    v_mul_f32 v93, v93, v109
    v_exp_f32 v82, v82
    v_mul_f32 v94, v94, v110
    v_exp_f32 v83, v83
    v_mul_f32 v95, v95, v111
    v_fma_f32 v80, v80, v71, v71
    s_add_u32 m0, s33, 24576
    s_nop 0
    buffer_load_dwordx4 v23, s[44:47], s76 offen offset:0 lds
    v_fma_f32 v81, v81, v71, v71
    v_fma_f32 v82, v82, v71, v71
    v_fma_f32 v83, v83, v71, v71
    v_rcp_f32 v80, v80
    v_rcp_f32 v81, v81
    v_rcp_f32 v82, v82
    s_add_u32 m0, s33, 28672
    s_mov_b32 s77, 917504
    buffer_load_dwordx4 v22, s[48:51], s77 offen offset:0 lds
    v_rcp_f32 v83, v83
    s_nop 0
    v_mul_f32 v92, v92, v80
    v_mul_f32 v93, v93, v81
    v_mul_f32 v94, v94, v82
    v_mul_f32 v95, v95, v83
    v_cvt_pk_bf16_f32 v90, v92, v93
    v_cvt_pk_bf16_f32 v91, v94, v95
    s_add_u32 m0, s33, 32768
    s_nop 0
    buffer_load_dwordx4 v22, s[52:55], s77 offen offset:0 lds
    s_add_u32 s75, s75, 0x300000
    s_load_dword s94, s[10:11], s75 offset:0x0
    s_load_dword s94, s[10:11], s75 offset:0x40
    s_load_dword s94, s[10:11], s75 offset:0x80
    s_load_dword s94, s[10:11], s75 offset:0xc0
    s_load_dword s94, s[10:11], s75 offset:0x100
    v_mov_b32 v5, 0
    s_mov_b64 exec, 1
    global_load_dwordx2 v[6:7], v5, s[24:25] sc1
    s_mov_b64 exec, -1
    s_barrier
    s_add_u32 m0, s79, 135168
    s_mov_b32 s78, 384
    buffer_load_dwordx4 v20, s[36:39], s78 offen sc1 lds
    s_nop 1
    v_permlane16_swap_b32 v88, v90
    v_permlane16_swap_b32 v89, v91
    v_fmac_f32 v96, v24, v72
    v_fmac_f32 v97, v25, v72
    v_fmac_f32 v98, v26, v72
    v_fmac_f32 v99, v27, v72
    v_fmac_f32 v112, v28, v72
    v_fmac_f32 v113, v29, v72
    v_fmac_f32 v114, v30, v72
    v_fmac_f32 v115, v31, v72
    s_add_u32 m0, s79, 136192
    s_nop 0
    buffer_load_dwordx4 v21, s[36:39], s78 offen sc1 lds
    v_mul_f32 v80, v96, v96
    v_mul_f32 v81, v97, v97
    v_mul_f32 v82, v98, v98
    v_mul_f32 v83, v99, v99
    v_fma_f32 v80, v80, v74, v73
    v_fma_f32 v81, v81, v74, v73
    v_fma_f32 v82, v82, v74, v73
    v_fma_f32 v83, v83, v74, v73
    s_add_u32 m0, s33, 36864
    s_mov_b32 s76, 983040
    buffer_load_dwordx4 v23, s[40:43], s76 offen offset:0 lds
    v_mul_f32 v80, v80, v96
    v_mul_f32 v81, v81, v97
    v_mul_f32 v82, v82, v98
    v_mul_f32 v83, v83, v99
    v_exp_f32 v80, v80
    v_mul_f32 v96, v96, v112
    v_exp_f32 v81, v81
    s_add_u32 m0, s33, 38912
    s_nop 0
    buffer_load_dwordx4 v23, s[40:43], s76 offen offset:2048 lds
    s_add_u32 m0, s33, 45056
    s_nop 0
    buffer_load_dwordx4 v23, s[44:47], s76 offen offset:0 lds
    v_mul_f32 v97, v97, v113
    v_exp_f32 v82, v82
    v_mul_f32 v98, v98, v114
    v_exp_f32 v83, v83
    v_mul_f32 v99, v99, v115
    v_fma_f32 v80, v80, v75, v75
    s_add_u32 m0, s33, 49152
    s_mov_b32 s77, 1146880
    buffer_load_dwordx4 v22, s[48:51], s77 offen offset:0 lds
    v_fma_f32 v81, v81, v75, v75
    v_fma_f32 v82, v82, v75, v75
    v_fma_f32 v83, v83, v75, v75
    v_rcp_f32 v80, v80
    v_rcp_f32 v81, v81
    v_rcp_f32 v82, v82
    s_add_u32 m0, s33, 53248
    s_nop 0
    buffer_load_dwordx4 v22, s[52:55], s77 offen offset:0 lds
    v_rcp_f32 v83, v83
    s_nop 0
    v_mul_f32 v96, v96, v80
    v_mul_f32 v97, v97, v81
    v_mul_f32 v98, v98, v82
    v_mul_f32 v99, v99, v83
    v_cvt_pk_bf16_f32 v96, v96, v97
    v_cvt_pk_bf16_f32 v97, v98, v99
    buffer_store_dwordx4 v[88:91], v19, s[68:71], s72 offen offset:0 sc1
    s_load_dword s94, s[10:11], s75 offset:0x140
    s_load_dword s94, s[10:11], s75 offset:0x180
    s_load_dword s94, s[10:11], s75 offset:0x1c0
    s_add_u32 s99, s99, 0x380000
    s_load_dword s94, s[16:17], s99 offset:0x0
    s_load_dword s94, s[16:17], s99 offset:0x40
    s_waitcnt vmcnt(17)
    s_barrier
    s_add_u32 m0, s79, 137216
    s_mov_b32 s78, 33152
    buffer_load_dwordx4 v20, s[36:39], s78 offen sc1 lds
    v_fmac_f32 v100, v24, v76
    v_fmac_f32 v101, v25, v76
    v_fmac_f32 v102, v26, v76
    v_fmac_f32 v103, v27, v76
    v_fmac_f32 v116, v28, v76
    v_fmac_f32 v117, v29, v76
    v_fmac_f32 v118, v30, v76
    v_fmac_f32 v119, v31, v76
    s_add_u32 m0, s79, 138240
    s_nop 0
    buffer_load_dwordx4 v21, s[36:39], s78 offen sc1 lds
    v_mul_f32 v80, v100, v100
    v_mul_f32 v81, v101, v101
    v_mul_f32 v82, v102, v102
    v_mul_f32 v83, v103, v103
    v_fma_f32 v80, v80, v78, v77
    v_fma_f32 v81, v81, v78, v77
    v_fma_f32 v82, v82, v78, v77
    v_fma_f32 v83, v83, v78, v77
    s_add_u32 m0, s81, 151552
    s_mov_b32 s78, 384
    s_mov_b64 exec, 0xffffffff
    buffer_load_dwordx4 v3, s[36:39], s78 offen sc1 lds
    s_mov_b64 exec, -1
    v_mul_f32 v80, v80, v100
    v_mul_f32 v81, v81, v101
    v_mul_f32 v82, v82, v102
    v_mul_f32 v83, v83, v103
    v_exp_f32 v80, v80
    v_mul_f32 v100, v100, v116
    v_exp_f32 v81, v81
    s_add_u32 m0, s33, 57344
    s_mov_b32 s76, 1179648
    buffer_load_dwordx4 v23, s[40:43], s76 offen offset:0 lds
    s_add_u32 m0, s33, 59392
    s_nop 0
    buffer_load_dwordx4 v23, s[40:43], s76 offen offset:2048 lds
    v_mul_f32 v101, v101, v117
    v_exp_f32 v82, v82
    v_mul_f32 v102, v102, v118
    v_exp_f32 v83, v83
    v_mul_f32 v103, v103, v119
    v_fma_f32 v80, v80, v79, v79
    s_add_u32 m0, s33, 65536
    s_nop 0
    buffer_load_dwordx4 v23, s[44:47], s76 offen offset:0 lds
    v_fma_f32 v81, v81, v79, v79
    v_fma_f32 v82, v82, v79, v79
    v_fma_f32 v83, v83, v79, v79
    v_rcp_f32 v80, v80
    v_rcp_f32 v81, v81
    v_rcp_f32 v82, v82
    s_add_u32 m0, s33, 69632
    s_mov_b32 s77, 1376256
    buffer_load_dwordx4 v22, s[48:51], s77 offen offset:0 lds
    v_rcp_f32 v83, v83
    s_nop 0
    v_mul_f32 v100, v100, v80
    v_mul_f32 v101, v101, v81
    v_mul_f32 v102, v102, v82
    v_mul_f32 v103, v103, v83
    v_cvt_pk_bf16_f32 v98, v100, v101
    v_cvt_pk_bf16_f32 v99, v102, v103
    s_add_u32 m0, s33, 73728
    s_nop 0
    buffer_load_dwordx4 v22, s[52:55], s77 offen offset:0 lds
    s_load_dword s94, s[16:17], s99 offset:0x80
    s_load_dword s94, s[16:17], s99 offset:0xc0
    s_load_dword s94, s[16:17], s99 offset:0x100
    s_load_dword s94, s[16:17], s99 offset:0x140
    s_load_dword s94, s[16:17], s99 offset:0x180
    s_waitcnt vmcnt(17)
    s_barrier
    s_add_u32 m0, s79, 98304
    s_mov_b32 s78, 512
    buffer_load_dwordx4 v20, s[36:39], s78 offen sc1 lds
    s_nop 1
    v_permlane16_swap_b32 v96, v98
    v_permlane16_swap_b32 v97, v99
    v_fmac_f32 v120, v32, v64
    v_fmac_f32 v121, v33, v64
    v_fmac_f32 v122, v34, v64
    v_fmac_f32 v123, v35, v64
    v_fmac_f32 v136, v36, v64
    v_fmac_f32 v137, v37, v64
    v_fmac_f32 v138, v38, v64
    v_fmac_f32 v139, v39, v64
    s_add_u32 m0, s79, 99328
    s_nop 0
    buffer_load_dwordx4 v21, s[36:39], s78 offen sc1 lds
    v_mul_f32 v80, v120, v120
    v_mul_f32 v81, v121, v121
    v_mul_f32 v82, v122, v122
    v_mul_f32 v83, v123, v123
    v_fma_f32 v80, v80, v66, v65
    v_fma_f32 v81, v81, v66, v65
    v_fma_f32 v82, v82, v66, v65
    v_fma_f32 v83, v83, v66, v65
    s_add_u32 m0, s33, 77824
    s_mov_b32 s76, 1376256
    buffer_load_dwordx4 v23, s[40:43], s76 offen offset:0 lds
    v_mul_f32 v80, v80, v120
    v_mul_f32 v81, v81, v121
    v_mul_f32 v82, v82, v122
    v_mul_f32 v83, v83, v123
    v_exp_f32 v80, v80
    v_mul_f32 v120, v120, v136
    v_exp_f32 v81, v81
    s_add_u32 m0, s33, 79872
    s_nop 0
    buffer_load_dwordx4 v23, s[40:43], s76 offen offset:2048 lds
    s_add_u32 m0, s33, 86016
    s_nop 0
    buffer_load_dwordx4 v23, s[44:47], s76 offen offset:0 lds
    v_mul_f32 v121, v121, v137
    v_exp_f32 v82, v82
    v_mul_f32 v122, v122, v138
    v_exp_f32 v83, v83
    v_mul_f32 v123, v123, v139
    v_fma_f32 v80, v80, v67, v67
    s_add_u32 m0, s33, 90112
    s_mov_b32 s77, 1605632
    buffer_load_dwordx4 v22, s[48:51], s77 offen offset:0 lds
    v_fma_f32 v81, v81, v67, v67
    v_fma_f32 v82, v82, v67, v67
    v_fma_f32 v83, v83, v67, v67
    v_rcp_f32 v80, v80
    v_rcp_f32 v81, v81
    v_rcp_f32 v82, v82
    s_add_u32 m0, s33, 94208
    s_nop 0
    buffer_load_dwordx4 v22, s[52:55], s77 offen offset:0 lds
    v_rcp_f32 v83, v83
    s_nop 0
    v_mul_f32 v120, v120, v80
    v_mul_f32 v121, v121, v81
    v_mul_f32 v122, v122, v82
    v_mul_f32 v123, v123, v83
    v_cvt_pk_bf16_f32 v120, v120, v121
    v_cvt_pk_bf16_f32 v121, v122, v123
    buffer_store_dwordx4 v[96:99], v19, s[68:71], s72 offen offset:2048 sc1
    s_load_dword s94, s[16:17], s99 offset:0x1c0
L_pad1:
    s_cbranch_execz L_vret1
    s_load_dword s94, s[18:19], s99 offset:0x0
    s_load_dword s94, s[18:19], s99 offset:0x40
    s_load_dword s94, s[18:19], s99 offset:0x80
    s_load_dword s94, s[18:19], s99 offset:0xc0
    s_waitcnt vmcnt(17)
    s_barrier
    s_add_u32 m0, s79, 100352
    s_mov_b32 s78, 33280
    buffer_load_dwordx4 v20, s[36:39], s78 offen sc1 lds
    v_fmac_f32 v124, v32, v68
    v_fmac_f32 v125, v33, v68
    v_fmac_f32 v126, v34, v68
    v_fmac_f32 v127, v35, v68
    v_fmac_f32 v140, v36, v68
    v_fmac_f32 v141, v37, v68
    v_fmac_f32 v142, v38, v68
    v_fmac_f32 v143, v39, v68
    s_add_u32 m0, s79, 101376
    s_nop 0
    buffer_load_dwordx4 v21, s[36:39], s78 offen sc1 lds
    v_mul_f32 v80, v124, v124
    v_mul_f32 v81, v125, v125
    v_mul_f32 v82, v126, v126
    v_mul_f32 v83, v127, v127
    v_fma_f32 v80, v80, v70, v69
    v_fma_f32 v81, v81, v70, v69
    v_fma_f32 v82, v82, v70, v69
    v_fma_f32 v83, v83, v70, v69
    s_add_u32 m0, s81, 114688
    s_mov_b32 s78, 512
    s_mov_b64 exec, 0xffffffff
    buffer_load_dwordx4 v3, s[36:39], s78 offen sc1 lds
    s_mov_b64 exec, -1
    v_mul_f32 v80, v80, v124
    v_mul_f32 v81, v81, v125
    v_mul_f32 v82, v82, v126
    v_mul_f32 v83, v83, v127
    v_exp_f32 v80, v80
    v_mul_f32 v124, v124, v140
    v_exp_f32 v81, v81
    s_add_u32 m0, s33, 16384
    s_mov_b32 s76, 1572864
    buffer_load_dwordx4 v23, s[40:43], s76 offen offset:0 lds
    s_add_u32 m0, s33, 18432
    s_nop 0
    buffer_load_dwordx4 v23, s[40:43], s76 offen offset:2048 lds
    v_mul_f32 v125, v125, v141
    v_exp_f32 v82, v82
    v_mul_f32 v126, v126, v142
    v_exp_f32 v83, v83
    v_mul_f32 v127, v127, v143
    v_fma_f32 v80, v80, v71, v71
    s_add_u32 m0, s33, 24576
    s_nop 0
    buffer_load_dwordx4 v23, s[44:47], s76 offen offset:0 lds
    v_fma_f32 v81, v81, v71, v71
    v_fma_f32 v82, v82, v71, v71
    v_fma_f32 v83, v83, v71, v71
    v_rcp_f32 v80, v80
    v_rcp_f32 v81, v81
    v_rcp_f32 v82, v82
    s_add_u32 m0, s33, 28672
    s_mov_b32 s77, 1835008
    buffer_load_dwordx4 v22, s[48:51], s77 offen offset:0 lds
    v_rcp_f32 v83, v83
    s_nop 0
    v_mul_f32 v124, v124, v80
    v_mul_f32 v125, v125, v81
    v_mul_f32 v126, v126, v82
    v_mul_f32 v127, v127, v83
    v_cvt_pk_bf16_f32 v122, v124, v125
    v_cvt_pk_bf16_f32 v123, v126, v127
    s_add_u32 m0, s33, 32768
    s_nop 0
    buffer_load_dwordx4 v22, s[52:55], s77 offen offset:0 lds
    s_load_dword s94, s[18:19], s99 offset:0x100
    s_load_dword s94, s[18:19], s99 offset:0x140
    s_load_dword s94, s[18:19], s99 offset:0x180
    s_load_dword s94, s[18:19], s99 offset:0x1c0
    s_load_dword s94, s[10:11], s75 offset:0x80000
    s_waitcnt vmcnt(16)
    s_barrier
    s_add_u32 m0, s79, 116736
    s_mov_b32 s78, 640
    buffer_load_dwordx4 v20, s[36:39], s78 offen sc1 lds
    s_nop 1
    v_permlane16_swap_b32 v120, v122
    v_permlane16_swap_b32 v121, v123
    v_fmac_f32 v128, v32, v72
    v_fmac_f32 v129, v33, v72
    v_fmac_f32 v130, v34, v72
    v_fmac_f32 v131, v35, v72
    v_fmac_f32 v144, v36, v72
    v_fmac_f32 v145, v37, v72
    v_fmac_f32 v146, v38, v72
    v_fmac_f32 v147, v39, v72
    s_add_u32 m0, s79, 117760
    s_nop 0
    buffer_load_dwordx4 v21, s[36:39], s78 offen sc1 lds
    v_mul_f32 v80, v128, v128
    v_mul_f32 v81, v129, v129
    v_mul_f32 v82, v130, v130
    v_mul_f32 v83, v131, v131
    v_fma_f32 v80, v80, v74, v73
    v_fma_f32 v81, v81, v74, v73
    v_fma_f32 v82, v82, v74, v73
    v_fma_f32 v83, v83, v74, v73
    s_add_u32 m0, s33, 36864
    s_mov_b32 s76, 1769472
    buffer_load_dwordx4 v23, s[40:43], s76 offen offset:0 lds
    v_mul_f32 v80, v80, v128
    v_mul_f32 v81, v81, v129
    v_mul_f32 v82, v82, v130
    v_mul_f32 v83, v83, v131
    v_exp_f32 v80, v80
    v_mul_f32 v128, v128, v144
    v_exp_f32 v81, v81
    s_add_u32 m0, s33, 38912
    s_nop 0
    buffer_load_dwordx4 v23, s[40:43], s76 offen offset:2048 lds
    s_add_u32 m0, s33, 45056
    s_nop 0
    buffer_load_dwordx4 v23, s[44:47], s76 offen offset:0 lds
    v_mul_f32 v129, v129, v145
    v_exp_f32 v82, v82
    v_mul_f32 v130, v130, v146
    v_exp_f32 v83, v83
    v_mul_f32 v131, v131, v147
    v_fma_f32 v80, v80, v75, v75
    s_add_u32 m0, s33, 49152
    s_mov_b32 s77, 2064384
    buffer_load_dwordx4 v22, s[48:51], s77 offen offset:0 lds
    v_fma_f32 v81, v81, v75, v75
    v_fma_f32 v82, v82, v75, v75
    v_fma_f32 v83, v83, v75, v75
    v_rcp_f32 v80, v80
    v_rcp_f32 v81, v81
    v_rcp_f32 v82, v82
    s_add_u32 m0, s33, 53248
    s_nop 0
    buffer_load_dwordx4 v22, s[52:55], s77 offen offset:0 lds
    v_rcp_f32 v83, v83
    s_nop 0
    v_mul_f32 v128, v128, v80
    v_mul_f32 v129, v129, v81
    v_mul_f32 v130, v130, v82
    v_mul_f32 v131, v131, v83
    v_cvt_pk_bf16_f32 v128, v128, v129
    v_cvt_pk_bf16_f32 v129, v130, v131
    buffer_store_dwordx4 v[120:123], v19, s[68:71], s72 offen offset:512 sc1
    s_load_dword s94, s[10:11], s75 offset:0x80040
    s_load_dword s94, s[10:11], s75 offset:0x80080
    s_load_dword s94, s[10:11], s75 offset:0x800c0
    s_load_dword s94, s[10:11], s75 offset:0x80100
    s_load_dword s94, s[10:11], s75 offset:0x80140
    s_waitcnt vmcnt(17)
    s_barrier
    s_add_u32 m0, s79, 118784
    s_mov_b32 s78, 33408
    buffer_load_dwordx4 v20, s[36:39], s78 offen sc1 lds
    v_fmac_f32 v132, v32, v76
    v_fmac_f32 v133, v33, v76
    v_fmac_f32 v134, v34, v76
    v_fmac_f32 v135, v35, v76
    v_fmac_f32 v148, v36, v76
    v_fmac_f32 v149, v37, v76
    v_fmac_f32 v150, v38, v76
    v_fmac_f32 v151, v39, v76
    s_add_u32 m0, s79, 119808
    s_nop 0
    buffer_load_dwordx4 v21, s[36:39], s78 offen sc1 lds
    v_mul_f32 v80, v132, v132
    v_mul_f32 v81, v133, v133
    v_mul_f32 v82, v134, v134
    v_mul_f32 v83, v135, v135
    v_fma_f32 v80, v80, v78, v77
    v_fma_f32 v81, v81, v78, v77
    v_fma_f32 v82, v82, v78, v77
    v_fma_f32 v83, v83, v78, v77
    s_add_u32 m0, s81, 133120
    s_mov_b32 s78, 640
    s_mov_b64 exec, 0xffffffff
    buffer_load_dwordx4 v3, s[36:39], s78 offen sc1 lds
    s_mov_b64 exec, -1
    v_mul_f32 v80, v80, v132
    v_mul_f32 v81, v81, v133
    v_mul_f32 v82, v82, v134
    v_mul_f32 v83, v83, v135
    v_exp_f32 v80, v80
    v_mul_f32 v132, v132, v148
    v_exp_f32 v81, v81
    s_add_u32 m0, s33, 57344
    s_mov_b32 s76, 1966080
    buffer_load_dwordx4 v23, s[40:43], s76 offen offset:0 lds
    s_add_u32 m0, s33, 59392
    s_nop 0
    buffer_load_dwordx4 v23, s[40:43], s76 offen offset:2048 lds
    v_mul_f32 v133, v133, v149
    v_exp_f32 v82, v82
    v_mul_f32 v134, v134, v150
    v_exp_f32 v83, v83
    v_mul_f32 v135, v135, v151
    v_fma_f32 v80, v80, v79, v79
    s_add_u32 m0, s33, 65536
    s_nop 0
    buffer_load_dwordx4 v23, s[44:47], s76 offen offset:0 lds
    v_fma_f32 v81, v81, v79, v79
    v_fma_f32 v82, v82, v79, v79
    v_fma_f32 v83, v83, v79, v79
    v_rcp_f32 v80, v80
    v_rcp_f32 v81, v81
    v_rcp_f32 v82, v82
    s_add_u32 m0, s33, 69632
    s_mov_b32 s77, 2293760
    buffer_load_dwordx4 v22, s[48:51], s77 offen offset:0 lds
    v_rcp_f32 v83, v83
    s_nop 0
    v_mul_f32 v132, v132, v80
    v_mul_f32 v133, v133, v81
    v_mul_f32 v134, v134, v82
    v_mul_f32 v135, v135, v83
    v_cvt_pk_bf16_f32 v130, v132, v133
    v_cvt_pk_bf16_f32 v131, v134, v135
    s_add_u32 m0, s33, 73728
    s_nop 0
    buffer_load_dwordx4 v22, s[52:55], s77 offen offset:0 lds
    s_load_dword s94, s[10:11], s75 offset:0x80180
    s_load_dword s94, s[10:11], s75 offset:0x801c0
    s_add_u32 s75, s75, 0x100000
    s_load_dword s94, s[10:11], s75 offset:0x0
    s_load_dword s94, s[10:11], s75 offset:0x40
    s_load_dword s94, s[10:11], s75 offset:0x80
    s_waitcnt vmcnt(16)
    s_barrier
    s_add_u32 m0, s79, 135168
    s_mov_b32 s78, 768
    buffer_load_dwordx4 v20, s[36:39], s78 offen sc1 lds
    s_nop 1
    v_permlane16_swap_b32 v128, v130
    v_permlane16_swap_b32 v129, v131
    v_fmac_f32 v152, v40, v64
    v_fmac_f32 v153, v41, v64
    v_fmac_f32 v154, v42, v64
    v_fmac_f32 v155, v43, v64
    v_fmac_f32 v168, v44, v64
    v_fmac_f32 v169, v45, v64
    v_fmac_f32 v170, v46, v64
    v_fmac_f32 v171, v47, v64
    s_add_u32 m0, s79, 136192
    s_nop 0
    buffer_load_dwordx4 v21, s[36:39], s78 offen sc1 lds
    v_mul_f32 v80, v152, v152
    v_mul_f32 v81, v153, v153
    v_mul_f32 v82, v154, v154
    v_mul_f32 v83, v155, v155
    v_fma_f32 v80, v80, v66, v65
    v_fma_f32 v81, v81, v66, v65
    v_fma_f32 v82, v82, v66, v65
    v_fma_f32 v83, v83, v66, v65
    s_add_u32 m0, s33, 77824
    s_mov_b32 s76, 2162688
    buffer_load_dwordx4 v23, s[40:43], s76 offen offset:0 lds
    v_mul_f32 v80, v80, v152
    v_mul_f32 v81, v81, v153
    v_mul_f32 v82, v82, v154
    v_mul_f32 v83, v83, v155
    v_exp_f32 v80, v80
    v_mul_f32 v152, v152, v168
    v_exp_f32 v81, v81
    s_add_u32 m0, s33, 79872
    s_nop 0
    buffer_load_dwordx4 v23, s[40:43], s76 offen offset:2048 lds
    s_add_u32 m0, s33, 86016
    s_nop 0
    buffer_load_dwordx4 v23, s[44:47], s76 offen offset:0 lds
    v_mul_f32 v153, v153, v169
    v_exp_f32 v82, v82
    v_mul_f32 v154, v154, v170
    v_exp_f32 v83, v83
    v_mul_f32 v155, v155, v171
    v_fma_f32 v80, v80, v67, v67
    s_add_u32 m0, s33, 90112
    s_mov_b32 s77, 2523136
    buffer_load_dwordx4 v22, s[48:51], s77 offen offset:0 lds
    v_fma_f32 v81, v81, v67, v67
    v_fma_f32 v82, v82, v67, v67
    v_fma_f32 v83, v83, v67, v67
    v_rcp_f32 v80, v80
    v_rcp_f32 v81, v81
    v_rcp_f32 v82, v82
    s_add_u32 m0, s33, 94208
    s_nop 0
    buffer_load_dwordx4 v22, s[52:55], s77 offen offset:0 lds
    v_rcp_f32 v83, v83
    s_nop 0
    v_mul_f32 v152, v152, v80
    v_mul_f32 v153, v153, v81
    v_mul_f32 v154, v154, v82
    v_mul_f32 v155, v155, v83
    v_cvt_pk_bf16_f32 v152, v152, v153
    v_cvt_pk_bf16_f32 v153, v154, v155
    buffer_store_dwordx4 v[128:131], v19, s[68:71], s72 offen offset:2560 sc1
    s_load_dword s94, s[10:11], s75 offset:0xc0
    s_load_dword s94, s[10:11], s75 offset:0x100
    s_load_dword s94, s[10:11], s75 offset:0x140
    s_load_dword s94, s[10:11], s75 offset:0x180
    s_load_dword s94, s[10:11], s75 offset:0x1c0
    s_waitcnt vmcnt(56)
    s_movk_i32 s98, 0x4000
L_tokA_chk:
    v_readfirstlane_b32 s100, v6
    v_readfirstlane_b32 s101, v7
    s_nop 1
    s_cmp_lg_u32 s100, 0
    s_cbranch_scc1 L_tokA_ok
    s_sub_u32 s98, s98, 1
    s_cbranch_scc1 L_tokA_ok
    s_sleep 1
    global_load_dwordx2 v[6:7], v5, s[24:25] sc1
    s_waitcnt vmcnt(0)
    s_branch L_tokA_chk
L_tokA_ok:
    s_waitcnt vmcnt(17)
    s_barrier
    s_add_u32 m0, s79, 137216
    s_mov_b32 s78, 33536
    buffer_load_dwordx4 v20, s[36:39], s78 offen sc1 lds
    v_fmac_f32 v156, v40, v68
    v_fmac_f32 v157, v41, v68
    v_fmac_f32 v158, v42, v68
    v_fmac_f32 v159, v43, v68
    v_fmac_f32 v172, v44, v68
    v_fmac_f32 v173, v45, v68
    v_fmac_f32 v174, v46, v68
    v_fmac_f32 v175, v47, v68
    s_add_u32 m0, s79, 138240
    s_nop 0
    buffer_load_dwordx4 v21, s[36:39], s78 offen sc1 lds
    v_mul_f32 v80, v156, v156
    v_mul_f32 v81, v157, v157
    v_mul_f32 v82, v158, v158
    v_mul_f32 v83, v159, v159
    v_fma_f32 v80, v80, v70, v69
    v_fma_f32 v81, v81, v70, v69
    v_fma_f32 v82, v82, v70, v69
    v_fma_f32 v83, v83, v70, v69
    s_add_u32 m0, s81, 151552
    s_mov_b32 s78, 768
    s_mov_b64 exec, 0xffffffff
    buffer_load_dwordx4 v3, s[36:39], s78 offen sc1 lds
    s_mov_b64 exec, -1
    v_mul_f32 v80, v80, v156
    v_mul_f32 v81, v81, v157
    v_mul_f32 v82, v82, v158
    v_mul_f32 v83, v83, v159
    v_exp_f32 v80, v80
    v_mul_f32 v156, v156, v172
    v_exp_f32 v81, v81
    s_add_u32 m0, s33, 16384
    s_mov_b32 s76, 2359296
    buffer_load_dwordx4 v23, s[40:43], s76 offen offset:0 lds
    s_add_u32 m0, s33, 18432
    s_nop 0
    buffer_load_dwordx4 v23, s[40:43], s76 offen offset:2048 lds
    v_mul_f32 v157, v157, v173
    v_exp_f32 v82, v82
    v_mul_f32 v158, v158, v174
    v_exp_f32 v83, v83
    v_mul_f32 v159, v159, v175
    v_fma_f32 v80, v80, v71, v71
    s_add_u32 m0, s33, 24576
    s_nop 0
    buffer_load_dwordx4 v23, s[44:47], s76 offen offset:0 lds
    v_fma_f32 v81, v81, v71, v71
    v_fma_f32 v82, v82, v71, v71
    v_fma_f32 v83, v83, v71, v71
    v_rcp_f32 v80, v80
    v_rcp_f32 v81, v81
    v_rcp_f32 v82, v82
    s_add_u32 m0, s33, 28672
    s_mov_b32 s77, 2752512
    buffer_load_dwordx4 v22, s[48:51], s77 offen offset:0 lds
    v_rcp_f32 v83, v83
    s_nop 0
    v_mul_f32 v156, v156, v80
    v_mul_f32 v157, v157, v81
    v_mul_f32 v158, v158, v82
    v_mul_f32 v159, v159, v83
    v_cvt_pk_bf16_f32 v154, v156, v157
    v_cvt_pk_bf16_f32 v155, v158, v159
    s_add_u32 m0, s33, 32768
    s_nop 0
    buffer_load_dwordx4 v22, s[52:55], s77 offen offset:0 lds
    s_load_dword s94, s[10:11], s75 offset:0x80000
    s_load_dword s94, s[10:11], s75 offset:0x80040
    s_load_dword s94, s[10:11], s75 offset:0x80080
    s_load_dword s94, s[10:11], s75 offset:0x800c0
    s_load_dword s94, s[10:11], s75 offset:0x80100
    s_waitcnt vmcnt(16)
    s_barrier
    s_add_u32 m0, s79, 98304
    s_mov_b32 s78, 896
    buffer_load_dwordx4 v20, s[36:39], s78 offen sc1 lds
    s_nop 1
    v_permlane16_swap_b32 v152, v154
    v_permlane16_swap_b32 v153, v155
    v_fmac_f32 v160, v40, v72
    v_fmac_f32 v161, v41, v72
    v_fmac_f32 v162, v42, v72
    v_fmac_f32 v163, v43, v72
    v_fmac_f32 v176, v44, v72
    v_fmac_f32 v177, v45, v72
    v_fmac_f32 v178, v46, v72
    v_fmac_f32 v179, v47, v72
    s_add_u32 m0, s79, 99328
    s_nop 0
    buffer_load_dwordx4 v21, s[36:39], s78 offen sc1 lds
    v_mul_f32 v80, v160, v160
    v_mul_f32 v81, v161, v161
    v_mul_f32 v82, v162, v162
    v_mul_f32 v83, v163, v163
    v_fma_f32 v80, v80, v74, v73
    v_fma_f32 v81, v81, v74, v73
    v_fma_f32 v82, v82, v74, v73
    v_fma_f32 v83, v83, v74, v73
    s_add_u32 m0, s33, 36864
    s_mov_b32 s76, 2555904
    buffer_load_dwordx4 v23, s[40:43], s76 offen offset:0 lds
    v_mul_f32 v80, v80, v160
    v_mul_f32 v81, v81, v161
    v_mul_f32 v82, v82, v162
    v_mul_f32 v83, v83, v163
    v_exp_f32 v80, v80
    v_mul_f32 v160, v160, v176
    v_exp_f32 v81, v81
    s_add_u32 m0, s33, 38912
    s_nop 0
    buffer_load_dwordx4 v23, s[40:43], s76 offen offset:2048 lds
    s_add_u32 m0, s33, 45056
    s_nop 0
    buffer_load_dwordx4 v23, s[44:47], s76 offen offset:0 lds
    v_mul_f32 v161, v161, v177
    v_exp_f32 v82, v82
    v_mul_f32 v162, v162, v178
    v_exp_f32 v83, v83
    v_mul_f32 v163, v163, v179
    v_fma_f32 v80, v80, v75, v75
    s_add_u32 m0, s33, 49152
    s_mov_b32 s77, 2981888
    buffer_load_dwordx4 v22, s[48:51], s77 offen offset:0 lds
    v_fma_f32 v81, v81, v75, v75
    v_fma_f32 v82, v82, v75, v75
    v_fma_f32 v83, v83, v75, v75
    v_rcp_f32 v80, v80
    v_rcp_f32 v81, v81
    v_rcp_f32 v82, v82
    s_add_u32 m0, s33, 53248
    s_nop 0
    buffer_load_dwordx4 v22, s[52:55], s77 offen offset:0 lds
    v_rcp_f32 v83, v83
    s_nop 0
    v_mul_f32 v160, v160, v80
    v_mul_f32 v161, v161, v81
    v_mul_f32 v162, v162, v82
    v_mul_f32 v163, v163, v83
    v_cvt_pk_bf16_f32 v160, v160, v161
    v_cvt_pk_bf16_f32 v161, v162, v163
    buffer_store_dwordx4 v[152:155], v19, s[68:71], s73 offen offset:0 sc1
    s_load_dword s94, s[10:11], s75 offset:0x80140
    s_load_dword s94, s[10:11], s75 offset:0x80180
    s_load_dword s94, s[10:11], s75 offset:0x801c0
    s_add_u32 s99, s99, 0x1c0000
    s_load_dword s94, s[16:17], s99 offset:0x0
    s_load_dword s94, s[16:17], s99 offset:0x40
    s_waitcnt vmcnt(17)
    s_barrier
    s_add_u32 m0, s79, 100352
    s_mov_b32 s78, 33664
    buffer_load_dwordx4 v20, s[36:39], s78 offen sc1 lds
    v_fmac_f32 v164, v40, v76
    v_fmac_f32 v165, v41, v76
    v_fmac_f32 v166, v42, v76
    v_fmac_f32 v167, v43, v76
    v_fmac_f32 v180, v44, v76
    v_fmac_f32 v181, v45, v76
    v_fmac_f32 v182, v46, v76
    v_fmac_f32 v183, v47, v76
    s_add_u32 m0, s79, 101376
    s_nop 0
    buffer_load_dwordx4 v21, s[36:39], s78 offen sc1 lds
    v_mul_f32 v80, v164, v164
    v_mul_f32 v81, v165, v165
    v_mul_f32 v82, v166, v166
    v_mul_f32 v83, v167, v167
    v_fma_f32 v80, v80, v78, v77
    v_fma_f32 v81, v81, v78, v77
    v_fma_f32 v82, v82, v78, v77
    v_fma_f32 v83, v83, v78, v77
    s_add_u32 m0, s81, 114688
    s_mov_b32 s78, 896
    s_mov_b64 exec, 0xffffffff
    buffer_load_dwordx4 v3, s[36:39], s78 offen sc1 lds
    s_mov_b64 exec, -1
    v_mul_f32 v80, v80, v164
    v_mul_f32 v81, v81, v165
    v_mul_f32 v82, v82, v166
    v_mul_f32 v83, v83, v167
    v_exp_f32 v80, v80
    v_mul_f32 v164, v164, v180
    v_exp_f32 v81, v81
    s_add_u32 m0, s33, 57344
    s_mov_b32 s76, 2752512
    buffer_load_dwordx4 v23, s[40:43], s76 offen offset:0 lds
    s_add_u32 m0, s33, 59392
    s_nop 0
    buffer_load_dwordx4 v23, s[40:43], s76 offen offset:2048 lds
    v_mul_f32 v165, v165, v181
    v_exp_f32 v82, v82
    v_mul_f32 v166, v166, v182
    v_exp_f32 v83, v83
    v_mul_f32 v167, v167, v183
    v_fma_f32 v80, v80, v79, v79
    s_add_u32 m0, s33, 65536
    s_nop 0
    buffer_load_dwordx4 v23, s[44:47], s76 offen offset:0 lds
    v_fma_f32 v81, v81, v79, v79
    v_fma_f32 v82, v82, v79, v79
    v_fma_f32 v83, v83, v79, v79
    v_rcp_f32 v80, v80
    v_rcp_f32 v81, v81
    v_rcp_f32 v82, v82
    s_add_u32 m0, s33, 69632
    s_mov_b32 s77, 3211264
    buffer_load_dwordx4 v22, s[48:51], s77 offen offset:0 lds
    v_rcp_f32 v83, v83
    s_nop 0
    v_mul_f32 v164, v164, v80
    v_mul_f32 v165, v165, v81
    v_mul_f32 v166, v166, v82
    v_mul_f32 v167, v167, v83
    v_cvt_pk_bf16_f32 v162, v164, v165
    v_cvt_pk_bf16_f32 v163, v166, v167
    s_add_u32 m0, s33, 73728
    s_nop 0
    buffer_load_dwordx4 v22, s[52:55], s77 offen offset:0 lds
    s_load_dword s94, s[16:17], s99 offset:0x80
    s_load_dword s94, s[16:17], s99 offset:0xc0
    s_load_dword s94, s[16:17], s99 offset:0x100
    s_load_dword s94, s[16:17], s99 offset:0x140
    s_load_dword s94, s[16:17], s99 offset:0x180
    s_waitcnt vmcnt(16)
    s_barrier
    s_add_u32 m0, s79, 116736
    s_mov_b32 s78, 1024
    buffer_load_dwordx4 v20, s[36:39], s78 offen sc1 lds
    s_nop 1
    v_permlane16_swap_b32 v160, v162
    v_permlane16_swap_b32 v161, v163
    v_fmac_f32 v184, v48, v64
    v_fmac_f32 v185, v49, v64
    v_fmac_f32 v186, v50, v64
    v_fmac_f32 v187, v51, v64
    v_fmac_f32 v200, v52, v64
    v_fmac_f32 v201, v53, v64
    v_fmac_f32 v202, v54, v64
    v_fmac_f32 v203, v55, v64
    s_add_u32 m0, s79, 117760
    s_nop 0
    buffer_load_dwordx4 v21, s[36:39], s78 offen sc1 lds
    v_mul_f32 v80, v184, v184
    v_mul_f32 v81, v185, v185
    v_mul_f32 v82, v186, v186
    v_mul_f32 v83, v187, v187
    v_fma_f32 v80, v80, v66, v65
    v_fma_f32 v81, v81, v66, v65
    v_fma_f32 v82, v82, v66, v65
    v_fma_f32 v83, v83, v66, v65
    s_add_u32 m0, s33, 77824
    s_mov_b32 s76, 2949120
    buffer_load_dwordx4 v23, s[40:43], s76 offen offset:0 lds
    v_mul_f32 v80, v80, v184
    v_mul_f32 v81, v81, v185
    v_mul_f32 v82, v82, v186
    v_mul_f32 v83, v83, v187
    v_exp_f32 v80, v80
    v_mul_f32 v184, v184, v200
    v_exp_f32 v81, v81
    s_add_u32 m0, s33, 79872
    s_nop 0
    buffer_load_dwordx4 v23, s[40:43], s76 offen offset:2048 lds
    s_add_u32 m0, s33, 86016
    s_nop 0
    buffer_load_dwordx4 v23, s[44:47], s76 offen offset:0 lds
    v_mul_f32 v185, v185, v201
    v_exp_f32 v82, v82
    v_mul_f32 v186, v186, v202
    v_exp_f32 v83, v83
    v_mul_f32 v187, v187, v203
    v_fma_f32 v80, v80, v67, v67
    s_add_u32 m0, s33, 90112
    s_mov_b32 s77, 3440640
    buffer_load_dwordx4 v22, s[48:51], s77 offen offset:0 lds
    v_fma_f32 v81, v81, v67, v67
    v_fma_f32 v82, v82, v67, v67
    v_fma_f32 v83, v83, v67, v67
    v_rcp_f32 v80, v80
    v_rcp_f32 v81, v81
    v_rcp_f32 v82, v82
    s_add_u32 m0, s33, 94208
    s_nop 0
    buffer_load_dwordx4 v22, s[52:55], s77 offen offset:0 lds
    v_rcp_f32 v83, v83
    s_nop 0
    v_mul_f32 v184, v184, v80
    v_mul_f32 v185, v185, v81
    v_mul_f32 v186, v186, v82
    v_mul_f32 v187, v187, v83
    v_cvt_pk_bf16_f32 v184, v184, v185
    v_cvt_pk_bf16_f32 v185, v186, v187
    buffer_store_dwordx4 v[160:163], v19, s[68:71], s73 offen offset:2048 sc1
    s_load_dword s94, s[16:17], s99 offset:0x1c0
    s_load_dword s94, s[18:19], s99 offset:0x0
    s_load_dword s94, s[18:19], s99 offset:0x40
    s_load_dword s94, s[18:19], s99 offset:0x80
    s_load_dword s94, s[18:19], s99 offset:0xc0
    s_waitcnt vmcnt(17)
    s_barrier
    s_add_u32 m0, s79, 118784
    s_mov_b32 s78, 33792
    buffer_load_dwordx4 v20, s[36:39], s78 offen sc1 lds
    v_fmac_f32 v188, v48, v68
    v_fmac_f32 v189, v49, v68
    v_fmac_f32 v190, v50, v68
    v_fmac_f32 v191, v51, v68
    v_fmac_f32 v204, v52, v68
    v_fmac_f32 v205, v53, v68
    v_fmac_f32 v206, v54, v68
    v_fmac_f32 v207, v55, v68
    s_add_u32 m0, s79, 119808
    s_nop 0
    buffer_load_dwordx4 v21, s[36:39], s78 offen sc1 lds
    v_mul_f32 v80, v188, v188
    v_mul_f32 v81, v189, v189
    v_mul_f32 v82, v190, v190
    v_mul_f32 v83, v191, v191
    v_fma_f32 v80, v80, v70, v69
    v_fma_f32 v81, v81, v70, v69
    v_fma_f32 v82, v82, v70, v69
    v_fma_f32 v83, v83, v70, v69
    s_add_u32 m0, s81, 133120
    s_mov_b32 s78, 1024
    s_mov_b64 exec, 0xffffffff
    buffer_load_dwordx4 v3, s[36:39], s78 offen sc1 lds
    s_mov_b64 exec, -1
    v_mul_f32 v80, v80, v188
    v_mul_f32 v81, v81, v189
    v_mul_f32 v82, v82, v190
    v_mul_f32 v83, v83, v191
    v_exp_f32 v80, v80
    v_mul_f32 v188, v188, v204
    v_exp_f32 v81, v81
    s_add_u32 m0, s33, 16384
    s_mov_b32 s76, 3145728
    buffer_load_dwordx4 v23, s[40:43], s76 offen offset:0 lds
    s_add_u32 m0, s33, 18432
    s_nop 0
    buffer_load_dwordx4 v23, s[40:43], s76 offen offset:2048 lds
    v_mul_f32 v189, v189, v205
    v_exp_f32 v82, v82
    v_mul_f32 v190, v190, v206
    v_exp_f32 v83, v83
    v_mul_f32 v191, v191, v207
    v_fma_f32 v80, v80, v71, v71
    s_add_u32 m0, s33, 24576
    s_nop 0
    buffer_load_dwordx4 v23, s[44:47], s76 offen offset:0 lds
    v_fma_f32 v81, v81, v71, v71
    v_fma_f32 v82, v82, v71, v71
    v_fma_f32 v83, v83, v71, v71
    v_rcp_f32 v80, v80
    v_rcp_f32 v81, v81
    v_rcp_f32 v82, v82
    s_add_u32 m0, s33, 28672
    s_mov_b32 s77, 3670016
    buffer_load_dwordx4 v22, s[48:51], s77 offen offset:0 lds
    v_rcp_f32 v83, v83
    s_nop 0
    v_mul_f32 v188, v188, v80
    v_mul_f32 v189, v189, v81
    v_mul_f32 v190, v190, v82
    v_mul_f32 v191, v191, v83
    v_cvt_pk_bf16_f32 v186, v188, v189
    v_cvt_pk_bf16_f32 v187, v190, v191
    s_add_u32 m0, s33, 32768
    s_nop 0
    buffer_load_dwordx4 v22, s[52:55], s77 offen offset:0 lds
    s_load_dword s94, s[18:19], s99 offset:0x100
    s_load_dword s94, s[18:19], s99 offset:0x140
    s_load_dword s94, s[18:19], s99 offset:0x180
    s_load_dword s94, s[18:19], s99 offset:0x1c0
    s_add_u32 s75, s75, 0x100000
    s_load_dword s94, s[10:11], s75 offset:0x0
    s_waitcnt vmcnt(16)
    s_barrier
    s_add_u32 m0, s79, 135168
L_pad2:
    s_cbranch_execz L_vret1
    s_mov_b32 s78, 1152
    buffer_load_dwordx4 v20, s[36:39], s78 offen sc1 lds
    s_nop 1
    v_permlane16_swap_b32 v184, v186
    v_permlane16_swap_b32 v185, v187
    v_fmac_f32 v192, v48, v72
    v_fmac_f32 v193, v49, v72
    v_fmac_f32 v194, v50, v72
    v_fmac_f32 v195, v51, v72
    v_fmac_f32 v208, v52, v72
    v_fmac_f32 v209, v53, v72
    v_fmac_f32 v210, v54, v72
    v_fmac_f32 v211, v55, v72
    s_add_u32 m0, s79, 136192
    s_nop 0
    buffer_load_dwordx4 v21, s[36:39], s78 offen sc1 lds
    v_mul_f32 v80, v192, v192
    v_mul_f32 v81, v193, v193
    v_mul_f32 v82, v194, v194
    v_mul_f32 v83, v195, v195
    v_fma_f32 v80, v80, v74, v73
    v_fma_f32 v81, v81, v74, v73
    v_fma_f32 v82, v82, v74, v73
    v_fma_f32 v83, v83, v74, v73
    s_add_u32 m0, s33, 36864
    s_mov_b32 s76, 3342336
    buffer_load_dwordx4 v23, s[40:43], s76 offen offset:0 lds
    v_mul_f32 v80, v80, v192
    v_mul_f32 v81, v81, v193
    v_mul_f32 v82, v82, v194
    v_mul_f32 v83, v83, v195
    v_exp_f32 v80, v80
    v_mul_f32 v192, v192, v208
    v_exp_f32 v81, v81
    s_add_u32 m0, s33, 38912
    s_nop 0
    buffer_load_dwordx4 v23, s[40:43], s76 offen offset:2048 lds
    s_add_u32 m0, s33, 45056
    s_nop 0
    buffer_load_dwordx4 v23, s[44:47], s76 offen offset:0 lds
    v_mul_f32 v193, v193, v209
    v_exp_f32 v82, v82
    v_mul_f32 v194, v194, v210
    v_exp_f32 v83, v83
    v_mul_f32 v195, v195, v211
    v_fma_f32 v80, v80, v75, v75
    s_add_u32 m0, s33, 49152
    s_mov_b32 s77, 3899392
    buffer_load_dwordx4 v22, s[48:51], s77 offen offset:0 lds
    v_fma_f32 v81, v81, v75, v75
    v_fma_f32 v82, v82, v75, v75
    v_fma_f32 v83, v83, v75, v75
    v_rcp_f32 v80, v80
    v_rcp_f32 v81, v81
    v_rcp_f32 v82, v82
    s_add_u32 m0, s33, 53248
    s_nop 0
    buffer_load_dwordx4 v22, s[52:55], s77 offen offset:0 lds
    v_rcp_f32 v83, v83
    s_nop 0
    v_mul_f32 v192, v192, v80
    v_mul_f32 v193, v193, v81
    v_mul_f32 v194, v194, v82
    v_mul_f32 v195, v195, v83
    v_cvt_pk_bf16_f32 v192, v192, v193
    v_cvt_pk_bf16_f32 v193, v194, v195
    buffer_store_dwordx4 v[184:187], v19, s[68:71], s73 offen offset:512 sc1
    s_load_dword s94, s[10:11], s75 offset:0x40
    s_load_dword s94, s[10:11], s75 offset:0x80
    s_load_dword s94, s[10:11], s75 offset:0xc0
    s_load_dword s94, s[10:11], s75 offset:0x100
    s_load_dword s94, s[10:11], s75 offset:0x140
    s_waitcnt vmcnt(17)
    s_barrier
    s_add_u32 m0, s79, 137216
    s_mov_b32 s78, 33920
    buffer_load_dwordx4 v20, s[36:39], s78 offen sc1 lds
    v_fmac_f32 v196, v48, v76
    v_fmac_f32 v197, v49, v76
    v_fmac_f32 v198, v50, v76
    v_fmac_f32 v199, v51, v76
    v_fmac_f32 v212, v52, v76
    v_fmac_f32 v213, v53, v76
    v_fmac_f32 v214, v54, v76
    v_fmac_f32 v215, v55, v76
    s_add_u32 m0, s79, 138240
    s_nop 0
    buffer_load_dwordx4 v21, s[36:39], s78 offen sc1 lds
    v_mul_f32 v80, v196, v196
    v_mul_f32 v81, v197, v197
    v_mul_f32 v82, v198, v198
    v_mul_f32 v83, v199, v199
    v_fma_f32 v80, v80, v78, v77
    v_fma_f32 v81, v81, v78, v77
    v_fma_f32 v82, v82, v78, v77
    v_fma_f32 v83, v83, v78, v77
    s_add_u32 m0, s81, 151552
    s_mov_b32 s78, 1152
    s_mov_b64 exec, 0xffffffff
    buffer_load_dwordx4 v3, s[36:39], s78 offen sc1 lds
    s_mov_b64 exec, -1
    v_mul_f32 v80, v80, v196
    v_mul_f32 v81, v81, v197
    v_mul_f32 v82, v82, v198
    v_mul_f32 v83, v83, v199
    v_exp_f32 v80, v80
    v_mul_f32 v196, v196, v212
    v_exp_f32 v81, v81
    s_add_u32 m0, s33, 57344
    s_mov_b32 s76, 3538944
    buffer_load_dwordx4 v23, s[40:43], s76 offen offset:0 lds
    s_add_u32 m0, s33, 59392
    s_nop 0
    buffer_load_dwordx4 v23, s[40:43], s76 offen offset:2048 lds
    v_mul_f32 v197, v197, v213
    v_exp_f32 v82, v82
    v_mul_f32 v198, v198, v214
    v_exp_f32 v83, v83
    v_mul_f32 v199, v199, v215
    v_fma_f32 v80, v80, v79, v79
    s_add_u32 m0, s33, 65536
    s_nop 0
    buffer_load_dwordx4 v23, s[44:47], s76 offen offset:0 lds
    v_fma_f32 v81, v81, v79, v79
    v_fma_f32 v82, v82, v79, v79
    v_fma_f32 v83, v83, v79, v79
    v_rcp_f32 v80, v80
    v_rcp_f32 v81, v81
    v_rcp_f32 v82, v82
    s_add_u32 m0, s33, 69632
    s_mov_b32 s77, 4128768
    buffer_load_dwordx4 v22, s[48:51], s77 offen offset:0 lds
    v_rcp_f32 v83, v83
    s_nop 0
    v_mul_f32 v196, v196, v80
    v_mul_f32 v197, v197, v81
    v_mul_f32 v198, v198, v82
    v_mul_f32 v199, v199, v83
    v_cvt_pk_bf16_f32 v194, v196, v197
    v_cvt_pk_bf16_f32 v195, v198, v199
    s_add_u32 m0, s33, 73728
    s_nop 0
    buffer_load_dwordx4 v22, s[52:55], s77 offen offset:0 lds
    s_load_dword s94, s[10:11], s75 offset:0x180
    s_load_dword s94, s[10:11], s75 offset:0x1c0
    s_load_dword s94, s[10:11], s75 offset:0x80000
    s_load_dword s94, s[10:11], s75 offset:0x80040
    s_load_dword s94, s[10:11], s75 offset:0x80080
    s_waitcnt vmcnt(16)
    s_barrier
    s_add_u32 m0, s79, 98304
    s_mov_b32 s78, 1280
    buffer_load_dwordx4 v20, s[36:39], s78 offen sc1 lds
    s_nop 1
    v_permlane16_swap_b32 v192, v194
    v_permlane16_swap_b32 v193, v195
    v_fmac_f32 v216, v56, v64
    v_fmac_f32 v217, v57, v64
    v_fmac_f32 v218, v58, v64
    v_fmac_f32 v219, v59, v64
    v_fmac_f32 v232, v60, v64
    v_fmac_f32 v233, v61, v64
    v_fmac_f32 v234, v62, v64
    v_fmac_f32 v235, v63, v64
    s_add_u32 m0, s79, 99328
    s_nop 0
    buffer_load_dwordx4 v21, s[36:39], s78 offen sc1 lds
    v_mul_f32 v80, v216, v216
    v_mul_f32 v81, v217, v217
    v_mul_f32 v82, v218, v218
    v_mul_f32 v83, v219, v219
    v_fma_f32 v80, v80, v66, v65
    v_fma_f32 v81, v81, v66, v65
    v_fma_f32 v82, v82, v66, v65
    v_fma_f32 v83, v83, v66, v65
    s_add_u32 m0, s33, 77824
    s_mov_b32 s76, 3735552
    buffer_load_dwordx4 v23, s[40:43], s76 offen offset:0 lds
    v_mul_f32 v80, v80, v216
    v_mul_f32 v81, v81, v217
    v_mul_f32 v82, v82, v218
    v_mul_f32 v83, v83, v219
    v_exp_f32 v80, v80
    v_mul_f32 v216, v216, v232
    v_exp_f32 v81, v81
    s_add_u32 m0, s33, 79872
    s_nop 0
    buffer_load_dwordx4 v23, s[40:43], s76 offen offset:2048 lds
    s_add_u32 m0, s33, 86016
    s_nop 0
    buffer_load_dwordx4 v23, s[44:47], s76 offen offset:0 lds
    v_mul_f32 v217, v217, v233
    v_exp_f32 v82, v82
    v_mul_f32 v218, v218, v234
    v_exp_f32 v83, v83
    v_mul_f32 v219, v219, v235
    v_fma_f32 v80, v80, v67, v67
    s_add_u32 m0, s33, 90112
    s_mov_b32 s77, 4358144
    buffer_load_dwordx4 v22, s[48:51], s77 offen offset:0 lds
    v_fma_f32 v81, v81, v67, v67
    v_fma_f32 v82, v82, v67, v67
    v_fma_f32 v83, v83, v67, v67
    v_rcp_f32 v80, v80
    v_rcp_f32 v81, v81
    v_rcp_f32 v82, v82
    s_add_u32 m0, s33, 94208
    s_nop 0
    buffer_load_dwordx4 v22, s[52:55], s77 offen offset:0 lds
    v_rcp_f32 v83, v83
    s_nop 0
    v_mul_f32 v216, v216, v80
    v_mul_f32 v217, v217, v81
    v_mul_f32 v218, v218, v82
    v_mul_f32 v219, v219, v83
    v_cvt_pk_bf16_f32 v216, v216, v217
    v_cvt_pk_bf16_f32 v217, v218, v219
    buffer_store_dwordx4 v[192:195], v19, s[68:71], s73 offen offset:2560 sc1
    s_load_dword s94, s[10:11], s75 offset:0x800c0
    s_load_dword s94, s[10:11], s75 offset:0x80100
    s_load_dword s94, s[10:11], s75 offset:0x80140
    s_load_dword s94, s[10:11], s75 offset:0x80180
    s_load_dword s94, s[10:11], s75 offset:0x801c0
    s_waitcnt vmcnt(17)
    s_barrier
    s_add_u32 m0, s79, 100352
    s_mov_b32 s78, 34048
    buffer_load_dwordx4 v20, s[36:39], s78 offen sc1 lds
    v_fmac_f32 v220, v56, v68
    v_fmac_f32 v221, v57, v68
    v_fmac_f32 v222, v58, v68
    v_fmac_f32 v223, v59, v68
    v_fmac_f32 v236, v60, v68
    v_fmac_f32 v237, v61, v68
    v_fmac_f32 v238, v62, v68
    v_fmac_f32 v239, v63, v68
    s_add_u32 m0, s79, 101376
    s_nop 0
    buffer_load_dwordx4 v21, s[36:39], s78 offen sc1 lds
    v_mul_f32 v80, v220, v220
    v_mul_f32 v81, v221, v221
    v_mul_f32 v82, v222, v222
    v_mul_f32 v83, v223, v223
    v_fma_f32 v80, v80, v70, v69
    v_fma_f32 v81, v81, v70, v69
    v_fma_f32 v82, v82, v70, v69
    v_fma_f32 v83, v83, v70, v69
    s_add_u32 m0, s81, 114688
    s_mov_b32 s78, 1280
    s_mov_b64 exec, 0xffffffff
    buffer_load_dwordx4 v3, s[36:39], s78 offen sc1 lds
    s_mov_b64 exec, -1
    v_mul_f32 v80, v80, v220
    v_mul_f32 v81, v81, v221
    v_mul_f32 v82, v82, v222
    v_mul_f32 v83, v83, v223
    v_exp_f32 v80, v80
    v_mul_f32 v220, v220, v236
    v_exp_f32 v81, v81
    s_add_u32 m0, s33, 16384
    s_mov_b32 s76, 3932160
    buffer_load_dwordx4 v23, s[40:43], s76 offen offset:0 lds
    s_add_u32 m0, s33, 18432
    s_nop 0
    buffer_load_dwordx4 v23, s[40:43], s76 offen offset:2048 lds
    v_mul_f32 v221, v221, v237
    v_exp_f32 v82, v82
    v_mul_f32 v222, v222, v238
    v_exp_f32 v83, v83
    v_mul_f32 v223, v223, v239
    v_fma_f32 v80, v80, v71, v71
    s_add_u32 m0, s33, 24576
    s_nop 0
    buffer_load_dwordx4 v23, s[44:47], s76 offen offset:0 lds
    v_fma_f32 v81, v81, v71, v71
    v_fma_f32 v82, v82, v71, v71
    v_fma_f32 v83, v83, v71, v71
    v_rcp_f32 v80, v80
    v_rcp_f32 v81, v81
    v_rcp_f32 v82, v82
    s_add_u32 m0, s33, 28672
    s_mov_b32 s77, 4587520
    buffer_load_dwordx4 v22, s[48:51], s77 offen offset:0 lds
    v_rcp_f32 v83, v83
    s_nop 0
    v_mul_f32 v220, v220, v80
    v_mul_f32 v221, v221, v81
    v_mul_f32 v222, v222, v82
    v_mul_f32 v223, v223, v83
    v_cvt_pk_bf16_f32 v218, v220, v221
    v_cvt_pk_bf16_f32 v219, v222, v223
    s_add_u32 m0, s33, 32768
    s_nop 0
    buffer_load_dwordx4 v22, s[52:55], s77 offen offset:0 lds
    s_add_u32 s75, s75, 0xffb00000
    s_load_dword s94, s[20:21], s75 offset:0x0
    s_load_dword s94, s[20:21], s75 offset:0x40
    s_load_dword s94, s[20:21], s75 offset:0x80
    s_load_dword s94, s[20:21], s75 offset:0xc0
    s_load_dword s94, s[20:21], s75 offset:0x100
    s_waitcnt vmcnt(16)
    s_barrier
    s_add_u32 m0, s79, 116736
    s_mov_b32 s78, 1408
    buffer_load_dwordx4 v20, s[36:39], s78 offen sc1 lds
    s_nop 1
    v_permlane16_swap_b32 v216, v218
    v_permlane16_swap_b32 v217, v219
    v_fmac_f32 v224, v56, v72
    v_fmac_f32 v225, v57, v72
    v_fmac_f32 v226, v58, v72
    v_fmac_f32 v227, v59, v72
    v_fmac_f32 v240, v60, v72
    v_fmac_f32 v241, v61, v72
    v_fmac_f32 v242, v62, v72
    v_fmac_f32 v243, v63, v72
    s_add_u32 m0, s79, 117760
    s_nop 0
    buffer_load_dwordx4 v21, s[36:39], s78 offen sc1 lds
    v_mul_f32 v80, v224, v224
    v_mul_f32 v81, v225, v225
    v_mul_f32 v82, v226, v226
    v_mul_f32 v83, v227, v227
    v_fma_f32 v80, v80, v74, v73
    v_fma_f32 v81, v81, v74, v73
    v_fma_f32 v82, v82, v74, v73
    v_fma_f32 v83, v83, v74, v73
    s_add_u32 m0, s33, 36864
    s_mov_b32 s76, 4128768
    buffer_load_dwordx4 v23, s[40:43], s76 offen offset:0 lds
    v_mul_f32 v80, v80, v224
    v_mul_f32 v81, v81, v225
    v_mul_f32 v82, v82, v226
    v_mul_f32 v83, v83, v227
    v_exp_f32 v80, v80
    v_mul_f32 v224, v224, v240
    v_exp_f32 v81, v81
    s_add_u32 m0, s33, 38912
    s_nop 0
    buffer_load_dwordx4 v23, s[40:43], s76 offen offset:2048 lds
    s_add_u32 m0, s33, 45056
    s_nop 0
    buffer_load_dwordx4 v23, s[44:47], s76 offen offset:0 lds
    v_mul_f32 v225, v225, v241
    v_exp_f32 v82, v82
    v_mul_f32 v226, v226, v242
    v_exp_f32 v83, v83
    v_mul_f32 v227, v227, v243
    v_fma_f32 v80, v80, v75, v75
    s_add_u32 m0, s33, 49152
    s_mov_b32 s77, 4816896
    buffer_load_dwordx4 v22, s[48:51], s77 offen offset:0 lds
    v_fma_f32 v81, v81, v75, v75
    v_fma_f32 v82, v82, v75, v75
    v_fma_f32 v83, v83, v75, v75
    v_rcp_f32 v80, v80
    v_rcp_f32 v81, v81
    v_rcp_f32 v82, v82
    s_add_u32 m0, s33, 53248
    s_nop 0
    buffer_load_dwordx4 v22, s[52:55], s77 offen offset:0 lds
    v_rcp_f32 v83, v83
    s_nop 0
    v_mul_f32 v224, v224, v80
    v_mul_f32 v225, v225, v81
    v_mul_f32 v226, v226, v82
    v_mul_f32 v227, v227, v83
    v_cvt_pk_bf16_f32 v224, v224, v225
    v_cvt_pk_bf16_f32 v225, v226, v227
    buffer_store_dwordx4 v[216:219], v19, s[68:71], s74 offen offset:0 sc1
    s_load_dword s94, s[20:21], s75 offset:0x140
    s_load_dword s94, s[20:21], s75 offset:0x180
    s_load_dword s94, s[20:21], s75 offset:0x1c0
    s_add_u32 s75, s75, 0x280000
    s_load_dword s94, s[20:21], s75 offset:0x0
    s_load_dword s94, s[20:21], s75 offset:0x40
    s_waitcnt vmcnt(17)
    s_barrier
    s_add_u32 m0, s79, 118784
    s_mov_b32 s78, 34176
    buffer_load_dwordx4 v20, s[36:39], s78 offen sc1 lds
    v_fmac_f32 v228, v56, v76
    v_fmac_f32 v229, v57, v76
    v_fmac_f32 v230, v58, v76
    v_fmac_f32 v231, v59, v76
    v_fmac_f32 v244, v60, v76
    v_fmac_f32 v245, v61, v76
    v_fmac_f32 v246, v62, v76
    v_fmac_f32 v247, v63, v76
    s_add_u32 m0, s79, 119808
    s_nop 0
    buffer_load_dwordx4 v21, s[36:39], s78 offen sc1 lds
    v_mul_f32 v80, v228, v228
    v_mul_f32 v81, v229, v229
    v_mul_f32 v82, v230, v230
    v_mul_f32 v83, v231, v231
    v_fma_f32 v80, v80, v78, v77
    v_fma_f32 v81, v81, v78, v77
    v_fma_f32 v82, v82, v78, v77
    v_fma_f32 v83, v83, v78, v77
    s_add_u32 m0, s81, 133120
    s_mov_b32 s78, 1408
    s_mov_b64 exec, 0xffffffff
    buffer_load_dwordx4 v3, s[36:39], s78 offen sc1 lds
    s_mov_b64 exec, -1
    v_mul_f32 v80, v80, v228
    v_mul_f32 v81, v81, v229
    v_mul_f32 v82, v82, v230
    v_mul_f32 v83, v83, v231
    v_exp_f32 v80, v80
    v_mul_f32 v228, v228, v244
    v_exp_f32 v81, v81
    s_add_u32 m0, s33, 57344
    s_mov_b32 s76, 4325376
    buffer_load_dwordx4 v23, s[40:43], s76 offen offset:0 lds
    s_add_u32 m0, s33, 59392
    s_nop 0
    buffer_load_dwordx4 v23, s[40:43], s76 offen offset:2048 lds
    v_mul_f32 v229, v229, v245
    v_exp_f32 v82, v82
    v_mul_f32 v230, v230, v246
    v_exp_f32 v83, v83
    v_mul_f32 v231, v231, v247
    v_fma_f32 v80, v80, v79, v79
    s_add_u32 m0, s33, 65536
    s_nop 0
    buffer_load_dwordx4 v23, s[44:47], s76 offen offset:0 lds
    v_fma_f32 v81, v81, v79, v79
    v_fma_f32 v82, v82, v79, v79
    v_fma_f32 v83, v83, v79, v79
    v_rcp_f32 v80, v80
    v_rcp_f32 v81, v81
    v_rcp_f32 v82, v82
    s_add_u32 m0, s33, 69632
    s_mov_b32 s77, 5046272
    buffer_load_dwordx4 v22, s[48:51], s77 offen offset:0 lds
    v_rcp_f32 v83, v83
    s_nop 0
    v_mul_f32 v228, v228, v80
    v_mul_f32 v229, v229, v81
    v_mul_f32 v230, v230, v82
    v_mul_f32 v231, v231, v83
    v_cvt_pk_bf16_f32 v226, v228, v229
    v_cvt_pk_bf16_f32 v227, v230, v231
    s_add_u32 m0, s33, 73728
    s_nop 0
    buffer_load_dwordx4 v22, s[52:55], s77 offen offset:0 lds
    s_load_dword s94, s[20:21], s75 offset:0x80
    s_load_dword s94, s[20:21], s75 offset:0xc0
    s_load_dword s94, s[20:21], s75 offset:0x100
    s_load_dword s94, s[20:21], s75 offset:0x140
    s_load_dword s94, s[20:21], s75 offset:0x180
    s_lshl_b32 s91, s4, 6
    s_add_u32 s91, s91, s29
    s_lshl_b32 s91, s91, 7
    s_add_u32 s91, s91, 0x1eb0000
    v_lshl_add_u32 v13, v1, 11, s91
    s_mov_b64 exec, 15
    global_load_dwordx2 v[14:15], v13, s[26:27] sc1
    s_mov_b64 exec, -1
    s_waitcnt vmcnt(17)
    s_barrier
    s_mov_b64 exec, 0
    s_cmp_eq_u32 s4, 0
    s_cbranch_scc1 L_pad4
    s_cmp_eq_u32 s4, 1
    s_cbranch_scc1 L_pad5
    s_cmp_eq_u32 s4, 2
    s_cbranch_scc1 L_pad10
    s_cmp_eq_u32 s4, 3
    s_cbranch_scc1 L_pad11
L_vret2:
    s_mov_b64 exec, -1
    s_nop 1
    v_permlane16_swap_b32 v224, v226
    v_permlane16_swap_b32 v225, v227
    buffer_store_dwordx4 v[224:227], v19, s[68:71], s74 offen offset:2048 sc1
    s_load_dword s94, s[20:21], s75 offset:0x1c0
    s_add_u32 s75, s75, 0xffe00000
    s_load_dword s94, s[20:21], s75 offset:0x0
    s_load_dword s94, s[20:21], s75 offset:0x40
    s_load_dword s94, s[20:21], s75 offset:0x80
    s_load_dword s94, s[20:21], s75 offset:0xc0
    s_waitcnt vmcnt(11)
    s_barrier
    s_add_u32 m0, s79, 135168
    s_mov_b32 s78, 1536
    buffer_load_dwordx4 v20, s[36:39], s78 offen sc1 lds
    s_add_u32 m0, s79, 136192
    s_nop 0
    buffer_load_dwordx4 v21, s[36:39], s78 offen sc1 lds
    s_add_u32 m0, s33, 77824
    s_mov_b32 s76, 4521984
    buffer_load_dwordx4 v23, s[40:43], s76 offen offset:0 lds
    s_add_u32 m0, s33, 79872
    s_nop 0
    buffer_load_dwordx4 v23, s[40:43], s76 offen offset:2048 lds
    s_add_u32 m0, s33, 86016
    s_nop 0
    buffer_load_dwordx4 v23, s[44:47], s76 offen offset:0 lds
    s_add_u32 m0, s33, 90112
    s_mov_b32 s77, 5275648
    buffer_load_dwordx4 v22, s[48:51], s77 offen offset:0 lds
    s_add_u32 m0, s33, 94208
    s_nop 0
    buffer_load_dwordx4 v22, s[52:55], s77 offen offset:0 lds
    s_add_u32 m0, s79, 137216
    s_mov_b32 s78, 34304
    buffer_load_dwordx4 v20, s[36:39], s78 offen sc1 lds
    s_add_u32 m0, s79, 138240
    s_nop 0
    buffer_load_dwordx4 v21, s[36:39], s78 offen sc1 lds
    s_add_u32 m0, s81, 151552
    s_mov_b32 s78, 1536
    s_mov_b64 exec, 0xffffffff
    buffer_load_dwordx4 v3, s[36:39], s78 offen sc1 lds
    s_mov_b64 exec, -1
    s_load_dword s94, s[20:21], s75 offset:0x100
    s_load_dword s94, s[20:21], s75 offset:0x140
    s_load_dword s94, s[20:21], s75 offset:0x180
    s_load_dword s94, s[20:21], s75 offset:0x1c0
    s_add_u32 s75, s75, 0x280000
    s_load_dword s94, s[20:21], s75 offset:0x0
    s_waitcnt vmcnt(11)
    s_mov_b64 exec, 15
    s_movk_i32 s98, 0x4000
L_pC_chk:
    v_cmp_ne_u64 vcc, s[100:101], v[14:15]
    s_nop 1
    s_cmp_eq_u64 vcc, 0
    s_cbranch_scc1 L_pC_ok
    s_sub_u32 s98, s98, 1
    s_cbranch_scc1 L_pC_ok
    s_sleep 1
    global_load_dwordx2 v[14:15], v13, s[26:27] sc1
    s_waitcnt vmcnt(0)
    s_branch L_pC_chk
L_pC_ok:
    s_mov_b64 exec, -1
    s_waitcnt vmcnt(12)
    s_barrier
    s_add_u32 m0, s33, 16384
    s_mov_b32 s76, 4718592
    buffer_load_dwordx4 v23, s[40:43], s76 offen offset:0 lds
    s_add_u32 m0, s33, 18432
    s_nop 0
    buffer_load_dwordx4 v23, s[40:43], s76 offen offset:2048 lds
    s_add_u32 m0, s33, 24576
    s_nop 0
    buffer_load_dwordx4 v23, s[44:47], s76 offen offset:0 lds
    s_add_u32 m0, s33, 28672
    s_mov_b32 s77, 5505024
    buffer_load_dwordx4 v22, s[48:51], s77 offen offset:0 lds
    s_add_u32 m0, s33, 32768
    s_nop 0
    buffer_load_dwordx4 v22, s[52:55], s77 offen offset:0 lds
    s_add_u32 m0, s79, 98304
    s_mov_b32 s78, 1664
    buffer_load_dwordx4 v20, s[36:39], s78 offen sc1 lds
    s_add_u32 m0, s79, 99328
    s_nop 0
    buffer_load_dwordx4 v21, s[36:39], s78 offen sc1 lds
    s_add_u32 m0, s33, 36864
    s_mov_b32 s76, 4915200
    buffer_load_dwordx4 v23, s[40:43], s76 offen offset:0 lds
    s_add_u32 m0, s33, 38912
    s_nop 0
    buffer_load_dwordx4 v23, s[40:43], s76 offen offset:2048 lds
    s_add_u32 m0, s33, 45056
    s_nop 0
    buffer_load_dwordx4 v23, s[44:47], s76 offen offset:0 lds
    s_add_u32 m0, s33, 49152
    s_mov_b32 s77, 5734400
    buffer_load_dwordx4 v22, s[48:51], s77 offen offset:0 lds
    s_load_dword s94, s[20:21], s75 offset:0x40
    s_load_dword s94, s[20:21], s75 offset:0x80
    s_load_dword s94, s[20:21], s75 offset:0xc0
    s_load_dword s94, s[20:21], s75 offset:0x100
    s_load_dword s94, s[20:21], s75 offset:0x140
    s_waitcnt vmcnt(14)
    s_barrier
    s_add_u32 m0, s33, 53248
    s_nop 0
    buffer_load_dwordx4 v22, s[52:55], s77 offen offset:0 lds
    s_add_u32 m0, s79, 100352
    s_mov_b32 s78, 34432
    buffer_load_dwordx4 v20, s[36:39], s78 offen sc1 lds
    s_add_u32 m0, s79, 101376
    s_nop 0
    buffer_load_dwordx4 v21, s[36:39], s78 offen sc1 lds
    s_add_u32 m0, s81, 114688
    s_mov_b32 s78, 1664
    s_mov_b64 exec, 0xffffffff
    buffer_load_dwordx4 v3, s[36:39], s78 offen sc1 lds
    s_mov_b64 exec, -1
    s_add_u32 m0, s33, 57344
    s_mov_b32 s76, 5111808
    buffer_load_dwordx4 v23, s[40:43], s76 offen offset:0 lds
    s_add_u32 m0, s33, 59392
    s_nop 0
    buffer_load_dwordx4 v23, s[40:43], s76 offen offset:2048 lds
    s_add_u32 m0, s33, 65536
    s_nop 0
    buffer_load_dwordx4 v23, s[44:47], s76 offen offset:0 lds
    s_add_u32 m0, s33, 69632
    s_mov_b32 s77, 5963776
    buffer_load_dwordx4 v22, s[48:51], s77 offen offset:0 lds
    s_add_u32 m0, s33, 73728
    s_nop 0
    buffer_load_dwordx4 v22, s[52:55], s77 offen offset:0 lds
    s_load_dword s94, s[20:21], s75 offset:0x180
    s_load_dword s94, s[20:21], s75 offset:0x1c0
    s_add_u32 s75, s75, 0xffe00000
    s_load_dword s94, s[20:21], s75 offset:0x0
    s_load_dword s94, s[20:21], s75 offset:0x40
    s_load_dword s94, s[20:21], s75 offset:0x80
    s_waitcnt vmcnt(30)
    s_waitcnt vmcnt(15)
    s_barrier
    s_mov_b64 exec, 0
    s_cmp_eq_u32 s4, 0
    s_cbranch_scc1 L_pad12
L_vret3:
    s_mov_b64 exec, -1
    s_load_dword s94, s[20:21], s75 offset:0xc0
    s_load_dword s94, s[20:21], s75 offset:0x100
    s_load_dword s94, s[20:21], s75 offset:0x140
    s_load_dword s94, s[20:21], s75 offset:0x180
    s_load_dword s94, s[20:21], s75 offset:0x1c0
    s_cmp_lg_u32 s4, 0
    s_cbranch_scc1 L_fH1
    s_lshl_b32 s91, s28, 4
    s_add_u32 s91, s91, s29
    s_lshl_b32 s91, s91, 7
    s_add_u32 s91, s91, 0x1e88000
    v_mov_b32 v12, s91
    v_mov_b32 v14, s100
    v_mov_b32 v15, s101
    s_mov_b64 exec, 1
    global_store_dwordx2 v12, v[14:15], s[26:27] sc1
    s_mov_b64 exec, -1
L_fH1:
    s_waitcnt vmcnt(8)
    s_barrier
    s_add_u32 m0, s79, 116736
    s_mov_b32 s78, 1792
    buffer_load_dwordx4 v20, s[36:39], s78 offen sc1 lds
    s_add_u32 m0, s79, 117760
    s_nop 0
    buffer_load_dwordx4 v21, s[36:39], s78 offen sc1 lds
    s_add_u32 m0, s33, 77824
    s_mov_b32 s76, 5308416
    buffer_load_dwordx4 v23, s[40:43], s76 offen offset:0 lds
    s_add_u32 m0, s33, 79872
    s_nop 0
    buffer_load_dwordx4 v23, s[40:43], s76 offen offset:2048 lds
    s_add_u32 m0, s33, 86016
    s_nop 0
    buffer_load_dwordx4 v23, s[44:47], s76 offen offset:0 lds
    s_add_u32 m0, s33, 90112
    s_mov_b32 s77, 6193152
    buffer_load_dwordx4 v22, s[48:51], s77 offen offset:0 lds
    s_add_u32 m0, s33, 94208
    s_nop 0
    buffer_load_dwordx4 v22, s[52:55], s77 offen offset:0 lds
    s_add_u32 m0, s79, 118784
    s_mov_b32 s78, 34560
    buffer_load_dwordx4 v20, s[36:39], s78 offen sc1 lds
    s_add_u32 m0, s79, 119808
    s_nop 0
    buffer_load_dwordx4 v21, s[36:39], s78 offen sc1 lds
    s_add_u32 m0, s81, 133120
    s_mov_b32 s78, 1792
    s_mov_b64 exec, 0xffffffff
    buffer_load_dwordx4 v3, s[36:39], s78 offen sc1 lds
    s_mov_b64 exec, -1
    s_add_u32 s75, s75, 0x280000
    s_load_dword s94, s[20:21], s75 offset:0x0
    s_load_dword s94, s[20:21], s75 offset:0x40
L_pad3:
    s_cbranch_execz L_vret1
    s_load_dword s94, s[20:21], s75 offset:0x80
    s_load_dword s94, s[20:21], s75 offset:0xc0
    s_load_dword s94, s[20:21], s75 offset:0x100
    s_waitcnt vmcnt(10)
    s_barrier
    s_add_u32 m0, s33, 16384
    s_mov_b32 s76, 5505024
    buffer_load_dwordx4 v23, s[40:43], s76 offen offset:0 lds
    s_add_u32 m0, s33, 18432
    s_nop 0
    buffer_load_dwordx4 v23, s[40:43], s76 offen offset:2048 lds
    s_add_u32 m0, s33, 24576
    s_nop 0
    buffer_load_dwordx4 v23, s[44:47], s76 offen offset:0 lds
    s_add_u32 m0, s33, 28672
    s_mov_b32 s77, 6422528
    buffer_load_dwordx4 v22, s[48:51], s77 offen offset:0 lds
    s_add_u32 m0, s33, 32768
    s_nop 0
    buffer_load_dwordx4 v22, s[52:55], s77 offen offset:0 lds
    s_add_u32 m0, s79, 135168
    s_mov_b32 s78, 1920
    buffer_load_dwordx4 v20, s[36:39], s78 offen sc1 lds
    s_add_u32 m0, s79, 136192
    s_nop 0
    buffer_load_dwordx4 v21, s[36:39], s78 offen sc1 lds
    s_add_u32 m0, s33, 36864
    s_mov_b32 s76, 5701632
    buffer_load_dwordx4 v23, s[40:43], s76 offen offset:0 lds
    s_add_u32 m0, s33, 38912
    s_nop 0
    buffer_load_dwordx4 v23, s[40:43], s76 offen offset:2048 lds
    s_add_u32 m0, s33, 45056
    s_nop 0
    buffer_load_dwordx4 v23, s[44:47], s76 offen offset:0 lds
    s_add_u32 m0, s33, 49152
    s_mov_b32 s77, 6651904
    buffer_load_dwordx4 v22, s[48:51], s77 offen offset:0 lds
    s_load_dword s94, s[20:21], s75 offset:0x140
    s_load_dword s94, s[20:21], s75 offset:0x180
    s_load_dword s94, s[20:21], s75 offset:0x1c0
    s_add_u32 s75, s75, 0xffe00000
    s_load_dword s94, s[20:21], s75 offset:0x0
    s_load_dword s94, s[20:21], s75 offset:0x40
    s_waitcnt vmcnt(14)
    s_barrier
    s_add_u32 m0, s33, 53248
    s_nop 0
    buffer_load_dwordx4 v22, s[52:55], s77 offen offset:0 lds
    s_add_u32 m0, s79, 137216
    s_mov_b32 s78, 34688
    buffer_load_dwordx4 v20, s[36:39], s78 offen sc1 lds
    s_add_u32 m0, s79, 138240
    s_nop 0
    buffer_load_dwordx4 v21, s[36:39], s78 offen sc1 lds
    s_add_u32 m0, s81, 151552
    s_mov_b32 s78, 1920
    s_mov_b64 exec, 0xffffffff
    buffer_load_dwordx4 v3, s[36:39], s78 offen sc1 lds
    s_mov_b64 exec, -1
    s_add_u32 m0, s33, 57344
    s_mov_b32 s76, 5898240
    buffer_load_dwordx4 v23, s[40:43], s76 offen offset:0 lds
    s_add_u32 m0, s33, 59392
    s_nop 0
    buffer_load_dwordx4 v23, s[40:43], s76 offen offset:2048 lds
    s_add_u32 m0, s33, 65536
    s_nop 0
    buffer_load_dwordx4 v23, s[44:47], s76 offen offset:0 lds
    s_add_u32 m0, s33, 69632
    s_mov_b32 s77, 6881280
    buffer_load_dwordx4 v22, s[48:51], s77 offen offset:0 lds
    s_add_u32 m0, s33, 73728
    s_nop 0
    buffer_load_dwordx4 v22, s[52:55], s77 offen offset:0 lds
    s_lshl2_add_u32 s91, s30, s4
    s_lshl_b32 s91, s91, 9
    s_add_u32 s91, s91, 0x1e88000
    v_lshl_add_u32 v13, v1, 7, s91
    s_mov_b64 exec, 15
    global_load_dwordx2 v[14:15], v13, s[26:27] sc1
    s_mov_b64 exec, -1
    s_waitcnt vmcnt(16)
    s_barrier
    s_add_u32 m0, s33, 77824
    s_mov_b32 s76, 6094848
    buffer_load_dwordx4 v23, s[40:43], s76 offen offset:0 lds
    s_add_u32 m0, s33, 79872
    s_nop 0
    buffer_load_dwordx4 v23, s[40:43], s76 offen offset:2048 lds
    s_add_u32 m0, s33, 86016
    s_nop 0
    buffer_load_dwordx4 v23, s[44:47], s76 offen offset:0 lds
    s_add_u32 m0, s33, 90112
    s_mov_b32 s77, 7110656
    buffer_load_dwordx4 v22, s[48:51], s77 offen offset:0 lds
    s_add_u32 m0, s33, 94208
    s_nop 0
    buffer_load_dwordx4 v22, s[52:55], s77 offen offset:0 lds
    s_waitcnt vmcnt(5)
    s_mov_b64 exec, 15
    s_movk_i32 s98, 0x4000
L_pH1_chk:
    v_cmp_ne_u64 vcc, s[100:101], v[14:15]
    s_nop 1
    s_cmp_eq_u64 vcc, 0
    s_cbranch_scc1 L_pH1_ok
    s_sub_u32 s98, s98, 1
    s_cbranch_scc1 L_pH1_ok
    s_sleep 1
    global_load_dwordx2 v[14:15], v13, s[26:27] sc1
    s_waitcnt vmcnt(0)
    s_branch L_pH1_chk
L_pH1_ok:
    s_mov_b64 exec, -1
    s_waitcnt vmcnt(14)
    s_barrier
    s_mov_b32 s40, s34
    s_mov_b32 s42, s35
    s_memrealtime s[44:45]
    s_memtime s[46:47]
    s_lshl4_add_u32 s91, s28, s29
    s_lshl_b32 s91, s91, 7
    s_add_u32 s92, s91, 0x1ea8000
    s_xor_b32 s91, s91, 17408
    s_add_u32 s91, s91, 0x1ea8000
    v_mov_b32 v239, s92
    v_writelane_b32 v239, s91, 1
    s_lshl_b32 m0, s33, 2
    s_nop 0
    buffer_load_dwordx4 v18, s[56:59], s82 offen offset:0 sc1 lds
    buffer_load_dwordx4 v18, s[56:59], s82 offen offset:1024 sc1 lds
    buffer_load_dwordx4 v18, s[56:59], s82 offen offset:2048 sc1 lds
    buffer_load_dwordx4 v18, s[56:59], s82 offen offset:3072 sc1 lds
    s_add_u32 s82, s82, 16384
    s_lshl1_add_u32 m0, s33, 16384
    s_nop 0
    buffer_load_dwordx4 v254, s[60:63], s83 offen lds
    s_lshl1_add_u32 m0, s33, 17408
    s_nop 0
    buffer_load_dwordx4 v255, s[60:63], s83 offen lds
    s_lshl1_add_u32 m0, s33, 24576
    s_nop 0
    buffer_load_dwordx4 v254, s[64:67], s83 offen lds
    s_lshl1_add_u32 m0, s33, 25600
    s_nop 0
    buffer_load_dwordx4 v255, s[64:67], s83 offen lds
    s_add_u32 s83, s83, 131072
    s_lshl_b32 s84, s2, 15
    s_lshl_b32 s85, s4, 13
    s_add_u32 s84, s84, s85
    s_add_u32 s36, s84, 0x1600000
    s_add_u32 s37, s36, 4096
    s_xor_b32 s84, s84, 163840
    s_add_u32 s38, s84, 0x1600000
    s_add_u32 s39, s38, 4096
    v_lshlrev_b32 v4, 4, v1
    s_lshl_b32 s84, s4, 12
    s_add_u32 s84, s84, 147456
    v_lshl_add_u32 v5, v1, 3, s84
    v_lshlrev_b32 v6, 2, v1
    s_waitcnt vmcnt(14)
    s_barrier
    s_lshl2_add_u32 m0, s33, 98304
    s_nop 0
    buffer_load_dwordx4 v18, s[56:59], s82 offen offset:0 sc1 lds
    buffer_load_dwordx4 v18, s[56:59], s82 offen offset:1024 sc1 lds
    buffer_load_dwordx4 v18, s[56:59], s82 offen offset:2048 sc1 lds
    buffer_load_dwordx4 v18, s[56:59], s82 offen offset:3072 sc1 lds
    s_add_u32 s82, s82, 16384
    s_lshl1_add_u32 m0, s33, 114688
    s_nop 0
    buffer_load_dwordx4 v254, s[60:63], s83 offen lds
    s_lshl1_add_u32 m0, s33, 115712
    s_nop 0
    buffer_load_dwordx4 v255, s[60:63], s83 offen lds
    s_lshl1_add_u32 m0, s33, 122880
    s_nop 0
    buffer_load_dwordx4 v254, s[64:67], s83 offen lds
    s_lshl1_add_u32 m0, s33, 123904
    s_nop 0
    buffer_load_dwordx4 v255, s[64:67], s83 offen lds
    s_add_u32 s83, s83, 131072
    s_waitcnt lgkmcnt(0)
    s_sub_u32 s40, s44, s40
    s_sub_u32 s42, s46, s42
    v_cvt_f32_u32 v8, s42
    v_cvt_f32_u32 v9, s40
    v_rcp_f32 v8, v8
    v_mul_f32 v9, 0x463b8000, v9
    v_mul_f32 v8, v8, v9
    v_cvt_u32_f32 v10, v8
    v_add_u32 v10, s44, v10
    v_mov_b32 v8, s100
    v_mov_b32 v9, s101
    s_cmp_eq_u32 s4, 0
    s_cselect_b64 exec, 1, 0
    s_cbranch_execz L_tp
    global_store_dwordx3 v239, v[8:10], s[26:27] sc1
L_tp:
    s_mov_b64 exec, -1
    s_waitcnt vmcnt(16)
    s_barrier
    s_lshl2_add_u32 m0, s33, 32768
    s_nop 0
    buffer_load_dwordx4 v18, s[56:59], s82 offen offset:0 sc1 lds
    buffer_load_dwordx4 v18, s[56:59], s82 offen offset:1024 sc1 lds
    buffer_load_dwordx4 v18, s[56:59], s82 offen offset:2048 sc1 lds
    buffer_load_dwordx4 v18, s[56:59], s82 offen offset:3072 sc1 lds
    s_add_u32 s82, s82, 16384
    s_lshl1_add_u32 m0, s33, 49152
    s_nop 0
    buffer_load_dwordx4 v254, s[60:63], s83 offen lds
    s_lshl1_add_u32 m0, s33, 50176
    s_nop 0
    buffer_load_dwordx4 v255, s[60:63], s83 offen lds
    s_lshl1_add_u32 m0, s33, 57344
    s_nop 0
    buffer_load_dwordx4 v254, s[64:67], s83 offen lds
    s_lshl1_add_u32 m0, s33, 58368
    s_nop 0
    buffer_load_dwordx4 v255, s[64:67], s83 offen lds
    s_add_u32 s83, s83, 131072
    s_waitcnt vmcnt(16)
    s_barrier
    s_setprio 1
    ds_read_b64_tr_b16 v[40:41], v250 offset:16384
    ds_read_b64_tr_b16 v[42:43], v250 offset:16896
    ds_read_b128 v[24:27], v248 offset:0
    ds_read_b128 v[28:31], v248 offset:1024
    ds_read_b128 v[32:35], v248 offset:2048
    ds_read_b128 v[36:39], v248 offset:3072
    ds_read_b64_tr_b16 v[44:45], v251 offset:16384
    ds_read_b64_tr_b16 v[46:47], v251 offset:16896
    ds_read_b64_tr_b16 v[48:49], v250 offset:24576
    ds_read_b64_tr_b16 v[50:51], v250 offset:25088
    ds_read_b64_tr_b16 v[52:53], v251 offset:24576
    ds_read_b64_tr_b16 v[54:55], v251 offset:25088
    s_lshl2_add_u32 m0, s33, 65536
    s_nop 0
    buffer_load_dwordx4 v18, s[56:59], s82 offen offset:0 sc1 lds
    buffer_load_dwordx4 v18, s[56:59], s82 offen offset:1024 sc1 lds
    buffer_load_dwordx4 v18, s[56:59], s82 offen offset:2048 sc1 lds
    buffer_load_dwordx4 v18, s[56:59], s82 offen offset:3072 sc1 lds
    s_add_u32 s82, s82, 16384
    s_waitcnt lgkmcnt(9)
    v_mfma_f32_16x16x32_bf16 v[88:91], v[40:43], v[24:27], 0
    ds_read_b64_tr_b16 v[72:73], v250 offset:20480
    ds_read_b64_tr_b16 v[74:75], v250 offset:20992
    s_waitcnt lgkmcnt(10)
    v_mfma_f32_16x16x32_bf16 v[92:95], v[40:43], v[28:31], 0
    ds_read_b128 v[56:59], v248 offset:8192
    s_lshl1_add_u32 m0, s33, 81920
    s_waitcnt lgkmcnt(10)
    v_mfma_f32_16x16x32_bf16 v[96:99], v[40:43], v[32:35], 0
    ds_read_b128 v[60:63], v248 offset:9216
    ds_read_b128 v[64:67], v248 offset:10240
    s_waitcnt lgkmcnt(11)
    v_mfma_f32_16x16x32_bf16 v[100:103], v[40:43], v[36:39], 0
    ds_read_b128 v[68:71], v248 offset:11264
    buffer_load_dwordx4 v254, s[60:63], s83 offen lds
    s_waitcnt lgkmcnt(10)
    v_mfma_f32_16x16x32_bf16 v[104:107], v[44:47], v[24:27], 0
    ds_read_b64_tr_b16 v[76:77], v251 offset:20480
    ds_read_b64_tr_b16 v[78:79], v251 offset:20992
    v_mfma_f32_16x16x32_bf16 v[108:111], v[44:47], v[28:31], 0
    ds_read_b64_tr_b16 v[80:81], v250 offset:28672
    s_lshl1_add_u32 m0, s33, 82944
    v_mfma_f32_16x16x32_bf16 v[112:115], v[44:47], v[32:35], 0
    ds_read_b64_tr_b16 v[82:83], v250 offset:29184
    ds_read_b64_tr_b16 v[84:85], v251 offset:28672
    v_mfma_f32_16x16x32_bf16 v[116:119], v[44:47], v[36:39], 0
    ds_read_b64_tr_b16 v[86:87], v251 offset:29184
    buffer_load_dwordx4 v255, s[60:63], s83 offen lds
    s_waitcnt lgkmcnt(14)
    v_mfma_f32_16x16x32_bf16 v[120:123], v[48:51], v[24:27], 0
    v_mfma_f32_16x16x32_bf16 v[124:127], v[48:51], v[28:31], 0
    s_lshl1_add_u32 m0, s33, 90112
    v_mfma_f32_16x16x32_bf16 v[128:131], v[48:51], v[32:35], 0
    v_mfma_f32_16x16x32_bf16 v[132:135], v[48:51], v[36:39], 0
    buffer_load_dwordx4 v254, s[64:67], s83 offen lds
    s_waitcnt lgkmcnt(12)
    v_mfma_f32_16x16x32_bf16 v[136:139], v[52:55], v[24:27], 0
    v_mfma_f32_16x16x32_bf16 v[140:143], v[52:55], v[28:31], 0
    s_lshl1_add_u32 m0, s33, 91136
    v_mfma_f32_16x16x32_bf16 v[144:147], v[52:55], v[32:35], 0
    v_mfma_f32_16x16x32_bf16 v[148:151], v[52:55], v[36:39], 0
    buffer_load_dwordx4 v255, s[64:67], s83 offen lds
    s_add_u32 s83, s83, 131072
    s_waitcnt vmcnt(16) lgkmcnt(0)
    s_barrier
    v_mfma_f32_16x16x32_bf16 v[88:91], v[72:75], v[56:59], v[88:91]
    ds_read_b64_tr_b16 v[40:41], v252 offset:49152
    ds_read_b64_tr_b16 v[42:43], v252 offset:49664
    v_mfma_f32_16x16x32_bf16 v[92:95], v[72:75], v[60:63], v[92:95]
    ds_read_b128 v[24:27], v249 offset:32768
    s_lshl_b32 m0, s33, 2
    v_mfma_f32_16x16x32_bf16 v[96:99], v[72:75], v[64:67], v[96:99]
    ds_read_b128 v[28:31], v249 offset:33792
    v_mfma_f32_16x16x32_bf16 v[100:103], v[72:75], v[68:71], v[100:103]
    ds_read_b128 v[32:35], v249 offset:34816
    buffer_load_dwordx4 v18, s[56:59], s82 offen offset:0 sc1 lds
    v_mfma_f32_16x16x32_bf16 v[104:107], v[76:79], v[56:59], v[104:107]
    ds_read_b128 v[36:39], v249 offset:35840
    v_mfma_f32_16x16x32_bf16 v[108:111], v[76:79], v[60:63], v[108:111]
    ds_read_b64_tr_b16 v[44:45], v253 offset:49152
    ds_read_b64_tr_b16 v[46:47], v253 offset:49664
    v_mfma_f32_16x16x32_bf16 v[112:115], v[76:79], v[64:67], v[112:115]
    ds_read_b64_tr_b16 v[48:49], v252 offset:57344
    v_mfma_f32_16x16x32_bf16 v[116:119], v[76:79], v[68:71], v[116:119]
    ds_read_b64_tr_b16 v[50:51], v252 offset:57856
    buffer_load_dwordx4 v18, s[56:59], s82 offen offset:1024 sc1 lds
    v_mfma_f32_16x16x32_bf16 v[120:123], v[80:83], v[56:59], v[120:123]
    ds_read_b64_tr_b16 v[52:53], v253 offset:57344
    v_mfma_f32_16x16x32_bf16 v[124:127], v[80:83], v[60:63], v[124:127]
    ds_read_b64_tr_b16 v[54:55], v253 offset:57856
    v_mfma_f32_16x16x32_bf16 v[128:131], v[80:83], v[64:67], v[128:131]
    v_mfma_f32_16x16x32_bf16 v[132:135], v[80:83], v[68:71], v[132:135]
    buffer_load_dwordx4 v18, s[56:59], s82 offen offset:2048 sc1 lds
    v_mfma_f32_16x16x32_bf16 v[136:139], v[84:87], v[56:59], v[136:139]
    v_mfma_f32_16x16x32_bf16 v[140:143], v[84:87], v[60:63], v[140:143]
    v_mfma_f32_16x16x32_bf16 v[144:147], v[84:87], v[64:67], v[144:147]
    v_mfma_f32_16x16x32_bf16 v[148:151], v[84:87], v[68:71], v[148:151]
    buffer_load_dwordx4 v18, s[56:59], s82 offen offset:3072 sc1 lds
    s_add_u32 s82, s82, 16384
    s_waitcnt lgkmcnt(9)
    v_mfma_f32_16x16x32_bf16 v[88:91], v[40:43], v[24:27], v[88:91]
    ds_read_b64_tr_b16 v[72:73], v252 offset:53248
    ds_read_b64_tr_b16 v[74:75], v252 offset:53760
    s_waitcnt lgkmcnt(10)
    v_mfma_f32_16x16x32_bf16 v[92:95], v[40:43], v[28:31], v[92:95]
    ds_read_b128 v[56:59], v249 offset:40960
    s_lshl1_add_u32 m0, s33, 16384
    s_waitcnt lgkmcnt(10)
    v_mfma_f32_16x16x32_bf16 v[96:99], v[40:43], v[32:35], v[96:99]
    ds_read_b128 v[60:63], v249 offset:41984
    ds_read_b128 v[64:67], v249 offset:43008
    s_waitcnt lgkmcnt(11)
    v_mfma_f32_16x16x32_bf16 v[100:103], v[40:43], v[36:39], v[100:103]
    ds_read_b128 v[68:71], v249 offset:44032
    buffer_load_dwordx4 v254, s[60:63], s83 offen lds
    s_waitcnt lgkmcnt(10)
    v_mfma_f32_16x16x32_bf16 v[104:107], v[44:47], v[24:27], v[104:107]
    ds_read_b64_tr_b16 v[76:77], v253 offset:53248
    ds_read_b64_tr_b16 v[78:79], v253 offset:53760
    v_mfma_f32_16x16x32_bf16 v[108:111], v[44:47], v[28:31], v[108:111]
    ds_read_b64_tr_b16 v[80:81], v252 offset:61440
    s_lshl1_add_u32 m0, s33, 17408
    v_mfma_f32_16x16x32_bf16 v[112:115], v[44:47], v[32:35], v[112:115]
    ds_read_b64_tr_b16 v[82:83], v252 offset:61952
    ds_read_b64_tr_b16 v[84:85], v253 offset:61440
    v_mfma_f32_16x16x32_bf16 v[116:119], v[44:47], v[36:39], v[116:119]
    ds_read_b64_tr_b16 v[86:87], v253 offset:61952
    buffer_load_dwordx4 v255, s[60:63], s83 offen lds
    s_waitcnt lgkmcnt(14)
    v_mfma_f32_16x16x32_bf16 v[120:123], v[48:51], v[24:27], v[120:123]
    v_mfma_f32_16x16x32_bf16 v[124:127], v[48:51], v[28:31], v[124:127]
    s_lshl1_add_u32 m0, s33, 24576
    v_mfma_f32_16x16x32_bf16 v[128:131], v[48:51], v[32:35], v[128:131]
    v_mfma_f32_16x16x32_bf16 v[132:135], v[48:51], v[36:39], v[132:135]
    buffer_load_dwordx4 v254, s[64:67], s83 offen lds
    s_waitcnt lgkmcnt(12)
    v_mfma_f32_16x16x32_bf16 v[136:139], v[52:55], v[24:27], v[136:139]
    v_mfma_f32_16x16x32_bf16 v[140:143], v[52:55], v[28:31], v[140:143]
    s_lshl1_add_u32 m0, s33, 25600
    v_mfma_f32_16x16x32_bf16 v[144:147], v[52:55], v[32:35], v[144:147]
    v_mfma_f32_16x16x32_bf16 v[148:151], v[52:55], v[36:39], v[148:151]
    buffer_load_dwordx4 v255, s[64:67], s83 offen lds
    s_add_u32 s83, s83, 131072
    s_waitcnt vmcnt(16) lgkmcnt(0)
    s_barrier
    v_mfma_f32_16x16x32_bf16 v[88:91], v[72:75], v[56:59], v[88:91]
    ds_read_b64_tr_b16 v[40:41], v250 offset:49152
    ds_read_b64_tr_b16 v[42:43], v250 offset:49664
    v_mfma_f32_16x16x32_bf16 v[92:95], v[72:75], v[60:63], v[92:95]
    ds_read_b128 v[24:27], v248 offset:32768
    s_lshl2_add_u32 m0, s33, 98304
    v_mfma_f32_16x16x32_bf16 v[96:99], v[72:75], v[64:67], v[96:99]
    ds_read_b128 v[28:31], v248 offset:33792
    v_mfma_f32_16x16x32_bf16 v[100:103], v[72:75], v[68:71], v[100:103]
    ds_read_b128 v[32:35], v248 offset:34816
    buffer_load_dwordx4 v18, s[56:59], s82 offen offset:0 sc1 lds
    v_mfma_f32_16x16x32_bf16 v[104:107], v[76:79], v[56:59], v[104:107]
    ds_read_b128 v[36:39], v248 offset:35840
    v_mfma_f32_16x16x32_bf16 v[108:111], v[76:79], v[60:63], v[108:111]
    ds_read_b64_tr_b16 v[44:45], v251 offset:49152
    ds_read_b64_tr_b16 v[46:47], v251 offset:49664
    v_mfma_f32_16x16x32_bf16 v[112:115], v[76:79], v[64:67], v[112:115]
    ds_read_b64_tr_b16 v[48:49], v250 offset:57344
    v_mfma_f32_16x16x32_bf16 v[116:119], v[76:79], v[68:71], v[116:119]
    ds_read_b64_tr_b16 v[50:51], v250 offset:57856
    buffer_load_dwordx4 v18, s[56:59], s82 offen offset:1024 sc1 lds
    v_mfma_f32_16x16x32_bf16 v[120:123], v[80:83], v[56:59], v[120:123]
    ds_read_b64_tr_b16 v[52:53], v251 offset:57344
    v_mfma_f32_16x16x32_bf16 v[124:127], v[80:83], v[60:63], v[124:127]
    ds_read_b64_tr_b16 v[54:55], v251 offset:57856
    v_mfma_f32_16x16x32_bf16 v[128:131], v[80:83], v[64:67], v[128:131]
    v_mfma_f32_16x16x32_bf16 v[132:135], v[80:83], v[68:71], v[132:135]
    buffer_load_dwordx4 v18, s[56:59], s82 offen offset:2048 sc1 lds
    v_mfma_f32_16x16x32_bf16 v[136:139], v[84:87], v[56:59], v[136:139]
    v_mfma_f32_16x16x32_bf16 v[140:143], v[84:87], v[60:63], v[140:143]
    v_mfma_f32_16x16x32_bf16 v[144:147], v[84:87], v[64:67], v[144:147]
    v_mfma_f32_16x16x32_bf16 v[148:151], v[84:87], v[68:71], v[148:151]
    buffer_load_dwordx4 v18, s[56:59], s82 offen offset:3072 sc1 lds
    s_add_u32 s82, s82, 16384
    s_waitcnt lgkmcnt(9)
    v_mfma_f32_16x16x32_bf16 v[88:91], v[40:43], v[24:27], v[88:91]
    ds_read_b64_tr_b16 v[72:73], v250 offset:53248
    ds_read_b64_tr_b16 v[74:75], v250 offset:53760
    s_waitcnt lgkmcnt(10)
    v_mfma_f32_16x16x32_bf16 v[92:95], v[40:43], v[28:31], v[92:95]
    ds_read_b128 v[56:59], v248 offset:40960
    s_lshl1_add_u32 m0, s33, 114688
    s_waitcnt lgkmcnt(10)
    v_mfma_f32_16x16x32_bf16 v[96:99], v[40:43], v[32:35], v[96:99]
    ds_read_b128 v[60:63], v248 offset:41984
    ds_read_b128 v[64:67], v248 offset:43008
    s_waitcnt lgkmcnt(11)
    v_mfma_f32_16x16x32_bf16 v[100:103], v[40:43], v[36:39], v[100:103]
    ds_read_b128 v[68:71], v248 offset:44032
    buffer_load_dwordx4 v254, s[60:63], s83 offen lds
    s_waitcnt lgkmcnt(10)
    v_mfma_f32_16x16x32_bf16 v[104:107], v[44:47], v[24:27], v[104:107]
    ds_read_b64_tr_b16 v[76:77], v251 offset:53248
    ds_read_b64_tr_b16 v[78:79], v251 offset:53760
    v_mfma_f32_16x16x32_bf16 v[108:111], v[44:47], v[28:31], v[108:111]
    ds_read_b64_tr_b16 v[80:81], v250 offset:61440
    s_lshl1_add_u32 m0, s33, 115712
    v_mfma_f32_16x16x32_bf16 v[112:115], v[44:47], v[32:35], v[112:115]
    ds_read_b64_tr_b16 v[82:83], v250 offset:61952
    ds_read_b64_tr_b16 v[84:85], v251 offset:61440
    v_mfma_f32_16x16x32_bf16 v[116:119], v[44:47], v[36:39], v[116:119]
    ds_read_b64_tr_b16 v[86:87], v251 offset:61952
    buffer_load_dwordx4 v255, s[60:63], s83 offen lds
    s_waitcnt lgkmcnt(14)
    v_mfma_f32_16x16x32_bf16 v[120:123], v[48:51], v[24:27], v[120:123]
    v_mfma_f32_16x16x32_bf16 v[124:127], v[48:51], v[28:31], v[124:127]
    s_lshl1_add_u32 m0, s33, 122880
    v_mfma_f32_16x16x32_bf16 v[128:131], v[48:51], v[32:35], v[128:131]
    v_mfma_f32_16x16x32_bf16 v[132:135], v[48:51], v[36:39], v[132:135]
    buffer_load_dwordx4 v254, s[64:67], s83 offen lds
    s_waitcnt lgkmcnt(12)
    v_mfma_f32_16x16x32_bf16 v[136:139], v[52:55], v[24:27], v[136:139]
    v_mfma_f32_16x16x32_bf16 v[140:143], v[52:55], v[28:31], v[140:143]
    s_lshl1_add_u32 m0, s33, 123904
    v_mfma_f32_16x16x32_bf16 v[144:147], v[52:55], v[32:35], v[144:147]
    v_mfma_f32_16x16x32_bf16 v[148:151], v[52:55], v[36:39], v[148:151]
    buffer_load_dwordx4 v255, s[64:67], s83 offen lds
    s_add_u32 s83, s83, 131072
    s_waitcnt vmcnt(16) lgkmcnt(0)
    s_barrier
    v_mfma_f32_16x16x32_bf16 v[88:91], v[72:75], v[56:59], v[88:91]
    ds_read_b64_tr_b16 v[40:41], v252 offset:16384
    ds_read_b64_tr_b16 v[42:43], v252 offset:16896
    v_mfma_f32_16x16x32_bf16 v[92:95], v[72:75], v[60:63], v[92:95]
    ds_read_b128 v[24:27], v249 offset:0
    s_lshl2_add_u32 m0, s33, 32768
    v_mfma_f32_16x16x32_bf16 v[96:99], v[72:75], v[64:67], v[96:99]
    ds_read_b128 v[28:31], v249 offset:1024
    v_mfma_f32_16x16x32_bf16 v[100:103], v[72:75], v[68:71], v[100:103]
    ds_read_b128 v[32:35], v249 offset:2048
    buffer_load_dwordx4 v18, s[56:59], s82 offen offset:0 sc1 lds
    v_mfma_f32_16x16x32_bf16 v[104:107], v[76:79], v[56:59], v[104:107]
    ds_read_b128 v[36:39], v249 offset:3072
    v_mfma_f32_16x16x32_bf16 v[108:111], v[76:79], v[60:63], v[108:111]
    ds_read_b64_tr_b16 v[44:45], v253 offset:16384
    ds_read_b64_tr_b16 v[46:47], v253 offset:16896
    v_mfma_f32_16x16x32_bf16 v[112:115], v[76:79], v[64:67], v[112:115]
    ds_read_b64_tr_b16 v[48:49], v252 offset:24576
    v_mfma_f32_16x16x32_bf16 v[116:119], v[76:79], v[68:71], v[116:119]
    ds_read_b64_tr_b16 v[50:51], v252 offset:25088
    buffer_load_dwordx4 v18, s[56:59], s82 offen offset:1024 sc1 lds
    v_mfma_f32_16x16x32_bf16 v[120:123], v[80:83], v[56:59], v[120:123]
    ds_read_b64_tr_b16 v[52:53], v253 offset:24576
    v_mfma_f32_16x16x32_bf16 v[124:127], v[80:83], v[60:63], v[124:127]
    ds_read_b64_tr_b16 v[54:55], v253 offset:25088
    v_mfma_f32_16x16x32_bf16 v[128:131], v[80:83], v[64:67], v[128:131]
    v_mfma_f32_16x16x32_bf16 v[132:135], v[80:83], v[68:71], v[132:135]
    buffer_load_dwordx4 v18, s[56:59], s82 offen offset:2048 sc1 lds
    v_mfma_f32_16x16x32_bf16 v[136:139], v[84:87], v[56:59], v[136:139]
    v_mfma_f32_16x16x32_bf16 v[140:143], v[84:87], v[60:63], v[140:143]
    v_mfma_f32_16x16x32_bf16 v[144:147], v[84:87], v[64:67], v[144:147]
    v_mfma_f32_16x16x32_bf16 v[148:151], v[84:87], v[68:71], v[148:151]
    buffer_load_dwordx4 v18, s[56:59], s82 offen offset:3072 sc1 lds
    s_add_u32 s82, s82, 16384
    s_waitcnt lgkmcnt(9)
    v_mfma_f32_16x16x32_bf16 v[88:91], v[40:43], v[24:27], v[88:91]
    ds_read_b64_tr_b16 v[72:73], v252 offset:20480
    ds_read_b64_tr_b16 v[74:75], v252 offset:20992
    s_waitcnt lgkmcnt(10)
    v_mfma_f32_16x16x32_bf16 v[92:95], v[40:43], v[28:31], v[92:95]
    ds_read_b128 v[56:59], v249 offset:8192
    s_lshl1_add_u32 m0, s33, 49152
    s_waitcnt lgkmcnt(10)
    v_mfma_f32_16x16x32_bf16 v[96:99], v[40:43], v[32:35], v[96:99]
    ds_read_b128 v[60:63], v249 offset:9216
    ds_read_b128 v[64:67], v249 offset:10240
    s_waitcnt lgkmcnt(11)
    v_mfma_f32_16x16x32_bf16 v[100:103], v[40:43], v[36:39], v[100:103]
    ds_read_b128 v[68:71], v249 offset:11264
    buffer_load_dwordx4 v254, s[60:63], s83 offen lds
    s_waitcnt lgkmcnt(10)
    v_mfma_f32_16x16x32_bf16 v[104:107], v[44:47], v[24:27], v[104:107]
    ds_read_b64_tr_b16 v[76:77], v253 offset:20480
    ds_read_b64_tr_b16 v[78:79], v253 offset:20992
    v_mfma_f32_16x16x32_bf16 v[108:111], v[44:47], v[28:31], v[108:111]
    ds_read_b64_tr_b16 v[80:81], v252 offset:28672
    s_lshl1_add_u32 m0, s33, 50176
    v_mfma_f32_16x16x32_bf16 v[112:115], v[44:47], v[32:35], v[112:115]
    ds_read_b64_tr_b16 v[82:83], v252 offset:29184
    ds_read_b64_tr_b16 v[84:85], v253 offset:28672
    v_mfma_f32_16x16x32_bf16 v[116:119], v[44:47], v[36:39], v[116:119]
    ds_read_b64_tr_b16 v[86:87], v253 offset:29184
    buffer_load_dwordx4 v255, s[60:63], s83 offen lds
    s_waitcnt lgkmcnt(14)
    v_mfma_f32_16x16x32_bf16 v[120:123], v[48:51], v[24:27], v[120:123]
    v_mfma_f32_16x16x32_bf16 v[124:127], v[48:51], v[28:31], v[124:127]
    s_lshl1_add_u32 m0, s33, 57344
    v_mfma_f32_16x16x32_bf16 v[128:131], v[48:51], v[32:35], v[128:131]
    v_mfma_f32_16x16x32_bf16 v[132:135], v[48:51], v[36:39], v[132:135]
    buffer_load_dwordx4 v254, s[64:67], s83 offen lds
    s_waitcnt lgkmcnt(12)
    v_mfma_f32_16x16x32_bf16 v[136:139], v[52:55], v[24:27], v[136:139]
    v_mfma_f32_16x16x32_bf16 v[140:143], v[52:55], v[28:31], v[140:143]
    s_lshl1_add_u32 m0, s33, 58368
    v_mfma_f32_16x16x32_bf16 v[144:147], v[52:55], v[32:35], v[144:147]
    v_mfma_f32_16x16x32_bf16 v[148:151], v[52:55], v[36:39], v[148:151]
    buffer_load_dwordx4 v255, s[64:67], s83 offen lds
    s_add_u32 s83, s83, 131072
    s_waitcnt vmcnt(16) lgkmcnt(0)
    s_barrier
    v_mfma_f32_16x16x32_bf16 v[88:91], v[72:75], v[56:59], v[88:91]
    ds_read_b64_tr_b16 v[40:41], v250 offset:16384
    ds_read_b64_tr_b16 v[42:43], v250 offset:16896
    v_mfma_f32_16x16x32_bf16 v[92:95], v[72:75], v[60:63], v[92:95]
    ds_read_b128 v[24:27], v248 offset:0
    s_lshl2_add_u32 m0, s33, 65536
    v_mfma_f32_16x16x32_bf16 v[96:99], v[72:75], v[64:67], v[96:99]
    ds_read_b128 v[28:31], v248 offset:1024
    v_mfma_f32_16x16x32_bf16 v[100:103], v[72:75], v[68:71], v[100:103]
    ds_read_b128 v[32:35], v248 offset:2048
    buffer_load_dwordx4 v18, s[56:59], s82 offen offset:0 sc1 lds
    v_mfma_f32_16x16x32_bf16 v[104:107], v[76:79], v[56:59], v[104:107]
    ds_read_b128 v[36:39], v248 offset:3072
    v_mfma_f32_16x16x32_bf16 v[108:111], v[76:79], v[60:63], v[108:111]
    ds_read_b64_tr_b16 v[44:45], v251 offset:16384
    ds_read_b64_tr_b16 v[46:47], v251 offset:16896
    v_mfma_f32_16x16x32_bf16 v[112:115], v[76:79], v[64:67], v[112:115]
    ds_read_b64_tr_b16 v[48:49], v250 offset:24576
    v_mfma_f32_16x16x32_bf16 v[116:119], v[76:79], v[68:71], v[116:119]
    ds_read_b64_tr_b16 v[50:51], v250 offset:25088
    buffer_load_dwordx4 v18, s[56:59], s82 offen offset:1024 sc1 lds
    v_mfma_f32_16x16x32_bf16 v[120:123], v[80:83], v[56:59], v[120:123]
    ds_read_b64_tr_b16 v[52:53], v251 offset:24576
    v_mfma_f32_16x16x32_bf16 v[124:127], v[80:83], v[60:63], v[124:127]
    ds_read_b64_tr_b16 v[54:55], v251 offset:25088
    v_mfma_f32_16x16x32_bf16 v[128:131], v[80:83], v[64:67], v[128:131]
    v_mfma_f32_16x16x32_bf16 v[132:135], v[80:83], v[68:71], v[132:135]
    buffer_load_dwordx4 v18, s[56:59], s82 offen offset:2048 sc1 lds
    v_mfma_f32_16x16x32_bf16 v[136:139], v[84:87], v[56:59], v[136:139]
    v_mfma_f32_16x16x32_bf16 v[140:143], v[84:87], v[60:63], v[140:143]
    v_mfma_f32_16x16x32_bf16 v[144:147], v[84:87], v[64:67], v[144:147]
    v_mfma_f32_16x16x32_bf16 v[148:151], v[84:87], v[68:71], v[148:151]
    buffer_load_dwordx4 v18, s[56:59], s82 offen offset:3072 sc1 lds
    s_add_u32 s82, s82, 16384
    s_waitcnt lgkmcnt(9)
    v_mfma_f32_16x16x32_bf16 v[88:91], v[40:43], v[24:27], v[88:91]
    ds_read_b64_tr_b16 v[72:73], v250 offset:20480
    ds_read_b64_tr_b16 v[74:75], v250 offset:20992
    s_waitcnt lgkmcnt(10)
    v_mfma_f32_16x16x32_bf16 v[92:95], v[40:43], v[28:31], v[92:95]
    ds_read_b128 v[56:59], v248 offset:8192
    s_lshl1_add_u32 m0, s33, 81920
    s_waitcnt lgkmcnt(10)
    v_mfma_f32_16x16x32_bf16 v[96:99], v[40:43], v[32:35], v[96:99]
    ds_read_b128 v[60:63], v248 offset:9216
    ds_read_b128 v[64:67], v248 offset:10240
    s_waitcnt lgkmcnt(11)
    v_mfma_f32_16x16x32_bf16 v[100:103], v[40:43], v[36:39], v[100:103]
    ds_read_b128 v[68:71], v248 offset:11264
L_pad4:
    s_cbranch_execz L_vret2
    buffer_load_dwordx4 v254, s[60:63], s83 offen lds
    s_waitcnt lgkmcnt(10)
    v_mfma_f32_16x16x32_bf16 v[104:107], v[44:47], v[24:27], v[104:107]
    ds_read_b64_tr_b16 v[76:77], v251 offset:20480
    ds_read_b64_tr_b16 v[78:79], v251 offset:20992
    v_mfma_f32_16x16x32_bf16 v[108:111], v[44:47], v[28:31], v[108:111]
    ds_read_b64_tr_b16 v[80:81], v250 offset:28672
    s_lshl1_add_u32 m0, s33, 82944
    v_mfma_f32_16x16x32_bf16 v[112:115], v[44:47], v[32:35], v[112:115]
    ds_read_b64_tr_b16 v[82:83], v250 offset:29184
    ds_read_b64_tr_b16 v[84:85], v251 offset:28672
    v_mfma_f32_16x16x32_bf16 v[116:119], v[44:47], v[36:39], v[116:119]
    ds_read_b64_tr_b16 v[86:87], v251 offset:29184
    buffer_load_dwordx4 v255, s[60:63], s83 offen lds
    s_waitcnt lgkmcnt(14)
    v_mfma_f32_16x16x32_bf16 v[120:123], v[48:51], v[24:27], v[120:123]
    v_mfma_f32_16x16x32_bf16 v[124:127], v[48:51], v[28:31], v[124:127]
    s_lshl1_add_u32 m0, s33, 90112
    v_mfma_f32_16x16x32_bf16 v[128:131], v[48:51], v[32:35], v[128:131]
    v_mfma_f32_16x16x32_bf16 v[132:135], v[48:51], v[36:39], v[132:135]
    buffer_load_dwordx4 v254, s[64:67], s83 offen lds
    s_waitcnt lgkmcnt(12)
    v_mfma_f32_16x16x32_bf16 v[136:139], v[52:55], v[24:27], v[136:139]
    v_mfma_f32_16x16x32_bf16 v[140:143], v[52:55], v[28:31], v[140:143]
    s_lshl1_add_u32 m0, s33, 91136
    v_mfma_f32_16x16x32_bf16 v[144:147], v[52:55], v[32:35], v[144:147]
    v_mfma_f32_16x16x32_bf16 v[148:151], v[52:55], v[36:39], v[148:151]
    buffer_load_dwordx4 v255, s[64:67], s83 offen lds
    s_add_u32 s83, s83, 131072
    s_waitcnt vmcnt(16) lgkmcnt(0)
    s_barrier
    v_mfma_f32_16x16x32_bf16 v[88:91], v[72:75], v[56:59], v[88:91]
    ds_read_b64_tr_b16 v[40:41], v252 offset:49152
    ds_read_b64_tr_b16 v[42:43], v252 offset:49664
    v_mfma_f32_16x16x32_bf16 v[92:95], v[72:75], v[60:63], v[92:95]
    ds_read_b128 v[24:27], v249 offset:32768
    s_lshl_b32 m0, s33, 2
    v_mfma_f32_16x16x32_bf16 v[96:99], v[72:75], v[64:67], v[96:99]
    ds_read_b128 v[28:31], v249 offset:33792
    v_mfma_f32_16x16x32_bf16 v[100:103], v[72:75], v[68:71], v[100:103]
    ds_read_b128 v[32:35], v249 offset:34816
    buffer_load_dwordx4 v18, s[56:59], s82 offen offset:0 sc1 lds
    v_mfma_f32_16x16x32_bf16 v[104:107], v[76:79], v[56:59], v[104:107]
    ds_read_b128 v[36:39], v249 offset:35840
    v_mfma_f32_16x16x32_bf16 v[108:111], v[76:79], v[60:63], v[108:111]
    ds_read_b64_tr_b16 v[44:45], v253 offset:49152
    ds_read_b64_tr_b16 v[46:47], v253 offset:49664
    v_mfma_f32_16x16x32_bf16 v[112:115], v[76:79], v[64:67], v[112:115]
    ds_read_b64_tr_b16 v[48:49], v252 offset:57344
    v_mfma_f32_16x16x32_bf16 v[116:119], v[76:79], v[68:71], v[116:119]
    ds_read_b64_tr_b16 v[50:51], v252 offset:57856
    buffer_load_dwordx4 v18, s[56:59], s82 offen offset:1024 sc1 lds
    v_mfma_f32_16x16x32_bf16 v[120:123], v[80:83], v[56:59], v[120:123]
    ds_read_b64_tr_b16 v[52:53], v253 offset:57344
    v_mfma_f32_16x16x32_bf16 v[124:127], v[80:83], v[60:63], v[124:127]
    ds_read_b64_tr_b16 v[54:55], v253 offset:57856
    v_mfma_f32_16x16x32_bf16 v[128:131], v[80:83], v[64:67], v[128:131]
    v_mfma_f32_16x16x32_bf16 v[132:135], v[80:83], v[68:71], v[132:135]
    buffer_load_dwordx4 v18, s[56:59], s82 offen offset:2048 sc1 lds
    v_mfma_f32_16x16x32_bf16 v[136:139], v[84:87], v[56:59], v[136:139]
    v_mfma_f32_16x16x32_bf16 v[140:143], v[84:87], v[60:63], v[140:143]
    v_mfma_f32_16x16x32_bf16 v[144:147], v[84:87], v[64:67], v[144:147]
    v_mfma_f32_16x16x32_bf16 v[148:151], v[84:87], v[68:71], v[148:151]
    buffer_load_dwordx4 v18, s[56:59], s82 offen offset:3072 sc1 lds
    s_add_u32 s82, s82, 16384
    s_waitcnt lgkmcnt(9)
    v_mfma_f32_16x16x32_bf16 v[88:91], v[40:43], v[24:27], v[88:91]
    ds_read_b64_tr_b16 v[72:73], v252 offset:53248
    ds_read_b64_tr_b16 v[74:75], v252 offset:53760
    s_waitcnt lgkmcnt(10)
    v_mfma_f32_16x16x32_bf16 v[92:95], v[40:43], v[28:31], v[92:95]
    ds_read_b128 v[56:59], v249 offset:40960
    s_lshl1_add_u32 m0, s33, 16384
    s_waitcnt lgkmcnt(10)
    v_mfma_f32_16x16x32_bf16 v[96:99], v[40:43], v[32:35], v[96:99]
    ds_read_b128 v[60:63], v249 offset:41984
    ds_read_b128 v[64:67], v249 offset:43008
    s_waitcnt lgkmcnt(11)
    v_mfma_f32_16x16x32_bf16 v[100:103], v[40:43], v[36:39], v[100:103]
    ds_read_b128 v[68:71], v249 offset:44032
    buffer_load_dwordx4 v254, s[60:63], s83 offen lds
    s_waitcnt lgkmcnt(10)
    v_mfma_f32_16x16x32_bf16 v[104:107], v[44:47], v[24:27], v[104:107]
    ds_read_b64_tr_b16 v[76:77], v253 offset:53248
    ds_read_b64_tr_b16 v[78:79], v253 offset:53760
    v_mfma_f32_16x16x32_bf16 v[108:111], v[44:47], v[28:31], v[108:111]
    ds_read_b64_tr_b16 v[80:81], v252 offset:61440
    s_lshl1_add_u32 m0, s33, 17408
    v_mfma_f32_16x16x32_bf16 v[112:115], v[44:47], v[32:35], v[112:115]
    ds_read_b64_tr_b16 v[82:83], v252 offset:61952
    ds_read_b64_tr_b16 v[84:85], v253 offset:61440
    v_mfma_f32_16x16x32_bf16 v[116:119], v[44:47], v[36:39], v[116:119]
    ds_read_b64_tr_b16 v[86:87], v253 offset:61952
    buffer_load_dwordx4 v255, s[60:63], s83 offen lds
    s_waitcnt lgkmcnt(14)
    v_mfma_f32_16x16x32_bf16 v[120:123], v[48:51], v[24:27], v[120:123]
    v_mfma_f32_16x16x32_bf16 v[124:127], v[48:51], v[28:31], v[124:127]
    s_lshl1_add_u32 m0, s33, 24576
    v_mfma_f32_16x16x32_bf16 v[128:131], v[48:51], v[32:35], v[128:131]
    v_mfma_f32_16x16x32_bf16 v[132:135], v[48:51], v[36:39], v[132:135]
    buffer_load_dwordx4 v254, s[64:67], s83 offen lds
    s_waitcnt lgkmcnt(12)
    v_mfma_f32_16x16x32_bf16 v[136:139], v[52:55], v[24:27], v[136:139]
    v_mfma_f32_16x16x32_bf16 v[140:143], v[52:55], v[28:31], v[140:143]
    s_lshl1_add_u32 m0, s33, 25600
    v_mfma_f32_16x16x32_bf16 v[144:147], v[52:55], v[32:35], v[144:147]
    v_mfma_f32_16x16x32_bf16 v[148:151], v[52:55], v[36:39], v[148:151]
    buffer_load_dwordx4 v255, s[64:67], s83 offen lds
    s_add_u32 s83, s83, 131072
    s_waitcnt vmcnt(16) lgkmcnt(0)
    s_barrier
    v_mfma_f32_16x16x32_bf16 v[88:91], v[72:75], v[56:59], v[88:91]
    ds_read_b64_tr_b16 v[40:41], v250 offset:49152
    ds_read_b64_tr_b16 v[42:43], v250 offset:49664
    v_mfma_f32_16x16x32_bf16 v[92:95], v[72:75], v[60:63], v[92:95]
    ds_read_b128 v[24:27], v248 offset:32768
    s_lshl2_add_u32 m0, s33, 98304
    v_mfma_f32_16x16x32_bf16 v[96:99], v[72:75], v[64:67], v[96:99]
    ds_read_b128 v[28:31], v248 offset:33792
    v_mfma_f32_16x16x32_bf16 v[100:103], v[72:75], v[68:71], v[100:103]
    ds_read_b128 v[32:35], v248 offset:34816
    buffer_load_dwordx4 v18, s[56:59], s82 offen offset:0 sc1 lds
    v_mfma_f32_16x16x32_bf16 v[104:107], v[76:79], v[56:59], v[104:107]
    ds_read_b128 v[36:39], v248 offset:35840
    v_mfma_f32_16x16x32_bf16 v[108:111], v[76:79], v[60:63], v[108:111]
    ds_read_b64_tr_b16 v[44:45], v251 offset:49152
    ds_read_b64_tr_b16 v[46:47], v251 offset:49664
    v_mfma_f32_16x16x32_bf16 v[112:115], v[76:79], v[64:67], v[112:115]
    ds_read_b64_tr_b16 v[48:49], v250 offset:57344
    v_mfma_f32_16x16x32_bf16 v[116:119], v[76:79], v[68:71], v[116:119]
    ds_read_b64_tr_b16 v[50:51], v250 offset:57856
    buffer_load_dwordx4 v18, s[56:59], s82 offen offset:1024 sc1 lds
    v_mfma_f32_16x16x32_bf16 v[120:123], v[80:83], v[56:59], v[120:123]
    ds_read_b64_tr_b16 v[52:53], v251 offset:57344
    v_mfma_f32_16x16x32_bf16 v[124:127], v[80:83], v[60:63], v[124:127]
    ds_read_b64_tr_b16 v[54:55], v251 offset:57856
    v_mfma_f32_16x16x32_bf16 v[128:131], v[80:83], v[64:67], v[128:131]
    v_mfma_f32_16x16x32_bf16 v[132:135], v[80:83], v[68:71], v[132:135]
    buffer_load_dwordx4 v18, s[56:59], s82 offen offset:2048 sc1 lds
    v_mfma_f32_16x16x32_bf16 v[136:139], v[84:87], v[56:59], v[136:139]
    v_mfma_f32_16x16x32_bf16 v[140:143], v[84:87], v[60:63], v[140:143]
    v_mfma_f32_16x16x32_bf16 v[144:147], v[84:87], v[64:67], v[144:147]
    v_mfma_f32_16x16x32_bf16 v[148:151], v[84:87], v[68:71], v[148:151]
    buffer_load_dwordx4 v18, s[56:59], s82 offen offset:3072 sc1 lds
    s_add_u32 s82, s82, 16384
    s_waitcnt lgkmcnt(9)
    v_mfma_f32_16x16x32_bf16 v[88:91], v[40:43], v[24:27], v[88:91]
    ds_read_b64_tr_b16 v[72:73], v250 offset:53248
    ds_read_b64_tr_b16 v[74:75], v250 offset:53760
    s_waitcnt lgkmcnt(10)
    v_mfma_f32_16x16x32_bf16 v[92:95], v[40:43], v[28:31], v[92:95]
    ds_read_b128 v[56:59], v248 offset:40960
    s_lshl1_add_u32 m0, s33, 114688
    s_waitcnt lgkmcnt(10)
    v_mfma_f32_16x16x32_bf16 v[96:99], v[40:43], v[32:35], v[96:99]
    ds_read_b128 v[60:63], v248 offset:41984
    ds_read_b128 v[64:67], v248 offset:43008
    s_waitcnt lgkmcnt(11)
    v_mfma_f32_16x16x32_bf16 v[100:103], v[40:43], v[36:39], v[100:103]
    ds_read_b128 v[68:71], v248 offset:44032
    buffer_load_dwordx4 v254, s[60:63], s83 offen lds
    s_waitcnt lgkmcnt(10)
    v_mfma_f32_16x16x32_bf16 v[104:107], v[44:47], v[24:27], v[104:107]
    ds_read_b64_tr_b16 v[76:77], v251 offset:53248
    ds_read_b64_tr_b16 v[78:79], v251 offset:53760
    v_mfma_f32_16x16x32_bf16 v[108:111], v[44:47], v[28:31], v[108:111]
    ds_read_b64_tr_b16 v[80:81], v250 offset:61440
    s_lshl1_add_u32 m0, s33, 115712
    v_mfma_f32_16x16x32_bf16 v[112:115], v[44:47], v[32:35], v[112:115]
    ds_read_b64_tr_b16 v[82:83], v250 offset:61952
    ds_read_b64_tr_b16 v[84:85], v251 offset:61440
    v_mfma_f32_16x16x32_bf16 v[116:119], v[44:47], v[36:39], v[116:119]
    ds_read_b64_tr_b16 v[86:87], v251 offset:61952
    buffer_load_dwordx4 v255, s[60:63], s83 offen lds
    s_waitcnt lgkmcnt(14)
    v_mfma_f32_16x16x32_bf16 v[120:123], v[48:51], v[24:27], v[120:123]
    v_mfma_f32_16x16x32_bf16 v[124:127], v[48:51], v[28:31], v[124:127]
    s_lshl1_add_u32 m0, s33, 122880
    v_mfma_f32_16x16x32_bf16 v[128:131], v[48:51], v[32:35], v[128:131]
    v_mfma_f32_16x16x32_bf16 v[132:135], v[48:51], v[36:39], v[132:135]
    buffer_load_dwordx4 v254, s[64:67], s83 offen lds
    s_waitcnt lgkmcnt(12)
    v_mfma_f32_16x16x32_bf16 v[136:139], v[52:55], v[24:27], v[136:139]
    v_mfma_f32_16x16x32_bf16 v[140:143], v[52:55], v[28:31], v[140:143]
    s_lshl1_add_u32 m0, s33, 123904
    v_mfma_f32_16x16x32_bf16 v[144:147], v[52:55], v[32:35], v[144:147]
    v_mfma_f32_16x16x32_bf16 v[148:151], v[52:55], v[36:39], v[148:151]
    buffer_load_dwordx4 v255, s[64:67], s83 offen lds
    s_add_u32 s83, s83, 131072
    s_waitcnt vmcnt(16) lgkmcnt(0)
    s_barrier
    v_mfma_f32_16x16x32_bf16 v[88:91], v[72:75], v[56:59], v[88:91]
    ds_read_b64_tr_b16 v[40:41], v252 offset:16384
    ds_read_b64_tr_b16 v[42:43], v252 offset:16896
    v_mfma_f32_16x16x32_bf16 v[92:95], v[72:75], v[60:63], v[92:95]
    ds_read_b128 v[24:27], v249 offset:0
    s_lshl2_add_u32 m0, s33, 32768
    v_mfma_f32_16x16x32_bf16 v[96:99], v[72:75], v[64:67], v[96:99]
    ds_read_b128 v[28:31], v249 offset:1024
    v_mfma_f32_16x16x32_bf16 v[100:103], v[72:75], v[68:71], v[100:103]
    ds_read_b128 v[32:35], v249 offset:2048
    buffer_load_dwordx4 v18, s[56:59], s82 offen offset:0 sc1 lds
    v_mfma_f32_16x16x32_bf16 v[104:107], v[76:79], v[56:59], v[104:107]
    ds_read_b128 v[36:39], v249 offset:3072
    v_mfma_f32_16x16x32_bf16 v[108:111], v[76:79], v[60:63], v[108:111]
    ds_read_b64_tr_b16 v[44:45], v253 offset:16384
    ds_read_b64_tr_b16 v[46:47], v253 offset:16896
    v_mfma_f32_16x16x32_bf16 v[112:115], v[76:79], v[64:67], v[112:115]
    ds_read_b64_tr_b16 v[48:49], v252 offset:24576
    v_mfma_f32_16x16x32_bf16 v[116:119], v[76:79], v[68:71], v[116:119]
    ds_read_b64_tr_b16 v[50:51], v252 offset:25088
    buffer_load_dwordx4 v18, s[56:59], s82 offen offset:1024 sc1 lds
    v_mfma_f32_16x16x32_bf16 v[120:123], v[80:83], v[56:59], v[120:123]
    ds_read_b64_tr_b16 v[52:53], v253 offset:24576
    v_mfma_f32_16x16x32_bf16 v[124:127], v[80:83], v[60:63], v[124:127]
    ds_read_b64_tr_b16 v[54:55], v253 offset:25088
    v_mfma_f32_16x16x32_bf16 v[128:131], v[80:83], v[64:67], v[128:131]
    v_mfma_f32_16x16x32_bf16 v[132:135], v[80:83], v[68:71], v[132:135]
    buffer_load_dwordx4 v18, s[56:59], s82 offen offset:2048 sc1 lds
    v_mfma_f32_16x16x32_bf16 v[136:139], v[84:87], v[56:59], v[136:139]
    v_mfma_f32_16x16x32_bf16 v[140:143], v[84:87], v[60:63], v[140:143]
    v_mfma_f32_16x16x32_bf16 v[144:147], v[84:87], v[64:67], v[144:147]
    v_mfma_f32_16x16x32_bf16 v[148:151], v[84:87], v[68:71], v[148:151]
    buffer_load_dwordx4 v18, s[56:59], s82 offen offset:3072 sc1 lds
    s_add_u32 s82, s82, 16384
    s_waitcnt lgkmcnt(9)
    v_mfma_f32_16x16x32_bf16 v[88:91], v[40:43], v[24:27], v[88:91]
    ds_read_b64_tr_b16 v[72:73], v252 offset:20480
    ds_read_b64_tr_b16 v[74:75], v252 offset:20992
    s_waitcnt lgkmcnt(10)
    v_mfma_f32_16x16x32_bf16 v[92:95], v[40:43], v[28:31], v[92:95]
    ds_read_b128 v[56:59], v249 offset:8192
    s_lshl1_add_u32 m0, s33, 49152
    s_waitcnt lgkmcnt(10)
    v_mfma_f32_16x16x32_bf16 v[96:99], v[40:43], v[32:35], v[96:99]
    ds_read_b128 v[60:63], v249 offset:9216
    ds_read_b128 v[64:67], v249 offset:10240
    s_waitcnt lgkmcnt(11)
    v_mfma_f32_16x16x32_bf16 v[100:103], v[40:43], v[36:39], v[100:103]
    ds_read_b128 v[68:71], v249 offset:11264
    buffer_load_dwordx4 v254, s[60:63], s83 offen lds
    s_waitcnt lgkmcnt(10)
    v_mfma_f32_16x16x32_bf16 v[104:107], v[44:47], v[24:27], v[104:107]
    ds_read_b64_tr_b16 v[76:77], v253 offset:20480
    ds_read_b64_tr_b16 v[78:79], v253 offset:20992
    v_mfma_f32_16x16x32_bf16 v[108:111], v[44:47], v[28:31], v[108:111]
    ds_read_b64_tr_b16 v[80:81], v252 offset:28672
    s_lshl1_add_u32 m0, s33, 50176
    v_mfma_f32_16x16x32_bf16 v[112:115], v[44:47], v[32:35], v[112:115]
    ds_read_b64_tr_b16 v[82:83], v252 offset:29184
    ds_read_b64_tr_b16 v[84:85], v253 offset:28672
    v_mfma_f32_16x16x32_bf16 v[116:119], v[44:47], v[36:39], v[116:119]
    ds_read_b64_tr_b16 v[86:87], v253 offset:29184
    buffer_load_dwordx4 v255, s[60:63], s83 offen lds
    s_waitcnt lgkmcnt(14)
    v_mfma_f32_16x16x32_bf16 v[120:123], v[48:51], v[24:27], v[120:123]
    v_mfma_f32_16x16x32_bf16 v[124:127], v[48:51], v[28:31], v[124:127]
    s_lshl1_add_u32 m0, s33, 57344
    v_mfma_f32_16x16x32_bf16 v[128:131], v[48:51], v[32:35], v[128:131]
    v_mfma_f32_16x16x32_bf16 v[132:135], v[48:51], v[36:39], v[132:135]
    buffer_load_dwordx4 v254, s[64:67], s83 offen lds
    s_waitcnt lgkmcnt(12)
    v_mfma_f32_16x16x32_bf16 v[136:139], v[52:55], v[24:27], v[136:139]
    v_mfma_f32_16x16x32_bf16 v[140:143], v[52:55], v[28:31], v[140:143]
    s_lshl1_add_u32 m0, s33, 58368
    v_mfma_f32_16x16x32_bf16 v[144:147], v[52:55], v[32:35], v[144:147]
    v_mfma_f32_16x16x32_bf16 v[148:151], v[52:55], v[36:39], v[148:151]
    buffer_load_dwordx4 v255, s[64:67], s83 offen lds
    s_add_u32 s83, s83, 131072
    s_waitcnt vmcnt(16) lgkmcnt(0)
    s_barrier
    v_mfma_f32_16x16x32_bf16 v[88:91], v[72:75], v[56:59], v[88:91]
    ds_read_b64_tr_b16 v[40:41], v250 offset:16384
    ds_read_b64_tr_b16 v[42:43], v250 offset:16896
    v_mfma_f32_16x16x32_bf16 v[92:95], v[72:75], v[60:63], v[92:95]
    ds_read_b128 v[24:27], v248 offset:0
    s_lshl2_add_u32 m0, s33, 65536
    v_mfma_f32_16x16x32_bf16 v[96:99], v[72:75], v[64:67], v[96:99]
    ds_read_b128 v[28:31], v248 offset:1024
    v_mfma_f32_16x16x32_bf16 v[100:103], v[72:75], v[68:71], v[100:103]
    ds_read_b128 v[32:35], v248 offset:2048
    buffer_load_dwordx4 v18, s[56:59], s82 offen offset:0 sc1 lds
    v_mfma_f32_16x16x32_bf16 v[104:107], v[76:79], v[56:59], v[104:107]
    ds_read_b128 v[36:39], v248 offset:3072
    v_mfma_f32_16x16x32_bf16 v[108:111], v[76:79], v[60:63], v[108:111]
    ds_read_b64_tr_b16 v[44:45], v251 offset:16384
    ds_read_b64_tr_b16 v[46:47], v251 offset:16896
    v_mfma_f32_16x16x32_bf16 v[112:115], v[76:79], v[64:67], v[112:115]
    ds_read_b64_tr_b16 v[48:49], v250 offset:24576
    v_mfma_f32_16x16x32_bf16 v[116:119], v[76:79], v[68:71], v[116:119]
    ds_read_b64_tr_b16 v[50:51], v250 offset:25088
    buffer_load_dwordx4 v18, s[56:59], s82 offen offset:1024 sc1 lds
    v_mfma_f32_16x16x32_bf16 v[120:123], v[80:83], v[56:59], v[120:123]
    ds_read_b64_tr_b16 v[52:53], v251 offset:24576
    v_mfma_f32_16x16x32_bf16 v[124:127], v[80:83], v[60:63], v[124:127]
    ds_read_b64_tr_b16 v[54:55], v251 offset:25088
    v_mfma_f32_16x16x32_bf16 v[128:131], v[80:83], v[64:67], v[128:131]
    v_mfma_f32_16x16x32_bf16 v[132:135], v[80:83], v[68:71], v[132:135]
    buffer_load_dwordx4 v18, s[56:59], s82 offen offset:2048 sc1 lds
    v_mfma_f32_16x16x32_bf16 v[136:139], v[84:87], v[56:59], v[136:139]
    v_mfma_f32_16x16x32_bf16 v[140:143], v[84:87], v[60:63], v[140:143]
    v_mfma_f32_16x16x32_bf16 v[144:147], v[84:87], v[64:67], v[144:147]
    v_mfma_f32_16x16x32_bf16 v[148:151], v[84:87], v[68:71], v[148:151]
    buffer_load_dwordx4 v18, s[56:59], s82 offen offset:3072 sc1 lds
    s_add_u32 s82, s82, 16384
    s_waitcnt lgkmcnt(9)
    v_mfma_f32_16x16x32_bf16 v[88:91], v[40:43], v[24:27], v[88:91]
    ds_read_b64_tr_b16 v[72:73], v250 offset:20480
    ds_read_b64_tr_b16 v[74:75], v250 offset:20992
    s_waitcnt lgkmcnt(10)
    v_mfma_f32_16x16x32_bf16 v[92:95], v[40:43], v[28:31], v[92:95]
    ds_read_b128 v[56:59], v248 offset:8192
    s_waitcnt lgkmcnt(10)
    v_mfma_f32_16x16x32_bf16 v[96:99], v[40:43], v[32:35], v[96:99]
    ds_read_b128 v[60:63], v248 offset:9216
    ds_read_b128 v[64:67], v248 offset:10240
    s_waitcnt lgkmcnt(11)
    v_mfma_f32_16x16x32_bf16 v[100:103], v[40:43], v[36:39], v[100:103]
    ds_read_b128 v[68:71], v248 offset:11264
    s_waitcnt lgkmcnt(10)
    v_mfma_f32_16x16x32_bf16 v[104:107], v[44:47], v[24:27], v[104:107]
    ds_read_b64_tr_b16 v[76:77], v251 offset:20480
    ds_read_b64_tr_b16 v[78:79], v251 offset:20992
    v_mfma_f32_16x16x32_bf16 v[108:111], v[44:47], v[28:31], v[108:111]
    ds_read_b64_tr_b16 v[80:81], v250 offset:28672
    v_mfma_f32_16x16x32_bf16 v[112:115], v[44:47], v[32:35], v[112:115]
    ds_read_b64_tr_b16 v[82:83], v250 offset:29184
    ds_read_b64_tr_b16 v[84:85], v251 offset:28672
    v_mfma_f32_16x16x32_bf16 v[116:119], v[44:47], v[36:39], v[116:119]
    ds_read_b64_tr_b16 v[86:87], v251 offset:29184
    s_waitcnt lgkmcnt(14)
    v_mfma_f32_16x16x32_bf16 v[120:123], v[48:51], v[24:27], v[120:123]
    v_mfma_f32_16x16x32_bf16 v[124:127], v[48:51], v[28:31], v[124:127]
    v_mfma_f32_16x16x32_bf16 v[128:131], v[48:51], v[32:35], v[128:131]
    v_mfma_f32_16x16x32_bf16 v[132:135], v[48:51], v[36:39], v[132:135]
    s_waitcnt lgkmcnt(12)
    v_mfma_f32_16x16x32_bf16 v[136:139], v[52:55], v[24:27], v[136:139]
    v_mfma_f32_16x16x32_bf16 v[140:143], v[52:55], v[28:31], v[140:143]
    v_mfma_f32_16x16x32_bf16 v[144:147], v[52:55], v[32:35], v[144:147]
    v_mfma_f32_16x16x32_bf16 v[148:151], v[52:55], v[36:39], v[148:151]
    s_waitcnt vmcnt(12) lgkmcnt(0)
    s_barrier
    v_mfma_f32_16x16x32_bf16 v[88:91], v[72:75], v[56:59], v[88:91]
    ds_read_b64_tr_b16 v[40:41], v252 offset:49152
    ds_read_b64_tr_b16 v[42:43], v252 offset:49664
    v_mfma_f32_16x16x32_bf16 v[92:95], v[72:75], v[60:63], v[92:95]
    ds_read_b128 v[24:27], v249 offset:32768
    v_mfma_f32_16x16x32_bf16 v[96:99], v[72:75], v[64:67], v[96:99]
    ds_read_b128 v[28:31], v249 offset:33792
    v_mfma_f32_16x16x32_bf16 v[100:103], v[72:75], v[68:71], v[100:103]
    ds_read_b128 v[32:35], v249 offset:34816
    v_mfma_f32_16x16x32_bf16 v[104:107], v[76:79], v[56:59], v[104:107]
    ds_read_b128 v[36:39], v249 offset:35840
    v_mfma_f32_16x16x32_bf16 v[108:111], v[76:79], v[60:63], v[108:111]
    ds_read_b64_tr_b16 v[44:45], v253 offset:49152
    ds_read_b64_tr_b16 v[46:47], v253 offset:49664
    v_mfma_f32_16x16x32_bf16 v[112:115], v[76:79], v[64:67], v[112:115]
    ds_read_b64_tr_b16 v[48:49], v252 offset:57344
    v_mfma_f32_16x16x32_bf16 v[116:119], v[76:79], v[68:71], v[116:119]
    ds_read_b64_tr_b16 v[50:51], v252 offset:57856
    v_mfma_f32_16x16x32_bf16 v[120:123], v[80:83], v[56:59], v[120:123]
    ds_read_b64_tr_b16 v[52:53], v253 offset:57344
    v_mfma_f32_16x16x32_bf16 v[124:127], v[80:83], v[60:63], v[124:127]
    ds_read_b64_tr_b16 v[54:55], v253 offset:57856
    v_mfma_f32_16x16x32_bf16 v[128:131], v[80:83], v[64:67], v[128:131]
    v_mfma_f32_16x16x32_bf16 v[132:135], v[80:83], v[68:71], v[132:135]
    v_mfma_f32_16x16x32_bf16 v[136:139], v[84:87], v[56:59], v[136:139]
    s_mov_b64 exec, 3
    global_load_dwordx3 v[236:238], v239, s[26:27] sc1
    s_mov_b64 exec, -1
    v_mfma_f32_16x16x32_bf16 v[140:143], v[84:87], v[60:63], v[140:143]
    v_mfma_f32_16x16x32_bf16 v[144:147], v[84:87], v[64:67], v[144:147]
    v_mfma_f32_16x16x32_bf16 v[148:151], v[84:87], v[68:71], v[148:151]
    s_waitcnt lgkmcnt(9)
    v_mfma_f32_16x16x32_bf16 v[88:91], v[40:43], v[24:27], v[88:91]
    ds_read_b64_tr_b16 v[72:73], v252 offset:53248
    ds_read_b64_tr_b16 v[74:75], v252 offset:53760
    s_waitcnt lgkmcnt(10)
    v_mfma_f32_16x16x32_bf16 v[92:95], v[40:43], v[28:31], v[92:95]
    ds_read_b128 v[56:59], v249 offset:40960
    s_waitcnt lgkmcnt(10)
    v_mfma_f32_16x16x32_bf16 v[96:99], v[40:43], v[32:35], v[96:99]
    ds_read_b128 v[60:63], v249 offset:41984
    ds_read_b128 v[64:67], v249 offset:43008
    s_waitcnt lgkmcnt(11)
    v_mfma_f32_16x16x32_bf16 v[100:103], v[40:43], v[36:39], v[100:103]
    ds_read_b128 v[68:71], v249 offset:44032
    s_waitcnt lgkmcnt(10)
    v_mfma_f32_16x16x32_bf16 v[104:107], v[44:47], v[24:27], v[104:107]
    ds_read_b64_tr_b16 v[76:77], v253 offset:53248
    ds_read_b64_tr_b16 v[78:79], v253 offset:53760
    v_mfma_f32_16x16x32_bf16 v[108:111], v[44:47], v[28:31], v[108:111]
    ds_read_b64_tr_b16 v[80:81], v252 offset:61440
    v_mfma_f32_16x16x32_bf16 v[112:115], v[44:47], v[32:35], v[112:115]
    ds_read_b64_tr_b16 v[82:83], v252 offset:61952
    ds_read_b64_tr_b16 v[84:85], v253 offset:61440
    v_mfma_f32_16x16x32_bf16 v[116:119], v[44:47], v[36:39], v[116:119]
    ds_read_b64_tr_b16 v[86:87], v253 offset:61952
    s_waitcnt lgkmcnt(14)
    v_mfma_f32_16x16x32_bf16 v[120:123], v[48:51], v[24:27], v[120:123]
    v_mfma_f32_16x16x32_bf16 v[124:127], v[48:51], v[28:31], v[124:127]
    v_mfma_f32_16x16x32_bf16 v[128:131], v[48:51], v[32:35], v[128:131]
    v_mfma_f32_16x16x32_bf16 v[132:135], v[48:51], v[36:39], v[132:135]
    s_waitcnt lgkmcnt(12)
    v_mfma_f32_16x16x32_bf16 v[136:139], v[52:55], v[24:27], v[136:139]
    v_mfma_f32_16x16x32_bf16 v[140:143], v[52:55], v[28:31], v[140:143]
    v_mfma_f32_16x16x32_bf16 v[144:147], v[52:55], v[32:35], v[144:147]
    v_mfma_f32_16x16x32_bf16 v[148:151], v[52:55], v[36:39], v[148:151]
    s_waitcnt vmcnt(5) lgkmcnt(0)
    s_barrier
    v_mfma_f32_16x16x32_bf16 v[88:91], v[72:75], v[56:59], v[88:91]
    ds_read_b64_tr_b16 v[40:41], v250 offset:49152
    ds_read_b64_tr_b16 v[42:43], v250 offset:49664
    v_mfma_f32_16x16x32_bf16 v[92:95], v[72:75], v[60:63], v[92:95]
    ds_read_b128 v[24:27], v248 offset:32768
    v_mfma_f32_16x16x32_bf16 v[96:99], v[72:75], v[64:67], v[96:99]
    ds_read_b128 v[28:31], v248 offset:33792
    v_mfma_f32_16x16x32_bf16 v[100:103], v[72:75], v[68:71], v[100:103]
    ds_read_b128 v[32:35], v248 offset:34816
    v_mfma_f32_16x16x32_bf16 v[104:107], v[76:79], v[56:59], v[104:107]
    ds_read_b128 v[36:39], v248 offset:35840
    v_mfma_f32_16x16x32_bf16 v[108:111], v[76:79], v[60:63], v[108:111]
    ds_read_b64_tr_b16 v[44:45], v251 offset:49152
    ds_read_b64_tr_b16 v[46:47], v251 offset:49664
    v_mfma_f32_16x16x32_bf16 v[112:115], v[76:79], v[64:67], v[112:115]
    ds_read_b64_tr_b16 v[48:49], v250 offset:57344
    v_mfma_f32_16x16x32_bf16 v[116:119], v[76:79], v[68:71], v[116:119]
    ds_read_b64_tr_b16 v[50:51], v250 offset:57856
    v_mfma_f32_16x16x32_bf16 v[120:123], v[80:83], v[56:59], v[120:123]
    ds_read_b64_tr_b16 v[52:53], v251 offset:57344
    v_mfma_f32_16x16x32_bf16 v[124:127], v[80:83], v[60:63], v[124:127]
    ds_read_b64_tr_b16 v[54:55], v251 offset:57856
    v_mfma_f32_16x16x32_bf16 v[128:131], v[80:83], v[64:67], v[128:131]
    v_mfma_f32_16x16x32_bf16 v[132:135], v[80:83], v[68:71], v[132:135]
    v_mfma_f32_16x16x32_bf16 v[136:139], v[84:87], v[56:59], v[136:139]
    v_mfma_f32_16x16x32_bf16 v[140:143], v[84:87], v[60:63], v[140:143]
    v_mfma_f32_16x16x32_bf16 v[144:147], v[84:87], v[64:67], v[144:147]
    v_mfma_f32_16x16x32_bf16 v[148:151], v[84:87], v[68:71], v[148:151]
    s_waitcnt lgkmcnt(9)
    v_mfma_f32_16x16x32_bf16 v[88:91], v[40:43], v[24:27], v[88:91]
    ds_read_b64_tr_b16 v[72:73], v250 offset:53248
    ds_read_b64_tr_b16 v[74:75], v250 offset:53760
    s_waitcnt lgkmcnt(10)
    v_mfma_f32_16x16x32_bf16 v[92:95], v[40:43], v[28:31], v[92:95]
    ds_read_b128 v[56:59], v248 offset:40960
    s_waitcnt lgkmcnt(10)
    v_mfma_f32_16x16x32_bf16 v[96:99], v[40:43], v[32:35], v[96:99]
    ds_read_b128 v[60:63], v248 offset:41984
    ds_read_b128 v[64:67], v248 offset:43008
    s_waitcnt lgkmcnt(11)
    v_mfma_f32_16x16x32_bf16 v[100:103], v[40:43], v[36:39], v[100:103]
    ds_read_b128 v[68:71], v248 offset:44032
    s_waitcnt lgkmcnt(10)
    v_mfma_f32_16x16x32_bf16 v[104:107], v[44:47], v[24:27], v[104:107]
    ds_read_b64_tr_b16 v[76:77], v251 offset:53248
    ds_read_b64_tr_b16 v[78:79], v251 offset:53760
    v_mfma_f32_16x16x32_bf16 v[108:111], v[44:47], v[28:31], v[108:111]
    ds_read_b64_tr_b16 v[80:81], v250 offset:61440
    v_mfma_f32_16x16x32_bf16 v[112:115], v[44:47], v[32:35], v[112:115]
    ds_read_b64_tr_b16 v[82:83], v250 offset:61952
    ds_read_b64_tr_b16 v[84:85], v251 offset:61440
    v_mfma_f32_16x16x32_bf16 v[116:119], v[44:47], v[36:39], v[116:119]
    ds_read_b64_tr_b16 v[86:87], v251 offset:61952
    s_waitcnt lgkmcnt(14)
    v_mfma_f32_16x16x32_bf16 v[120:123], v[48:51], v[24:27], v[120:123]
    v_mfma_f32_16x16x32_bf16 v[124:127], v[48:51], v[28:31], v[124:127]
    v_mfma_f32_16x16x32_bf16 v[128:131], v[48:51], v[32:35], v[128:131]
    v_mfma_f32_16x16x32_bf16 v[132:135], v[48:51], v[36:39], v[132:135]
    s_waitcnt lgkmcnt(12)
    v_mfma_f32_16x16x32_bf16 v[136:139], v[52:55], v[24:27], v[136:139]
    v_mfma_f32_16x16x32_bf16 v[140:143], v[52:55], v[28:31], v[140:143]
    v_mfma_f32_16x16x32_bf16 v[144:147], v[52:55], v[32:35], v[144:147]
    v_mfma_f32_16x16x32_bf16 v[148:151], v[52:55], v[36:39], v[148:151]
    s_waitcnt vmcnt(0) lgkmcnt(0)
    s_barrier
    v_mfma_f32_16x16x32_bf16 v[88:91], v[72:75], v[56:59], v[88:91]
    ds_read_b64_tr_b16 v[40:41], v252 offset:16384
    ds_read_b64_tr_b16 v[42:43], v252 offset:16896
    v_readlane_b32 s90, v238, 0
    v_readlane_b32 s91, v238, 1
    v_mfma_f32_16x16x32_bf16 v[92:95], v[72:75], v[60:63], v[92:95]
    ds_read_b128 v[24:27], v249 offset:0
    s_nop 1
    s_sub_u32 s90, s91, s90
    v_mfma_f32_16x16x32_bf16 v[96:99], v[72:75], v[64:67], v[96:99]
    ds_read_b128 v[28:31], v249 offset:1024
    s_abs_i32 s91, s90
    v_mfma_f32_16x16x32_bf16 v[100:103], v[72:75], v[68:71], v[100:103]
    ds_read_b128 v[32:35], v249 offset:2048
    s_min_u32 s91, s91, 0x1000
    s_add_u32 s91, s91, 35
    v_mfma_f32_16x16x32_bf16 v[104:107], v[76:79], v[56:59], v[104:107]
    ds_read_b128 v[36:39], v249 offset:3072
    s_mul_i32 s91, s91, 937
    s_lshr_b32 s91, s91, 16
    v_mfma_f32_16x16x32_bf16 v[108:111], v[76:79], v[60:63], v[108:111]
    ds_read_b64_tr_b16 v[44:45], v253 offset:16384
    ds_read_b64_tr_b16 v[46:47], v253 offset:16896
    s_min_u32 s91, s91, 4
    v_mfma_f32_16x16x32_bf16 v[112:115], v[76:79], v[64:67], v[112:115]
    ds_read_b64_tr_b16 v[48:49], v252 offset:24576
    s_sub_u32 s92, 0, s91
    s_cmp_lt_i32 s90, 0
    v_mfma_f32_16x16x32_bf16 v[116:119], v[76:79], v[68:71], v[116:119]
    ds_read_b64_tr_b16 v[50:51], v252 offset:25088
    s_cselect_b32 s91, s92, s91
    v_mfma_f32_16x16x32_bf16 v[120:123], v[80:83], v[56:59], v[120:123]
    ds_read_b64_tr_b16 v[52:53], v253 offset:24576
    s_add_u32 s34, s91, 16
    s_and_b32 s91, s91, 3
    v_mfma_f32_16x16x32_bf16 v[124:127], v[80:83], v[60:63], v[124:127]
    ds_read_b64_tr_b16 v[54:55], v253 offset:25088
    s_mov_b32 s46, 0x9a69a69a
    s_mov_b32 s47, 0x269a69a6
    v_mfma_f32_16x16x32_bf16 v[128:131], v[80:83], v[64:67], v[128:131]
    s_cmp_eq_u32 s91, 1
    v_mfma_f32_16x16x32_bf16 v[132:135], v[80:83], v[68:71], v[132:135]
    s_cselect_b32 s46, 0xd34d34e6, s46
    s_cselect_b32 s47, 0x34d34d34, s47
    v_mfma_f32_16x16x32_bf16 v[136:139], v[84:87], v[56:59], v[136:139]
    s_cmp_eq_u32 s91, 2
    s_cselect_b32 s46, 0x9a7334e6, s46
    v_mfma_f32_16x16x32_bf16 v[140:143], v[84:87], v[60:63], v[140:143]
    s_cselect_b32 s47, 0x269a69a6, s47
    v_mfma_f32_16x16x32_bf16 v[144:147], v[84:87], v[64:67], v[144:147]
    s_cmp_eq_u32 s91, 3
    s_cselect_b32 s46, 0x9a7334e6, s46
    v_mfma_f32_16x16x32_bf16 v[148:151], v[84:87], v[68:71], v[148:151]
    s_cselect_b32 s47, 0x34d34d39, s47
    s_waitcnt lgkmcnt(9)
    v_mfma_f32_16x16x32_bf16 v[88:91], v[40:43], v[24:27], v[88:91]
    ds_read_b64_tr_b16 v[72:73], v252 offset:20480
    ds_read_b64_tr_b16 v[74:75], v252 offset:20992
    s_waitcnt lgkmcnt(10)
    v_mfma_f32_16x16x32_bf16 v[92:95], v[40:43], v[28:31], v[92:95]
    ds_read_b128 v[56:59], v249 offset:8192
    s_waitcnt lgkmcnt(10)
    v_mfma_f32_16x16x32_bf16 v[96:99], v[40:43], v[32:35], v[96:99]
    ds_read_b128 v[60:63], v249 offset:9216
    ds_read_b128 v[64:67], v249 offset:10240
    s_waitcnt lgkmcnt(11)
    v_mfma_f32_16x16x32_bf16 v[100:103], v[40:43], v[36:39], v[100:103]
    ds_read_b128 v[68:71], v249 offset:11264
    s_waitcnt lgkmcnt(10)
    v_mfma_f32_16x16x32_bf16 v[104:107], v[44:47], v[24:27], v[104:107]
    ds_read_b64_tr_b16 v[76:77], v253 offset:20480
    ds_read_b64_tr_b16 v[78:79], v253 offset:20992
    v_mfma_f32_16x16x32_bf16 v[108:111], v[44:47], v[28:31], v[108:111]
    ds_read_b64_tr_b16 v[80:81], v252 offset:28672
    v_mfma_f32_16x16x32_bf16 v[112:115], v[44:47], v[32:35], v[112:115]
    ds_read_b64_tr_b16 v[82:83], v252 offset:29184
    ds_read_b64_tr_b16 v[84:85], v253 offset:28672
L_pad5:
    s_cbranch_execz L_vret2
    v_mfma_f32_16x16x32_bf16 v[116:119], v[44:47], v[36:39], v[116:119]
    ds_read_b64_tr_b16 v[86:87], v253 offset:29184
    s_waitcnt lgkmcnt(14)
    v_mfma_f32_16x16x32_bf16 v[120:123], v[48:51], v[24:27], v[120:123]
    v_mfma_f32_16x16x32_bf16 v[124:127], v[48:51], v[28:31], v[124:127]
    s_lshl_b32 s48, s46, 15
    s_and_b32 s48, s48, 0x38000
    v_mfma_f32_16x16x32_bf16 v[128:131], v[48:51], v[32:35], v[128:131]
    s_lshr_b64 s[46:47], s[46:47], 3
    v_mfma_f32_16x16x32_bf16 v[132:135], v[48:51], v[36:39], v[132:135]
    v_xor_b32 v252, s48, v252
    s_waitcnt lgkmcnt(12)
    v_mfma_f32_16x16x32_bf16 v[136:139], v[52:55], v[24:27], v[136:139]
    v_xor_b32 v249, s48, v249
    v_mfma_f32_16x16x32_bf16 v[140:143], v[52:55], v[28:31], v[140:143]
    v_xor_b32 v253, s48, v253
    v_mfma_f32_16x16x32_bf16 v[144:147], v[52:55], v[32:35], v[144:147]
    s_sub_u32 s34, s34, 1
    v_mfma_f32_16x16x32_bf16 v[148:151], v[52:55], v[36:39], v[148:151]
.p2align 6
L_dl:
    s_waitcnt lgkmcnt(0)
    s_barrier
    v_mfma_f32_16x16x32_bf16 v[88:91], v[72:75], v[56:59], v[88:91]
    ds_read_b64_tr_b16 v[40:41], v252 offset:16384
    ds_read_b64_tr_b16 v[42:43], v252 offset:16896
    v_mfma_f32_16x16x32_bf16 v[92:95], v[72:75], v[60:63], v[92:95]
    ds_read_b128 v[24:27], v249 offset:0
    v_mfma_f32_16x16x32_bf16 v[96:99], v[72:75], v[64:67], v[96:99]
    ds_read_b128 v[28:31], v249 offset:1024
    v_mfma_f32_16x16x32_bf16 v[100:103], v[72:75], v[68:71], v[100:103]
    ds_read_b128 v[32:35], v249 offset:2048
    v_mfma_f32_16x16x32_bf16 v[104:107], v[76:79], v[56:59], v[104:107]
    ds_read_b128 v[36:39], v249 offset:3072
    v_mfma_f32_16x16x32_bf16 v[108:111], v[76:79], v[60:63], v[108:111]
    ds_read_b64_tr_b16 v[44:45], v253 offset:16384
    ds_read_b64_tr_b16 v[46:47], v253 offset:16896
    v_mfma_f32_16x16x32_bf16 v[112:115], v[76:79], v[64:67], v[112:115]
    ds_read_b64_tr_b16 v[48:49], v252 offset:24576
    v_mfma_f32_16x16x32_bf16 v[116:119], v[76:79], v[68:71], v[116:119]
    ds_read_b64_tr_b16 v[50:51], v252 offset:25088
    v_mfma_f32_16x16x32_bf16 v[120:123], v[80:83], v[56:59], v[120:123]
    ds_read_b64_tr_b16 v[52:53], v253 offset:24576
    v_mfma_f32_16x16x32_bf16 v[124:127], v[80:83], v[60:63], v[124:127]
    ds_read_b64_tr_b16 v[54:55], v253 offset:25088
    v_mfma_f32_16x16x32_bf16 v[128:131], v[80:83], v[64:67], v[128:131]
    v_mfma_f32_16x16x32_bf16 v[132:135], v[80:83], v[68:71], v[132:135]
    v_mfma_f32_16x16x32_bf16 v[136:139], v[84:87], v[56:59], v[136:139]
    v_mfma_f32_16x16x32_bf16 v[140:143], v[84:87], v[60:63], v[140:143]
    v_mfma_f32_16x16x32_bf16 v[144:147], v[84:87], v[64:67], v[144:147]
    v_mfma_f32_16x16x32_bf16 v[148:151], v[84:87], v[68:71], v[148:151]
    s_waitcnt lgkmcnt(9)
    v_mfma_f32_16x16x32_bf16 v[88:91], v[40:43], v[24:27], v[88:91]
    ds_read_b64_tr_b16 v[72:73], v252 offset:20480
    ds_read_b64_tr_b16 v[74:75], v252 offset:20992
    s_waitcnt lgkmcnt(10)
    v_mfma_f32_16x16x32_bf16 v[92:95], v[40:43], v[28:31], v[92:95]
    ds_read_b128 v[56:59], v249 offset:8192
    s_waitcnt lgkmcnt(10)
    v_mfma_f32_16x16x32_bf16 v[96:99], v[40:43], v[32:35], v[96:99]
    ds_read_b128 v[60:63], v249 offset:9216
    ds_read_b128 v[64:67], v249 offset:10240
    s_waitcnt lgkmcnt(11)
    v_mfma_f32_16x16x32_bf16 v[100:103], v[40:43], v[36:39], v[100:103]
    ds_read_b128 v[68:71], v249 offset:11264
    s_waitcnt lgkmcnt(10)
    v_mfma_f32_16x16x32_bf16 v[104:107], v[44:47], v[24:27], v[104:107]
    ds_read_b64_tr_b16 v[76:77], v253 offset:20480
    ds_read_b64_tr_b16 v[78:79], v253 offset:20992
    v_mfma_f32_16x16x32_bf16 v[108:111], v[44:47], v[28:31], v[108:111]
    ds_read_b64_tr_b16 v[80:81], v252 offset:28672
    v_mfma_f32_16x16x32_bf16 v[112:115], v[44:47], v[32:35], v[112:115]
    ds_read_b64_tr_b16 v[82:83], v252 offset:29184
    ds_read_b64_tr_b16 v[84:85], v253 offset:28672
    v_mfma_f32_16x16x32_bf16 v[116:119], v[44:47], v[36:39], v[116:119]
    ds_read_b64_tr_b16 v[86:87], v253 offset:29184
    s_waitcnt lgkmcnt(14)
    v_mfma_f32_16x16x32_bf16 v[120:123], v[48:51], v[24:27], v[120:123]
    v_mfma_f32_16x16x32_bf16 v[124:127], v[48:51], v[28:31], v[124:127]
    s_lshl_b32 s48, s46, 15
    s_and_b32 s48, s48, 0x38000
    v_mfma_f32_16x16x32_bf16 v[128:131], v[48:51], v[32:35], v[128:131]
    s_lshr_b64 s[46:47], s[46:47], 3
    v_mfma_f32_16x16x32_bf16 v[132:135], v[48:51], v[36:39], v[132:135]
    v_xor_b32 v252, s48, v252
    s_waitcnt lgkmcnt(12)
    v_mfma_f32_16x16x32_bf16 v[136:139], v[52:55], v[24:27], v[136:139]
    v_xor_b32 v249, s48, v249
    v_mfma_f32_16x16x32_bf16 v[140:143], v[52:55], v[28:31], v[140:143]
    v_xor_b32 v253, s48, v253
    v_mfma_f32_16x16x32_bf16 v[144:147], v[52:55], v[32:35], v[144:147]
    s_sub_u32 s34, s34, 1
    v_mfma_f32_16x16x32_bf16 v[148:151], v[52:55], v[36:39], v[148:151]
    s_cbranch_scc0 L_dl
    s_waitcnt lgkmcnt(0)
    s_barrier
    v_mfma_f32_16x16x32_bf16 v[88:91], v[72:75], v[56:59], v[88:91]
    v_mfma_f32_16x16x32_bf16 v[92:95], v[72:75], v[60:63], v[92:95]
    v_mfma_f32_16x16x32_bf16 v[96:99], v[72:75], v[64:67], v[96:99]
    v_mfma_f32_16x16x32_bf16 v[100:103], v[72:75], v[68:71], v[100:103]
    v_mfma_f32_16x16x32_bf16 v[104:107], v[76:79], v[56:59], v[104:107]
    v_mfma_f32_16x16x32_bf16 v[108:111], v[76:79], v[60:63], v[108:111]
    v_mfma_f32_16x16x32_bf16 v[112:115], v[76:79], v[64:67], v[112:115]
    v_mfma_f32_16x16x32_bf16 v[116:119], v[76:79], v[68:71], v[116:119]
    v_mfma_f32_16x16x32_bf16 v[120:123], v[80:83], v[56:59], v[120:123]
    v_mfma_f32_16x16x32_bf16 v[124:127], v[80:83], v[60:63], v[124:127]
    v_mfma_f32_16x16x32_bf16 v[128:131], v[80:83], v[64:67], v[128:131]
    v_mfma_f32_16x16x32_bf16 v[132:135], v[80:83], v[68:71], v[132:135]
    v_mfma_f32_16x16x32_bf16 v[136:139], v[84:87], v[56:59], v[136:139]
    v_mfma_f32_16x16x32_bf16 v[140:143], v[84:87], v[60:63], v[140:143]
    v_mfma_f32_16x16x32_bf16 v[144:147], v[84:87], v[64:67], v[144:147]
    v_mfma_f32_16x16x32_bf16 v[148:151], v[84:87], v[68:71], v[148:151]
    s_setprio 0
    s_lshl4_add_u32 s91, s28, s29
    s_xor_b32 s91, s91, 136
    s_lshl_b32 s91, s91, 7
    s_add_u32 s91, s91, 0x1ea0000
    v_mov_b32 v13, s91
    s_nop 7
    v_max_f32_e64 v8, |v120|, |v121|
    v_max_f32_e64 v9, |v128|, |v129|
    v_max_f32_e64 v10, |v136|, |v137|
    v_max_f32_e64 v11, |v144|, |v145|
    v_max3_f32 v8, |v122|, |v123|, v8
    v_max3_f32 v9, |v130|, |v131|, v9
    v_max3_f32 v10, |v138|, |v139|, v10
    v_max3_f32 v11, |v146|, |v147|, v11
    v_max3_f32 v8, |v124|, |v125|, v8
    v_max3_f32 v9, |v132|, |v133|, v9
    v_max3_f32 v10, |v140|, |v141|, v10
    v_max3_f32 v11, |v148|, |v149|, v11
    v_max3_f32 v8, |v126|, |v127|, v8
    v_max3_f32 v9, |v134|, |v135|, v9
    v_max3_f32 v10, |v142|, |v143|, v10
    v_max3_f32 v11, |v150|, |v151|, v11
    v_max3_f32 v8, v8, v9, v10
    v_max_f32 v8, v8, v11
    v_min_f32 v8, 0x7f7fffff, v8
    v_frexp_exp_i32_f32 v8, v8
    v_max_i32 v8, -100, v8
    v_sub_u32 v9, 15, v8
    v_add_u32 v8, -15, v8
    v_ldexp_f32 v9, 1.0, v9
    v_ldexp_f32 v8, 1.0, v8
    buffer_store_dword v8, v6, s[68:71], s37 offen sc1
    v_fma_mixlo_f16 v32, v120, v9, 0
    v_fma_mixlo_f16 v33, v122, v9, 0
    v_fma_mixlo_f16 v34, v124, v9, 0
    v_fma_mixlo_f16 v35, v126, v9, 0
    v_fma_mixhi_f16 v32, v121, v9, 0
    v_fma_mixhi_f16 v33, v123, v9, 0
    v_fma_mixhi_f16 v34, v125, v9, 0
    v_fma_mixhi_f16 v35, v127, v9, 0
    s_nop 0
    buffer_store_dwordx4 v[32:35], v4, s[68:71], s36 offen offset:0 sc1
    v_fma_mixlo_f16 v36, v128, v9, 0
    v_fma_mixlo_f16 v37, v130, v9, 0
    v_fma_mixlo_f16 v38, v132, v9, 0
    v_fma_mixlo_f16 v39, v134, v9, 0
    v_fma_mixhi_f16 v36, v129, v9, 0
    v_fma_mixhi_f16 v37, v131, v9, 0
    v_fma_mixhi_f16 v38, v133, v9, 0
    v_fma_mixhi_f16 v39, v135, v9, 0
    s_nop 0
    buffer_store_dwordx4 v[36:39], v4, s[68:71], s36 offen offset:1024 sc1
    s_barrier
    v_fma_mixlo_f16 v40, v136, v9, 0
    v_fma_mixlo_f16 v41, v138, v9, 0
    v_fma_mixlo_f16 v42, v140, v9, 0
    v_fma_mixlo_f16 v43, v142, v9, 0
    v_fma_mixhi_f16 v40, v137, v9, 0
    v_fma_mixhi_f16 v41, v139, v9, 0
    v_fma_mixhi_f16 v42, v141, v9, 0
    v_fma_mixhi_f16 v43, v143, v9, 0
    s_nop 0
    buffer_store_dwordx4 v[40:43], v4, s[68:71], s36 offen offset:2048 sc1
    v_fma_mixlo_f16 v44, v144, v9, 0
    v_fma_mixlo_f16 v45, v146, v9, 0
    v_fma_mixlo_f16 v46, v148, v9, 0
    v_fma_mixlo_f16 v47, v150, v9, 0
    v_fma_mixhi_f16 v44, v145, v9, 0
    v_fma_mixhi_f16 v45, v147, v9, 0
    v_fma_mixhi_f16 v46, v149, v9, 0
    v_fma_mixhi_f16 v47, v151, v9, 0
    s_nop 0
    buffer_store_dwordx4 v[44:47], v4, s[68:71], s36 offen offset:3072 sc1
    s_barrier
    s_barrier
    s_waitcnt vmcnt(0)
    s_barrier
    s_cmp_lg_u32 s4, 0
    s_cbranch_scc1 L_fP
    s_lshl_b32 s91, s28, 4
    s_add_u32 s91, s91, s29
    s_lshl_b32 s91, s91, 7
    s_add_u32 s91, s91, 0x1ea0000
    v_mov_b32 v16, s91
    v_mov_b32 v18, s100
    v_mov_b32 v19, s101
    s_mov_b64 exec, 1
    global_store_dwordx2 v16, v[18:19], s[26:27] sc1
    s_mov_b64 exec, -1
L_fP:
    s_barrier
    s_mov_b64 exec, 1
    global_load_dwordx2 v[14:15], v13, s[26:27] sc1
    s_mov_b64 exec, -1
    s_barrier
    s_barrier
    s_waitcnt vmcnt(0)
    s_mov_b64 exec, 1
    s_movk_i32 s98, 0x4000
L_pP_chk:
    v_cmp_ne_u64 vcc, s[100:101], v[14:15]
    s_nop 1
    s_cmp_eq_u64 vcc, 0
    s_cbranch_scc1 L_pP_ok
    s_sub_u32 s98, s98, 1
    s_cbranch_scc1 L_pP_ok
    s_sleep 1
    global_load_dwordx2 v[14:15], v13, s[26:27] sc1
    s_waitcnt vmcnt(0)
    s_branch L_pP_chk
L_pP_ok:
    s_mov_b64 exec, -1
    buffer_load_dword v168, v6, s[68:71], s39 offen sc1
    buffer_load_dwordx4 v[152:155], v4, s[68:71], s38 offen offset:0 sc1
    buffer_load_dwordx4 v[156:159], v4, s[68:71], s38 offen offset:1024 sc1
    buffer_load_dwordx4 v[160:163], v4, s[68:71], s38 offen offset:2048 sc1
    buffer_load_dwordx4 v[164:167], v4, s[68:71], s38 offen offset:3072 sc1
    s_barrier
    s_barrier
    s_waitcnt vmcnt(3)
    v_fma_mix_f32 v88, v152, v168, v88 op_sel:[0,0,0] op_sel_hi:[1,0,0]
    v_fma_mix_f32 v89, v152, v168, v89 op_sel:[1,0,0] op_sel_hi:[1,0,0]
    v_fma_mix_f32 v90, v153, v168, v90 op_sel:[0,0,0] op_sel_hi:[1,0,0]
    v_fma_mix_f32 v91, v153, v168, v91 op_sel:[1,0,0] op_sel_hi:[1,0,0]
    v_cvt_pk_bf16_f32 v28, v88, v89
    v_cvt_pk_bf16_f32 v29, v90, v91
    v_lshlrev_b32 v88, 16, v28
    v_and_b32 v89, 0xffff0000, v28
    v_lshlrev_b32 v90, 16, v29
    v_and_b32 v91, 0xffff0000, v29
    v_mul_f32 v24, 0xbfb8aa3b, v88
    v_mul_f32 v25, 0xbfb8aa3b, v89
    v_mul_f32 v26, 0xbfb8aa3b, v90
    v_mul_f32 v27, 0xbfb8aa3b, v91
    v_exp_f32 v24, v24
    v_exp_f32 v25, v25
    v_exp_f32 v26, v26
    v_exp_f32 v27, v27
    s_nop 0
    v_add_f32 v24, 1.0, v24
    v_add_f32 v25, 1.0, v25
    v_add_f32 v26, 1.0, v26
    v_add_f32 v27, 1.0, v27
    v_rcp_f32 v24, v24
    v_rcp_f32 v25, v25
    v_rcp_f32 v26, v26
    v_rcp_f32 v27, v27
    s_nop 0
    v_mul_f32 v24, v24, v88
    v_mul_f32 v25, v25, v89
    v_mul_f32 v26, v26, v90
    v_mul_f32 v27, v27, v91
    v_cvt_pk_bf16_f32 v88, v24, v25
    v_cvt_pk_bf16_f32 v89, v26, v27
    ds_write_b64 v5, v[88:89] offset:0
    v_fma_mix_f32 v92, v154, v168, v92 op_sel:[0,0,0] op_sel_hi:[1,0,0]
    v_fma_mix_f32 v93, v154, v168, v93 op_sel:[1,0,0] op_sel_hi:[1,0,0]
    v_fma_mix_f32 v94, v155, v168, v94 op_sel:[0,0,0] op_sel_hi:[1,0,0]
    v_fma_mix_f32 v95, v155, v168, v95 op_sel:[1,0,0] op_sel_hi:[1,0,0]
    v_cvt_pk_bf16_f32 v28, v92, v93
    v_cvt_pk_bf16_f32 v29, v94, v95
    v_lshlrev_b32 v92, 16, v28
    v_and_b32 v93, 0xffff0000, v28
    v_lshlrev_b32 v94, 16, v29
    v_and_b32 v95, 0xffff0000, v29
    v_mul_f32 v24, 0xbfb8aa3b, v92
    v_mul_f32 v25, 0xbfb8aa3b, v93
    v_mul_f32 v26, 0xbfb8aa3b, v94
    v_mul_f32 v27, 0xbfb8aa3b, v95
    v_exp_f32 v24, v24
    v_exp_f32 v25, v25
    v_exp_f32 v26, v26
    v_exp_f32 v27, v27
    s_nop 0
    v_add_f32 v24, 1.0, v24
    v_add_f32 v25, 1.0, v25
    s_barrier
    v_add_f32 v26, 1.0, v26
    v_add_f32 v27, 1.0, v27
    v_rcp_f32 v24, v24
    v_rcp_f32 v25, v25
    v_rcp_f32 v26, v26
    v_rcp_f32 v27, v27
    s_nop 0
    v_mul_f32 v24, v24, v92
    v_mul_f32 v25, v25, v93
    v_mul_f32 v26, v26, v94
    v_mul_f32 v27, v27, v95
    v_cvt_pk_bf16_f32 v92, v24, v25
    v_cvt_pk_bf16_f32 v93, v26, v27
    ds_write_b64 v5, v[92:93] offset:512
    s_waitcnt vmcnt(2)
    v_fma_mix_f32 v96, v156, v168, v96 op_sel:[0,0,0] op_sel_hi:[1,0,0]
    v_fma_mix_f32 v97, v156, v168, v97 op_sel:[1,0,0] op_sel_hi:[1,0,0]
    v_fma_mix_f32 v98, v157, v168, v98 op_sel:[0,0,0] op_sel_hi:[1,0,0]
    v_fma_mix_f32 v99, v157, v168, v99 op_sel:[1,0,0] op_sel_hi:[1,0,0]
    v_cvt_pk_bf16_f32 v28, v96, v97
    v_cvt_pk_bf16_f32 v29, v98, v99
    v_lshlrev_b32 v96, 16, v28
    v_and_b32 v97, 0xffff0000, v28
    v_lshlrev_b32 v98, 16, v29
    v_and_b32 v99, 0xffff0000, v29
    v_mul_f32 v24, 0xbfb8aa3b, v96
    v_mul_f32 v25, 0xbfb8aa3b, v97
    v_mul_f32 v26, 0xbfb8aa3b, v98
    v_mul_f32 v27, 0xbfb8aa3b, v99
    v_exp_f32 v24, v24
    v_exp_f32 v25, v25
    v_exp_f32 v26, v26
    v_exp_f32 v27, v27
    s_nop 0
    v_add_f32 v24, 1.0, v24
    v_add_f32 v25, 1.0, v25
    v_add_f32 v26, 1.0, v26
    v_add_f32 v27, 1.0, v27
    v_rcp_f32 v24, v24
    v_rcp_f32 v25, v25
    v_rcp_f32 v26, v26
    v_rcp_f32 v27, v27
    s_nop 0
    v_mul_f32 v24, v24, v96
    v_mul_f32 v25, v25, v97
    v_mul_f32 v26, v26, v98
    v_mul_f32 v27, v27, v99
    v_cvt_pk_bf16_f32 v96, v24, v25
    v_cvt_pk_bf16_f32 v97, v26, v27
    ds_write_b64 v5, v[96:97] offset:1024
    s_barrier
    v_fma_mix_f32 v100, v158, v168, v100 op_sel:[0,0,0] op_sel_hi:[1,0,0]
    v_fma_mix_f32 v101, v158, v168, v101 op_sel:[1,0,0] op_sel_hi:[1,0,0]
    v_fma_mix_f32 v102, v159, v168, v102 op_sel:[0,0,0] op_sel_hi:[1,0,0]
    v_fma_mix_f32 v103, v159, v168, v103 op_sel:[1,0,0] op_sel_hi:[1,0,0]
    v_cvt_pk_bf16_f32 v28, v100, v101
    v_cvt_pk_bf16_f32 v29, v102, v103
    v_lshlrev_b32 v100, 16, v28
    v_and_b32 v101, 0xffff0000, v28
    v_lshlrev_b32 v102, 16, v29
    v_and_b32 v103, 0xffff0000, v29
    v_mul_f32 v24, 0xbfb8aa3b, v100
    v_mul_f32 v25, 0xbfb8aa3b, v101
    v_mul_f32 v26, 0xbfb8aa3b, v102
    v_mul_f32 v27, 0xbfb8aa3b, v103
    v_exp_f32 v24, v24
    v_exp_f32 v25, v25
    v_exp_f32 v26, v26
    v_exp_f32 v27, v27
    s_nop 0
    v_add_f32 v24, 1.0, v24
    v_add_f32 v25, 1.0, v25
    v_add_f32 v26, 1.0, v26
    v_add_f32 v27, 1.0, v27
    v_rcp_f32 v24, v24
    v_rcp_f32 v25, v25
    v_rcp_f32 v26, v26
    v_rcp_f32 v27, v27
    s_nop 0
    v_mul_f32 v24, v24, v100
    v_mul_f32 v25, v25, v101
    v_mul_f32 v26, v26, v102
    v_mul_f32 v27, v27, v103
    v_cvt_pk_bf16_f32 v100, v24, v25
    v_cvt_pk_bf16_f32 v101, v26, v27
    ds_write_b64 v5, v[100:101] offset:1536
    s_waitcnt vmcnt(1)
    v_fma_mix_f32 v104, v160, v168, v104 op_sel:[0,0,0] op_sel_hi:[1,0,0]
    v_fma_mix_f32 v105, v160, v168, v105 op_sel:[1,0,0] op_sel_hi:[1,0,0]
    v_fma_mix_f32 v106, v161, v168, v106 op_sel:[0,0,0] op_sel_hi:[1,0,0]
    v_fma_mix_f32 v107, v161, v168, v107 op_sel:[1,0,0] op_sel_hi:[1,0,0]
    v_cvt_pk_bf16_f32 v28, v104, v105
    v_cvt_pk_bf16_f32 v29, v106, v107
    v_lshlrev_b32 v104, 16, v28
    v_and_b32 v105, 0xffff0000, v28
    v_lshlrev_b32 v106, 16, v29
    v_and_b32 v107, 0xffff0000, v29
    v_mul_f32 v24, 0xbfb8aa3b, v104
    v_mul_f32 v25, 0xbfb8aa3b, v105
    v_mul_f32 v26, 0xbfb8aa3b, v106
    v_mul_f32 v27, 0xbfb8aa3b, v107
    v_exp_f32 v24, v24
    v_exp_f32 v25, v25
    v_exp_f32 v26, v26
    v_exp_f32 v27, v27
    s_nop 0
    v_add_f32 v24, 1.0, v24
    v_add_f32 v25, 1.0, v25
    s_barrier
    v_add_f32 v26, 1.0, v26
    v_add_f32 v27, 1.0, v27
    v_rcp_f32 v24, v24
    v_rcp_f32 v25, v25
    v_rcp_f32 v26, v26
    v_rcp_f32 v27, v27
    s_nop 0
    v_mul_f32 v24, v24, v104
    v_mul_f32 v25, v25, v105
    v_mul_f32 v26, v26, v106
    v_mul_f32 v27, v27, v107
    v_cvt_pk_bf16_f32 v104, v24, v25
    v_cvt_pk_bf16_f32 v105, v26, v27
    ds_write_b64 v5, v[104:105] offset:2048
    v_fma_mix_f32 v108, v162, v168, v108 op_sel:[0,0,0] op_sel_hi:[1,0,0]
    v_fma_mix_f32 v109, v162, v168, v109 op_sel:[1,0,0] op_sel_hi:[1,0,0]
    v_fma_mix_f32 v110, v163, v168, v110 op_sel:[0,0,0] op_sel_hi:[1,0,0]
    v_fma_mix_f32 v111, v163, v168, v111 op_sel:[1,0,0] op_sel_hi:[1,0,0]
    v_cvt_pk_bf16_f32 v28, v108, v109
    v_cvt_pk_bf16_f32 v29, v110, v111
    v_lshlrev_b32 v108, 16, v28
    v_and_b32 v109, 0xffff0000, v28
    v_lshlrev_b32 v110, 16, v29
    v_and_b32 v111, 0xffff0000, v29
    v_mul_f32 v24, 0xbfb8aa3b, v108
    v_mul_f32 v25, 0xbfb8aa3b, v109
    v_mul_f32 v26, 0xbfb8aa3b, v110
    v_mul_f32 v27, 0xbfb8aa3b, v111
    v_exp_f32 v24, v24
    v_exp_f32 v25, v25
    v_exp_f32 v26, v26
    v_exp_f32 v27, v27
    s_nop 0
    v_add_f32 v24, 1.0, v24
    v_add_f32 v25, 1.0, v25
    v_add_f32 v26, 1.0, v26
    v_add_f32 v27, 1.0, v27
    v_rcp_f32 v24, v24
    v_rcp_f32 v25, v25
    v_rcp_f32 v26, v26
    v_rcp_f32 v27, v27
    s_nop 0
    v_mul_f32 v24, v24, v108
    v_mul_f32 v25, v25, v109
    v_mul_f32 v26, v26, v110
    v_mul_f32 v27, v27, v111
    v_cvt_pk_bf16_f32 v108, v24, v25
    v_cvt_pk_bf16_f32 v109, v26, v27
    ds_write_b64 v5, v[108:109] offset:2560
    s_barrier
    s_waitcnt vmcnt(0)
    v_fma_mix_f32 v112, v164, v168, v112 op_sel:[0,0,0] op_sel_hi:[1,0,0]
    v_fma_mix_f32 v113, v164, v168, v113 op_sel:[1,0,0] op_sel_hi:[1,0,0]
    v_fma_mix_f32 v114, v165, v168, v114 op_sel:[0,0,0] op_sel_hi:[1,0,0]
    v_fma_mix_f32 v115, v165, v168, v115 op_sel:[1,0,0] op_sel_hi:[1,0,0]
    v_cvt_pk_bf16_f32 v28, v112, v113
    v_cvt_pk_bf16_f32 v29, v114, v115
    v_lshlrev_b32 v112, 16, v28
    v_and_b32 v113, 0xffff0000, v28
    v_lshlrev_b32 v114, 16, v29
    v_and_b32 v115, 0xffff0000, v29
    v_mul_f32 v24, 0xbfb8aa3b, v112
    v_mul_f32 v25, 0xbfb8aa3b, v113
    v_mul_f32 v26, 0xbfb8aa3b, v114
    v_mul_f32 v27, 0xbfb8aa3b, v115
    v_exp_f32 v24, v24
    v_exp_f32 v25, v25
    v_exp_f32 v26, v26
    v_exp_f32 v27, v27
    s_nop 0
    v_add_f32 v24, 1.0, v24
    v_add_f32 v25, 1.0, v25
    v_add_f32 v26, 1.0, v26
    v_add_f32 v27, 1.0, v27
    v_rcp_f32 v24, v24
    v_rcp_f32 v25, v25
    v_rcp_f32 v26, v26
    v_rcp_f32 v27, v27
    s_nop 0
    v_mul_f32 v24, v24, v112
    v_mul_f32 v25, v25, v113
    v_mul_f32 v26, v26, v114
    v_mul_f32 v27, v27, v115
    v_cvt_pk_bf16_f32 v112, v24, v25
    v_cvt_pk_bf16_f32 v113, v26, v27
    ds_write_b64 v5, v[112:113] offset:3072
    v_fma_mix_f32 v116, v166, v168, v116 op_sel:[0,0,0] op_sel_hi:[1,0,0]
    v_fma_mix_f32 v117, v166, v168, v117 op_sel:[1,0,0] op_sel_hi:[1,0,0]
    v_fma_mix_f32 v118, v167, v168, v118 op_sel:[0,0,0] op_sel_hi:[1,0,0]
    v_fma_mix_f32 v119, v167, v168, v119 op_sel:[1,0,0] op_sel_hi:[1,0,0]
    v_cvt_pk_bf16_f32 v28, v116, v117
    v_cvt_pk_bf16_f32 v29, v118, v119
    v_lshlrev_b32 v116, 16, v28
    v_and_b32 v117, 0xffff0000, v28
    v_lshlrev_b32 v118, 16, v29
    v_and_b32 v119, 0xffff0000, v29
    v_mul_f32 v24, 0xbfb8aa3b, v116
    v_mul_f32 v25, 0xbfb8aa3b, v117
    v_mul_f32 v26, 0xbfb8aa3b, v118
    v_mul_f32 v27, 0xbfb8aa3b, v119
    v_exp_f32 v24, v24
    v_exp_f32 v25, v25
    v_exp_f32 v26, v26
    v_exp_f32 v27, v27
    s_nop 0
    v_add_f32 v24, 1.0, v24
    v_add_f32 v25, 1.0, v25
    s_barrier
    v_add_f32 v26, 1.0, v26
    v_add_f32 v27, 1.0, v27
    v_rcp_f32 v24, v24
    v_rcp_f32 v25, v25
    v_rcp_f32 v26, v26
    v_rcp_f32 v27, v27
    s_nop 0
    v_mul_f32 v24, v24, v116
    v_mul_f32 v25, v25, v117
    v_mul_f32 v26, v26, v118
    v_mul_f32 v27, v27, v119
    v_cvt_pk_bf16_f32 v116, v24, v25
    v_cvt_pk_bf16_f32 v117, v26, v27
    ds_write_b64 v5, v[116:117] offset:3584
    s_waitcnt lgkmcnt(0)
    s_barrier
    s_branch L_fin
.p2align 12
L_teamB:
    s_mov_b64 exec, -1
    s_setprio 3
    v_lshrrev_b32 v64, 4, v1
    v_bfe_u32 v65, v1, 2, 2
    v_and_b32 v66, 3, v1
    v_and_b32 v67, 15, v1
    v_lshrrev_b32 v68, 3, v1
    v_and_b32 v69, 7, v1
    s_lshl_b32 s85, s28, 7
    s_lshl_b32 s86, s4, 5
    s_add_u32 s86, s85, s86
    v_add_u32 v71, s86, v68
    v_xor_b32 v70, v69, v64
    v_lshlrev_b32 v70, 4, v70
    v_lshl_add_u32 v20, v71, 11, v70
    v_xor_b32 v21, 64, v20
    v_add_u32 v21, 16384, v21
    s_lshl_b32 s79, s4, 12
    s_and_b32 s72, s28, 3
    s_bitcmp1_b32 s28, 3
    s_cselect_b32 s91, 4, 0
    s_add_u32 s72, s72, s91
    s_mul_i32 s72, s72, 256
    s_waitcnt lgkmcnt(0)
    s_mov_b32 s36, s8
    s_mov_b32 s37, s9
    s_mov_b32 s38, 0x400000
    s_mov_b32 s39, 0x20000
    s_add_u32 m0, s79, 135168
    s_add_u32 s72, s72, 128
    s_and_b32 s78, s72, 0x7ff
    buffer_load_dwordx4 v20, s[36:39], s78 offen lds
    s_add_u32 m0, s79, 136192
    s_nop 0
    buffer_load_dwordx4 v21, s[36:39], s78 offen lds
    s_add_u32 m0, s79, 137216
    s_add_u32 s78, s78, 32768
    buffer_load_dwordx4 v20, s[36:39], s78 offen lds
    s_add_u32 m0, s79, 138240
    s_nop 0
    buffer_load_dwordx4 v21, s[36:39], s78 offen lds
    s_setprio 0
    s_mov_b32 s68, s26
    s_mov_b32 s69, s27
    s_mov_b32 s70, 0x10000000
    s_mov_b32 s71, 0x20000
L_fan5:
    s_cbranch_execz L_teamB
    s_lshl_b32 s85, s4, 3
    s_and_b32 s86, s4, 1
    s_lshl_b32 s86, s86, 2
    v_and_b32 v70, 2, v68
    v_xor_b32 v70, v70, v69
    v_xor_b32 v70, s86, v70
    v_add_u32 v71, s85, v68
    v_mul_u32_u24 v71, 7168, v71
    v_lshl_add_u32 v22, v70, 4, v71
    v_lshrrev_b32 v71, 2, v1
    s_lshl_b32 s86, s86, 2
    v_add_u32 v71, s86, v71
    v_mul_u32_u24 v71, 7168, v71
    v_and_b32 v70, 2, v64
    v_xor_b32 v70, v70, v66
    v_lshl_add_u32 v9, v70, 4, v71
    s_mul_i32 s85, s29, 320
    s_and_b32 s86, s29, 1
    s_lshl_b32 s87, s86, 6
    s_add_u32 s87, s87, s85
    s_add_u32 s40, s16, s87
    s_addc_u32 s41, s17, 0
    s_sub_u32 s42, 7340032, s87
    s_mov_b32 s43, 0x20000
    s_add_u32 s44, s18, s87
    s_addc_u32 s45, s19, 0
    s_sub_u32 s46, 7340032, s87
    s_mov_b32 s47, 0x20000
    s_xor_b32 s86, s86, 1
    s_lshl_b32 s86, s86, 8
    s_add_u32 s87, s86, s85
    s_cmp_lt_u32 s4, 2
    s_cselect_b32 s88, s16, s18
    s_cselect_b32 s89, s17, s19
    s_add_u32 s48, s88, s87
    s_addc_u32 s49, s89, 0
    s_sub_u32 s50, 7340032, s87
    s_mov_b32 s51, 0x20000
    s_and_b32 s77, s28, 3
    s_bitcmp1_b32 s28, 3
    s_cselect_b32 s91, 4, 0
    s_add_u32 s77, s77, s91
    s_mul_i32 s77, s77, 917504
    s_add_u32 s77, s77, 0x38000
    s_add_u32 m0, s33, 57344
    s_add_u32 s77, s77, 229376
    s_cmp_eq_u32 s77, 7340032
    s_cselect_b32 s77, 0, s77
L_fan6:
    s_cbranch_execz L_teamB
    buffer_load_dwordx4 v22, s[40:43], s77 offen offset:0 lds
    s_add_u32 m0, s33, 61312
    s_nop 0
    buffer_load_dwordx4 v22, s[40:43], s77 offen offset:128 lds
    s_add_u32 m0, s33, 65536
    s_nop 0
    buffer_load_dwordx4 v22, s[44:47], s77 offen offset:0 lds
    s_add_u32 m0, s33, 69504
    s_nop 0
    buffer_load_dwordx4 v22, s[44:47], s77 offen offset:128 lds
    s_add_u32 m0, s33, 73728
    s_nop 0
    buffer_load_dwordx4 v9, s[48:51], s77 offen lds
    s_lshl_b32 s84, s28, 7
    s_lshl_b32 s85, s29, 3
    s_add_u32 s84, s84, s85
    s_lshl1_add_u32 s84, s4, s84
    s_lshl_b32 s90, s84, 3
    s_lshl_b32 s84, s84, 11
    v_lshl_add_u32 v86, v1, 4, s84
    v_and_b32 v70, 1, v67
    v_lshlrev_b32 v70, 4, v70
    v_mov_b32 v71, 0x3f80
    v_lshlrev_b32 v70, v70, v71
    v_lshrrev_b32 v71, 1, v67
    v_cmp_eq_u32 vcc, 0, v71
    s_nop 1
    v_cndmask_b32 v144, 0, v70, vcc
    v_cmp_eq_u32 vcc, 1, v71
    s_nop 1
    v_cndmask_b32 v145, 0, v70, vcc
    v_cmp_eq_u32 vcc, 2, v71
    s_nop 1
    v_cndmask_b32 v146, 0, v70, vcc
    v_cmp_eq_u32 vcc, 3, v71
    s_nop 1
    v_cndmask_b32 v147, 0, v70, vcc
    s_lshl_b32 s91, s4, 12
    s_add_u32 s91, s91, 16384
    v_lshlrev_b32 v70, 1, v64
    v_xor_b32 v71, v69, v70
    v_lshl_add_u32 v71, v71, 4, s91
    v_and_b32 v148, 4, v70
    v_add_u32 v70, v70, v148
    v_and_b32 v148, 1, v68
    v_add_u32 v70, v70, v148
    v_lshl_add_u32 v148, v70, 7, v71
    s_lshl_b32 s91, s5, 11
    s_add_u32 s91, s91, 32768
L_fan7:
    s_cbranch_execz L_teamB
    v_and_b32 v70, 2, v64
    v_xor_b32 v70, v66, v70
    v_lshl_add_u32 v70, v70, 4, s91
    v_lshrrev_b32 v71, 2, v1
    v_lshl_add_u32 v149, v71, 6, v70
    s_lshl2_add_u32 s91, s2, s4
    s_lshl_b32 s52, s91, 9
    s_lshr_b32 s92, s91, 2
    s_mul_i32 s92, s92, 7168
    s_and_b32 s91, s91, 3
    s_lshl_b32 s91, s91, 9
    s_add_u32 s92, s92, s91
    s_add_u32 s53, s92, 5120
    s_barrier
    s_and_b32 s91, s28, 4
    s_cmp_eq_u32 s91, 0
    s_cbranch_scc0 L_cr0
    ds_read_b128 v[112:115], v148 offset:0
    ds_read_b128 v[116:119], v148 offset:512
    ds_read_b128 v[120:123], v148 offset:2048
    ds_read_b128 v[124:127], v148 offset:2560
    ds_read_b128 v[128:131], v149 offset:0
    ds_read_b128 v[132:135], v149 offset:1024
L_cr0:
    s_add_u32 m0, s33, 77824
    s_add_u32 s77, s77, 229376
    buffer_load_dwordx4 v22, s[40:43], s77 offen offset:0 lds
    s_add_u32 m0, s33, 81792
    s_nop 0
    buffer_load_dwordx4 v22, s[40:43], s77 offen offset:128 lds
    s_add_u32 m0, s33, 86016
    s_nop 0
    buffer_load_dwordx4 v22, s[44:47], s77 offen offset:0 lds
    s_add_u32 m0, s33, 89984
    s_nop 0
    buffer_load_dwordx4 v22, s[44:47], s77 offen offset:128 lds
    s_add_u32 m0, s33, 94208
    s_nop 0
    buffer_load_dwordx4 v9, s[48:51], s77 offen lds
    s_add_u32 m0, s79, 98304
    s_add_u32 s72, s72, 128
    s_and_b32 s78, s72, 0x7ff
    buffer_load_dwordx4 v20, s[36:39], s78 offen lds
    s_add_u32 m0, s79, 99328
    s_nop 0
    buffer_load_dwordx4 v21, s[36:39], s78 offen lds
    s_and_b32 s91, s28, 4
    s_cmp_eq_u32 s91, 0
    s_cbranch_scc0 L_cm0
    s_waitcnt lgkmcnt(0)
    s_setprio 2
    v_mfma_f32_16x16x32_bf16 v[136:139], v[144:147], v[112:115], 0
    v_mfma_f32_16x16x32_bf16 v[140:143], v[144:147], v[128:131], 0
    v_mfma_f32_16x16x32_bf16 v[136:139], v[144:147], v[116:119], v[136:139]
    v_mfma_f32_16x16x32_bf16 v[140:143], v[144:147], v[132:135], v[140:143]
    v_mfma_f32_16x16x32_bf16 v[136:139], v[144:147], v[120:123], v[136:139]
    v_mfma_f32_16x16x32_bf16 v[136:139], v[144:147], v[124:127], v[136:139]
    s_setprio 0
L_cm0:
    s_barrier
    s_and_b32 s91, s28, 4
    s_cmp_eq_u32 s91, 0
    s_cbranch_scc0 L_cr1
    ds_read_b128 v[112:115], v148 offset:20480
    ds_read_b128 v[116:119], v148 offset:20992
    ds_read_b128 v[120:123], v148 offset:22528
    ds_read_b128 v[124:127], v148 offset:23040
    ds_read_b128 v[128:131], v149 offset:20480
    ds_read_b128 v[132:135], v149 offset:21504
L_cr1:
    s_add_u32 m0, s79, 100352
    s_add_u32 s78, s78, 32768
    buffer_load_dwordx4 v20, s[36:39], s78 offen lds
    s_add_u32 m0, s79, 101376
    s_nop 0
    buffer_load_dwordx4 v21, s[36:39], s78 offen lds
    s_add_u32 m0, s33, 16384
    s_add_u32 s77, s77, 229376
    s_cmp_eq_u32 s77, 7340032
    s_cselect_b32 s77, 0, s77
    buffer_load_dwordx4 v22, s[40:43], s77 offen offset:0 lds
    s_add_u32 m0, s33, 20352
    s_nop 0
    buffer_load_dwordx4 v22, s[40:43], s77 offen offset:128 lds
    s_add_u32 m0, s33, 24576
    s_nop 0
    buffer_load_dwordx4 v22, s[44:47], s77 offen offset:0 lds
    s_add_u32 m0, s33, 28544
    s_nop 0
    buffer_load_dwordx4 v22, s[44:47], s77 offen offset:128 lds
    s_add_u32 m0, s33, 32768
    s_nop 0
    buffer_load_dwordx4 v9, s[48:51], s77 offen lds
    s_and_b32 s91, s28, 4
    s_cmp_eq_u32 s91, 0
    s_cbranch_scc0 L_cm1
    s_waitcnt lgkmcnt(0)
    s_setprio 2
    v_mfma_f32_16x16x32_bf16 v[136:139], v[144:147], v[112:115], v[136:139]
    v_mfma_f32_16x16x32_bf16 v[140:143], v[144:147], v[128:131], v[140:143]
    v_mfma_f32_16x16x32_bf16 v[136:139], v[144:147], v[116:119], v[136:139]
    v_mfma_f32_16x16x32_bf16 v[140:143], v[144:147], v[132:135], v[140:143]
    v_mfma_f32_16x16x32_bf16 v[136:139], v[144:147], v[120:123], v[136:139]
    v_mfma_f32_16x16x32_bf16 v[136:139], v[144:147], v[124:127], v[136:139]
    s_setprio 0
L_cm1:
    s_waitcnt vmcnt(14)
    s_barrier
    s_and_b32 s91, s28, 4
    s_cmp_eq_u32 s91, 4
    s_cbranch_scc0 L_cr2
    ds_read_b128 v[112:115], v148 offset:40960
    ds_read_b128 v[116:119], v148 offset:41472
    ds_read_b128 v[120:123], v148 offset:43008
    ds_read_b128 v[124:127], v148 offset:43520
    ds_read_b128 v[128:131], v149 offset:40960
    ds_read_b128 v[132:135], v149 offset:41984
L_cr2:
    global_load_dwordx4 v[24:27], v86, s[8:9] offset:0
    global_load_dwordx4 v[32:35], v86, s[8:9] offset:2048
    global_load_dwordx4 v[28:31], v86, s[8:9] offset:1024
    global_load_dwordx4 v[36:39], v86, s[8:9] offset:3072
    s_add_u32 m0, s79, 116736
    s_add_u32 s72, s72, 128
    s_and_b32 s78, s72, 0x7ff
    buffer_load_dwordx4 v20, s[36:39], s78 offen lds
    s_add_u32 m0, s79, 117760
    s_nop 0
    buffer_load_dwordx4 v21, s[36:39], s78 offen lds
    s_add_u32 m0, s33, 36864
    s_add_u32 s77, s77, 229376
    buffer_load_dwordx4 v22, s[40:43], s77 offen offset:0 lds
    s_add_u32 m0, s33, 40832
    s_nop 0
    buffer_load_dwordx4 v22, s[40:43], s77 offen offset:128 lds
    s_add_u32 m0, s33, 45056
    s_nop 0
    buffer_load_dwordx4 v22, s[44:47], s77 offen offset:0 lds
    s_add_u32 m0, s33, 49024
    s_nop 0
    buffer_load_dwordx4 v22, s[44:47], s77 offen offset:128 lds
    s_add_u32 m0, s33, 53248
    s_nop 0
    buffer_load_dwordx4 v9, s[48:51], s77 offen lds
    s_and_b32 s91, s28, 4
    s_cmp_eq_u32 s91, 4
    s_cbranch_scc0 L_cm2
    s_waitcnt lgkmcnt(0)
    s_setprio 2
    v_mfma_f32_16x16x32_bf16 v[136:139], v[144:147], v[112:115], 0
    v_mfma_f32_16x16x32_bf16 v[140:143], v[144:147], v[128:131], 0
    v_mfma_f32_16x16x32_bf16 v[136:139], v[144:147], v[116:119], v[136:139]
    v_mfma_f32_16x16x32_bf16 v[140:143], v[144:147], v[132:135], v[140:143]
    v_mfma_f32_16x16x32_bf16 v[136:139], v[144:147], v[120:123], v[136:139]
    v_mfma_f32_16x16x32_bf16 v[136:139], v[144:147], v[124:127], v[136:139]
    s_setprio 0
L_cm2:
    s_waitcnt vmcnt(20)
    s_barrier
    s_and_b32 s91, s28, 4
    s_cmp_eq_u32 s91, 4
    s_cbranch_scc0 L_cr3
    ds_read_b128 v[112:115], v148 offset:61440
    ds_read_b128 v[116:119], v148 offset:61952
    ds_read_b128 v[120:123], v148 offset:63488
    ds_read_b128 v[124:127], v148 offset:64000
    ds_read_b128 v[128:131], v149 offset:61440
    ds_read_b128 v[132:135], v149 offset:62464
L_cr3:
    s_add_u32 m0, s79, 118784
    s_add_u32 s78, s78, 32768
    buffer_load_dwordx4 v20, s[36:39], s78 offen lds
    s_add_u32 m0, s79, 119808
    s_nop 0
    buffer_load_dwordx4 v21, s[36:39], s78 offen lds
    s_add_u32 m0, s33, 57344
    s_add_u32 s77, s77, 229376
    s_cmp_eq_u32 s77, 7340032
    s_cselect_b32 s77, 0, s77
    buffer_load_dwordx4 v22, s[40:43], s77 offen offset:0 lds
    s_add_u32 m0, s33, 61312
    s_nop 0
    buffer_load_dwordx4 v22, s[40:43], s77 offen offset:128 lds
    s_add_u32 m0, s33, 65536
    s_nop 0
    buffer_load_dwordx4 v22, s[44:47], s77 offen offset:0 lds
    s_add_u32 m0, s33, 69504
    s_nop 0
    buffer_load_dwordx4 v22, s[44:47], s77 offen offset:128 lds
    s_add_u32 m0, s33, 73728
    s_nop 0
    buffer_load_dwordx4 v9, s[48:51], s77 offen lds
    s_and_b32 s91, s28, 4
    s_cmp_eq_u32 s91, 4
    s_cbranch_scc0 L_cm3
    s_waitcnt lgkmcnt(0)
    s_setprio 2
    v_mfma_f32_16x16x32_bf16 v[136:139], v[144:147], v[112:115], v[136:139]
    v_mfma_f32_16x16x32_bf16 v[140:143], v[144:147], v[128:131], v[140:143]
    v_mfma_f32_16x16x32_bf16 v[136:139], v[144:147], v[116:119], v[136:139]
    v_mfma_f32_16x16x32_bf16 v[140:143], v[144:147], v[132:135], v[140:143]
    v_mfma_f32_16x16x32_bf16 v[136:139], v[144:147], v[120:123], v[136:139]
    v_mfma_f32_16x16x32_bf16 v[136:139], v[144:147], v[124:127], v[136:139]
    s_setprio 0
L_cm3:
    s_sub_u32 s91, s2, 224
    s_lshl1_add_u32 s91, s91, 1
    s_cmp_ge_u32 s2, 224
    s_cselect_b32 s91, s91, s2
    s_cselect_b32 s88, s12, s20
    s_cselect_b32 s89, s13, s21
    s_cselect_b32 s34, 0x800000, 0
    s_lshr_b32 s92, s91, 2
    s_lshl_b32 s92, s92, 17
    s_add_u32 s34, s34, s92
    s_and_b32 s93, s91, 3
    s_lshl_b32 s93, s93, 13
    s_add_u32 s34, s34, s93
    s_and_b32 s93, s91, 1
    s_lshl_b32 s93, s93, 7
    s_add_u32 s92, s92, s93
    s_and_b32 s93, s91, 2
    s_lshl_b32 s93, s93, 9
    s_add_u32 s92, s92, s93
    s_add_u32 s92, s92, 256
    s_add_u32 s88, s88, s92
    s_addc_u32 s89, s89, 0
    s_lshl_b32 s76, s4, 15
    s_waitcnt vmcnt(18)
    s_barrier
    s_add_u32 m0, s79, 135168
    s_add_u32 s72, s72, 128
    s_and_b32 s78, s72, 0x7ff
    buffer_load_dwordx4 v20, s[36:39], s78 offen lds
    s_add_u32 m0, s79, 136192
    s_nop 0
    buffer_load_dwordx4 v21, s[36:39], s78 offen lds
    s_add_u32 m0, s33, 77824
    s_add_u32 s77, s77, 229376
    buffer_load_dwordx4 v22, s[40:43], s77 offen offset:0 lds
    s_add_u32 m0, s33, 81792
    s_nop 0
    buffer_load_dwordx4 v22, s[40:43], s77 offen offset:128 lds
    s_add_u32 m0, s33, 86016
    s_nop 0
    buffer_load_dwordx4 v22, s[44:47], s77 offen offset:0 lds
    s_add_u32 m0, s33, 89984
    s_nop 0
    buffer_load_dwordx4 v22, s[44:47], s77 offen offset:128 lds
    s_add_u32 m0, s33, 94208
    s_nop 0
    buffer_load_dwordx4 v9, s[48:51], s77 offen lds
    v_add_f32_dpp v136, v136, v136 row_ror:8 row_mask:0xf bank_mask:0xf
    v_add_f32_dpp v137, v137, v137 row_ror:8 row_mask:0xf bank_mask:0xf
    v_add_f32_dpp v138, v138, v138 row_ror:8 row_mask:0xf bank_mask:0xf
    v_add_f32_dpp v139, v139, v139 row_ror:8 row_mask:0xf bank_mask:0xf
    v_add_f32_dpp v140, v140, v140 row_ror:8 row_mask:0xf bank_mask:0xf
    v_add_f32_dpp v141, v141, v141 row_ror:8 row_mask:0xf bank_mask:0xf
    v_add_f32_dpp v142, v142, v142 row_ror:8 row_mask:0xf bank_mask:0xf
    v_add_f32_dpp v143, v143, v143 row_ror:8 row_mask:0xf bank_mask:0xf
    v_add_f32_dpp v140, v140, v140 row_ror:4 row_mask:0xf bank_mask:0xf
    v_add_f32_dpp v141, v141, v141 row_ror:4 row_mask:0xf bank_mask:0xf
    v_add_f32_dpp v142, v142, v142 row_ror:4 row_mask:0xf bank_mask:0xf
    v_add_f32_dpp v143, v143, v143 row_ror:4 row_mask:0xf bank_mask:0xf
    s_lshl_b32 s91, s29, 4
    s_add_u32 s91, s91, s28
    s_mul_i32 s91, s91, 1280
    s_mul_i32 s92, s5, 640
    s_add_u32 s91, s91, s92
    s_add_u32 s91, s91, 0x1e10000
    s_lshl_b32 s92, s6, 8
    v_and_b32 v112, 8, v1
    v_cmp_eq_u32 vcc, 0, v112
    v_mov_b32 v112, s92
    v_mov_b32 v113, 256
    v_cndmask_b32 v112, v113, v112, vcc
    v_cndmask_b32 v136, v140, v136, vcc
    v_cndmask_b32 v137, v141, v137, vcc
    v_cndmask_b32 v138, v142, v138, vcc
    v_cndmask_b32 v139, v143, v139, vcc
    v_and_b32 v113, 15, v1
    v_lshl_add_u32 v112, v113, 5, v112
    v_and_b32 v113, 16, v1
    v_add3_u32 v112, v112, v113, s91
    s_mov_b64 exec, 0x0fff0fff
    global_store_dwordx4 v112, v[136:139], s[26:27] sc1
    s_mov_b64 exec, -1
    s_load_dword s94, s[88:89], s76 offset:0
    s_load_dword s94, s[88:89], s76 offset:64
    s_load_dword s94, s[88:89], s76 offset:2048
    s_load_dword s94, s[88:89], s76 offset:2112
    s_waitcnt vmcnt(15)
    s_barrier
    s_add_u32 m0, s79, 137216
    s_add_u32 s78, s78, 32768
    buffer_load_dwordx4 v20, s[36:39], s78 offen lds
    s_waitcnt vmcnt(23)
    v_lshlrev_b32 v40, 16, v24
    v_and_b32 v41, 0xffff0000, v24
    v_lshlrev_b32 v42, 16, v25
    v_and_b32 v43, 0xffff0000, v25
    v_lshlrev_b32 v44, 16, v26
    v_and_b32 v45, 0xffff0000, v26
    v_lshlrev_b32 v46, 16, v27
    v_and_b32 v47, 0xffff0000, v27
    s_add_u32 m0, s79, 138240
    s_nop 0
    buffer_load_dwordx4 v21, s[36:39], s78 offen lds
    v_lshlrev_b32 v48, 16, v28
    v_and_b32 v49, 0xffff0000, v28
    v_lshlrev_b32 v50, 16, v29
    v_and_b32 v51, 0xffff0000, v29
    v_lshlrev_b32 v52, 16, v30
    v_and_b32 v53, 0xffff0000, v30
    v_lshlrev_b32 v54, 16, v31
    v_and_b32 v55, 0xffff0000, v31
    s_add_u32 m0, s33, 16384
    s_add_u32 s77, s77, 229376
    s_cmp_eq_u32 s77, 7340032
    s_cselect_b32 s77, 0, s77
    buffer_load_dwordx4 v22, s[40:43], s77 offen offset:0 lds
    v_lshlrev_b32 v56, 16, v32
    v_and_b32 v57, 0xffff0000, v32
    v_lshlrev_b32 v58, 16, v33
    v_and_b32 v59, 0xffff0000, v33
    v_lshlrev_b32 v60, 16, v34
    v_and_b32 v61, 0xffff0000, v34
    v_lshlrev_b32 v62, 16, v35
    v_and_b32 v63, 0xffff0000, v35
    s_add_u32 m0, s33, 20352
    s_nop 0
    buffer_load_dwordx4 v22, s[40:43], s77 offen offset:128 lds
    v_lshlrev_b32 v64, 16, v36
    v_and_b32 v65, 0xffff0000, v36
    v_lshlrev_b32 v66, 16, v37
    v_and_b32 v67, 0xffff0000, v37
    v_lshlrev_b32 v68, 16, v38
    v_and_b32 v69, 0xffff0000, v38
    v_lshlrev_b32 v70, 16, v39
    v_and_b32 v71, 0xffff0000, v39
    s_add_u32 m0, s33, 24576
    s_nop 0
    buffer_load_dwordx4 v22, s[44:47], s77 offen offset:0 lds
    v_add_f32 v72, v40, v41
    v_add_f32 v74, v56, v57
    v_add_f32 v72, v72, v42
    v_add_f32 v74, v74, v58
    v_add_f32 v72, v72, v43
    v_add_f32 v74, v74, v59
    v_add_f32 v72, v72, v44
    v_add_f32 v74, v74, v60
    s_add_u32 m0, s33, 28544
    s_nop 0
    buffer_load_dwordx4 v22, s[44:47], s77 offen offset:128 lds
    s_add_u32 m0, s33, 32768
    s_nop 0
    buffer_load_dwordx4 v9, s[48:51], s77 offen lds
    v_add_f32 v72, v72, v45
    v_add_f32 v74, v74, v61
    v_add_f32 v72, v72, v46
    v_add_f32 v74, v74, v62
    v_add_f32 v72, v72, v47
    v_add_f32 v74, v74, v63
    v_add_f32 v72, v72, v48
    v_add_f32 v74, v74, v64
    s_load_dword s94, s[88:89], s76 offset:4096
    s_load_dword s94, s[88:89], s76 offset:4160
    s_load_dword s94, s[88:89], s76 offset:6144
    s_load_dword s94, s[88:89], s76 offset:6208
    s_waitcnt vmcnt(15)
    s_barrier
    s_add_u32 m0, s79, 98304
    s_add_u32 s72, s72, 128
    s_and_b32 s78, s72, 0x7ff
    buffer_load_dwordx4 v20, s[36:39], s78 offen lds
    v_add_f32 v72, v72, v49
    v_add_f32 v74, v74, v65
    v_add_f32 v72, v72, v50
    v_add_f32 v74, v74, v66
    v_add_f32 v72, v72, v51
    v_add_f32 v74, v74, v67
    v_add_f32 v72, v72, v52
    v_add_f32 v74, v74, v68
    s_add_u32 m0, s79, 99328
    s_nop 0
    buffer_load_dwordx4 v21, s[36:39], s78 offen lds
    v_add_f32 v72, v72, v53
    v_add_f32 v74, v74, v69
    v_add_f32 v72, v72, v54
    v_add_f32 v74, v74, v70
    v_add_f32 v72, v72, v55
    v_add_f32 v74, v74, v71
    s_nop 0
    v_add_f32_dpp v72, v72, v72 quad_perm:[1,0,3,2] row_mask:0xf bank_mask:0xf
    v_add_f32_dpp v74, v74, v74 quad_perm:[1,0,3,2] row_mask:0xf bank_mask:0xf
    s_add_u32 m0, s33, 36864
    s_add_u32 s77, s77, 229376
    buffer_load_dwordx4 v22, s[40:43], s77 offen offset:0 lds
    s_nop 0
    v_add_f32_dpp v72, v72, v72 quad_perm:[2,3,0,1] row_mask:0xf bank_mask:0xf
    v_add_f32_dpp v74, v74, v74 quad_perm:[2,3,0,1] row_mask:0xf bank_mask:0xf
    s_nop 0
    v_add_f32_dpp v72, v72, v72 row_half_mirror row_mask:0xf bank_mask:0xf
    v_add_f32_dpp v74, v74, v74 row_half_mirror row_mask:0xf bank_mask:0xf
    s_nop 0
    v_add_f32_dpp v72, v72, v72 row_mirror row_mask:0xf bank_mask:0xf
    v_add_f32_dpp v74, v74, v74 row_mirror row_mask:0xf bank_mask:0xf
    v_mov_b32 v78, v72
    s_add_u32 m0, s33, 40832
    s_nop 0
    buffer_load_dwordx4 v22, s[40:43], s77 offen offset:128 lds
    v_mov_b32 v79, v74
    s_nop 0
    v_permlane16_swap_b32 v72, v78
    v_permlane16_swap_b32 v74, v79
    v_add_f32 v72, v72, v78
    v_add_f32 v74, v74, v79
    v_mov_b32 v78, v72
    v_mov_b32 v79, v74
    s_nop 0
    v_permlane32_swap_b32 v72, v78
    s_add_u32 m0, s33, 45056
    s_nop 0
    buffer_load_dwordx4 v22, s[44:47], s77 offen offset:0 lds
    s_add_u32 m0, s33, 49024
    s_nop 0
    buffer_load_dwordx4 v22, s[44:47], s77 offen offset:128 lds
    v_permlane32_swap_b32 v74, v79
    v_add_f32 v72, v72, v78
    v_add_f32 v74, v74, v79
    v_mul_f32 v72, 0x3a800000, v72
    v_mul_f32 v74, 0x3a800000, v74
    v_sub_f32 v78, v40, v72
    v_sub_f32 v79, v56, v74
    v_mul_f32 v73, v78, v78
    s_add_u32 m0, s33, 53248
    s_nop 0
    buffer_load_dwordx4 v9, s[48:51], s77 offen lds
    v_mul_f32 v75, v79, v79
    v_sub_f32 v78, v41, v72
    v_sub_f32 v79, v57, v74
    v_fmac_f32 v73, v78, v78
    v_fmac_f32 v75, v79, v79
    v_sub_f32 v78, v42, v72
    v_sub_f32 v79, v58, v74
    v_fmac_f32 v73, v78, v78
    s_load_dword s94, s[88:89], s76 offset:8192
    s_load_dword s94, s[88:89], s76 offset:8256
    s_load_dword s94, s[88:89], s76 offset:10240
    s_load_dword s94, s[88:89], s76 offset:10304
    s_waitcnt vmcnt(15)
    s_barrier
    s_add_u32 m0, s79, 100352
    s_add_u32 s78, s78, 32768
    buffer_load_dwordx4 v20, s[36:39], s78 offen lds
    v_fmac_f32 v75, v79, v79
    v_sub_f32 v78, v43, v72
    v_sub_f32 v79, v59, v74
    v_fmac_f32 v73, v78, v78
    v_fmac_f32 v75, v79, v79
    v_sub_f32 v78, v44, v72
    v_sub_f32 v79, v60, v74
    v_fmac_f32 v73, v78, v78
    s_add_u32 m0, s79, 101376
    s_nop 0
    buffer_load_dwordx4 v21, s[36:39], s78 offen lds
    v_fmac_f32 v75, v79, v79
    v_sub_f32 v78, v45, v72
    v_sub_f32 v79, v61, v74
    v_fmac_f32 v73, v78, v78
    v_fmac_f32 v75, v79, v79
    v_sub_f32 v78, v46, v72
    v_sub_f32 v79, v62, v74
    v_fmac_f32 v73, v78, v78
    s_add_u32 m0, s33, 57344
    s_add_u32 s77, s77, 229376
    s_cmp_eq_u32 s77, 7340032
    s_cselect_b32 s77, 0, s77
    buffer_load_dwordx4 v22, s[40:43], s77 offen offset:0 lds
    v_fmac_f32 v75, v79, v79
    v_sub_f32 v78, v47, v72
    v_sub_f32 v79, v63, v74
    v_fmac_f32 v73, v78, v78
    v_fmac_f32 v75, v79, v79
    v_sub_f32 v78, v48, v72
    v_sub_f32 v79, v64, v74
    v_fmac_f32 v73, v78, v78
    s_add_u32 m0, s33, 61312
    s_nop 0
    buffer_load_dwordx4 v22, s[40:43], s77 offen offset:128 lds
    v_fmac_f32 v75, v79, v79
    v_sub_f32 v78, v49, v72
    v_sub_f32 v79, v65, v74
    v_fmac_f32 v73, v78, v78
    v_fmac_f32 v75, v79, v79
    v_sub_f32 v78, v50, v72
    v_sub_f32 v79, v66, v74
    v_fmac_f32 v73, v78, v78
    s_add_u32 m0, s33, 65536
    s_nop 0
    buffer_load_dwordx4 v22, s[44:47], s77 offen offset:0 lds
    v_fmac_f32 v75, v79, v79
    v_sub_f32 v78, v51, v72
    v_sub_f32 v79, v67, v74
    v_fmac_f32 v73, v78, v78
    v_fmac_f32 v75, v79, v79
    v_sub_f32 v78, v52, v72
    v_sub_f32 v79, v68, v74
    v_fmac_f32 v73, v78, v78
    s_add_u32 m0, s33, 69504
    s_nop 0
    buffer_load_dwordx4 v22, s[44:47], s77 offen offset:128 lds
    s_add_u32 m0, s33, 73728
    s_nop 0
    buffer_load_dwordx4 v9, s[48:51], s77 offen lds
    v_fmac_f32 v75, v79, v79
    v_sub_f32 v78, v53, v72
    v_sub_f32 v79, v69, v74
    v_fmac_f32 v73, v78, v78
    v_fmac_f32 v75, v79, v79
    v_sub_f32 v78, v54, v72
    v_sub_f32 v79, v70, v74
    v_fmac_f32 v73, v78, v78
    s_load_dword s94, s[88:89], s76 offset:12288
    s_load_dword s94, s[88:89], s76 offset:12352
    s_load_dword s94, s[88:89], s76 offset:14336
    s_load_dword s94, s[88:89], s76 offset:14400
    s_waitcnt vmcnt(14)
    s_barrier
    s_add_u32 m0, s79, 116736
    s_add_u32 s72, s72, 128
    s_and_b32 s78, s72, 0x7ff
    buffer_load_dwordx4 v20, s[36:39], s78 offen lds
    v_fmac_f32 v75, v79, v79
    v_sub_f32 v78, v55, v72
    v_sub_f32 v79, v71, v74
    v_fmac_f32 v73, v78, v78
    v_fmac_f32 v75, v79, v79
    s_nop 0
    v_add_f32_dpp v73, v73, v73 quad_perm:[1,0,3,2] row_mask:0xf bank_mask:0xf
    v_add_f32_dpp v75, v75, v75 quad_perm:[1,0,3,2] row_mask:0xf bank_mask:0xf
    s_nop 0
    v_add_f32_dpp v73, v73, v73 quad_perm:[2,3,0,1] row_mask:0xf bank_mask:0xf
    s_add_u32 m0, s79, 117760
    s_nop 0
    buffer_load_dwordx4 v21, s[36:39], s78 offen lds
    v_add_f32_dpp v75, v75, v75 quad_perm:[2,3,0,1] row_mask:0xf bank_mask:0xf
    s_nop 0
    v_add_f32_dpp v73, v73, v73 row_half_mirror row_mask:0xf bank_mask:0xf
    v_add_f32_dpp v75, v75, v75 row_half_mirror row_mask:0xf bank_mask:0xf
    s_nop 0
    v_add_f32_dpp v73, v73, v73 row_mirror row_mask:0xf bank_mask:0xf
    v_add_f32_dpp v75, v75, v75 row_mirror row_mask:0xf bank_mask:0xf
    v_mov_b32 v78, v73
    v_mov_b32 v79, v75
    s_add_u32 m0, s33, 77824
    s_add_u32 s77, s77, 229376
    buffer_load_dwordx4 v22, s[40:43], s77 offen offset:0 lds
    s_nop 0
    v_permlane16_swap_b32 v73, v78
    v_permlane16_swap_b32 v75, v79
L_pad6:
    s_cbranch_execz L_vret0
    v_add_f32 v73, v73, v78
    v_add_f32 v75, v75, v79
    v_mov_b32 v78, v73
    v_mov_b32 v79, v75
    s_nop 0
    v_permlane32_swap_b32 v73, v78
    s_add_u32 m0, s33, 81792
    s_nop 0
    buffer_load_dwordx4 v22, s[40:43], s77 offen offset:128 lds
    v_permlane32_swap_b32 v75, v79
    v_add_f32 v73, v73, v78
    v_add_f32 v75, v75, v79
    v_mul_f32 v73, 0x3a800000, v73
    v_mul_f32 v75, 0x3a800000, v75
    v_cvt_pk_bf16_f32 v72, v72, v72
    v_lshlrev_b32 v72, 16, v72
    v_cvt_pk_bf16_f32 v73, v73, v73
    s_add_u32 m0, s33, 86016
    s_nop 0
    buffer_load_dwordx4 v22, s[44:47], s77 offen offset:0 lds
    s_add_u32 m0, s33, 89984
    s_nop 0
    buffer_load_dwordx4 v22, s[44:47], s77 offen offset:128 lds
    v_lshlrev_b32 v73, 16, v73
    v_add_f32 v73, 0x3727c5ac, v73
    v_cvt_pk_bf16_f32 v73, v73, v73
    v_lshlrev_b32 v73, 16, v73
    v_sqrt_f32 v73, v73
    v_cvt_pk_bf16_f32 v74, v74, v74
    v_lshlrev_b32 v74, 16, v74
    s_add_u32 m0, s33, 94208
    s_nop 0
    buffer_load_dwordx4 v9, s[48:51], s77 offen lds
    v_cvt_pk_bf16_f32 v75, v75, v75
    v_lshlrev_b32 v75, 16, v75
    v_add_f32 v75, 0x3727c5ac, v75
    v_cvt_pk_bf16_f32 v75, v75, v75
    v_lshlrev_b32 v75, 16, v75
    v_sqrt_f32 v75, v75
    s_nop 0
    v_cvt_pk_bf16_f32 v73, v73, v73
    s_load_dword s94, s[88:89], s76 offset:16384
    s_load_dword s94, s[88:89], s76 offset:16448
    s_load_dword s94, s[88:89], s76 offset:18432
    s_load_dword s94, s[88:89], s76 offset:18496
    s_waitcnt vmcnt(14)
    s_barrier
    s_add_u32 m0, s79, 118784
    s_add_u32 s78, s78, 32768
    buffer_load_dwordx4 v20, s[36:39], s78 offen lds
    v_lshlrev_b32 v73, 16, v73
    v_rcp_f32 v76, v73
    s_nop 0
    v_cvt_pk_bf16_f32 v75, v75, v75
    v_lshlrev_b32 v75, 16, v75
    v_rcp_f32 v77, v75
    s_nop 0
    v_fma_f32 v78, -v73, v76, 1.0
    s_add_u32 m0, s79, 119808
    s_nop 0
    buffer_load_dwordx4 v21, s[36:39], s78 offen lds
    v_fma_f32 v76, v78, v76, v76
    s_nop 0
    v_fma_f32 v79, -v75, v77, 1.0
    v_fma_f32 v77, v79, v77, v77
    v_sub_f32 v80, v40, v72
    v_sub_f32 v81, v41, v72
    v_cvt_pk_bf16_f32 v80, v80, v81
    v_and_b32 v81, 0xffff0000, v80
    v_lshlrev_b32 v80, 16, v80
    s_add_u32 m0, s33, 16384
    s_add_u32 s77, s77, 229376
    s_cmp_eq_u32 s77, 7340032
    s_cselect_b32 s77, 0, s77
    buffer_load_dwordx4 v22, s[40:43], s77 offen offset:0 lds
    v_mul_f32 v80, v80, v76
    v_mul_f32 v81, v81, v76
    v_cvt_pk_bf16_f32 v24, v80, v81
    v_sub_f32 v80, v42, v72
    v_sub_f32 v81, v43, v72
    v_cvt_pk_bf16_f32 v80, v80, v81
    v_and_b32 v81, 0xffff0000, v80
    v_lshlrev_b32 v80, 16, v80
    s_add_u32 m0, s33, 20352
    s_nop 0
    buffer_load_dwordx4 v22, s[40:43], s77 offen offset:128 lds
    v_mul_f32 v80, v80, v76
    v_mul_f32 v81, v81, v76
    v_cvt_pk_bf16_f32 v25, v80, v81
    v_sub_f32 v80, v44, v72
    v_sub_f32 v81, v45, v72
    v_cvt_pk_bf16_f32 v80, v80, v81
    v_and_b32 v81, 0xffff0000, v80
    v_lshlrev_b32 v80, 16, v80
    s_add_u32 m0, s33, 24576
    s_nop 0
    buffer_load_dwordx4 v22, s[44:47], s77 offen offset:0 lds
    s_add_u32 m0, s33, 28544
    s_nop 0
    buffer_load_dwordx4 v22, s[44:47], s77 offen offset:128 lds
    v_mul_f32 v80, v80, v76
    v_mul_f32 v81, v81, v76
    v_cvt_pk_bf16_f32 v26, v80, v81
    v_sub_f32 v80, v46, v72
    v_sub_f32 v81, v47, v72
    v_cvt_pk_bf16_f32 v80, v80, v81
    v_and_b32 v81, 0xffff0000, v80
    v_lshlrev_b32 v80, 16, v80
    s_add_u32 m0, s33, 32768
    s_nop 0
    buffer_load_dwordx4 v9, s[48:51], s77 offen lds
    v_mul_f32 v80, v80, v76
    v_mul_f32 v81, v81, v76
    v_cvt_pk_bf16_f32 v27, v80, v81
    v_sub_f32 v80, v48, v72
    v_sub_f32 v81, v49, v72
    v_cvt_pk_bf16_f32 v80, v80, v81
    v_and_b32 v81, 0xffff0000, v80
    v_lshlrev_b32 v80, 16, v80
    s_load_dword s94, s[88:89], s76 offset:20480
    s_load_dword s94, s[88:89], s76 offset:20544
    s_load_dword s94, s[88:89], s76 offset:22528
    s_load_dword s94, s[88:89], s76 offset:22592
    s_waitcnt vmcnt(14)
    s_barrier
    s_add_u32 m0, s79, 135168
    s_add_u32 s72, s72, 128
    s_and_b32 s78, s72, 0x7ff
    buffer_load_dwordx4 v20, s[36:39], s78 offen lds
    v_mul_f32 v80, v80, v76
    v_mul_f32 v81, v81, v76
    v_cvt_pk_bf16_f32 v28, v80, v81
    v_sub_f32 v80, v50, v72
    v_sub_f32 v81, v51, v72
    v_cvt_pk_bf16_f32 v80, v80, v81
    v_and_b32 v81, 0xffff0000, v80
    v_lshlrev_b32 v80, 16, v80
    s_add_u32 m0, s79, 136192
    s_nop 0
    buffer_load_dwordx4 v21, s[36:39], s78 offen lds
    v_mul_f32 v80, v80, v76
    v_mul_f32 v81, v81, v76
    v_cvt_pk_bf16_f32 v29, v80, v81
    v_sub_f32 v80, v52, v72
    v_sub_f32 v81, v53, v72
    v_cvt_pk_bf16_f32 v80, v80, v81
    v_and_b32 v81, 0xffff0000, v80
    v_lshlrev_b32 v80, 16, v80
    s_add_u32 m0, s33, 36864
    s_add_u32 s77, s77, 229376
    buffer_load_dwordx4 v22, s[40:43], s77 offen offset:0 lds
    v_mul_f32 v80, v80, v76
    v_mul_f32 v81, v81, v76
    v_cvt_pk_bf16_f32 v30, v80, v81
    v_sub_f32 v80, v54, v72
    v_sub_f32 v81, v55, v72
    v_cvt_pk_bf16_f32 v80, v80, v81
    v_and_b32 v81, 0xffff0000, v80
    v_lshlrev_b32 v80, 16, v80
    s_add_u32 m0, s33, 40832
    s_nop 0
    buffer_load_dwordx4 v22, s[40:43], s77 offen offset:128 lds
    v_mul_f32 v80, v80, v76
    v_mul_f32 v81, v81, v76
    v_cvt_pk_bf16_f32 v31, v80, v81
    v_sub_f32 v80, v56, v74
    v_sub_f32 v81, v57, v74
    v_cvt_pk_bf16_f32 v80, v80, v81
    v_and_b32 v81, 0xffff0000, v80
    v_lshlrev_b32 v80, 16, v80
    s_add_u32 m0, s33, 45056
    s_nop 0
    buffer_load_dwordx4 v22, s[44:47], s77 offen offset:0 lds
    v_mul_f32 v80, v80, v77
    v_mul_f32 v81, v81, v77
    v_cvt_pk_bf16_f32 v32, v80, v81
    v_sub_f32 v80, v58, v74
    v_sub_f32 v81, v59, v74
    v_cvt_pk_bf16_f32 v80, v80, v81
    v_and_b32 v81, 0xffff0000, v80
    v_lshlrev_b32 v80, 16, v80
    s_add_u32 m0, s33, 49024
    s_nop 0
    buffer_load_dwordx4 v22, s[44:47], s77 offen offset:128 lds
    s_add_u32 m0, s33, 53248
    s_nop 0
    buffer_load_dwordx4 v9, s[48:51], s77 offen lds
    v_mul_f32 v80, v80, v77
    v_mul_f32 v81, v81, v77
    v_cvt_pk_bf16_f32 v33, v80, v81
    v_sub_f32 v80, v60, v74
    v_sub_f32 v81, v61, v74
    v_cvt_pk_bf16_f32 v80, v80, v81
    v_and_b32 v81, 0xffff0000, v80
    v_lshlrev_b32 v80, 16, v80
    s_load_dword s94, s[88:89], s76 offset:24576
    s_load_dword s94, s[88:89], s76 offset:24640
    s_load_dword s94, s[88:89], s76 offset:26624
    s_load_dword s94, s[88:89], s76 offset:26688
    s_waitcnt vmcnt(14)
    s_barrier
    s_add_u32 m0, s79, 137216
    s_add_u32 s78, s78, 32768
    buffer_load_dwordx4 v20, s[36:39], s78 offen lds
    v_mul_f32 v80, v80, v77
    v_mul_f32 v81, v81, v77
    v_cvt_pk_bf16_f32 v34, v80, v81
    v_sub_f32 v80, v62, v74
    v_sub_f32 v81, v63, v74
    v_cvt_pk_bf16_f32 v80, v80, v81
    v_and_b32 v81, 0xffff0000, v80
    v_lshlrev_b32 v80, 16, v80
    s_add_u32 m0, s79, 138240
    s_nop 0
    buffer_load_dwordx4 v21, s[36:39], s78 offen lds
    v_mul_f32 v80, v80, v77
    v_mul_f32 v81, v81, v77
    v_cvt_pk_bf16_f32 v35, v80, v81
    v_sub_f32 v80, v64, v74
    v_sub_f32 v81, v65, v74
    v_cvt_pk_bf16_f32 v80, v80, v81
    v_and_b32 v81, 0xffff0000, v80
    v_lshlrev_b32 v80, 16, v80
    s_add_u32 m0, s33, 57344
    s_add_u32 s77, s77, 229376
    s_cmp_eq_u32 s77, 7340032
    s_cselect_b32 s77, 0, s77
    buffer_load_dwordx4 v22, s[40:43], s77 offen offset:0 lds
    v_mul_f32 v80, v80, v77
    v_mul_f32 v81, v81, v77
    v_cvt_pk_bf16_f32 v36, v80, v81
    v_sub_f32 v80, v66, v74
    v_sub_f32 v81, v67, v74
    v_cvt_pk_bf16_f32 v80, v80, v81
    v_and_b32 v81, 0xffff0000, v80
    v_lshlrev_b32 v80, 16, v80
    s_add_u32 m0, s33, 61312
    s_nop 0
    buffer_load_dwordx4 v22, s[40:43], s77 offen offset:128 lds
    v_mul_f32 v80, v80, v77
    v_mul_f32 v81, v81, v77
    v_cvt_pk_bf16_f32 v37, v80, v81
    v_sub_f32 v80, v68, v74
    v_sub_f32 v81, v69, v74
    v_cvt_pk_bf16_f32 v80, v80, v81
    v_and_b32 v81, 0xffff0000, v80
    v_lshlrev_b32 v80, 16, v80
    s_add_u32 m0, s33, 65536
    s_nop 0
    buffer_load_dwordx4 v22, s[44:47], s77 offen offset:0 lds
    v_mul_f32 v80, v80, v77
    v_mul_f32 v81, v81, v77
    v_cvt_pk_bf16_f32 v38, v80, v81
    v_sub_f32 v80, v70, v74
    v_sub_f32 v81, v71, v74
    v_cvt_pk_bf16_f32 v80, v80, v81
    v_and_b32 v81, 0xffff0000, v80
    v_lshlrev_b32 v80, 16, v80
    s_add_u32 m0, s33, 69504
    s_nop 0
    buffer_load_dwordx4 v22, s[44:47], s77 offen offset:128 lds
    s_add_u32 m0, s33, 73728
    s_nop 0
    buffer_load_dwordx4 v9, s[48:51], s77 offen lds
    v_mul_f32 v80, v80, v77
    v_mul_f32 v81, v81, v77
    v_cvt_pk_bf16_f32 v39, v80, v81
    s_add_u32 s90, s90, 0x1e00000
    v_mov_b32 v7, s90
    s_mov_b64 exec, 1
    global_store_dwordx4 v7, v[72:75], s[26:27] sc1
    s_mov_b64 exec, -1
    v_lshrrev_b32 v64, 4, v1
    v_bfe_u32 v65, v1, 2, 2
    v_and_b32 v66, 3, v1
    v_and_b32 v67, 15, v1
    v_lshrrev_b32 v68, 3, v1
    v_and_b32 v69, 7, v1
    s_lshl_b32 s85, s6, 2
    s_lshl_b32 s86, s5, 1
    s_or_b32 s85, s85, s86
    v_lshl_add_u32 v70, v64, 3, v65
    v_lshlrev_b32 v70, 7, v70
    global_store_dwordx4 v86, v[24:27], s[26:27] offset:0 sc1
    s_load_dword s94, s[88:89], s76 offset:28672
    s_load_dword s94, s[88:89], s76 offset:28736
    s_load_dword s94, s[88:89], s76 offset:30720
    s_load_dword s94, s[88:89], s76 offset:30784
    s_waitcnt vmcnt(16)
    s_barrier
    s_add_u32 m0, s79, 98304
    s_add_u32 s72, s72, 128
    s_and_b32 s78, s72, 0x7ff
    buffer_load_dwordx4 v20, s[36:39], s78 offen lds
    v_and_b32 v71, 1, v66
    v_lshl_add_u32 v70, v71, 3, v70
    v_add_u32 v70, 16384, v70
    v_and_b32 v71, 2, v65
    v_and_b32 v72, 1, v64
    v_lshl_add_u32 v71, v72, 2, v71
    v_lshrrev_b32 v72, 1, v66
    v_xor_b32 v71, v71, v72
    s_add_u32 m0, s79, 99328
    s_nop 0
    buffer_load_dwordx4 v21, s[36:39], s78 offen lds
    v_xor_b32 v71, s85, v71
    v_xor_b32 v72, 0, v71
    v_lshl_add_u32 v4, v72, 4, v70
    v_add_u32 v6, 40960, v4
    v_xor_b32 v72, 2, v71
    v_lshl_add_u32 v5, v72, 4, v70
    v_add_u32 v7, 40960, v5
    v_lshrrev_b32 v70, 1, v67
    s_add_u32 m0, s33, 77824
    s_add_u32 s77, s77, 229376
    buffer_load_dwordx4 v22, s[40:43], s77 offen offset:0 lds
    v_xor_b32 v70, v70, v64
    v_lshlrev_b32 v70, 4, v70
    v_lshl_add_u32 v70, v67, 7, v70
    s_lshl_b32 s85, s5, 13
    v_add_u32 v16, s85, v70
    v_xor_b32 v17, 64, v16
    s_sub_u32 s95, 16384, s85
    s_mov_b32 s80, 135168
    s_lshl_b32 s86, s28, 7
    s_sub_u32 s86, s86, 16
    s_max_i32 s86, s86, 0
    s_lshl_b32 s87, s4, 2
    v_add_u32 v71, s87, v68
    s_add_u32 m0, s33, 81792
    s_nop 0
    buffer_load_dwordx4 v22, s[40:43], s77 offen offset:128 lds
    v_lshrrev_b32 v70, 1, v71
    v_and_b32 v70, 7, v70
    v_xor_b32 v70, v70, v69
    v_lshlrev_b32 v70, 4, v70
    v_add_u32 v71, s86, v71
    v_lshl_add_u32 v3, v71, 11, v70
    s_lshl_b32 s81, s4, 9
    s_lshl_b32 s85, s4, 3
    s_and_b32 s86, s4, 1
    s_lshl_b32 s86, s86, 2
    v_and_b32 v70, 2, v68
    s_add_u32 m0, s33, 86016
    s_nop 0
    buffer_load_dwordx4 v22, s[44:47], s77 offen offset:0 lds
    v_xor_b32 v70, v70, v69
    v_xor_b32 v70, s86, v70
    v_add_u32 v71, s85, v68
    v_mul_u32_u24 v71, 6144, v71
    v_lshl_add_u32 v23, v70, 4, v71
    s_lshl_b32 s85, s4, 12
    v_lshl_add_u32 v10, v1, 4, s85
    s_lshl_b32 s85, s4, 4
    v_and_b32 v70, 2, v68
    v_xor_b32 v70, v70, v69
    s_add_u32 m0, s33, 89984
    s_nop 0
    buffer_load_dwordx4 v22, s[44:47], s77 offen offset:128 lds
    s_add_u32 m0, s33, 94208
    s_nop 0
    buffer_load_dwordx4 v9, s[48:51], s77 offen lds
    v_xor_b32 v70, 0, v70
    v_add_u32 v71, s85, v68
    v_mul_u32_u24 v71, 2048, v71
    v_lshl_add_u32 v11, v70, 4, v71
    s_add_u32 s85, s85, 8
    v_and_b32 v70, 2, v68
    v_xor_b32 v70, v70, v69
    v_xor_b32 v70, 4, v70
    v_add_u32 v71, s85, v68
    s_load_dword s94, s[10:11], s52 offset:0x0
    s_load_dword s94, s[10:11], s52 offset:0x40
    s_load_dword s94, s[10:11], s52 offset:0x80
    s_load_dword s94, s[10:11], s52 offset:0xc0
    s_load_dword s94, s[10:11], s52 offset:0x100
    global_store_dwordx4 v86, v[28:31], s[26:27] offset:1024 sc1
    v_mov_b32 v87, 0
    s_mov_b64 exec, 1
    global_load_dwordx2 v[18:19], v87, s[24:25] sc1
    s_mov_b64 exec, -1
    s_waitcnt vmcnt(18)
    s_barrier
    s_add_u32 m0, s79, 100352
    s_add_u32 s78, s78, 32768
    buffer_load_dwordx4 v20, s[36:39], s78 offen lds
    v_mul_u32_u24 v71, 2048, v71
    v_lshl_add_u32 v12, v70, 4, v71
    s_lshl_b32 s85, s31, 8
    s_lshl_b32 s86, s32, 7
    s_add_u32 s86, s85, s86
    s_xor_b32 s87, s86, 128
    s_lshr_b32 s91, s31, 2
    s_lshl1_add_u32 s91, s91, s32
    s_lshl_b32 s91, s91, 13
    s_add_u32 s91, s91, 0x2000000
    s_xor_b32 s85, s91, 8192
    s_and_b32 s92, s31, 3
    s_cmp_eq_u32 s92, 1
    s_cselect_b32 s86, s91, s86
    s_cselect_b32 s87, s85, s87
    s_cselect_b32 s91, 0x2a00000, 0
    s_cselect_b32 s92, s26, s20
    s_cselect_b32 s93, s27, s21
    s_max_u32 s91, s91, 7340032
    s_add_u32 s60, s92, s86
    s_addc_u32 s61, s93, 0
    s_sub_u32 s62, s91, s86
    s_mov_b32 s63, 0x20000
    s_add_u32 m0, s79, 101376
    s_nop 0
    buffer_load_dwordx4 v21, s[36:39], s78 offen lds
    s_add_u32 s64, s92, s87
    s_addc_u32 s65, s93, 0
    s_sub_u32 s66, s91, s87
    s_mov_b32 s67, 0x20000
    s_add_u32 s56, s26, 0x400000
    s_addc_u32 s57, s27, 0
    s_mov_b32 s58, 0xe00000
    s_mov_b32 s59, 0x20000
    s_mul_i32 s82, s30, 917504
    s_mul_i32 s85, s32, 327680
    s_add_u32 s82, s82, s85
    s_mul_i32 s83, s32, 2621440
    s_mul_i32 s85, s32, 10
    s_sub_u32 s85, 40, s85
    s_lshl_b32 s14, s85, 13
    s_lshl_b32 s35, s85, 16
    s_add_u32 s83, s83, 1441792
    s_add_u32 s82, s82, 196608
    s_lshl_b32 s84, s30, 7
    s_lshl_b32 s85, s5, 6
    s_add_u32 s84, s84, s85
    s_lshl_b32 s84, s84, 11
    s_lshl_b32 s85, s31, 8
    s_add_u32 s84, s84, s85
    s_lshl_b32 s85, s32, 7
    s_add_u32 s84, s84, s85
    s_lshl_b32 s85, s6, 6
    s_add_u32 m0, s33, 16384
    s_add_u32 s77, s77, 229376
    s_cmp_eq_u32 s77, 7340032
    s_cselect_b32 s77, 0, s77
    buffer_load_dwordx4 v22, s[40:43], s77 offen offset:0 lds
    s_add_u32 s84, s84, s85
    v_lshrrev_b32 v70, 2, v1
    v_lshl_add_u32 v71, v66, 4, s84
    v_lshl_add_u32 v13, v70, 11, v71
    v_lshrrev_b32 v72, 4, v1
    v_and_b32 v73, 15, v1
    v_and_b32 v74, 1, v72
    v_xor_b32 v74, s5, v74
    v_lshrrev_b32 v75, 1, v72
    s_add_u32 m0, s33, 20352
    s_nop 0
    buffer_load_dwordx4 v22, s[40:43], s77 offen offset:128 lds
    v_lshl_add_u32 v74, v74, 1, v75
    v_lshlrev_b32 v74, 8, v74
    v_lshl_add_u32 v0, v73, 4, v74
    v_lshrrev_b32 v72, 4, v1
    v_and_b32 v73, 1, v72
    v_lshrrev_b32 v72, 1, v72
    v_lshlrev_b32 v72, 8, v72
    v_lshl_add_u32 v72, v73, 10, v72
    s_add_u32 m0, s33, 24576
    s_nop 0
    buffer_load_dwordx4 v22, s[44:47], s77 offen offset:0 lds
    v_and_b32 v73, 15, v1
    v_lshl_add_u32 v8, v73, 4, v72
    s_mov_b32 s54, 7332992
    s_mov_b32 s55, 0x20000
    s_mul_i32 s84, s6, 3072
    s_add_u32 s84, s84, 153600
    v_lshl_add_u32 v85, v1, 3, s84
    s_mul_i32 s84, s28, 112
    s_lshl1_add_u32 s85, s29, s6
    s_add_u32 s86, s85, 2
    s_and_b32 s86, s86, 31
    s_add_u32 s84, s84, s86
    s_add_u32 s84, s84, 80
    s_lshl_b32 s84, s84, 13
    s_lshl_b32 s86, s5, 12
    s_add_u32 s84, s84, s86
    s_add_u32 s84, s84, 0x400000
    s_lshl_b32 s87, s5, 9
    s_add_u32 s73, s84, s87
    s_xor_b32 s87, s87, 512
    s_add_u32 m0, s33, 28544
    s_nop 0
    buffer_load_dwordx4 v22, s[44:47], s77 offen offset:128 lds
    s_add_u32 m0, s33, 32768
    s_nop 0
    buffer_load_dwordx4 v9, s[48:51], s77 offen lds
    s_add_u32 s74, s84, s87
    s_lshl_b32 s84, s28, 5
    s_add_u32 s84, s84, s85
    s_lshl_b32 s84, s84, 13
    s_add_u32 s84, s84, s86
    s_add_u32 s75, s84, 0x1200000
    v_mov_b32 v84, 0xc0135761
    v_mov_b32 v152, 0
    v_mov_b32 v153, 0
    v_mov_b32 v154, 0
    v_mov_b32 v155, 0
    v_mov_b32 v156, 0
    v_mov_b32 v157, 0
    s_load_dword s94, s[10:11], s52 offset:0x140
    s_load_dword s94, s[10:11], s52 offset:0x180
    s_load_dword s94, s[10:11], s52 offset:0x1c0
    s_load_dword s94, s[16:17], s53 offset:0x0
    s_load_dword s94, s[16:17], s53 offset:0x40
    global_store_dwordx4 v86, v[32:35], s[26:27] offset:2048 sc1
    s_waitcnt vmcnt(19)
    s_barrier
    s_add_u32 m0, s79, 116736
    s_add_u32 s72, s72, 128
    s_and_b32 s78, s72, 0x7ff
    buffer_load_dwordx4 v20, s[36:39], s78 offen lds
    v_mov_b32 v158, 0
    v_mov_b32 v159, 0
    v_mov_b32 v160, 0
    v_mov_b32 v161, 0
    v_mov_b32 v162, 0
    v_mov_b32 v163, 0
    v_mov_b32 v164, 0
    v_mov_b32 v165, 0
    s_add_u32 m0, s79, 117760
    s_nop 0
    buffer_load_dwordx4 v21, s[36:39], s78 offen lds
    v_mov_b32 v166, 0
    v_mov_b32 v167, 0
    v_mov_b32 v168, 0
    v_mov_b32 v169, 0
    v_mov_b32 v170, 0
    v_mov_b32 v171, 0
    v_mov_b32 v172, 0
    v_mov_b32 v173, 0
    s_add_u32 m0, s33, 36864
    s_add_u32 s77, s77, 229376
    buffer_load_dwordx4 v22, s[40:43], s77 offen offset:0 lds
    v_mov_b32 v174, 0
    v_mov_b32 v175, 0
    v_mov_b32 v176, 0
    v_mov_b32 v177, 0
    v_mov_b32 v178, 0
    v_mov_b32 v179, 0
    v_mov_b32 v180, 0
    v_mov_b32 v181, 0
    s_add_u32 m0, s33, 40832
    s_nop 0
    buffer_load_dwordx4 v22, s[40:43], s77 offen offset:128 lds
    v_mov_b32 v182, 0
    v_mov_b32 v183, 0
    v_mov_b32 v184, 0
    v_mov_b32 v185, 0
    v_mov_b32 v186, 0
    v_mov_b32 v187, 0
    v_mov_b32 v188, 0
    v_mov_b32 v189, 0
    s_add_u32 m0, s33, 45056
    s_nop 0
    buffer_load_dwordx4 v22, s[44:47], s77 offen offset:0 lds
    v_mov_b32 v190, 0
    v_mov_b32 v191, 0
    v_mov_b32 v192, 0
    v_mov_b32 v193, 0
    v_mov_b32 v194, 0
    v_mov_b32 v195, 0
    v_mov_b32 v196, 0
    v_mov_b32 v197, 0
    s_add_u32 m0, s33, 49024
    s_nop 0
    buffer_load_dwordx4 v22, s[44:47], s77 offen offset:128 lds
    s_add_u32 m0, s33, 53248
    s_nop 0
    buffer_load_dwordx4 v9, s[48:51], s77 offen lds
    v_mov_b32 v198, 0
    v_mov_b32 v199, 0
    v_mov_b32 v200, 0
    v_mov_b32 v201, 0
    v_mov_b32 v202, 0
    v_mov_b32 v203, 0
    v_mov_b32 v204, 0
    v_mov_b32 v205, 0
    s_load_dword s94, s[16:17], s53 offset:0x80
    s_load_dword s94, s[16:17], s53 offset:0xc0
    s_load_dword s94, s[16:17], s53 offset:0x100
    s_load_dword s94, s[16:17], s53 offset:0x140
    s_load_dword s94, s[16:17], s53 offset:0x180
    global_store_dwordx4 v86, v[36:39], s[26:27] offset:3072 sc1
    s_waitcnt vmcnt(18)
    s_barrier
    s_add_u32 m0, s79, 118784
    s_add_u32 s78, s78, 32768
    buffer_load_dwordx4 v20, s[36:39], s78 offen lds
    v_mov_b32 v206, 0
    v_mov_b32 v207, 0
    v_mov_b32 v208, 0
    v_mov_b32 v209, 0
    v_mov_b32 v210, 0
    v_mov_b32 v211, 0
    v_mov_b32 v212, 0
    v_mov_b32 v213, 0
    s_add_u32 m0, s79, 119808
    s_nop 0
    buffer_load_dwordx4 v21, s[36:39], s78 offen lds
    v_mov_b32 v214, 0
    v_mov_b32 v215, 0
    v_mov_b32 v216, 0
    v_mov_b32 v217, 0
    v_mov_b32 v218, 0
    v_mov_b32 v219, 0
    v_mov_b32 v220, 0
    v_mov_b32 v221, 0
    s_add_u32 m0, s33, 57344
    s_add_u32 s77, s77, 229376
    s_cmp_eq_u32 s77, 7340032
    s_cselect_b32 s77, 0, s77
    buffer_load_dwordx4 v22, s[40:43], s77 offen offset:0 lds
    v_mov_b32 v222, 0
    v_mov_b32 v223, 0
    v_mov_b32 v224, 0
    v_mov_b32 v225, 0
    v_mov_b32 v226, 0
    v_mov_b32 v227, 0
    v_mov_b32 v228, 0
    v_mov_b32 v229, 0
    s_add_u32 m0, s33, 61312
    s_nop 0
    buffer_load_dwordx4 v22, s[40:43], s77 offen offset:128 lds
    v_mov_b32 v230, 0
    v_mov_b32 v231, 0
    v_mov_b32 v232, 0
    v_mov_b32 v233, 0
    v_mov_b32 v234, 0
    v_mov_b32 v235, 0
    v_mov_b32 v236, 0
    v_mov_b32 v237, 0
    s_add_u32 m0, s33, 65536
    s_nop 0
    buffer_load_dwordx4 v22, s[44:47], s77 offen offset:0 lds
    v_mov_b32 v238, 0
    v_mov_b32 v239, 0
    v_mov_b32 v240, 0
    v_mov_b32 v241, 0
    v_mov_b32 v242, 0
    v_mov_b32 v243, 0
    v_mov_b32 v244, 0
    v_mov_b32 v245, 0
    s_add_u32 m0, s33, 69504
    s_nop 0
    buffer_load_dwordx4 v22, s[44:47], s77 offen offset:128 lds
    s_add_u32 m0, s33, 73728
    s_nop 0
    buffer_load_dwordx4 v9, s[48:51], s77 offen lds
    v_mov_b32 v246, 0
    v_mov_b32 v247, 0
    v_mov_b32 v248, 0
    v_mov_b32 v249, 0
    v_mov_b32 v250, 0
    v_mov_b32 v251, 0
    v_mov_b32 v252, 0
    v_mov_b32 v253, 0
    s_load_dword s94, s[16:17], s53 offset:0x1c0
    s_load_dword s94, s[18:19], s53 offset:0x0
    s_load_dword s94, s[18:19], s53 offset:0x40
    s_load_dword s94, s[18:19], s53 offset:0x80
    s_load_dword s94, s[18:19], s53 offset:0xc0
    s_waitcnt vmcnt(16)
    s_barrier
    s_add_u32 m0, s79, 135168
    s_add_u32 s72, s72, 128
    s_and_b32 s78, s72, 0x7ff
    buffer_load_dwordx4 v20, s[36:39], s78 offen lds
    v_mov_b32 v254, 0
    v_mov_b32 v255, 0
    v_mov_b32 v112, 0
    v_mov_b32 v113, 0
    v_mov_b32 v114, 0
    v_mov_b32 v115, 0
    v_mov_b32 v116, 0
    v_mov_b32 v117, 0
    v_mov_b32 v118, 0
    v_mov_b32 v119, 0
    s_add_u32 m0, s79, 136192
    s_nop 0
    buffer_load_dwordx4 v21, s[36:39], s78 offen lds
    v_mov_b32 v120, 0
    v_mov_b32 v121, 0
    v_mov_b32 v122, 0
    v_mov_b32 v123, 0
    v_mov_b32 v124, 0
    v_mov_b32 v125, 0
    v_mov_b32 v126, 0
    v_mov_b32 v127, 0
    s_add_u32 m0, s33, 77824
    s_add_u32 s77, s77, 229376
    buffer_load_dwordx4 v22, s[40:43], s77 offen offset:0 lds
    v_mov_b32 v128, 0
    v_mov_b32 v129, 0
    v_mov_b32 v130, 0
    v_mov_b32 v131, 0
    v_mov_b32 v132, 0
    v_mov_b32 v133, 0
    v_mov_b32 v134, 0
    v_mov_b32 v135, 0
    s_add_u32 m0, s33, 81792
    s_nop 0
    buffer_load_dwordx4 v22, s[40:43], s77 offen offset:128 lds
    v_mov_b32 v136, 0
    v_mov_b32 v137, 0
    v_mov_b32 v138, 0
    v_mov_b32 v139, 0
    v_mov_b32 v140, 0
    v_mov_b32 v141, 0
    v_mov_b32 v142, 0
    v_mov_b32 v143, 0
    s_add_u32 m0, s33, 86016
    s_nop 0
    buffer_load_dwordx4 v22, s[44:47], s77 offen offset:0 lds
    s_add_u32 m0, s33, 89984
    s_nop 0
    buffer_load_dwordx4 v22, s[44:47], s77 offen offset:128 lds
L_pad7:
    s_cbranch_execz L_vret0
    v_mov_b32 v144, 0
    v_mov_b32 v145, 0
    v_mov_b32 v146, 0
    v_mov_b32 v147, 0
    v_mov_b32 v148, 0
    v_mov_b32 v149, 0
    v_mov_b32 v150, 0
    v_mov_b32 v151, 0
    s_add_u32 m0, s33, 94208
    s_nop 0
    buffer_load_dwordx4 v9, s[48:51], s77 offen lds
    s_load_dword s94, s[18:19], s53 offset:0x100
    s_load_dword s94, s[18:19], s53 offset:0x140
    s_load_dword s94, s[18:19], s53 offset:0x180
    s_load_dword s94, s[18:19], s53 offset:0x1c0
    s_load_dword s94, s[10:11], s52 offset:0x80000
    s_waitcnt vmcnt(30)
    s_movk_i32 s98, 0x4000
L_tokB_chk:
    v_readfirstlane_b32 s100, v18
    v_readfirstlane_b32 s101, v19
    s_nop 1
    s_cmp_lg_u32 s100, 0
    s_cbranch_scc1 L_tokB_ok
    s_sub_u32 s98, s98, 1
    s_cbranch_scc1 L_tokB_ok
    s_sleep 1
    global_load_dwordx2 v[18:19], v87, s[24:25] sc1
    s_waitcnt vmcnt(0)
    s_branch L_tokB_chk
L_tokB_ok:
    s_waitcnt vmcnt(14)
    s_waitcnt vmcnt(15)
    s_barrier
    s_add_u32 m0, s79, 137216
    s_add_u32 s78, s78, 32768
    buffer_load_dwordx4 v20, s[36:39], s78 offen lds
    s_add_u32 m0, s79, 138240
    s_nop 0
    buffer_load_dwordx4 v21, s[36:39], s78 offen lds
    s_add_u32 m0, s33, 16384
    s_add_u32 s77, s77, 229376
    s_cmp_eq_u32 s77, 7340032
    s_cselect_b32 s77, 0, s77
    buffer_load_dwordx4 v22, s[40:43], s77 offen offset:0 lds
    s_add_u32 m0, s33, 20352
    s_nop 0
    buffer_load_dwordx4 v22, s[40:43], s77 offen offset:128 lds
    s_add_u32 m0, s33, 24576
    s_nop 0
    buffer_load_dwordx4 v22, s[44:47], s77 offen offset:0 lds
    s_add_u32 m0, s33, 28544
    s_nop 0
    buffer_load_dwordx4 v22, s[44:47], s77 offen offset:128 lds
    s_add_u32 m0, s33, 32768
    s_nop 0
    buffer_load_dwordx4 v9, s[48:51], s77 offen lds
    s_load_dword s94, s[10:11], s52 offset:0x80040
    s_load_dword s94, s[10:11], s52 offset:0x80080
    s_load_dword s94, s[10:11], s52 offset:0x800c0
    s_load_dword s94, s[10:11], s52 offset:0x80100
    s_load_dword s94, s[10:11], s52 offset:0x80140
    s_cmp_lg_u32 s4, 0
    s_cbranch_scc1 L_fLN
    s_lshl_b32 s91, s28, 4
    s_add_u32 s91, s91, s29
    s_lshl_b32 s91, s91, 7
    s_add_u32 s91, s91, 0x1e80000
    v_mov_b32 v24, s91
    v_mov_b32 v26, s100
    v_mov_b32 v27, s101
    s_mov_b64 exec, 1
    global_store_dwordx2 v24, v[26:27], s[26:27] sc1
    s_mov_b64 exec, -1
L_fLN:
    s_waitcnt vmcnt(14)
    s_barrier
    s_add_u32 m0, s79, 98304
    s_add_u32 s72, s72, 128
    s_and_b32 s78, s72, 0x7ff
    buffer_load_dwordx4 v20, s[36:39], s78 offen lds
    s_add_u32 m0, s79, 99328
    s_nop 0
    buffer_load_dwordx4 v21, s[36:39], s78 offen lds
    s_add_u32 m0, s33, 36864
    s_add_u32 s77, s77, 229376
    buffer_load_dwordx4 v22, s[40:43], s77 offen offset:0 lds
    s_add_u32 m0, s33, 40832
    s_nop 0
    buffer_load_dwordx4 v22, s[40:43], s77 offen offset:128 lds
    s_add_u32 m0, s33, 45056
    s_nop 0
    buffer_load_dwordx4 v22, s[44:47], s77 offen offset:0 lds
    s_add_u32 m0, s33, 49024
    s_nop 0
    buffer_load_dwordx4 v22, s[44:47], s77 offen offset:128 lds
    s_add_u32 m0, s33, 53248
    s_nop 0
    buffer_load_dwordx4 v9, s[48:51], s77 offen lds
    s_load_dword s94, s[10:11], s52 offset:0x80180
    s_load_dword s94, s[10:11], s52 offset:0x801c0
    s_add_u32 s52, s52, 0x100000
    s_load_dword s94, s[10:11], s52 offset:0x0
    s_load_dword s94, s[10:11], s52 offset:0x40
    s_load_dword s94, s[10:11], s52 offset:0x80
    global_load_dwordx4 v[24:27], v11, s[88:89]
    s_waitcnt vmcnt(15)
    s_barrier
    s_add_u32 m0, s79, 100352
    s_add_u32 s78, s78, 32768
    buffer_load_dwordx4 v20, s[36:39], s78 offen lds
    s_add_u32 m0, s79, 101376
    s_nop 0
    buffer_load_dwordx4 v21, s[36:39], s78 offen lds
    s_add_u32 m0, s33, 57344
    s_add_u32 s77, s77, 229376
    s_cmp_eq_u32 s77, 7340032
    s_cselect_b32 s77, 0, s77
    buffer_load_dwordx4 v22, s[40:43], s77 offen offset:0 lds
    s_add_u32 m0, s33, 61312
    s_nop 0
    buffer_load_dwordx4 v22, s[40:43], s77 offen offset:128 lds
    s_add_u32 m0, s33, 65536
    s_nop 0
    buffer_load_dwordx4 v22, s[44:47], s77 offen offset:0 lds
    s_add_u32 m0, s33, 69504
    s_nop 0
    buffer_load_dwordx4 v22, s[44:47], s77 offen offset:128 lds
    s_add_u32 m0, s33, 73728
    s_nop 0
    buffer_load_dwordx4 v9, s[48:51], s77 offen lds
    s_load_dword s94, s[10:11], s52 offset:0xc0
    s_load_dword s94, s[10:11], s52 offset:0x100
    s_load_dword s94, s[10:11], s52 offset:0x140
    s_load_dword s94, s[10:11], s52 offset:0x180
    s_load_dword s94, s[10:11], s52 offset:0x1c0
    global_load_dwordx4 v[28:31], v12, s[88:89]
    s_waitcnt vmcnt(16)
    s_barrier
    s_add_u32 m0, s79, 116736
    s_add_u32 s72, s72, 128
    s_and_b32 s78, s72, 0x7ff
    buffer_load_dwordx4 v20, s[36:39], s78 offen lds
    s_add_u32 m0, s79, 117760
    s_nop 0
    buffer_load_dwordx4 v21, s[36:39], s78 offen lds
    s_add_u32 m0, s33, 77824
    s_add_u32 s77, s77, 229376
    buffer_load_dwordx4 v22, s[40:43], s77 offen offset:0 lds
    s_add_u32 m0, s33, 81792
    s_nop 0
    buffer_load_dwordx4 v22, s[40:43], s77 offen offset:128 lds
    s_add_u32 m0, s33, 86016
    s_nop 0
    buffer_load_dwordx4 v22, s[44:47], s77 offen offset:0 lds
    s_add_u32 m0, s33, 89984
    s_nop 0
    buffer_load_dwordx4 v22, s[44:47], s77 offen offset:128 lds
    s_add_u32 m0, s33, 94208
    s_nop 0
    buffer_load_dwordx4 v9, s[48:51], s77 offen lds
    s_load_dword s94, s[10:11], s52 offset:0x80000
    s_load_dword s94, s[10:11], s52 offset:0x80040
    s_load_dword s94, s[10:11], s52 offset:0x80080
    s_load_dword s94, s[10:11], s52 offset:0x800c0
    s_load_dword s94, s[10:11], s52 offset:0x80100
    s_lshl1_add_u32 s91, s33, s34
    s_add_u32 s91, s91, 0x2000000
    v_lshl_add_u32 v32, v1, 4, s91
    s_and_b32 s85, s31, 3
    s_cmp_eq_u32 s85, 1
    s_cselect_b64 vcc, -1, 0
    s_lshl_b32 s85, s4, 11
    v_lshl_add_u32 v70, v1, 4, s85
    v_add_u32 v71, 1024, v70
    v_cndmask_b32 v11, v11, v70, vcc
    v_cndmask_b32 v12, v12, v71, vcc
    s_waitcnt vmcnt(15)
    global_store_dwordx4 v32, v[24:27], s[26:27] offset:0 sc1
    s_waitcnt vmcnt(17)
    s_barrier
    s_add_u32 m0, s79, 118784
    s_add_u32 s78, s78, 32768
    buffer_load_dwordx4 v20, s[36:39], s78 offen lds
    s_add_u32 m0, s79, 119808
    s_nop 0
    buffer_load_dwordx4 v21, s[36:39], s78 offen lds
    s_add_u32 m0, s33, 16384
    s_add_u32 s77, s77, 229376
    s_cmp_eq_u32 s77, 7340032
    s_cselect_b32 s77, 0, s77
    buffer_load_dwordx4 v22, s[40:43], s77 offen offset:0 lds
    s_add_u32 m0, s33, 20352
    s_nop 0
    buffer_load_dwordx4 v22, s[40:43], s77 offen offset:128 lds
    s_add_u32 m0, s33, 24576
    s_nop 0
    buffer_load_dwordx4 v22, s[44:47], s77 offen offset:0 lds
    s_add_u32 m0, s33, 28544
    s_nop 0
    buffer_load_dwordx4 v22, s[44:47], s77 offen offset:128 lds
    s_add_u32 m0, s33, 32768
    s_nop 0
    buffer_load_dwordx4 v9, s[48:51], s77 offen lds
    s_load_dword s94, s[10:11], s52 offset:0x80140
    s_load_dword s94, s[10:11], s52 offset:0x80180
    s_load_dword s94, s[10:11], s52 offset:0x801c0
    s_add_u32 s53, s53, 0x1c0000
    s_load_dword s94, s[16:17], s53 offset:0x0
    s_load_dword s94, s[16:17], s53 offset:0x40
    s_waitcnt vmcnt(15)
    global_store_dwordx4 v32, v[28:31], s[26:27] offset:1024 sc1
    s_waitcnt vmcnt(17)
    s_barrier
    s_add_u32 m0, s79, 135168
    s_add_u32 s72, s72, 128
    s_and_b32 s78, s72, 0x7ff
    buffer_load_dwordx4 v20, s[36:39], s78 offen lds
    s_add_u32 m0, s79, 136192
    s_nop 0
    buffer_load_dwordx4 v21, s[36:39], s78 offen lds
    s_add_u32 m0, s33, 36864
    s_add_u32 s77, s77, 229376
    buffer_load_dwordx4 v22, s[40:43], s77 offen offset:0 lds
    s_add_u32 m0, s33, 40832
    s_nop 0
    buffer_load_dwordx4 v22, s[40:43], s77 offen offset:128 lds
    s_add_u32 m0, s33, 45056
    s_nop 0
    buffer_load_dwordx4 v22, s[44:47], s77 offen offset:0 lds
    s_add_u32 m0, s33, 49024
    s_nop 0
    buffer_load_dwordx4 v22, s[44:47], s77 offen offset:128 lds
    s_add_u32 m0, s33, 53248
    s_nop 0
    buffer_load_dwordx4 v9, s[48:51], s77 offen lds
    s_load_dword s94, s[16:17], s53 offset:0x80
    s_load_dword s94, s[16:17], s53 offset:0xc0
    s_load_dword s94, s[16:17], s53 offset:0x100
    s_load_dword s94, s[16:17], s53 offset:0x140
    s_load_dword s94, s[16:17], s53 offset:0x180
    s_waitcnt vmcnt(16)
    s_barrier
    s_add_u32 m0, s79, 137216
    s_add_u32 s78, s78, 32768
    buffer_load_dwordx4 v20, s[36:39], s78 offen lds
    s_add_u32 m0, s79, 138240
    s_nop 0
    buffer_load_dwordx4 v21, s[36:39], s78 offen lds
    s_add_u32 m0, s33, 57344
    s_add_u32 s77, s77, 229376
    s_cmp_eq_u32 s77, 7340032
    s_cselect_b32 s77, 0, s77
    buffer_load_dwordx4 v22, s[40:43], s77 offen offset:0 lds
    s_add_u32 m0, s33, 61312
    s_nop 0
    buffer_load_dwordx4 v22, s[40:43], s77 offen offset:128 lds
    s_add_u32 m0, s33, 65536
    s_nop 0
    buffer_load_dwordx4 v22, s[44:47], s77 offen offset:0 lds
    s_add_u32 m0, s33, 69504
    s_nop 0
    buffer_load_dwordx4 v22, s[44:47], s77 offen offset:128 lds
    s_add_u32 m0, s33, 73728
    s_nop 0
    buffer_load_dwordx4 v9, s[48:51], s77 offen lds
    s_load_dword s94, s[16:17], s53 offset:0x1c0
    s_load_dword s94, s[18:19], s53 offset:0x0
    s_load_dword s94, s[18:19], s53 offset:0x40
    s_load_dword s94, s[18:19], s53 offset:0x80
    s_load_dword s94, s[18:19], s53 offset:0xc0
    s_sub_u32 s91, s28, s6
    s_max_i32 s91, s91, 0
    s_lshl_b32 s91, s91, 4
    s_cmp_lg_u32 s5, 0
    s_cselect_b32 s91, s29, s91
    s_cselect_b32 s92, 11, 7
    s_lshl_b32 s91, s91, 7
    s_add_u32 s91, s91, 0x1e80000
    v_lshlrev_b32 v87, s92, v1
    v_add_u32 v87, s91, v87
    s_mov_b64 exec, 0xffff
    global_load_dwordx2 v[18:19], v87, s[26:27] sc1
    s_mov_b64 exec, -1
    s_waitcnt vmcnt(16)
    s_barrier
    s_add_u32 m0, s79, 98304
    s_add_u32 s72, s72, 128
    s_and_b32 s78, s72, 0x7ff
    buffer_load_dwordx4 v20, s[36:39], s78 offen lds
    s_add_u32 m0, s79, 99328
    s_nop 0
    buffer_load_dwordx4 v21, s[36:39], s78 offen lds
    s_add_u32 m0, s33, 77824
    s_add_u32 s77, s77, 229376
    buffer_load_dwordx4 v22, s[40:43], s77 offen offset:0 lds
    s_add_u32 m0, s33, 81792
    s_nop 0
    buffer_load_dwordx4 v22, s[40:43], s77 offen offset:128 lds
    s_add_u32 m0, s33, 86016
    s_nop 0
    buffer_load_dwordx4 v22, s[44:47], s77 offen offset:0 lds
    s_add_u32 m0, s33, 89984
    s_nop 0
    buffer_load_dwordx4 v22, s[44:47], s77 offen offset:128 lds
    s_add_u32 m0, s33, 94208
    s_nop 0
    buffer_load_dwordx4 v9, s[48:51], s77 offen lds
    s_load_dword s94, s[18:19], s53 offset:0x100
    s_load_dword s94, s[18:19], s53 offset:0x140
    s_load_dword s94, s[18:19], s53 offset:0x180
    s_load_dword s94, s[18:19], s53 offset:0x1c0
    s_add_u32 s52, s52, 0x100000
    s_load_dword s94, s[10:11], s52 offset:0x0
    s_waitcnt vmcnt(7)
    s_mov_b64 exec, 0xffff
    s_movk_i32 s98, 0x4000
L_pLN_chk:
    v_cmp_ne_u64 vcc, s[100:101], v[18:19]
    s_nop 1
    s_cmp_eq_u64 vcc, 0
    s_cbranch_scc1 L_pLN_ok
    s_sub_u32 s98, s98, 1
    s_cbranch_scc1 L_pLN_ok
    s_sleep 1
    global_load_dwordx2 v[18:19], v87, s[26:27] sc1
    s_waitcnt vmcnt(0)
    s_branch L_pLN_chk
L_pLN_ok:
    s_mov_b64 exec, -1
    s_waitcnt vmcnt(15)
    s_barrier
    s_mul_i32 s91, s29, 20480
    s_mul_i32 s92, s4, 320
    s_add_u32 s91, s91, s92
    s_add_u32 s91, s91, 0x1e10000
    v_lshrrev_b32 v24, 2, v1
    v_mul_u32_u24 v24, 1280, v24
    v_and_b32 v25, 3, v1
    v_lshlrev_b32 v25, 4, v25
    v_add3_u32 v24, v24, v25, s91
    global_load_dwordx4 v[88:91], v24, s[26:27] offset:0
    global_load_dwordx4 v[92:95], v24, s[26:27] offset:64
    global_load_dwordx4 v[96:99], v24, s[26:27] offset:128
    global_load_dwordx4 v[100:103], v24, s[26:27] offset:192
    global_load_dwordx4 v[104:107], v24, s[26:27] offset:256
    s_add_u32 s92, s92, 159744
    v_lshrrev_b32 v37, 4, v1
    v_add_u32 v25, s92, v25
    v_lshl_add_u32 v36, v37, 2, v25
    v_lshl_add_u32 v25, v37, 6, v25
    s_lshl_b32 s91, s28, 2
    s_add_u32 s91, s91, s4
    s_lshl_b32 s91, s91, 8
    s_add_u32 s91, s91, 0x1e00000
    v_and_b32 v27, 31, v1
    v_lshl_add_u32 v26, v27, 3, s91
    global_load_dwordx2 v[28:29], v26, s[26:27]
    s_lshl_b32 s91, s4, 9
    s_add_u32 s91, s91, 161024
    v_lshl_add_u32 v27, v27, 4, s91
    s_add_u32 m0, s79, 100352
    s_add_u32 s78, s78, 32768
    buffer_load_dwordx4 v20, s[36:39], s78 offen lds
    s_add_u32 m0, s79, 101376
    s_nop 0
    buffer_load_dwordx4 v21, s[36:39], s78 offen lds
    s_add_u32 m0, s33, 16384
    s_add_u32 s77, s77, 229376
    s_cmp_eq_u32 s77, 7340032
    s_cselect_b32 s77, 0, s77
    buffer_load_dwordx4 v22, s[40:43], s77 offen offset:0 lds
    s_add_u32 m0, s33, 20352
    s_nop 0
    buffer_load_dwordx4 v22, s[40:43], s77 offen offset:128 lds
    s_add_u32 m0, s33, 24576
    s_nop 0
    buffer_load_dwordx4 v22, s[44:47], s77 offen offset:0 lds
    s_add_u32 m0, s33, 28544
    s_nop 0
    buffer_load_dwordx4 v22, s[44:47], s77 offen offset:128 lds
    s_add_u32 m0, s33, 32768
    s_nop 0
    buffer_load_dwordx4 v9, s[48:51], s77 offen lds
    s_load_dword s94, s[10:11], s52 offset:0x40
    s_load_dword s94, s[10:11], s52 offset:0x80
    s_load_dword s94, s[10:11], s52 offset:0xc0
    s_load_dword s94, s[10:11], s52 offset:0x100
    s_load_dword s94, s[10:11], s52 offset:0x140
    s_waitcnt vmcnt(35)
    s_waitcnt vmcnt(21)
    s_barrier
    s_add_u32 m0, s79, 116736
    s_add_u32 s72, s72, 128
    s_and_b32 s78, s72, 0x7ff
    buffer_load_dwordx4 v20, s[36:39], s78 offen lds
    s_add_u32 m0, s79, 117760
    s_nop 0
    buffer_load_dwordx4 v21, s[36:39], s78 offen lds
    s_add_u32 m0, s33, 36864
    s_add_u32 s77, s77, 229376
    buffer_load_dwordx4 v22, s[40:43], s77 offen offset:0 lds
    s_add_u32 m0, s33, 40832
    s_nop 0
    buffer_load_dwordx4 v22, s[40:43], s77 offen offset:128 lds
    s_add_u32 m0, s33, 45056
    s_nop 0
    buffer_load_dwordx4 v22, s[44:47], s77 offen offset:0 lds
    s_add_u32 m0, s33, 49024
    s_nop 0
    buffer_load_dwordx4 v22, s[44:47], s77 offen offset:128 lds
    s_add_u32 m0, s33, 53248
    s_nop 0
    buffer_load_dwordx4 v9, s[48:51], s77 offen lds
    s_load_dword s94, s[10:11], s52 offset:0x180
    s_load_dword s94, s[10:11], s52 offset:0x1c0
    s_load_dword s94, s[10:11], s52 offset:0x80000
    s_load_dword s94, s[10:11], s52 offset:0x80040
    s_load_dword s94, s[10:11], s52 offset:0x80080
    s_cmp_lg_u32 s4, 0
    s_cbranch_scc1 L_fC
    s_lshl_b32 s91, s28, 4
    s_add_u32 s91, s91, s29
    s_lshl_b32 s91, s91, 7
    s_add_u32 s91, s91, 0x1eb0000
    v_mov_b32 v32, s91
    v_mov_b32 v34, s100
    v_mov_b32 v35, s101
    s_mov_b64 exec, 1
    global_store_dwordx2 v32, v[34:35], s[26:27] sc1
    s_mov_b64 exec, -1
L_fC:
    s_waitcnt vmcnt(20)
    s_barrier
    s_add_u32 m0, s79, 118784
    s_add_u32 s78, s78, 32768
    buffer_load_dwordx4 v20, s[36:39], s78 offen lds
    s_waitcnt vmcnt(15)
    v_rcp_f32 v30, v29
    v_mul_f32 v32, -1.0, v28
    v_mul_f32 v35, v29, v29
    v_fma_f32 v31, -v29, v30, 1.0
    v_fma_f32 v30, v31, v30, v30
    v_mul_f32 v33, 0xc0135761, v30
    v_mul_f32 v31, v30, v30
    s_add_u32 m0, s79, 119808
    s_nop 0
    buffer_load_dwordx4 v21, s[36:39], s78 offen lds
    v_mul_f32 v31, v31, v30
    v_mul_f32 v34, 0xbdd2d3e8, v31
    ds_write_b128 v27, v[32:35]
    v_permlane16_swap_b32 v88, v92
    v_permlane16_swap_b32 v96, v100
    v_permlane16_swap_b32 v89, v93
    v_permlane16_swap_b32 v97, v101
    v_permlane16_swap_b32 v90, v94
    v_permlane16_swap_b32 v98, v102
    s_add_u32 m0, s33, 57344
    s_add_u32 s77, s77, 229376
    s_cmp_eq_u32 s77, 7340032
    s_cselect_b32 s77, 0, s77
    buffer_load_dwordx4 v22, s[40:43], s77 offen offset:0 lds
    v_permlane16_swap_b32 v91, v95
    v_permlane16_swap_b32 v99, v103
    v_permlane16_swap_b32 v104, v105
    v_permlane16_swap_b32 v106, v107
    v_add_f32 v88, v88, v92
    v_add_f32 v96, v96, v100
    v_add_f32 v89, v89, v93
    v_add_f32 v97, v97, v101
    s_add_u32 m0, s33, 61312
    s_nop 0
    buffer_load_dwordx4 v22, s[40:43], s77 offen offset:128 lds
    v_add_f32 v90, v90, v94
    v_add_f32 v98, v98, v102
    v_add_f32 v91, v91, v95
    v_add_f32 v99, v99, v103
    v_add_f32 v104, v104, v105
    v_add_f32 v106, v106, v107
    s_nop 0
    v_permlane32_swap_b32 v88, v96
    v_permlane32_swap_b32 v89, v97
    s_add_u32 m0, s33, 65536
    s_nop 0
    buffer_load_dwordx4 v22, s[44:47], s77 offen offset:0 lds
    v_permlane32_swap_b32 v90, v98
    v_permlane32_swap_b32 v91, v99
    v_permlane32_swap_b32 v104, v106
    v_add_f32 v88, v88, v96
    v_add_f32 v89, v89, v97
    v_add_f32 v90, v90, v98
    v_add_f32 v91, v91, v99
    v_add_f32 v104, v104, v106
    s_add_u32 m0, s33, 69504
    s_nop 0
    buffer_load_dwordx4 v22, s[44:47], s77 offen offset:128 lds
    s_add_u32 m0, s33, 73728
    s_nop 0
    buffer_load_dwordx4 v9, s[48:51], s77 offen lds
    v_add_f32_dpp v88, v88, v88 row_ror:8 row_mask:0xf bank_mask:0xf
    v_add_f32_dpp v89, v89, v89 row_ror:8 row_mask:0xf bank_mask:0xf
    v_add_f32_dpp v90, v90, v90 row_ror:8 row_mask:0xf bank_mask:0xf
    v_add_f32_dpp v91, v91, v91 row_ror:8 row_mask:0xf bank_mask:0xf
    v_add_f32_dpp v104, v104, v104 row_ror:8 row_mask:0xf bank_mask:0xf
    v_add_f32_dpp v88, v88, v88 row_ror:4 row_mask:0xf bank_mask:0xf
    v_add_f32_dpp v89, v89, v89 row_ror:4 row_mask:0xf bank_mask:0xf
    v_add_f32_dpp v90, v90, v90 row_ror:4 row_mask:0xf bank_mask:0xf
    s_load_dword s94, s[10:11], s52 offset:0x800c0
    s_load_dword s94, s[10:11], s52 offset:0x80100
    s_load_dword s94, s[10:11], s52 offset:0x80140
    s_load_dword s94, s[10:11], s52 offset:0x80180
    s_load_dword s94, s[10:11], s52 offset:0x801c0
    s_waitcnt vmcnt(14)
    s_barrier
    s_mov_b32 s36, s26
    s_mov_b32 s37, s27
    s_mov_b32 s38, 0x400000
    s_mov_b32 s39, 0x20000
    s_add_u32 m0, s33, 77824
    s_add_u32 s77, s77, 229376
    buffer_load_dwordx4 v22, s[40:43], s77 offen offset:0 lds
    v_add_f32_dpp v91, v91, v91 row_ror:4 row_mask:0xf bank_mask:0xf
    v_add_f32_dpp v104, v104, v104 row_ror:4 row_mask:0xf bank_mask:0xf
    s_mov_b32 s92, 0x000f000f
    s_mov_b32 s93, s92
    s_mov_b64 exec, s[92:93]
    ds_write_b128 v25, v[88:91]
    ds_write_b32 v36, v104 offset:256
    s_mov_b64 exec, -1
    v_mov_b32 v88, 0
    v_mov_b32 v89, 0
    v_mov_b32 v90, 0
    v_mov_b32 v91, 0
    v_mov_b32 v92, 0
    v_mov_b32 v93, 0
    v_mov_b32 v94, 0
    v_mov_b32 v95, 0
    s_add_u32 m0, s33, 81792
    s_nop 0
    buffer_load_dwordx4 v22, s[40:43], s77 offen offset:128 lds
    s_add_u32 m0, s33, 86016
    s_nop 0
    buffer_load_dwordx4 v22, s[44:47], s77 offen offset:0 lds
    v_mov_b32 v96, 0
    v_mov_b32 v97, 0
    v_mov_b32 v98, 0
    v_mov_b32 v99, 0
    v_mov_b32 v100, 0
    v_mov_b32 v101, 0
    v_mov_b32 v102, 0
    v_mov_b32 v103, 0
    s_add_u32 m0, s33, 89984
    s_nop 0
    buffer_load_dwordx4 v22, s[44:47], s77 offen offset:128 lds
    v_mov_b32 v104, 0
    v_mov_b32 v105, 0
    v_mov_b32 v106, 0
    v_mov_b32 v107, 0
    v_mov_b32 v108, 0
    v_mov_b32 v109, 0
    v_mov_b32 v110, 0
    v_mov_b32 v111, 0
    s_add_u32 m0, s33, 94208
    s_nop 0
    buffer_load_dwordx4 v9, s[48:51], s77 offen lds
    s_add_u32 m0, s79, 135168
    s_mov_b32 s78, 0
    buffer_load_dwordx4 v20, s[36:39], s78 offen sc1 lds
    s_add_u32 m0, s79, 136192
    s_nop 0
    buffer_load_dwordx4 v21, s[36:39], s78 offen sc1 lds
    s_waitcnt vmcnt(14)
    s_barrier
    s_lshl_b32 s85, s29, 7
    s_add_u32 s86, s85, 4096
    s_add_u32 s87, s85, 128
    s_and_b32 s87, s87, 0x7ff
    s_add_u32 s87, s87, 5120
    s_add_u32 s40, s10, s85
    s_addc_u32 s41, s11, 0
    s_add_u32 s44, s10, s86
    s_addc_u32 s45, s11, 0
    s_add_u32 s48, s16, s87
    s_addc_u32 s49, s17, 0
    s_add_u32 s52, s18, s87
    s_addc_u32 s53, s19, 0
    s_sub_u32 s42, 6291456, s85
    s_sub_u32 s46, 6291456, s86
    s_mov_b32 s50, s54
    s_add_u32 m0, s79, 137216
    s_mov_b32 s78, 32768
    buffer_load_dwordx4 v20, s[36:39], s78 offen sc1 lds
    s_add_u32 m0, s79, 138240
    s_nop 0
    buffer_load_dwordx4 v21, s[36:39], s78 offen sc1 lds
    s_add_u32 m0, s81, 151552
    s_mov_b32 s78, 0
    s_mov_b64 exec, 0xffffffff
    buffer_load_dwordx4 v3, s[36:39], s78 offen sc1 lds
    s_mov_b64 exec, -1
    s_add_u32 m0, s33, 16384
    s_mov_b32 s76, 0
    buffer_load_dwordx4 v23, s[40:43], s76 offen offset:0 lds
    s_add_u32 m0, s33, 18432
    s_nop 0
    buffer_load_dwordx4 v23, s[40:43], s76 offen offset:2048 lds
    s_add_u32 m0, s33, 24576
    s_nop 0
    buffer_load_dwordx4 v23, s[44:47], s76 offen offset:0 lds
    s_add_u32 m0, s33, 28672
    s_mov_b32 s77, 0
    buffer_load_dwordx4 v22, s[48:51], s77 offen offset:0 lds
    s_add_u32 m0, s33, 32768
    s_nop 0
    buffer_load_dwordx4 v22, s[52:55], s77 offen offset:0 lds
    s_waitcnt vmcnt(15)
    s_barrier
    s_add_u32 m0, s79, 98304
    s_mov_b32 s78, 128
    buffer_load_dwordx4 v20, s[36:39], s78 offen sc1 lds
    s_add_u32 m0, s79, 99328
    s_nop 0
    buffer_load_dwordx4 v21, s[36:39], s78 offen sc1 lds
    s_add_u32 m0, s33, 36864
    s_mov_b32 s76, 196608
    buffer_load_dwordx4 v23, s[40:43], s76 offen offset:0 lds
    s_add_u32 m0, s33, 38912
    s_nop 0
    buffer_load_dwordx4 v23, s[40:43], s76 offen offset:2048 lds
    s_add_u32 m0, s33, 45056
    s_nop 0
    buffer_load_dwordx4 v23, s[44:47], s76 offen offset:0 lds
    s_add_u32 m0, s33, 49152
    s_mov_b32 s77, 229376
    buffer_load_dwordx4 v22, s[48:51], s77 offen offset:0 lds
    s_add_u32 m0, s33, 53248
    s_nop 0
    buffer_load_dwordx4 v22, s[52:55], s77 offen offset:0 lds
    s_waitcnt vmcnt(17)
    s_barrier
    s_add_u32 m0, s79, 100352
    s_mov_b32 s78, 32896
    buffer_load_dwordx4 v20, s[36:39], s78 offen sc1 lds
    s_add_u32 m0, s79, 101376
    s_nop 0
    buffer_load_dwordx4 v21, s[36:39], s78 offen sc1 lds
    s_add_u32 m0, s81, 114688
    s_mov_b32 s78, 128
    s_mov_b64 exec, 0xffffffff
    buffer_load_dwordx4 v3, s[36:39], s78 offen sc1 lds
    s_mov_b64 exec, -1
    s_add_u32 m0, s33, 57344
    s_mov_b32 s76, 393216
L_pad8:
    s_cbranch_execz L_vret0
    buffer_load_dwordx4 v23, s[40:43], s76 offen offset:0 lds
    s_add_u32 m0, s33, 59392
    s_nop 0
    buffer_load_dwordx4 v23, s[40:43], s76 offen offset:2048 lds
    s_add_u32 m0, s33, 65536
    s_nop 0
    buffer_load_dwordx4 v23, s[44:47], s76 offen offset:0 lds
    s_add_u32 m0, s33, 69632
    s_mov_b32 s77, 458752
    buffer_load_dwordx4 v22, s[48:51], s77 offen offset:0 lds
    s_add_u32 m0, s33, 73728
    s_nop 0
    buffer_load_dwordx4 v22, s[52:55], s77 offen offset:0 lds
    s_waitcnt lgkmcnt(0)
    s_waitcnt vmcnt(15)
    s_barrier
    s_setprio 1
    v_add_u32 v14, s80, v16
    v_add_u32 v15, s80, v17
    s_add_u32 s84, s80, s95
    v_add_u32 v18, s84, v16
    v_add_u32 v19, s84, v17
    s_add_u32 s80, s80, 18432
    s_cmp_ge_u32 s80, 153600
    s_cselect_b32 s84, 55296, 0
    s_sub_u32 s80, s80, s84
    ds_read_b64_tr_b16 v[64:65], v4 offset:4096
    ds_read_b64_tr_b16 v[66:67], v4 offset:4608
    ds_read_b128 v[24:27], v14 offset:0
    ds_read_b128 v[28:31], v14 offset:2048
    ds_read_b128 v[32:35], v14 offset:4096
    ds_read_b128 v[36:39], v14 offset:6144
    ds_read_b64_tr_b16 v[68:69], v5 offset:4096
    ds_read_b64_tr_b16 v[70:71], v5 offset:4608
    ds_read_b64_tr_b16 v[72:73], v4 offset:8192
    ds_read_b64_tr_b16 v[74:75], v4 offset:8704
    ds_read_b128 v[56:59], v18
    s_mov_b32 s34, 7
.p2align 6
L_p2:
    s_waitcnt lgkmcnt(8)
    v_mfma_f32_16x16x32_bf16 v[88:91], v[64:67], v[24:27], v[88:91]
    ds_read_b64_tr_b16 v[76:77], v5 offset:8192
    s_waitcnt lgkmcnt(8)
    v_mfma_f32_16x16x32_bf16 v[92:95], v[64:67], v[28:31], v[92:95]
    ds_read_b64_tr_b16 v[78:79], v5 offset:8704
    s_waitcnt lgkmcnt(8)
    v_mfma_f32_16x16x32_bf16 v[96:99], v[64:67], v[32:35], v[96:99]
    ds_read_b64_tr_b16 v[80:81], v4 offset:0
    s_waitcnt lgkmcnt(8)
    v_mfma_f32_16x16x32_bf16 v[100:103], v[64:67], v[36:39], v[100:103]
    ds_read_b64_tr_b16 v[82:83], v4 offset:512
    s_waitcnt lgkmcnt(4)
    v_mfma_f32_16x16x32_bf16 v[248:251], v[64:67], v[56:59], v[248:251]
    v_mfma_f32_16x16x32_bf16 v[104:107], v[68:71], v[24:27], v[104:107]
    ds_read_b64_tr_b16 v[64:65], v5 offset:0
    v_mfma_f32_16x16x32_bf16 v[108:111], v[68:71], v[28:31], v[108:111]
    v_mfma_f32_16x16x32_bf16 v[112:115], v[68:71], v[32:35], v[112:115]
    ds_read_b64_tr_b16 v[66:67], v5 offset:512
    v_mfma_f32_16x16x32_bf16 v[116:119], v[68:71], v[36:39], v[116:119]
    v_mfma_f32_16x16x32_bf16 v[120:123], v[24:27], v[72:75], v[120:123]
    ds_read_b64_tr_b16 v[68:69], v4 offset:12288
    v_mfma_f32_16x16x32_bf16 v[124:127], v[28:31], v[72:75], v[124:127]
    v_mfma_f32_16x16x32_bf16 v[128:131], v[32:35], v[72:75], v[128:131]
    ds_read_b64_tr_b16 v[70:71], v4 offset:12800
    v_mfma_f32_16x16x32_bf16 v[132:135], v[36:39], v[72:75], v[132:135]
    v_mfma_f32_16x16x32_bf16 v[252:255], v[56:59], v[72:75], v[252:255]
    s_waitcnt lgkmcnt(6)
    v_mfma_f32_16x16x32_bf16 v[136:139], v[24:27], v[76:79], v[136:139]
    ds_read_b64_tr_b16 v[72:73], v4 offset:16384
    v_mfma_f32_16x16x32_bf16 v[140:143], v[28:31], v[76:79], v[140:143]
    v_mfma_f32_16x16x32_bf16 v[144:147], v[32:35], v[76:79], v[144:147]
    ds_read_b64_tr_b16 v[74:75], v4 offset:16896
    v_mfma_f32_16x16x32_bf16 v[148:151], v[36:39], v[76:79], v[148:151]
    s_waitcnt lgkmcnt(6)
    v_mfma_f32_16x16x32_bf16 v[152:155], v[80:83], v[24:27], v[152:155]
    ds_read_b64_tr_b16 v[76:77], v5 offset:12288
    v_mfma_f32_16x16x32_bf16 v[156:159], v[80:83], v[28:31], v[156:159]
    v_mfma_f32_16x16x32_bf16 v[160:163], v[80:83], v[32:35], v[160:163]
    ds_read_b64_tr_b16 v[78:79], v5 offset:12800
    v_mfma_f32_16x16x32_bf16 v[164:167], v[80:83], v[36:39], v[164:167]
    s_waitcnt lgkmcnt(6)
    v_mfma_f32_16x16x32_bf16 v[168:171], v[64:67], v[24:27], v[168:171]
    ds_read_b64_tr_b16 v[80:81], v5 offset:16384
    v_mfma_f32_16x16x32_bf16 v[172:175], v[64:67], v[28:31], v[172:175]
    v_mfma_f32_16x16x32_bf16 v[176:179], v[64:67], v[32:35], v[176:179]
    ds_read_b64_tr_b16 v[82:83], v5 offset:16896
    v_mfma_f32_16x16x32_bf16 v[180:183], v[64:67], v[36:39], v[180:183]
    s_waitcnt lgkmcnt(6)
    v_mfma_f32_16x16x32_bf16 v[184:187], v[68:71], v[24:27], v[184:187]
    v_mfma_f32_16x16x32_bf16 v[188:191], v[68:71], v[28:31], v[188:191]
    v_mfma_f32_16x16x32_bf16 v[192:195], v[68:71], v[32:35], v[192:195]
    v_mfma_f32_16x16x32_bf16 v[196:199], v[68:71], v[36:39], v[196:199]
    s_waitcnt vmcnt(8) lgkmcnt(0)
    s_barrier
    v_mfma_f32_16x16x32_bf16 v[200:203], v[72:75], v[24:27], v[200:203]
    ds_read_b64_tr_b16 v[64:65], v4 offset:24576
    v_mfma_f32_16x16x32_bf16 v[204:207], v[72:75], v[28:31], v[204:207]
    ds_read_b64_tr_b16 v[66:67], v4 offset:25088
    v_mfma_f32_16x16x32_bf16 v[208:211], v[72:75], v[32:35], v[208:211]
    ds_read_b128 v[40:43], v15 offset:0
    v_mfma_f32_16x16x32_bf16 v[212:215], v[72:75], v[36:39], v[212:215]
    ds_read_b128 v[44:47], v15 offset:2048
    v_mfma_f32_16x16x32_bf16 v[216:219], v[76:79], v[24:27], v[216:219]
    ds_read_b128 v[48:51], v15 offset:4096
    v_mfma_f32_16x16x32_bf16 v[220:223], v[76:79], v[28:31], v[220:223]
    ds_read_b128 v[52:55], v15 offset:6144
    v_mfma_f32_16x16x32_bf16 v[224:227], v[76:79], v[32:35], v[224:227]
    ds_read_b64_tr_b16 v[68:69], v5 offset:24576
    v_mfma_f32_16x16x32_bf16 v[228:231], v[76:79], v[36:39], v[228:231]
    ds_read_b64_tr_b16 v[70:71], v5 offset:25088
    v_mfma_f32_16x16x32_bf16 v[232:235], v[80:83], v[24:27], v[232:235]
    ds_read_b64_tr_b16 v[72:73], v4 offset:28672
    v_mfma_f32_16x16x32_bf16 v[236:239], v[80:83], v[28:31], v[236:239]
    ds_read_b64_tr_b16 v[74:75], v4 offset:29184
    v_mfma_f32_16x16x32_bf16 v[240:243], v[80:83], v[32:35], v[240:243]
    ds_read_b128 v[60:63], v19
    v_mfma_f32_16x16x32_bf16 v[244:247], v[80:83], v[36:39], v[244:247]
    s_waitcnt lgkmcnt(8)
    v_mfma_f32_16x16x32_bf16 v[88:91], v[64:67], v[40:43], v[88:91]
    ds_read_b64_tr_b16 v[76:77], v5 offset:28672
    s_waitcnt lgkmcnt(8)
    v_mfma_f32_16x16x32_bf16 v[92:95], v[64:67], v[44:47], v[92:95]
    ds_read_b64_tr_b16 v[78:79], v5 offset:29184
    s_waitcnt lgkmcnt(8)
    v_mfma_f32_16x16x32_bf16 v[96:99], v[64:67], v[48:51], v[96:99]
    ds_read_b64_tr_b16 v[80:81], v4 offset:20480
    s_waitcnt lgkmcnt(8)
    v_mfma_f32_16x16x32_bf16 v[100:103], v[64:67], v[52:55], v[100:103]
    ds_read_b64_tr_b16 v[82:83], v4 offset:20992
    s_waitcnt lgkmcnt(4)
    v_mfma_f32_16x16x32_bf16 v[248:251], v[64:67], v[60:63], v[248:251]
    v_mfma_f32_16x16x32_bf16 v[104:107], v[68:71], v[40:43], v[104:107]
    ds_read_b64_tr_b16 v[64:65], v5 offset:20480
    v_mfma_f32_16x16x32_bf16 v[108:111], v[68:71], v[44:47], v[108:111]
    v_add_u32 v14, s80, v16
    v_mfma_f32_16x16x32_bf16 v[112:115], v[68:71], v[48:51], v[112:115]
    ds_read_b64_tr_b16 v[66:67], v5 offset:20992
    v_mfma_f32_16x16x32_bf16 v[116:119], v[68:71], v[52:55], v[116:119]
    v_add_u32 v15, s80, v17
    v_mfma_f32_16x16x32_bf16 v[120:123], v[40:43], v[72:75], v[120:123]
    ds_read_b64_tr_b16 v[68:69], v4 offset:32768
    v_mfma_f32_16x16x32_bf16 v[124:127], v[44:47], v[72:75], v[124:127]
    s_add_u32 s84, s80, s95
    v_mfma_f32_16x16x32_bf16 v[128:131], v[48:51], v[72:75], v[128:131]
    ds_read_b64_tr_b16 v[70:71], v4 offset:33280
    v_mfma_f32_16x16x32_bf16 v[132:135], v[52:55], v[72:75], v[132:135]
    v_add_u32 v18, s84, v16
    v_mfma_f32_16x16x32_bf16 v[252:255], v[60:63], v[72:75], v[252:255]
    s_waitcnt lgkmcnt(6)
    v_mfma_f32_16x16x32_bf16 v[136:139], v[40:43], v[76:79], v[136:139]
    ds_read_b64_tr_b16 v[72:73], v4 offset:36864
    v_mfma_f32_16x16x32_bf16 v[140:143], v[44:47], v[76:79], v[140:143]
    v_add_u32 v19, s84, v17
    v_mfma_f32_16x16x32_bf16 v[144:147], v[48:51], v[76:79], v[144:147]
    ds_read_b64_tr_b16 v[74:75], v4 offset:37376
    v_mfma_f32_16x16x32_bf16 v[148:151], v[52:55], v[76:79], v[148:151]
    s_add_u32 s80, s80, 18432
    s_waitcnt lgkmcnt(6)
    v_mfma_f32_16x16x32_bf16 v[152:155], v[80:83], v[40:43], v[152:155]
    ds_read_b64_tr_b16 v[76:77], v5 offset:32768
    v_mfma_f32_16x16x32_bf16 v[156:159], v[80:83], v[44:47], v[156:159]
    s_cmp_ge_u32 s80, 153600
    s_cselect_b32 s84, 55296, 0
    v_mfma_f32_16x16x32_bf16 v[160:163], v[80:83], v[48:51], v[160:163]
    ds_read_b64_tr_b16 v[78:79], v5 offset:33280
    v_mfma_f32_16x16x32_bf16 v[164:167], v[80:83], v[52:55], v[164:167]
    s_sub_u32 s80, s80, s84
    s_waitcnt lgkmcnt(6)
    v_mfma_f32_16x16x32_bf16 v[168:171], v[64:67], v[40:43], v[168:171]
    ds_read_b64_tr_b16 v[80:81], v5 offset:36864
    v_mfma_f32_16x16x32_bf16 v[172:175], v[64:67], v[44:47], v[172:175]
    v_mfma_f32_16x16x32_bf16 v[176:179], v[64:67], v[48:51], v[176:179]
    ds_read_b64_tr_b16 v[82:83], v5 offset:37376
    v_mfma_f32_16x16x32_bf16 v[180:183], v[64:67], v[52:55], v[180:183]
    s_waitcnt lgkmcnt(6)
    v_mfma_f32_16x16x32_bf16 v[184:187], v[68:71], v[40:43], v[184:187]
    v_mfma_f32_16x16x32_bf16 v[188:191], v[68:71], v[44:47], v[188:191]
    v_mfma_f32_16x16x32_bf16 v[192:195], v[68:71], v[48:51], v[192:195]
    v_mfma_f32_16x16x32_bf16 v[196:199], v[68:71], v[52:55], v[196:199]
    s_waitcnt vmcnt(0) lgkmcnt(0)
    s_barrier
    v_mfma_f32_16x16x32_bf16 v[200:203], v[72:75], v[40:43], v[200:203]
    ds_read_b64_tr_b16 v[64:65], v6 offset:4096
    v_mfma_f32_16x16x32_bf16 v[204:207], v[72:75], v[44:47], v[204:207]
    ds_read_b64_tr_b16 v[66:67], v6 offset:4608
    v_mfma_f32_16x16x32_bf16 v[208:211], v[72:75], v[48:51], v[208:211]
    ds_read_b128 v[24:27], v14 offset:0
    v_mfma_f32_16x16x32_bf16 v[212:215], v[72:75], v[52:55], v[212:215]
    ds_read_b128 v[28:31], v14 offset:2048
    v_mfma_f32_16x16x32_bf16 v[216:219], v[76:79], v[40:43], v[216:219]
    ds_read_b128 v[32:35], v14 offset:4096
    v_mfma_f32_16x16x32_bf16 v[220:223], v[76:79], v[44:47], v[220:223]
    ds_read_b128 v[36:39], v14 offset:6144
    v_mfma_f32_16x16x32_bf16 v[224:227], v[76:79], v[48:51], v[224:227]
    ds_read_b64_tr_b16 v[68:69], v7 offset:4096
    v_mfma_f32_16x16x32_bf16 v[228:231], v[76:79], v[52:55], v[228:231]
    ds_read_b64_tr_b16 v[70:71], v7 offset:4608
    v_mfma_f32_16x16x32_bf16 v[232:235], v[80:83], v[40:43], v[232:235]
    ds_read_b64_tr_b16 v[72:73], v6 offset:8192
    v_mfma_f32_16x16x32_bf16 v[236:239], v[80:83], v[44:47], v[236:239]
    ds_read_b64_tr_b16 v[74:75], v6 offset:8704
    v_mfma_f32_16x16x32_bf16 v[240:243], v[80:83], v[48:51], v[240:243]
    ds_read_b128 v[56:59], v18
    v_mfma_f32_16x16x32_bf16 v[244:247], v[80:83], v[52:55], v[244:247]
    s_waitcnt lgkmcnt(8)
    v_mfma_f32_16x16x32_bf16 v[88:91], v[64:67], v[24:27], v[88:91]
    ds_read_b64_tr_b16 v[76:77], v7 offset:8192
    s_waitcnt lgkmcnt(8)
    v_mfma_f32_16x16x32_bf16 v[92:95], v[64:67], v[28:31], v[92:95]
    ds_read_b64_tr_b16 v[78:79], v7 offset:8704
    s_waitcnt lgkmcnt(8)
    v_mfma_f32_16x16x32_bf16 v[96:99], v[64:67], v[32:35], v[96:99]
    ds_read_b64_tr_b16 v[80:81], v6 offset:0
    s_waitcnt lgkmcnt(8)
    v_mfma_f32_16x16x32_bf16 v[100:103], v[64:67], v[36:39], v[100:103]
    ds_read_b64_tr_b16 v[82:83], v6 offset:512
    s_waitcnt lgkmcnt(4)
    v_mfma_f32_16x16x32_bf16 v[248:251], v[64:67], v[56:59], v[248:251]
    v_mfma_f32_16x16x32_bf16 v[104:107], v[68:71], v[24:27], v[104:107]
    ds_read_b64_tr_b16 v[64:65], v7 offset:0
    v_mfma_f32_16x16x32_bf16 v[108:111], v[68:71], v[28:31], v[108:111]
    v_mfma_f32_16x16x32_bf16 v[112:115], v[68:71], v[32:35], v[112:115]
    ds_read_b64_tr_b16 v[66:67], v7 offset:512
    v_mfma_f32_16x16x32_bf16 v[116:119], v[68:71], v[36:39], v[116:119]
    v_mfma_f32_16x16x32_bf16 v[120:123], v[24:27], v[72:75], v[120:123]
    ds_read_b64_tr_b16 v[68:69], v6 offset:12288
    v_mfma_f32_16x16x32_bf16 v[124:127], v[28:31], v[72:75], v[124:127]
    v_mfma_f32_16x16x32_bf16 v[128:131], v[32:35], v[72:75], v[128:131]
    ds_read_b64_tr_b16 v[70:71], v6 offset:12800
    v_mfma_f32_16x16x32_bf16 v[132:135], v[36:39], v[72:75], v[132:135]
    v_mfma_f32_16x16x32_bf16 v[252:255], v[56:59], v[72:75], v[252:255]
    s_waitcnt lgkmcnt(6)
    v_mfma_f32_16x16x32_bf16 v[136:139], v[24:27], v[76:79], v[136:139]
    ds_read_b64_tr_b16 v[72:73], v6 offset:16384
    v_mfma_f32_16x16x32_bf16 v[140:143], v[28:31], v[76:79], v[140:143]
    v_mfma_f32_16x16x32_bf16 v[144:147], v[32:35], v[76:79], v[144:147]
    ds_read_b64_tr_b16 v[74:75], v6 offset:16896
    v_mfma_f32_16x16x32_bf16 v[148:151], v[36:39], v[76:79], v[148:151]
    s_waitcnt lgkmcnt(6)
    v_mfma_f32_16x16x32_bf16 v[152:155], v[80:83], v[24:27], v[152:155]
    ds_read_b64_tr_b16 v[76:77], v7 offset:12288
    v_mfma_f32_16x16x32_bf16 v[156:159], v[80:83], v[28:31], v[156:159]
    v_mfma_f32_16x16x32_bf16 v[160:163], v[80:83], v[32:35], v[160:163]
    ds_read_b64_tr_b16 v[78:79], v7 offset:12800
    v_mfma_f32_16x16x32_bf16 v[164:167], v[80:83], v[36:39], v[164:167]
    s_waitcnt lgkmcnt(6)
    v_mfma_f32_16x16x32_bf16 v[168:171], v[64:67], v[24:27], v[168:171]
    ds_read_b64_tr_b16 v[80:81], v7 offset:16384
    v_mfma_f32_16x16x32_bf16 v[172:175], v[64:67], v[28:31], v[172:175]
    v_mfma_f32_16x16x32_bf16 v[176:179], v[64:67], v[32:35], v[176:179]
    ds_read_b64_tr_b16 v[82:83], v7 offset:16896
    v_mfma_f32_16x16x32_bf16 v[180:183], v[64:67], v[36:39], v[180:183]
    s_waitcnt lgkmcnt(6)
    v_mfma_f32_16x16x32_bf16 v[184:187], v[68:71], v[24:27], v[184:187]
    v_mfma_f32_16x16x32_bf16 v[188:191], v[68:71], v[28:31], v[188:191]
    v_mfma_f32_16x16x32_bf16 v[192:195], v[68:71], v[32:35], v[192:195]
    v_mfma_f32_16x16x32_bf16 v[196:199], v[68:71], v[36:39], v[196:199]
    s_waitcnt lgkmcnt(0)
    s_barrier
    v_mfma_f32_16x16x32_bf16 v[200:203], v[72:75], v[24:27], v[200:203]
    ds_read_b64_tr_b16 v[64:65], v6 offset:24576
    v_mfma_f32_16x16x32_bf16 v[204:207], v[72:75], v[28:31], v[204:207]
    ds_read_b64_tr_b16 v[66:67], v6 offset:25088
    v_mfma_f32_16x16x32_bf16 v[208:211], v[72:75], v[32:35], v[208:211]
    ds_read_b128 v[40:43], v15 offset:0
    v_mfma_f32_16x16x32_bf16 v[212:215], v[72:75], v[36:39], v[212:215]
    ds_read_b128 v[44:47], v15 offset:2048
    v_mfma_f32_16x16x32_bf16 v[216:219], v[76:79], v[24:27], v[216:219]
    ds_read_b128 v[48:51], v15 offset:4096
    v_mfma_f32_16x16x32_bf16 v[220:223], v[76:79], v[28:31], v[220:223]
    ds_read_b128 v[52:55], v15 offset:6144
    v_mfma_f32_16x16x32_bf16 v[224:227], v[76:79], v[32:35], v[224:227]
    ds_read_b64_tr_b16 v[68:69], v7 offset:24576
    v_mfma_f32_16x16x32_bf16 v[228:231], v[76:79], v[36:39], v[228:231]
    ds_read_b64_tr_b16 v[70:71], v7 offset:25088
    v_mfma_f32_16x16x32_bf16 v[232:235], v[80:83], v[24:27], v[232:235]
    ds_read_b64_tr_b16 v[72:73], v6 offset:28672
    v_mfma_f32_16x16x32_bf16 v[236:239], v[80:83], v[28:31], v[236:239]
    ds_read_b64_tr_b16 v[74:75], v6 offset:29184
    v_mfma_f32_16x16x32_bf16 v[240:243], v[80:83], v[32:35], v[240:243]
    ds_read_b128 v[60:63], v19
    v_mfma_f32_16x16x32_bf16 v[244:247], v[80:83], v[36:39], v[244:247]
    s_waitcnt lgkmcnt(8)
    v_mfma_f32_16x16x32_bf16 v[88:91], v[64:67], v[40:43], v[88:91]
    ds_read_b64_tr_b16 v[76:77], v7 offset:28672
    s_waitcnt lgkmcnt(8)
    v_mfma_f32_16x16x32_bf16 v[92:95], v[64:67], v[44:47], v[92:95]
    ds_read_b64_tr_b16 v[78:79], v7 offset:29184
    s_waitcnt lgkmcnt(8)
    v_mfma_f32_16x16x32_bf16 v[96:99], v[64:67], v[48:51], v[96:99]
    ds_read_b64_tr_b16 v[80:81], v6 offset:20480
    s_waitcnt lgkmcnt(8)
    v_mfma_f32_16x16x32_bf16 v[100:103], v[64:67], v[52:55], v[100:103]
    ds_read_b64_tr_b16 v[82:83], v6 offset:20992
    s_waitcnt lgkmcnt(4)
    v_mfma_f32_16x16x32_bf16 v[248:251], v[64:67], v[60:63], v[248:251]
    v_mfma_f32_16x16x32_bf16 v[104:107], v[68:71], v[40:43], v[104:107]
    ds_read_b64_tr_b16 v[64:65], v7 offset:20480
    v_mfma_f32_16x16x32_bf16 v[108:111], v[68:71], v[44:47], v[108:111]
    v_add_u32 v14, s80, v16
    v_mfma_f32_16x16x32_bf16 v[112:115], v[68:71], v[48:51], v[112:115]
    ds_read_b64_tr_b16 v[66:67], v7 offset:20992
    v_mfma_f32_16x16x32_bf16 v[116:119], v[68:71], v[52:55], v[116:119]
    v_add_u32 v15, s80, v17
    v_mfma_f32_16x16x32_bf16 v[120:123], v[40:43], v[72:75], v[120:123]
    ds_read_b64_tr_b16 v[68:69], v6 offset:32768
    v_mfma_f32_16x16x32_bf16 v[124:127], v[44:47], v[72:75], v[124:127]
    s_add_u32 s84, s80, s95
    v_mfma_f32_16x16x32_bf16 v[128:131], v[48:51], v[72:75], v[128:131]
    ds_read_b64_tr_b16 v[70:71], v6 offset:33280
    v_mfma_f32_16x16x32_bf16 v[132:135], v[52:55], v[72:75], v[132:135]
    v_add_u32 v18, s84, v16
    v_mfma_f32_16x16x32_bf16 v[252:255], v[60:63], v[72:75], v[252:255]
    s_waitcnt lgkmcnt(6)
    v_mfma_f32_16x16x32_bf16 v[136:139], v[40:43], v[76:79], v[136:139]
    ds_read_b64_tr_b16 v[72:73], v6 offset:36864
    v_mfma_f32_16x16x32_bf16 v[140:143], v[44:47], v[76:79], v[140:143]
    v_add_u32 v19, s84, v17
    v_mfma_f32_16x16x32_bf16 v[144:147], v[48:51], v[76:79], v[144:147]
    ds_read_b64_tr_b16 v[74:75], v6 offset:37376
    v_mfma_f32_16x16x32_bf16 v[148:151], v[52:55], v[76:79], v[148:151]
    s_add_u32 s80, s80, 18432
    s_waitcnt lgkmcnt(6)
    v_mfma_f32_16x16x32_bf16 v[152:155], v[80:83], v[40:43], v[152:155]
    ds_read_b64_tr_b16 v[76:77], v7 offset:32768
    v_mfma_f32_16x16x32_bf16 v[156:159], v[80:83], v[44:47], v[156:159]
    s_cmp_ge_u32 s80, 153600
    s_cselect_b32 s84, 55296, 0
    v_mfma_f32_16x16x32_bf16 v[160:163], v[80:83], v[48:51], v[160:163]
    ds_read_b64_tr_b16 v[78:79], v7 offset:33280
    v_mfma_f32_16x16x32_bf16 v[164:167], v[80:83], v[52:55], v[164:167]
    s_sub_u32 s80, s80, s84
    s_waitcnt lgkmcnt(6)
    v_mfma_f32_16x16x32_bf16 v[168:171], v[64:67], v[40:43], v[168:171]
    ds_read_b64_tr_b16 v[80:81], v7 offset:36864
    v_mfma_f32_16x16x32_bf16 v[172:175], v[64:67], v[44:47], v[172:175]
    v_mfma_f32_16x16x32_bf16 v[176:179], v[64:67], v[48:51], v[176:179]
    ds_read_b64_tr_b16 v[82:83], v7 offset:37376
    v_mfma_f32_16x16x32_bf16 v[180:183], v[64:67], v[52:55], v[180:183]
    s_waitcnt lgkmcnt(6)
    v_mfma_f32_16x16x32_bf16 v[184:187], v[68:71], v[40:43], v[184:187]
    v_mfma_f32_16x16x32_bf16 v[188:191], v[68:71], v[44:47], v[188:191]
    v_mfma_f32_16x16x32_bf16 v[192:195], v[68:71], v[48:51], v[192:195]
    v_mfma_f32_16x16x32_bf16 v[196:199], v[68:71], v[52:55], v[196:199]
    s_waitcnt lgkmcnt(0)
    s_barrier
    v_mfma_f32_16x16x32_bf16 v[200:203], v[72:75], v[40:43], v[200:203]
    ds_read_b64_tr_b16 v[64:65], v4 offset:4096
    v_mfma_f32_16x16x32_bf16 v[204:207], v[72:75], v[44:47], v[204:207]
    ds_read_b64_tr_b16 v[66:67], v4 offset:4608
    v_mfma_f32_16x16x32_bf16 v[208:211], v[72:75], v[48:51], v[208:211]
    ds_read_b128 v[24:27], v14 offset:0
    v_mfma_f32_16x16x32_bf16 v[212:215], v[72:75], v[52:55], v[212:215]
    ds_read_b128 v[28:31], v14 offset:2048
    v_mfma_f32_16x16x32_bf16 v[216:219], v[76:79], v[40:43], v[216:219]
    ds_read_b128 v[32:35], v14 offset:4096
    v_mfma_f32_16x16x32_bf16 v[220:223], v[76:79], v[44:47], v[220:223]
    ds_read_b128 v[36:39], v14 offset:6144
    v_mfma_f32_16x16x32_bf16 v[224:227], v[76:79], v[48:51], v[224:227]
    ds_read_b64_tr_b16 v[68:69], v5 offset:4096
    v_mfma_f32_16x16x32_bf16 v[228:231], v[76:79], v[52:55], v[228:231]
    ds_read_b64_tr_b16 v[70:71], v5 offset:4608
    v_mfma_f32_16x16x32_bf16 v[232:235], v[80:83], v[40:43], v[232:235]
    ds_read_b64_tr_b16 v[72:73], v4 offset:8192
    v_mfma_f32_16x16x32_bf16 v[236:239], v[80:83], v[44:47], v[236:239]
    ds_read_b64_tr_b16 v[74:75], v4 offset:8704
    v_mfma_f32_16x16x32_bf16 v[240:243], v[80:83], v[48:51], v[240:243]
    ds_read_b128 v[56:59], v18
    v_mfma_f32_16x16x32_bf16 v[244:247], v[80:83], v[52:55], v[244:247]
    s_sub_u32 s34, s34, 1
    s_cmp_lg_u32 s34, 0
    s_cbranch_scc1 L_p2
    s_waitcnt lgkmcnt(8)
    v_mfma_f32_16x16x32_bf16 v[88:91], v[64:67], v[24:27], v[88:91]
    ds_read_b64_tr_b16 v[76:77], v5 offset:8192
    s_waitcnt lgkmcnt(8)
    v_mfma_f32_16x16x32_bf16 v[92:95], v[64:67], v[28:31], v[92:95]
    ds_read_b64_tr_b16 v[78:79], v5 offset:8704
    s_waitcnt lgkmcnt(8)
    v_mfma_f32_16x16x32_bf16 v[96:99], v[64:67], v[32:35], v[96:99]
    ds_read_b64_tr_b16 v[80:81], v4 offset:0
    s_waitcnt lgkmcnt(8)
    v_mfma_f32_16x16x32_bf16 v[100:103], v[64:67], v[36:39], v[100:103]
    ds_read_b64_tr_b16 v[82:83], v4 offset:512
    s_waitcnt lgkmcnt(4)
    v_mfma_f32_16x16x32_bf16 v[248:251], v[64:67], v[56:59], v[248:251]
    v_mfma_f32_16x16x32_bf16 v[104:107], v[68:71], v[24:27], v[104:107]
    ds_read_b64_tr_b16 v[64:65], v5 offset:0
    v_mfma_f32_16x16x32_bf16 v[108:111], v[68:71], v[28:31], v[108:111]
    v_mfma_f32_16x16x32_bf16 v[112:115], v[68:71], v[32:35], v[112:115]
    ds_read_b64_tr_b16 v[66:67], v5 offset:512
    v_mfma_f32_16x16x32_bf16 v[116:119], v[68:71], v[36:39], v[116:119]
    v_mfma_f32_16x16x32_bf16 v[120:123], v[24:27], v[72:75], v[120:123]
    ds_read_b64_tr_b16 v[68:69], v4 offset:12288
    v_mfma_f32_16x16x32_bf16 v[124:127], v[28:31], v[72:75], v[124:127]
    v_mfma_f32_16x16x32_bf16 v[128:131], v[32:35], v[72:75], v[128:131]
    ds_read_b64_tr_b16 v[70:71], v4 offset:12800
    v_mfma_f32_16x16x32_bf16 v[132:135], v[36:39], v[72:75], v[132:135]
    v_mfma_f32_16x16x32_bf16 v[252:255], v[56:59], v[72:75], v[252:255]
    s_waitcnt lgkmcnt(6)
    v_mfma_f32_16x16x32_bf16 v[136:139], v[24:27], v[76:79], v[136:139]
    ds_read_b64_tr_b16 v[72:73], v4 offset:16384
    v_mfma_f32_16x16x32_bf16 v[140:143], v[28:31], v[76:79], v[140:143]
    v_mfma_f32_16x16x32_bf16 v[144:147], v[32:35], v[76:79], v[144:147]
    ds_read_b64_tr_b16 v[74:75], v4 offset:16896
    v_mfma_f32_16x16x32_bf16 v[148:151], v[36:39], v[76:79], v[148:151]
    s_waitcnt lgkmcnt(6)
    v_mfma_f32_16x16x32_bf16 v[152:155], v[80:83], v[24:27], v[152:155]
    ds_read_b64_tr_b16 v[76:77], v5 offset:12288
    v_mfma_f32_16x16x32_bf16 v[156:159], v[80:83], v[28:31], v[156:159]
    v_mfma_f32_16x16x32_bf16 v[160:163], v[80:83], v[32:35], v[160:163]
    ds_read_b64_tr_b16 v[78:79], v5 offset:12800
    v_mfma_f32_16x16x32_bf16 v[164:167], v[80:83], v[36:39], v[164:167]
    s_waitcnt lgkmcnt(6)
    v_mfma_f32_16x16x32_bf16 v[168:171], v[64:67], v[24:27], v[168:171]
    ds_read_b64_tr_b16 v[80:81], v5 offset:16384
    v_mfma_f32_16x16x32_bf16 v[172:175], v[64:67], v[28:31], v[172:175]
    v_mfma_f32_16x16x32_bf16 v[176:179], v[64:67], v[32:35], v[176:179]
    ds_read_b64_tr_b16 v[82:83], v5 offset:16896
    v_mfma_f32_16x16x32_bf16 v[180:183], v[64:67], v[36:39], v[180:183]
    s_waitcnt lgkmcnt(6)
    v_mfma_f32_16x16x32_bf16 v[184:187], v[68:71], v[24:27], v[184:187]
    v_mfma_f32_16x16x32_bf16 v[188:191], v[68:71], v[28:31], v[188:191]
    v_mfma_f32_16x16x32_bf16 v[192:195], v[68:71], v[32:35], v[192:195]
    v_mfma_f32_16x16x32_bf16 v[196:199], v[68:71], v[36:39], v[196:199]
    s_waitcnt lgkmcnt(0)
    s_barrier
    v_mfma_f32_16x16x32_bf16 v[200:203], v[72:75], v[24:27], v[200:203]
    ds_read_b64_tr_b16 v[64:65], v4 offset:24576
    v_mfma_f32_16x16x32_bf16 v[204:207], v[72:75], v[28:31], v[204:207]
    ds_read_b64_tr_b16 v[66:67], v4 offset:25088
    v_mfma_f32_16x16x32_bf16 v[208:211], v[72:75], v[32:35], v[208:211]
    ds_read_b128 v[40:43], v15 offset:0
    v_mfma_f32_16x16x32_bf16 v[212:215], v[72:75], v[36:39], v[212:215]
    ds_read_b128 v[44:47], v15 offset:2048
    v_mfma_f32_16x16x32_bf16 v[216:219], v[76:79], v[24:27], v[216:219]
    ds_read_b128 v[48:51], v15 offset:4096
    v_mfma_f32_16x16x32_bf16 v[220:223], v[76:79], v[28:31], v[220:223]
    ds_read_b128 v[52:55], v15 offset:6144
    v_mfma_f32_16x16x32_bf16 v[224:227], v[76:79], v[32:35], v[224:227]
    ds_read_b64_tr_b16 v[68:69], v5 offset:24576
    v_mfma_f32_16x16x32_bf16 v[228:231], v[76:79], v[36:39], v[228:231]
    ds_read_b64_tr_b16 v[70:71], v5 offset:25088
    v_mfma_f32_16x16x32_bf16 v[232:235], v[80:83], v[24:27], v[232:235]
    ds_read_b64_tr_b16 v[72:73], v4 offset:28672
    v_mfma_f32_16x16x32_bf16 v[236:239], v[80:83], v[28:31], v[236:239]
    ds_read_b64_tr_b16 v[74:75], v4 offset:29184
    v_mfma_f32_16x16x32_bf16 v[240:243], v[80:83], v[32:35], v[240:243]
    ds_read_b128 v[60:63], v19
    v_mfma_f32_16x16x32_bf16 v[244:247], v[80:83], v[36:39], v[244:247]
    s_waitcnt lgkmcnt(8)
    v_mfma_f32_16x16x32_bf16 v[88:91], v[64:67], v[40:43], v[88:91]
    ds_read_b64_tr_b16 v[76:77], v5 offset:28672
    s_waitcnt lgkmcnt(8)
    v_mfma_f32_16x16x32_bf16 v[92:95], v[64:67], v[44:47], v[92:95]
    ds_read_b64_tr_b16 v[78:79], v5 offset:29184
    s_waitcnt lgkmcnt(8)
    v_mfma_f32_16x16x32_bf16 v[96:99], v[64:67], v[48:51], v[96:99]
    ds_read_b64_tr_b16 v[80:81], v4 offset:20480
    s_waitcnt lgkmcnt(8)
    v_mfma_f32_16x16x32_bf16 v[100:103], v[64:67], v[52:55], v[100:103]
    ds_read_b64_tr_b16 v[82:83], v4 offset:20992
    s_waitcnt lgkmcnt(4)
    v_mfma_f32_16x16x32_bf16 v[248:251], v[64:67], v[60:63], v[248:251]
    v_mfma_f32_16x16x32_bf16 v[104:107], v[68:71], v[40:43], v[104:107]
    ds_read_b64_tr_b16 v[64:65], v5 offset:20480
    v_mfma_f32_16x16x32_bf16 v[108:111], v[68:71], v[44:47], v[108:111]
    v_add_u32 v14, s80, v16
    v_mfma_f32_16x16x32_bf16 v[112:115], v[68:71], v[48:51], v[112:115]
    ds_read_b64_tr_b16 v[66:67], v5 offset:20992
    v_mfma_f32_16x16x32_bf16 v[116:119], v[68:71], v[52:55], v[116:119]
    v_add_u32 v15, s80, v17
    v_mfma_f32_16x16x32_bf16 v[120:123], v[40:43], v[72:75], v[120:123]
    ds_read_b64_tr_b16 v[68:69], v4 offset:32768
    v_mfma_f32_16x16x32_bf16 v[124:127], v[44:47], v[72:75], v[124:127]
    s_add_u32 s84, s80, s95
    v_mfma_f32_16x16x32_bf16 v[128:131], v[48:51], v[72:75], v[128:131]
    ds_read_b64_tr_b16 v[70:71], v4 offset:33280
    v_mfma_f32_16x16x32_bf16 v[132:135], v[52:55], v[72:75], v[132:135]
    v_add_u32 v18, s84, v16
    v_mfma_f32_16x16x32_bf16 v[252:255], v[60:63], v[72:75], v[252:255]
    s_waitcnt lgkmcnt(6)
    v_mfma_f32_16x16x32_bf16 v[136:139], v[40:43], v[76:79], v[136:139]
    ds_read_b64_tr_b16 v[72:73], v4 offset:36864
    v_mfma_f32_16x16x32_bf16 v[140:143], v[44:47], v[76:79], v[140:143]
    v_add_u32 v19, s84, v17
    v_mfma_f32_16x16x32_bf16 v[144:147], v[48:51], v[76:79], v[144:147]
    ds_read_b64_tr_b16 v[74:75], v4 offset:37376
    v_mfma_f32_16x16x32_bf16 v[148:151], v[52:55], v[76:79], v[148:151]
    s_add_u32 s80, s80, 18432
    s_waitcnt lgkmcnt(6)
    v_mfma_f32_16x16x32_bf16 v[152:155], v[80:83], v[40:43], v[152:155]
    ds_read_b64_tr_b16 v[76:77], v5 offset:32768
    v_mfma_f32_16x16x32_bf16 v[156:159], v[80:83], v[44:47], v[156:159]
    s_cmp_ge_u32 s80, 153600
    s_cselect_b32 s84, 55296, 0
    v_mfma_f32_16x16x32_bf16 v[160:163], v[80:83], v[48:51], v[160:163]
    ds_read_b64_tr_b16 v[78:79], v5 offset:33280
    v_mfma_f32_16x16x32_bf16 v[164:167], v[80:83], v[52:55], v[164:167]
    s_sub_u32 s80, s80, s84
    s_waitcnt lgkmcnt(6)
    v_mfma_f32_16x16x32_bf16 v[168:171], v[64:67], v[40:43], v[168:171]
    ds_read_b64_tr_b16 v[80:81], v5 offset:36864
    v_mfma_f32_16x16x32_bf16 v[172:175], v[64:67], v[44:47], v[172:175]
    v_mfma_f32_16x16x32_bf16 v[176:179], v[64:67], v[48:51], v[176:179]
    ds_read_b64_tr_b16 v[82:83], v5 offset:37376
    v_mfma_f32_16x16x32_bf16 v[180:183], v[64:67], v[52:55], v[180:183]
    s_waitcnt lgkmcnt(6)
    v_mfma_f32_16x16x32_bf16 v[184:187], v[68:71], v[40:43], v[184:187]
    v_mfma_f32_16x16x32_bf16 v[188:191], v[68:71], v[44:47], v[188:191]
    v_mfma_f32_16x16x32_bf16 v[192:195], v[68:71], v[48:51], v[192:195]
    v_mfma_f32_16x16x32_bf16 v[196:199], v[68:71], v[52:55], v[196:199]
    s_waitcnt lgkmcnt(0)
    s_barrier
    v_mfma_f32_16x16x32_bf16 v[200:203], v[72:75], v[40:43], v[200:203]
    ds_read_b64_tr_b16 v[64:65], v6 offset:4096
    v_mfma_f32_16x16x32_bf16 v[204:207], v[72:75], v[44:47], v[204:207]
    ds_read_b64_tr_b16 v[66:67], v6 offset:4608
    v_mfma_f32_16x16x32_bf16 v[208:211], v[72:75], v[48:51], v[208:211]
    ds_read_b128 v[24:27], v14 offset:0
    v_mfma_f32_16x16x32_bf16 v[212:215], v[72:75], v[52:55], v[212:215]
    ds_read_b128 v[28:31], v14 offset:2048
    v_mfma_f32_16x16x32_bf16 v[216:219], v[76:79], v[40:43], v[216:219]
    ds_read_b128 v[32:35], v14 offset:4096
    v_mfma_f32_16x16x32_bf16 v[220:223], v[76:79], v[44:47], v[220:223]
    ds_read_b128 v[36:39], v14 offset:6144
    v_mfma_f32_16x16x32_bf16 v[224:227], v[76:79], v[48:51], v[224:227]
    ds_read_b64_tr_b16 v[68:69], v7 offset:4096
    v_mfma_f32_16x16x32_bf16 v[228:231], v[76:79], v[52:55], v[228:231]
    ds_read_b64_tr_b16 v[70:71], v7 offset:4608
    v_mfma_f32_16x16x32_bf16 v[232:235], v[80:83], v[40:43], v[232:235]
    ds_read_b64_tr_b16 v[72:73], v6 offset:8192
    v_mfma_f32_16x16x32_bf16 v[236:239], v[80:83], v[44:47], v[236:239]
    ds_read_b64_tr_b16 v[74:75], v6 offset:8704
    v_mfma_f32_16x16x32_bf16 v[240:243], v[80:83], v[48:51], v[240:243]
    ds_read_b128 v[56:59], v18
    v_mfma_f32_16x16x32_bf16 v[244:247], v[80:83], v[52:55], v[244:247]
    s_waitcnt lgkmcnt(8)
    v_mfma_f32_16x16x32_bf16 v[88:91], v[64:67], v[24:27], v[88:91]
    ds_read_b64_tr_b16 v[76:77], v7 offset:8192
    s_waitcnt lgkmcnt(8)
    v_mfma_f32_16x16x32_bf16 v[92:95], v[64:67], v[28:31], v[92:95]
    ds_read_b64_tr_b16 v[78:79], v7 offset:8704
    s_waitcnt lgkmcnt(8)
    v_mfma_f32_16x16x32_bf16 v[96:99], v[64:67], v[32:35], v[96:99]
    ds_read_b64_tr_b16 v[80:81], v6 offset:0
    s_waitcnt lgkmcnt(8)
    v_mfma_f32_16x16x32_bf16 v[100:103], v[64:67], v[36:39], v[100:103]
    ds_read_b64_tr_b16 v[82:83], v6 offset:512
    s_waitcnt lgkmcnt(4)
    v_mfma_f32_16x16x32_bf16 v[248:251], v[64:67], v[56:59], v[248:251]
    v_mfma_f32_16x16x32_bf16 v[104:107], v[68:71], v[24:27], v[104:107]
    ds_read_b64_tr_b16 v[64:65], v7 offset:0
    v_mfma_f32_16x16x32_bf16 v[108:111], v[68:71], v[28:31], v[108:111]
    v_mfma_f32_16x16x32_bf16 v[112:115], v[68:71], v[32:35], v[112:115]
    ds_read_b64_tr_b16 v[66:67], v7 offset:512
    v_mfma_f32_16x16x32_bf16 v[116:119], v[68:71], v[36:39], v[116:119]
    v_mfma_f32_16x16x32_bf16 v[120:123], v[24:27], v[72:75], v[120:123]
    ds_read_b64_tr_b16 v[68:69], v6 offset:12288
    v_mfma_f32_16x16x32_bf16 v[124:127], v[28:31], v[72:75], v[124:127]
    v_mfma_f32_16x16x32_bf16 v[128:131], v[32:35], v[72:75], v[128:131]
    ds_read_b64_tr_b16 v[70:71], v6 offset:12800
    v_mfma_f32_16x16x32_bf16 v[132:135], v[36:39], v[72:75], v[132:135]
    v_mfma_f32_16x16x32_bf16 v[252:255], v[56:59], v[72:75], v[252:255]
    s_waitcnt lgkmcnt(6)
    v_mfma_f32_16x16x32_bf16 v[136:139], v[24:27], v[76:79], v[136:139]
L_pad9:
    s_cbranch_execz L_vret1
    ds_read_b64_tr_b16 v[72:73], v6 offset:16384
    v_mfma_f32_16x16x32_bf16 v[140:143], v[28:31], v[76:79], v[140:143]
    v_mfma_f32_16x16x32_bf16 v[144:147], v[32:35], v[76:79], v[144:147]
    ds_read_b64_tr_b16 v[74:75], v6 offset:16896
    v_mfma_f32_16x16x32_bf16 v[148:151], v[36:39], v[76:79], v[148:151]
    s_waitcnt lgkmcnt(6)
    v_mfma_f32_16x16x32_bf16 v[152:155], v[80:83], v[24:27], v[152:155]
    ds_read_b64_tr_b16 v[76:77], v7 offset:12288
    v_mfma_f32_16x16x32_bf16 v[156:159], v[80:83], v[28:31], v[156:159]
    v_mfma_f32_16x16x32_bf16 v[160:163], v[80:83], v[32:35], v[160:163]
    ds_read_b64_tr_b16 v[78:79], v7 offset:12800
    v_mfma_f32_16x16x32_bf16 v[164:167], v[80:83], v[36:39], v[164:167]
    s_waitcnt lgkmcnt(6)
    v_mfma_f32_16x16x32_bf16 v[168:171], v[64:67], v[24:27], v[168:171]
    ds_read_b64_tr_b16 v[80:81], v7 offset:16384
    v_mfma_f32_16x16x32_bf16 v[172:175], v[64:67], v[28:31], v[172:175]
    v_mfma_f32_16x16x32_bf16 v[176:179], v[64:67], v[32:35], v[176:179]
    ds_read_b64_tr_b16 v[82:83], v7 offset:16896
    v_mfma_f32_16x16x32_bf16 v[180:183], v[64:67], v[36:39], v[180:183]
    s_waitcnt lgkmcnt(6)
    v_mfma_f32_16x16x32_bf16 v[184:187], v[68:71], v[24:27], v[184:187]
    v_mfma_f32_16x16x32_bf16 v[188:191], v[68:71], v[28:31], v[188:191]
    v_mfma_f32_16x16x32_bf16 v[192:195], v[68:71], v[32:35], v[192:195]
    v_mfma_f32_16x16x32_bf16 v[196:199], v[68:71], v[36:39], v[196:199]
    s_waitcnt lgkmcnt(0)
    s_barrier
    v_mfma_f32_16x16x32_bf16 v[200:203], v[72:75], v[24:27], v[200:203]
    ds_read_b64_tr_b16 v[64:65], v6 offset:24576
    v_mfma_f32_16x16x32_bf16 v[204:207], v[72:75], v[28:31], v[204:207]
    ds_read_b64_tr_b16 v[66:67], v6 offset:25088
    v_mfma_f32_16x16x32_bf16 v[208:211], v[72:75], v[32:35], v[208:211]
    ds_read_b128 v[40:43], v15 offset:0
    v_mfma_f32_16x16x32_bf16 v[212:215], v[72:75], v[36:39], v[212:215]
    ds_read_b128 v[44:47], v15 offset:2048
    v_mfma_f32_16x16x32_bf16 v[216:219], v[76:79], v[24:27], v[216:219]
    ds_read_b128 v[48:51], v15 offset:4096
    v_mfma_f32_16x16x32_bf16 v[220:223], v[76:79], v[28:31], v[220:223]
    ds_read_b128 v[52:55], v15 offset:6144
    v_mfma_f32_16x16x32_bf16 v[224:227], v[76:79], v[32:35], v[224:227]
    ds_read_b64_tr_b16 v[68:69], v7 offset:24576
    v_mfma_f32_16x16x32_bf16 v[228:231], v[76:79], v[36:39], v[228:231]
    ds_read_b64_tr_b16 v[70:71], v7 offset:25088
    v_mfma_f32_16x16x32_bf16 v[232:235], v[80:83], v[24:27], v[232:235]
    ds_read_b64_tr_b16 v[72:73], v6 offset:28672
    v_mfma_f32_16x16x32_bf16 v[236:239], v[80:83], v[28:31], v[236:239]
    ds_read_b64_tr_b16 v[74:75], v6 offset:29184
    v_mfma_f32_16x16x32_bf16 v[240:243], v[80:83], v[32:35], v[240:243]
    ds_read_b128 v[60:63], v19
    v_mfma_f32_16x16x32_bf16 v[244:247], v[80:83], v[36:39], v[244:247]
    s_waitcnt lgkmcnt(8)
    v_mfma_f32_16x16x32_bf16 v[88:91], v[64:67], v[40:43], v[88:91]
    ds_read_b64_tr_b16 v[76:77], v7 offset:28672
    s_waitcnt lgkmcnt(8)
    v_mfma_f32_16x16x32_bf16 v[92:95], v[64:67], v[44:47], v[92:95]
    ds_read_b64_tr_b16 v[78:79], v7 offset:29184
    s_waitcnt lgkmcnt(8)
    v_mfma_f32_16x16x32_bf16 v[96:99], v[64:67], v[48:51], v[96:99]
    ds_read_b64_tr_b16 v[80:81], v6 offset:20480
    s_waitcnt lgkmcnt(8)
    v_mfma_f32_16x16x32_bf16 v[100:103], v[64:67], v[52:55], v[100:103]
    ds_read_b64_tr_b16 v[82:83], v6 offset:20992
    s_waitcnt lgkmcnt(4)
    v_mfma_f32_16x16x32_bf16 v[248:251], v[64:67], v[60:63], v[248:251]
    v_mfma_f32_16x16x32_bf16 v[104:107], v[68:71], v[40:43], v[104:107]
    ds_read_b64_tr_b16 v[64:65], v7 offset:20480
    v_mfma_f32_16x16x32_bf16 v[108:111], v[68:71], v[44:47], v[108:111]
    v_mfma_f32_16x16x32_bf16 v[112:115], v[68:71], v[48:51], v[112:115]
    ds_read_b64_tr_b16 v[66:67], v7 offset:20992
    v_mfma_f32_16x16x32_bf16 v[116:119], v[68:71], v[52:55], v[116:119]
    v_mfma_f32_16x16x32_bf16 v[120:123], v[40:43], v[72:75], v[120:123]
    ds_read_b64_tr_b16 v[68:69], v6 offset:32768
    v_mfma_f32_16x16x32_bf16 v[124:127], v[44:47], v[72:75], v[124:127]
    v_mfma_f32_16x16x32_bf16 v[128:131], v[48:51], v[72:75], v[128:131]
    ds_read_b64_tr_b16 v[70:71], v6 offset:33280
    v_mfma_f32_16x16x32_bf16 v[132:135], v[52:55], v[72:75], v[132:135]
    v_mfma_f32_16x16x32_bf16 v[252:255], v[60:63], v[72:75], v[252:255]
    s_waitcnt lgkmcnt(6)
    v_mfma_f32_16x16x32_bf16 v[136:139], v[40:43], v[76:79], v[136:139]
    ds_read_b64_tr_b16 v[72:73], v6 offset:36864
    v_mfma_f32_16x16x32_bf16 v[140:143], v[44:47], v[76:79], v[140:143]
    v_mfma_f32_16x16x32_bf16 v[144:147], v[48:51], v[76:79], v[144:147]
    ds_read_b64_tr_b16 v[74:75], v6 offset:37376
    v_mfma_f32_16x16x32_bf16 v[148:151], v[52:55], v[76:79], v[148:151]
    s_waitcnt lgkmcnt(6)
    v_mfma_f32_16x16x32_bf16 v[152:155], v[80:83], v[40:43], v[152:155]
    ds_read_b64_tr_b16 v[76:77], v7 offset:32768
    v_mfma_f32_16x16x32_bf16 v[156:159], v[80:83], v[44:47], v[156:159]
    v_mfma_f32_16x16x32_bf16 v[160:163], v[80:83], v[48:51], v[160:163]
    ds_read_b64_tr_b16 v[78:79], v7 offset:33280
    v_mfma_f32_16x16x32_bf16 v[164:167], v[80:83], v[52:55], v[164:167]
    s_waitcnt lgkmcnt(6)
    v_mfma_f32_16x16x32_bf16 v[168:171], v[64:67], v[40:43], v[168:171]
    ds_read_b64_tr_b16 v[80:81], v7 offset:36864
    v_mfma_f32_16x16x32_bf16 v[172:175], v[64:67], v[44:47], v[172:175]
    v_mfma_f32_16x16x32_bf16 v[176:179], v[64:67], v[48:51], v[176:179]
    ds_read_b64_tr_b16 v[82:83], v7 offset:37376
    v_mfma_f32_16x16x32_bf16 v[180:183], v[64:67], v[52:55], v[180:183]
    s_waitcnt lgkmcnt(6)
    v_mfma_f32_16x16x32_bf16 v[184:187], v[68:71], v[40:43], v[184:187]
    v_mfma_f32_16x16x32_bf16 v[188:191], v[68:71], v[44:47], v[188:191]
    v_mfma_f32_16x16x32_bf16 v[192:195], v[68:71], v[48:51], v[192:195]
    v_mfma_f32_16x16x32_bf16 v[196:199], v[68:71], v[52:55], v[196:199]
    s_waitcnt lgkmcnt(0)
    s_barrier
    v_mfma_f32_16x16x32_bf16 v[200:203], v[72:75], v[40:43], v[200:203]
    v_mfma_f32_16x16x32_bf16 v[204:207], v[72:75], v[44:47], v[204:207]
    v_mfma_f32_16x16x32_bf16 v[208:211], v[72:75], v[48:51], v[208:211]
    v_mfma_f32_16x16x32_bf16 v[212:215], v[72:75], v[52:55], v[212:215]
    v_mfma_f32_16x16x32_bf16 v[216:219], v[76:79], v[40:43], v[216:219]
    v_mfma_f32_16x16x32_bf16 v[220:223], v[76:79], v[44:47], v[220:223]
    v_mfma_f32_16x16x32_bf16 v[224:227], v[76:79], v[48:51], v[224:227]
    v_mfma_f32_16x16x32_bf16 v[228:231], v[76:79], v[52:55], v[228:231]
    v_mfma_f32_16x16x32_bf16 v[232:235], v[80:83], v[40:43], v[232:235]
    v_mfma_f32_16x16x32_bf16 v[236:239], v[80:83], v[44:47], v[236:239]
    v_mfma_f32_16x16x32_bf16 v[240:243], v[80:83], v[48:51], v[240:243]
    v_mfma_f32_16x16x32_bf16 v[244:247], v[80:83], v[52:55], v[244:247]
    s_setprio 0
    s_mov_b32 s76, 0xbdd2d3e8
    v_cvt_pk_bf16_f32 v100, v100, v101
    v_cvt_pk_bf16_f32 v101, v102, v103
    v_cvt_pk_bf16_f32 v102, v116, v117
    v_cvt_pk_bf16_f32 v103, v118, v119
    v_cvt_pk_bf16_f32 v32, v132, v133
    v_cvt_pk_bf16_f32 v33, v134, v135
    v_cvt_pk_bf16_f32 v42, v148, v149
    v_cvt_pk_bf16_f32 v43, v150, v151
    v_cvt_pk_bf16_f32 v44, v248, v249
    v_cvt_pk_bf16_f32 v45, v250, v251
    v_cvt_pk_bf16_f32 v24, v252, v253
    v_cvt_pk_bf16_f32 v25, v254, v255
    s_cmp_lg_u32 s5, 0
    s_cbranch_scc1 L_hx1
    ds_write_b64 v85, v[100:101]
    ds_write_b64 v85, v[102:103] offset:512
    ds_write_b64 v85, v[32:33] offset:1024
    ds_write_b64 v85, v[42:43] offset:1536
    s_branch L_hx2
L_hx1:
    ds_write_b64 v85, v[44:45] offset:2048
    ds_write_b64 v85, v[24:25] offset:2560
L_hx2:
    s_waitcnt lgkmcnt(0)
    v_mul_f32 v80, v184, v184
    v_mul_f32 v81, v185, v185
    v_mul_f32 v82, v186, v186
    v_mul_f32 v83, v187, v187
    v_fma_f32 v80, v80, s76, v84
    v_fma_f32 v81, v81, s76, v84
    v_fma_f32 v82, v82, s76, v84
    v_fma_f32 v83, v83, s76, v84
    v_mul_f32 v80, v80, v184
    v_mul_f32 v81, v81, v185
    v_mul_f32 v82, v82, v186
    v_mul_f32 v83, v83, v187
    v_exp_f32 v80, v80
    v_mul_f32 v184, v184, v200
    v_exp_f32 v81, v81
    v_mul_f32 v185, v185, v201
    v_exp_f32 v82, v82
    v_mul_f32 v186, v186, v202
    v_exp_f32 v83, v83
    v_mul_f32 v187, v187, v203
    v_add_f32 v80, 1.0, v80
    v_add_f32 v81, 1.0, v81
    v_add_f32 v82, 1.0, v82
    v_add_f32 v83, 1.0, v83
    v_rcp_f32 v80, v80
    v_rcp_f32 v81, v81
    v_rcp_f32 v82, v82
    v_rcp_f32 v83, v83
    s_nop 0
    v_mul_f32 v184, v184, v80
    v_mul_f32 v185, v185, v81
    v_mul_f32 v186, v186, v82
    v_mul_f32 v187, v187, v83
    v_cvt_pk_bf16_f32 v184, v184, v185
    v_cvt_pk_bf16_f32 v185, v186, v187
    v_mul_f32 v80, v188, v188
    v_mul_f32 v81, v189, v189
    v_mul_f32 v82, v190, v190
    v_mul_f32 v83, v191, v191
    v_fma_f32 v80, v80, s76, v84
    v_fma_f32 v81, v81, s76, v84
    v_fma_f32 v82, v82, s76, v84
    v_fma_f32 v83, v83, s76, v84
    v_mul_f32 v80, v80, v188
    v_mul_f32 v81, v81, v189
    v_mul_f32 v82, v82, v190
    v_mul_f32 v83, v83, v191
    v_exp_f32 v80, v80
    v_mul_f32 v188, v188, v204
    v_exp_f32 v81, v81
    v_mul_f32 v189, v189, v205
    v_exp_f32 v82, v82
    v_mul_f32 v190, v190, v206
    v_exp_f32 v83, v83
    v_mul_f32 v191, v191, v207
    v_add_f32 v80, 1.0, v80
    v_add_f32 v81, 1.0, v81
    v_add_f32 v82, 1.0, v82
    v_add_f32 v83, 1.0, v83
    v_rcp_f32 v80, v80
    v_rcp_f32 v81, v81
    v_rcp_f32 v82, v82
    s_barrier
    s_cmp_lg_u32 s5, 0
    s_cbranch_scc1 L_hx3
    ds_read_b64 v[46:47], v85 offset:2048
    ds_read_b64 v[34:35], v85 offset:2560
    s_branch L_hx4
L_hx3:
    ds_read_b64 v[44:45], v85 offset:512
    ds_read_b64 v[46:47], v85
    ds_read_b64 v[24:25], v85 offset:1536
    ds_read_b64 v[34:35], v85 offset:1024
L_hx4:
    v_rcp_f32 v83, v83
    s_nop 0
    v_mul_f32 v188, v188, v80
    v_mul_f32 v189, v189, v81
    v_mul_f32 v190, v190, v82
    v_mul_f32 v191, v191, v83
    v_cvt_pk_bf16_f32 v186, v188, v189
    v_cvt_pk_bf16_f32 v187, v190, v191
    s_nop 1
    v_permlane16_swap_b32 v184, v186
    v_permlane16_swap_b32 v185, v187
    buffer_store_dwordx4 v[184:187], v8, s[68:71], s73 offen offset:0 sc1
    v_mul_f32 v80, v192, v192
    v_mul_f32 v81, v193, v193
    v_mul_f32 v82, v194, v194
    v_mul_f32 v83, v195, v195
    v_fma_f32 v80, v80, s76, v84
    v_fma_f32 v81, v81, s76, v84
    v_fma_f32 v82, v82, s76, v84
    v_fma_f32 v83, v83, s76, v84
    v_mul_f32 v80, v80, v192
    v_mul_f32 v81, v81, v193
    v_mul_f32 v82, v82, v194
    v_mul_f32 v83, v83, v195
    v_exp_f32 v80, v80
    v_mul_f32 v192, v192, v208
    v_exp_f32 v81, v81
    v_mul_f32 v193, v193, v209
    v_exp_f32 v82, v82
    v_mul_f32 v194, v194, v210
    v_exp_f32 v83, v83
    v_mul_f32 v195, v195, v211
    v_add_f32 v80, 1.0, v80
    v_add_f32 v81, 1.0, v81
    v_add_f32 v82, 1.0, v82
    v_add_f32 v83, 1.0, v83
    v_rcp_f32 v80, v80
    v_rcp_f32 v81, v81
    v_rcp_f32 v82, v82
    v_rcp_f32 v83, v83
    s_nop 0
    v_mul_f32 v192, v192, v80
    v_mul_f32 v193, v193, v81
    v_mul_f32 v194, v194, v82
    v_mul_f32 v195, v195, v83
    v_cvt_pk_bf16_f32 v192, v192, v193
    v_cvt_pk_bf16_f32 v193, v194, v195
    v_mul_f32 v80, v196, v196
    v_mul_f32 v81, v197, v197
    v_mul_f32 v82, v198, v198
    v_mul_f32 v83, v199, v199
    v_fma_f32 v80, v80, s76, v84
    v_fma_f32 v81, v81, s76, v84
    v_fma_f32 v82, v82, s76, v84
    v_fma_f32 v83, v83, s76, v84
    v_mul_f32 v80, v80, v196
    v_mul_f32 v81, v81, v197
    v_mul_f32 v82, v82, v198
    v_mul_f32 v83, v83, v199
    v_exp_f32 v80, v80
    v_mul_f32 v196, v196, v212
    v_exp_f32 v81, v81
    v_mul_f32 v197, v197, v213
    v_exp_f32 v82, v82
    v_mul_f32 v198, v198, v214
    v_exp_f32 v83, v83
    v_mul_f32 v199, v199, v215
    v_add_f32 v80, 1.0, v80
    s_barrier
    s_waitcnt lgkmcnt(0)
    v_add_f32 v81, 1.0, v81
    v_add_f32 v82, 1.0, v82
    v_add_f32 v83, 1.0, v83
    v_rcp_f32 v80, v80
    v_rcp_f32 v81, v81
    v_rcp_f32 v82, v82
    v_rcp_f32 v83, v83
    s_nop 0
    v_mul_f32 v196, v196, v80
    v_mul_f32 v197, v197, v81
    v_mul_f32 v198, v198, v82
    v_mul_f32 v199, v199, v83
    v_cvt_pk_bf16_f32 v194, v196, v197
    v_cvt_pk_bf16_f32 v195, v198, v199
    s_nop 1
    v_permlane16_swap_b32 v192, v194
    v_permlane16_swap_b32 v193, v195
    buffer_store_dwordx4 v[192:195], v8, s[68:71], s73 offen offset:2048 sc1
    v_mul_f32 v80, v216, v216
    v_mul_f32 v81, v217, v217
    v_mul_f32 v82, v218, v218
    v_mul_f32 v83, v219, v219
    v_fma_f32 v80, v80, s76, v84
    v_fma_f32 v81, v81, s76, v84
    v_fma_f32 v82, v82, s76, v84
    v_fma_f32 v83, v83, s76, v84
    v_mul_f32 v80, v80, v216
    v_mul_f32 v81, v81, v217
    v_mul_f32 v82, v82, v218
    v_mul_f32 v83, v83, v219
    v_exp_f32 v80, v80
    v_mul_f32 v216, v216, v232
    v_exp_f32 v81, v81
    v_mul_f32 v217, v217, v233
    v_exp_f32 v82, v82
    v_mul_f32 v218, v218, v234
    v_exp_f32 v83, v83
    v_mul_f32 v219, v219, v235
    v_add_f32 v80, 1.0, v80
    v_add_f32 v81, 1.0, v81
    v_add_f32 v82, 1.0, v82
    v_add_f32 v83, 1.0, v83
    v_rcp_f32 v80, v80
    v_rcp_f32 v81, v81
    v_rcp_f32 v82, v82
    v_rcp_f32 v83, v83
    s_nop 0
    v_mul_f32 v216, v216, v80
    v_mul_f32 v217, v217, v81
    v_mul_f32 v218, v218, v82
    v_mul_f32 v219, v219, v83
    v_cvt_pk_bf16_f32 v216, v216, v217
    v_cvt_pk_bf16_f32 v217, v218, v219
    v_mul_f32 v80, v220, v220
    v_mul_f32 v81, v221, v221
    v_mul_f32 v82, v222, v222
    v_mul_f32 v83, v223, v223
    v_fma_f32 v80, v80, s76, v84
    v_fma_f32 v81, v81, s76, v84
    v_fma_f32 v82, v82, s76, v84
    v_fma_f32 v83, v83, s76, v84
    v_mul_f32 v80, v80, v220
    v_mul_f32 v81, v81, v221
    v_mul_f32 v82, v82, v222
    v_mul_f32 v83, v83, v223
    v_exp_f32 v80, v80
    v_mul_f32 v220, v220, v236
    v_exp_f32 v81, v81
    s_lshl2_add_u32 s91, s2, s4
    s_lshl_b32 s39, s91, 9
    s_lshr_b32 s92, s91, 2
    s_mul_i32 s92, s92, 7168
    s_and_b32 s91, s91, 3
    s_lshl_b32 s91, s91, 9
    s_add_u32 s92, s92, s91
    s_add_u32 s34, s92, 5120
    s_add_u32 s39, s39, 0x180080
    s_load_dword s94, s[20:21], s39 offset:0x0
    s_load_dword s94, s[20:21], s39 offset:0x40
    s_load_dword s94, s[20:21], s39 offset:0x80
    s_load_dword s94, s[20:21], s39 offset:0xc0
    s_load_dword s94, s[20:21], s39 offset:0x100
    s_barrier
    v_mul_f32 v221, v221, v237
    v_exp_f32 v82, v82
    v_mul_f32 v222, v222, v238
    v_exp_f32 v83, v83
    v_mul_f32 v223, v223, v239
    v_add_f32 v80, 1.0, v80
    v_add_f32 v81, 1.0, v81
    v_add_f32 v82, 1.0, v82
    v_add_f32 v83, 1.0, v83
    v_rcp_f32 v80, v80
    v_rcp_f32 v81, v81
    v_rcp_f32 v82, v82
    v_rcp_f32 v83, v83
    s_nop 0
    v_mul_f32 v220, v220, v80
    v_mul_f32 v221, v221, v81
    v_mul_f32 v222, v222, v82
    v_mul_f32 v223, v223, v83
    v_cvt_pk_bf16_f32 v218, v220, v221
    v_cvt_pk_bf16_f32 v219, v222, v223
    s_nop 1
    v_permlane16_swap_b32 v216, v218
    v_permlane16_swap_b32 v217, v219
    buffer_store_dwordx4 v[216:219], v8, s[68:71], s74 offen offset:0 sc1
    v_mul_f32 v80, v224, v224
    v_mul_f32 v81, v225, v225
    v_mul_f32 v82, v226, v226
    v_mul_f32 v83, v227, v227
    v_fma_f32 v80, v80, s76, v84
    v_fma_f32 v81, v81, s76, v84
    v_fma_f32 v82, v82, s76, v84
    v_fma_f32 v83, v83, s76, v84
    v_mul_f32 v80, v80, v224
    v_mul_f32 v81, v81, v225
    v_mul_f32 v82, v82, v226
    v_mul_f32 v83, v83, v227
    v_exp_f32 v80, v80
    v_mul_f32 v224, v224, v240
    v_exp_f32 v81, v81
    v_mul_f32 v225, v225, v241
    v_exp_f32 v82, v82
    v_mul_f32 v226, v226, v242
    v_exp_f32 v83, v83
    v_mul_f32 v227, v227, v243
    v_add_f32 v80, 1.0, v80
    v_add_f32 v81, 1.0, v81
    v_add_f32 v82, 1.0, v82
    v_add_f32 v83, 1.0, v83
    v_rcp_f32 v80, v80
    v_rcp_f32 v81, v81
    v_rcp_f32 v82, v82
    v_rcp_f32 v83, v83
    s_nop 0
    v_mul_f32 v224, v224, v80
    v_mul_f32 v225, v225, v81
    v_mul_f32 v226, v226, v82
    v_mul_f32 v227, v227, v83
    v_cvt_pk_bf16_f32 v224, v224, v225
    v_cvt_pk_bf16_f32 v225, v226, v227
    v_mul_f32 v80, v228, v228
    v_mul_f32 v81, v229, v229
    v_mul_f32 v82, v230, v230
    v_mul_f32 v83, v231, v231
    v_fma_f32 v80, v80, s76, v84
    v_fma_f32 v81, v81, s76, v84
    v_fma_f32 v82, v82, s76, v84
    v_fma_f32 v83, v83, s76, v84
    s_load_dword s94, s[20:21], s39 offset:0x140
    s_add_u32 s39, s39, 0x27ff80
    s_load_dword s94, s[20:21], s39 offset:0x0
    s_load_dword s94, s[20:21], s39 offset:0x40
    s_load_dword s94, s[20:21], s39 offset:0x80
    s_load_dword s94, s[20:21], s39 offset:0xc0
    s_barrier
    v_mul_f32 v80, v80, v228
    v_mul_f32 v81, v81, v229
    v_mul_f32 v82, v82, v230
    v_mul_f32 v83, v83, v231
    v_exp_f32 v80, v80
    v_mul_f32 v228, v228, v244
    v_exp_f32 v81, v81
    v_mul_f32 v229, v229, v245
    v_exp_f32 v82, v82
    v_mul_f32 v230, v230, v246
    v_exp_f32 v83, v83
    v_mul_f32 v231, v231, v247
    v_add_f32 v80, 1.0, v80
    v_add_f32 v81, 1.0, v81
    v_add_f32 v82, 1.0, v82
    v_add_f32 v83, 1.0, v83
    v_rcp_f32 v80, v80
    v_rcp_f32 v81, v81
    v_rcp_f32 v82, v82
    v_rcp_f32 v83, v83
    s_nop 0
    v_mul_f32 v228, v228, v80
    v_mul_f32 v229, v229, v81
    v_mul_f32 v230, v230, v82
    v_mul_f32 v231, v231, v83
    v_cvt_pk_bf16_f32 v226, v228, v229
    v_cvt_pk_bf16_f32 v227, v230, v231
    s_nop 1
    v_permlane16_swap_b32 v224, v226
    v_permlane16_swap_b32 v225, v227
    buffer_store_dwordx4 v[224:227], v8, s[68:71], s74 offen offset:2048 sc1
    v_lshrrev_b32 v64, 4, v1
    v_and_b32 v66, 14, v1
    v_lshlrev_b32 v64, 2, v64
    v_sub_u32 v64, v66, v64
    v_and_b32 v65, 1, v1
    v_cmp_le_i32 s[40:41], 0, v64
    v_cmp_le_i32 s[42:43], 2, v64
    v_mul_u32_u24 v66, 0x202, v65
    s_mov_b32 s80, 0x01000c0c
    v_lshl_add_u32 v66, v66, 16, s80
    v_add_u32 v67, 0x04040000, v66
    v_cndmask_b32 v76, v66, v67, s[40:41]
    v_cndmask_b32 v77, v66, v67, s[42:43]
    v_lshlrev_b32 v65, 4, v65
    v_mov_b32 v68, 0x0c0c0c0c
    v_mov_b32 v66, 0xc0c0100
    v_alignbit_b32 v66, v66, v66, v65
    v_cndmask_b32 v78, v66, v68, s[40:41]
    v_cndmask_b32 v86, v68, v66, s[40:41]
    v_mov_b32 v66, 0xc0c0302
    v_alignbit_b32 v66, v66, v66, v65
    v_cndmask_b32 v79, v66, v68, s[42:43]
    v_cndmask_b32 v87, v68, v66, s[42:43]
    s_or_b32 s80, s28, s5
    s_cmp_eq_u32 s80, 0
    s_cselect_b64 s[80:81], 0, -1
    s_or_b64 s[40:41], s[40:41], s[80:81]
    s_or_b64 s[42:43], s[42:43], s[80:81]
    v_mov_b32 v7, 0xce6e6b28
    s_mov_b32 s77, 0x3e3504f3
    s_mov_b32 s78, 0x3fb8aa3b
    v_cvt_pk_bf16_f32 v88, v88, v89
    v_cvt_pk_bf16_f32 v89, v90, v91
    v_cvt_pk_bf16_f32 v90, v104, v105
    v_cvt_pk_bf16_f32 v91, v106, v107
    v_cvt_pk_bf16_f32 v152, v152, v153
    v_cvt_pk_bf16_f32 v153, v154, v155
    v_cvt_pk_bf16_f32 v154, v168, v169
    v_cvt_pk_bf16_f32 v155, v170, v171
    v_cvt_pk_bf16_f32 v92, v92, v93
    v_cvt_pk_bf16_f32 v93, v94, v95
    v_cvt_pk_bf16_f32 v94, v108, v109
    v_cvt_pk_bf16_f32 v95, v110, v111
    v_cvt_pk_bf16_f32 v156, v156, v157
    v_cvt_pk_bf16_f32 v157, v158, v159
    v_cvt_pk_bf16_f32 v158, v172, v173
    v_cvt_pk_bf16_f32 v159, v174, v175
    s_load_dword s94, s[20:21], s39 offset:0x100
    s_load_dword s94, s[20:21], s39 offset:0x140
    s_load_dword s94, s[20:21], s39 offset:0x180
    s_load_dword s94, s[20:21], s39 offset:0x1c0
    s_add_u32 s39, s39, 0xffe00000
    s_load_dword s94, s[20:21], s39 offset:0x0
    s_barrier
    s_setprio 3
    v_mfma_f32_16x16x32_bf16 v[48:51], v[44:47], v[152:155], 0
    v_mfma_f32_16x16x32_bf16 v[52:55], v[88:91], v[152:155], 0
    s_setprio 0
    v_cvt_pk_bf16_f32 v96, v96, v97
    v_cvt_pk_bf16_f32 v97, v98, v99
    v_cvt_pk_bf16_f32 v98, v112, v113
    v_cvt_pk_bf16_f32 v99, v114, v115
    v_cvt_pk_bf16_f32 v160, v160, v161
    v_cvt_pk_bf16_f32 v161, v162, v163
    v_cvt_pk_bf16_f32 v162, v176, v177
    v_cvt_pk_bf16_f32 v163, v178, v179
    s_setprio 3
    v_mfma_f32_16x16x32_bf16 v[56:59], v[88:91], v[156:159], 0
    v_mfma_f32_16x16x32_bf16 v[60:63], v[92:95], v[156:159], 0
    s_setprio 0
    v_cvt_pk_bf16_f32 v48, v48, v49
    v_cvt_pk_bf16_f32 v49, v50, v51
    v_cvt_pk_bf16_f32 v50, v52, v53
    v_cvt_pk_bf16_f32 v51, v54, v55
    v_perm_b32 v64, v50, v48, v76
    v_perm_b32 v65, v51, v49, v77
    v_mul_f32 v64, s77, v64
    v_mul_f32 v65, s77, v65
    v_cvt_pk_bf16_f32 v65, v64, v65
    v_lshlrev_b32 v64, 16, v65
    v_and_b32 v65, 0xffff0000, v65
    v_cndmask_b32 v64, v7, v64, s[40:41]
    v_cndmask_b32 v65, v7, v65, s[42:43]
    v_max_f32 v72, v64, v65
    v_cvt_pk_bf16_f32 v164, v164, v165
    v_cvt_pk_bf16_f32 v165, v166, v167
    v_cvt_pk_bf16_f32 v166, v180, v181
    v_cvt_pk_bf16_f32 v167, v182, v183
    s_setprio 3
    v_mfma_f32_16x16x32_bf16 v[48:51], v[92:95], v[160:163], 0
    v_mfma_f32_16x16x32_bf16 v[52:55], v[96:99], v[160:163], 0
    s_setprio 0
    v_cvt_pk_bf16_f32 v56, v56, v57
    v_cvt_pk_bf16_f32 v57, v58, v59
    v_cvt_pk_bf16_f32 v58, v60, v61
    v_cvt_pk_bf16_f32 v59, v62, v63
    v_perm_b32 v66, v58, v56, v76
    v_perm_b32 v67, v59, v57, v77
    v_mul_f32 v66, s77, v66
    v_mul_f32 v67, s77, v67
    v_cvt_pk_bf16_f32 v67, v66, v67
    v_lshlrev_b32 v66, 16, v67
    v_and_b32 v67, 0xffff0000, v67
    v_max_f32 v73, v66, v67
    s_setprio 3
    v_mfma_f32_16x16x32_bf16 v[56:59], v[96:99], v[164:167], 0
    v_mfma_f32_16x16x32_bf16 v[60:63], v[100:103], v[164:167], 0
    s_setprio 0
    v_cvt_pk_bf16_f32 v26, v120, v121
    v_cvt_pk_bf16_f32 v27, v122, v123
    v_cvt_pk_bf16_f32 v36, v136, v137
    v_cvt_pk_bf16_f32 v37, v138, v139
    s_load_dword s94, s[20:21], s39 offset:0x40
    s_load_dword s94, s[20:21], s39 offset:0x80
    s_load_dword s94, s[20:21], s39 offset:0xc0
    s_load_dword s94, s[20:21], s39 offset:0x100
    s_load_dword s94, s[20:21], s39 offset:0x140
    s_barrier
    v_cvt_pk_bf16_f32 v28, v124, v125
    v_cvt_pk_bf16_f32 v29, v126, v127
    v_cvt_pk_bf16_f32 v38, v140, v141
    v_cvt_pk_bf16_f32 v39, v142, v143
    v_cvt_pk_bf16_f32 v30, v128, v129
    v_cvt_pk_bf16_f32 v31, v130, v131
    v_cvt_pk_bf16_f32 v40, v144, v145
    v_cvt_pk_bf16_f32 v41, v146, v147
    v_cvt_pk_bf16_f32 v48, v48, v49
    v_cvt_pk_bf16_f32 v49, v50, v51
    v_cvt_pk_bf16_f32 v50, v52, v53
    v_cvt_pk_bf16_f32 v51, v54, v55
    v_perm_b32 v68, v50, v48, v76
    v_perm_b32 v69, v51, v49, v77
    v_mul_f32 v68, s77, v68
    v_mul_f32 v69, s77, v69
    v_cvt_pk_bf16_f32 v69, v68, v69
    v_lshlrev_b32 v68, 16, v69
    v_and_b32 v69, 0xffff0000, v69
    v_max_f32 v74, v68, v69
    v_cvt_pk_bf16_f32 v56, v56, v57
    v_cvt_pk_bf16_f32 v57, v58, v59
    v_cvt_pk_bf16_f32 v58, v60, v61
    v_cvt_pk_bf16_f32 v59, v62, v63
    v_perm_b32 v70, v58, v56, v76
    v_perm_b32 v71, v59, v57, v77
    v_mul_f32 v70, s77, v70
    v_mul_f32 v71, s77, v71
    v_cvt_pk_bf16_f32 v71, v70, v71
    v_lshlrev_b32 v70, 16, v71
    v_and_b32 v71, 0xffff0000, v71
    v_max_f32 v75, v70, v71
    v_permlane32_swap_b32 v72, v73
    v_max_f32 v72, v72, v73
    v_permlane32_swap_b32 v74, v75
    v_max_f32 v74, v74, v75
    s_nop 1
    v_permlane16_swap_b32 v72, v74
    v_max_f32 v72, v72, v74
    v_mov_b32 v74, v72
    s_nop 1
    v_permlane16_swap_b32 v72, v74
    v_mov_b32 v73, v72
    v_mov_b32 v75, v74
    s_nop 0
    v_permlane32_swap_b32 v72, v73
    v_permlane32_swap_b32 v74, v75
    v_sub_f32 v64, v64, v72
    v_sub_f32 v65, v65, v72
    v_sub_f32 v66, v66, v73
    v_sub_f32 v67, v67, v73
    v_sub_f32 v68, v68, v74
    v_sub_f32 v69, v69, v74
    v_sub_f32 v70, v70, v75
    v_sub_f32 v71, v71, v75
    v_mul_f32 v64, s78, v64
    v_mul_f32 v65, s78, v65
    v_mul_f32 v66, s78, v66
    v_mul_f32 v67, s78, v67
    v_mul_f32 v68, s78, v68
    v_mul_f32 v69, s78, v69
    v_mul_f32 v70, s78, v70
    v_mul_f32 v71, s78, v71
    v_exp_f32 v64, v64
    v_exp_f32 v65, v65
    v_exp_f32 v66, v66
    v_exp_f32 v67, v67
    v_exp_f32 v68, v68
    v_exp_f32 v69, v69
    v_exp_f32 v70, v70
    v_exp_f32 v71, v71
    v_add_f32 v72, v64, v65
    v_add_f32 v73, v66, v67
    s_load_dword s94, s[20:21], s39 offset:0x180
    s_load_dword s94, s[20:21], s39 offset:0x1c0
    s_add_u32 s39, s39, 0x280000
    s_load_dword s94, s[20:21], s39 offset:0x0
    s_load_dword s94, s[20:21], s39 offset:0x40
    s_load_dword s94, s[20:21], s39 offset:0x80
    s_lshl4_add_u32 s91, s28, s29
    s_lshl_b32 s91, s91, 7
    s_add_u32 s92, s91, 0x1ea8000
    s_xor_b32 s91, s91, 17408
    s_add_u32 s91, s91, 0x1ea8000
    v_mov_b32 v23, s92
    v_writelane_b32 v23, s91, 1
    s_mov_b64 exec, 3
    global_load_dwordx3 v[20:22], v23, s[26:27] sc1
    s_mov_b64 exec, -1
    s_barrier
    v_add_f32 v74, v68, v69
    v_add_f32 v75, v70, v71
    v_permlane32_swap_b32 v72, v73
    v_add_f32 v72, v72, v73
    v_permlane32_swap_b32 v74, v75
    v_add_f32 v74, v74, v75
    s_nop 1
    v_permlane16_swap_b32 v72, v74
    v_add_f32 v72, v72, v74
    v_rcp_f32 v72, v72
    s_nop 0
    v_mov_b32 v74, v72
    s_nop 1
    v_permlane16_swap_b32 v72, v74
    v_mov_b32 v73, v72
    v_mov_b32 v75, v74
    s_nop 0
    v_permlane32_swap_b32 v72, v73
    v_permlane32_swap_b32 v74, v75
    v_mul_f32 v64, v64, v72
    v_mul_f32 v65, v65, v72
    v_mul_f32 v66, v66, v73
    v_mul_f32 v67, v67, v73
    v_mul_f32 v68, v68, v74
    v_mul_f32 v69, v69, v74
    v_mul_f32 v70, v70, v75
    v_mul_f32 v71, v71, v75
    v_cvt_pk_bf16_f32 v72, v64, v65
L_pad10:
    s_cbranch_execz L_vret2
    v_cvt_pk_bf16_f32 v73, v66, v67
    v_cvt_pk_bf16_f32 v74, v68, v69
    v_cvt_pk_bf16_f32 v75, v70, v71
    v_perm_b32 v152, v72, v72, v78
    v_perm_b32 v153, v72, v72, v79
    v_perm_b32 v154, v72, v72, v86
    v_perm_b32 v155, v72, v72, v87
    v_perm_b32 v156, v73, v73, v78
    v_perm_b32 v157, v73, v73, v79
    v_perm_b32 v158, v73, v73, v86
    v_perm_b32 v159, v73, v73, v87
    s_setprio 3
    v_mfma_f32_16x16x32_bf16 v[48:51], v[24:27], v[152:155], 0
    v_mfma_f32_16x16x32_bf16 v[52:55], v[34:37], v[152:155], 0
    s_setprio 0
    v_perm_b32 v160, v74, v74, v78
    v_perm_b32 v161, v74, v74, v79
    v_perm_b32 v162, v74, v74, v86
    v_perm_b32 v163, v74, v74, v87
    s_setprio 3
    v_mfma_f32_16x16x32_bf16 v[56:59], v[26:29], v[156:159], 0
    v_mfma_f32_16x16x32_bf16 v[60:63], v[36:39], v[156:159], 0
    s_setprio 0
    v_perm_b32 v164, v75, v75, v78
    v_perm_b32 v165, v75, v75, v79
    v_perm_b32 v166, v75, v75, v86
    v_perm_b32 v167, v75, v75, v87
    v_cvt_pk_bf16_f32 v168, v48, v49
    v_cvt_pk_bf16_f32 v169, v50, v51
    v_cvt_pk_bf16_f32 v170, v52, v53
    v_cvt_pk_bf16_f32 v171, v54, v55
    s_setprio 3
    v_mfma_f32_16x16x32_bf16 v[48:51], v[28:31], v[160:163], 0
    v_mfma_f32_16x16x32_bf16 v[52:55], v[38:41], v[160:163], 0
    s_load_dword s94, s[20:21], s39 offset:0xc0
    s_load_dword s94, s[20:21], s39 offset:0x100
    s_load_dword s94, s[20:21], s39 offset:0x140
    s_load_dword s94, s[20:21], s39 offset:0x180
    s_load_dword s94, s[20:21], s39 offset:0x1c0
    s_waitcnt vmcnt(1)
    s_barrier
    s_lshl1_add_u32 m0, s33, 81920
    s_nop 0
    buffer_load_dwordx4 v11, s[60:63], s83 offen lds
    s_setprio 0
    v_cvt_pk_bf16_f32 v172, v56, v57
    v_cvt_pk_bf16_f32 v173, v58, v59
    v_cvt_pk_bf16_f32 v174, v60, v61
    v_cvt_pk_bf16_f32 v175, v62, v63
    s_setprio 3
    v_mfma_f32_16x16x32_bf16 v[56:59], v[30:33], v[164:167], 0
    v_mfma_f32_16x16x32_bf16 v[60:63], v[40:43], v[164:167], 0
    s_setprio 0
    v_permlane16_swap_b32 v168, v170
    v_permlane16_swap_b32 v169, v171
    buffer_store_dwordx4 v[168:171], v0, s[68:71], s75 offen offset:0 sc1
    v_permlane16_swap_b32 v172, v174
    v_permlane16_swap_b32 v173, v175
    buffer_store_dwordx4 v[172:175], v0, s[68:71], s75 offen offset:1024 sc1
    v_cvt_pk_bf16_f32 v176, v48, v49
    v_cvt_pk_bf16_f32 v177, v50, v51
    v_cvt_pk_bf16_f32 v178, v52, v53
    v_cvt_pk_bf16_f32 v179, v54, v55
    v_cvt_pk_bf16_f32 v180, v56, v57
    v_cvt_pk_bf16_f32 v181, v58, v59
    v_cvt_pk_bf16_f32 v182, v60, v61
    v_cvt_pk_bf16_f32 v183, v62, v63
    v_permlane16_swap_b32 v176, v178
    v_permlane16_swap_b32 v177, v179
    buffer_store_dwordx4 v[176:179], v0, s[68:71], s75 offen offset:2048 sc1
    v_permlane16_swap_b32 v180, v182
    v_permlane16_swap_b32 v181, v183
    buffer_store_dwordx4 v[180:183], v0, s[68:71], s75 offen offset:3072 sc1
    s_lshl1_add_u32 m0, s33, 82944
    s_nop 0
    buffer_load_dwordx4 v12, s[60:63], s83 offen lds
    v_lshrrev_b32 v64, 4, v1
    v_bfe_u32 v65, v1, 2, 2
    v_and_b32 v66, 3, v1
    v_and_b32 v67, 15, v1
    v_lshrrev_b32 v68, 3, v1
    v_and_b32 v69, 7, v1
    s_lshl_b32 s85, s6, 2
    v_lshl_add_u32 v70, v64, 3, v65
    v_lshlrev_b32 v70, 7, v70
    s_lshl1_add_u32 m0, s33, 90112
    s_nop 0
    buffer_load_dwordx4 v11, s[64:67], s83 offen lds
    v_and_b32 v71, 1, v66
    v_lshl_add_u32 v70, v71, 3, v70
    v_add_u32 v70, 0, v70
    v_and_b32 v71, 2, v65
    v_and_b32 v72, 1, v64
    v_lshl_add_u32 v71, v72, 2, v71
    v_lshrrev_b32 v72, 1, v66
    v_xor_b32 v71, v71, v72
    v_xor_b32 v71, s85, v71
    v_xor_b32 v72, 0, v71
    v_lshl_add_u32 v80, v72, 4, v70
    v_add_u32 v82, 49152, v80
    v_add_u32 v84, 98304, v80
    v_xor_b32 v72, 2, v71
    v_lshl_add_u32 v81, v72, 4, v70
    v_add_u32 v83, 49152, v81
    s_lshl1_add_u32 m0, s33, 91136
    s_nop 0
    buffer_load_dwordx4 v12, s[64:67], s83 offen lds
    s_add_u32 s83, s83, 131072
    v_add_u32 v85, 98304, v81
    s_lshl_b32 s85, s5, 12
    v_lshl_add_u32 v48, v1, 4, s85
    v_add_u32 v49, 49152, v48
    v_add_u32 v50, 98304, v48
    v_mov_b32 v88, 0
    v_mov_b32 v89, 0
    v_mov_b32 v90, 0
    v_mov_b32 v91, 0
    v_mov_b32 v92, 0
    v_mov_b32 v93, 0
    v_mov_b32 v94, 0
    v_mov_b32 v95, 0
    v_mov_b32 v96, 0
    v_mov_b32 v97, 0
    v_mov_b32 v98, 0
    v_mov_b32 v99, 0
    v_mov_b32 v100, 0
    v_mov_b32 v101, 0
    v_mov_b32 v102, 0
    v_mov_b32 v103, 0
    v_mov_b32 v104, 0
    v_mov_b32 v105, 0
    v_mov_b32 v106, 0
    v_mov_b32 v107, 0
    s_load_dword s94, s[20:21], s39 offset:0x80000
    s_load_dword s94, s[20:21], s39 offset:0x80040
    s_load_dword s94, s[20:21], s39 offset:0x80080
    s_load_dword s94, s[20:21], s39 offset:0x800c0
    s_load_dword s94, s[20:21], s39 offset:0x80100
    s_cmp_lg_u32 s4, 0
    s_cbranch_scc1 L_fH2
    s_lshl_b32 s91, s28, 4
    s_add_u32 s91, s91, s29
    s_lshl_b32 s91, s91, 7
    s_add_u32 s91, s91, 0x1e90000
    v_mov_b32 v16, s91
    v_mov_b32 v18, s100
    v_mov_b32 v19, s101
    s_mov_b64 exec, 1
    global_store_dwordx2 v16, v[18:19], s[26:27] sc1
    s_mov_b64 exec, -1
L_fH2:
    s_waitcnt vmcnt(8)
    s_mov_b64 exec, 3
    s_movk_i32 s98, 0x4000
L_pT_chk:
    v_cmp_ne_u64 vcc, s[100:101], v[20:21]
    s_nop 1
    s_cmp_eq_u64 vcc, 0
    s_cbranch_scc1 L_pT_ok
    s_sub_u32 s98, s98, 1
    s_cbranch_scc1 L_pT_ok
    s_sleep 1
    global_load_dwordx3 v[20:22], v23, s[26:27] sc1
    s_waitcnt vmcnt(0)
    s_branch L_pT_chk
L_pT_ok:
    s_mov_b64 exec, -1
    v_readlane_b32 s90, v22, 0
    v_readlane_b32 s91, v22, 1
    s_nop 1
    s_sub_u32 s90, s91, s90
    s_abs_i32 s91, s90
    s_min_u32 s91, s91, 0x1000
    s_add_u32 s91, s91, 35
    s_mul_i32 s91, s91, 937
    s_lshr_b32 s91, s91, 16
    s_min_u32 s91, s91, 4
    s_sub_u32 s92, 0, s91
    s_cmp_lt_i32 s90, 0
    s_cselect_b32 s91, s92, s91
    s_add_u32 s50, s91, 4
    s_and_b32 s91, s91, 3
    s_mov_b32 s46, 0x58458458
    s_mov_b32 s47, 0x4584584
    s_cmp_eq_u32 s91, 1
    s_cselect_b32 s46, 0xc22c22c4, s46
    s_cselect_b32 s47, 0x22c22c22, s47
    s_cmp_eq_u32 s91, 2
    s_cselect_b32 s46, 0x116222c4, s46
    s_cselect_b32 s47, 0x16116116, s47
    s_cmp_eq_u32 s91, 3
    s_cselect_b32 s46, 0x116222c4, s46
    s_cselect_b32 s47, 0x308b08b1, s47
    s_movk_i32 s44, 0x4000
    s_mov_b32 s45, 131072
    s_barrier
    s_lshl_b32 s48, s46, 15
    s_and_b32 s48, s48, 0x38000
    s_lshr_b64 s[46:47], s[46:47], 3
    s_lshl2_add_u32 m0, s33, s48
    s_lshl1_add_u32 s49, s33, s48
    buffer_load_dwordx4 v10, s[56:59], s82 offen offset:0 sc1 lds
    v_mov_b32 v108, 0
    v_mov_b32 v109, 0
    v_mov_b32 v110, 0
    v_mov_b32 v111, 0
    v_mov_b32 v112, 0
    v_mov_b32 v113, 0
    v_mov_b32 v114, 0
    v_mov_b32 v115, 0
    v_mov_b32 v116, 0
    v_mov_b32 v117, 0
    v_mov_b32 v118, 0
    v_mov_b32 v119, 0
    s_lshl_b32 s84, s4, 12
    s_add_u32 s84, s84, 147456
    v_lshl_add_u32 v3, v1, 3, s84
    v_lshrrev_b32 v70, 1, v64
    v_xor_b32 v70, v70, v65
    v_lshl_add_u32 v70, v70, 4, s84
    buffer_load_dwordx4 v10, s[56:59], s82 offen offset:1024 sc1 lds
    v_lshl_add_u32 v70, v67, 6, v70
    v_and_b32 v71, 1, v64
    v_lshl_add_u32 v14, v71, 3, v70
    v_xor_b32 v15, 32, v14
    v_xor_b32 v70, v66, v64
    v_lshl_add_u32 v70, v70, 4, s84
    v_lshrrev_b32 v71, 2, v1
    v_lshl_add_u32 v17, v71, 6, v70
    buffer_load_dwordx4 v10, s[56:59], s82 offen offset:2048 sc1 lds
    s_lshl_b32 s85, s4, 12
    v_lshl_add_u32 v72, v1, 4, s85
    s_lshl_b32 s85, s4, 4
    v_and_b32 v70, 2, v68
    v_xor_b32 v70, v70, v69
    v_xor_b32 v70, 0, v70
    v_add_u32 v71, s85, v68
    v_mul_u32_u24 v71, 2048, v71
    v_lshl_add_u32 v4, v70, 4, v71
    s_add_u32 s85, s85, 8
    v_and_b32 v70, 2, v68
    buffer_load_dwordx4 v10, s[56:59], s82 offen offset:3072 sc1 lds
    s_add_u32 s82, s82, s44
    v_xor_b32 v70, v70, v69
    v_xor_b32 v70, 4, v70
    v_add_u32 v71, s85, v68
    v_mul_u32_u24 v71, 2048, v71
    v_lshl_add_u32 v5, v70, 4, v71
    s_and_b32 s85, s31, 3
    s_lshl1_add_u32 s85, s85, s32
    s_cmp_eq_u32 s85, 3
    s_cselect_b64 vcc, -1, 0
    s_lshl_b32 s85, s4, 11
    v_lshl_add_u32 v70, v1, 4, s85
    v_add_u32 v71, 1024, v70
    s_add_u32 m0, s49, 16384
    s_nop 0
    buffer_load_dwordx4 v11, s[60:63], s83 offen lds
    v_cndmask_b32 v4, v4, v70, vcc
    v_cndmask_b32 v5, v5, v71, vcc
    s_mov_b32 s72, s8
    s_mov_b32 s73, s9
    s_mov_b32 s74, 0x400000
    s_mov_b32 s75, 0x20000
    s_add_u32 m0, s49, 17408
    s_nop 0
    buffer_load_dwordx4 v12, s[60:63], s83 offen lds
    s_add_u32 m0, s49, 24576
    s_nop 0
    buffer_load_dwordx4 v11, s[64:67], s83 offen lds
    s_add_u32 m0, s49, 25600
    s_nop 0
    buffer_load_dwordx4 v12, s[64:67], s83 offen lds
    s_add_u32 s83, s83, s45
    s_load_dword s94, s[20:21], s39 offset:0x80140
    s_load_dword s94, s[20:21], s39 offset:0x80180
    s_load_dword s94, s[20:21], s39 offset:0x801c0
    s_add_u32 s39, s39, 0x180000
    s_load_dword s94, s[20:21], s39 offset:0x0
    s_load_dword s94, s[20:21], s39 offset:0x40
    s_barrier
    s_lshl_b32 s48, s46, 15
    s_and_b32 s48, s48, 0x38000
    s_lshr_b64 s[46:47], s[46:47], 3
    s_lshl2_add_u32 m0, s33, s48
    s_lshl1_add_u32 s49, s33, s48
    buffer_load_dwordx4 v10, s[56:59], s82 offen offset:0 sc1 lds
    buffer_load_dwordx4 v10, s[56:59], s82 offen offset:1024 sc1 lds
    buffer_load_dwordx4 v10, s[56:59], s82 offen offset:2048 sc1 lds
    buffer_load_dwordx4 v10, s[56:59], s82 offen offset:3072 sc1 lds
    s_add_u32 s82, s82, s44
    s_add_u32 m0, s49, 16384
    s_nop 0
    buffer_load_dwordx4 v11, s[60:63], s83 offen lds
    s_add_u32 m0, s49, 17408
    s_nop 0
    buffer_load_dwordx4 v12, s[60:63], s83 offen lds
    s_add_u32 m0, s49, 24576
    s_nop 0
    buffer_load_dwordx4 v11, s[64:67], s83 offen lds
    s_add_u32 m0, s49, 25600
    s_nop 0
    buffer_load_dwordx4 v12, s[64:67], s83 offen lds
    s_add_u32 s83, s83, s45
    s_load_dword s94, s[20:21], s39 offset:0x80
    s_load_dword s94, s[20:21], s39 offset:0xc0
    s_load_dword s94, s[20:21], s39 offset:0x100
    s_load_dword s94, s[20:21], s39 offset:0x140
    s_load_dword s94, s[20:21], s39 offset:0x180
    s_waitcnt vmcnt(16)
    s_barrier
    s_lshl_b32 s48, s46, 15
    s_and_b32 s48, s48, 0x38000
    s_lshr_b64 s[46:47], s[46:47], 3
    s_lshl2_add_u32 m0, s33, s48
    s_lshl1_add_u32 s49, s33, s48
    buffer_load_dwordx4 v10, s[56:59], s82 offen offset:0 sc1 lds
    buffer_load_dwordx4 v10, s[56:59], s82 offen offset:1024 sc1 lds
    buffer_load_dwordx4 v10, s[56:59], s82 offen offset:2048 sc1 lds
    buffer_load_dwordx4 v10, s[56:59], s82 offen offset:3072 sc1 lds
    s_add_u32 s82, s82, s44
    s_add_u32 m0, s49, 16384
    s_nop 0
    buffer_load_dwordx4 v11, s[60:63], s83 offen lds
    s_add_u32 m0, s49, 17408
    s_nop 0
    buffer_load_dwordx4 v12, s[60:63], s83 offen lds
    s_add_u32 m0, s49, 24576
    s_nop 0
    buffer_load_dwordx4 v11, s[64:67], s83 offen lds
    s_add_u32 m0, s49, 25600
    s_nop 0
    buffer_load_dwordx4 v12, s[64:67], s83 offen lds
    s_add_u32 s83, s83, s45
    s_load_dword s94, s[20:21], s39 offset:0x1c0
    s_add_u32 s39, s39, 0xfff80000
    s_load_dword s94, s[20:21], s39 offset:0x0
    s_load_dword s94, s[20:21], s39 offset:0x40
    s_load_dword s94, s[20:21], s39 offset:0x80
    s_load_dword s94, s[20:21], s39 offset:0xc0
    s_waitcnt vmcnt(16)
    s_barrier
    s_lshl_b32 s48, s46, 15
    s_and_b32 s48, s48, 0x38000
    s_lshr_b64 s[46:47], s[46:47], 3
    s_lshl2_add_u32 m0, s33, s48
    s_lshl1_add_u32 s49, s33, s48
    buffer_load_dwordx4 v10, s[56:59], s82 offen offset:0 sc1 lds
    buffer_load_dwordx4 v10, s[56:59], s82 offen offset:1024 sc1 lds
    buffer_load_dwordx4 v10, s[56:59], s82 offen offset:2048 sc1 lds
    buffer_load_dwordx4 v10, s[56:59], s82 offen offset:3072 sc1 lds
    s_add_u32 s82, s82, s44
    s_add_u32 m0, s49, 16384
    s_nop 0
    buffer_load_dwordx4 v11, s[60:63], s83 offen lds
    s_add_u32 m0, s49, 17408
    s_nop 0
    buffer_load_dwordx4 v12, s[60:63], s83 offen lds
    s_add_u32 m0, s49, 24576
    s_nop 0
    buffer_load_dwordx4 v11, s[64:67], s83 offen lds
    s_add_u32 m0, s49, 25600
    s_nop 0
    buffer_load_dwordx4 v12, s[64:67], s83 offen lds
    s_add_u32 s83, s83, s45
    s_load_dword s94, s[20:21], s39 offset:0x100
    s_load_dword s94, s[20:21], s39 offset:0x140
    s_load_dword s94, s[20:21], s39 offset:0x180
    s_load_dword s94, s[20:21], s39 offset:0x1c0
    s_add_u32 s39, s39, 0x100000
    s_load_dword s94, s[20:21], s39 offset:0x0
    s_waitcnt vmcnt(16)
    s_barrier
    s_lshl_b32 s48, s46, 15
    s_and_b32 s48, s48, 0x38000
    s_lshr_b64 s[46:47], s[46:47], 3
    s_lshl2_add_u32 m0, s33, s48
    s_lshl1_add_u32 s49, s33, s48
    buffer_load_dwordx4 v10, s[56:59], s82 offen offset:0 sc1 lds
    buffer_load_dwordx4 v10, s[56:59], s82 offen offset:1024 sc1 lds
    buffer_load_dwordx4 v10, s[56:59], s82 offen offset:2048 sc1 lds
    buffer_load_dwordx4 v10, s[56:59], s82 offen offset:3072 sc1 lds
    s_add_u32 s82, s82, s44
    s_add_u32 m0, s49, 16384
    s_nop 0
    buffer_load_dwordx4 v11, s[60:63], s83 offen lds
    s_add_u32 m0, s49, 17408
    s_nop 0
    buffer_load_dwordx4 v12, s[60:63], s83 offen lds
    s_add_u32 m0, s49, 24576
    s_nop 0
    buffer_load_dwordx4 v11, s[64:67], s83 offen lds
    s_add_u32 m0, s49, 25600
    s_nop 0
    buffer_load_dwordx4 v12, s[64:67], s83 offen lds
    s_add_u32 s83, s83, s45
    s_load_dword s94, s[20:21], s39 offset:0x40
    s_load_dword s94, s[20:21], s39 offset:0x80
    s_load_dword s94, s[20:21], s39 offset:0xc0
    s_load_dword s94, s[20:21], s39 offset:0x100
    s_load_dword s94, s[20:21], s39 offset:0x140
    s_waitcnt vmcnt(43)
    s_waitcnt vmcnt(16)
    s_barrier
    s_lshl_b32 s48, s46, 15
    s_and_b32 s48, s48, 0x38000
    s_lshr_b64 s[46:47], s[46:47], 3
    s_lshl2_add_u32 m0, s33, s48
    s_lshl1_add_u32 s49, s33, s48
    buffer_load_dwordx4 v10, s[56:59], s82 offen offset:0 sc1 lds
    buffer_load_dwordx4 v10, s[56:59], s82 offen offset:1024 sc1 lds
    buffer_load_dwordx4 v10, s[56:59], s82 offen offset:2048 sc1 lds
    buffer_load_dwordx4 v10, s[56:59], s82 offen offset:3072 sc1 lds
    s_add_u32 s82, s82, s44
    s_add_u32 m0, s49, 16384
    s_nop 0
    buffer_load_dwordx4 v11, s[60:63], s83 offen lds
    s_add_u32 m0, s49, 17408
    s_nop 0
    buffer_load_dwordx4 v12, s[60:63], s83 offen lds
    s_add_u32 m0, s49, 24576
    s_nop 0
    buffer_load_dwordx4 v11, s[64:67], s83 offen lds
    s_add_u32 m0, s49, 25600
    s_nop 0
    buffer_load_dwordx4 v12, s[64:67], s83 offen lds
    s_add_u32 s83, s83, s45
    s_load_dword s94, s[20:21], s39 offset:0x180
    s_load_dword s94, s[20:21], s39 offset:0x1c0
    s_add_u32 s39, s39, 0xff980000
    s_load_dword s94, s[12:13], s39 offset:0x0
    s_load_dword s94, s[12:13], s39 offset:0x40
    s_load_dword s94, s[12:13], s39 offset:0x80
    s_lshl2_add_u32 s91, s30, s4
    s_lshl_b32 s91, s91, 9
    s_add_u32 s91, s91, 0x1e90000
    v_lshl_add_u32 v20, v1, 7, s91
    s_mov_b64 exec, 15
    global_load_dwordx2 v[22:23], v20, s[26:27] sc1
    s_mov_b64 exec, -1
    s_cmp_lg_u32 s4, 0
    s_cbranch_scc1 L_fO
    s_lshl_b32 s91, s28, 4
    s_add_u32 s91, s91, s29
    s_lshl_b32 s91, s91, 7
    s_add_u32 s91, s91, 0x1e98000
    v_mov_b32 v16, s91
    v_mov_b32 v18, s100
    v_mov_b32 v19, s101
    s_mov_b64 exec, 1
    global_store_dwordx2 v16, v[18:19], s[26:27] sc1
    s_mov_b64 exec, -1
L_fO:
    s_waitcnt vmcnt(17)
    s_barrier
    s_lshl_b32 s48, s46, 15
    s_and_b32 s48, s48, 0x38000
    s_lshr_b64 s[46:47], s[46:47], 3
    s_lshl2_add_u32 m0, s33, s48
    s_lshl1_add_u32 s49, s33, s48
    buffer_load_dwordx4 v10, s[56:59], s82 offen offset:0 sc1 lds
    buffer_load_dwordx4 v10, s[56:59], s82 offen offset:1024 sc1 lds
    buffer_load_dwordx4 v10, s[56:59], s82 offen offset:2048 sc1 lds
    buffer_load_dwordx4 v10, s[56:59], s82 offen offset:3072 sc1 lds
    s_add_u32 s82, s82, s44
    s_add_u32 m0, s49, 16384
    s_nop 0
    buffer_load_dwordx4 v11, s[60:63], s83 offen lds
    s_add_u32 m0, s49, 17408
    s_nop 0
    buffer_load_dwordx4 v12, s[60:63], s83 offen lds
    s_add_u32 m0, s49, 24576
    s_nop 0
    buffer_load_dwordx4 v11, s[64:67], s83 offen lds
    s_add_u32 m0, s49, 25600
    s_nop 0
    buffer_load_dwordx4 v12, s[64:67], s83 offen lds
    s_add_u32 s83, s83, s45
    s_load_dword s94, s[12:13], s39 offset:0xc0
    s_load_dword s94, s[12:13], s39 offset:0x100
    s_load_dword s94, s[12:13], s39 offset:0x140
    s_load_dword s94, s[12:13], s39 offset:0x180
    s_load_dword s94, s[12:13], s39 offset:0x1c0
    s_waitcnt vmcnt(17)
    s_barrier
    s_lshl_b32 s48, s46, 15
    s_and_b32 s48, s48, 0x38000
    s_lshr_b64 s[46:47], s[46:47], 3
    s_lshl2_add_u32 m0, s33, s48
    s_lshl1_add_u32 s49, s33, s48
    buffer_load_dwordx4 v10, s[56:59], s82 offen offset:0 sc1 lds
    buffer_load_dwordx4 v10, s[56:59], s82 offen offset:1024 sc1 lds
    buffer_load_dwordx4 v10, s[56:59], s82 offen offset:2048 sc1 lds
    buffer_load_dwordx4 v10, s[56:59], s82 offen offset:3072 sc1 lds
    s_add_u32 s82, s82, s44
    s_add_u32 m0, s49, 16384
    s_nop 0
    buffer_load_dwordx4 v11, s[60:63], s83 offen lds
    s_add_u32 m0, s49, 17408
    s_nop 0
    buffer_load_dwordx4 v12, s[60:63], s83 offen lds
    s_add_u32 m0, s49, 24576
    s_nop 0
    buffer_load_dwordx4 v11, s[64:67], s83 offen lds
    s_add_u32 m0, s49, 25600
    s_nop 0
    buffer_load_dwordx4 v12, s[64:67], s83 offen lds
    s_add_u32 s83, s83, s45
    s_load_dword s94, s[12:13], s39 offset:0x80000
    s_load_dword s94, s[12:13], s39 offset:0x80040
    s_load_dword s94, s[12:13], s39 offset:0x80080
    s_load_dword s94, s[12:13], s39 offset:0x800c0
    s_load_dword s94, s[12:13], s39 offset:0x80100
    s_waitcnt vmcnt(16)
    s_mov_b64 exec, 15
    s_movk_i32 s98, 0x4000
L_pH2_chk:
    v_cmp_ne_u64 vcc, s[100:101], v[22:23]
    s_nop 1
    s_cmp_eq_u64 vcc, 0
    s_cbranch_scc1 L_pH2_ok
    s_sub_u32 s98, s98, 1
    s_cbranch_scc1 L_pH2_ok
    s_sleep 1
    global_load_dwordx2 v[22:23], v20, s[26:27] sc1
    s_waitcnt vmcnt(0)
    s_branch L_pH2_chk
L_pH2_ok:
    s_mov_b64 exec, -1
    s_add_u32 s82, s82, s14
    s_add_u32 s83, s83, s35
    s_cmp_lg_u32 s32, 0
    s_cselect_b32 s44, 0xffffc000, s44
    s_lshl_b32 s45, s44, 3
    s_waitcnt vmcnt(17)
    s_barrier
    s_cmp_eq_u32 s50, 0
    s_cbranch_scc1 L_bl_end
L_bl:
    s_lshl_b32 s48, s46, 15
    s_and_b32 s48, s48, 0x38000
    s_lshr_b64 s[46:47], s[46:47], 3
    s_lshl2_add_u32 m0, s33, s48
    s_lshl1_add_u32 s49, s33, s48
    buffer_load_dwordx4 v10, s[56:59], s82 offen offset:0 sc1 lds
    buffer_load_dwordx4 v10, s[56:59], s82 offen offset:1024 sc1 lds
    buffer_load_dwordx4 v10, s[56:59], s82 offen offset:2048 sc1 lds
    buffer_load_dwordx4 v10, s[56:59], s82 offen offset:3072 sc1 lds
    s_add_u32 s82, s82, s44
    s_add_u32 m0, s49, 16384
    s_nop 0
    buffer_load_dwordx4 v11, s[60:63], s83 offen lds
    s_add_u32 m0, s49, 17408
    s_nop 0
    buffer_load_dwordx4 v12, s[60:63], s83 offen lds
    s_add_u32 m0, s49, 24576
    s_nop 0
    buffer_load_dwordx4 v11, s[64:67], s83 offen lds
    s_add_u32 m0, s49, 25600
    s_nop 0
    buffer_load_dwordx4 v12, s[64:67], s83 offen lds
    s_add_u32 s83, s83, s45
    s_sub_u32 s50, s50, 1
    s_cmp_lg_u32 s50, 0
    s_waitcnt vmcnt(16)
    s_barrier
    s_cbranch_scc1 L_bl
L_bl_end:
    s_lshl_b32 m0, s33, 2
    s_nop 0
    buffer_load_dwordx4 v10, s[56:59], s82 offen offset:0 sc1 lds
    buffer_load_dwordx4 v10, s[56:59], s82 offen offset:1024 sc1 lds
    buffer_load_dwordx4 v10, s[56:59], s82 offen offset:2048 sc1 lds
    buffer_load_dwordx4 v10, s[56:59], s82 offen offset:3072 sc1 lds
    s_add_u32 s82, s82, s44
    s_lshl1_add_u32 m0, s33, 16384
    s_nop 0
    buffer_load_dwordx4 v11, s[60:63], s83 offen lds
    s_lshl1_add_u32 m0, s33, 17408
    s_nop 0
    buffer_load_dwordx4 v12, s[60:63], s83 offen lds
    s_lshl1_add_u32 m0, s33, 24576
    s_nop 0
    buffer_load_dwordx4 v11, s[64:67], s83 offen lds
    s_lshl1_add_u32 m0, s33, 25600
    s_nop 0
    buffer_load_dwordx4 v12, s[64:67], s83 offen lds
    s_add_u32 s83, s83, s45
    s_load_dword s94, s[12:13], s39 offset:0x80140
    s_load_dword s94, s[12:13], s39 offset:0x80180
    s_load_dword s94, s[12:13], s39 offset:0x801c0
    s_add_u32 s39, s39, 0x100000
    s_load_dword s94, s[12:13], s39 offset:0x0
    s_load_dword s94, s[12:13], s39 offset:0x40
    s_waitcnt vmcnt(16)
    s_barrier
    s_lshl2_add_u32 m0, s33, 98304
    s_nop 0
    buffer_load_dwordx4 v10, s[56:59], s82 offen offset:0 sc1 lds
    buffer_load_dwordx4 v10, s[56:59], s82 offen offset:1024 sc1 lds
    buffer_load_dwordx4 v10, s[56:59], s82 offen offset:2048 sc1 lds
    buffer_load_dwordx4 v10, s[56:59], s82 offen offset:3072 sc1 lds
    s_add_u32 s82, s82, s44
    s_lshl1_add_u32 m0, s33, 114688
    s_nop 0
    buffer_load_dwordx4 v11, s[60:63], s83 offen lds
    s_lshl1_add_u32 m0, s33, 115712
    s_nop 0
    buffer_load_dwordx4 v12, s[60:63], s83 offen lds
    s_lshl1_add_u32 m0, s33, 122880
    s_nop 0
    buffer_load_dwordx4 v11, s[64:67], s83 offen lds
    s_lshl1_add_u32 m0, s33, 123904
    s_nop 0
    buffer_load_dwordx4 v12, s[64:67], s83 offen lds
    s_add_u32 s83, s83, s45
    s_load_dword s94, s[12:13], s39 offset:0x80
    s_load_dword s94, s[12:13], s39 offset:0xc0
    s_load_dword s94, s[12:13], s39 offset:0x100
    s_load_dword s94, s[12:13], s39 offset:0x140
    s_load_dword s94, s[12:13], s39 offset:0x180
    s_lshl2_add_u32 s91, s30, s4
    s_lshl_b32 s91, s91, 9
    s_add_u32 s91, s91, 0x1e98000
    v_lshl_add_u32 v20, v1, 7, s91
    s_mov_b64 exec, 15
    global_load_dwordx2 v[22:23], v20, s[26:27] sc1
    s_mov_b64 exec, -1
    s_waitcnt vmcnt(17)
    s_barrier
    s_lshl2_add_u32 m0, s33, 32768
    s_nop 0
    buffer_load_dwordx4 v10, s[56:59], s82 offen offset:0 sc1 lds
    buffer_load_dwordx4 v10, s[56:59], s82 offen offset:1024 sc1 lds
    buffer_load_dwordx4 v10, s[56:59], s82 offen offset:2048 sc1 lds
    buffer_load_dwordx4 v10, s[56:59], s82 offen offset:3072 sc1 lds
    s_add_u32 s82, s82, s44
    s_lshl1_add_u32 m0, s33, 49152
    s_nop 0
    buffer_load_dwordx4 v11, s[60:63], s83 offen lds
    s_lshl1_add_u32 m0, s33, 50176
    s_nop 0
    buffer_load_dwordx4 v12, s[60:63], s83 offen lds
    s_lshl1_add_u32 m0, s33, 57344
    s_nop 0
    buffer_load_dwordx4 v11, s[64:67], s83 offen lds
    s_lshl1_add_u32 m0, s33, 58368
    s_nop 0
    buffer_load_dwordx4 v12, s[64:67], s83 offen lds
    s_add_u32 s83, s83, s45
    s_load_dword s94, s[12:13], s39 offset:0x1c0
    s_load_dword s94, s[12:13], s39 offset:0x80000
    s_load_dword s94, s[12:13], s39 offset:0x80040
    s_load_dword s94, s[12:13], s39 offset:0x80080
    s_load_dword s94, s[12:13], s39 offset:0x800c0
    s_waitcnt vmcnt(17)
    s_barrier
    s_lshl2_add_u32 m0, s33, 65536
    s_nop 0
    buffer_load_dwordx4 v10, s[56:59], s82 offen offset:0 sc1 lds
    buffer_load_dwordx4 v10, s[56:59], s82 offen offset:1024 sc1 lds
    buffer_load_dwordx4 v10, s[56:59], s82 offen offset:2048 sc1 lds
    buffer_load_dwordx4 v10, s[56:59], s82 offen offset:3072 sc1 lds
    s_add_u32 s82, s82, s44
    s_lshl1_add_u32 m0, s33, 81920
    s_nop 0
    buffer_load_dwordx4 v11, s[60:63], s83 offen lds
    s_lshl1_add_u32 m0, s33, 82944
    s_nop 0
    buffer_load_dwordx4 v12, s[60:63], s83 offen lds
    s_lshl1_add_u32 m0, s33, 90112
    s_nop 0
    buffer_load_dwordx4 v11, s[64:67], s83 offen lds
    s_lshl1_add_u32 m0, s33, 91136
    s_nop 0
    buffer_load_dwordx4 v12, s[64:67], s83 offen lds
    s_add_u32 s83, s83, s45
    s_load_dword s94, s[12:13], s39 offset:0x80100
    s_load_dword s94, s[12:13], s39 offset:0x80140
    s_load_dword s94, s[12:13], s39 offset:0x80180
L_pad11:
    s_cbranch_execz L_vret2
    s_load_dword s94, s[12:13], s39 offset:0x801c0
    s_waitcnt vmcnt(16)
    s_mov_b64 exec, 15
    s_movk_i32 s98, 0x4000
L_pO_chk:
    v_cmp_ne_u64 vcc, s[100:101], v[22:23]
    s_nop 1
    s_cmp_eq_u64 vcc, 0
    s_cbranch_scc1 L_pO_ok
    s_sub_u32 s98, s98, 1
    s_cbranch_scc1 L_pO_ok
    s_sleep 1
    global_load_dwordx2 v[22:23], v20, s[26:27] sc1
    s_waitcnt vmcnt(0)
    s_branch L_pO_chk
L_pO_ok:
    s_mov_b64 exec, -1
    s_waitcnt vmcnt(17)
    s_barrier
    s_lshl_b32 s85, s31, 8
    s_lshl_b32 s86, s32, 7
    s_add_u32 s86, s85, s86
    s_xor_b32 s87, s86, 128
    s_lshr_b32 s91, s31, 2
    s_lshl1_add_u32 s91, s91, s32
    s_lshl_b32 s91, s91, 13
    s_add_u32 s91, s91, 0x2800000
    s_xor_b32 s85, s91, 8192
    s_and_b32 s92, s31, 3
    s_lshl1_add_u32 s92, s92, s32
    s_cmp_eq_u32 s92, 3
    s_cselect_b32 s86, s91, s86
    s_cselect_b32 s87, s85, s87
    s_cselect_b32 s91, 0x2a00000, 0
    s_cselect_b32 s92, s26, s12
    s_cselect_b32 s93, s27, s13
    s_max_u32 s91, s91, 2097152
    s_add_u32 s60, s92, s86
    s_addc_u32 s61, s93, 0
    s_sub_u32 s62, s91, s86
    s_mov_b32 s63, 0x20000
    s_add_u32 s56, s26, 0x1200000
    s_addc_u32 s57, s27, 0
    s_mov_b32 s58, 0x400000
    s_mov_b32 s59, 0x20000
    s_lshl_b32 s82, s30, 18
    s_mov_b32 s83, 0
    s_lshl_b32 m0, s33, 2
    s_nop 0
    buffer_load_dwordx4 v10, s[56:59], s82 offen offset:0 sc1 lds
    buffer_load_dwordx4 v10, s[56:59], s82 offen offset:1024 sc1 lds
    buffer_load_dwordx4 v10, s[56:59], s82 offen offset:2048 sc1 lds
    buffer_load_dwordx4 v10, s[56:59], s82 offen offset:3072 sc1 lds
    s_add_u32 s82, s82, 16384
    s_lshl1_add_u32 m0, s33, 16384
    s_nop 0
    buffer_load_dwordx4 v4, s[60:63], s83 offen lds
    s_lshl1_add_u32 m0, s33, 17408
    s_nop 0
    buffer_load_dwordx4 v5, s[60:63], s83 offen lds
    s_add_u32 s83, s83, 131072
    s_waitcnt vmcnt(14)
    s_barrier
    s_lshl2_add_u32 m0, s33, 98304
    s_nop 0
    buffer_load_dwordx4 v10, s[56:59], s82 offen offset:0 sc1 lds
    buffer_load_dwordx4 v10, s[56:59], s82 offen offset:1024 sc1 lds
    buffer_load_dwordx4 v10, s[56:59], s82 offen offset:2048 sc1 lds
    buffer_load_dwordx4 v10, s[56:59], s82 offen offset:3072 sc1 lds
    s_add_u32 s82, s82, 16384
    s_lshl1_add_u32 m0, s33, 114688
    s_nop 0
    buffer_load_dwordx4 v4, s[60:63], s83 offen lds
    s_lshl1_add_u32 m0, s33, 115712
    s_nop 0
    buffer_load_dwordx4 v5, s[60:63], s83 offen lds
    s_add_u32 s83, s83, 131072
    s_lshl2_add_u32 m0, s33, 122880
    s_nop 0
    buffer_load_dwordx4 v10, s[56:59], s82 offen offset:0 sc1 lds
    buffer_load_dwordx4 v10, s[56:59], s82 offen offset:1024 sc1 lds
    buffer_load_dwordx4 v10, s[56:59], s82 offen offset:2048 sc1 lds
    buffer_load_dwordx4 v10, s[56:59], s82 offen offset:3072 sc1 lds
    s_add_u32 s82, s82, 16384
    s_lshl1_add_u32 m0, s33, 139264
    s_nop 0
    buffer_load_dwordx4 v4, s[60:63], s83 offen lds
    s_lshl1_add_u32 m0, s33, 140288
    s_nop 0
    buffer_load_dwordx4 v5, s[60:63], s83 offen lds
    s_add_u32 s83, s83, 131072
    s_waitcnt vmcnt(18)
    s_barrier
    s_lshl2_add_u32 m0, s33, 24576
    s_nop 0
    buffer_load_dwordx4 v10, s[56:59], s82 offen offset:0 sc1 lds
    buffer_load_dwordx4 v10, s[56:59], s82 offen offset:1024 sc1 lds
    buffer_load_dwordx4 v10, s[56:59], s82 offen offset:2048 sc1 lds
    buffer_load_dwordx4 v10, s[56:59], s82 offen offset:3072 sc1 lds
    s_add_u32 s82, s82, 16384
    s_lshl1_add_u32 m0, s33, 40960
    s_nop 0
    buffer_load_dwordx4 v4, s[60:63], s83 offen lds
    s_lshl1_add_u32 m0, s33, 41984
    s_nop 0
    buffer_load_dwordx4 v5, s[60:63], s83 offen lds
    s_add_u32 s83, s83, 131072
    s_waitcnt vmcnt(18)
    s_barrier
    s_setprio 1
    ds_read_b64_tr_b16 v[40:41], v80 offset:16384
    ds_read_b64_tr_b16 v[42:43], v80 offset:16896
    ds_read_b128 v[24:27], v48 offset:0
    ds_read_b128 v[28:31], v48 offset:1024
    ds_read_b128 v[32:35], v48 offset:2048
    ds_read_b128 v[36:39], v48 offset:3072
    ds_read_b64_tr_b16 v[44:45], v81 offset:16384
    ds_read_b64_tr_b16 v[46:47], v81 offset:16896
    s_waitcnt lgkmcnt(5)
    v_mfma_f32_16x16x32_bf16 v[88:91], v[40:43], v[24:27], v[88:91]
    ds_read_b64_tr_b16 v[72:73], v80 offset:20480
    ds_read_b64_tr_b16 v[74:75], v80 offset:20992
    s_lshl2_add_u32 m0, s33, 49152
    s_waitcnt lgkmcnt(6)
    v_mfma_f32_16x16x32_bf16 v[92:95], v[40:43], v[28:31], v[92:95]
    buffer_load_dwordx4 v10, s[56:59], s82 offen offset:0 sc1 lds
    ds_read_b128 v[56:59], v48 offset:8192
    ds_read_b128 v[60:63], v48 offset:9216
    s_waitcnt lgkmcnt(7)
    v_mfma_f32_16x16x32_bf16 v[96:99], v[40:43], v[32:35], v[96:99]
    ds_read_b128 v[64:67], v48 offset:10240
    ds_read_b128 v[68:71], v48 offset:11264
    s_waitcnt lgkmcnt(8)
    v_mfma_f32_16x16x32_bf16 v[100:103], v[40:43], v[36:39], v[100:103]
    ds_read_b64_tr_b16 v[76:77], v81 offset:20480
    ds_read_b64_tr_b16 v[78:79], v81 offset:20992
    s_waitcnt lgkmcnt(8)
    v_mfma_f32_16x16x32_bf16 v[104:107], v[44:47], v[24:27], v[104:107]
    buffer_load_dwordx4 v10, s[56:59], s82 offen offset:1024 sc1 lds
    v_mfma_f32_16x16x32_bf16 v[108:111], v[44:47], v[28:31], v[108:111]
    v_mfma_f32_16x16x32_bf16 v[112:115], v[44:47], v[32:35], v[112:115]
    v_mfma_f32_16x16x32_bf16 v[116:119], v[44:47], v[36:39], v[116:119]
    s_waitcnt vmcnt(14) lgkmcnt(0)
    s_barrier
    v_mfma_f32_16x16x32_bf16 v[88:91], v[72:75], v[56:59], v[88:91]
    ds_read_b64_tr_b16 v[40:41], v84 offset:16384
    ds_read_b64_tr_b16 v[42:43], v84 offset:16896
    v_mfma_f32_16x16x32_bf16 v[92:95], v[72:75], v[60:63], v[92:95]
    buffer_load_dwordx4 v10, s[56:59], s82 offen offset:2048 sc1 lds
    ds_read_b128 v[24:27], v50 offset:0
    ds_read_b128 v[28:31], v50 offset:1024
    v_mfma_f32_16x16x32_bf16 v[96:99], v[72:75], v[64:67], v[96:99]
    ds_read_b128 v[32:35], v50 offset:2048
    v_mfma_f32_16x16x32_bf16 v[100:103], v[72:75], v[68:71], v[100:103]
    ds_read_b128 v[36:39], v50 offset:3072
    ds_read_b64_tr_b16 v[44:45], v85 offset:16384
    v_mfma_f32_16x16x32_bf16 v[104:107], v[76:79], v[56:59], v[104:107]
    buffer_load_dwordx4 v10, s[56:59], s82 offen offset:3072 sc1 lds
    s_add_u32 s82, s82, 16384
    ds_read_b64_tr_b16 v[46:47], v85 offset:16896
    v_mfma_f32_16x16x32_bf16 v[108:111], v[76:79], v[60:63], v[108:111]
    v_mfma_f32_16x16x32_bf16 v[112:115], v[76:79], v[64:67], v[112:115]
    v_mfma_f32_16x16x32_bf16 v[116:119], v[76:79], v[68:71], v[116:119]
    s_waitcnt lgkmcnt(5)
    v_mfma_f32_16x16x32_bf16 v[88:91], v[40:43], v[24:27], v[88:91]
    ds_read_b64_tr_b16 v[72:73], v84 offset:20480
    ds_read_b64_tr_b16 v[74:75], v84 offset:20992
    s_lshl1_add_u32 m0, s33, 65536
    s_waitcnt lgkmcnt(6)
    v_mfma_f32_16x16x32_bf16 v[92:95], v[40:43], v[28:31], v[92:95]
    buffer_load_dwordx4 v4, s[60:63], s83 offen lds
    ds_read_b128 v[56:59], v50 offset:8192
    ds_read_b128 v[60:63], v50 offset:9216
    s_waitcnt lgkmcnt(7)
    v_mfma_f32_16x16x32_bf16 v[96:99], v[40:43], v[32:35], v[96:99]
    ds_read_b128 v[64:67], v50 offset:10240
    ds_read_b128 v[68:71], v50 offset:11264
    s_waitcnt lgkmcnt(8)
    v_mfma_f32_16x16x32_bf16 v[100:103], v[40:43], v[36:39], v[100:103]
    ds_read_b64_tr_b16 v[76:77], v85 offset:20480
    ds_read_b64_tr_b16 v[78:79], v85 offset:20992
    s_lshl1_add_u32 m0, s33, 66560
    s_waitcnt lgkmcnt(8)
    v_mfma_f32_16x16x32_bf16 v[104:107], v[44:47], v[24:27], v[104:107]
    buffer_load_dwordx4 v5, s[60:63], s83 offen lds
    s_add_u32 s83, s83, 131072
    v_mfma_f32_16x16x32_bf16 v[108:111], v[44:47], v[28:31], v[108:111]
    v_mfma_f32_16x16x32_bf16 v[112:115], v[44:47], v[32:35], v[112:115]
    v_mfma_f32_16x16x32_bf16 v[116:119], v[44:47], v[36:39], v[116:119]
    s_waitcnt vmcnt(12) lgkmcnt(0)
    s_barrier
    v_mfma_f32_16x16x32_bf16 v[88:91], v[72:75], v[56:59], v[88:91]
    ds_read_b64_tr_b16 v[40:41], v84 offset:40960
    ds_read_b64_tr_b16 v[42:43], v84 offset:41472
    s_lshl2_add_u32 m0, s33, 73728
    v_mfma_f32_16x16x32_bf16 v[92:95], v[72:75], v[60:63], v[92:95]
    buffer_load_dwordx4 v10, s[56:59], s82 offen offset:0 sc1 lds
    ds_read_b128 v[24:27], v50 offset:24576
    ds_read_b128 v[28:31], v50 offset:25600
    v_mfma_f32_16x16x32_bf16 v[96:99], v[72:75], v[64:67], v[96:99]
    ds_read_b128 v[32:35], v50 offset:26624
    v_mfma_f32_16x16x32_bf16 v[100:103], v[72:75], v[68:71], v[100:103]
    ds_read_b128 v[36:39], v50 offset:27648
    ds_read_b64_tr_b16 v[44:45], v85 offset:40960
    v_mfma_f32_16x16x32_bf16 v[104:107], v[76:79], v[56:59], v[104:107]
    buffer_load_dwordx4 v10, s[56:59], s82 offen offset:1024 sc1 lds
    ds_read_b64_tr_b16 v[46:47], v85 offset:41472
    v_mfma_f32_16x16x32_bf16 v[108:111], v[76:79], v[60:63], v[108:111]
    v_mfma_f32_16x16x32_bf16 v[112:115], v[76:79], v[64:67], v[112:115]
    v_mfma_f32_16x16x32_bf16 v[116:119], v[76:79], v[68:71], v[116:119]
    s_waitcnt lgkmcnt(5)
    v_mfma_f32_16x16x32_bf16 v[88:91], v[40:43], v[24:27], v[88:91]
    ds_read_b64_tr_b16 v[72:73], v84 offset:45056
    ds_read_b64_tr_b16 v[74:75], v84 offset:45568
    s_waitcnt lgkmcnt(6)
    v_mfma_f32_16x16x32_bf16 v[92:95], v[40:43], v[28:31], v[92:95]
    buffer_load_dwordx4 v10, s[56:59], s82 offen offset:2048 sc1 lds
    ds_read_b128 v[56:59], v50 offset:32768
    ds_read_b128 v[60:63], v50 offset:33792
    s_waitcnt lgkmcnt(7)
    v_mfma_f32_16x16x32_bf16 v[96:99], v[40:43], v[32:35], v[96:99]
    ds_read_b128 v[64:67], v50 offset:34816
    ds_read_b128 v[68:71], v50 offset:35840
    s_waitcnt lgkmcnt(8)
    v_mfma_f32_16x16x32_bf16 v[100:103], v[40:43], v[36:39], v[100:103]
    ds_read_b64_tr_b16 v[76:77], v85 offset:45056
    ds_read_b64_tr_b16 v[78:79], v85 offset:45568
    s_waitcnt lgkmcnt(8)
    v_mfma_f32_16x16x32_bf16 v[104:107], v[44:47], v[24:27], v[104:107]
    buffer_load_dwordx4 v10, s[56:59], s82 offen offset:3072 sc1 lds
    s_add_u32 s82, s82, 16384
    v_mfma_f32_16x16x32_bf16 v[108:111], v[44:47], v[28:31], v[108:111]
    v_mfma_f32_16x16x32_bf16 v[112:115], v[44:47], v[32:35], v[112:115]
    v_mfma_f32_16x16x32_bf16 v[116:119], v[44:47], v[36:39], v[116:119]
    s_waitcnt vmcnt(10) lgkmcnt(0)
    s_barrier
    v_mfma_f32_16x16x32_bf16 v[88:91], v[72:75], v[56:59], v[88:91]
    ds_read_b64_tr_b16 v[40:41], v80 offset:40960
    ds_read_b64_tr_b16 v[42:43], v80 offset:41472
    s_lshl1_add_u32 m0, s33, 90112
    v_mfma_f32_16x16x32_bf16 v[92:95], v[72:75], v[60:63], v[92:95]
    buffer_load_dwordx4 v4, s[60:63], s83 offen lds
    ds_read_b128 v[24:27], v48 offset:24576
    ds_read_b128 v[28:31], v48 offset:25600
    v_mfma_f32_16x16x32_bf16 v[96:99], v[72:75], v[64:67], v[96:99]
    ds_read_b128 v[32:35], v48 offset:26624
    v_mfma_f32_16x16x32_bf16 v[100:103], v[72:75], v[68:71], v[100:103]
    ds_read_b128 v[36:39], v48 offset:27648
    ds_read_b64_tr_b16 v[44:45], v81 offset:40960
    s_lshl1_add_u32 m0, s33, 91136
    v_mfma_f32_16x16x32_bf16 v[104:107], v[76:79], v[56:59], v[104:107]
    buffer_load_dwordx4 v5, s[60:63], s83 offen lds
    s_add_u32 s83, s83, 131072
    ds_read_b64_tr_b16 v[46:47], v81 offset:41472
    v_mfma_f32_16x16x32_bf16 v[108:111], v[76:79], v[60:63], v[108:111]
    v_mfma_f32_16x16x32_bf16 v[112:115], v[76:79], v[64:67], v[112:115]
    v_mfma_f32_16x16x32_bf16 v[116:119], v[76:79], v[68:71], v[116:119]
    s_waitcnt lgkmcnt(5)
    v_mfma_f32_16x16x32_bf16 v[88:91], v[40:43], v[24:27], v[88:91]
    ds_read_b64_tr_b16 v[72:73], v80 offset:45056
    ds_read_b64_tr_b16 v[74:75], v80 offset:45568
    s_lshl_b32 m0, s33, 2
    s_waitcnt lgkmcnt(6)
    v_mfma_f32_16x16x32_bf16 v[92:95], v[40:43], v[28:31], v[92:95]
    buffer_load_dwordx4 v10, s[56:59], s82 offen offset:0 sc1 lds
    ds_read_b128 v[56:59], v48 offset:32768
    ds_read_b128 v[60:63], v48 offset:33792
    s_waitcnt lgkmcnt(7)
    v_mfma_f32_16x16x32_bf16 v[96:99], v[40:43], v[32:35], v[96:99]
    ds_read_b128 v[64:67], v48 offset:34816
    ds_read_b128 v[68:71], v48 offset:35840
    s_waitcnt lgkmcnt(8)
    v_mfma_f32_16x16x32_bf16 v[100:103], v[40:43], v[36:39], v[100:103]
    buffer_load_dwordx4 v10, s[56:59], s82 offen offset:1024 sc1 lds
    ds_read_b64_tr_b16 v[76:77], v81 offset:45056
    ds_read_b64_tr_b16 v[78:79], v81 offset:45568
    s_waitcnt lgkmcnt(8)
    v_mfma_f32_16x16x32_bf16 v[104:107], v[44:47], v[24:27], v[104:107]
    v_mfma_f32_16x16x32_bf16 v[108:111], v[44:47], v[28:31], v[108:111]
    buffer_load_dwordx4 v10, s[56:59], s82 offen offset:2048 sc1 lds
    v_mfma_f32_16x16x32_bf16 v[112:115], v[44:47], v[32:35], v[112:115]
    v_mfma_f32_16x16x32_bf16 v[116:119], v[44:47], v[36:39], v[116:119]
    s_waitcnt vmcnt(9) lgkmcnt(0)
    s_barrier
    v_mfma_f32_16x16x32_bf16 v[88:91], v[72:75], v[56:59], v[88:91]
    ds_read_b64_tr_b16 v[40:41], v82 offset:16384
    ds_read_b64_tr_b16 v[42:43], v82 offset:16896
    v_mfma_f32_16x16x32_bf16 v[92:95], v[72:75], v[60:63], v[92:95]
    buffer_load_dwordx4 v10, s[56:59], s82 offen offset:3072 sc1 lds
    s_add_u32 s82, s82, 16384
    ds_read_b128 v[24:27], v49 offset:0
    ds_read_b128 v[28:31], v49 offset:1024
    v_mfma_f32_16x16x32_bf16 v[96:99], v[72:75], v[64:67], v[96:99]
    ds_read_b128 v[32:35], v49 offset:2048
    s_lshl1_add_u32 m0, s33, 16384
    v_mfma_f32_16x16x32_bf16 v[100:103], v[72:75], v[68:71], v[100:103]
    buffer_load_dwordx4 v4, s[60:63], s83 offen lds
    ds_read_b128 v[36:39], v49 offset:3072
    ds_read_b64_tr_b16 v[44:45], v83 offset:16384
    v_mfma_f32_16x16x32_bf16 v[104:107], v[76:79], v[56:59], v[104:107]
    ds_read_b64_tr_b16 v[46:47], v83 offset:16896
    s_lshl1_add_u32 m0, s33, 17408
    v_mfma_f32_16x16x32_bf16 v[108:111], v[76:79], v[60:63], v[108:111]
    buffer_load_dwordx4 v5, s[60:63], s83 offen lds
    s_add_u32 s83, s83, 131072
    v_mfma_f32_16x16x32_bf16 v[112:115], v[76:79], v[64:67], v[112:115]
    v_mfma_f32_16x16x32_bf16 v[116:119], v[76:79], v[68:71], v[116:119]
    s_waitcnt lgkmcnt(5)
    v_mfma_f32_16x16x32_bf16 v[88:91], v[40:43], v[24:27], v[88:91]
    ds_read_b64_tr_b16 v[72:73], v82 offset:20480
    ds_read_b64_tr_b16 v[74:75], v82 offset:20992
    s_lshl2_add_u32 m0, s33, 98304
    s_waitcnt lgkmcnt(6)
    v_mfma_f32_16x16x32_bf16 v[92:95], v[40:43], v[28:31], v[92:95]
    buffer_load_dwordx4 v10, s[56:59], s82 offen offset:0 sc1 lds
    ds_read_b128 v[56:59], v49 offset:8192
    ds_read_b128 v[60:63], v49 offset:9216
    s_waitcnt lgkmcnt(7)
    v_mfma_f32_16x16x32_bf16 v[96:99], v[40:43], v[32:35], v[96:99]
    ds_read_b128 v[64:67], v49 offset:10240
    ds_read_b128 v[68:71], v49 offset:11264
    s_waitcnt lgkmcnt(8)
    v_mfma_f32_16x16x32_bf16 v[100:103], v[40:43], v[36:39], v[100:103]
    buffer_load_dwordx4 v10, s[56:59], s82 offen offset:1024 sc1 lds
    ds_read_b64_tr_b16 v[76:77], v83 offset:20480
    ds_read_b64_tr_b16 v[78:79], v83 offset:20992
    s_waitcnt lgkmcnt(8)
    v_mfma_f32_16x16x32_bf16 v[104:107], v[44:47], v[24:27], v[104:107]
    v_mfma_f32_16x16x32_bf16 v[108:111], v[44:47], v[28:31], v[108:111]
    buffer_load_dwordx4 v10, s[56:59], s82 offen offset:2048 sc1 lds
    v_mfma_f32_16x16x32_bf16 v[112:115], v[44:47], v[32:35], v[112:115]
    v_mfma_f32_16x16x32_bf16 v[116:119], v[44:47], v[36:39], v[116:119]
    s_waitcnt vmcnt(9) lgkmcnt(0)
    s_barrier
    v_mfma_f32_16x16x32_bf16 v[88:91], v[72:75], v[56:59], v[88:91]
    ds_read_b64_tr_b16 v[40:41], v82 offset:40960
    ds_read_b64_tr_b16 v[42:43], v82 offset:41472
    v_mfma_f32_16x16x32_bf16 v[92:95], v[72:75], v[60:63], v[92:95]
    buffer_load_dwordx4 v10, s[56:59], s82 offen offset:3072 sc1 lds
    s_add_u32 s82, s82, 16384
    ds_read_b128 v[24:27], v49 offset:24576
    ds_read_b128 v[28:31], v49 offset:25600
    v_mfma_f32_16x16x32_bf16 v[96:99], v[72:75], v[64:67], v[96:99]
    ds_read_b128 v[32:35], v49 offset:26624
    s_lshl1_add_u32 m0, s33, 114688
    v_mfma_f32_16x16x32_bf16 v[100:103], v[72:75], v[68:71], v[100:103]
    buffer_load_dwordx4 v4, s[60:63], s83 offen lds
    ds_read_b128 v[36:39], v49 offset:27648
    ds_read_b64_tr_b16 v[44:45], v83 offset:40960
    v_mfma_f32_16x16x32_bf16 v[104:107], v[76:79], v[56:59], v[104:107]
    ds_read_b64_tr_b16 v[46:47], v83 offset:41472
    s_lshl1_add_u32 m0, s33, 115712
    v_mfma_f32_16x16x32_bf16 v[108:111], v[76:79], v[60:63], v[108:111]
    buffer_load_dwordx4 v5, s[60:63], s83 offen lds
    s_add_u32 s83, s83, 131072
    v_mfma_f32_16x16x32_bf16 v[112:115], v[76:79], v[64:67], v[112:115]
    v_mfma_f32_16x16x32_bf16 v[116:119], v[76:79], v[68:71], v[116:119]
    s_waitcnt lgkmcnt(5)
    v_mfma_f32_16x16x32_bf16 v[88:91], v[40:43], v[24:27], v[88:91]
    ds_read_b64_tr_b16 v[72:73], v82 offset:45056
    ds_read_b64_tr_b16 v[74:75], v82 offset:45568
    s_lshl2_add_u32 m0, s33, 122880
    s_waitcnt lgkmcnt(6)
    v_mfma_f32_16x16x32_bf16 v[92:95], v[40:43], v[28:31], v[92:95]
    buffer_load_dwordx4 v10, s[56:59], s82 offen offset:0 sc1 lds
    ds_read_b128 v[56:59], v49 offset:32768
    ds_read_b128 v[60:63], v49 offset:33792
    s_waitcnt lgkmcnt(7)
    v_mfma_f32_16x16x32_bf16 v[96:99], v[40:43], v[32:35], v[96:99]
    ds_read_b128 v[64:67], v49 offset:34816
    ds_read_b128 v[68:71], v49 offset:35840
    s_waitcnt lgkmcnt(8)
    v_mfma_f32_16x16x32_bf16 v[100:103], v[40:43], v[36:39], v[100:103]
    buffer_load_dwordx4 v10, s[56:59], s82 offen offset:1024 sc1 lds
    ds_read_b64_tr_b16 v[76:77], v83 offset:45056
    ds_read_b64_tr_b16 v[78:79], v83 offset:45568
    s_waitcnt lgkmcnt(8)
    v_mfma_f32_16x16x32_bf16 v[104:107], v[44:47], v[24:27], v[104:107]
    v_mfma_f32_16x16x32_bf16 v[108:111], v[44:47], v[28:31], v[108:111]
    buffer_load_dwordx4 v10, s[56:59], s82 offen offset:2048 sc1 lds
    v_mfma_f32_16x16x32_bf16 v[112:115], v[44:47], v[32:35], v[112:115]
    v_mfma_f32_16x16x32_bf16 v[116:119], v[44:47], v[36:39], v[116:119]
    s_waitcnt vmcnt(9) lgkmcnt(0)
    s_barrier
    v_mfma_f32_16x16x32_bf16 v[88:91], v[72:75], v[56:59], v[88:91]
    ds_read_b64_tr_b16 v[40:41], v80 offset:16384
    ds_read_b64_tr_b16 v[42:43], v80 offset:16896
    v_mfma_f32_16x16x32_bf16 v[92:95], v[72:75], v[60:63], v[92:95]
    buffer_load_dwordx4 v10, s[56:59], s82 offen offset:3072 sc1 lds
    s_add_u32 s82, s82, 16384
    ds_read_b128 v[24:27], v48 offset:0
    ds_read_b128 v[28:31], v48 offset:1024
    v_mfma_f32_16x16x32_bf16 v[96:99], v[72:75], v[64:67], v[96:99]
    ds_read_b128 v[32:35], v48 offset:2048
    s_lshl1_add_u32 m0, s33, 139264
    v_mfma_f32_16x16x32_bf16 v[100:103], v[72:75], v[68:71], v[100:103]
    buffer_load_dwordx4 v4, s[60:63], s83 offen lds
    ds_read_b128 v[36:39], v48 offset:3072
    ds_read_b64_tr_b16 v[44:45], v81 offset:16384
    v_mfma_f32_16x16x32_bf16 v[104:107], v[76:79], v[56:59], v[104:107]
    ds_read_b64_tr_b16 v[46:47], v81 offset:16896
    s_lshl1_add_u32 m0, s33, 140288
    v_mfma_f32_16x16x32_bf16 v[108:111], v[76:79], v[60:63], v[108:111]
    buffer_load_dwordx4 v5, s[60:63], s83 offen lds
    s_add_u32 s83, s83, 131072
    v_mfma_f32_16x16x32_bf16 v[112:115], v[76:79], v[64:67], v[112:115]
    v_mfma_f32_16x16x32_bf16 v[116:119], v[76:79], v[68:71], v[116:119]
    s_waitcnt lgkmcnt(5)
    v_mfma_f32_16x16x32_bf16 v[88:91], v[40:43], v[24:27], v[88:91]
    ds_read_b64_tr_b16 v[72:73], v80 offset:20480
    ds_read_b64_tr_b16 v[74:75], v80 offset:20992
    s_lshl2_add_u32 m0, s33, 24576
    s_waitcnt lgkmcnt(6)
    v_mfma_f32_16x16x32_bf16 v[92:95], v[40:43], v[28:31], v[92:95]
    buffer_load_dwordx4 v10, s[56:59], s82 offen offset:0 sc1 lds
    ds_read_b128 v[56:59], v48 offset:8192
    ds_read_b128 v[60:63], v48 offset:9216
    s_waitcnt lgkmcnt(7)
    v_mfma_f32_16x16x32_bf16 v[96:99], v[40:43], v[32:35], v[96:99]
    ds_read_b128 v[64:67], v48 offset:10240
    ds_read_b128 v[68:71], v48 offset:11264
    s_waitcnt lgkmcnt(8)
    v_mfma_f32_16x16x32_bf16 v[100:103], v[40:43], v[36:39], v[100:103]
    buffer_load_dwordx4 v10, s[56:59], s82 offen offset:1024 sc1 lds
    ds_read_b64_tr_b16 v[76:77], v81 offset:20480
    ds_read_b64_tr_b16 v[78:79], v81 offset:20992
    s_waitcnt lgkmcnt(8)
    v_mfma_f32_16x16x32_bf16 v[104:107], v[44:47], v[24:27], v[104:107]
    v_mfma_f32_16x16x32_bf16 v[108:111], v[44:47], v[28:31], v[108:111]
    buffer_load_dwordx4 v10, s[56:59], s82 offen offset:2048 sc1 lds
    v_mfma_f32_16x16x32_bf16 v[112:115], v[44:47], v[32:35], v[112:115]
    v_mfma_f32_16x16x32_bf16 v[116:119], v[44:47], v[36:39], v[116:119]
    s_waitcnt vmcnt(9) lgkmcnt(0)
    s_barrier
    v_mfma_f32_16x16x32_bf16 v[88:91], v[72:75], v[56:59], v[88:91]
    ds_read_b64_tr_b16 v[40:41], v84 offset:16384
    ds_read_b64_tr_b16 v[42:43], v84 offset:16896
    v_mfma_f32_16x16x32_bf16 v[92:95], v[72:75], v[60:63], v[92:95]
    buffer_load_dwordx4 v10, s[56:59], s82 offen offset:3072 sc1 lds
    s_add_u32 s82, s82, 16384
    ds_read_b128 v[24:27], v50 offset:0
    ds_read_b128 v[28:31], v50 offset:1024
    v_mfma_f32_16x16x32_bf16 v[96:99], v[72:75], v[64:67], v[96:99]
    ds_read_b128 v[32:35], v50 offset:2048
    s_lshl1_add_u32 m0, s33, 40960
    v_mfma_f32_16x16x32_bf16 v[100:103], v[72:75], v[68:71], v[100:103]
    buffer_load_dwordx4 v4, s[60:63], s83 offen lds
    ds_read_b128 v[36:39], v50 offset:3072
    ds_read_b64_tr_b16 v[44:45], v85 offset:16384
    v_mfma_f32_16x16x32_bf16 v[104:107], v[76:79], v[56:59], v[104:107]
    ds_read_b64_tr_b16 v[46:47], v85 offset:16896
    s_lshl1_add_u32 m0, s33, 41984
    v_mfma_f32_16x16x32_bf16 v[108:111], v[76:79], v[60:63], v[108:111]
    buffer_load_dwordx4 v5, s[60:63], s83 offen lds
    s_add_u32 s83, s83, 131072
    v_mfma_f32_16x16x32_bf16 v[112:115], v[76:79], v[64:67], v[112:115]
    v_mfma_f32_16x16x32_bf16 v[116:119], v[76:79], v[68:71], v[116:119]
    s_waitcnt lgkmcnt(5)
    v_mfma_f32_16x16x32_bf16 v[88:91], v[40:43], v[24:27], v[88:91]
    ds_read_b64_tr_b16 v[72:73], v84 offset:20480
    ds_read_b64_tr_b16 v[74:75], v84 offset:20992
    s_lshl2_add_u32 m0, s33, 49152
    s_waitcnt lgkmcnt(6)
    v_mfma_f32_16x16x32_bf16 v[92:95], v[40:43], v[28:31], v[92:95]
    buffer_load_dwordx4 v10, s[56:59], s82 offen offset:0 sc1 lds
    ds_read_b128 v[56:59], v50 offset:8192
    ds_read_b128 v[60:63], v50 offset:9216
    s_waitcnt lgkmcnt(7)
    v_mfma_f32_16x16x32_bf16 v[96:99], v[40:43], v[32:35], v[96:99]
    ds_read_b128 v[64:67], v50 offset:10240
    ds_read_b128 v[68:71], v50 offset:11264
    s_waitcnt lgkmcnt(8)
    v_mfma_f32_16x16x32_bf16 v[100:103], v[40:43], v[36:39], v[100:103]
    buffer_load_dwordx4 v10, s[56:59], s82 offen offset:1024 sc1 lds
    ds_read_b64_tr_b16 v[76:77], v85 offset:20480
    ds_read_b64_tr_b16 v[78:79], v85 offset:20992
    s_waitcnt lgkmcnt(8)
    v_mfma_f32_16x16x32_bf16 v[104:107], v[44:47], v[24:27], v[104:107]
    v_mfma_f32_16x16x32_bf16 v[108:111], v[44:47], v[28:31], v[108:111]
    buffer_load_dwordx4 v10, s[56:59], s82 offen offset:2048 sc1 lds
    v_mfma_f32_16x16x32_bf16 v[112:115], v[44:47], v[32:35], v[112:115]
    v_mfma_f32_16x16x32_bf16 v[116:119], v[44:47], v[36:39], v[116:119]
    s_waitcnt vmcnt(9) lgkmcnt(0)
    s_barrier
    v_mfma_f32_16x16x32_bf16 v[88:91], v[72:75], v[56:59], v[88:91]
    ds_read_b64_tr_b16 v[40:41], v84 offset:40960
    ds_read_b64_tr_b16 v[42:43], v84 offset:41472
    v_mfma_f32_16x16x32_bf16 v[92:95], v[72:75], v[60:63], v[92:95]
    buffer_load_dwordx4 v10, s[56:59], s82 offen offset:3072 sc1 lds
    s_add_u32 s82, s82, 16384
    ds_read_b128 v[24:27], v50 offset:24576
    ds_read_b128 v[28:31], v50 offset:25600
    v_mfma_f32_16x16x32_bf16 v[96:99], v[72:75], v[64:67], v[96:99]
    ds_read_b128 v[32:35], v50 offset:26624
    s_lshl1_add_u32 m0, s33, 65536
    v_mfma_f32_16x16x32_bf16 v[100:103], v[72:75], v[68:71], v[100:103]
    buffer_load_dwordx4 v4, s[60:63], s83 offen lds
    ds_read_b128 v[36:39], v50 offset:27648
    ds_read_b64_tr_b16 v[44:45], v85 offset:40960
    v_mfma_f32_16x16x32_bf16 v[104:107], v[76:79], v[56:59], v[104:107]
    ds_read_b64_tr_b16 v[46:47], v85 offset:41472
    s_lshl1_add_u32 m0, s33, 66560
    v_mfma_f32_16x16x32_bf16 v[108:111], v[76:79], v[60:63], v[108:111]
    buffer_load_dwordx4 v5, s[60:63], s83 offen lds
    s_add_u32 s83, s83, 131072
    v_mfma_f32_16x16x32_bf16 v[112:115], v[76:79], v[64:67], v[112:115]
    v_mfma_f32_16x16x32_bf16 v[116:119], v[76:79], v[68:71], v[116:119]
    s_waitcnt lgkmcnt(5)
    v_mfma_f32_16x16x32_bf16 v[88:91], v[40:43], v[24:27], v[88:91]
    ds_read_b64_tr_b16 v[72:73], v84 offset:45056
    ds_read_b64_tr_b16 v[74:75], v84 offset:45568
    s_lshl2_add_u32 m0, s33, 73728
    s_waitcnt lgkmcnt(6)
    v_mfma_f32_16x16x32_bf16 v[92:95], v[40:43], v[28:31], v[92:95]
    buffer_load_dwordx4 v10, s[56:59], s82 offen offset:0 sc1 lds
    ds_read_b128 v[56:59], v50 offset:32768
    ds_read_b128 v[60:63], v50 offset:33792
    s_waitcnt lgkmcnt(7)
    v_mfma_f32_16x16x32_bf16 v[96:99], v[40:43], v[32:35], v[96:99]
    ds_read_b128 v[64:67], v50 offset:34816
    ds_read_b128 v[68:71], v50 offset:35840
    s_waitcnt lgkmcnt(8)
    v_mfma_f32_16x16x32_bf16 v[100:103], v[40:43], v[36:39], v[100:103]
    buffer_load_dwordx4 v10, s[56:59], s82 offen offset:1024 sc1 lds
    ds_read_b64_tr_b16 v[76:77], v85 offset:45056
    ds_read_b64_tr_b16 v[78:79], v85 offset:45568
    s_waitcnt lgkmcnt(8)
    v_mfma_f32_16x16x32_bf16 v[104:107], v[44:47], v[24:27], v[104:107]
    v_mfma_f32_16x16x32_bf16 v[108:111], v[44:47], v[28:31], v[108:111]
    buffer_load_dwordx4 v10, s[56:59], s82 offen offset:2048 sc1 lds
    v_mfma_f32_16x16x32_bf16 v[112:115], v[44:47], v[32:35], v[112:115]
    v_mfma_f32_16x16x32_bf16 v[116:119], v[44:47], v[36:39], v[116:119]
    s_waitcnt vmcnt(9) lgkmcnt(0)
    s_barrier
    v_mfma_f32_16x16x32_bf16 v[88:91], v[72:75], v[56:59], v[88:91]
    ds_read_b64_tr_b16 v[40:41], v80 offset:40960
    ds_read_b64_tr_b16 v[42:43], v80 offset:41472
    v_mfma_f32_16x16x32_bf16 v[92:95], v[72:75], v[60:63], v[92:95]
    buffer_load_dwordx4 v10, s[56:59], s82 offen offset:3072 sc1 lds
    s_add_u32 s82, s82, 16384
    ds_read_b128 v[24:27], v48 offset:24576
    ds_read_b128 v[28:31], v48 offset:25600
    v_mfma_f32_16x16x32_bf16 v[96:99], v[72:75], v[64:67], v[96:99]
    ds_read_b128 v[32:35], v48 offset:26624
    s_lshl1_add_u32 m0, s33, 90112
    v_mfma_f32_16x16x32_bf16 v[100:103], v[72:75], v[68:71], v[100:103]
    buffer_load_dwordx4 v4, s[60:63], s83 offen lds
    ds_read_b128 v[36:39], v48 offset:27648
    ds_read_b64_tr_b16 v[44:45], v81 offset:40960
    v_mfma_f32_16x16x32_bf16 v[104:107], v[76:79], v[56:59], v[104:107]
    ds_read_b64_tr_b16 v[46:47], v81 offset:41472
    s_lshl1_add_u32 m0, s33, 91136
    v_mfma_f32_16x16x32_bf16 v[108:111], v[76:79], v[60:63], v[108:111]
    buffer_load_dwordx4 v5, s[60:63], s83 offen lds
    s_add_u32 s83, s83, 131072
    v_mfma_f32_16x16x32_bf16 v[112:115], v[76:79], v[64:67], v[112:115]
    v_mfma_f32_16x16x32_bf16 v[116:119], v[76:79], v[68:71], v[116:119]
    s_waitcnt lgkmcnt(5)
    v_mfma_f32_16x16x32_bf16 v[88:91], v[40:43], v[24:27], v[88:91]
    ds_read_b64_tr_b16 v[72:73], v80 offset:45056
    ds_read_b64_tr_b16 v[74:75], v80 offset:45568
    s_lshl_b32 m0, s33, 2
    s_waitcnt lgkmcnt(6)
    v_mfma_f32_16x16x32_bf16 v[92:95], v[40:43], v[28:31], v[92:95]
    buffer_load_dwordx4 v10, s[56:59], s82 offen offset:0 sc1 lds
    ds_read_b128 v[56:59], v48 offset:32768
    ds_read_b128 v[60:63], v48 offset:33792
    s_waitcnt lgkmcnt(7)
    v_mfma_f32_16x16x32_bf16 v[96:99], v[40:43], v[32:35], v[96:99]
    ds_read_b128 v[64:67], v48 offset:34816
    ds_read_b128 v[68:71], v48 offset:35840
    s_waitcnt lgkmcnt(8)
    v_mfma_f32_16x16x32_bf16 v[100:103], v[40:43], v[36:39], v[100:103]
    buffer_load_dwordx4 v10, s[56:59], s82 offen offset:1024 sc1 lds
    ds_read_b64_tr_b16 v[76:77], v81 offset:45056
L_pad12:
    s_cbranch_execz L_vret3
    ds_read_b64_tr_b16 v[78:79], v81 offset:45568
    s_waitcnt lgkmcnt(8)
    v_mfma_f32_16x16x32_bf16 v[104:107], v[44:47], v[24:27], v[104:107]
    v_mfma_f32_16x16x32_bf16 v[108:111], v[44:47], v[28:31], v[108:111]
    buffer_load_dwordx4 v10, s[56:59], s82 offen offset:2048 sc1 lds
    v_mfma_f32_16x16x32_bf16 v[112:115], v[44:47], v[32:35], v[112:115]
    v_mfma_f32_16x16x32_bf16 v[116:119], v[44:47], v[36:39], v[116:119]
    s_waitcnt vmcnt(9) lgkmcnt(0)
    s_barrier
    v_mfma_f32_16x16x32_bf16 v[88:91], v[72:75], v[56:59], v[88:91]
    ds_read_b64_tr_b16 v[40:41], v82 offset:16384
    ds_read_b64_tr_b16 v[42:43], v82 offset:16896
    v_mfma_f32_16x16x32_bf16 v[92:95], v[72:75], v[60:63], v[92:95]
    buffer_load_dwordx4 v10, s[56:59], s82 offen offset:3072 sc1 lds
    s_add_u32 s82, s82, 16384
    ds_read_b128 v[24:27], v49 offset:0
    ds_read_b128 v[28:31], v49 offset:1024
    v_mfma_f32_16x16x32_bf16 v[96:99], v[72:75], v[64:67], v[96:99]
    ds_read_b128 v[32:35], v49 offset:2048
    s_lshl1_add_u32 m0, s33, 16384
    v_mfma_f32_16x16x32_bf16 v[100:103], v[72:75], v[68:71], v[100:103]
    buffer_load_dwordx4 v4, s[60:63], s83 offen lds
    ds_read_b128 v[36:39], v49 offset:3072
    ds_read_b64_tr_b16 v[44:45], v83 offset:16384
    v_mfma_f32_16x16x32_bf16 v[104:107], v[76:79], v[56:59], v[104:107]
    ds_read_b64_tr_b16 v[46:47], v83 offset:16896
    s_lshl1_add_u32 m0, s33, 17408
    v_mfma_f32_16x16x32_bf16 v[108:111], v[76:79], v[60:63], v[108:111]
    buffer_load_dwordx4 v5, s[60:63], s83 offen lds
    s_add_u32 s83, s83, 131072
    v_mfma_f32_16x16x32_bf16 v[112:115], v[76:79], v[64:67], v[112:115]
    v_mfma_f32_16x16x32_bf16 v[116:119], v[76:79], v[68:71], v[116:119]
    s_waitcnt lgkmcnt(5)
    v_mfma_f32_16x16x32_bf16 v[88:91], v[40:43], v[24:27], v[88:91]
    ds_read_b64_tr_b16 v[72:73], v82 offset:20480
    ds_read_b64_tr_b16 v[74:75], v82 offset:20992
    s_lshl2_add_u32 m0, s33, 98304
    s_waitcnt lgkmcnt(6)
    v_mfma_f32_16x16x32_bf16 v[92:95], v[40:43], v[28:31], v[92:95]
    buffer_load_dwordx4 v10, s[56:59], s82 offen offset:0 sc1 lds
    ds_read_b128 v[56:59], v49 offset:8192
    ds_read_b128 v[60:63], v49 offset:9216
    s_waitcnt lgkmcnt(7)
    v_mfma_f32_16x16x32_bf16 v[96:99], v[40:43], v[32:35], v[96:99]
    ds_read_b128 v[64:67], v49 offset:10240
    ds_read_b128 v[68:71], v49 offset:11264
    s_waitcnt lgkmcnt(8)
    v_mfma_f32_16x16x32_bf16 v[100:103], v[40:43], v[36:39], v[100:103]
    buffer_load_dwordx4 v10, s[56:59], s82 offen offset:1024 sc1 lds
    ds_read_b64_tr_b16 v[76:77], v83 offset:20480
    ds_read_b64_tr_b16 v[78:79], v83 offset:20992
    s_waitcnt lgkmcnt(8)
    v_mfma_f32_16x16x32_bf16 v[104:107], v[44:47], v[24:27], v[104:107]
    v_mfma_f32_16x16x32_bf16 v[108:111], v[44:47], v[28:31], v[108:111]
    buffer_load_dwordx4 v10, s[56:59], s82 offen offset:2048 sc1 lds
    v_mfma_f32_16x16x32_bf16 v[112:115], v[44:47], v[32:35], v[112:115]
    v_mfma_f32_16x16x32_bf16 v[116:119], v[44:47], v[36:39], v[116:119]
    s_waitcnt vmcnt(9) lgkmcnt(0)
    s_barrier
    v_mfma_f32_16x16x32_bf16 v[88:91], v[72:75], v[56:59], v[88:91]
    ds_read_b64_tr_b16 v[40:41], v82 offset:40960
    ds_read_b64_tr_b16 v[42:43], v82 offset:41472
    v_mfma_f32_16x16x32_bf16 v[92:95], v[72:75], v[60:63], v[92:95]
    buffer_load_dwordx4 v10, s[56:59], s82 offen offset:3072 sc1 lds
    s_add_u32 s82, s82, 16384
    ds_read_b128 v[24:27], v49 offset:24576
    ds_read_b128 v[28:31], v49 offset:25600
    v_mfma_f32_16x16x32_bf16 v[96:99], v[72:75], v[64:67], v[96:99]
    ds_read_b128 v[32:35], v49 offset:26624
    s_lshl1_add_u32 m0, s33, 114688
    v_mfma_f32_16x16x32_bf16 v[100:103], v[72:75], v[68:71], v[100:103]
    buffer_load_dwordx4 v4, s[60:63], s83 offen lds
    ds_read_b128 v[36:39], v49 offset:27648
    ds_read_b64_tr_b16 v[44:45], v83 offset:40960
    v_mfma_f32_16x16x32_bf16 v[104:107], v[76:79], v[56:59], v[104:107]
    ds_read_b64_tr_b16 v[46:47], v83 offset:41472
    s_lshl1_add_u32 m0, s33, 115712
    v_mfma_f32_16x16x32_bf16 v[108:111], v[76:79], v[60:63], v[108:111]
    buffer_load_dwordx4 v5, s[60:63], s83 offen lds
    s_add_u32 s83, s83, 131072
    v_mfma_f32_16x16x32_bf16 v[112:115], v[76:79], v[64:67], v[112:115]
    v_mfma_f32_16x16x32_bf16 v[116:119], v[76:79], v[68:71], v[116:119]
    s_waitcnt lgkmcnt(5)
    v_mfma_f32_16x16x32_bf16 v[88:91], v[40:43], v[24:27], v[88:91]
    ds_read_b64_tr_b16 v[72:73], v82 offset:45056
    ds_read_b64_tr_b16 v[74:75], v82 offset:45568
    s_lshl2_add_u32 m0, s33, 122880
    s_waitcnt lgkmcnt(6)
    v_mfma_f32_16x16x32_bf16 v[92:95], v[40:43], v[28:31], v[92:95]
    buffer_load_dwordx4 v10, s[56:59], s82 offen offset:0 sc1 lds
    ds_read_b128 v[56:59], v49 offset:32768
    ds_read_b128 v[60:63], v49 offset:33792
    s_waitcnt lgkmcnt(7)
    v_mfma_f32_16x16x32_bf16 v[96:99], v[40:43], v[32:35], v[96:99]
    ds_read_b128 v[64:67], v49 offset:34816
    ds_read_b128 v[68:71], v49 offset:35840
    s_waitcnt lgkmcnt(8)
    v_mfma_f32_16x16x32_bf16 v[100:103], v[40:43], v[36:39], v[100:103]
    buffer_load_dwordx4 v10, s[56:59], s82 offen offset:1024 sc1 lds
    ds_read_b64_tr_b16 v[76:77], v83 offset:45056
    ds_read_b64_tr_b16 v[78:79], v83 offset:45568
    s_waitcnt lgkmcnt(8)
    v_mfma_f32_16x16x32_bf16 v[104:107], v[44:47], v[24:27], v[104:107]
    v_mfma_f32_16x16x32_bf16 v[108:111], v[44:47], v[28:31], v[108:111]
    buffer_load_dwordx4 v10, s[56:59], s82 offen offset:2048 sc1 lds
    v_mfma_f32_16x16x32_bf16 v[112:115], v[44:47], v[32:35], v[112:115]
    v_mfma_f32_16x16x32_bf16 v[116:119], v[44:47], v[36:39], v[116:119]
    s_waitcnt vmcnt(9) lgkmcnt(0)
    s_barrier
    v_mfma_f32_16x16x32_bf16 v[88:91], v[72:75], v[56:59], v[88:91]
    ds_read_b64_tr_b16 v[40:41], v80 offset:16384
    ds_read_b64_tr_b16 v[42:43], v80 offset:16896
    v_mfma_f32_16x16x32_bf16 v[92:95], v[72:75], v[60:63], v[92:95]
    buffer_load_dwordx4 v10, s[56:59], s82 offen offset:3072 sc1 lds
    s_add_u32 s82, s82, 16384
    ds_read_b128 v[24:27], v48 offset:0
    ds_read_b128 v[28:31], v48 offset:1024
    v_mfma_f32_16x16x32_bf16 v[96:99], v[72:75], v[64:67], v[96:99]
    ds_read_b128 v[32:35], v48 offset:2048
    s_lshl1_add_u32 m0, s33, 139264
    v_mfma_f32_16x16x32_bf16 v[100:103], v[72:75], v[68:71], v[100:103]
    buffer_load_dwordx4 v4, s[60:63], s83 offen lds
    ds_read_b128 v[36:39], v48 offset:3072
    ds_read_b64_tr_b16 v[44:45], v81 offset:16384
    v_mfma_f32_16x16x32_bf16 v[104:107], v[76:79], v[56:59], v[104:107]
    ds_read_b64_tr_b16 v[46:47], v81 offset:16896
    s_lshl1_add_u32 m0, s33, 140288
    v_mfma_f32_16x16x32_bf16 v[108:111], v[76:79], v[60:63], v[108:111]
    buffer_load_dwordx4 v5, s[60:63], s83 offen lds
    s_add_u32 s83, s83, 131072
    v_mfma_f32_16x16x32_bf16 v[112:115], v[76:79], v[64:67], v[112:115]
    v_mfma_f32_16x16x32_bf16 v[116:119], v[76:79], v[68:71], v[116:119]
    s_waitcnt lgkmcnt(5)
    v_mfma_f32_16x16x32_bf16 v[88:91], v[40:43], v[24:27], v[88:91]
    ds_read_b64_tr_b16 v[72:73], v80 offset:20480
    ds_read_b64_tr_b16 v[74:75], v80 offset:20992
    s_lshl2_add_u32 m0, s33, 24576
    s_waitcnt lgkmcnt(6)
    v_mfma_f32_16x16x32_bf16 v[92:95], v[40:43], v[28:31], v[92:95]
    buffer_load_dwordx4 v10, s[56:59], s82 offen offset:0 sc1 lds
    ds_read_b128 v[56:59], v48 offset:8192
    ds_read_b128 v[60:63], v48 offset:9216
    s_waitcnt lgkmcnt(7)
    v_mfma_f32_16x16x32_bf16 v[96:99], v[40:43], v[32:35], v[96:99]
    ds_read_b128 v[64:67], v48 offset:10240
    ds_read_b128 v[68:71], v48 offset:11264
    s_waitcnt lgkmcnt(8)
    v_mfma_f32_16x16x32_bf16 v[100:103], v[40:43], v[36:39], v[100:103]
    buffer_load_dwordx4 v10, s[56:59], s82 offen offset:1024 sc1 lds
    ds_read_b64_tr_b16 v[76:77], v81 offset:20480
    ds_read_b64_tr_b16 v[78:79], v81 offset:20992
    s_waitcnt lgkmcnt(8)
    v_mfma_f32_16x16x32_bf16 v[104:107], v[44:47], v[24:27], v[104:107]
    v_mfma_f32_16x16x32_bf16 v[108:111], v[44:47], v[28:31], v[108:111]
    buffer_load_dwordx4 v10, s[56:59], s82 offen offset:2048 sc1 lds
    v_mfma_f32_16x16x32_bf16 v[112:115], v[44:47], v[32:35], v[112:115]
    v_mfma_f32_16x16x32_bf16 v[116:119], v[44:47], v[36:39], v[116:119]
    s_waitcnt vmcnt(9) lgkmcnt(0)
    s_barrier
    v_mfma_f32_16x16x32_bf16 v[88:91], v[72:75], v[56:59], v[88:91]
    ds_read_b64_tr_b16 v[40:41], v84 offset:16384
    ds_read_b64_tr_b16 v[42:43], v84 offset:16896
    v_mfma_f32_16x16x32_bf16 v[92:95], v[72:75], v[60:63], v[92:95]
    buffer_load_dwordx4 v10, s[56:59], s82 offen offset:3072 sc1 lds
    s_add_u32 s82, s82, 16384
    ds_read_b128 v[24:27], v50 offset:0
    ds_read_b128 v[28:31], v50 offset:1024
    v_mfma_f32_16x16x32_bf16 v[96:99], v[72:75], v[64:67], v[96:99]
    ds_read_b128 v[32:35], v50 offset:2048
    s_lshl1_add_u32 m0, s33, 40960
    v_mfma_f32_16x16x32_bf16 v[100:103], v[72:75], v[68:71], v[100:103]
    buffer_load_dwordx4 v4, s[60:63], s83 offen lds
    ds_read_b128 v[36:39], v50 offset:3072
    ds_read_b64_tr_b16 v[44:45], v85 offset:16384
    v_mfma_f32_16x16x32_bf16 v[104:107], v[76:79], v[56:59], v[104:107]
    ds_read_b64_tr_b16 v[46:47], v85 offset:16896
    s_lshl1_add_u32 m0, s33, 41984
    v_mfma_f32_16x16x32_bf16 v[108:111], v[76:79], v[60:63], v[108:111]
    buffer_load_dwordx4 v5, s[60:63], s83 offen lds
    s_add_u32 s83, s83, 131072
    v_mfma_f32_16x16x32_bf16 v[112:115], v[76:79], v[64:67], v[112:115]
    v_mfma_f32_16x16x32_bf16 v[116:119], v[76:79], v[68:71], v[116:119]
    s_waitcnt lgkmcnt(5)
    v_mfma_f32_16x16x32_bf16 v[88:91], v[40:43], v[24:27], v[88:91]
    ds_read_b64_tr_b16 v[72:73], v84 offset:20480
    ds_read_b64_tr_b16 v[74:75], v84 offset:20992
    s_waitcnt lgkmcnt(6)
    v_mfma_f32_16x16x32_bf16 v[92:95], v[40:43], v[28:31], v[92:95]
    ds_read_b128 v[56:59], v50 offset:8192
    ds_read_b128 v[60:63], v50 offset:9216
    s_waitcnt lgkmcnt(7)
    v_mfma_f32_16x16x32_bf16 v[96:99], v[40:43], v[32:35], v[96:99]
    ds_read_b128 v[64:67], v50 offset:10240
    ds_read_b128 v[68:71], v50 offset:11264
    s_waitcnt lgkmcnt(8)
    v_mfma_f32_16x16x32_bf16 v[100:103], v[40:43], v[36:39], v[100:103]
    ds_read_b64_tr_b16 v[76:77], v85 offset:20480
    ds_read_b64_tr_b16 v[78:79], v85 offset:20992
    s_mov_b32 s84, 0
    s_waitcnt lgkmcnt(8)
    v_mfma_f32_16x16x32_bf16 v[104:107], v[44:47], v[24:27], v[104:107]
    buffer_load_dwordx4 v[120:123], v13, s[72:75], s84 offen
    v_mfma_f32_16x16x32_bf16 v[108:111], v[44:47], v[28:31], v[108:111]
    v_mfma_f32_16x16x32_bf16 v[112:115], v[44:47], v[32:35], v[112:115]
    s_mov_b32 s84, 32768
    v_mfma_f32_16x16x32_bf16 v[116:119], v[44:47], v[36:39], v[116:119]
    buffer_load_dwordx4 v[124:127], v13, s[72:75], s84 offen
    s_waitcnt vmcnt(8) lgkmcnt(0)
    s_barrier
    v_mfma_f32_16x16x32_bf16 v[88:91], v[72:75], v[56:59], v[88:91]
    ds_read_b64_tr_b16 v[40:41], v84 offset:40960
    ds_read_b64_tr_b16 v[42:43], v84 offset:41472
    v_mfma_f32_16x16x32_bf16 v[92:95], v[72:75], v[60:63], v[92:95]
    ds_read_b128 v[24:27], v50 offset:24576
    ds_read_b128 v[28:31], v50 offset:25600
    v_mfma_f32_16x16x32_bf16 v[96:99], v[72:75], v[64:67], v[96:99]
    ds_read_b128 v[32:35], v50 offset:26624
    v_mfma_f32_16x16x32_bf16 v[100:103], v[72:75], v[68:71], v[100:103]
    ds_read_b128 v[36:39], v50 offset:27648
    ds_read_b64_tr_b16 v[44:45], v85 offset:40960
    s_mov_b32 s84, 65536
    v_mfma_f32_16x16x32_bf16 v[104:107], v[76:79], v[56:59], v[104:107]
    ds_read_b64_tr_b16 v[46:47], v85 offset:41472
    buffer_load_dwordx4 v[128:131], v13, s[72:75], s84 offen
    v_mfma_f32_16x16x32_bf16 v[108:111], v[76:79], v[60:63], v[108:111]
    v_mfma_f32_16x16x32_bf16 v[112:115], v[76:79], v[64:67], v[112:115]
    s_mov_b32 s84, 98304
    v_mfma_f32_16x16x32_bf16 v[116:119], v[76:79], v[68:71], v[116:119]
    buffer_load_dwordx4 v[132:135], v13, s[72:75], s84 offen
    s_waitcnt lgkmcnt(5)
    v_mfma_f32_16x16x32_bf16 v[88:91], v[40:43], v[24:27], v[88:91]
    ds_read_b64_tr_b16 v[72:73], v84 offset:45056
    ds_read_b64_tr_b16 v[74:75], v84 offset:45568
    s_waitcnt lgkmcnt(6)
    v_mfma_f32_16x16x32_bf16 v[92:95], v[40:43], v[28:31], v[92:95]
    ds_read_b128 v[56:59], v50 offset:32768
    ds_read_b128 v[60:63], v50 offset:33792
    s_waitcnt lgkmcnt(7)
    v_mfma_f32_16x16x32_bf16 v[96:99], v[40:43], v[32:35], v[96:99]
    ds_read_b128 v[64:67], v50 offset:34816
    ds_read_b128 v[68:71], v50 offset:35840
    s_waitcnt lgkmcnt(8)
    v_mfma_f32_16x16x32_bf16 v[100:103], v[40:43], v[36:39], v[100:103]
    ds_read_b64_tr_b16 v[76:77], v85 offset:45056
    ds_read_b64_tr_b16 v[78:79], v85 offset:45568
    s_waitcnt lgkmcnt(8)
    v_mfma_f32_16x16x32_bf16 v[104:107], v[44:47], v[24:27], v[104:107]
    v_mfma_f32_16x16x32_bf16 v[108:111], v[44:47], v[28:31], v[108:111]
    v_mfma_f32_16x16x32_bf16 v[112:115], v[44:47], v[32:35], v[112:115]
    v_mfma_f32_16x16x32_bf16 v[116:119], v[44:47], v[36:39], v[116:119]
    s_waitcnt vmcnt(4) lgkmcnt(0)
    s_barrier
    v_mfma_f32_16x16x32_bf16 v[88:91], v[72:75], v[56:59], v[88:91]
    ds_read_b64_tr_b16 v[40:41], v80 offset:40960
    ds_read_b64_tr_b16 v[42:43], v80 offset:41472
    v_mfma_f32_16x16x32_bf16 v[92:95], v[72:75], v[60:63], v[92:95]
    ds_read_b128 v[24:27], v48 offset:24576
    ds_read_b128 v[28:31], v48 offset:25600
    v_mfma_f32_16x16x32_bf16 v[96:99], v[72:75], v[64:67], v[96:99]
    ds_read_b128 v[32:35], v48 offset:26624
    v_mfma_f32_16x16x32_bf16 v[100:103], v[72:75], v[68:71], v[100:103]
    ds_read_b128 v[36:39], v48 offset:27648
    ds_read_b64_tr_b16 v[44:45], v81 offset:40960
    v_mfma_f32_16x16x32_bf16 v[104:107], v[76:79], v[56:59], v[104:107]
    ds_read_b64_tr_b16 v[46:47], v81 offset:41472
    v_mfma_f32_16x16x32_bf16 v[108:111], v[76:79], v[60:63], v[108:111]
    ds_read_b64 v[168:169], v3 offset:0
    ds_read_b64 v[170:171], v3 offset:512
    ds_read_b64 v[172:173], v3 offset:1024
    v_mfma_f32_16x16x32_bf16 v[112:115], v[76:79], v[64:67], v[112:115]
    ds_read_b64 v[174:175], v3 offset:1536
    ds_read_b64 v[176:177], v3 offset:2048
    ds_read_b64 v[178:179], v3 offset:2560
    v_mfma_f32_16x16x32_bf16 v[116:119], v[76:79], v[68:71], v[116:119]
    ds_read_b64 v[180:181], v3 offset:3072
    ds_read_b64 v[182:183], v3 offset:3584
    s_waitcnt lgkmcnt(13)
    v_mfma_f32_16x16x32_bf16 v[88:91], v[40:43], v[24:27], v[88:91]
    ds_read_b64_tr_b16 v[72:73], v80 offset:45056
    ds_read_b64_tr_b16 v[74:75], v80 offset:45568
    s_waitcnt lgkmcnt(14)
    v_mfma_f32_16x16x32_bf16 v[92:95], v[40:43], v[28:31], v[92:95]
    ds_read_b128 v[56:59], v48 offset:32768
    ds_read_b128 v[60:63], v48 offset:33792
    s_waitcnt lgkmcnt(15)
    v_mfma_f32_16x16x32_bf16 v[96:99], v[40:43], v[32:35], v[96:99]
    ds_read_b128 v[64:67], v48 offset:34816
    ds_read_b128 v[68:71], v48 offset:35840
    s_waitcnt lgkmcnt(15)
    v_mfma_f32_16x16x32_bf16 v[100:103], v[40:43], v[36:39], v[100:103]
    ds_read_b64_tr_b16 v[76:77], v81 offset:45056
    ds_read_b64_tr_b16 v[78:79], v81 offset:45568
    s_waitcnt lgkmcnt(15)
    v_mfma_f32_16x16x32_bf16 v[104:107], v[44:47], v[24:27], v[104:107]
    v_lshlrev_b32 v184, 16, v168
    v_and_b32 v185, 0xffff0000, v168
    v_mfma_f32_16x16x32_bf16 v[108:111], v[44:47], v[28:31], v[108:111]
    v_lshlrev_b32 v186, 16, v169
    v_and_b32 v187, 0xffff0000, v169
    v_mfma_f32_16x16x32_bf16 v[112:115], v[44:47], v[32:35], v[112:115]
    s_waitcnt lgkmcnt(14)
    v_lshlrev_b32 v188, 16, v170
    v_and_b32 v189, 0xffff0000, v170
    v_mfma_f32_16x16x32_bf16 v[116:119], v[44:47], v[36:39], v[116:119]
    v_lshlrev_b32 v190, 16, v171
    v_and_b32 v191, 0xffff0000, v171
    s_waitcnt lgkmcnt(5)
    v_mfma_f32_16x16x32_bf16 v[88:91], v[72:75], v[56:59], v[88:91]
    v_lshlrev_b32 v192, 16, v172
    v_and_b32 v193, 0xffff0000, v172
    s_waitcnt lgkmcnt(4)
    v_mfma_f32_16x16x32_bf16 v[92:95], v[72:75], v[60:63], v[92:95]
    v_lshlrev_b32 v194, 16, v173
    v_and_b32 v195, 0xffff0000, v173
    s_waitcnt lgkmcnt(3)
    v_mfma_f32_16x16x32_bf16 v[96:99], v[72:75], v[64:67], v[96:99]
    v_lshlrev_b32 v196, 16, v174
    v_and_b32 v197, 0xffff0000, v174
    s_waitcnt lgkmcnt(2)
    v_mfma_f32_16x16x32_bf16 v[100:103], v[72:75], v[68:71], v[100:103]
    v_lshlrev_b32 v198, 16, v175
    v_and_b32 v199, 0xffff0000, v175
    s_waitcnt lgkmcnt(0)
    v_mfma_f32_16x16x32_bf16 v[104:107], v[76:79], v[56:59], v[104:107]
    s_mov_b32 s72, s22
    v_lshlrev_b32 v200, 16, v176
    v_and_b32 v201, 0xffff0000, v176
    v_mfma_f32_16x16x32_bf16 v[108:111], v[76:79], v[60:63], v[108:111]
    s_mov_b32 s73, s23
    v_lshlrev_b32 v202, 16, v177
    v_and_b32 v203, 0xffff0000, v177
    v_mfma_f32_16x16x32_bf16 v[112:115], v[76:79], v[64:67], v[112:115]
    s_mov_b32 s74, 0x400000
    v_lshlrev_b32 v204, 16, v178
    v_and_b32 v205, 0xffff0000, v178
    v_mfma_f32_16x16x32_bf16 v[116:119], v[76:79], v[68:71], v[116:119]
    s_mov_b32 s75, 0x20000
    v_lshlrev_b32 v206, 16, v179
    v_and_b32 v207, 0xffff0000, v179
    v_lshlrev_b32 v208, 16, v180
    v_and_b32 v209, 0xffff0000, v180
    v_lshlrev_b32 v210, 16, v181
    v_and_b32 v211, 0xffff0000, v181
    v_lshlrev_b32 v212, 16, v182
    v_and_b32 v213, 0xffff0000, v182
    v_lshlrev_b32 v214, 16, v183
    v_and_b32 v215, 0xffff0000, v183
    v_cvt_pk_bf16_f32 v40, v88, v89
    v_cvt_pk_bf16_f32 v41, v90, v91
    v_lshlrev_b32 v88, 16, v40
    v_and_b32 v89, 0xffff0000, v40
    v_lshlrev_b32 v90, 16, v41
    v_and_b32 v91, 0xffff0000, v41
    v_cvt_pk_bf16_f32 v42, v104, v105
    v_cvt_pk_bf16_f32 v43, v106, v107
    v_lshlrev_b32 v104, 16, v42
    v_and_b32 v105, 0xffff0000, v42
    v_lshlrev_b32 v106, 16, v43
    v_and_b32 v107, 0xffff0000, v43
    v_pk_mul_f32 v[88:89], v[88:89], v[184:185]
    v_pk_mul_f32 v[90:91], v[90:91], v[186:187]
    v_pk_mul_f32 v[104:105], v[104:105], v[200:201]
    v_pk_mul_f32 v[106:107], v[106:107], v[202:203]
    v_cvt_pk_bf16_f32 v88, v88, v89
    v_cvt_pk_bf16_f32 v89, v90, v91
    ds_write_b64 v14, v[88:89] offset:0
    v_cvt_pk_bf16_f32 v104, v104, v105
    v_cvt_pk_bf16_f32 v105, v106, v107
    ds_write_b64 v15, v[104:105] offset:0
    ds_read_b128 v[48:51], v17 offset:0
    v_cvt_pk_bf16_f32 v40, v92, v93
    v_cvt_pk_bf16_f32 v41, v94, v95
    v_lshlrev_b32 v92, 16, v40
    v_and_b32 v93, 0xffff0000, v40
    v_lshlrev_b32 v94, 16, v41
    v_and_b32 v95, 0xffff0000, v41
    v_cvt_pk_bf16_f32 v42, v108, v109
    v_cvt_pk_bf16_f32 v43, v110, v111
    v_lshlrev_b32 v108, 16, v42
    v_and_b32 v109, 0xffff0000, v42
    v_lshlrev_b32 v110, 16, v43
    v_and_b32 v111, 0xffff0000, v43
    v_pk_mul_f32 v[92:93], v[92:93], v[188:189]
    v_pk_mul_f32 v[94:95], v[94:95], v[190:191]
    v_pk_mul_f32 v[108:109], v[108:109], v[204:205]
    v_pk_mul_f32 v[110:111], v[110:111], v[206:207]
    v_cvt_pk_bf16_f32 v92, v92, v93
    v_cvt_pk_bf16_f32 v93, v94, v95
    ds_write_b64 v14, v[92:93] offset:1024
    v_cvt_pk_bf16_f32 v108, v108, v109
    v_cvt_pk_bf16_f32 v109, v110, v111
    ds_write_b64 v15, v[108:109] offset:1024
    ds_read_b128 v[52:55], v17 offset:1024
    s_waitcnt vmcnt(0)
    v_lshlrev_b32 v136, 16, v120
    v_and_b32 v137, 0xffff0000, v120
    v_lshlrev_b32 v138, 16, v121
    v_and_b32 v139, 0xffff0000, v121
    v_lshlrev_b32 v140, 16, v122
    v_and_b32 v141, 0xffff0000, v122
    v_lshlrev_b32 v142, 16, v123
    v_and_b32 v143, 0xffff0000, v123
    s_waitcnt lgkmcnt(3)
    v_lshlrev_b32 v24, 16, v48
    v_and_b32 v25, 0xffff0000, v48
    v_lshlrev_b32 v26, 16, v49
    v_and_b32 v27, 0xffff0000, v49
    v_lshlrev_b32 v28, 16, v50
    v_and_b32 v29, 0xffff0000, v50
    v_lshlrev_b32 v30, 16, v51
    v_and_b32 v31, 0xffff0000, v51
    v_pk_add_f32 v[24:25], v[24:25], v[136:137]
    v_pk_add_f32 v[26:27], v[26:27], v[138:139]
    v_pk_add_f32 v[28:29], v[28:29], v[140:141]
    v_pk_add_f32 v[30:31], v[30:31], v[142:143]
    v_cvt_pk_bf16_f32 v48, v24, v25
    v_cvt_pk_bf16_f32 v49, v26, v27
    v_cvt_pk_bf16_f32 v50, v28, v29
    v_cvt_pk_bf16_f32 v51, v30, v31
    s_mov_b32 s84, 0
    buffer_store_dwordx4 v[48:51], v13, s[72:75], s84 offen
    v_cvt_pk_bf16_f32 v40, v96, v97
    v_cvt_pk_bf16_f32 v41, v98, v99
    v_lshlrev_b32 v96, 16, v40
    v_and_b32 v97, 0xffff0000, v40
    v_lshlrev_b32 v98, 16, v41
    v_and_b32 v99, 0xffff0000, v41
    v_cvt_pk_bf16_f32 v42, v112, v113
    v_cvt_pk_bf16_f32 v43, v114, v115
    v_lshlrev_b32 v112, 16, v42
    v_and_b32 v113, 0xffff0000, v42
    v_lshlrev_b32 v114, 16, v43
    v_and_b32 v115, 0xffff0000, v43
    v_pk_mul_f32 v[96:97], v[96:97], v[192:193]
    v_pk_mul_f32 v[98:99], v[98:99], v[194:195]
    v_pk_mul_f32 v[112:113], v[112:113], v[208:209]
    v_pk_mul_f32 v[114:115], v[114:115], v[210:211]
    v_cvt_pk_bf16_f32 v96, v96, v97
    v_cvt_pk_bf16_f32 v97, v98, v99
    ds_write_b64 v14, v[96:97] offset:2048
    v_cvt_pk_bf16_f32 v112, v112, v113
    v_cvt_pk_bf16_f32 v113, v114, v115
    ds_write_b64 v15, v[112:113] offset:2048
    ds_read_b128 v[56:59], v17 offset:2048
    v_lshlrev_b32 v144, 16, v124
    v_and_b32 v145, 0xffff0000, v124
    v_lshlrev_b32 v146, 16, v125
    v_and_b32 v147, 0xffff0000, v125
    v_lshlrev_b32 v148, 16, v126
    v_and_b32 v149, 0xffff0000, v126
    v_lshlrev_b32 v150, 16, v127
    v_and_b32 v151, 0xffff0000, v127
    s_waitcnt lgkmcnt(3)
    v_lshlrev_b32 v24, 16, v52
    v_and_b32 v25, 0xffff0000, v52
    v_lshlrev_b32 v26, 16, v53
    v_and_b32 v27, 0xffff0000, v53
    v_lshlrev_b32 v28, 16, v54
    v_and_b32 v29, 0xffff0000, v54
    v_lshlrev_b32 v30, 16, v55
    v_and_b32 v31, 0xffff0000, v55
    v_pk_add_f32 v[24:25], v[24:25], v[144:145]
    v_pk_add_f32 v[26:27], v[26:27], v[146:147]
    v_pk_add_f32 v[28:29], v[28:29], v[148:149]
    v_pk_add_f32 v[30:31], v[30:31], v[150:151]
    v_cvt_pk_bf16_f32 v52, v24, v25
    v_cvt_pk_bf16_f32 v53, v26, v27
    v_cvt_pk_bf16_f32 v54, v28, v29
    v_cvt_pk_bf16_f32 v55, v30, v31
    s_mov_b32 s84, 32768
    buffer_store_dwordx4 v[52:55], v13, s[72:75], s84 offen
    v_cvt_pk_bf16_f32 v40, v100, v101
    v_cvt_pk_bf16_f32 v41, v102, v103
    v_lshlrev_b32 v100, 16, v40
    v_and_b32 v101, 0xffff0000, v40
    v_lshlrev_b32 v102, 16, v41
    v_and_b32 v103, 0xffff0000, v41
    v_cvt_pk_bf16_f32 v42, v116, v117
    v_cvt_pk_bf16_f32 v43, v118, v119
    v_lshlrev_b32 v116, 16, v42
    v_and_b32 v117, 0xffff0000, v42
    v_lshlrev_b32 v118, 16, v43
    v_and_b32 v119, 0xffff0000, v43
    v_pk_mul_f32 v[100:101], v[100:101], v[196:197]
    v_pk_mul_f32 v[102:103], v[102:103], v[198:199]
    v_pk_mul_f32 v[116:117], v[116:117], v[212:213]
    v_pk_mul_f32 v[118:119], v[118:119], v[214:215]
    v_cvt_pk_bf16_f32 v100, v100, v101
    v_cvt_pk_bf16_f32 v101, v102, v103
    ds_write_b64 v14, v[100:101] offset:3072
    v_cvt_pk_bf16_f32 v116, v116, v117
    v_cvt_pk_bf16_f32 v117, v118, v119
    ds_write_b64 v15, v[116:117] offset:3072
    ds_read_b128 v[60:63], v17 offset:3072
    v_lshlrev_b32 v152, 16, v128
    v_and_b32 v153, 0xffff0000, v128
    v_lshlrev_b32 v154, 16, v129
    v_and_b32 v155, 0xffff0000, v129
    v_lshlrev_b32 v156, 16, v130
    v_and_b32 v157, 0xffff0000, v130
    v_lshlrev_b32 v158, 16, v131
    v_and_b32 v159, 0xffff0000, v131
    s_waitcnt lgkmcnt(3)
    v_lshlrev_b32 v24, 16, v56
    v_and_b32 v25, 0xffff0000, v56
    v_lshlrev_b32 v26, 16, v57
    v_and_b32 v27, 0xffff0000, v57
    v_lshlrev_b32 v28, 16, v58
    v_and_b32 v29, 0xffff0000, v58
    v_lshlrev_b32 v30, 16, v59
    v_and_b32 v31, 0xffff0000, v59
    v_pk_add_f32 v[24:25], v[24:25], v[152:153]
    v_pk_add_f32 v[26:27], v[26:27], v[154:155]
    v_pk_add_f32 v[28:29], v[28:29], v[156:157]
    v_pk_add_f32 v[30:31], v[30:31], v[158:159]
    v_cvt_pk_bf16_f32 v56, v24, v25
    v_cvt_pk_bf16_f32 v57, v26, v27
    v_cvt_pk_bf16_f32 v58, v28, v29
    v_cvt_pk_bf16_f32 v59, v30, v31
    s_mov_b32 s84, 65536
    buffer_store_dwordx4 v[56:59], v13, s[72:75], s84 offen
    v_lshlrev_b32 v160, 16, v132
    v_and_b32 v161, 0xffff0000, v132
    v_lshlrev_b32 v162, 16, v133
    v_and_b32 v163, 0xffff0000, v133
    v_lshlrev_b32 v164, 16, v134
    v_and_b32 v165, 0xffff0000, v134
    v_lshlrev_b32 v166, 16, v135
    v_and_b32 v167, 0xffff0000, v135
    s_waitcnt lgkmcnt(0)
    v_lshlrev_b32 v24, 16, v60
    v_and_b32 v25, 0xffff0000, v60
    v_lshlrev_b32 v26, 16, v61
    v_and_b32 v27, 0xffff0000, v61
    v_lshlrev_b32 v28, 16, v62
    v_and_b32 v29, 0xffff0000, v62
    v_lshlrev_b32 v30, 16, v63
    v_and_b32 v31, 0xffff0000, v63
    v_pk_add_f32 v[24:25], v[24:25], v[160:161]
    v_pk_add_f32 v[26:27], v[26:27], v[162:163]
    v_pk_add_f32 v[28:29], v[28:29], v[164:165]
    v_pk_add_f32 v[30:31], v[30:31], v[166:167]
    v_cvt_pk_bf16_f32 v60, v24, v25
    v_cvt_pk_bf16_f32 v61, v26, v27
    v_cvt_pk_bf16_f32 v62, v28, v29
    v_cvt_pk_bf16_f32 v63, v30, v31
    s_mov_b32 s84, 98304
    buffer_store_dwordx4 v[60:63], v13, s[72:75], s84 offen
L_fin:
L_end:
    s_endpgm
L_code_end:
.section .rodata,"a"
.p2align 6
.amdhsa_kernel recurrent_scan__sliding_local_dilated__glu_gated_geglu__prompt_kernel
  .amdhsa_next_free_vgpr 256
  .amdhsa_next_free_sgpr 102
  .amdhsa_accum_offset 256
  .amdhsa_group_segment_fixed_size 0
  .amdhsa_kernarg_size 80
  .amdhsa_user_sgpr_count 2
  .amdhsa_user_sgpr_kernarg_segment_ptr 1
  .amdhsa_system_sgpr_workgroup_id_x 1
.end_amdhsa_kernel
```

```asm
; @launch grid=(256,1,1) block=(512,1,1) lds=163840
.amdgcn_target "amdgcn-amd-amdhsa--gfx950"
.text
.globl recurrent_scan__sliding_local_dilated__glu_gated_geglu__prompt_kernel
.p2align 12
.p2align 8
.type recurrent_scan__sliding_local_dilated__glu_gated_geglu__prompt_kernel,@function
recurrent_scan__sliding_local_dilated__glu_gated_geglu__prompt_kernel:
    s_cmp_ge_u32 s2, 256
    s_cbranch_scc1 L_end
    s_load_dwordx4 s[8:11], s[0:1], 0
    s_load_dwordx2 s[12:13], s[0:1], 16
    s_load_dwordx4 s[16:19], s[0:1], 32
    s_load_dwordx4 s[20:23], s[0:1], 48
    s_load_dwordx4 s[24:27], s[0:1], 64
    v_lshrrev_b32 v3, 6, v0
    v_and_b32 v1, 63, v0
    v_readfirstlane_b32 s3, v3
    s_and_b32 s84, s2, 7
    s_lshr_b32 s85, s2, 3
    s_mov_b32 s15, s85
    s_and_b32 s32, s84, 1
    s_lshl_b32 s86, s32, 3
    s_and_b32 s87, s85, 7
    s_add_u32 s28, s86, s87
    s_lshr_b32 s86, s84, 1
    s_lshl_b32 s86, s86, 2
    s_lshr_b32 s87, s85, 3
    s_add_u32 s29, s86, s87
    s_lshl_b32 s87, s32, 3
    s_xor_b32 s86, s86, s87
    s_and_b32 s87, s85, 3
    s_add_u32 s30, s86, s87
    s_lshr_b32 s31, s85, 2
    s_and_b32 s4, s3, 3
    s_lshr_b32 s5, s4, 1
    s_and_b32 s6, s4, 1
    s_lshr_b32 s7, s3, 2
    s_lshl_b32 s33, s4, 10
    s_mov_b64 exec, 0
    s_cmp_eq_u32 s3, 5
    s_cbranch_scc1 L_fan5
    s_cmp_eq_u32 s3, 6
    s_cbranch_scc1 L_fan6
    s_cmp_eq_u32 s3, 7
    s_cbranch_scc1 L_fan7
    s_cmp_lg_u32 s7, 0
    s_cbranch_scc1 L_teamB
L_teamA:
    s_mov_b64 exec, -1
    v_lshrrev_b32 v64, 4, v1
    v_bfe_u32 v65, v1, 2, 2
    v_and_b32 v66, 3, v1
    v_and_b32 v67, 15, v1
    v_lshrrev_b32 v68, 3, v1
    v_and_b32 v69, 7, v1
    s_lshl_b32 s85, s28, 7
    s_lshl_b32 s86, s4, 5
    s_add_u32 s86, s85, s86
    v_add_u32 v71, s86, v68
    v_xor_b32 v70, v69, v64
    v_lshlrev_b32 v70, 4, v70
    v_lshl_add_u32 v20, v71, 11, v70
    v_xor_b32 v21, 64, v20
    v_add_u32 v21, 16384, v21
    s_lshl_b32 s79, s4, 12
    s_and_b32 s72, s28, 3
    s_bitcmp1_b32 s28, 3
    s_cselect_b32 s91, 4, 0
    s_add_u32 s72, s72, s91
    s_mul_i32 s72, s72, 256
    s_sub_u32 s72, s72, 128
    s_lshl_b32 s85, s4, 3
    s_and_b32 s86, s4, 1
    s_lshl_b32 s86, s86, 2
    v_and_b32 v70, 2, v68
    v_xor_b32 v70, v70, v69
    v_xor_b32 v70, s86, v70
    v_add_u32 v71, s85, v68
    v_mul_u32_u24 v71, 7168, v71
    v_lshl_add_u32 v22, v70, 4, v71
    v_lshrrev_b32 v71, 2, v1
    s_lshl_b32 s86, s86, 2
    v_add_u32 v71, s86, v71
    v_mul_u32_u24 v71, 7168, v71
    v_and_b32 v70, 2, v64
    v_xor_b32 v70, v70, v66
    v_lshl_add_u32 v76, v70, 4, v71
    s_and_b32 s77, s28, 3
    s_bitcmp1_b32 s28, 3
    s_cselect_b32 s91, 4, 0
    s_add_u32 s77, s77, s91
    s_mul_i32 s77, s77, 917504
    s_add_u32 s77, s77, 0xfffc8000
    s_waitcnt lgkmcnt(0)
    s_mov_b32 s36, s8
    s_mov_b32 s37, s9
    s_mov_b32 s38, 0x400000
    s_mov_b32 s39, 0x20000
    s_add_u32 m0, s79, 116736
    s_add_u32 s72, s72, 128
    s_and_b32 s78, s72, 0x7ff
    buffer_load_dwordx4 v20, s[36:39], s78 offen lds
    s_add_u32 m0, s79, 117760
    s_nop 0
    buffer_load_dwordx4 v21, s[36:39], s78 offen lds
    s_add_u32 m0, s79, 118784
    s_add_u32 s78, s78, 32768
    buffer_load_dwordx4 v20, s[36:39], s78 offen lds
    s_add_u32 m0, s79, 119808
    s_nop 0
    buffer_load_dwordx4 v21, s[36:39], s78 offen lds
    s_mul_i32 s85, s29, 320
    s_and_b32 s86, s29, 1
    s_lshl_b32 s87, s86, 6
    s_add_u32 s87, s87, s85
    s_add_u32 s40, s16, s87
    s_addc_u32 s41, s17, 0
    s_sub_u32 s42, 7340032, s87
    s_mov_b32 s43, 0x20000
    s_add_u32 s44, s18, s87
    s_addc_u32 s45, s19, 0
    s_sub_u32 s46, 7340032, s87
    s_mov_b32 s47, 0x20000
    s_xor_b32 s86, s86, 1
    s_lshl_b32 s86, s86, 8
    s_add_u32 s87, s86, s85
    s_cmp_lt_u32 s4, 2
    s_cselect_b32 s88, s16, s18
    s_cselect_b32 s89, s17, s19
    s_add_u32 s48, s88, s87
    s_addc_u32 s49, s89, 0
    s_sub_u32 s50, 7340032, s87
    s_mov_b32 s51, 0x20000
    s_add_u32 m0, s33, 16384
    s_add_u32 s77, s77, 229376
    buffer_load_dwordx4 v22, s[40:43], s77 offen offset:0 lds
    s_add_u32 m0, s33, 20352
    s_nop 0
    buffer_load_dwordx4 v22, s[40:43], s77 offen offset:128 lds
    s_add_u32 m0, s33, 24576
    s_nop 0
    buffer_load_dwordx4 v22, s[44:47], s77 offen offset:0 lds
    s_add_u32 m0, s33, 28544
    s_nop 0
    buffer_load_dwordx4 v22, s[44:47], s77 offen offset:128 lds
    s_add_u32 m0, s33, 32768
    s_nop 0
    buffer_load_dwordx4 v76, s[48:51], s77 offen lds
    s_add_u32 m0, s33, 36864
    s_add_u32 s77, s77, 229376
    buffer_load_dwordx4 v22, s[40:43], s77 offen offset:0 lds
    s_add_u32 m0, s33, 40832
    s_nop 0
    buffer_load_dwordx4 v22, s[40:43], s77 offen offset:128 lds
    s_add_u32 m0, s33, 45056
    s_nop 0
    buffer_load_dwordx4 v22, s[44:47], s77 offen offset:0 lds
    s_add_u32 m0, s33, 49024
    s_nop 0
    buffer_load_dwordx4 v22, s[44:47], s77 offen offset:128 lds
    s_add_u32 m0, s33, 53248
    s_nop 0
    buffer_load_dwordx4 v76, s[48:51], s77 offen lds
    s_mov_b32 s68, s26
    s_mov_b32 s69, s27
    s_mov_b32 s70, 0x10000000
    s_mov_b32 s71, 0x20000
    s_getpc_b64 s[92:93]
L_pc:
    s_lshl2_add_u32 s91, s15, s4
    s_lshl_b32 s91, s91, 9
    s_min_u32 s91, s91, L_code_end - L_pc - 512
    s_load_dword s94, s[92:93], s91 offset:0
    s_load_dword s94, s[92:93], s91 offset:64
    s_load_dword s94, s[92:93], s91 offset:128
    s_load_dword s94, s[92:93], s91 offset:192
    s_load_dword s94, s[92:93], s91 offset:256
    s_load_dword s94, s[92:93], s91 offset:320
    s_load_dword s94, s[92:93], s91 offset:384
    s_load_dword s94, s[92:93], s91 offset:448
    v_lshrrev_b32 v64, 4, v1
    v_bfe_u32 v65, v1, 2, 2
    v_and_b32 v66, 3, v1
    v_and_b32 v67, 15, v1
    v_lshrrev_b32 v68, 3, v1
    v_and_b32 v69, 7, v1
    s_lshl_b32 s85, s6, 12
    s_add_u32 s85, s85, 16384
    v_lshl_add_u32 v70, v64, 3, v65
    v_lshlrev_b32 v70, 7, v70
    v_and_b32 v71, 1, v66
    v_lshl_add_u32 v70, v71, 3, v70
    v_add_u32 v70, s85, v70
    v_and_b32 v71, 2, v65
    v_and_b32 v72, 1, v64
    v_lshl_add_u32 v71, v72, 2, v71
    v_lshrrev_b32 v72, 1, v66
    v_xor_b32 v71, v71, v72
    v_xor_b32 v72, 0, v71
    v_lshl_add_u32 v4, v72, 4, v70
    v_add_u32 v9, 40960, v4
    v_xor_b32 v72, 2, v71
    v_lshl_add_u32 v5, v72, 4, v70
    v_add_u32 v10, 40960, v5
    v_xor_b32 v72, 4, v71
    v_lshl_add_u32 v6, v72, 4, v70
    v_add_u32 v11, 40960, v6
    v_xor_b32 v72, 6, v71
    v_lshl_add_u32 v7, v72, 4, v70
    v_add_u32 v12, 40960, v7
    v_lshl_add_u32 v70, v64, 3, v65
    v_lshlrev_b32 v70, 6, v70
    v_and_b32 v71, 1, v66
    v_lshl_add_u32 v70, v71, 3, v70
    v_and_b32 v71, 1, v64
    v_xor_b32 v71, s6, v71
    v_lshl_add_u32 v70, v71, 5, v70
    v_lshrrev_b32 v71, 1, v66
    v_lshl_add_u32 v70, v71, 4, v70
    v_add_u32 v8, 16384, v70
    v_add_u32 v13, 57344, v70
    v_lshrrev_b32 v70, 1, v67
    v_xor_b32 v70, v70, v64
    v_lshlrev_b32 v70, 4, v70
    v_lshl_add_u32 v70, v67, 7, v70
    s_lshl_b32 s85, s5, 13
    v_add_u32 v16, s85, v70
    v_xor_b32 v17, 64, v16
    s_mov_b32 s80, 116736
    s_lshl_b32 s86, s28, 7
    s_sub_u32 s86, s86, 16
    s_max_i32 s86, s86, 0
    s_lshl_b32 s87, s4, 2
    v_add_u32 v71, s87, v68
    v_lshrrev_b32 v70, 1, v71
    v_and_b32 v70, 7, v70
    v_xor_b32 v70, v70, v69
    v_lshlrev_b32 v70, 4, v70
    v_add_u32 v71, s86, v71
    v_lshl_add_u32 v3, v71, 11, v70
    s_lshl_b32 s81, s4, 9
    s_lshl_b32 s85, s4, 3
    s_and_b32 s86, s4, 1
    s_lshl_b32 s86, s86, 2
    v_and_b32 v70, 2, v68
    v_xor_b32 v70, v70, v69
    v_xor_b32 v70, s86, v70
    v_add_u32 v71, s85, v68
    v_mul_u32_u24 v71, 6144, v71
    v_lshl_add_u32 v23, v70, 4, v71
    s_lshl_b32 s85, s6, 2
    v_lshl_add_u32 v70, v64, 3, v65
    v_lshlrev_b32 v70, 7, v70
    v_and_b32 v71, 1, v66
    v_lshl_add_u32 v70, v71, 3, v70
    v_add_u32 v70, 0, v70
    v_and_b32 v71, 2, v65
    v_and_b32 v72, 1, v64
    v_lshl_add_u32 v71, v72, 2, v71
    v_lshrrev_b32 v72, 1, v66
    v_xor_b32 v71, v71, v72
    v_xor_b32 v71, s85, v71
    v_xor_b32 v72, 0, v71
    v_lshl_add_u32 v250, v72, 4, v70
    v_add_u32 v252, 65536, v250
    v_xor_b32 v72, 2, v71
    v_lshl_add_u32 v251, v72, 4, v70
    v_add_u32 v253, 65536, v251
    s_lshl_b32 s85, s5, 12
    v_lshl_add_u32 v248, v1, 4, s85
    v_add_u32 v249, 65536, v248
    s_lshl_b32 s85, s4, 12
    v_lshl_add_u32 v18, v1, 4, s85
    s_lshl_b32 s85, s4, 4
    v_and_b32 v70, 2, v68
    v_xor_b32 v70, v70, v69
    v_xor_b32 v70, 0, v70
    v_add_u32 v71, s85, v68
    v_mul_u32_u24 v71, 2048, v71
    v_lshl_add_u32 v254, v70, 4, v71
    s_add_u32 s85, s85, 8
    v_and_b32 v70, 2, v68
    v_xor_b32 v70, v70, v69
    v_xor_b32 v70, 4, v70
    v_add_u32 v71, s85, v68
    v_mul_u32_u24 v71, 2048, v71
    v_lshl_add_u32 v255, v70, 4, v71
    s_lshl_b32 s85, s31, 8
    s_lshl_b32 s86, s32, 7
    s_add_u32 s86, s85, s86
    s_xor_b32 s87, s86, 128
    s_lshr_b32 s91, s31, 2
    s_lshl1_add_u32 s91, s91, s32
    s_lshl_b32 s91, s91, 13
    s_add_u32 s91, s91, 0x2000000
    s_xor_b32 s85, s91, 8192
    s_and_b32 s92, s31, 3
    s_cmp_eq_u32 s92, 1
    s_cselect_b32 s86, s91, s86
    s_cselect_b32 s87, s85, s87
    s_cselect_b32 s91, 0x2a00000, 0
    s_cselect_b32 s92, s26, s20
    s_cselect_b32 s93, s27, s21
    s_max_u32 s91, s91, 7340032
    s_add_u32 s60, s92, s86
    s_addc_u32 s61, s93, 0
    s_sub_u32 s62, s91, s86
    s_mov_b32 s63, 0x20000
    s_add_u32 s64, s92, s87
    s_addc_u32 s65, s93, 0
    s_sub_u32 s66, s91, s87
    s_mov_b32 s67, 0x20000
    s_add_u32 s56, s26, 0x400000
    s_addc_u32 s57, s27, 0
    s_mov_b32 s58, 0xe00000
    s_mov_b32 s59, 0x20000
    s_mul_i32 s82, s30, 917504
    s_mul_i32 s85, s32, 327680
    s_add_u32 s82, s82, s85
    s_mul_i32 s83, s32, 2621440
    s_mul_i32 s85, s32, 10
    s_sub_u32 s85, 40, s85
    s_lshl_b32 s14, s85, 13
    s_lshl_b32 s35, s85, 16
    s_and_b32 s85, s31, 3
    s_cmp_eq_u32 s85, 1
    s_cselect_b64 vcc, -1, 0
    s_lshl_b32 s85, s4, 11
    v_lshl_add_u32 v70, v1, 4, s85
    v_add_u32 v71, 1024, v70
    v_cndmask_b32 v254, v254, v70, vcc
    v_cndmask_b32 v255, v255, v71, vcc
    v_lshrrev_b32 v78, 4, v1
    v_and_b32 v79, 1, v78
    v_lshrrev_b32 v78, 1, v78
    v_lshlrev_b32 v78, 8, v78
    v_lshl_add_u32 v78, v79, 10, v78
    v_and_b32 v79, 15, v1
    v_lshl_add_u32 v19, v79, 4, v78
    s_mul_i32 s84, s28, 112
    s_mul_i32 s85, s29, 5
    s_add_u32 s84, s84, s85
    s_lshl_b32 s84, s84, 13
    s_lshl_b32 s85, s5, 12
    s_add_u32 s84, s84, s85
    s_add_u32 s84, s84, 0x400000
    s_and_b32 s85, s29, 1
    s_lshl1_add_u32 s86, s6, s85
    s_lshl_b32 s86, s86, 13
    s_add_u32 s72, s84, s86
    s_add_u32 s73, s72, 8192
    s_xor_b32 s85, s85, 1
    s_lshl_b32 s85, s85, 15
    s_add_u32 s84, s84, s85
    s_lshl_b32 s85, s6, 9
    s_add_u32 s74, s84, s85
    s_lshl2_add_u32 s91, s2, s4
    s_lshl_b32 s75, s91, 9
    s_lshr_b32 s92, s91, 2
    s_mul_i32 s92, s92, 7168
    s_and_b32 s91, s91, 3
    s_lshl_b32 s91, s91, 9
    s_add_u32 s92, s92, s91
    s_add_u32 s99, s92, 5120
    s_mov_b32 s36, s26
    s_mov_b32 s37, s27
    s_mov_b32 s38, 0x400000
    s_mov_b32 s39, 0x20000
    s_lshl_b32 s85, s29, 7
    s_add_u32 s40, s10, s85
    s_addc_u32 s41, s11, 0
    s_sub_u32 s42, 6291456, s85
    s_mov_b32 s43, 0x20000
    s_add_u32 s86, s85, 4096
    s_add_u32 s44, s10, s86
    s_addc_u32 s45, s11, 0
    s_sub_u32 s46, 6291456, s86
    s_mov_b32 s47, 0x20000
    s_add_u32 s86, s85, 128
    s_and_b32 s86, s86, 0x7ff
    s_add_u32 s86, s86, 5120
    s_add_u32 s48, s16, s86
    s_addc_u32 s49, s17, 0
    s_sub_u32 s50, 7340032, s86
    s_mov_b32 s51, 0x20000
    s_add_u32 s52, s18, s86
    s_addc_u32 s53, s19, 0
    s_sub_u32 s54, 7340032, s86
    s_mov_b32 s55, 0x20000
    s_mov_b64 exec, 0
    s_cmp_eq_u32 s4, 0
    s_cbranch_scc1 L_pad6
    s_cmp_eq_u32 s4, 1
    s_cbranch_scc1 L_pad7
    s_cmp_eq_u32 s4, 2
    s_cbranch_scc1 L_pad0
    s_cmp_eq_u32 s4, 3
    s_cbranch_scc1 L_pad8
L_vret0:
    s_mov_b64 exec, -1
    s_mov_b64 exec, 0
    s_cmp_eq_u32 s4, 0
    s_cbranch_scc1 L_pad9
    s_cmp_eq_u32 s4, 1
    s_cbranch_scc1 L_pad1
    s_cmp_eq_u32 s4, 2
    s_cbranch_scc1 L_pad2
    s_cmp_eq_u32 s4, 3
    s_cbranch_scc1 L_pad3
L_vret1:
    s_mov_b64 exec, -1
    s_setprio 1
    s_waitcnt vmcnt(5)
    s_barrier
    v_add_u32 v14, s80, v16
    v_add_u32 v15, s80, v17
    s_add_u32 s80, s80, 18432
    s_cmp_ge_u32 s80, 153600
    s_cselect_b32 s84, 55296, 0
    s_sub_u32 s80, s80, s84
    ds_read_b64_tr_b16 v[64:65], v4 offset:0
    ds_read_b64_tr_b16 v[66:67], v4 offset:512
    ds_read_b128 v[24:27], v14 offset:0
    ds_read_b128 v[28:31], v14 offset:2048
    ds_read_b128 v[32:35], v14 offset:4096
    ds_read_b128 v[36:39], v14 offset:6144
    ds_read_b64_tr_b16 v[68:69], v4 offset:8192
    ds_read_b64_tr_b16 v[70:71], v4 offset:8704
    ds_read_b64_tr_b16 v[72:73], v5 offset:0
    ds_read_b64_tr_b16 v[74:75], v5 offset:512
    s_waitcnt lgkmcnt(7)
    v_mfma_f32_16x16x32_bf16 v[88:91], v[64:67], v[24:27], 0
    ds_read_b64_tr_b16 v[76:77], v5 offset:8192
    s_waitcnt lgkmcnt(7)
    v_mfma_f32_16x16x32_bf16 v[92:95], v[64:67], v[28:31], 0
    ds_read_b64_tr_b16 v[78:79], v5 offset:8704
    s_waitcnt lgkmcnt(7)
    v_mfma_f32_16x16x32_bf16 v[96:99], v[64:67], v[32:35], 0
    ds_read_b64_tr_b16 v[80:81], v6 offset:0
    s_waitcnt lgkmcnt(7)
    v_mfma_f32_16x16x32_bf16 v[100:103], v[64:67], v[36:39], 0
    ds_read_b64_tr_b16 v[82:83], v6 offset:512
    s_waitcnt lgkmcnt(6)
    v_mfma_f32_16x16x32_bf16 v[104:107], v[68:71], v[24:27], 0
    ds_read_b64_tr_b16 v[64:65], v6 offset:8192
    v_mfma_f32_16x16x32_bf16 v[108:111], v[68:71], v[28:31], 0
    v_mfma_f32_16x16x32_bf16 v[112:115], v[68:71], v[32:35], 0
    ds_read_b64_tr_b16 v[66:67], v6 offset:8704
    v_mfma_f32_16x16x32_bf16 v[116:119], v[68:71], v[36:39], 0
    s_waitcnt lgkmcnt(6)
    v_mfma_f32_16x16x32_bf16 v[120:123], v[72:75], v[24:27], 0
    ds_read_b64_tr_b16 v[68:69], v7 offset:0
    v_mfma_f32_16x16x32_bf16 v[124:127], v[72:75], v[28:31], 0
    v_mfma_f32_16x16x32_bf16 v[128:131], v[72:75], v[32:35], 0
    ds_read_b64_tr_b16 v[70:71], v7 offset:512
    v_mfma_f32_16x16x32_bf16 v[132:135], v[72:75], v[36:39], 0
    s_waitcnt lgkmcnt(6)
    v_mfma_f32_16x16x32_bf16 v[136:139], v[76:79], v[24:27], 0
    ds_read_b64_tr_b16 v[72:73], v7 offset:8192
    v_mfma_f32_16x16x32_bf16 v[140:143], v[76:79], v[28:31], 0
    v_mfma_f32_16x16x32_bf16 v[144:147], v[76:79], v[32:35], 0
    ds_read_b64_tr_b16 v[74:75], v7 offset:8704
    v_mfma_f32_16x16x32_bf16 v[148:151], v[76:79], v[36:39], 0
    s_waitcnt lgkmcnt(6)
    v_mfma_f32_16x16x32_bf16 v[152:155], v[80:83], v[24:27], 0
    ds_read_b64_tr_b16 v[76:77], v8 offset:16384
    v_mfma_f32_16x16x32_bf16 v[156:159], v[80:83], v[28:31], 0
    v_mfma_f32_16x16x32_bf16 v[160:163], v[80:83], v[32:35], 0
    ds_read_b64_tr_b16 v[78:79], v8 offset:16640
    v_mfma_f32_16x16x32_bf16 v[164:167], v[80:83], v[36:39], 0
    s_waitcnt lgkmcnt(6)
    v_mfma_f32_16x16x32_bf16 v[168:171], v[64:67], v[24:27], 0
    ds_read_b64_tr_b16 v[80:81], v8 offset:18432
    v_mfma_f32_16x16x32_bf16 v[172:175], v[64:67], v[28:31], 0
    v_mfma_f32_16x16x32_bf16 v[176:179], v[64:67], v[32:35], 0
    ds_read_b64_tr_b16 v[82:83], v8 offset:18688
    v_mfma_f32_16x16x32_bf16 v[180:183], v[64:67], v[36:39], 0
    s_waitcnt lgkmcnt(6)
    v_mfma_f32_16x16x32_bf16 v[184:187], v[68:71], v[24:27], 0
    v_mfma_f32_16x16x32_bf16 v[188:191], v[68:71], v[28:31], 0
    v_mfma_f32_16x16x32_bf16 v[192:195], v[68:71], v[32:35], 0
    v_mfma_f32_16x16x32_bf16 v[196:199], v[68:71], v[36:39], 0
    s_waitcnt vmcnt(0) lgkmcnt(0)
    s_barrier
    v_mfma_f32_16x16x32_bf16 v[200:203], v[72:75], v[24:27], 0
    ds_read_b64_tr_b16 v[64:65], v4 offset:20480
    v_mfma_f32_16x16x32_bf16 v[204:207], v[72:75], v[28:31], 0
    ds_read_b64_tr_b16 v[66:67], v4 offset:20992
    v_mfma_f32_16x16x32_bf16 v[208:211], v[72:75], v[32:35], 0
    ds_read_b128 v[40:43], v15 offset:0
    v_mfma_f32_16x16x32_bf16 v[212:215], v[72:75], v[36:39], 0
    ds_read_b128 v[44:47], v15 offset:2048
    v_mfma_f32_16x16x32_bf16 v[216:219], v[76:79], v[24:27], 0
    ds_read_b128 v[48:51], v15 offset:4096
    v_mfma_f32_16x16x32_bf16 v[220:223], v[76:79], v[28:31], 0
    ds_read_b128 v[52:55], v15 offset:6144
    v_mfma_f32_16x16x32_bf16 v[224:227], v[76:79], v[32:35], 0
    ds_read_b64_tr_b16 v[68:69], v4 offset:28672
    v_mfma_f32_16x16x32_bf16 v[228:231], v[76:79], v[36:39], 0
    ds_read_b64_tr_b16 v[70:71], v4 offset:29184
    v_mfma_f32_16x16x32_bf16 v[232:235], v[80:83], v[24:27], 0
    ds_read_b64_tr_b16 v[72:73], v5 offset:20480
    v_mfma_f32_16x16x32_bf16 v[236:239], v[80:83], v[28:31], 0
    v_mfma_f32_16x16x32_bf16 v[240:243], v[80:83], v[32:35], 0
    ds_read_b64_tr_b16 v[74:75], v5 offset:20992
    v_mfma_f32_16x16x32_bf16 v[244:247], v[80:83], v[36:39], 0
    s_waitcnt lgkmcnt(7)
    v_mfma_f32_16x16x32_bf16 v[88:91], v[64:67], v[40:43], v[88:91]
    ds_read_b64_tr_b16 v[76:77], v5 offset:28672
    s_waitcnt lgkmcnt(7)
    v_mfma_f32_16x16x32_bf16 v[92:95], v[64:67], v[44:47], v[92:95]
    ds_read_b64_tr_b16 v[78:79], v5 offset:29184
    s_waitcnt lgkmcnt(7)
    v_mfma_f32_16x16x32_bf16 v[96:99], v[64:67], v[48:51], v[96:99]
    ds_read_b64_tr_b16 v[80:81], v6 offset:20480
    s_waitcnt lgkmcnt(7)
    v_mfma_f32_16x16x32_bf16 v[100:103], v[64:67], v[52:55], v[100:103]
    ds_read_b64_tr_b16 v[82:83], v6 offset:20992
    s_waitcnt lgkmcnt(6)
    v_mfma_f32_16x16x32_bf16 v[104:107], v[68:71], v[40:43], v[104:107]
    ds_read_b64_tr_b16 v[64:65], v6 offset:28672
    v_mfma_f32_16x16x32_bf16 v[108:111], v[68:71], v[44:47], v[108:111]
    v_add_u32 v14, s80, v16
    v_mfma_f32_16x16x32_bf16 v[112:115], v[68:71], v[48:51], v[112:115]
    ds_read_b64_tr_b16 v[66:67], v6 offset:29184
    v_mfma_f32_16x16x32_bf16 v[116:119], v[68:71], v[52:55], v[116:119]
    v_add_u32 v15, s80, v17
    s_waitcnt lgkmcnt(6)
    v_mfma_f32_16x16x32_bf16 v[120:123], v[72:75], v[40:43], v[120:123]
    ds_read_b64_tr_b16 v[68:69], v7 offset:20480
    v_mfma_f32_16x16x32_bf16 v[124:127], v[72:75], v[44:47], v[124:127]
    s_add_u32 s80, s80, 18432
    v_mfma_f32_16x16x32_bf16 v[128:131], v[72:75], v[48:51], v[128:131]
    ds_read_b64_tr_b16 v[70:71], v7 offset:20992
    v_mfma_f32_16x16x32_bf16 v[132:135], v[72:75], v[52:55], v[132:135]
    s_cmp_ge_u32 s80, 153600
    s_cselect_b32 s84, 55296, 0
    s_waitcnt lgkmcnt(6)
    v_mfma_f32_16x16x32_bf16 v[136:139], v[76:79], v[40:43], v[136:139]
    ds_read_b64_tr_b16 v[72:73], v7 offset:28672
    v_mfma_f32_16x16x32_bf16 v[140:143], v[76:79], v[44:47], v[140:143]
    s_sub_u32 s80, s80, s84
    v_mfma_f32_16x16x32_bf16 v[144:147], v[76:79], v[48:51], v[144:147]
    ds_read_b64_tr_b16 v[74:75], v7 offset:29184
    v_mfma_f32_16x16x32_bf16 v[148:151], v[76:79], v[52:55], v[148:151]
    s_waitcnt lgkmcnt(6)
    v_mfma_f32_16x16x32_bf16 v[152:155], v[80:83], v[40:43], v[152:155]
    ds_read_b64_tr_b16 v[76:77], v8 offset:36864
    v_mfma_f32_16x16x32_bf16 v[156:159], v[80:83], v[44:47], v[156:159]
    v_mfma_f32_16x16x32_bf16 v[160:163], v[80:83], v[48:51], v[160:163]
    ds_read_b64_tr_b16 v[78:79], v8 offset:37120
    v_mfma_f32_16x16x32_bf16 v[164:167], v[80:83], v[52:55], v[164:167]
    s_waitcnt lgkmcnt(6)
    v_mfma_f32_16x16x32_bf16 v[168:171], v[64:67], v[40:43], v[168:171]
    ds_read_b64_tr_b16 v[80:81], v8 offset:38912
    v_mfma_f32_16x16x32_bf16 v[172:175], v[64:67], v[44:47], v[172:175]
    v_mfma_f32_16x16x32_bf16 v[176:179], v[64:67], v[48:51], v[176:179]
    ds_read_b64_tr_b16 v[82:83], v8 offset:39168
    v_mfma_f32_16x16x32_bf16 v[180:183], v[64:67], v[52:55], v[180:183]
    s_waitcnt lgkmcnt(6)
    v_mfma_f32_16x16x32_bf16 v[184:187], v[68:71], v[40:43], v[184:187]
    v_mfma_f32_16x16x32_bf16 v[188:191], v[68:71], v[44:47], v[188:191]
    v_mfma_f32_16x16x32_bf16 v[192:195], v[68:71], v[48:51], v[192:195]
    v_mfma_f32_16x16x32_bf16 v[196:199], v[68:71], v[52:55], v[196:199]
    s_waitcnt lgkmcnt(0)
    s_barrier
    v_mfma_f32_16x16x32_bf16 v[200:203], v[72:75], v[40:43], v[200:203]
    ds_read_b64_tr_b16 v[64:65], v9 offset:0
    v_mfma_f32_16x16x32_bf16 v[204:207], v[72:75], v[44:47], v[204:207]
    ds_read_b64_tr_b16 v[66:67], v9 offset:512
    v_mfma_f32_16x16x32_bf16 v[208:211], v[72:75], v[48:51], v[208:211]
    ds_read_b128 v[24:27], v14 offset:0
    v_mfma_f32_16x16x32_bf16 v[212:215], v[72:75], v[52:55], v[212:215]
    ds_read_b128 v[28:31], v14 offset:2048
    v_mfma_f32_16x16x32_bf16 v[216:219], v[76:79], v[40:43], v[216:219]
    ds_read_b128 v[32:35], v14 offset:4096
    v_mfma_f32_16x16x32_bf16 v[220:223], v[76:79], v[44:47], v[220:223]
    ds_read_b128 v[36:39], v14 offset:6144
    v_mfma_f32_16x16x32_bf16 v[224:227], v[76:79], v[48:51], v[224:227]
    ds_read_b64_tr_b16 v[68:69], v9 offset:8192
    v_mfma_f32_16x16x32_bf16 v[228:231], v[76:79], v[52:55], v[228:231]
    ds_read_b64_tr_b16 v[70:71], v9 offset:8704
    v_mfma_f32_16x16x32_bf16 v[232:235], v[80:83], v[40:43], v[232:235]
    ds_read_b64_tr_b16 v[72:73], v10 offset:0
    v_mfma_f32_16x16x32_bf16 v[236:239], v[80:83], v[44:47], v[236:239]
    v_mfma_f32_16x16x32_bf16 v[240:243], v[80:83], v[48:51], v[240:243]
    ds_read_b64_tr_b16 v[74:75], v10 offset:512
    v_mfma_f32_16x16x32_bf16 v[244:247], v[80:83], v[52:55], v[244:247]
    s_waitcnt lgkmcnt(7)
    v_mfma_f32_16x16x32_bf16 v[88:91], v[64:67], v[24:27], v[88:91]
    ds_read_b64_tr_b16 v[76:77], v10 offset:8192
    s_waitcnt lgkmcnt(7)
    v_mfma_f32_16x16x32_bf16 v[92:95], v[64:67], v[28:31], v[92:95]
    ds_read_b64_tr_b16 v[78:79], v10 offset:8704
    s_waitcnt lgkmcnt(7)
    v_mfma_f32_16x16x32_bf16 v[96:99], v[64:67], v[32:35], v[96:99]
    ds_read_b64_tr_b16 v[80:81], v11 offset:0
    s_waitcnt lgkmcnt(7)
    v_mfma_f32_16x16x32_bf16 v[100:103], v[64:67], v[36:39], v[100:103]
    ds_read_b64_tr_b16 v[82:83], v11 offset:512
    s_waitcnt lgkmcnt(6)
    v_mfma_f32_16x16x32_bf16 v[104:107], v[68:71], v[24:27], v[104:107]
    ds_read_b64_tr_b16 v[64:65], v11 offset:8192
    v_mfma_f32_16x16x32_bf16 v[108:111], v[68:71], v[28:31], v[108:111]
    v_mfma_f32_16x16x32_bf16 v[112:115], v[68:71], v[32:35], v[112:115]
    ds_read_b64_tr_b16 v[66:67], v11 offset:8704
    v_mfma_f32_16x16x32_bf16 v[116:119], v[68:71], v[36:39], v[116:119]
    s_waitcnt lgkmcnt(6)
    v_mfma_f32_16x16x32_bf16 v[120:123], v[72:75], v[24:27], v[120:123]
    ds_read_b64_tr_b16 v[68:69], v12 offset:0
    v_mfma_f32_16x16x32_bf16 v[124:127], v[72:75], v[28:31], v[124:127]
    v_mfma_f32_16x16x32_bf16 v[128:131], v[72:75], v[32:35], v[128:131]
    ds_read_b64_tr_b16 v[70:71], v12 offset:512
    v_mfma_f32_16x16x32_bf16 v[132:135], v[72:75], v[36:39], v[132:135]
    s_waitcnt lgkmcnt(6)
    v_mfma_f32_16x16x32_bf16 v[136:139], v[76:79], v[24:27], v[136:139]
    ds_read_b64_tr_b16 v[72:73], v12 offset:8192
    v_mfma_f32_16x16x32_bf16 v[140:143], v[76:79], v[28:31], v[140:143]
    v_mfma_f32_16x16x32_bf16 v[144:147], v[76:79], v[32:35], v[144:147]
    ds_read_b64_tr_b16 v[74:75], v12 offset:8704
    v_mfma_f32_16x16x32_bf16 v[148:151], v[76:79], v[36:39], v[148:151]
    s_waitcnt lgkmcnt(6)
    v_mfma_f32_16x16x32_bf16 v[152:155], v[80:83], v[24:27], v[152:155]
    ds_read_b64_tr_b16 v[76:77], v13 offset:16384
    v_mfma_f32_16x16x32_bf16 v[156:159], v[80:83], v[28:31], v[156:159]
    v_mfma_f32_16x16x32_bf16 v[160:163], v[80:83], v[32:35], v[160:163]
    ds_read_b64_tr_b16 v[78:79], v13 offset:16640
    v_mfma_f32_16x16x32_bf16 v[164:167], v[80:83], v[36:39], v[164:167]
    s_waitcnt lgkmcnt(6)
    v_mfma_f32_16x16x32_bf16 v[168:171], v[64:67], v[24:27], v[168:171]
    ds_read_b64_tr_b16 v[80:81], v13 offset:18432
    v_mfma_f32_16x16x32_bf16 v[172:175], v[64:67], v[28:31], v[172:175]
    v_mfma_f32_16x16x32_bf16 v[176:179], v[64:67], v[32:35], v[176:179]
    ds_read_b64_tr_b16 v[82:83], v13 offset:18688
    v_mfma_f32_16x16x32_bf16 v[180:183], v[64:67], v[36:39], v[180:183]
    s_waitcnt lgkmcnt(6)
    v_mfma_f32_16x16x32_bf16 v[184:187], v[68:71], v[24:27], v[184:187]
    v_mfma_f32_16x16x32_bf16 v[188:191], v[68:71], v[28:31], v[188:191]
    v_mfma_f32_16x16x32_bf16 v[192:195], v[68:71], v[32:35], v[192:195]
    v_mfma_f32_16x16x32_bf16 v[196:199], v[68:71], v[36:39], v[196:199]
    s_waitcnt lgkmcnt(0)
    s_barrier
    v_mfma_f32_16x16x32_bf16 v[200:203], v[72:75], v[24:27], v[200:203]
    ds_read_b64_tr_b16 v[64:65], v9 offset:20480
    v_mfma_f32_16x16x32_bf16 v[204:207], v[72:75], v[28:31], v[204:207]
    ds_read_b64_tr_b16 v[66:67], v9 offset:20992
    v_mfma_f32_16x16x32_bf16 v[208:211], v[72:75], v[32:35], v[208:211]
    ds_read_b128 v[40:43], v15 offset:0
    v_mfma_f32_16x16x32_bf16 v[212:215], v[72:75], v[36:39], v[212:215]
    ds_read_b128 v[44:47], v15 offset:2048
    v_mfma_f32_16x16x32_bf16 v[216:219], v[76:79], v[24:27], v[216:219]
    ds_read_b128 v[48:51], v15 offset:4096
    v_mfma_f32_16x16x32_bf16 v[220:223], v[76:79], v[28:31], v[220:223]
    ds_read_b128 v[52:55], v15 offset:6144
    v_mfma_f32_16x16x32_bf16 v[224:227], v[76:79], v[32:35], v[224:227]
    ds_read_b64_tr_b16 v[68:69], v9 offset:28672
    v_mfma_f32_16x16x32_bf16 v[228:231], v[76:79], v[36:39], v[228:231]
    ds_read_b64_tr_b16 v[70:71], v9 offset:29184
    v_mfma_f32_16x16x32_bf16 v[232:235], v[80:83], v[24:27], v[232:235]
    ds_read_b64_tr_b16 v[72:73], v10 offset:20480
    v_mfma_f32_16x16x32_bf16 v[236:239], v[80:83], v[28:31], v[236:239]
    v_mfma_f32_16x16x32_bf16 v[240:243], v[80:83], v[32:35], v[240:243]
    ds_read_b64_tr_b16 v[74:75], v10 offset:20992
    v_mfma_f32_16x16x32_bf16 v[244:247], v[80:83], v[36:39], v[244:247]
    s_waitcnt lgkmcnt(7)
    v_mfma_f32_16x16x32_bf16 v[88:91], v[64:67], v[40:43], v[88:91]
    ds_read_b64_tr_b16 v[76:77], v10 offset:28672
    s_waitcnt lgkmcnt(7)
    v_mfma_f32_16x16x32_bf16 v[92:95], v[64:67], v[44:47], v[92:95]
    ds_read_b64_tr_b16 v[78:79], v10 offset:29184
    s_waitcnt lgkmcnt(7)
    v_mfma_f32_16x16x32_bf16 v[96:99], v[64:67], v[48:51], v[96:99]
    ds_read_b64_tr_b16 v[80:81], v11 offset:20480
    s_waitcnt lgkmcnt(7)
    v_mfma_f32_16x16x32_bf16 v[100:103], v[64:67], v[52:55], v[100:103]
    ds_read_b64_tr_b16 v[82:83], v11 offset:20992
    s_waitcnt lgkmcnt(6)
    v_mfma_f32_16x16x32_bf16 v[104:107], v[68:71], v[40:43], v[104:107]
    ds_read_b64_tr_b16 v[64:65], v11 offset:28672
    v_mfma_f32_16x16x32_bf16 v[108:111], v[68:71], v[44:47], v[108:111]
    v_add_u32 v14, s80, v16
    v_mfma_f32_16x16x32_bf16 v[112:115], v[68:71], v[48:51], v[112:115]
    ds_read_b64_tr_b16 v[66:67], v11 offset:29184
    v_mfma_f32_16x16x32_bf16 v[116:119], v[68:71], v[52:55], v[116:119]
    v_add_u32 v15, s80, v17
    s_waitcnt lgkmcnt(6)
    v_mfma_f32_16x16x32_bf16 v[120:123], v[72:75], v[40:43], v[120:123]
    ds_read_b64_tr_b16 v[68:69], v12 offset:20480
    v_mfma_f32_16x16x32_bf16 v[124:127], v[72:75], v[44:47], v[124:127]
    s_add_u32 s80, s80, 18432
    v_mfma_f32_16x16x32_bf16 v[128:131], v[72:75], v[48:51], v[128:131]
    ds_read_b64_tr_b16 v[70:71], v12 offset:20992
    v_mfma_f32_16x16x32_bf16 v[132:135], v[72:75], v[52:55], v[132:135]
    s_cmp_ge_u32 s80, 153600
    s_cselect_b32 s84, 55296, 0
    s_waitcnt lgkmcnt(6)
    v_mfma_f32_16x16x32_bf16 v[136:139], v[76:79], v[40:43], v[136:139]
    ds_read_b64_tr_b16 v[72:73], v12 offset:28672
    v_mfma_f32_16x16x32_bf16 v[140:143], v[76:79], v[44:47], v[140:143]
    s_sub_u32 s80, s80, s84
    v_mfma_f32_16x16x32_bf16 v[144:147], v[76:79], v[48:51], v[144:147]
    ds_read_b64_tr_b16 v[74:75], v12 offset:29184
    v_mfma_f32_16x16x32_bf16 v[148:151], v[76:79], v[52:55], v[148:151]
    s_waitcnt lgkmcnt(6)
    v_mfma_f32_16x16x32_bf16 v[152:155], v[80:83], v[40:43], v[152:155]
    ds_read_b64_tr_b16 v[76:77], v13 offset:36864
    v_mfma_f32_16x16x32_bf16 v[156:159], v[80:83], v[44:47], v[156:159]
    v_mfma_f32_16x16x32_bf16 v[160:163], v[80:83], v[48:51], v[160:163]
    ds_read_b64_tr_b16 v[78:79], v13 offset:37120
    v_mfma_f32_16x16x32_bf16 v[164:167], v[80:83], v[52:55], v[164:167]
    s_waitcnt lgkmcnt(6)
    v_mfma_f32_16x16x32_bf16 v[168:171], v[64:67], v[40:43], v[168:171]
    ds_read_b64_tr_b16 v[80:81], v13 offset:38912
    v_mfma_f32_16x16x32_bf16 v[172:175], v[64:67], v[44:47], v[172:175]
    v_mfma_f32_16x16x32_bf16 v[176:179], v[64:67], v[48:51], v[176:179]
    ds_read_b64_tr_b16 v[82:83], v13 offset:39168
    v_mfma_f32_16x16x32_bf16 v[180:183], v[64:67], v[52:55], v[180:183]
    s_waitcnt lgkmcnt(6)
    v_mfma_f32_16x16x32_bf16 v[184:187], v[68:71], v[40:43], v[184:187]
    v_mfma_f32_16x16x32_bf16 v[188:191], v[68:71], v[44:47], v[188:191]
    v_mfma_f32_16x16x32_bf16 v[192:195], v[68:71], v[48:51], v[192:195]
    v_mfma_f32_16x16x32_bf16 v[196:199], v[68:71], v[52:55], v[196:199]
    s_waitcnt lgkmcnt(0)
    s_barrier
    v_mfma_f32_16x16x32_bf16 v[200:203], v[72:75], v[40:43], v[200:203]
    ds_read_b64_tr_b16 v[64:65], v4 offset:0
    v_mfma_f32_16x16x32_bf16 v[204:207], v[72:75], v[44:47], v[204:207]
    ds_read_b64_tr_b16 v[66:67], v4 offset:512
    v_mfma_f32_16x16x32_bf16 v[208:211], v[72:75], v[48:51], v[208:211]
    ds_read_b128 v[24:27], v14 offset:0
    v_mfma_f32_16x16x32_bf16 v[212:215], v[72:75], v[52:55], v[212:215]
    ds_read_b128 v[28:31], v14 offset:2048
    v_mfma_f32_16x16x32_bf16 v[216:219], v[76:79], v[40:43], v[216:219]
    ds_read_b128 v[32:35], v14 offset:4096
    v_mfma_f32_16x16x32_bf16 v[220:223], v[76:79], v[44:47], v[220:223]
    ds_read_b128 v[36:39], v14 offset:6144
    v_mfma_f32_16x16x32_bf16 v[224:227], v[76:79], v[48:51], v[224:227]
    ds_read_b64_tr_b16 v[68:69], v4 offset:8192
    v_mfma_f32_16x16x32_bf16 v[228:231], v[76:79], v[52:55], v[228:231]
    ds_read_b64_tr_b16 v[70:71], v4 offset:8704
    v_mfma_f32_16x16x32_bf16 v[232:235], v[80:83], v[40:43], v[232:235]
    ds_read_b64_tr_b16 v[72:73], v5 offset:0
    v_mfma_f32_16x16x32_bf16 v[236:239], v[80:83], v[44:47], v[236:239]
    v_mfma_f32_16x16x32_bf16 v[240:243], v[80:83], v[48:51], v[240:243]
    ds_read_b64_tr_b16 v[74:75], v5 offset:512
    v_mfma_f32_16x16x32_bf16 v[244:247], v[80:83], v[52:55], v[244:247]
    s_or_b32 s91, s2, s4
    s_cbranch_scc1 L_notok
    s_memrealtime s[92:93]
    v_mov_b32 v60, 0
    s_waitcnt lgkmcnt(0)
    s_or_b32 s92, s92, 1
    v_mov_b32 v62, s92
    v_mov_b32 v63, s93
    s_mov_b64 exec, 1
    global_store_dwordx2 v60, v[62:63], s[24:25] sc1
    s_mov_b64 exec, -1
L_notok:
    s_mov_b32 s34, 6
.p2align 6
L_p1:
    s_waitcnt lgkmcnt(7)
    v_mfma_f32_16x16x32_bf16 v[88:91], v[64:67], v[24:27], v[88:91]
    ds_read_b64_tr_b16 v[76:77], v5 offset:8192
    s_waitcnt lgkmcnt(7)
    v_mfma_f32_16x16x32_bf16 v[92:95], v[64:67], v[28:31], v[92:95]
    ds_read_b64_tr_b16 v[78:79], v5 offset:8704
    s_waitcnt lgkmcnt(7)
    v_mfma_f32_16x16x32_bf16 v[96:99], v[64:67], v[32:35], v[96:99]
    ds_read_b64_tr_b16 v[80:81], v6 offset:0
    s_waitcnt lgkmcnt(7)
    v_mfma_f32_16x16x32_bf16 v[100:103], v[64:67], v[36:39], v[100:103]
    ds_read_b64_tr_b16 v[82:83], v6 offset:512
    s_waitcnt lgkmcnt(6)
    v_mfma_f32_16x16x32_bf16 v[104:107], v[68:71], v[24:27], v[104:107]
    ds_read_b64_tr_b16 v[64:65], v6 offset:8192
    v_mfma_f32_16x16x32_bf16 v[108:111], v[68:71], v[28:31], v[108:111]
    v_mfma_f32_16x16x32_bf16 v[112:115], v[68:71], v[32:35], v[112:115]
    ds_read_b64_tr_b16 v[66:67], v6 offset:8704
    v_mfma_f32_16x16x32_bf16 v[116:119], v[68:71], v[36:39], v[116:119]
    s_waitcnt lgkmcnt(6)
    v_mfma_f32_16x16x32_bf16 v[120:123], v[72:75], v[24:27], v[120:123]
    ds_read_b64_tr_b16 v[68:69], v7 offset:0
    v_mfma_f32_16x16x32_bf16 v[124:127], v[72:75], v[28:31], v[124:127]
    v_mfma_f32_16x16x32_bf16 v[128:131], v[72:75], v[32:35], v[128:131]
    ds_read_b64_tr_b16 v[70:71], v7 offset:512
    v_mfma_f32_16x16x32_bf16 v[132:135], v[72:75], v[36:39], v[132:135]
    s_waitcnt lgkmcnt(6)
    v_mfma_f32_16x16x32_bf16 v[136:139], v[76:79], v[24:27], v[136:139]
    ds_read_b64_tr_b16 v[72:73], v7 offset:8192
    v_mfma_f32_16x16x32_bf16 v[140:143], v[76:79], v[28:31], v[140:143]
    v_mfma_f32_16x16x32_bf16 v[144:147], v[76:79], v[32:35], v[144:147]
    ds_read_b64_tr_b16 v[74:75], v7 offset:8704
    v_mfma_f32_16x16x32_bf16 v[148:151], v[76:79], v[36:39], v[148:151]
    s_waitcnt lgkmcnt(6)
    v_mfma_f32_16x16x32_bf16 v[152:155], v[80:83], v[24:27], v[152:155]
    ds_read_b64_tr_b16 v[76:77], v8 offset:16384
    v_mfma_f32_16x16x32_bf16 v[156:159], v[80:83], v[28:31], v[156:159]
    v_mfma_f32_16x16x32_bf16 v[160:163], v[80:83], v[32:35], v[160:163]
    ds_read_b64_tr_b16 v[78:79], v8 offset:16640
    v_mfma_f32_16x16x32_bf16 v[164:167], v[80:83], v[36:39], v[164:167]
    s_waitcnt lgkmcnt(6)
    v_mfma_f32_16x16x32_bf16 v[168:171], v[64:67], v[24:27], v[168:171]
    ds_read_b64_tr_b16 v[80:81], v8 offset:18432
    v_mfma_f32_16x16x32_bf16 v[172:175], v[64:67], v[28:31], v[172:175]
    v_mfma_f32_16x16x32_bf16 v[176:179], v[64:67], v[32:35], v[176:179]
    ds_read_b64_tr_b16 v[82:83], v8 offset:18688
    v_mfma_f32_16x16x32_bf16 v[180:183], v[64:67], v[36:39], v[180:183]
    s_waitcnt lgkmcnt(6)
    v_mfma_f32_16x16x32_bf16 v[184:187], v[68:71], v[24:27], v[184:187]
    v_mfma_f32_16x16x32_bf16 v[188:191], v[68:71], v[28:31], v[188:191]
    v_mfma_f32_16x16x32_bf16 v[192:195], v[68:71], v[32:35], v[192:195]
    v_mfma_f32_16x16x32_bf16 v[196:199], v[68:71], v[36:39], v[196:199]
    s_waitcnt lgkmcnt(0)
    s_barrier
    v_mfma_f32_16x16x32_bf16 v[200:203], v[72:75], v[24:27], v[200:203]
    ds_read_b64_tr_b16 v[64:65], v4 offset:20480
    v_mfma_f32_16x16x32_bf16 v[204:207], v[72:75], v[28:31], v[204:207]
    ds_read_b64_tr_b16 v[66:67], v4 offset:20992
    v_mfma_f32_16x16x32_bf16 v[208:211], v[72:75], v[32:35], v[208:211]
    ds_read_b128 v[40:43], v15 offset:0
    v_mfma_f32_16x16x32_bf16 v[212:215], v[72:75], v[36:39], v[212:215]
    ds_read_b128 v[44:47], v15 offset:2048
    v_mfma_f32_16x16x32_bf16 v[216:219], v[76:79], v[24:27], v[216:219]
    ds_read_b128 v[48:51], v15 offset:4096
    v_mfma_f32_16x16x32_bf16 v[220:223], v[76:79], v[28:31], v[220:223]
    ds_read_b128 v[52:55], v15 offset:6144
    v_mfma_f32_16x16x32_bf16 v[224:227], v[76:79], v[32:35], v[224:227]
    ds_read_b64_tr_b16 v[68:69], v4 offset:28672
    v_mfma_f32_16x16x32_bf16 v[228:231], v[76:79], v[36:39], v[228:231]
    ds_read_b64_tr_b16 v[70:71], v4 offset:29184
    v_mfma_f32_16x16x32_bf16 v[232:235], v[80:83], v[24:27], v[232:235]
    ds_read_b64_tr_b16 v[72:73], v5 offset:20480
    v_mfma_f32_16x16x32_bf16 v[236:239], v[80:83], v[28:31], v[236:239]
    v_mfma_f32_16x16x32_bf16 v[240:243], v[80:83], v[32:35], v[240:243]
    ds_read_b64_tr_b16 v[74:75], v5 offset:20992
    v_mfma_f32_16x16x32_bf16 v[244:247], v[80:83], v[36:39], v[244:247]
    s_waitcnt lgkmcnt(7)
    v_mfma_f32_16x16x32_bf16 v[88:91], v[64:67], v[40:43], v[88:91]
    ds_read_b64_tr_b16 v[76:77], v5 offset:28672
    s_waitcnt lgkmcnt(7)
    v_mfma_f32_16x16x32_bf16 v[92:95], v[64:67], v[44:47], v[92:95]
    ds_read_b64_tr_b16 v[78:79], v5 offset:29184
    s_waitcnt lgkmcnt(7)
    v_mfma_f32_16x16x32_bf16 v[96:99], v[64:67], v[48:51], v[96:99]
    ds_read_b64_tr_b16 v[80:81], v6 offset:20480
    s_waitcnt lgkmcnt(7)
    v_mfma_f32_16x16x32_bf16 v[100:103], v[64:67], v[52:55], v[100:103]
    ds_read_b64_tr_b16 v[82:83], v6 offset:20992
    s_waitcnt lgkmcnt(6)
    v_mfma_f32_16x16x32_bf16 v[104:107], v[68:71], v[40:43], v[104:107]
    ds_read_b64_tr_b16 v[64:65], v6 offset:28672
    v_mfma_f32_16x16x32_bf16 v[108:111], v[68:71], v[44:47], v[108:111]
    v_add_u32 v14, s80, v16
    v_mfma_f32_16x16x32_bf16 v[112:115], v[68:71], v[48:51], v[112:115]
    ds_read_b64_tr_b16 v[66:67], v6 offset:29184
    v_mfma_f32_16x16x32_bf16 v[116:119], v[68:71], v[52:55], v[116:119]
    v_add_u32 v15, s80, v17
    s_waitcnt lgkmcnt(6)
    v_mfma_f32_16x16x32_bf16 v[120:123], v[72:75], v[40:43], v[120:123]
    ds_read_b64_tr_b16 v[68:69], v7 offset:20480
    v_mfma_f32_16x16x32_bf16 v[124:127], v[72:75], v[44:47], v[124:127]
    s_add_u32 s80, s80, 18432
    v_mfma_f32_16x16x32_bf16 v[128:131], v[72:75], v[48:51], v[128:131]
    ds_read_b64_tr_b16 v[70:71], v7 offset:20992
    v_mfma_f32_16x16x32_bf16 v[132:135], v[72:75], v[52:55], v[132:135]
    s_cmp_ge_u32 s80, 153600
    s_cselect_b32 s84, 55296, 0
    s_waitcnt lgkmcnt(6)
    v_mfma_f32_16x16x32_bf16 v[136:139], v[76:79], v[40:43], v[136:139]
    ds_read_b64_tr_b16 v[72:73], v7 offset:28672
    v_mfma_f32_16x16x32_bf16 v[140:143], v[76:79], v[44:47], v[140:143]
    s_sub_u32 s80, s80, s84
    v_mfma_f32_16x16x32_bf16 v[144:147], v[76:79], v[48:51], v[144:147]
    ds_read_b64_tr_b16 v[74:75], v7 offset:29184
    v_mfma_f32_16x16x32_bf16 v[148:151], v[76:79], v[52:55], v[148:151]
    s_waitcnt lgkmcnt(6)
    v_mfma_f32_16x16x32_bf16 v[152:155], v[80:83], v[40:43], v[152:155]
    ds_read_b64_tr_b16 v[76:77], v8 offset:36864
    v_mfma_f32_16x16x32_bf16 v[156:159], v[80:83], v[44:47], v[156:159]
    v_mfma_f32_16x16x32_bf16 v[160:163], v[80:83], v[48:51], v[160:163]
    ds_read_b64_tr_b16 v[78:79], v8 offset:37120
    v_mfma_f32_16x16x32_bf16 v[164:167], v[80:83], v[52:55], v[164:167]
    s_waitcnt lgkmcnt(6)
    v_mfma_f32_16x16x32_bf16 v[168:171], v[64:67], v[40:43], v[168:171]
    ds_read_b64_tr_b16 v[80:81], v8 offset:38912
    v_mfma_f32_16x16x32_bf16 v[172:175], v[64:67], v[44:47], v[172:175]
    v_mfma_f32_16x16x32_bf16 v[176:179], v[64:67], v[48:51], v[176:179]
    ds_read_b64_tr_b16 v[82:83], v8 offset:39168
    v_mfma_f32_16x16x32_bf16 v[180:183], v[64:67], v[52:55], v[180:183]
    s_waitcnt lgkmcnt(6)
    v_mfma_f32_16x16x32_bf16 v[184:187], v[68:71], v[40:43], v[184:187]
    v_mfma_f32_16x16x32_bf16 v[188:191], v[68:71], v[44:47], v[188:191]
    v_mfma_f32_16x16x32_bf16 v[192:195], v[68:71], v[48:51], v[192:195]
    v_mfma_f32_16x16x32_bf16 v[196:199], v[68:71], v[52:55], v[196:199]
    s_waitcnt lgkmcnt(0)
    s_barrier
    v_mfma_f32_16x16x32_bf16 v[200:203], v[72:75], v[40:43], v[200:203]
    ds_read_b64_tr_b16 v[64:65], v9 offset:0
    v_mfma_f32_16x16x32_bf16 v[204:207], v[72:75], v[44:47], v[204:207]
    ds_read_b64_tr_b16 v[66:67], v9 offset:512
    v_mfma_f32_16x16x32_bf16 v[208:211], v[72:75], v[48:51], v[208:211]
    ds_read_b128 v[24:27], v14 offset:0
    v_mfma_f32_16x16x32_bf16 v[212:215], v[72:75], v[52:55], v[212:215]
    ds_read_b128 v[28:31], v14 offset:2048
    v_mfma_f32_16x16x32_bf16 v[216:219], v[76:79], v[40:43], v[216:219]
    ds_read_b128 v[32:35], v14 offset:4096
    v_mfma_f32_16x16x32_bf16 v[220:223], v[76:79], v[44:47], v[220:223]
    ds_read_b128 v[36:39], v14 offset:6144
    v_mfma_f32_16x16x32_bf16 v[224:227], v[76:79], v[48:51], v[224:227]
    ds_read_b64_tr_b16 v[68:69], v9 offset:8192
    v_mfma_f32_16x16x32_bf16 v[228:231], v[76:79], v[52:55], v[228:231]
    ds_read_b64_tr_b16 v[70:71], v9 offset:8704
    v_mfma_f32_16x16x32_bf16 v[232:235], v[80:83], v[40:43], v[232:235]
    ds_read_b64_tr_b16 v[72:73], v10 offset:0
    v_mfma_f32_16x16x32_bf16 v[236:239], v[80:83], v[44:47], v[236:239]
    v_mfma_f32_16x16x32_bf16 v[240:243], v[80:83], v[48:51], v[240:243]
    ds_read_b64_tr_b16 v[74:75], v10 offset:512
    v_mfma_f32_16x16x32_bf16 v[244:247], v[80:83], v[52:55], v[244:247]
    s_waitcnt lgkmcnt(7)
    v_mfma_f32_16x16x32_bf16 v[88:91], v[64:67], v[24:27], v[88:91]
    ds_read_b64_tr_b16 v[76:77], v10 offset:8192
    s_waitcnt lgkmcnt(7)
    v_mfma_f32_16x16x32_bf16 v[92:95], v[64:67], v[28:31], v[92:95]
    ds_read_b64_tr_b16 v[78:79], v10 offset:8704
    s_waitcnt lgkmcnt(7)
    v_mfma_f32_16x16x32_bf16 v[96:99], v[64:67], v[32:35], v[96:99]
    ds_read_b64_tr_b16 v[80:81], v11 offset:0
    s_waitcnt lgkmcnt(7)
    v_mfma_f32_16x16x32_bf16 v[100:103], v[64:67], v[36:39], v[100:103]
    ds_read_b64_tr_b16 v[82:83], v11 offset:512
    s_waitcnt lgkmcnt(6)
    v_mfma_f32_16x16x32_bf16 v[104:107], v[68:71], v[24:27], v[104:107]
    ds_read_b64_tr_b16 v[64:65], v11 offset:8192
    v_mfma_f32_16x16x32_bf16 v[108:111], v[68:71], v[28:31], v[108:111]
    v_mfma_f32_16x16x32_bf16 v[112:115], v[68:71], v[32:35], v[112:115]
    ds_read_b64_tr_b16 v[66:67], v11 offset:8704
    v_mfma_f32_16x16x32_bf16 v[116:119], v[68:71], v[36:39], v[116:119]
    s_waitcnt lgkmcnt(6)
    v_mfma_f32_16x16x32_bf16 v[120:123], v[72:75], v[24:27], v[120:123]
    ds_read_b64_tr_b16 v[68:69], v12 offset:0
    v_mfma_f32_16x16x32_bf16 v[124:127], v[72:75], v[28:31], v[124:127]
    v_mfma_f32_16x16x32_bf16 v[128:131], v[72:75], v[32:35], v[128:131]
    ds_read_b64_tr_b16 v[70:71], v12 offset:512
    v_mfma_f32_16x16x32_bf16 v[132:135], v[72:75], v[36:39], v[132:135]
    s_waitcnt lgkmcnt(6)
    v_mfma_f32_16x16x32_bf16 v[136:139], v[76:79], v[24:27], v[136:139]
    ds_read_b64_tr_b16 v[72:73], v12 offset:8192
    v_mfma_f32_16x16x32_bf16 v[140:143], v[76:79], v[28:31], v[140:143]
    v_mfma_f32_16x16x32_bf16 v[144:147], v[76:79], v[32:35], v[144:147]
    ds_read_b64_tr_b16 v[74:75], v12 offset:8704
    v_mfma_f32_16x16x32_bf16 v[148:151], v[76:79], v[36:39], v[148:151]
    s_waitcnt lgkmcnt(6)
    v_mfma_f32_16x16x32_bf16 v[152:155], v[80:83], v[24:27], v[152:155]
    ds_read_b64_tr_b16 v[76:77], v13 offset:16384
    v_mfma_f32_16x16x32_bf16 v[156:159], v[80:83], v[28:31], v[156:159]
    v_mfma_f32_16x16x32_bf16 v[160:163], v[80:83], v[32:35], v[160:163]
    ds_read_b64_tr_b16 v[78:79], v13 offset:16640
    v_mfma_f32_16x16x32_bf16 v[164:167], v[80:83], v[36:39], v[164:167]
    s_waitcnt lgkmcnt(6)
    v_mfma_f32_16x16x32_bf16 v[168:171], v[64:67], v[24:27], v[168:171]
    ds_read_b64_tr_b16 v[80:81], v13 offset:18432
    v_mfma_f32_16x16x32_bf16 v[172:175], v[64:67], v[28:31], v[172:175]
    v_mfma_f32_16x16x32_bf16 v[176:179], v[64:67], v[32:35], v[176:179]
    ds_read_b64_tr_b16 v[82:83], v13 offset:18688
    v_mfma_f32_16x16x32_bf16 v[180:183], v[64:67], v[36:39], v[180:183]
    s_waitcnt lgkmcnt(6)
    v_mfma_f32_16x16x32_bf16 v[184:187], v[68:71], v[24:27], v[184:187]
    v_mfma_f32_16x16x32_bf16 v[188:191], v[68:71], v[28:31], v[188:191]
    v_mfma_f32_16x16x32_bf16 v[192:195], v[68:71], v[32:35], v[192:195]
    v_mfma_f32_16x16x32_bf16 v[196:199], v[68:71], v[36:39], v[196:199]
    s_waitcnt lgkmcnt(0)
    s_barrier
    v_mfma_f32_16x16x32_bf16 v[200:203], v[72:75], v[24:27], v[200:203]
    ds_read_b64_tr_b16 v[64:65], v9 offset:20480
    v_mfma_f32_16x16x32_bf16 v[204:207], v[72:75], v[28:31], v[204:207]
    ds_read_b64_tr_b16 v[66:67], v9 offset:20992
    v_mfma_f32_16x16x32_bf16 v[208:211], v[72:75], v[32:35], v[208:211]
    ds_read_b128 v[40:43], v15 offset:0
    v_mfma_f32_16x16x32_bf16 v[212:215], v[72:75], v[36:39], v[212:215]
    ds_read_b128 v[44:47], v15 offset:2048
    v_mfma_f32_16x16x32_bf16 v[216:219], v[76:79], v[24:27], v[216:219]
    ds_read_b128 v[48:51], v15 offset:4096
    v_mfma_f32_16x16x32_bf16 v[220:223], v[76:79], v[28:31], v[220:223]
    ds_read_b128 v[52:55], v15 offset:6144
    v_mfma_f32_16x16x32_bf16 v[224:227], v[76:79], v[32:35], v[224:227]
    ds_read_b64_tr_b16 v[68:69], v9 offset:28672
    v_mfma_f32_16x16x32_bf16 v[228:231], v[76:79], v[36:39], v[228:231]
    ds_read_b64_tr_b16 v[70:71], v9 offset:29184
    v_mfma_f32_16x16x32_bf16 v[232:235], v[80:83], v[24:27], v[232:235]
    ds_read_b64_tr_b16 v[72:73], v10 offset:20480
    v_mfma_f32_16x16x32_bf16 v[236:239], v[80:83], v[28:31], v[236:239]
    v_mfma_f32_16x16x32_bf16 v[240:243], v[80:83], v[32:35], v[240:243]
    ds_read_b64_tr_b16 v[74:75], v10 offset:20992
    v_mfma_f32_16x16x32_bf16 v[244:247], v[80:83], v[36:39], v[244:247]
    s_waitcnt lgkmcnt(7)
    v_mfma_f32_16x16x32_bf16 v[88:91], v[64:67], v[40:43], v[88:91]
    ds_read_b64_tr_b16 v[76:77], v10 offset:28672
    s_waitcnt lgkmcnt(7)
    v_mfma_f32_16x16x32_bf16 v[92:95], v[64:67], v[44:47], v[92:95]
    ds_read_b64_tr_b16 v[78:79], v10 offset:29184
    s_waitcnt lgkmcnt(7)
    v_mfma_f32_16x16x32_bf16 v[96:99], v[64:67], v[48:51], v[96:99]
    ds_read_b64_tr_b16 v[80:81], v11 offset:20480
    s_waitcnt lgkmcnt(7)
    v_mfma_f32_16x16x32_bf16 v[100:103], v[64:67], v[52:55], v[100:103]
    ds_read_b64_tr_b16 v[82:83], v11 offset:20992
    s_waitcnt lgkmcnt(6)
    v_mfma_f32_16x16x32_bf16 v[104:107], v[68:71], v[40:43], v[104:107]
    ds_read_b64_tr_b16 v[64:65], v11 offset:28672
    v_mfma_f32_16x16x32_bf16 v[108:111], v[68:71], v[44:47], v[108:111]
    v_add_u32 v14, s80, v16
    v_mfma_f32_16x16x32_bf16 v[112:115], v[68:71], v[48:51], v[112:115]
    ds_read_b64_tr_b16 v[66:67], v11 offset:29184
    v_mfma_f32_16x16x32_bf16 v[116:119], v[68:71], v[52:55], v[116:119]
    v_add_u32 v15, s80, v17
    s_waitcnt lgkmcnt(6)
    v_mfma_f32_16x16x32_bf16 v[120:123], v[72:75], v[40:43], v[120:123]
    ds_read_b64_tr_b16 v[68:69], v12 offset:20480
    v_mfma_f32_16x16x32_bf16 v[124:127], v[72:75], v[44:47], v[124:127]
    s_add_u32 s80, s80, 18432
    v_mfma_f32_16x16x32_bf16 v[128:131], v[72:75], v[48:51], v[128:131]
    ds_read_b64_tr_b16 v[70:71], v12 offset:20992
    v_mfma_f32_16x16x32_bf16 v[132:135], v[72:75], v[52:55], v[132:135]
    s_cmp_ge_u32 s80, 153600
    s_cselect_b32 s84, 55296, 0
    s_waitcnt lgkmcnt(6)
    v_mfma_f32_16x16x32_bf16 v[136:139], v[76:79], v[40:43], v[136:139]
    ds_read_b64_tr_b16 v[72:73], v12 offset:28672
    v_mfma_f32_16x16x32_bf16 v[140:143], v[76:79], v[44:47], v[140:143]
    s_sub_u32 s80, s80, s84
    v_mfma_f32_16x16x32_bf16 v[144:147], v[76:79], v[48:51], v[144:147]
    ds_read_b64_tr_b16 v[74:75], v12 offset:29184
    v_mfma_f32_16x16x32_bf16 v[148:151], v[76:79], v[52:55], v[148:151]
    s_waitcnt lgkmcnt(6)
    v_mfma_f32_16x16x32_bf16 v[152:155], v[80:83], v[40:43], v[152:155]
    ds_read_b64_tr_b16 v[76:77], v13 offset:36864
    v_mfma_f32_16x16x32_bf16 v[156:159], v[80:83], v[44:47], v[156:159]
    v_mfma_f32_16x16x32_bf16 v[160:163], v[80:83], v[48:51], v[160:163]
    ds_read_b64_tr_b16 v[78:79], v13 offset:37120
    v_mfma_f32_16x16x32_bf16 v[164:167], v[80:83], v[52:55], v[164:167]
    s_waitcnt lgkmcnt(6)
    v_mfma_f32_16x16x32_bf16 v[168:171], v[64:67], v[40:43], v[168:171]
    ds_read_b64_tr_b16 v[80:81], v13 offset:38912
    v_mfma_f32_16x16x32_bf16 v[172:175], v[64:67], v[44:47], v[172:175]
    v_mfma_f32_16x16x32_bf16 v[176:179], v[64:67], v[48:51], v[176:179]
    ds_read_b64_tr_b16 v[82:83], v13 offset:39168
    v_mfma_f32_16x16x32_bf16 v[180:183], v[64:67], v[52:55], v[180:183]
    s_waitcnt lgkmcnt(6)
    v_mfma_f32_16x16x32_bf16 v[184:187], v[68:71], v[40:43], v[184:187]
    v_mfma_f32_16x16x32_bf16 v[188:191], v[68:71], v[44:47], v[188:191]
    v_mfma_f32_16x16x32_bf16 v[192:195], v[68:71], v[48:51], v[192:195]
    v_mfma_f32_16x16x32_bf16 v[196:199], v[68:71], v[52:55], v[196:199]
    s_waitcnt lgkmcnt(0)
    s_barrier
    v_mfma_f32_16x16x32_bf16 v[200:203], v[72:75], v[40:43], v[200:203]
    ds_read_b64_tr_b16 v[64:65], v4 offset:0
    v_mfma_f32_16x16x32_bf16 v[204:207], v[72:75], v[44:47], v[204:207]
    ds_read_b64_tr_b16 v[66:67], v4 offset:512
    v_mfma_f32_16x16x32_bf16 v[208:211], v[72:75], v[48:51], v[208:211]
    ds_read_b128 v[24:27], v14 offset:0
    v_mfma_f32_16x16x32_bf16 v[212:215], v[72:75], v[52:55], v[212:215]
    ds_read_b128 v[28:31], v14 offset:2048
    v_mfma_f32_16x16x32_bf16 v[216:219], v[76:79], v[40:43], v[216:219]
    ds_read_b128 v[32:35], v14 offset:4096
    v_mfma_f32_16x16x32_bf16 v[220:223], v[76:79], v[44:47], v[220:223]
    ds_read_b128 v[36:39], v14 offset:6144
    v_mfma_f32_16x16x32_bf16 v[224:227], v[76:79], v[48:51], v[224:227]
    ds_read_b64_tr_b16 v[68:69], v4 offset:8192
    v_mfma_f32_16x16x32_bf16 v[228:231], v[76:79], v[52:55], v[228:231]
    ds_read_b64_tr_b16 v[70:71], v4 offset:8704
    v_mfma_f32_16x16x32_bf16 v[232:235], v[80:83], v[40:43], v[232:235]
    ds_read_b64_tr_b16 v[72:73], v5 offset:0
    v_mfma_f32_16x16x32_bf16 v[236:239], v[80:83], v[44:47], v[236:239]
    v_mfma_f32_16x16x32_bf16 v[240:243], v[80:83], v[48:51], v[240:243]
    ds_read_b64_tr_b16 v[74:75], v5 offset:512
    v_mfma_f32_16x16x32_bf16 v[244:247], v[80:83], v[52:55], v[244:247]
    s_sub_u32 s34, s34, 1
    s_cmp_lg_u32 s34, 0
    s_cbranch_scc1 L_p1
    s_waitcnt lgkmcnt(7)
    v_mfma_f32_16x16x32_bf16 v[88:91], v[64:67], v[24:27], v[88:91]
    ds_read_b64_tr_b16 v[76:77], v5 offset:8192
    s_waitcnt lgkmcnt(7)
    v_mfma_f32_16x16x32_bf16 v[92:95], v[64:67], v[28:31], v[92:95]
    ds_read_b64_tr_b16 v[78:79], v5 offset:8704
    s_waitcnt lgkmcnt(7)
    v_mfma_f32_16x16x32_bf16 v[96:99], v[64:67], v[32:35], v[96:99]
    ds_read_b64_tr_b16 v[80:81], v6 offset:0
    s_waitcnt lgkmcnt(7)
    v_mfma_f32_16x16x32_bf16 v[100:103], v[64:67], v[36:39], v[100:103]
    ds_read_b64_tr_b16 v[82:83], v6 offset:512
    s_waitcnt lgkmcnt(6)
    v_mfma_f32_16x16x32_bf16 v[104:107], v[68:71], v[24:27], v[104:107]
    ds_read_b64_tr_b16 v[64:65], v6 offset:8192
    v_mfma_f32_16x16x32_bf16 v[108:111], v[68:71], v[28:31], v[108:111]
    v_mfma_f32_16x16x32_bf16 v[112:115], v[68:71], v[32:35], v[112:115]
    ds_read_b64_tr_b16 v[66:67], v6 offset:8704
    v_mfma_f32_16x16x32_bf16 v[116:119], v[68:71], v[36:39], v[116:119]
    s_waitcnt lgkmcnt(6)
    v_mfma_f32_16x16x32_bf16 v[120:123], v[72:75], v[24:27], v[120:123]
    ds_read_b64_tr_b16 v[68:69], v7 offset:0
    v_mfma_f32_16x16x32_bf16 v[124:127], v[72:75], v[28:31], v[124:127]
    v_mfma_f32_16x16x32_bf16 v[128:131], v[72:75], v[32:35], v[128:131]
    ds_read_b64_tr_b16 v[70:71], v7 offset:512
    v_mfma_f32_16x16x32_bf16 v[132:135], v[72:75], v[36:39], v[132:135]
    s_waitcnt lgkmcnt(6)
    v_mfma_f32_16x16x32_bf16 v[136:139], v[76:79], v[24:27], v[136:139]
    ds_read_b64_tr_b16 v[72:73], v7 offset:8192
    v_mfma_f32_16x16x32_bf16 v[140:143], v[76:79], v[28:31], v[140:143]
    v_mfma_f32_16x16x32_bf16 v[144:147], v[76:79], v[32:35], v[144:147]
    ds_read_b64_tr_b16 v[74:75], v7 offset:8704
    v_mfma_f32_16x16x32_bf16 v[148:151], v[76:79], v[36:39], v[148:151]
    s_waitcnt lgkmcnt(6)
    v_mfma_f32_16x16x32_bf16 v[152:155], v[80:83], v[24:27], v[152:155]
    ds_read_b64_tr_b16 v[76:77], v8 offset:16384
    v_mfma_f32_16x16x32_bf16 v[156:159], v[80:83], v[28:31], v[156:159]
    v_mfma_f32_16x16x32_bf16 v[160:163], v[80:83], v[32:35], v[160:163]
    ds_read_b64_tr_b16 v[78:79], v8 offset:16640
    v_mfma_f32_16x16x32_bf16 v[164:167], v[80:83], v[36:39], v[164:167]
    s_waitcnt lgkmcnt(6)
    v_mfma_f32_16x16x32_bf16 v[168:171], v[64:67], v[24:27], v[168:171]
    ds_read_b64_tr_b16 v[80:81], v8 offset:18432
    v_mfma_f32_16x16x32_bf16 v[172:175], v[64:67], v[28:31], v[172:175]
    v_mfma_f32_16x16x32_bf16 v[176:179], v[64:67], v[32:35], v[176:179]
    ds_read_b64_tr_b16 v[82:83], v8 offset:18688
    v_mfma_f32_16x16x32_bf16 v[180:183], v[64:67], v[36:39], v[180:183]
    s_waitcnt lgkmcnt(6)
    v_mfma_f32_16x16x32_bf16 v[184:187], v[68:71], v[24:27], v[184:187]
    v_mfma_f32_16x16x32_bf16 v[188:191], v[68:71], v[28:31], v[188:191]
    v_mfma_f32_16x16x32_bf16 v[192:195], v[68:71], v[32:35], v[192:195]
    v_mfma_f32_16x16x32_bf16 v[196:199], v[68:71], v[36:39], v[196:199]
    s_waitcnt lgkmcnt(0)
    s_barrier
    v_mfma_f32_16x16x32_bf16 v[200:203], v[72:75], v[24:27], v[200:203]
    ds_read_b64_tr_b16 v[64:65], v4 offset:20480
    v_mfma_f32_16x16x32_bf16 v[204:207], v[72:75], v[28:31], v[204:207]
    ds_read_b64_tr_b16 v[66:67], v4 offset:20992
    v_mfma_f32_16x16x32_bf16 v[208:211], v[72:75], v[32:35], v[208:211]
    ds_read_b128 v[40:43], v15 offset:0
L_pad0:
    s_cbranch_execz L_vret0
    v_mfma_f32_16x16x32_bf16 v[212:215], v[72:75], v[36:39], v[212:215]
    ds_read_b128 v[44:47], v15 offset:2048
    v_mfma_f32_16x16x32_bf16 v[216:219], v[76:79], v[24:27], v[216:219]
    ds_read_b128 v[48:51], v15 offset:4096
    v_mfma_f32_16x16x32_bf16 v[220:223], v[76:79], v[28:31], v[220:223]
    ds_read_b128 v[52:55], v15 offset:6144
    v_mfma_f32_16x16x32_bf16 v[224:227], v[76:79], v[32:35], v[224:227]
    ds_read_b64_tr_b16 v[68:69], v4 offset:28672
    v_mfma_f32_16x16x32_bf16 v[228:231], v[76:79], v[36:39], v[228:231]
    ds_read_b64_tr_b16 v[70:71], v4 offset:29184
    v_mfma_f32_16x16x32_bf16 v[232:235], v[80:83], v[24:27], v[232:235]
    ds_read_b64_tr_b16 v[72:73], v5 offset:20480
    v_mfma_f32_16x16x32_bf16 v[236:239], v[80:83], v[28:31], v[236:239]
    v_mfma_f32_16x16x32_bf16 v[240:243], v[80:83], v[32:35], v[240:243]
    ds_read_b64_tr_b16 v[74:75], v5 offset:20992
    v_mfma_f32_16x16x32_bf16 v[244:247], v[80:83], v[36:39], v[244:247]
    s_waitcnt lgkmcnt(7)
    v_mfma_f32_16x16x32_bf16 v[88:91], v[64:67], v[40:43], v[88:91]
    ds_read_b64_tr_b16 v[76:77], v5 offset:28672
    s_waitcnt lgkmcnt(7)
    v_mfma_f32_16x16x32_bf16 v[92:95], v[64:67], v[44:47], v[92:95]
    ds_read_b64_tr_b16 v[78:79], v5 offset:29184
    s_waitcnt lgkmcnt(7)
    v_mfma_f32_16x16x32_bf16 v[96:99], v[64:67], v[48:51], v[96:99]
    ds_read_b64_tr_b16 v[80:81], v6 offset:20480
    s_waitcnt lgkmcnt(7)
    v_mfma_f32_16x16x32_bf16 v[100:103], v[64:67], v[52:55], v[100:103]
    ds_read_b64_tr_b16 v[82:83], v6 offset:20992
    s_waitcnt lgkmcnt(6)
    v_mfma_f32_16x16x32_bf16 v[104:107], v[68:71], v[40:43], v[104:107]
    ds_read_b64_tr_b16 v[64:65], v6 offset:28672
    v_mfma_f32_16x16x32_bf16 v[108:111], v[68:71], v[44:47], v[108:111]
    v_add_u32 v14, s80, v16
    v_mfma_f32_16x16x32_bf16 v[112:115], v[68:71], v[48:51], v[112:115]
    ds_read_b64_tr_b16 v[66:67], v6 offset:29184
    v_mfma_f32_16x16x32_bf16 v[116:119], v[68:71], v[52:55], v[116:119]
    v_add_u32 v15, s80, v17
    s_waitcnt lgkmcnt(6)
    v_mfma_f32_16x16x32_bf16 v[120:123], v[72:75], v[40:43], v[120:123]
    ds_read_b64_tr_b16 v[68:69], v7 offset:20480
    v_mfma_f32_16x16x32_bf16 v[124:127], v[72:75], v[44:47], v[124:127]
    s_add_u32 s80, s80, 18432
    v_mfma_f32_16x16x32_bf16 v[128:131], v[72:75], v[48:51], v[128:131]
    ds_read_b64_tr_b16 v[70:71], v7 offset:20992
    v_mfma_f32_16x16x32_bf16 v[132:135], v[72:75], v[52:55], v[132:135]
    s_cmp_ge_u32 s80, 153600
    s_cselect_b32 s84, 55296, 0
    s_waitcnt lgkmcnt(6)
    v_mfma_f32_16x16x32_bf16 v[136:139], v[76:79], v[40:43], v[136:139]
    ds_read_b64_tr_b16 v[72:73], v7 offset:28672
    v_mfma_f32_16x16x32_bf16 v[140:143], v[76:79], v[44:47], v[140:143]
    s_sub_u32 s80, s80, s84
    v_mfma_f32_16x16x32_bf16 v[144:147], v[76:79], v[48:51], v[144:147]
    ds_read_b64_tr_b16 v[74:75], v7 offset:29184
    v_mfma_f32_16x16x32_bf16 v[148:151], v[76:79], v[52:55], v[148:151]
    s_waitcnt lgkmcnt(6)
    v_mfma_f32_16x16x32_bf16 v[152:155], v[80:83], v[40:43], v[152:155]
    ds_read_b64_tr_b16 v[76:77], v8 offset:36864
    v_mfma_f32_16x16x32_bf16 v[156:159], v[80:83], v[44:47], v[156:159]
    v_mfma_f32_16x16x32_bf16 v[160:163], v[80:83], v[48:51], v[160:163]
    ds_read_b64_tr_b16 v[78:79], v8 offset:37120
    v_mfma_f32_16x16x32_bf16 v[164:167], v[80:83], v[52:55], v[164:167]
    s_waitcnt lgkmcnt(6)
    v_mfma_f32_16x16x32_bf16 v[168:171], v[64:67], v[40:43], v[168:171]
    ds_read_b64_tr_b16 v[80:81], v8 offset:38912
    v_mfma_f32_16x16x32_bf16 v[172:175], v[64:67], v[44:47], v[172:175]
    v_mfma_f32_16x16x32_bf16 v[176:179], v[64:67], v[48:51], v[176:179]
    ds_read_b64_tr_b16 v[82:83], v8 offset:39168
    v_mfma_f32_16x16x32_bf16 v[180:183], v[64:67], v[52:55], v[180:183]
    s_waitcnt lgkmcnt(6)
    v_mfma_f32_16x16x32_bf16 v[184:187], v[68:71], v[40:43], v[184:187]
    v_mfma_f32_16x16x32_bf16 v[188:191], v[68:71], v[44:47], v[188:191]
    v_mfma_f32_16x16x32_bf16 v[192:195], v[68:71], v[48:51], v[192:195]
    v_mfma_f32_16x16x32_bf16 v[196:199], v[68:71], v[52:55], v[196:199]
    s_waitcnt lgkmcnt(0)
    s_barrier
    v_mfma_f32_16x16x32_bf16 v[200:203], v[72:75], v[40:43], v[200:203]
    ds_read_b64_tr_b16 v[64:65], v9 offset:0
    v_mfma_f32_16x16x32_bf16 v[204:207], v[72:75], v[44:47], v[204:207]
    ds_read_b64_tr_b16 v[66:67], v9 offset:512
    v_mfma_f32_16x16x32_bf16 v[208:211], v[72:75], v[48:51], v[208:211]
    ds_read_b128 v[24:27], v14 offset:0
    v_mfma_f32_16x16x32_bf16 v[212:215], v[72:75], v[52:55], v[212:215]
    ds_read_b128 v[28:31], v14 offset:2048
    v_mfma_f32_16x16x32_bf16 v[216:219], v[76:79], v[40:43], v[216:219]
    ds_read_b128 v[32:35], v14 offset:4096
    v_mfma_f32_16x16x32_bf16 v[220:223], v[76:79], v[44:47], v[220:223]
    ds_read_b128 v[36:39], v14 offset:6144
    v_mfma_f32_16x16x32_bf16 v[224:227], v[76:79], v[48:51], v[224:227]
    ds_read_b64_tr_b16 v[68:69], v9 offset:8192
    v_mfma_f32_16x16x32_bf16 v[228:231], v[76:79], v[52:55], v[228:231]
    ds_read_b64_tr_b16 v[70:71], v9 offset:8704
    v_mfma_f32_16x16x32_bf16 v[232:235], v[80:83], v[40:43], v[232:235]
    ds_read_b64_tr_b16 v[72:73], v10 offset:0
    v_mfma_f32_16x16x32_bf16 v[236:239], v[80:83], v[44:47], v[236:239]
    v_mfma_f32_16x16x32_bf16 v[240:243], v[80:83], v[48:51], v[240:243]
    ds_read_b64_tr_b16 v[74:75], v10 offset:512
    v_mfma_f32_16x16x32_bf16 v[244:247], v[80:83], v[52:55], v[244:247]
    s_waitcnt lgkmcnt(7)
    v_mfma_f32_16x16x32_bf16 v[88:91], v[64:67], v[24:27], v[88:91]
    ds_read_b64_tr_b16 v[76:77], v10 offset:8192
    s_waitcnt lgkmcnt(7)
    v_mfma_f32_16x16x32_bf16 v[92:95], v[64:67], v[28:31], v[92:95]
    ds_read_b64_tr_b16 v[78:79], v10 offset:8704
    s_waitcnt lgkmcnt(7)
    v_mfma_f32_16x16x32_bf16 v[96:99], v[64:67], v[32:35], v[96:99]
    ds_read_b64_tr_b16 v[80:81], v11 offset:0
    s_waitcnt lgkmcnt(7)
    v_mfma_f32_16x16x32_bf16 v[100:103], v[64:67], v[36:39], v[100:103]
    ds_read_b64_tr_b16 v[82:83], v11 offset:512
    s_waitcnt lgkmcnt(6)
    v_mfma_f32_16x16x32_bf16 v[104:107], v[68:71], v[24:27], v[104:107]
    ds_read_b64_tr_b16 v[64:65], v11 offset:8192
    v_mfma_f32_16x16x32_bf16 v[108:111], v[68:71], v[28:31], v[108:111]
    v_mfma_f32_16x16x32_bf16 v[112:115], v[68:71], v[32:35], v[112:115]
    ds_read_b64_tr_b16 v[66:67], v11 offset:8704
    v_mfma_f32_16x16x32_bf16 v[116:119], v[68:71], v[36:39], v[116:119]
    s_waitcnt lgkmcnt(6)
    v_mfma_f32_16x16x32_bf16 v[120:123], v[72:75], v[24:27], v[120:123]
    ds_read_b64_tr_b16 v[68:69], v12 offset:0
    v_mfma_f32_16x16x32_bf16 v[124:127], v[72:75], v[28:31], v[124:127]
    v_mfma_f32_16x16x32_bf16 v[128:131], v[72:75], v[32:35], v[128:131]
    ds_read_b64_tr_b16 v[70:71], v12 offset:512
    v_mfma_f32_16x16x32_bf16 v[132:135], v[72:75], v[36:39], v[132:135]
    s_waitcnt lgkmcnt(6)
    v_mfma_f32_16x16x32_bf16 v[136:139], v[76:79], v[24:27], v[136:139]
    ds_read_b64_tr_b16 v[72:73], v12 offset:8192
    v_mfma_f32_16x16x32_bf16 v[140:143], v[76:79], v[28:31], v[140:143]
    v_mfma_f32_16x16x32_bf16 v[144:147], v[76:79], v[32:35], v[144:147]
    ds_read_b64_tr_b16 v[74:75], v12 offset:8704
    v_mfma_f32_16x16x32_bf16 v[148:151], v[76:79], v[36:39], v[148:151]
    s_waitcnt lgkmcnt(6)
    v_mfma_f32_16x16x32_bf16 v[152:155], v[80:83], v[24:27], v[152:155]
    ds_read_b64_tr_b16 v[76:77], v13 offset:16384
    v_mfma_f32_16x16x32_bf16 v[156:159], v[80:83], v[28:31], v[156:159]
    v_mfma_f32_16x16x32_bf16 v[160:163], v[80:83], v[32:35], v[160:163]
    ds_read_b64_tr_b16 v[78:79], v13 offset:16640
    v_mfma_f32_16x16x32_bf16 v[164:167], v[80:83], v[36:39], v[164:167]
    s_waitcnt lgkmcnt(6)
    v_mfma_f32_16x16x32_bf16 v[168:171], v[64:67], v[24:27], v[168:171]
    ds_read_b64_tr_b16 v[80:81], v13 offset:18432
    v_mfma_f32_16x16x32_bf16 v[172:175], v[64:67], v[28:31], v[172:175]
    v_mfma_f32_16x16x32_bf16 v[176:179], v[64:67], v[32:35], v[176:179]
    ds_read_b64_tr_b16 v[82:83], v13 offset:18688
    v_mfma_f32_16x16x32_bf16 v[180:183], v[64:67], v[36:39], v[180:183]
    s_waitcnt lgkmcnt(6)
    v_mfma_f32_16x16x32_bf16 v[184:187], v[68:71], v[24:27], v[184:187]
    v_mfma_f32_16x16x32_bf16 v[188:191], v[68:71], v[28:31], v[188:191]
    v_mfma_f32_16x16x32_bf16 v[192:195], v[68:71], v[32:35], v[192:195]
    v_mfma_f32_16x16x32_bf16 v[196:199], v[68:71], v[36:39], v[196:199]
    s_waitcnt lgkmcnt(0)
    s_barrier
    v_mfma_f32_16x16x32_bf16 v[200:203], v[72:75], v[24:27], v[200:203]
    ds_read_b64_tr_b16 v[64:65], v9 offset:20480
    v_mfma_f32_16x16x32_bf16 v[204:207], v[72:75], v[28:31], v[204:207]
    ds_read_b64_tr_b16 v[66:67], v9 offset:20992
    v_mfma_f32_16x16x32_bf16 v[208:211], v[72:75], v[32:35], v[208:211]
    ds_read_b128 v[40:43], v15 offset:0
    v_mfma_f32_16x16x32_bf16 v[212:215], v[72:75], v[36:39], v[212:215]
    ds_read_b128 v[44:47], v15 offset:2048
    v_mfma_f32_16x16x32_bf16 v[216:219], v[76:79], v[24:27], v[216:219]
    ds_read_b128 v[48:51], v15 offset:4096
    v_mfma_f32_16x16x32_bf16 v[220:223], v[76:79], v[28:31], v[220:223]
    ds_read_b128 v[52:55], v15 offset:6144
    v_mfma_f32_16x16x32_bf16 v[224:227], v[76:79], v[32:35], v[224:227]
    ds_read_b64_tr_b16 v[68:69], v9 offset:28672
    v_mfma_f32_16x16x32_bf16 v[228:231], v[76:79], v[36:39], v[228:231]
    ds_read_b64_tr_b16 v[70:71], v9 offset:29184
    v_mfma_f32_16x16x32_bf16 v[232:235], v[80:83], v[24:27], v[232:235]
    ds_read_b64_tr_b16 v[72:73], v10 offset:20480
    v_mfma_f32_16x16x32_bf16 v[236:239], v[80:83], v[28:31], v[236:239]
    v_mfma_f32_16x16x32_bf16 v[240:243], v[80:83], v[32:35], v[240:243]
    ds_read_b64_tr_b16 v[74:75], v10 offset:20992
    v_mfma_f32_16x16x32_bf16 v[244:247], v[80:83], v[36:39], v[244:247]
    s_waitcnt lgkmcnt(7)
    v_mfma_f32_16x16x32_bf16 v[88:91], v[64:67], v[40:43], v[88:91]
    ds_read_b64_tr_b16 v[76:77], v10 offset:28672
    s_waitcnt lgkmcnt(7)
    v_mfma_f32_16x16x32_bf16 v[92:95], v[64:67], v[44:47], v[92:95]
    ds_read_b64_tr_b16 v[78:79], v10 offset:29184
    s_waitcnt lgkmcnt(7)
    v_mfma_f32_16x16x32_bf16 v[96:99], v[64:67], v[48:51], v[96:99]
    ds_read_b64_tr_b16 v[80:81], v11 offset:20480
    s_waitcnt lgkmcnt(7)
    v_mfma_f32_16x16x32_bf16 v[100:103], v[64:67], v[52:55], v[100:103]
    ds_read_b64_tr_b16 v[82:83], v11 offset:20992
    s_waitcnt lgkmcnt(6)
    v_mfma_f32_16x16x32_bf16 v[104:107], v[68:71], v[40:43], v[104:107]
    ds_read_b64_tr_b16 v[64:65], v11 offset:28672
    v_mfma_f32_16x16x32_bf16 v[108:111], v[68:71], v[44:47], v[108:111]
    v_mfma_f32_16x16x32_bf16 v[112:115], v[68:71], v[48:51], v[112:115]
    ds_read_b64_tr_b16 v[66:67], v11 offset:29184
    v_mfma_f32_16x16x32_bf16 v[116:119], v[68:71], v[52:55], v[116:119]
    s_waitcnt lgkmcnt(6)
    v_mfma_f32_16x16x32_bf16 v[120:123], v[72:75], v[40:43], v[120:123]
    ds_read_b64_tr_b16 v[68:69], v12 offset:20480
    v_mfma_f32_16x16x32_bf16 v[124:127], v[72:75], v[44:47], v[124:127]
    v_mfma_f32_16x16x32_bf16 v[128:131], v[72:75], v[48:51], v[128:131]
    ds_read_b64_tr_b16 v[70:71], v12 offset:20992
    v_mfma_f32_16x16x32_bf16 v[132:135], v[72:75], v[52:55], v[132:135]
    s_waitcnt lgkmcnt(6)
    v_mfma_f32_16x16x32_bf16 v[136:139], v[76:79], v[40:43], v[136:139]
    ds_read_b64_tr_b16 v[72:73], v12 offset:28672
    v_mfma_f32_16x16x32_bf16 v[140:143], v[76:79], v[44:47], v[140:143]
    v_mfma_f32_16x16x32_bf16 v[144:147], v[76:79], v[48:51], v[144:147]
    ds_read_b64_tr_b16 v[74:75], v12 offset:29184
    v_mfma_f32_16x16x32_bf16 v[148:151], v[76:79], v[52:55], v[148:151]
    s_waitcnt lgkmcnt(6)
    v_mfma_f32_16x16x32_bf16 v[152:155], v[80:83], v[40:43], v[152:155]
    ds_read_b64_tr_b16 v[76:77], v13 offset:36864
    v_mfma_f32_16x16x32_bf16 v[156:159], v[80:83], v[44:47], v[156:159]
    v_mfma_f32_16x16x32_bf16 v[160:163], v[80:83], v[48:51], v[160:163]
    ds_read_b64_tr_b16 v[78:79], v13 offset:37120
    v_mfma_f32_16x16x32_bf16 v[164:167], v[80:83], v[52:55], v[164:167]
    s_waitcnt lgkmcnt(6)
    v_mfma_f32_16x16x32_bf16 v[168:171], v[64:67], v[40:43], v[168:171]
    ds_read_b64_tr_b16 v[80:81], v13 offset:38912
    v_mfma_f32_16x16x32_bf16 v[172:175], v[64:67], v[44:47], v[172:175]
    v_mfma_f32_16x16x32_bf16 v[176:179], v[64:67], v[48:51], v[176:179]
    ds_read_b64_tr_b16 v[82:83], v13 offset:39168
    v_mfma_f32_16x16x32_bf16 v[180:183], v[64:67], v[52:55], v[180:183]
    s_waitcnt lgkmcnt(6)
    v_mfma_f32_16x16x32_bf16 v[184:187], v[68:71], v[40:43], v[184:187]
    v_mfma_f32_16x16x32_bf16 v[188:191], v[68:71], v[44:47], v[188:191]
    v_mfma_f32_16x16x32_bf16 v[192:195], v[68:71], v[48:51], v[192:195]
    v_mfma_f32_16x16x32_bf16 v[196:199], v[68:71], v[52:55], v[196:199]
    s_waitcnt lgkmcnt(0)
    s_barrier
    v_mfma_f32_16x16x32_bf16 v[200:203], v[72:75], v[40:43], v[200:203]
    v_mfma_f32_16x16x32_bf16 v[204:207], v[72:75], v[44:47], v[204:207]
    v_mfma_f32_16x16x32_bf16 v[208:211], v[72:75], v[48:51], v[208:211]
    v_mfma_f32_16x16x32_bf16 v[212:215], v[72:75], v[52:55], v[212:215]
    v_mfma_f32_16x16x32_bf16 v[216:219], v[76:79], v[40:43], v[216:219]
    v_mfma_f32_16x16x32_bf16 v[220:223], v[76:79], v[44:47], v[220:223]
    v_mfma_f32_16x16x32_bf16 v[224:227], v[76:79], v[48:51], v[224:227]
    v_mfma_f32_16x16x32_bf16 v[228:231], v[76:79], v[52:55], v[228:231]
    v_mfma_f32_16x16x32_bf16 v[232:235], v[80:83], v[40:43], v[232:235]
    v_mfma_f32_16x16x32_bf16 v[236:239], v[80:83], v[44:47], v[236:239]
    v_mfma_f32_16x16x32_bf16 v[240:243], v[80:83], v[48:51], v[240:243]
    v_mfma_f32_16x16x32_bf16 v[244:247], v[80:83], v[52:55], v[244:247]
    s_setprio 0
    s_lshl_b32 s84, s5, 10
    s_add_u32 s84, s84, 161024
    v_and_b32 v16, 15, v1
    v_lshl_add_u32 v16, v16, 4, s84
    ds_read_b128 v[64:67], v16 offset:0
    ds_read_b128 v[68:71], v16 offset:256
    ds_read_b128 v[72:75], v16 offset:512
    ds_read_b128 v[76:79], v16 offset:768
    v_and_b32 v17, 48, v1
    s_lshl_b32 s84, s6, 8
    s_add_u32 s84, s84, 159744
    v_add_u32 v16, s84, v17
    s_lshl_b32 s84, s6, 6
    s_add_u32 s84, s84, 159744
    v_add_u32 v17, s84, v17
    ds_read_b128 v[24:27], v16 offset:0
    ds_read_b128 v[28:31], v16 offset:640
    ds_read_b128 v[32:35], v16 offset:64
    ds_read_b128 v[36:39], v16 offset:704
    ds_read_b128 v[40:43], v16 offset:128
    ds_read_b128 v[44:47], v16 offset:768
    ds_read_b128 v[48:51], v16 offset:192
    ds_read_b128 v[52:55], v16 offset:832
    ds_read_b128 v[56:59], v17 offset:512
    ds_read_b128 v[60:63], v17 offset:1152
    s_memrealtime s[92:93]
    s_memtime s[90:91]
    s_add_u32 m0, s79, 116736
    s_mov_b32 s78, 256
    buffer_load_dwordx4 v20, s[36:39], s78 offen sc1 lds
    s_waitcnt lgkmcnt(0)
    s_mov_b32 s34, s92
    s_mov_b32 s35, s90
    v_fmac_f32 v88, v24, v64
    v_fmac_f32 v89, v25, v64
    v_fmac_f32 v90, v26, v64
    v_fmac_f32 v91, v27, v64
    v_fmac_f32 v104, v28, v64
    v_fmac_f32 v105, v29, v64
    v_fmac_f32 v106, v30, v64
    v_fmac_f32 v107, v31, v64
    s_add_u32 m0, s79, 117760
    s_nop 0
    buffer_load_dwordx4 v21, s[36:39], s78 offen sc1 lds
    s_add_u32 m0, s33, 77824
    s_mov_b32 s76, 589824
    buffer_load_dwordx4 v23, s[40:43], s76 offen offset:0 lds
    s_add_u32 m0, s33, 79872
    s_nop 0
    buffer_load_dwordx4 v23, s[40:43], s76 offen offset:2048 lds
    s_add_u32 m0, s33, 86016
    s_nop 0
    buffer_load_dwordx4 v23, s[44:47], s76 offen offset:0 lds
    v_mul_f32 v80, v88, v88
    v_mul_f32 v81, v89, v89
    v_mul_f32 v82, v90, v90
    v_mul_f32 v83, v91, v91
    v_fma_f32 v80, v80, v66, v65
    v_fma_f32 v81, v81, v66, v65
    v_fma_f32 v82, v82, v66, v65
    v_fma_f32 v83, v83, v66, v65
    s_add_u32 m0, s33, 90112
    s_mov_b32 s77, 688128
    buffer_load_dwordx4 v22, s[48:51], s77 offen offset:0 lds
    s_add_u32 m0, s33, 94208
    s_nop 0
    buffer_load_dwordx4 v22, s[52:55], s77 offen offset:0 lds
    s_barrier
    s_add_u32 m0, s79, 118784
    s_mov_b32 s78, 33024
    buffer_load_dwordx4 v20, s[36:39], s78 offen sc1 lds
    v_mul_f32 v80, v80, v88
    v_mul_f32 v81, v81, v89
    v_mul_f32 v82, v82, v90
    v_mul_f32 v83, v83, v91
    v_exp_f32 v80, v80
    v_mul_f32 v88, v88, v104
    v_exp_f32 v81, v81
    s_add_u32 m0, s79, 119808
    s_nop 0
    buffer_load_dwordx4 v21, s[36:39], s78 offen sc1 lds
    v_mul_f32 v89, v89, v105
    v_exp_f32 v82, v82
    v_mul_f32 v90, v90, v106
    v_exp_f32 v83, v83
    v_mul_f32 v91, v91, v107
    v_fma_f32 v80, v80, v67, v67
    s_add_u32 m0, s81, 133120
    s_mov_b32 s78, 256
    s_mov_b64 exec, 0xffffffff
    buffer_load_dwordx4 v3, s[36:39], s78 offen sc1 lds
    s_mov_b64 exec, -1
    v_fma_f32 v81, v81, v67, v67
    v_fma_f32 v82, v82, v67, v67
    v_fma_f32 v83, v83, v67, v67
    v_rcp_f32 v80, v80
    v_rcp_f32 v81, v81
    v_rcp_f32 v82, v82
    s_add_u32 m0, s33, 16384
    s_mov_b32 s76, 786432
    buffer_load_dwordx4 v23, s[40:43], s76 offen offset:0 lds
    s_add_u32 m0, s33, 18432
    s_nop 0
    buffer_load_dwordx4 v23, s[40:43], s76 offen offset:2048 lds
    v_rcp_f32 v83, v83
    s_nop 0
    v_mul_f32 v88, v88, v80
    v_mul_f32 v89, v89, v81
    v_mul_f32 v90, v90, v82
    v_mul_f32 v91, v91, v83
    v_cvt_pk_bf16_f32 v88, v88, v89
    v_cvt_pk_bf16_f32 v89, v90, v91
    s_add_u32 m0, s33, 24576
    s_nop 0
    buffer_load_dwordx4 v23, s[44:47], s76 offen offset:0 lds
    v_fmac_f32 v92, v24, v68
    v_fmac_f32 v93, v25, v68
    v_fmac_f32 v94, v26, v68
    v_fmac_f32 v95, v27, v68
    v_fmac_f32 v108, v28, v68
    v_fmac_f32 v109, v29, v68
    v_fmac_f32 v110, v30, v68
    v_fmac_f32 v111, v31, v68
    s_add_u32 m0, s33, 28672
    s_mov_b32 s77, 917504
    buffer_load_dwordx4 v22, s[48:51], s77 offen offset:0 lds
    v_mul_f32 v80, v92, v92
    v_mul_f32 v81, v93, v93
    v_mul_f32 v82, v94, v94
    v_mul_f32 v83, v95, v95
    v_fma_f32 v80, v80, v70, v69
    v_fma_f32 v81, v81, v70, v69
    v_fma_f32 v82, v82, v70, v69
    v_fma_f32 v83, v83, v70, v69
    s_add_u32 m0, s33, 32768
    s_nop 0
    buffer_load_dwordx4 v22, s[52:55], s77 offen offset:0 lds
    s_add_u32 s75, s75, 0x300000
    s_load_dword s94, s[10:11], s75 offset:0x0
    s_load_dword s94, s[10:11], s75 offset:0x40
    s_load_dword s94, s[10:11], s75 offset:0x80
    s_load_dword s94, s[10:11], s75 offset:0xc0
    s_load_dword s94, s[10:11], s75 offset:0x100
    v_mov_b32 v5, 0
    s_mov_b64 exec, 1
    global_load_dwordx2 v[6:7], v5, s[24:25] sc1
    s_mov_b64 exec, -1
    s_barrier
    s_add_u32 m0, s79, 135168
    s_mov_b32 s78, 384
    buffer_load_dwordx4 v20, s[36:39], s78 offen sc1 lds
    v_mul_f32 v80, v80, v92
    v_mul_f32 v81, v81, v93
    v_mul_f32 v82, v82, v94
    v_mul_f32 v83, v83, v95
    v_exp_f32 v80, v80
    v_mul_f32 v92, v92, v108
    v_exp_f32 v81, v81
    s_add_u32 m0, s79, 136192
    s_nop 0
    buffer_load_dwordx4 v21, s[36:39], s78 offen sc1 lds
    v_mul_f32 v93, v93, v109
    v_exp_f32 v82, v82
    v_mul_f32 v94, v94, v110
    v_exp_f32 v83, v83
    v_mul_f32 v95, v95, v111
    v_fma_f32 v80, v80, v71, v71
    s_add_u32 m0, s33, 36864
    s_mov_b32 s76, 983040
    buffer_load_dwordx4 v23, s[40:43], s76 offen offset:0 lds
    v_fma_f32 v81, v81, v71, v71
    v_fma_f32 v82, v82, v71, v71
    v_fma_f32 v83, v83, v71, v71
    v_rcp_f32 v80, v80
    v_rcp_f32 v81, v81
    v_rcp_f32 v82, v82
    s_add_u32 m0, s33, 38912
    s_nop 0
    buffer_load_dwordx4 v23, s[40:43], s76 offen offset:2048 lds
    v_rcp_f32 v83, v83
    s_nop 0
    v_mul_f32 v92, v92, v80
    v_mul_f32 v93, v93, v81
    v_mul_f32 v94, v94, v82
    v_mul_f32 v95, v95, v83
    v_cvt_pk_bf16_f32 v90, v92, v93
    v_cvt_pk_bf16_f32 v91, v94, v95
    s_add_u32 m0, s33, 45056
    s_nop 0
    buffer_load_dwordx4 v23, s[44:47], s76 offen offset:0 lds
    s_nop 1
    v_permlane16_swap_b32 v88, v90
    v_permlane16_swap_b32 v89, v91
    s_add_u32 m0, s33, 49152
    s_mov_b32 s77, 1146880
    buffer_load_dwordx4 v22, s[48:51], s77 offen offset:0 lds
    v_fmac_f32 v96, v24, v72
    v_fmac_f32 v97, v25, v72
    v_fmac_f32 v98, v26, v72
    v_fmac_f32 v99, v27, v72
    v_fmac_f32 v112, v28, v72
    v_fmac_f32 v113, v29, v72
    v_fmac_f32 v114, v30, v72
    v_fmac_f32 v115, v31, v72
    s_add_u32 m0, s33, 53248
    s_nop 0
    buffer_load_dwordx4 v22, s[52:55], s77 offen offset:0 lds
    v_mul_f32 v80, v96, v96
    v_mul_f32 v81, v97, v97
    v_mul_f32 v82, v98, v98
    v_mul_f32 v83, v99, v99
    v_fma_f32 v80, v80, v74, v73
    v_fma_f32 v81, v81, v74, v73
    v_fma_f32 v82, v82, v74, v73
    v_fma_f32 v83, v83, v74, v73
    buffer_store_dwordx4 v[88:91], v19, s[68:71], s72 offen offset:0 sc1
    s_load_dword s94, s[10:11], s75 offset:0x140
    s_load_dword s94, s[10:11], s75 offset:0x180
    s_load_dword s94, s[10:11], s75 offset:0x1c0
    s_add_u32 s99, s99, 0x380000
    s_load_dword s94, s[16:17], s99 offset:0x0
    s_load_dword s94, s[16:17], s99 offset:0x40
    s_waitcnt vmcnt(17)
    s_barrier
    s_add_u32 m0, s79, 137216
    s_mov_b32 s78, 33152
    buffer_load_dwordx4 v20, s[36:39], s78 offen sc1 lds
    v_mul_f32 v80, v80, v96
    v_mul_f32 v81, v81, v97
    v_mul_f32 v82, v82, v98
    v_mul_f32 v83, v83, v99
    v_exp_f32 v80, v80
    v_mul_f32 v96, v96, v112
    v_exp_f32 v81, v81
    s_add_u32 m0, s79, 138240
    s_nop 0
    buffer_load_dwordx4 v21, s[36:39], s78 offen sc1 lds
    v_mul_f32 v97, v97, v113
    v_exp_f32 v82, v82
    v_mul_f32 v98, v98, v114
    v_exp_f32 v83, v83
    v_mul_f32 v99, v99, v115
    v_fma_f32 v80, v80, v75, v75
    s_add_u32 m0, s81, 151552
    s_mov_b32 s78, 384
    s_mov_b64 exec, 0xffffffff
    buffer_load_dwordx4 v3, s[36:39], s78 offen sc1 lds
    s_mov_b64 exec, -1
    v_fma_f32 v81, v81, v75, v75
    v_fma_f32 v82, v82, v75, v75
    v_fma_f32 v83, v83, v75, v75
    v_rcp_f32 v80, v80
    v_rcp_f32 v81, v81
    v_rcp_f32 v82, v82
    s_add_u32 m0, s33, 57344
    s_mov_b32 s76, 1179648
    buffer_load_dwordx4 v23, s[40:43], s76 offen offset:0 lds
    s_add_u32 m0, s33, 59392
    s_nop 0
    buffer_load_dwordx4 v23, s[40:43], s76 offen offset:2048 lds
    v_rcp_f32 v83, v83
    s_nop 0
    v_mul_f32 v96, v96, v80
    v_mul_f32 v97, v97, v81
    v_mul_f32 v98, v98, v82
    v_mul_f32 v99, v99, v83
    v_cvt_pk_bf16_f32 v96, v96, v97
    v_cvt_pk_bf16_f32 v97, v98, v99
    s_add_u32 m0, s33, 65536
    s_nop 0
    buffer_load_dwordx4 v23, s[44:47], s76 offen offset:0 lds
    v_fmac_f32 v100, v24, v76
    v_fmac_f32 v101, v25, v76
    v_fmac_f32 v102, v26, v76
    v_fmac_f32 v103, v27, v76
    v_fmac_f32 v116, v28, v76
    v_fmac_f32 v117, v29, v76
    v_fmac_f32 v118, v30, v76
    v_fmac_f32 v119, v31, v76
    s_add_u32 m0, s33, 69632
    s_mov_b32 s77, 1376256
    buffer_load_dwordx4 v22, s[48:51], s77 offen offset:0 lds
    v_mul_f32 v80, v100, v100
    v_mul_f32 v81, v101, v101
    v_mul_f32 v82, v102, v102
    v_mul_f32 v83, v103, v103
    v_fma_f32 v80, v80, v78, v77
    v_fma_f32 v81, v81, v78, v77
    v_fma_f32 v82, v82, v78, v77
    v_fma_f32 v83, v83, v78, v77
    s_add_u32 m0, s33, 73728
    s_nop 0
    buffer_load_dwordx4 v22, s[52:55], s77 offen offset:0 lds
    s_load_dword s94, s[16:17], s99 offset:0x80
    s_load_dword s94, s[16:17], s99 offset:0xc0
    s_load_dword s94, s[16:17], s99 offset:0x100
    s_load_dword s94, s[16:17], s99 offset:0x140
    s_load_dword s94, s[16:17], s99 offset:0x180
    s_waitcnt vmcnt(17)
    s_barrier
    s_add_u32 m0, s79, 98304
    s_mov_b32 s78, 512
    buffer_load_dwordx4 v20, s[36:39], s78 offen sc1 lds
    v_mul_f32 v80, v80, v100
    v_mul_f32 v81, v81, v101
    v_mul_f32 v82, v82, v102
    v_mul_f32 v83, v83, v103
    v_exp_f32 v80, v80
    v_mul_f32 v100, v100, v116
    v_exp_f32 v81, v81
    s_add_u32 m0, s79, 99328
    s_nop 0
    buffer_load_dwordx4 v21, s[36:39], s78 offen sc1 lds
    v_mul_f32 v101, v101, v117
    v_exp_f32 v82, v82
    v_mul_f32 v102, v102, v118
    v_exp_f32 v83, v83
    v_mul_f32 v103, v103, v119
    v_fma_f32 v80, v80, v79, v79
    s_add_u32 m0, s33, 77824
    s_mov_b32 s76, 1376256
    buffer_load_dwordx4 v23, s[40:43], s76 offen offset:0 lds
    v_fma_f32 v81, v81, v79, v79
    v_fma_f32 v82, v82, v79, v79
    v_fma_f32 v83, v83, v79, v79
    v_rcp_f32 v80, v80
    v_rcp_f32 v81, v81
    v_rcp_f32 v82, v82
    s_add_u32 m0, s33, 79872
    s_nop 0
    buffer_load_dwordx4 v23, s[40:43], s76 offen offset:2048 lds
    v_rcp_f32 v83, v83
    s_nop 0
    v_mul_f32 v100, v100, v80
    v_mul_f32 v101, v101, v81
    v_mul_f32 v102, v102, v82
    v_mul_f32 v103, v103, v83
    v_cvt_pk_bf16_f32 v98, v100, v101
    v_cvt_pk_bf16_f32 v99, v102, v103
    s_add_u32 m0, s33, 86016
    s_nop 0
    buffer_load_dwordx4 v23, s[44:47], s76 offen offset:0 lds
    s_nop 1
    v_permlane16_swap_b32 v96, v98
    v_permlane16_swap_b32 v97, v99
    s_add_u32 m0, s33, 90112
    s_mov_b32 s77, 1605632
    buffer_load_dwordx4 v22, s[48:51], s77 offen offset:0 lds
    v_fmac_f32 v120, v32, v64
    v_fmac_f32 v121, v33, v64
    v_fmac_f32 v122, v34, v64
    v_fmac_f32 v123, v35, v64
    v_fmac_f32 v136, v36, v64
    v_fmac_f32 v137, v37, v64
    v_fmac_f32 v138, v38, v64
    v_fmac_f32 v139, v39, v64
    s_add_u32 m0, s33, 94208
    s_nop 0
    buffer_load_dwordx4 v22, s[52:55], s77 offen offset:0 lds
    v_mul_f32 v80, v120, v120
    v_mul_f32 v81, v121, v121
    v_mul_f32 v82, v122, v122
    v_mul_f32 v83, v123, v123
    v_fma_f32 v80, v80, v66, v65
    v_fma_f32 v81, v81, v66, v65
    v_fma_f32 v82, v82, v66, v65
    v_fma_f32 v83, v83, v66, v65
    buffer_store_dwordx4 v[96:99], v19, s[68:71], s72 offen offset:2048 sc1
    s_load_dword s94, s[16:17], s99 offset:0x1c0
    s_load_dword s94, s[18:19], s99 offset:0x0
    s_load_dword s94, s[18:19], s99 offset:0x40
    s_load_dword s94, s[18:19], s99 offset:0x80
    s_load_dword s94, s[18:19], s99 offset:0xc0
    s_waitcnt vmcnt(17)
    s_barrier
    s_add_u32 m0, s79, 100352
    s_mov_b32 s78, 33280
    buffer_load_dwordx4 v20, s[36:39], s78 offen sc1 lds
    v_mul_f32 v80, v80, v120
    v_mul_f32 v81, v81, v121
    v_mul_f32 v82, v82, v122
    v_mul_f32 v83, v83, v123
    v_exp_f32 v80, v80
    v_mul_f32 v120, v120, v136
    v_exp_f32 v81, v81
    s_add_u32 m0, s79, 101376
    s_nop 0
    buffer_load_dwordx4 v21, s[36:39], s78 offen sc1 lds
    v_mul_f32 v121, v121, v137
    v_exp_f32 v82, v82
    v_mul_f32 v122, v122, v138
    v_exp_f32 v83, v83
    v_mul_f32 v123, v123, v139
L_pad1:
    s_cbranch_execz L_vret1
    v_fma_f32 v80, v80, v67, v67
    s_add_u32 m0, s81, 114688
    s_mov_b32 s78, 512
    s_mov_b64 exec, 0xffffffff
    buffer_load_dwordx4 v3, s[36:39], s78 offen sc1 lds
    s_mov_b64 exec, -1
    v_fma_f32 v81, v81, v67, v67
    v_fma_f32 v82, v82, v67, v67
    v_fma_f32 v83, v83, v67, v67
    v_rcp_f32 v80, v80
    v_rcp_f32 v81, v81
    v_rcp_f32 v82, v82
    s_add_u32 m0, s33, 16384
    s_mov_b32 s76, 1572864
    buffer_load_dwordx4 v23, s[40:43], s76 offen offset:0 lds
    s_add_u32 m0, s33, 18432
    s_nop 0
    buffer_load_dwordx4 v23, s[40:43], s76 offen offset:2048 lds
    v_rcp_f32 v83, v83
    s_nop 0
    v_mul_f32 v120, v120, v80
    v_mul_f32 v121, v121, v81
    v_mul_f32 v122, v122, v82
    v_mul_f32 v123, v123, v83
    v_cvt_pk_bf16_f32 v120, v120, v121
    v_cvt_pk_bf16_f32 v121, v122, v123
    s_add_u32 m0, s33, 24576
    s_nop 0
    buffer_load_dwordx4 v23, s[44:47], s76 offen offset:0 lds
    v_fmac_f32 v124, v32, v68
    v_fmac_f32 v125, v33, v68
    v_fmac_f32 v126, v34, v68
    v_fmac_f32 v127, v35, v68
    v_fmac_f32 v140, v36, v68
    v_fmac_f32 v141, v37, v68
    v_fmac_f32 v142, v38, v68
    v_fmac_f32 v143, v39, v68
    s_add_u32 m0, s33, 28672
    s_mov_b32 s77, 1835008
    buffer_load_dwordx4 v22, s[48:51], s77 offen offset:0 lds
    v_mul_f32 v80, v124, v124
    v_mul_f32 v81, v125, v125
    v_mul_f32 v82, v126, v126
    v_mul_f32 v83, v127, v127
    v_fma_f32 v80, v80, v70, v69
    v_fma_f32 v81, v81, v70, v69
    v_fma_f32 v82, v82, v70, v69
    v_fma_f32 v83, v83, v70, v69
    s_add_u32 m0, s33, 32768
    s_nop 0
    buffer_load_dwordx4 v22, s[52:55], s77 offen offset:0 lds
    s_load_dword s94, s[18:19], s99 offset:0x100
    s_load_dword s94, s[18:19], s99 offset:0x140
    s_load_dword s94, s[18:19], s99 offset:0x180
    s_load_dword s94, s[18:19], s99 offset:0x1c0
    s_load_dword s94, s[10:11], s75 offset:0x80000
    s_waitcnt vmcnt(16)
    s_barrier
    s_add_u32 m0, s79, 116736
    s_mov_b32 s78, 640
    buffer_load_dwordx4 v20, s[36:39], s78 offen sc1 lds
    v_mul_f32 v80, v80, v124
    v_mul_f32 v81, v81, v125
    v_mul_f32 v82, v82, v126
    v_mul_f32 v83, v83, v127
    v_exp_f32 v80, v80
    v_mul_f32 v124, v124, v140
    v_exp_f32 v81, v81
    s_add_u32 m0, s79, 117760
    s_nop 0
    buffer_load_dwordx4 v21, s[36:39], s78 offen sc1 lds
    v_mul_f32 v125, v125, v141
    v_exp_f32 v82, v82
    v_mul_f32 v126, v126, v142
    v_exp_f32 v83, v83
    v_mul_f32 v127, v127, v143
    v_fma_f32 v80, v80, v71, v71
    s_add_u32 m0, s33, 36864
    s_mov_b32 s76, 1769472
    buffer_load_dwordx4 v23, s[40:43], s76 offen offset:0 lds
    v_fma_f32 v81, v81, v71, v71
    v_fma_f32 v82, v82, v71, v71
    v_fma_f32 v83, v83, v71, v71
    v_rcp_f32 v80, v80
    v_rcp_f32 v81, v81
    v_rcp_f32 v82, v82
    s_add_u32 m0, s33, 38912
    s_nop 0
    buffer_load_dwordx4 v23, s[40:43], s76 offen offset:2048 lds
    v_rcp_f32 v83, v83
    s_nop 0
    v_mul_f32 v124, v124, v80
    v_mul_f32 v125, v125, v81
    v_mul_f32 v126, v126, v82
    v_mul_f32 v127, v127, v83
    v_cvt_pk_bf16_f32 v122, v124, v125
    v_cvt_pk_bf16_f32 v123, v126, v127
    s_add_u32 m0, s33, 45056
    s_nop 0
    buffer_load_dwordx4 v23, s[44:47], s76 offen offset:0 lds
    s_nop 1
    v_permlane16_swap_b32 v120, v122
    v_permlane16_swap_b32 v121, v123
    s_add_u32 m0, s33, 49152
    s_mov_b32 s77, 2064384
    buffer_load_dwordx4 v22, s[48:51], s77 offen offset:0 lds
    v_fmac_f32 v128, v32, v72
    v_fmac_f32 v129, v33, v72
    v_fmac_f32 v130, v34, v72
    v_fmac_f32 v131, v35, v72
    v_fmac_f32 v144, v36, v72
    v_fmac_f32 v145, v37, v72
    v_fmac_f32 v146, v38, v72
    v_fmac_f32 v147, v39, v72
    s_add_u32 m0, s33, 53248
    s_nop 0
    buffer_load_dwordx4 v22, s[52:55], s77 offen offset:0 lds
    v_mul_f32 v80, v128, v128
    v_mul_f32 v81, v129, v129
    v_mul_f32 v82, v130, v130
    v_mul_f32 v83, v131, v131
    v_fma_f32 v80, v80, v74, v73
    v_fma_f32 v81, v81, v74, v73
    v_fma_f32 v82, v82, v74, v73
    v_fma_f32 v83, v83, v74, v73
    buffer_store_dwordx4 v[120:123], v19, s[68:71], s72 offen offset:512 sc1
    s_load_dword s94, s[10:11], s75 offset:0x80040
    s_load_dword s94, s[10:11], s75 offset:0x80080
    s_load_dword s94, s[10:11], s75 offset:0x800c0
    s_load_dword s94, s[10:11], s75 offset:0x80100
    s_load_dword s94, s[10:11], s75 offset:0x80140
    s_waitcnt vmcnt(17)
    s_barrier
    s_add_u32 m0, s79, 118784
    s_mov_b32 s78, 33408
    buffer_load_dwordx4 v20, s[36:39], s78 offen sc1 lds
    v_mul_f32 v80, v80, v128
    v_mul_f32 v81, v81, v129
    v_mul_f32 v82, v82, v130
    v_mul_f32 v83, v83, v131
    v_exp_f32 v80, v80
    v_mul_f32 v128, v128, v144
    v_exp_f32 v81, v81
    s_add_u32 m0, s79, 119808
    s_nop 0
    buffer_load_dwordx4 v21, s[36:39], s78 offen sc1 lds
    v_mul_f32 v129, v129, v145
    v_exp_f32 v82, v82
    v_mul_f32 v130, v130, v146
    v_exp_f32 v83, v83
    v_mul_f32 v131, v131, v147
    v_fma_f32 v80, v80, v75, v75
    s_add_u32 m0, s81, 133120
    s_mov_b32 s78, 640
    s_mov_b64 exec, 0xffffffff
    buffer_load_dwordx4 v3, s[36:39], s78 offen sc1 lds
    s_mov_b64 exec, -1
    v_fma_f32 v81, v81, v75, v75
    v_fma_f32 v82, v82, v75, v75
    v_fma_f32 v83, v83, v75, v75
    v_rcp_f32 v80, v80
    v_rcp_f32 v81, v81
    v_rcp_f32 v82, v82
    s_add_u32 m0, s33, 57344
    s_mov_b32 s76, 1966080
    buffer_load_dwordx4 v23, s[40:43], s76 offen offset:0 lds
    s_add_u32 m0, s33, 59392
    s_nop 0
    buffer_load_dwordx4 v23, s[40:43], s76 offen offset:2048 lds
    v_rcp_f32 v83, v83
    s_nop 0
    v_mul_f32 v128, v128, v80
    v_mul_f32 v129, v129, v81
    v_mul_f32 v130, v130, v82
    v_mul_f32 v131, v131, v83
    v_cvt_pk_bf16_f32 v128, v128, v129
    v_cvt_pk_bf16_f32 v129, v130, v131
    s_add_u32 m0, s33, 65536
    s_nop 0
    buffer_load_dwordx4 v23, s[44:47], s76 offen offset:0 lds
    v_fmac_f32 v132, v32, v76
    v_fmac_f32 v133, v33, v76
    v_fmac_f32 v134, v34, v76
    v_fmac_f32 v135, v35, v76
    v_fmac_f32 v148, v36, v76
    v_fmac_f32 v149, v37, v76
    v_fmac_f32 v150, v38, v76
    v_fmac_f32 v151, v39, v76
    s_add_u32 m0, s33, 69632
    s_mov_b32 s77, 2293760
    buffer_load_dwordx4 v22, s[48:51], s77 offen offset:0 lds
    v_mul_f32 v80, v132, v132
    v_mul_f32 v81, v133, v133
    v_mul_f32 v82, v134, v134
    v_mul_f32 v83, v135, v135
    v_fma_f32 v80, v80, v78, v77
    v_fma_f32 v81, v81, v78, v77
    v_fma_f32 v82, v82, v78, v77
    v_fma_f32 v83, v83, v78, v77
    s_add_u32 m0, s33, 73728
    s_nop 0
    buffer_load_dwordx4 v22, s[52:55], s77 offen offset:0 lds
    s_load_dword s94, s[10:11], s75 offset:0x80180
    s_load_dword s94, s[10:11], s75 offset:0x801c0
    s_add_u32 s75, s75, 0x100000
    s_load_dword s94, s[10:11], s75 offset:0x0
    s_load_dword s94, s[10:11], s75 offset:0x40
    s_load_dword s94, s[10:11], s75 offset:0x80
    s_waitcnt vmcnt(16)
    s_barrier
    s_add_u32 m0, s79, 135168
    s_mov_b32 s78, 768
    buffer_load_dwordx4 v20, s[36:39], s78 offen sc1 lds
    v_mul_f32 v80, v80, v132
    v_mul_f32 v81, v81, v133
    v_mul_f32 v82, v82, v134
    v_mul_f32 v83, v83, v135
    v_exp_f32 v80, v80
    v_mul_f32 v132, v132, v148
    v_exp_f32 v81, v81
    s_add_u32 m0, s79, 136192
    s_nop 0
    buffer_load_dwordx4 v21, s[36:39], s78 offen sc1 lds
    v_mul_f32 v133, v133, v149
    v_exp_f32 v82, v82
    v_mul_f32 v134, v134, v150
    v_exp_f32 v83, v83
    v_mul_f32 v135, v135, v151
    v_fma_f32 v80, v80, v79, v79
    s_add_u32 m0, s33, 77824
    s_mov_b32 s76, 2162688
    buffer_load_dwordx4 v23, s[40:43], s76 offen offset:0 lds
    v_fma_f32 v81, v81, v79, v79
    v_fma_f32 v82, v82, v79, v79
    v_fma_f32 v83, v83, v79, v79
    v_rcp_f32 v80, v80
    v_rcp_f32 v81, v81
    v_rcp_f32 v82, v82
    s_add_u32 m0, s33, 79872
    s_nop 0
    buffer_load_dwordx4 v23, s[40:43], s76 offen offset:2048 lds
    v_rcp_f32 v83, v83
    s_nop 0
    v_mul_f32 v132, v132, v80
    v_mul_f32 v133, v133, v81
    v_mul_f32 v134, v134, v82
    v_mul_f32 v135, v135, v83
    v_cvt_pk_bf16_f32 v130, v132, v133
    v_cvt_pk_bf16_f32 v131, v134, v135
    s_add_u32 m0, s33, 86016
    s_nop 0
    buffer_load_dwordx4 v23, s[44:47], s76 offen offset:0 lds
    s_nop 1
    v_permlane16_swap_b32 v128, v130
    v_permlane16_swap_b32 v129, v131
    s_add_u32 m0, s33, 90112
    s_mov_b32 s77, 2523136
    buffer_load_dwordx4 v22, s[48:51], s77 offen offset:0 lds
    v_fmac_f32 v152, v40, v64
    v_fmac_f32 v153, v41, v64
    v_fmac_f32 v154, v42, v64
    v_fmac_f32 v155, v43, v64
    v_fmac_f32 v168, v44, v64
    v_fmac_f32 v169, v45, v64
    v_fmac_f32 v170, v46, v64
    v_fmac_f32 v171, v47, v64
    s_add_u32 m0, s33, 94208
    s_nop 0
    buffer_load_dwordx4 v22, s[52:55], s77 offen offset:0 lds
    v_mul_f32 v80, v152, v152
    v_mul_f32 v81, v153, v153
    v_mul_f32 v82, v154, v154
    v_mul_f32 v83, v155, v155
    v_fma_f32 v80, v80, v66, v65
    v_fma_f32 v81, v81, v66, v65
    v_fma_f32 v82, v82, v66, v65
    v_fma_f32 v83, v83, v66, v65
    buffer_store_dwordx4 v[128:131], v19, s[68:71], s72 offen offset:2560 sc1
    s_load_dword s94, s[10:11], s75 offset:0xc0
    s_load_dword s94, s[10:11], s75 offset:0x100
    s_load_dword s94, s[10:11], s75 offset:0x140
    s_load_dword s94, s[10:11], s75 offset:0x180
    s_load_dword s94, s[10:11], s75 offset:0x1c0
    s_waitcnt vmcnt(56)
    s_movk_i32 s98, 0x4000
L_tokA_chk:
    v_readfirstlane_b32 s100, v6
    v_readfirstlane_b32 s101, v7
    s_nop 1
    s_cmp_lg_u32 s100, 0
    s_cbranch_scc1 L_tokA_ok
    s_sub_u32 s98, s98, 1
    s_cbranch_scc1 L_tokA_ok
    s_sleep 1
    global_load_dwordx2 v[6:7], v5, s[24:25] sc1
    s_waitcnt vmcnt(0)
    s_branch L_tokA_chk
L_tokA_ok:
    s_waitcnt vmcnt(17)
    s_barrier
    s_add_u32 m0, s79, 137216
    s_mov_b32 s78, 33536
    buffer_load_dwordx4 v20, s[36:39], s78 offen sc1 lds
    v_mul_f32 v80, v80, v152
    v_mul_f32 v81, v81, v153
    v_mul_f32 v82, v82, v154
    v_mul_f32 v83, v83, v155
    v_exp_f32 v80, v80
    v_mul_f32 v152, v152, v168
    v_exp_f32 v81, v81
    s_add_u32 m0, s79, 138240
    s_nop 0
    buffer_load_dwordx4 v21, s[36:39], s78 offen sc1 lds
    v_mul_f32 v153, v153, v169
    v_exp_f32 v82, v82
    v_mul_f32 v154, v154, v170
    v_exp_f32 v83, v83
    v_mul_f32 v155, v155, v171
    v_fma_f32 v80, v80, v67, v67
    s_add_u32 m0, s81, 151552
    s_mov_b32 s78, 768
    s_mov_b64 exec, 0xffffffff
    buffer_load_dwordx4 v3, s[36:39], s78 offen sc1 lds
    s_mov_b64 exec, -1
    v_fma_f32 v81, v81, v67, v67
    v_fma_f32 v82, v82, v67, v67
    v_fma_f32 v83, v83, v67, v67
    v_rcp_f32 v80, v80
    v_rcp_f32 v81, v81
    v_rcp_f32 v82, v82
    s_add_u32 m0, s33, 16384
    s_mov_b32 s76, 2359296
    buffer_load_dwordx4 v23, s[40:43], s76 offen offset:0 lds
    s_add_u32 m0, s33, 18432
    s_nop 0
    buffer_load_dwordx4 v23, s[40:43], s76 offen offset:2048 lds
    v_rcp_f32 v83, v83
    s_nop 0
    v_mul_f32 v152, v152, v80
    v_mul_f32 v153, v153, v81
    v_mul_f32 v154, v154, v82
    v_mul_f32 v155, v155, v83
    v_cvt_pk_bf16_f32 v152, v152, v153
    v_cvt_pk_bf16_f32 v153, v154, v155
    s_add_u32 m0, s33, 24576
    s_nop 0
    buffer_load_dwordx4 v23, s[44:47], s76 offen offset:0 lds
    v_fmac_f32 v156, v40, v68
    v_fmac_f32 v157, v41, v68
    v_fmac_f32 v158, v42, v68
    v_fmac_f32 v159, v43, v68
    v_fmac_f32 v172, v44, v68
    v_fmac_f32 v173, v45, v68
    v_fmac_f32 v174, v46, v68
    v_fmac_f32 v175, v47, v68
    s_add_u32 m0, s33, 28672
    s_mov_b32 s77, 2752512
    buffer_load_dwordx4 v22, s[48:51], s77 offen offset:0 lds
    v_mul_f32 v80, v156, v156
    v_mul_f32 v81, v157, v157
    v_mul_f32 v82, v158, v158
    v_mul_f32 v83, v159, v159
    v_fma_f32 v80, v80, v70, v69
    v_fma_f32 v81, v81, v70, v69
    v_fma_f32 v82, v82, v70, v69
    v_fma_f32 v83, v83, v70, v69
    s_add_u32 m0, s33, 32768
    s_nop 0
    buffer_load_dwordx4 v22, s[52:55], s77 offen offset:0 lds
    s_load_dword s94, s[10:11], s75 offset:0x80000
    s_load_dword s94, s[10:11], s75 offset:0x80040
    s_load_dword s94, s[10:11], s75 offset:0x80080
    s_load_dword s94, s[10:11], s75 offset:0x800c0
    s_load_dword s94, s[10:11], s75 offset:0x80100
    s_waitcnt vmcnt(16)
    s_barrier
    s_add_u32 m0, s79, 98304
    s_mov_b32 s78, 896
    buffer_load_dwordx4 v20, s[36:39], s78 offen sc1 lds
    v_mul_f32 v80, v80, v156
    v_mul_f32 v81, v81, v157
    v_mul_f32 v82, v82, v158
    v_mul_f32 v83, v83, v159
    v_exp_f32 v80, v80
    v_mul_f32 v156, v156, v172
    v_exp_f32 v81, v81
    s_add_u32 m0, s79, 99328
    s_nop 0
    buffer_load_dwordx4 v21, s[36:39], s78 offen sc1 lds
    v_mul_f32 v157, v157, v173
    v_exp_f32 v82, v82
    v_mul_f32 v158, v158, v174
    v_exp_f32 v83, v83
    v_mul_f32 v159, v159, v175
    v_fma_f32 v80, v80, v71, v71
    s_add_u32 m0, s33, 36864
    s_mov_b32 s76, 2555904
    buffer_load_dwordx4 v23, s[40:43], s76 offen offset:0 lds
    v_fma_f32 v81, v81, v71, v71
    v_fma_f32 v82, v82, v71, v71
    v_fma_f32 v83, v83, v71, v71
    v_rcp_f32 v80, v80
    v_rcp_f32 v81, v81
    v_rcp_f32 v82, v82
    s_add_u32 m0, s33, 38912
    s_nop 0
    buffer_load_dwordx4 v23, s[40:43], s76 offen offset:2048 lds
    v_rcp_f32 v83, v83
    s_nop 0
    v_mul_f32 v156, v156, v80
    v_mul_f32 v157, v157, v81
    v_mul_f32 v158, v158, v82
    v_mul_f32 v159, v159, v83
    v_cvt_pk_bf16_f32 v154, v156, v157
    v_cvt_pk_bf16_f32 v155, v158, v159
    s_add_u32 m0, s33, 45056
    s_nop 0
    buffer_load_dwordx4 v23, s[44:47], s76 offen offset:0 lds
    s_nop 1
    v_permlane16_swap_b32 v152, v154
    v_permlane16_swap_b32 v153, v155
    s_add_u32 m0, s33, 49152
    s_mov_b32 s77, 2981888
    buffer_load_dwordx4 v22, s[48:51], s77 offen offset:0 lds
    v_fmac_f32 v160, v40, v72
    v_fmac_f32 v161, v41, v72
    v_fmac_f32 v162, v42, v72
    v_fmac_f32 v163, v43, v72
    v_fmac_f32 v176, v44, v72
    v_fmac_f32 v177, v45, v72
    v_fmac_f32 v178, v46, v72
    v_fmac_f32 v179, v47, v72
    s_add_u32 m0, s33, 53248
    s_nop 0
    buffer_load_dwordx4 v22, s[52:55], s77 offen offset:0 lds
    v_mul_f32 v80, v160, v160
    v_mul_f32 v81, v161, v161
    v_mul_f32 v82, v162, v162
    v_mul_f32 v83, v163, v163
    v_fma_f32 v80, v80, v74, v73
    v_fma_f32 v81, v81, v74, v73
    v_fma_f32 v82, v82, v74, v73
    v_fma_f32 v83, v83, v74, v73
    buffer_store_dwordx4 v[152:155], v19, s[68:71], s73 offen offset:0 sc1
    s_load_dword s94, s[10:11], s75 offset:0x80140
    s_load_dword s94, s[10:11], s75 offset:0x80180
    s_load_dword s94, s[10:11], s75 offset:0x801c0
    s_add_u32 s99, s99, 0x1c0000
    s_load_dword s94, s[16:17], s99 offset:0x0
    s_load_dword s94, s[16:17], s99 offset:0x40
    s_waitcnt vmcnt(17)
    s_barrier
    s_add_u32 m0, s79, 100352
    s_mov_b32 s78, 33664
    buffer_load_dwordx4 v20, s[36:39], s78 offen sc1 lds
    v_mul_f32 v80, v80, v160
    v_mul_f32 v81, v81, v161
    v_mul_f32 v82, v82, v162
    v_mul_f32 v83, v83, v163
    v_exp_f32 v80, v80
    v_mul_f32 v160, v160, v176
    v_exp_f32 v81, v81
    s_add_u32 m0, s79, 101376
    s_nop 0
    buffer_load_dwordx4 v21, s[36:39], s78 offen sc1 lds
    v_mul_f32 v161, v161, v177
    v_exp_f32 v82, v82
    v_mul_f32 v162, v162, v178
    v_exp_f32 v83, v83
    v_mul_f32 v163, v163, v179
    v_fma_f32 v80, v80, v75, v75
    s_add_u32 m0, s81, 114688
    s_mov_b32 s78, 896
    s_mov_b64 exec, 0xffffffff
    buffer_load_dwordx4 v3, s[36:39], s78 offen sc1 lds
    s_mov_b64 exec, -1
    v_fma_f32 v81, v81, v75, v75
    v_fma_f32 v82, v82, v75, v75
    v_fma_f32 v83, v83, v75, v75
    v_rcp_f32 v80, v80
    v_rcp_f32 v81, v81
    v_rcp_f32 v82, v82
    s_add_u32 m0, s33, 57344
    s_mov_b32 s76, 2752512
    buffer_load_dwordx4 v23, s[40:43], s76 offen offset:0 lds
    s_add_u32 m0, s33, 59392
    s_nop 0
    buffer_load_dwordx4 v23, s[40:43], s76 offen offset:2048 lds
    v_rcp_f32 v83, v83
    s_nop 0
    v_mul_f32 v160, v160, v80
    v_mul_f32 v161, v161, v81
    v_mul_f32 v162, v162, v82
    v_mul_f32 v163, v163, v83
    v_cvt_pk_bf16_f32 v160, v160, v161
    v_cvt_pk_bf16_f32 v161, v162, v163
    s_add_u32 m0, s33, 65536
    s_nop 0
    buffer_load_dwordx4 v23, s[44:47], s76 offen offset:0 lds
    v_fmac_f32 v164, v40, v76
    v_fmac_f32 v165, v41, v76
    v_fmac_f32 v166, v42, v76
    v_fmac_f32 v167, v43, v76
    v_fmac_f32 v180, v44, v76
    v_fmac_f32 v181, v45, v76
    v_fmac_f32 v182, v46, v76
    v_fmac_f32 v183, v47, v76
    s_add_u32 m0, s33, 69632
    s_mov_b32 s77, 3211264
    buffer_load_dwordx4 v22, s[48:51], s77 offen offset:0 lds
    v_mul_f32 v80, v164, v164
    v_mul_f32 v81, v165, v165
    v_mul_f32 v82, v166, v166
    v_mul_f32 v83, v167, v167
    v_fma_f32 v80, v80, v78, v77
    v_fma_f32 v81, v81, v78, v77
    v_fma_f32 v82, v82, v78, v77
    v_fma_f32 v83, v83, v78, v77
    s_add_u32 m0, s33, 73728
    s_nop 0
    buffer_load_dwordx4 v22, s[52:55], s77 offen offset:0 lds
    s_load_dword s94, s[16:17], s99 offset:0x80
    s_load_dword s94, s[16:17], s99 offset:0xc0
    s_load_dword s94, s[16:17], s99 offset:0x100
    s_load_dword s94, s[16:17], s99 offset:0x140
    s_load_dword s94, s[16:17], s99 offset:0x180
    s_waitcnt vmcnt(16)
    s_barrier
    s_add_u32 m0, s79, 116736
    s_mov_b32 s78, 1024
    buffer_load_dwordx4 v20, s[36:39], s78 offen sc1 lds
    v_mul_f32 v80, v80, v164
    v_mul_f32 v81, v81, v165
    v_mul_f32 v82, v82, v166
    v_mul_f32 v83, v83, v167
    v_exp_f32 v80, v80
    v_mul_f32 v164, v164, v180
    v_exp_f32 v81, v81
    s_add_u32 m0, s79, 117760
    s_nop 0
    buffer_load_dwordx4 v21, s[36:39], s78 offen sc1 lds
    v_mul_f32 v165, v165, v181
    v_exp_f32 v82, v82
    v_mul_f32 v166, v166, v182
    v_exp_f32 v83, v83
    v_mul_f32 v167, v167, v183
    v_fma_f32 v80, v80, v79, v79
    s_add_u32 m0, s33, 77824
    s_mov_b32 s76, 2949120
    buffer_load_dwordx4 v23, s[40:43], s76 offen offset:0 lds
    v_fma_f32 v81, v81, v79, v79
    v_fma_f32 v82, v82, v79, v79
    v_fma_f32 v83, v83, v79, v79
    v_rcp_f32 v80, v80
    v_rcp_f32 v81, v81
    v_rcp_f32 v82, v82
    s_add_u32 m0, s33, 79872
    s_nop 0
    buffer_load_dwordx4 v23, s[40:43], s76 offen offset:2048 lds
    v_rcp_f32 v83, v83
    s_nop 0
    v_mul_f32 v164, v164, v80
    v_mul_f32 v165, v165, v81
    v_mul_f32 v166, v166, v82
    v_mul_f32 v167, v167, v83
    v_cvt_pk_bf16_f32 v162, v164, v165
    v_cvt_pk_bf16_f32 v163, v166, v167
    s_add_u32 m0, s33, 86016
    s_nop 0
    buffer_load_dwordx4 v23, s[44:47], s76 offen offset:0 lds
    s_nop 1
    v_permlane16_swap_b32 v160, v162
    v_permlane16_swap_b32 v161, v163
    s_add_u32 m0, s33, 90112
    s_mov_b32 s77, 3440640
    buffer_load_dwordx4 v22, s[48:51], s77 offen offset:0 lds
    v_fmac_f32 v184, v48, v64
    v_fmac_f32 v185, v49, v64
    v_fmac_f32 v186, v50, v64
    v_fmac_f32 v187, v51, v64
    v_fmac_f32 v200, v52, v64
    v_fmac_f32 v201, v53, v64
    v_fmac_f32 v202, v54, v64
    v_fmac_f32 v203, v55, v64
    s_add_u32 m0, s33, 94208
    s_nop 0
    buffer_load_dwordx4 v22, s[52:55], s77 offen offset:0 lds
    v_mul_f32 v80, v184, v184
    v_mul_f32 v81, v185, v185
    v_mul_f32 v82, v186, v186
    v_mul_f32 v83, v187, v187
    v_fma_f32 v80, v80, v66, v65
    v_fma_f32 v81, v81, v66, v65
    v_fma_f32 v82, v82, v66, v65
    v_fma_f32 v83, v83, v66, v65
    buffer_store_dwordx4 v[160:163], v19, s[68:71], s73 offen offset:2048 sc1
    s_load_dword s94, s[16:17], s99 offset:0x1c0
    s_load_dword s94, s[18:19], s99 offset:0x0
    s_load_dword s94, s[18:19], s99 offset:0x40
    s_load_dword s94, s[18:19], s99 offset:0x80
    s_load_dword s94, s[18:19], s99 offset:0xc0
    s_waitcnt vmcnt(17)
    s_barrier
    s_add_u32 m0, s79, 118784
    s_mov_b32 s78, 33792
    buffer_load_dwordx4 v20, s[36:39], s78 offen sc1 lds
    v_mul_f32 v80, v80, v184
    v_mul_f32 v81, v81, v185
    v_mul_f32 v82, v82, v186
    v_mul_f32 v83, v83, v187
    v_exp_f32 v80, v80
    v_mul_f32 v184, v184, v200
    v_exp_f32 v81, v81
    s_add_u32 m0, s79, 119808
    s_nop 0
    buffer_load_dwordx4 v21, s[36:39], s78 offen sc1 lds
    v_mul_f32 v185, v185, v201
    v_exp_f32 v82, v82
    v_mul_f32 v186, v186, v202
    v_exp_f32 v83, v83
    v_mul_f32 v187, v187, v203
    v_fma_f32 v80, v80, v67, v67
    s_add_u32 m0, s81, 133120
    s_mov_b32 s78, 1024
    s_mov_b64 exec, 0xffffffff
    buffer_load_dwordx4 v3, s[36:39], s78 offen sc1 lds
    s_mov_b64 exec, -1
    v_fma_f32 v81, v81, v67, v67
    v_fma_f32 v82, v82, v67, v67
    v_fma_f32 v83, v83, v67, v67
    v_rcp_f32 v80, v80
    v_rcp_f32 v81, v81
    v_rcp_f32 v82, v82
    s_add_u32 m0, s33, 16384
    s_mov_b32 s76, 3145728
    buffer_load_dwordx4 v23, s[40:43], s76 offen offset:0 lds
    s_add_u32 m0, s33, 18432
    s_nop 0
    buffer_load_dwordx4 v23, s[40:43], s76 offen offset:2048 lds
    v_rcp_f32 v83, v83
    s_nop 0
    v_mul_f32 v184, v184, v80
    v_mul_f32 v185, v185, v81
    v_mul_f32 v186, v186, v82
    v_mul_f32 v187, v187, v83
    v_cvt_pk_bf16_f32 v184, v184, v185
    v_cvt_pk_bf16_f32 v185, v186, v187
    s_add_u32 m0, s33, 24576
    s_nop 0
    buffer_load_dwordx4 v23, s[44:47], s76 offen offset:0 lds
    v_fmac_f32 v188, v48, v68
    v_fmac_f32 v189, v49, v68
    v_fmac_f32 v190, v50, v68
    v_fmac_f32 v191, v51, v68
    v_fmac_f32 v204, v52, v68
    v_fmac_f32 v205, v53, v68
    v_fmac_f32 v206, v54, v68
    v_fmac_f32 v207, v55, v68
    s_add_u32 m0, s33, 28672
    s_mov_b32 s77, 3670016
    buffer_load_dwordx4 v22, s[48:51], s77 offen offset:0 lds
    v_mul_f32 v80, v188, v188
    v_mul_f32 v81, v189, v189
    v_mul_f32 v82, v190, v190
    v_mul_f32 v83, v191, v191
    v_fma_f32 v80, v80, v70, v69
    v_fma_f32 v81, v81, v70, v69
    v_fma_f32 v82, v82, v70, v69
    v_fma_f32 v83, v83, v70, v69
    s_add_u32 m0, s33, 32768
    s_nop 0
    buffer_load_dwordx4 v22, s[52:55], s77 offen offset:0 lds
    s_load_dword s94, s[18:19], s99 offset:0x100
    s_load_dword s94, s[18:19], s99 offset:0x140
    s_load_dword s94, s[18:19], s99 offset:0x180
    s_load_dword s94, s[18:19], s99 offset:0x1c0
    s_add_u32 s75, s75, 0x100000
    s_load_dword s94, s[10:11], s75 offset:0x0
    s_waitcnt vmcnt(16)
    s_barrier
    s_add_u32 m0, s79, 135168
    s_mov_b32 s78, 1152
    buffer_load_dwordx4 v20, s[36:39], s78 offen sc1 lds
    v_mul_f32 v80, v80, v188
    v_mul_f32 v81, v81, v189
    v_mul_f32 v82, v82, v190
    v_mul_f32 v83, v83, v191
    v_exp_f32 v80, v80
    v_mul_f32 v188, v188, v204
    v_exp_f32 v81, v81
    s_add_u32 m0, s79, 136192
    s_nop 0
    buffer_load_dwordx4 v21, s[36:39], s78 offen sc1 lds
    v_mul_f32 v189, v189, v205
    v_exp_f32 v82, v82
    v_mul_f32 v190, v190, v206
    v_exp_f32 v83, v83
    v_mul_f32 v191, v191, v207
    v_fma_f32 v80, v80, v71, v71
    s_add_u32 m0, s33, 36864
    s_mov_b32 s76, 3342336
    buffer_load_dwordx4 v23, s[40:43], s76 offen offset:0 lds
    v_fma_f32 v81, v81, v71, v71
    v_fma_f32 v82, v82, v71, v71
L_pad2:
    s_cbranch_execz L_vret1
    v_fma_f32 v83, v83, v71, v71
    v_rcp_f32 v80, v80
    v_rcp_f32 v81, v81
    v_rcp_f32 v82, v82
    s_add_u32 m0, s33, 38912
    s_nop 0
    buffer_load_dwordx4 v23, s[40:43], s76 offen offset:2048 lds
    v_rcp_f32 v83, v83
    s_nop 0
    v_mul_f32 v188, v188, v80
    v_mul_f32 v189, v189, v81
    v_mul_f32 v190, v190, v82
    v_mul_f32 v191, v191, v83
    v_cvt_pk_bf16_f32 v186, v188, v189
    v_cvt_pk_bf16_f32 v187, v190, v191
    s_add_u32 m0, s33, 45056
    s_nop 0
    buffer_load_dwordx4 v23, s[44:47], s76 offen offset:0 lds
    s_nop 1
    v_permlane16_swap_b32 v184, v186
    v_permlane16_swap_b32 v185, v187
    s_add_u32 m0, s33, 49152
    s_mov_b32 s77, 3899392
    buffer_load_dwordx4 v22, s[48:51], s77 offen offset:0 lds
    v_fmac_f32 v192, v48, v72
    v_fmac_f32 v193, v49, v72
    v_fmac_f32 v194, v50, v72
    v_fmac_f32 v195, v51, v72
    v_fmac_f32 v208, v52, v72
    v_fmac_f32 v209, v53, v72
    v_fmac_f32 v210, v54, v72
    v_fmac_f32 v211, v55, v72
    s_add_u32 m0, s33, 53248
    s_nop 0
    buffer_load_dwordx4 v22, s[52:55], s77 offen offset:0 lds
    v_mul_f32 v80, v192, v192
    v_mul_f32 v81, v193, v193
    v_mul_f32 v82, v194, v194
    v_mul_f32 v83, v195, v195
    v_fma_f32 v80, v80, v74, v73
    v_fma_f32 v81, v81, v74, v73
    v_fma_f32 v82, v82, v74, v73
    v_fma_f32 v83, v83, v74, v73
    buffer_store_dwordx4 v[184:187], v19, s[68:71], s73 offen offset:512 sc1
    s_load_dword s94, s[10:11], s75 offset:0x40
    s_load_dword s94, s[10:11], s75 offset:0x80
    s_load_dword s94, s[10:11], s75 offset:0xc0
    s_load_dword s94, s[10:11], s75 offset:0x100
    s_load_dword s94, s[10:11], s75 offset:0x140
    s_waitcnt vmcnt(17)
    s_barrier
    s_add_u32 m0, s79, 137216
    s_mov_b32 s78, 33920
    buffer_load_dwordx4 v20, s[36:39], s78 offen sc1 lds
    v_mul_f32 v80, v80, v192
    v_mul_f32 v81, v81, v193
    v_mul_f32 v82, v82, v194
    v_mul_f32 v83, v83, v195
    v_exp_f32 v80, v80
    v_mul_f32 v192, v192, v208
    v_exp_f32 v81, v81
    s_add_u32 m0, s79, 138240
    s_nop 0
    buffer_load_dwordx4 v21, s[36:39], s78 offen sc1 lds
    v_mul_f32 v193, v193, v209
    v_exp_f32 v82, v82
    v_mul_f32 v194, v194, v210
    v_exp_f32 v83, v83
    v_mul_f32 v195, v195, v211
    v_fma_f32 v80, v80, v75, v75
    s_add_u32 m0, s81, 151552
    s_mov_b32 s78, 1152
    s_mov_b64 exec, 0xffffffff
    buffer_load_dwordx4 v3, s[36:39], s78 offen sc1 lds
    s_mov_b64 exec, -1
    v_fma_f32 v81, v81, v75, v75
    v_fma_f32 v82, v82, v75, v75
    v_fma_f32 v83, v83, v75, v75
    v_rcp_f32 v80, v80
    v_rcp_f32 v81, v81
    v_rcp_f32 v82, v82
    s_add_u32 m0, s33, 57344
    s_mov_b32 s76, 3538944
    buffer_load_dwordx4 v23, s[40:43], s76 offen offset:0 lds
    s_add_u32 m0, s33, 59392
    s_nop 0
    buffer_load_dwordx4 v23, s[40:43], s76 offen offset:2048 lds
    v_rcp_f32 v83, v83
    s_nop 0
    v_mul_f32 v192, v192, v80
    v_mul_f32 v193, v193, v81
    v_mul_f32 v194, v194, v82
    v_mul_f32 v195, v195, v83
    v_cvt_pk_bf16_f32 v192, v192, v193
    v_cvt_pk_bf16_f32 v193, v194, v195
    s_add_u32 m0, s33, 65536
    s_nop 0
    buffer_load_dwordx4 v23, s[44:47], s76 offen offset:0 lds
    v_fmac_f32 v196, v48, v76
    v_fmac_f32 v197, v49, v76
    v_fmac_f32 v198, v50, v76
    v_fmac_f32 v199, v51, v76
    v_fmac_f32 v212, v52, v76
    v_fmac_f32 v213, v53, v76
    v_fmac_f32 v214, v54, v76
    v_fmac_f32 v215, v55, v76
    s_add_u32 m0, s33, 69632
    s_mov_b32 s77, 4128768
    buffer_load_dwordx4 v22, s[48:51], s77 offen offset:0 lds
    v_mul_f32 v80, v196, v196
    v_mul_f32 v81, v197, v197
    v_mul_f32 v82, v198, v198
    v_mul_f32 v83, v199, v199
    v_fma_f32 v80, v80, v78, v77
    v_fma_f32 v81, v81, v78, v77
    v_fma_f32 v82, v82, v78, v77
    v_fma_f32 v83, v83, v78, v77
    s_add_u32 m0, s33, 73728
    s_nop 0
    buffer_load_dwordx4 v22, s[52:55], s77 offen offset:0 lds
    s_load_dword s94, s[10:11], s75 offset:0x180
    s_load_dword s94, s[10:11], s75 offset:0x1c0
    s_load_dword s94, s[10:11], s75 offset:0x80000
    s_load_dword s94, s[10:11], s75 offset:0x80040
    s_load_dword s94, s[10:11], s75 offset:0x80080
    s_waitcnt vmcnt(16)
    s_barrier
    s_add_u32 m0, s79, 98304
    s_mov_b32 s78, 1280
    buffer_load_dwordx4 v20, s[36:39], s78 offen sc1 lds
    v_mul_f32 v80, v80, v196
    v_mul_f32 v81, v81, v197
    v_mul_f32 v82, v82, v198
    v_mul_f32 v83, v83, v199
    v_exp_f32 v80, v80
    v_mul_f32 v196, v196, v212
    v_exp_f32 v81, v81
    s_add_u32 m0, s79, 99328
    s_nop 0
    buffer_load_dwordx4 v21, s[36:39], s78 offen sc1 lds
    v_mul_f32 v197, v197, v213
    v_exp_f32 v82, v82
    v_mul_f32 v198, v198, v214
    v_exp_f32 v83, v83
    v_mul_f32 v199, v199, v215
    v_fma_f32 v80, v80, v79, v79
    s_add_u32 m0, s33, 77824
    s_mov_b32 s76, 3735552
    buffer_load_dwordx4 v23, s[40:43], s76 offen offset:0 lds
    v_fma_f32 v81, v81, v79, v79
    v_fma_f32 v82, v82, v79, v79
    v_fma_f32 v83, v83, v79, v79
    v_rcp_f32 v80, v80
    v_rcp_f32 v81, v81
    v_rcp_f32 v82, v82
    s_add_u32 m0, s33, 79872
    s_nop 0
    buffer_load_dwordx4 v23, s[40:43], s76 offen offset:2048 lds
    v_rcp_f32 v83, v83
    s_nop 0
    v_mul_f32 v196, v196, v80
    v_mul_f32 v197, v197, v81
    v_mul_f32 v198, v198, v82
    v_mul_f32 v199, v199, v83
    v_cvt_pk_bf16_f32 v194, v196, v197
    v_cvt_pk_bf16_f32 v195, v198, v199
    s_add_u32 m0, s33, 86016
    s_nop 0
    buffer_load_dwordx4 v23, s[44:47], s76 offen offset:0 lds
    s_nop 1
    v_permlane16_swap_b32 v192, v194
    v_permlane16_swap_b32 v193, v195
    s_add_u32 m0, s33, 90112
    s_mov_b32 s77, 4358144
    buffer_load_dwordx4 v22, s[48:51], s77 offen offset:0 lds
    v_fmac_f32 v216, v56, v64
    v_fmac_f32 v217, v57, v64
    v_fmac_f32 v218, v58, v64
    v_fmac_f32 v219, v59, v64
    v_fmac_f32 v232, v60, v64
    v_fmac_f32 v233, v61, v64
    v_fmac_f32 v234, v62, v64
    v_fmac_f32 v235, v63, v64
    s_add_u32 m0, s33, 94208
    s_nop 0
    buffer_load_dwordx4 v22, s[52:55], s77 offen offset:0 lds
    v_mul_f32 v80, v216, v216
    v_mul_f32 v81, v217, v217
    v_mul_f32 v82, v218, v218
    v_mul_f32 v83, v219, v219
    v_fma_f32 v80, v80, v66, v65
    v_fma_f32 v81, v81, v66, v65
    v_fma_f32 v82, v82, v66, v65
    v_fma_f32 v83, v83, v66, v65
    buffer_store_dwordx4 v[192:195], v19, s[68:71], s73 offen offset:2560 sc1
    s_load_dword s94, s[10:11], s75 offset:0x800c0
    s_load_dword s94, s[10:11], s75 offset:0x80100
    s_load_dword s94, s[10:11], s75 offset:0x80140
    s_load_dword s94, s[10:11], s75 offset:0x80180
    s_load_dword s94, s[10:11], s75 offset:0x801c0
    s_waitcnt vmcnt(17)
    s_barrier
    s_add_u32 m0, s79, 100352
    s_mov_b32 s78, 34048
    buffer_load_dwordx4 v20, s[36:39], s78 offen sc1 lds
    v_mul_f32 v80, v80, v216
    v_mul_f32 v81, v81, v217
    v_mul_f32 v82, v82, v218
    v_mul_f32 v83, v83, v219
    v_exp_f32 v80, v80
    v_mul_f32 v216, v216, v232
    v_exp_f32 v81, v81
    s_add_u32 m0, s79, 101376
    s_nop 0
    buffer_load_dwordx4 v21, s[36:39], s78 offen sc1 lds
    v_mul_f32 v217, v217, v233
    v_exp_f32 v82, v82
    v_mul_f32 v218, v218, v234
    v_exp_f32 v83, v83
    v_mul_f32 v219, v219, v235
    v_fma_f32 v80, v80, v67, v67
    s_add_u32 m0, s81, 114688
    s_mov_b32 s78, 1280
    s_mov_b64 exec, 0xffffffff
    buffer_load_dwordx4 v3, s[36:39], s78 offen sc1 lds
    s_mov_b64 exec, -1
    v_fma_f32 v81, v81, v67, v67
    v_fma_f32 v82, v82, v67, v67
    v_fma_f32 v83, v83, v67, v67
    v_rcp_f32 v80, v80
    v_rcp_f32 v81, v81
    v_rcp_f32 v82, v82
    s_add_u32 m0, s33, 16384
    s_mov_b32 s76, 3932160
    buffer_load_dwordx4 v23, s[40:43], s76 offen offset:0 lds
    s_add_u32 m0, s33, 18432
    s_nop 0
    buffer_load_dwordx4 v23, s[40:43], s76 offen offset:2048 lds
    v_rcp_f32 v83, v83
    s_nop 0
    v_mul_f32 v216, v216, v80
    v_mul_f32 v217, v217, v81
    v_mul_f32 v218, v218, v82
    v_mul_f32 v219, v219, v83
    v_cvt_pk_bf16_f32 v216, v216, v217
    v_cvt_pk_bf16_f32 v217, v218, v219
    s_add_u32 m0, s33, 24576
    s_nop 0
    buffer_load_dwordx4 v23, s[44:47], s76 offen offset:0 lds
    v_fmac_f32 v220, v56, v68
    v_fmac_f32 v221, v57, v68
    v_fmac_f32 v222, v58, v68
    v_fmac_f32 v223, v59, v68
    v_fmac_f32 v236, v60, v68
    v_fmac_f32 v237, v61, v68
    v_fmac_f32 v238, v62, v68
    v_fmac_f32 v239, v63, v68
    s_add_u32 m0, s33, 28672
    s_mov_b32 s77, 4587520
    buffer_load_dwordx4 v22, s[48:51], s77 offen offset:0 lds
    v_mul_f32 v80, v220, v220
    v_mul_f32 v81, v221, v221
    v_mul_f32 v82, v222, v222
    v_mul_f32 v83, v223, v223
    v_fma_f32 v80, v80, v70, v69
    v_fma_f32 v81, v81, v70, v69
    v_fma_f32 v82, v82, v70, v69
    v_fma_f32 v83, v83, v70, v69
    s_add_u32 m0, s33, 32768
    s_nop 0
    buffer_load_dwordx4 v22, s[52:55], s77 offen offset:0 lds
    s_add_u32 s75, s75, 0xffb00000
    s_load_dword s94, s[20:21], s75 offset:0x0
    s_load_dword s94, s[20:21], s75 offset:0x40
    s_load_dword s94, s[20:21], s75 offset:0x80
    s_load_dword s94, s[20:21], s75 offset:0xc0
    s_load_dword s94, s[20:21], s75 offset:0x100
    s_waitcnt vmcnt(16)
    s_barrier
    s_add_u32 m0, s79, 116736
    s_mov_b32 s78, 1408
    buffer_load_dwordx4 v20, s[36:39], s78 offen sc1 lds
    v_mul_f32 v80, v80, v220
    v_mul_f32 v81, v81, v221
    v_mul_f32 v82, v82, v222
    v_mul_f32 v83, v83, v223
    v_exp_f32 v80, v80
    v_mul_f32 v220, v220, v236
    v_exp_f32 v81, v81
    s_add_u32 m0, s79, 117760
    s_nop 0
    buffer_load_dwordx4 v21, s[36:39], s78 offen sc1 lds
    v_mul_f32 v221, v221, v237
    v_exp_f32 v82, v82
    v_mul_f32 v222, v222, v238
    v_exp_f32 v83, v83
    v_mul_f32 v223, v223, v239
    v_fma_f32 v80, v80, v71, v71
    s_add_u32 m0, s33, 36864
    s_mov_b32 s76, 4128768
    buffer_load_dwordx4 v23, s[40:43], s76 offen offset:0 lds
    v_fma_f32 v81, v81, v71, v71
    v_fma_f32 v82, v82, v71, v71
    v_fma_f32 v83, v83, v71, v71
    v_rcp_f32 v80, v80
    v_rcp_f32 v81, v81
    v_rcp_f32 v82, v82
    s_add_u32 m0, s33, 38912
    s_nop 0
    buffer_load_dwordx4 v23, s[40:43], s76 offen offset:2048 lds
    v_rcp_f32 v83, v83
    s_nop 0
    v_mul_f32 v220, v220, v80
    v_mul_f32 v221, v221, v81
    v_mul_f32 v222, v222, v82
    v_mul_f32 v223, v223, v83
    v_cvt_pk_bf16_f32 v218, v220, v221
    v_cvt_pk_bf16_f32 v219, v222, v223
    s_add_u32 m0, s33, 45056
    s_nop 0
    buffer_load_dwordx4 v23, s[44:47], s76 offen offset:0 lds
    s_nop 1
    v_permlane16_swap_b32 v216, v218
    v_permlane16_swap_b32 v217, v219
    s_add_u32 m0, s33, 49152
    s_mov_b32 s77, 4816896
    buffer_load_dwordx4 v22, s[48:51], s77 offen offset:0 lds
    v_fmac_f32 v224, v56, v72
    v_fmac_f32 v225, v57, v72
    v_fmac_f32 v226, v58, v72
    v_fmac_f32 v227, v59, v72
    v_fmac_f32 v240, v60, v72
    v_fmac_f32 v241, v61, v72
    v_fmac_f32 v242, v62, v72
    v_fmac_f32 v243, v63, v72
    s_add_u32 m0, s33, 53248
    s_nop 0
    buffer_load_dwordx4 v22, s[52:55], s77 offen offset:0 lds
    v_mul_f32 v80, v224, v224
    v_mul_f32 v81, v225, v225
    v_mul_f32 v82, v226, v226
    v_mul_f32 v83, v227, v227
    v_fma_f32 v80, v80, v74, v73
    v_fma_f32 v81, v81, v74, v73
    v_fma_f32 v82, v82, v74, v73
    v_fma_f32 v83, v83, v74, v73
    buffer_store_dwordx4 v[216:219], v19, s[68:71], s74 offen offset:0 sc1
    s_load_dword s94, s[20:21], s75 offset:0x140
    s_load_dword s94, s[20:21], s75 offset:0x180
    s_load_dword s94, s[20:21], s75 offset:0x1c0
    s_add_u32 s75, s75, 0x280000
    s_load_dword s94, s[20:21], s75 offset:0x0
    s_load_dword s94, s[20:21], s75 offset:0x40
    s_waitcnt vmcnt(17)
    s_barrier
    s_add_u32 m0, s79, 118784
    s_mov_b32 s78, 34176
    buffer_load_dwordx4 v20, s[36:39], s78 offen sc1 lds
    v_mul_f32 v80, v80, v224
    v_mul_f32 v81, v81, v225
    v_mul_f32 v82, v82, v226
    v_mul_f32 v83, v83, v227
    v_exp_f32 v80, v80
    v_mul_f32 v224, v224, v240
    v_exp_f32 v81, v81
    s_add_u32 m0, s79, 119808
    s_nop 0
    buffer_load_dwordx4 v21, s[36:39], s78 offen sc1 lds
    v_mul_f32 v225, v225, v241
    v_exp_f32 v82, v82
    v_mul_f32 v226, v226, v242
    v_exp_f32 v83, v83
    v_mul_f32 v227, v227, v243
    v_fma_f32 v80, v80, v75, v75
    s_add_u32 m0, s81, 133120
    s_mov_b32 s78, 1408
    s_mov_b64 exec, 0xffffffff
    buffer_load_dwordx4 v3, s[36:39], s78 offen sc1 lds
    s_mov_b64 exec, -1
    v_fma_f32 v81, v81, v75, v75
    v_fma_f32 v82, v82, v75, v75
    v_fma_f32 v83, v83, v75, v75
    v_rcp_f32 v80, v80
    v_rcp_f32 v81, v81
    v_rcp_f32 v82, v82
    s_add_u32 m0, s33, 57344
    s_mov_b32 s76, 4325376
    buffer_load_dwordx4 v23, s[40:43], s76 offen offset:0 lds
    s_add_u32 m0, s33, 59392
    s_nop 0
    buffer_load_dwordx4 v23, s[40:43], s76 offen offset:2048 lds
    v_rcp_f32 v83, v83
    s_nop 0
    v_mul_f32 v224, v224, v80
    v_mul_f32 v225, v225, v81
    v_mul_f32 v226, v226, v82
    v_mul_f32 v227, v227, v83
    v_cvt_pk_bf16_f32 v224, v224, v225
    v_cvt_pk_bf16_f32 v225, v226, v227
    s_add_u32 m0, s33, 65536
    s_nop 0
    buffer_load_dwordx4 v23, s[44:47], s76 offen offset:0 lds
    v_fmac_f32 v228, v56, v76
    v_fmac_f32 v229, v57, v76
    v_fmac_f32 v230, v58, v76
    v_fmac_f32 v231, v59, v76
    v_fmac_f32 v244, v60, v76
    v_fmac_f32 v245, v61, v76
    v_fmac_f32 v246, v62, v76
    v_fmac_f32 v247, v63, v76
    s_add_u32 m0, s33, 69632
    s_mov_b32 s77, 5046272
    buffer_load_dwordx4 v22, s[48:51], s77 offen offset:0 lds
    v_mul_f32 v80, v228, v228
    v_mul_f32 v81, v229, v229
    v_mul_f32 v82, v230, v230
    v_mul_f32 v83, v231, v231
    v_fma_f32 v80, v80, v78, v77
    v_fma_f32 v81, v81, v78, v77
    v_fma_f32 v82, v82, v78, v77
    v_fma_f32 v83, v83, v78, v77
    s_add_u32 m0, s33, 73728
    s_nop 0
    buffer_load_dwordx4 v22, s[52:55], s77 offen offset:0 lds
    s_load_dword s94, s[20:21], s75 offset:0x80
    s_load_dword s94, s[20:21], s75 offset:0xc0
    s_load_dword s94, s[20:21], s75 offset:0x100
    s_load_dword s94, s[20:21], s75 offset:0x140
    s_load_dword s94, s[20:21], s75 offset:0x180
    s_lshl_b32 s91, s4, 6
    s_add_u32 s91, s91, s29
    s_lshl_b32 s91, s91, 7
    s_add_u32 s91, s91, 0x1eb0000
    v_lshl_add_u32 v13, v1, 11, s91
    s_mov_b64 exec, 15
    global_load_dwordx2 v[14:15], v13, s[26:27] sc1
    s_mov_b64 exec, -1
    s_waitcnt vmcnt(17)
    s_barrier
    s_mov_b64 exec, 0
    s_cmp_eq_u32 s4, 0
    s_cbranch_scc1 L_pad4
    s_cmp_eq_u32 s4, 1
    s_cbranch_scc1 L_pad5
    s_cmp_eq_u32 s4, 2
    s_cbranch_scc1 L_pad10
    s_cmp_eq_u32 s4, 3
    s_cbranch_scc1 L_pad11
L_vret2:
    s_mov_b64 exec, -1
    v_mul_f32 v80, v80, v228
    v_mul_f32 v81, v81, v229
    v_mul_f32 v82, v82, v230
    v_mul_f32 v83, v83, v231
    v_exp_f32 v80, v80
    v_mul_f32 v228, v228, v244
    v_exp_f32 v81, v81
    v_mul_f32 v229, v229, v245
    v_exp_f32 v82, v82
    v_mul_f32 v230, v230, v246
    v_exp_f32 v83, v83
    v_mul_f32 v231, v231, v247
    v_fma_f32 v80, v80, v79, v79
    v_fma_f32 v81, v81, v79, v79
    v_fma_f32 v82, v82, v79, v79
    v_fma_f32 v83, v83, v79, v79
    v_rcp_f32 v80, v80
    v_rcp_f32 v81, v81
    v_rcp_f32 v82, v82
    v_rcp_f32 v83, v83
    s_nop 0
    v_mul_f32 v228, v228, v80
    v_mul_f32 v229, v229, v81
    v_mul_f32 v230, v230, v82
    v_mul_f32 v231, v231, v83
    v_cvt_pk_bf16_f32 v226, v228, v229
    v_cvt_pk_bf16_f32 v227, v230, v231
    s_nop 1
    v_permlane16_swap_b32 v224, v226
    v_permlane16_swap_b32 v225, v227
    buffer_store_dwordx4 v[224:227], v19, s[68:71], s74 offen offset:2048 sc1
    s_load_dword s94, s[20:21], s75 offset:0x1c0
    s_add_u32 s75, s75, 0xffe00000
    s_load_dword s94, s[20:21], s75 offset:0x0
    s_load_dword s94, s[20:21], s75 offset:0x40
    s_load_dword s94, s[20:21], s75 offset:0x80
    s_load_dword s94, s[20:21], s75 offset:0xc0
    s_waitcnt vmcnt(11)
    s_barrier
    s_add_u32 m0, s79, 135168
    s_mov_b32 s78, 1536
    buffer_load_dwordx4 v20, s[36:39], s78 offen sc1 lds
    s_add_u32 m0, s79, 136192
    s_nop 0
    buffer_load_dwordx4 v21, s[36:39], s78 offen sc1 lds
    s_add_u32 m0, s33, 77824
    s_mov_b32 s76, 4521984
    buffer_load_dwordx4 v23, s[40:43], s76 offen offset:0 lds
    s_add_u32 m0, s33, 79872
    s_nop 0
    buffer_load_dwordx4 v23, s[40:43], s76 offen offset:2048 lds
    s_add_u32 m0, s33, 86016
    s_nop 0
    buffer_load_dwordx4 v23, s[44:47], s76 offen offset:0 lds
    s_add_u32 m0, s33, 90112
    s_mov_b32 s77, 5275648
    buffer_load_dwordx4 v22, s[48:51], s77 offen offset:0 lds
    s_add_u32 m0, s33, 94208
    s_nop 0
    buffer_load_dwordx4 v22, s[52:55], s77 offen offset:0 lds
    s_add_u32 m0, s79, 137216
    s_mov_b32 s78, 34304
    buffer_load_dwordx4 v20, s[36:39], s78 offen sc1 lds
    s_add_u32 m0, s79, 138240
    s_nop 0
    buffer_load_dwordx4 v21, s[36:39], s78 offen sc1 lds
    s_add_u32 m0, s81, 151552
    s_mov_b32 s78, 1536
    s_mov_b64 exec, 0xffffffff
    buffer_load_dwordx4 v3, s[36:39], s78 offen sc1 lds
    s_mov_b64 exec, -1
    s_load_dword s94, s[20:21], s75 offset:0x100
    s_load_dword s94, s[20:21], s75 offset:0x140
    s_load_dword s94, s[20:21], s75 offset:0x180
    s_load_dword s94, s[20:21], s75 offset:0x1c0
    s_add_u32 s75, s75, 0x280000
    s_load_dword s94, s[20:21], s75 offset:0x0
    s_waitcnt vmcnt(11)
    s_mov_b64 exec, 15
    s_movk_i32 s98, 0x4000
L_pC_chk:
    v_cmp_ne_u64 vcc, s[100:101], v[14:15]
    s_nop 1
    s_cmp_eq_u64 vcc, 0
    s_cbranch_scc1 L_pC_ok
    s_sub_u32 s98, s98, 1
    s_cbranch_scc1 L_pC_ok
    s_sleep 1
    global_load_dwordx2 v[14:15], v13, s[26:27] sc1
    s_waitcnt vmcnt(0)
    s_branch L_pC_chk
L_pC_ok:
    s_mov_b64 exec, -1
    s_waitcnt vmcnt(12)
    s_barrier
    s_add_u32 m0, s33, 16384
    s_mov_b32 s76, 4718592
    buffer_load_dwordx4 v23, s[40:43], s76 offen offset:0 lds
    s_add_u32 m0, s33, 18432
    s_nop 0
    buffer_load_dwordx4 v23, s[40:43], s76 offen offset:2048 lds
    s_add_u32 m0, s33, 24576
    s_nop 0
    buffer_load_dwordx4 v23, s[44:47], s76 offen offset:0 lds
    s_add_u32 m0, s33, 28672
    s_mov_b32 s77, 5505024
    buffer_load_dwordx4 v22, s[48:51], s77 offen offset:0 lds
    s_add_u32 m0, s33, 32768
    s_nop 0
    buffer_load_dwordx4 v22, s[52:55], s77 offen offset:0 lds
    s_add_u32 m0, s79, 98304
    s_mov_b32 s78, 1664
    buffer_load_dwordx4 v20, s[36:39], s78 offen sc1 lds
    s_add_u32 m0, s79, 99328
    s_nop 0
    buffer_load_dwordx4 v21, s[36:39], s78 offen sc1 lds
    s_add_u32 m0, s33, 36864
    s_mov_b32 s76, 4915200
    buffer_load_dwordx4 v23, s[40:43], s76 offen offset:0 lds
    s_add_u32 m0, s33, 38912
    s_nop 0
    buffer_load_dwordx4 v23, s[40:43], s76 offen offset:2048 lds
    s_add_u32 m0, s33, 45056
    s_nop 0
    buffer_load_dwordx4 v23, s[44:47], s76 offen offset:0 lds
    s_add_u32 m0, s33, 49152
    s_mov_b32 s77, 5734400
    buffer_load_dwordx4 v22, s[48:51], s77 offen offset:0 lds
    s_load_dword s94, s[20:21], s75 offset:0x40
    s_load_dword s94, s[20:21], s75 offset:0x80
    s_load_dword s94, s[20:21], s75 offset:0xc0
    s_load_dword s94, s[20:21], s75 offset:0x100
    s_load_dword s94, s[20:21], s75 offset:0x140
    s_waitcnt vmcnt(14)
    s_barrier
    s_add_u32 m0, s33, 53248
    s_nop 0
    buffer_load_dwordx4 v22, s[52:55], s77 offen offset:0 lds
    s_add_u32 m0, s79, 100352
    s_mov_b32 s78, 34432
    buffer_load_dwordx4 v20, s[36:39], s78 offen sc1 lds
    s_add_u32 m0, s79, 101376
    s_nop 0
    buffer_load_dwordx4 v21, s[36:39], s78 offen sc1 lds
    s_add_u32 m0, s81, 114688
    s_mov_b32 s78, 1664
    s_mov_b64 exec, 0xffffffff
    buffer_load_dwordx4 v3, s[36:39], s78 offen sc1 lds
    s_mov_b64 exec, -1
    s_add_u32 m0, s33, 57344
    s_mov_b32 s76, 5111808
    buffer_load_dwordx4 v23, s[40:43], s76 offen offset:0 lds
    s_add_u32 m0, s33, 59392
    s_nop 0
    buffer_load_dwordx4 v23, s[40:43], s76 offen offset:2048 lds
    s_add_u32 m0, s33, 65536
    s_nop 0
    buffer_load_dwordx4 v23, s[44:47], s76 offen offset:0 lds
    s_add_u32 m0, s33, 69632
    s_mov_b32 s77, 5963776
    buffer_load_dwordx4 v22, s[48:51], s77 offen offset:0 lds
    s_add_u32 m0, s33, 73728
    s_nop 0
    buffer_load_dwordx4 v22, s[52:55], s77 offen offset:0 lds
    s_load_dword s94, s[20:21], s75 offset:0x180
    s_load_dword s94, s[20:21], s75 offset:0x1c0
    s_add_u32 s75, s75, 0xffe00000
    s_load_dword s94, s[20:21], s75 offset:0x0
    s_load_dword s94, s[20:21], s75 offset:0x40
    s_load_dword s94, s[20:21], s75 offset:0x80
    s_waitcnt vmcnt(30)
    s_waitcnt vmcnt(15)
    s_barrier
    s_mov_b64 exec, 0
    s_cmp_eq_u32 s4, 0
    s_cbranch_scc1 L_pad12
L_vret3:
    s_mov_b64 exec, -1
    s_load_dword s94, s[20:21], s75 offset:0xc0
    s_load_dword s94, s[20:21], s75 offset:0x100
    s_load_dword s94, s[20:21], s75 offset:0x140
    s_load_dword s94, s[20:21], s75 offset:0x180
    s_load_dword s94, s[20:21], s75 offset:0x1c0
    s_cmp_lg_u32 s4, 0
    s_cbranch_scc1 L_fH1
    s_lshl_b32 s91, s28, 4
    s_add_u32 s91, s91, s29
    s_lshl_b32 s91, s91, 7
    s_add_u32 s91, s91, 0x1e88000
    v_mov_b32 v12, s91
    v_mov_b32 v14, s100
    v_mov_b32 v15, s101
    s_mov_b64 exec, 1
    global_store_dwordx2 v12, v[14:15], s[26:27] sc1
    s_mov_b64 exec, -1
L_fH1:
    s_waitcnt vmcnt(8)
    s_barrier
    s_add_u32 m0, s79, 116736
    s_mov_b32 s78, 1792
    buffer_load_dwordx4 v20, s[36:39], s78 offen sc1 lds
    s_add_u32 m0, s79, 117760
    s_nop 0
    buffer_load_dwordx4 v21, s[36:39], s78 offen sc1 lds
    s_add_u32 m0, s33, 77824
    s_mov_b32 s76, 5308416
    buffer_load_dwordx4 v23, s[40:43], s76 offen offset:0 lds
    s_add_u32 m0, s33, 79872
    s_nop 0
    buffer_load_dwordx4 v23, s[40:43], s76 offen offset:2048 lds
    s_add_u32 m0, s33, 86016
    s_nop 0
    buffer_load_dwordx4 v23, s[44:47], s76 offen offset:0 lds
    s_add_u32 m0, s33, 90112
    s_mov_b32 s77, 6193152
    buffer_load_dwordx4 v22, s[48:51], s77 offen offset:0 lds
    s_add_u32 m0, s33, 94208
    s_nop 0
    buffer_load_dwordx4 v22, s[52:55], s77 offen offset:0 lds
    s_add_u32 m0, s79, 118784
    s_mov_b32 s78, 34560
    buffer_load_dwordx4 v20, s[36:39], s78 offen sc1 lds
    s_add_u32 m0, s79, 119808
    s_nop 0
    buffer_load_dwordx4 v21, s[36:39], s78 offen sc1 lds
    s_add_u32 m0, s81, 133120
    s_mov_b32 s78, 1792
    s_mov_b64 exec, 0xffffffff
    buffer_load_dwordx4 v3, s[36:39], s78 offen sc1 lds
    s_mov_b64 exec, -1
    s_add_u32 s75, s75, 0x280000
    s_load_dword s94, s[20:21], s75 offset:0x0
    s_load_dword s94, s[20:21], s75 offset:0x40
L_pad3:
    s_cbranch_execz L_vret1
    s_load_dword s94, s[20:21], s75 offset:0x80
    s_load_dword s94, s[20:21], s75 offset:0xc0
    s_load_dword s94, s[20:21], s75 offset:0x100
    s_waitcnt vmcnt(10)
    s_barrier
    s_add_u32 m0, s33, 16384
    s_mov_b32 s76, 5505024
    buffer_load_dwordx4 v23, s[40:43], s76 offen offset:0 lds
    s_add_u32 m0, s33, 18432
    s_nop 0
    buffer_load_dwordx4 v23, s[40:43], s76 offen offset:2048 lds
    s_add_u32 m0, s33, 24576
    s_nop 0
    buffer_load_dwordx4 v23, s[44:47], s76 offen offset:0 lds
    s_add_u32 m0, s33, 28672
    s_mov_b32 s77, 6422528
    buffer_load_dwordx4 v22, s[48:51], s77 offen offset:0 lds
    s_add_u32 m0, s33, 32768
    s_nop 0
    buffer_load_dwordx4 v22, s[52:55], s77 offen offset:0 lds
    s_add_u32 m0, s79, 135168
    s_mov_b32 s78, 1920
    buffer_load_dwordx4 v20, s[36:39], s78 offen sc1 lds
    s_add_u32 m0, s79, 136192
    s_nop 0
    buffer_load_dwordx4 v21, s[36:39], s78 offen sc1 lds
    s_add_u32 m0, s33, 36864
    s_mov_b32 s76, 5701632
    buffer_load_dwordx4 v23, s[40:43], s76 offen offset:0 lds
    s_add_u32 m0, s33, 38912
    s_nop 0
    buffer_load_dwordx4 v23, s[40:43], s76 offen offset:2048 lds
    s_add_u32 m0, s33, 45056
    s_nop 0
    buffer_load_dwordx4 v23, s[44:47], s76 offen offset:0 lds
    s_add_u32 m0, s33, 49152
    s_mov_b32 s77, 6651904
    buffer_load_dwordx4 v22, s[48:51], s77 offen offset:0 lds
    s_load_dword s94, s[20:21], s75 offset:0x140
    s_load_dword s94, s[20:21], s75 offset:0x180
    s_load_dword s94, s[20:21], s75 offset:0x1c0
    s_add_u32 s75, s75, 0xffe00000
    s_load_dword s94, s[20:21], s75 offset:0x0
    s_load_dword s94, s[20:21], s75 offset:0x40
    s_waitcnt vmcnt(14)
    s_barrier
    s_add_u32 m0, s33, 53248
    s_nop 0
    buffer_load_dwordx4 v22, s[52:55], s77 offen offset:0 lds
    s_add_u32 m0, s79, 137216
    s_mov_b32 s78, 34688
    buffer_load_dwordx4 v20, s[36:39], s78 offen sc1 lds
    s_add_u32 m0, s79, 138240
    s_nop 0
    buffer_load_dwordx4 v21, s[36:39], s78 offen sc1 lds
    s_add_u32 m0, s81, 151552
    s_mov_b32 s78, 1920
    s_mov_b64 exec, 0xffffffff
    buffer_load_dwordx4 v3, s[36:39], s78 offen sc1 lds
    s_mov_b64 exec, -1
    s_add_u32 m0, s33, 57344
    s_mov_b32 s76, 5898240
    buffer_load_dwordx4 v23, s[40:43], s76 offen offset:0 lds
    s_add_u32 m0, s33, 59392
    s_nop 0
    buffer_load_dwordx4 v23, s[40:43], s76 offen offset:2048 lds
    s_add_u32 m0, s33, 65536
    s_nop 0
    buffer_load_dwordx4 v23, s[44:47], s76 offen offset:0 lds
    s_add_u32 m0, s33, 69632
    s_mov_b32 s77, 6881280
    buffer_load_dwordx4 v22, s[48:51], s77 offen offset:0 lds
    s_add_u32 m0, s33, 73728
    s_nop 0
    buffer_load_dwordx4 v22, s[52:55], s77 offen offset:0 lds
    s_lshl2_add_u32 s91, s30, s4
    s_lshl_b32 s91, s91, 9
    s_add_u32 s91, s91, 0x1e88000
    v_lshl_add_u32 v13, v1, 7, s91
    s_mov_b64 exec, 15
    global_load_dwordx2 v[14:15], v13, s[26:27] sc1
    s_mov_b64 exec, -1
    s_waitcnt vmcnt(16)
    s_barrier
    s_add_u32 m0, s33, 77824
    s_mov_b32 s76, 6094848
    buffer_load_dwordx4 v23, s[40:43], s76 offen offset:0 lds
    s_add_u32 m0, s33, 79872
    s_nop 0
    buffer_load_dwordx4 v23, s[40:43], s76 offen offset:2048 lds
    s_add_u32 m0, s33, 86016
    s_nop 0
    buffer_load_dwordx4 v23, s[44:47], s76 offen offset:0 lds
    s_add_u32 m0, s33, 90112
    s_mov_b32 s77, 7110656
    buffer_load_dwordx4 v22, s[48:51], s77 offen offset:0 lds
    s_add_u32 m0, s33, 94208
    s_nop 0
    buffer_load_dwordx4 v22, s[52:55], s77 offen offset:0 lds
    s_waitcnt vmcnt(5)
    s_mov_b64 exec, 15
    s_movk_i32 s98, 0x4000
L_pH1_chk:
    v_cmp_ne_u64 vcc, s[100:101], v[14:15]
    s_nop 1
    s_cmp_eq_u64 vcc, 0
    s_cbranch_scc1 L_pH1_ok
    s_sub_u32 s98, s98, 1
    s_cbranch_scc1 L_pH1_ok
    s_sleep 1
    global_load_dwordx2 v[14:15], v13, s[26:27] sc1
    s_waitcnt vmcnt(0)
    s_branch L_pH1_chk
L_pH1_ok:
    s_mov_b64 exec, -1
    s_waitcnt vmcnt(14)
    s_barrier
    s_mov_b32 s40, s34
    s_mov_b32 s42, s35
    s_memrealtime s[44:45]
    s_memtime s[46:47]
    s_lshl4_add_u32 s91, s28, s29
    s_lshl_b32 s91, s91, 7
    s_add_u32 s92, s91, 0x1ea8000
    s_xor_b32 s91, s91, 17408
    s_add_u32 s91, s91, 0x1ea8000
    v_mov_b32 v239, s92
    v_writelane_b32 v239, s91, 1
    s_lshl_b32 m0, s33, 2
    s_nop 0
    buffer_load_dwordx4 v18, s[56:59], s82 offen offset:0 sc1 lds
    buffer_load_dwordx4 v18, s[56:59], s82 offen offset:1024 sc1 lds
    buffer_load_dwordx4 v18, s[56:59], s82 offen offset:2048 sc1 lds
    buffer_load_dwordx4 v18, s[56:59], s82 offen offset:3072 sc1 lds
    s_add_u32 s82, s82, 16384
    s_lshl1_add_u32 m0, s33, 16384
    s_nop 0
    buffer_load_dwordx4 v254, s[60:63], s83 offen lds
    s_lshl1_add_u32 m0, s33, 17408
    s_nop 0
    buffer_load_dwordx4 v255, s[60:63], s83 offen lds
    s_lshl1_add_u32 m0, s33, 24576
    s_nop 0
    buffer_load_dwordx4 v254, s[64:67], s83 offen lds
    s_lshl1_add_u32 m0, s33, 25600
    s_nop 0
    buffer_load_dwordx4 v255, s[64:67], s83 offen lds
    s_add_u32 s83, s83, 131072
    s_lshl_b32 s84, s2, 15
    s_lshl_b32 s85, s4, 13
    s_add_u32 s84, s84, s85
    s_add_u32 s36, s84, 0x1600000
    s_add_u32 s37, s36, 4096
    s_xor_b32 s84, s84, 163840
    s_add_u32 s38, s84, 0x1600000
    s_add_u32 s39, s38, 4096
    v_lshlrev_b32 v4, 4, v1
    s_lshl_b32 s84, s4, 12
    s_add_u32 s84, s84, 147456
    v_lshl_add_u32 v5, v1, 3, s84
    v_lshlrev_b32 v6, 2, v1
    s_waitcnt vmcnt(14)
    s_barrier
    s_lshl2_add_u32 m0, s33, 98304
    s_nop 0
    buffer_load_dwordx4 v18, s[56:59], s82 offen offset:0 sc1 lds
    buffer_load_dwordx4 v18, s[56:59], s82 offen offset:1024 sc1 lds
    buffer_load_dwordx4 v18, s[56:59], s82 offen offset:2048 sc1 lds
    buffer_load_dwordx4 v18, s[56:59], s82 offen offset:3072 sc1 lds
    s_add_u32 s82, s82, 16384
    s_lshl1_add_u32 m0, s33, 114688
    s_nop 0
    buffer_load_dwordx4 v254, s[60:63], s83 offen lds
    s_lshl1_add_u32 m0, s33, 115712
    s_nop 0
    buffer_load_dwordx4 v255, s[60:63], s83 offen lds
    s_lshl1_add_u32 m0, s33, 122880
    s_nop 0
    buffer_load_dwordx4 v254, s[64:67], s83 offen lds
    s_lshl1_add_u32 m0, s33, 123904
    s_nop 0
    buffer_load_dwordx4 v255, s[64:67], s83 offen lds
    s_add_u32 s83, s83, 131072
    s_waitcnt lgkmcnt(0)
    s_sub_u32 s40, s44, s40
    s_sub_u32 s42, s46, s42
    v_cvt_f32_u32 v8, s42
    v_cvt_f32_u32 v9, s40
    v_rcp_f32 v8, v8
    v_mul_f32 v9, 0x463b8000, v9
    v_mul_f32 v8, v8, v9
    v_cvt_u32_f32 v10, v8
    v_add_u32 v10, s44, v10
    v_mov_b32 v8, s100
    v_mov_b32 v9, s101
    s_cmp_eq_u32 s4, 0
    s_cselect_b64 exec, 1, 0
    s_cbranch_execz L_tp
    global_store_dwordx3 v239, v[8:10], s[26:27] sc1
L_tp:
    s_mov_b64 exec, -1
    s_waitcnt vmcnt(16)
    s_barrier
    s_lshl2_add_u32 m0, s33, 32768
    s_nop 0
    buffer_load_dwordx4 v18, s[56:59], s82 offen offset:0 sc1 lds
    buffer_load_dwordx4 v18, s[56:59], s82 offen offset:1024 sc1 lds
    buffer_load_dwordx4 v18, s[56:59], s82 offen offset:2048 sc1 lds
    buffer_load_dwordx4 v18, s[56:59], s82 offen offset:3072 sc1 lds
    s_add_u32 s82, s82, 16384
    s_lshl1_add_u32 m0, s33, 49152
    s_nop 0
    buffer_load_dwordx4 v254, s[60:63], s83 offen lds
    s_lshl1_add_u32 m0, s33, 50176
    s_nop 0
    buffer_load_dwordx4 v255, s[60:63], s83 offen lds
    s_lshl1_add_u32 m0, s33, 57344
    s_nop 0
    buffer_load_dwordx4 v254, s[64:67], s83 offen lds
    s_lshl1_add_u32 m0, s33, 58368
    s_nop 0
    buffer_load_dwordx4 v255, s[64:67], s83 offen lds
    s_add_u32 s83, s83, 131072
    s_waitcnt vmcnt(16)
    s_barrier
    s_setprio 1
    ds_read_b64_tr_b16 v[40:41], v250 offset:16384
    ds_read_b64_tr_b16 v[42:43], v250 offset:16896
    ds_read_b128 v[24:27], v248 offset:0
    ds_read_b128 v[28:31], v248 offset:1024
    ds_read_b128 v[32:35], v248 offset:2048
    ds_read_b128 v[36:39], v248 offset:3072
    ds_read_b64_tr_b16 v[44:45], v251 offset:16384
    ds_read_b64_tr_b16 v[46:47], v251 offset:16896
    ds_read_b64_tr_b16 v[48:49], v250 offset:24576
    ds_read_b64_tr_b16 v[50:51], v250 offset:25088
    ds_read_b64_tr_b16 v[52:53], v251 offset:24576
    ds_read_b64_tr_b16 v[54:55], v251 offset:25088
    s_lshl2_add_u32 m0, s33, 65536
    s_nop 0
    buffer_load_dwordx4 v18, s[56:59], s82 offen offset:0 sc1 lds
    buffer_load_dwordx4 v18, s[56:59], s82 offen offset:1024 sc1 lds
    buffer_load_dwordx4 v18, s[56:59], s82 offen offset:2048 sc1 lds
    buffer_load_dwordx4 v18, s[56:59], s82 offen offset:3072 sc1 lds
    s_add_u32 s82, s82, 16384
    s_waitcnt lgkmcnt(9)
    v_mfma_f32_16x16x32_bf16 v[88:91], v[40:43], v[24:27], 0
    ds_read_b64_tr_b16 v[72:73], v250 offset:20480
    ds_read_b64_tr_b16 v[74:75], v250 offset:20992
    s_waitcnt lgkmcnt(10)
    v_mfma_f32_16x16x32_bf16 v[92:95], v[40:43], v[28:31], 0
    ds_read_b128 v[56:59], v248 offset:8192
    s_lshl1_add_u32 m0, s33, 81920
    s_waitcnt lgkmcnt(10)
    v_mfma_f32_16x16x32_bf16 v[96:99], v[40:43], v[32:35], 0
    ds_read_b128 v[60:63], v248 offset:9216
    ds_read_b128 v[64:67], v248 offset:10240
    s_waitcnt lgkmcnt(11)
    v_mfma_f32_16x16x32_bf16 v[100:103], v[40:43], v[36:39], 0
    ds_read_b128 v[68:71], v248 offset:11264
    buffer_load_dwordx4 v254, s[60:63], s83 offen lds
    s_waitcnt lgkmcnt(10)
    v_mfma_f32_16x16x32_bf16 v[104:107], v[44:47], v[24:27], 0
    ds_read_b64_tr_b16 v[76:77], v251 offset:20480
    ds_read_b64_tr_b16 v[78:79], v251 offset:20992
    v_mfma_f32_16x16x32_bf16 v[108:111], v[44:47], v[28:31], 0
    ds_read_b64_tr_b16 v[80:81], v250 offset:28672
    s_lshl1_add_u32 m0, s33, 82944
    v_mfma_f32_16x16x32_bf16 v[112:115], v[44:47], v[32:35], 0
    ds_read_b64_tr_b16 v[82:83], v250 offset:29184
    ds_read_b64_tr_b16 v[84:85], v251 offset:28672
    v_mfma_f32_16x16x32_bf16 v[116:119], v[44:47], v[36:39], 0
    ds_read_b64_tr_b16 v[86:87], v251 offset:29184
    buffer_load_dwordx4 v255, s[60:63], s83 offen lds
    s_waitcnt lgkmcnt(14)
    v_mfma_f32_16x16x32_bf16 v[120:123], v[48:51], v[24:27], 0
    v_mfma_f32_16x16x32_bf16 v[124:127], v[48:51], v[28:31], 0
    s_lshl1_add_u32 m0, s33, 90112
    v_mfma_f32_16x16x32_bf16 v[128:131], v[48:51], v[32:35], 0
    v_mfma_f32_16x16x32_bf16 v[132:135], v[48:51], v[36:39], 0
    buffer_load_dwordx4 v254, s[64:67], s83 offen lds
    s_waitcnt lgkmcnt(12)
    v_mfma_f32_16x16x32_bf16 v[136:139], v[52:55], v[24:27], 0
    v_mfma_f32_16x16x32_bf16 v[140:143], v[52:55], v[28:31], 0
    s_lshl1_add_u32 m0, s33, 91136
    v_mfma_f32_16x16x32_bf16 v[144:147], v[52:55], v[32:35], 0
    v_mfma_f32_16x16x32_bf16 v[148:151], v[52:55], v[36:39], 0
    buffer_load_dwordx4 v255, s[64:67], s83 offen lds
    s_add_u32 s83, s83, 131072
    s_waitcnt vmcnt(16) lgkmcnt(0)
    s_barrier
    v_mfma_f32_16x16x32_bf16 v[88:91], v[72:75], v[56:59], v[88:91]
    ds_read_b64_tr_b16 v[40:41], v252 offset:49152
    ds_read_b64_tr_b16 v[42:43], v252 offset:49664
    v_mfma_f32_16x16x32_bf16 v[92:95], v[72:75], v[60:63], v[92:95]
    ds_read_b128 v[24:27], v249 offset:32768
    s_lshl_b32 m0, s33, 2
    v_mfma_f32_16x16x32_bf16 v[96:99], v[72:75], v[64:67], v[96:99]
    ds_read_b128 v[28:31], v249 offset:33792
    v_mfma_f32_16x16x32_bf16 v[100:103], v[72:75], v[68:71], v[100:103]
    ds_read_b128 v[32:35], v249 offset:34816
    buffer_load_dwordx4 v18, s[56:59], s82 offen offset:0 sc1 lds
    v_mfma_f32_16x16x32_bf16 v[104:107], v[76:79], v[56:59], v[104:107]
    ds_read_b128 v[36:39], v249 offset:35840
    v_mfma_f32_16x16x32_bf16 v[108:111], v[76:79], v[60:63], v[108:111]
    ds_read_b64_tr_b16 v[44:45], v253 offset:49152
    ds_read_b64_tr_b16 v[46:47], v253 offset:49664
    v_mfma_f32_16x16x32_bf16 v[112:115], v[76:79], v[64:67], v[112:115]
    ds_read_b64_tr_b16 v[48:49], v252 offset:57344
    v_mfma_f32_16x16x32_bf16 v[116:119], v[76:79], v[68:71], v[116:119]
    ds_read_b64_tr_b16 v[50:51], v252 offset:57856
    buffer_load_dwordx4 v18, s[56:59], s82 offen offset:1024 sc1 lds
    v_mfma_f32_16x16x32_bf16 v[120:123], v[80:83], v[56:59], v[120:123]
    ds_read_b64_tr_b16 v[52:53], v253 offset:57344
    v_mfma_f32_16x16x32_bf16 v[124:127], v[80:83], v[60:63], v[124:127]
    ds_read_b64_tr_b16 v[54:55], v253 offset:57856
    v_mfma_f32_16x16x32_bf16 v[128:131], v[80:83], v[64:67], v[128:131]
    v_mfma_f32_16x16x32_bf16 v[132:135], v[80:83], v[68:71], v[132:135]
    buffer_load_dwordx4 v18, s[56:59], s82 offen offset:2048 sc1 lds
    v_mfma_f32_16x16x32_bf16 v[136:139], v[84:87], v[56:59], v[136:139]
    v_mfma_f32_16x16x32_bf16 v[140:143], v[84:87], v[60:63], v[140:143]
    v_mfma_f32_16x16x32_bf16 v[144:147], v[84:87], v[64:67], v[144:147]
    v_mfma_f32_16x16x32_bf16 v[148:151], v[84:87], v[68:71], v[148:151]
    buffer_load_dwordx4 v18, s[56:59], s82 offen offset:3072 sc1 lds
    s_add_u32 s82, s82, 16384
    s_waitcnt lgkmcnt(9)
    v_mfma_f32_16x16x32_bf16 v[88:91], v[40:43], v[24:27], v[88:91]
    ds_read_b64_tr_b16 v[72:73], v252 offset:53248
    ds_read_b64_tr_b16 v[74:75], v252 offset:53760
    s_waitcnt lgkmcnt(10)
    v_mfma_f32_16x16x32_bf16 v[92:95], v[40:43], v[28:31], v[92:95]
    ds_read_b128 v[56:59], v249 offset:40960
    s_lshl1_add_u32 m0, s33, 16384
    s_waitcnt lgkmcnt(10)
    v_mfma_f32_16x16x32_bf16 v[96:99], v[40:43], v[32:35], v[96:99]
    ds_read_b128 v[60:63], v249 offset:41984
    ds_read_b128 v[64:67], v249 offset:43008
    s_waitcnt lgkmcnt(11)
    v_mfma_f32_16x16x32_bf16 v[100:103], v[40:43], v[36:39], v[100:103]
    ds_read_b128 v[68:71], v249 offset:44032
    buffer_load_dwordx4 v254, s[60:63], s83 offen lds
    s_waitcnt lgkmcnt(10)
    v_mfma_f32_16x16x32_bf16 v[104:107], v[44:47], v[24:27], v[104:107]
    ds_read_b64_tr_b16 v[76:77], v253 offset:53248
    ds_read_b64_tr_b16 v[78:79], v253 offset:53760
    v_mfma_f32_16x16x32_bf16 v[108:111], v[44:47], v[28:31], v[108:111]
    ds_read_b64_tr_b16 v[80:81], v252 offset:61440
    s_lshl1_add_u32 m0, s33, 17408
    v_mfma_f32_16x16x32_bf16 v[112:115], v[44:47], v[32:35], v[112:115]
    ds_read_b64_tr_b16 v[82:83], v252 offset:61952
    ds_read_b64_tr_b16 v[84:85], v253 offset:61440
    v_mfma_f32_16x16x32_bf16 v[116:119], v[44:47], v[36:39], v[116:119]
    ds_read_b64_tr_b16 v[86:87], v253 offset:61952
    buffer_load_dwordx4 v255, s[60:63], s83 offen lds
    s_waitcnt lgkmcnt(14)
    v_mfma_f32_16x16x32_bf16 v[120:123], v[48:51], v[24:27], v[120:123]
    v_mfma_f32_16x16x32_bf16 v[124:127], v[48:51], v[28:31], v[124:127]
    s_lshl1_add_u32 m0, s33, 24576
    v_mfma_f32_16x16x32_bf16 v[128:131], v[48:51], v[32:35], v[128:131]
    v_mfma_f32_16x16x32_bf16 v[132:135], v[48:51], v[36:39], v[132:135]
    buffer_load_dwordx4 v254, s[64:67], s83 offen lds
    s_waitcnt lgkmcnt(12)
    v_mfma_f32_16x16x32_bf16 v[136:139], v[52:55], v[24:27], v[136:139]
    v_mfma_f32_16x16x32_bf16 v[140:143], v[52:55], v[28:31], v[140:143]
    s_lshl1_add_u32 m0, s33, 25600
    v_mfma_f32_16x16x32_bf16 v[144:147], v[52:55], v[32:35], v[144:147]
    v_mfma_f32_16x16x32_bf16 v[148:151], v[52:55], v[36:39], v[148:151]
    buffer_load_dwordx4 v255, s[64:67], s83 offen lds
    s_add_u32 s83, s83, 131072
    s_waitcnt vmcnt(16) lgkmcnt(0)
    s_barrier
    v_mfma_f32_16x16x32_bf16 v[88:91], v[72:75], v[56:59], v[88:91]
    ds_read_b64_tr_b16 v[40:41], v250 offset:49152
    ds_read_b64_tr_b16 v[42:43], v250 offset:49664
    v_mfma_f32_16x16x32_bf16 v[92:95], v[72:75], v[60:63], v[92:95]
    ds_read_b128 v[24:27], v248 offset:32768
    s_lshl2_add_u32 m0, s33, 98304
    v_mfma_f32_16x16x32_bf16 v[96:99], v[72:75], v[64:67], v[96:99]
    ds_read_b128 v[28:31], v248 offset:33792
    v_mfma_f32_16x16x32_bf16 v[100:103], v[72:75], v[68:71], v[100:103]
    ds_read_b128 v[32:35], v248 offset:34816
    buffer_load_dwordx4 v18, s[56:59], s82 offen offset:0 sc1 lds
    v_mfma_f32_16x16x32_bf16 v[104:107], v[76:79], v[56:59], v[104:107]
    ds_read_b128 v[36:39], v248 offset:35840
    v_mfma_f32_16x16x32_bf16 v[108:111], v[76:79], v[60:63], v[108:111]
    ds_read_b64_tr_b16 v[44:45], v251 offset:49152
    ds_read_b64_tr_b16 v[46:47], v251 offset:49664
    v_mfma_f32_16x16x32_bf16 v[112:115], v[76:79], v[64:67], v[112:115]
    ds_read_b64_tr_b16 v[48:49], v250 offset:57344
    v_mfma_f32_16x16x32_bf16 v[116:119], v[76:79], v[68:71], v[116:119]
    ds_read_b64_tr_b16 v[50:51], v250 offset:57856
    buffer_load_dwordx4 v18, s[56:59], s82 offen offset:1024 sc1 lds
    v_mfma_f32_16x16x32_bf16 v[120:123], v[80:83], v[56:59], v[120:123]
    ds_read_b64_tr_b16 v[52:53], v251 offset:57344
    v_mfma_f32_16x16x32_bf16 v[124:127], v[80:83], v[60:63], v[124:127]
    ds_read_b64_tr_b16 v[54:55], v251 offset:57856
    v_mfma_f32_16x16x32_bf16 v[128:131], v[80:83], v[64:67], v[128:131]
    v_mfma_f32_16x16x32_bf16 v[132:135], v[80:83], v[68:71], v[132:135]
    buffer_load_dwordx4 v18, s[56:59], s82 offen offset:2048 sc1 lds
    v_mfma_f32_16x16x32_bf16 v[136:139], v[84:87], v[56:59], v[136:139]
    v_mfma_f32_16x16x32_bf16 v[140:143], v[84:87], v[60:63], v[140:143]
    v_mfma_f32_16x16x32_bf16 v[144:147], v[84:87], v[64:67], v[144:147]
    v_mfma_f32_16x16x32_bf16 v[148:151], v[84:87], v[68:71], v[148:151]
    buffer_load_dwordx4 v18, s[56:59], s82 offen offset:3072 sc1 lds
    s_add_u32 s82, s82, 16384
    s_waitcnt lgkmcnt(9)
    v_mfma_f32_16x16x32_bf16 v[88:91], v[40:43], v[24:27], v[88:91]
    ds_read_b64_tr_b16 v[72:73], v250 offset:53248
    ds_read_b64_tr_b16 v[74:75], v250 offset:53760
    s_waitcnt lgkmcnt(10)
    v_mfma_f32_16x16x32_bf16 v[92:95], v[40:43], v[28:31], v[92:95]
    ds_read_b128 v[56:59], v248 offset:40960
    s_lshl1_add_u32 m0, s33, 114688
    s_waitcnt lgkmcnt(10)
    v_mfma_f32_16x16x32_bf16 v[96:99], v[40:43], v[32:35], v[96:99]
    ds_read_b128 v[60:63], v248 offset:41984
    ds_read_b128 v[64:67], v248 offset:43008
    s_waitcnt lgkmcnt(11)
    v_mfma_f32_16x16x32_bf16 v[100:103], v[40:43], v[36:39], v[100:103]
    ds_read_b128 v[68:71], v248 offset:44032
    buffer_load_dwordx4 v254, s[60:63], s83 offen lds
    s_waitcnt lgkmcnt(10)
    v_mfma_f32_16x16x32_bf16 v[104:107], v[44:47], v[24:27], v[104:107]
    ds_read_b64_tr_b16 v[76:77], v251 offset:53248
    ds_read_b64_tr_b16 v[78:79], v251 offset:53760
    v_mfma_f32_16x16x32_bf16 v[108:111], v[44:47], v[28:31], v[108:111]
    ds_read_b64_tr_b16 v[80:81], v250 offset:61440
    s_lshl1_add_u32 m0, s33, 115712
    v_mfma_f32_16x16x32_bf16 v[112:115], v[44:47], v[32:35], v[112:115]
    ds_read_b64_tr_b16 v[82:83], v250 offset:61952
    ds_read_b64_tr_b16 v[84:85], v251 offset:61440
    v_mfma_f32_16x16x32_bf16 v[116:119], v[44:47], v[36:39], v[116:119]
    ds_read_b64_tr_b16 v[86:87], v251 offset:61952
    buffer_load_dwordx4 v255, s[60:63], s83 offen lds
    s_waitcnt lgkmcnt(14)
    v_mfma_f32_16x16x32_bf16 v[120:123], v[48:51], v[24:27], v[120:123]
    v_mfma_f32_16x16x32_bf16 v[124:127], v[48:51], v[28:31], v[124:127]
    s_lshl1_add_u32 m0, s33, 122880
    v_mfma_f32_16x16x32_bf16 v[128:131], v[48:51], v[32:35], v[128:131]
    v_mfma_f32_16x16x32_bf16 v[132:135], v[48:51], v[36:39], v[132:135]
    buffer_load_dwordx4 v254, s[64:67], s83 offen lds
    s_waitcnt lgkmcnt(12)
    v_mfma_f32_16x16x32_bf16 v[136:139], v[52:55], v[24:27], v[136:139]
    v_mfma_f32_16x16x32_bf16 v[140:143], v[52:55], v[28:31], v[140:143]
    s_lshl1_add_u32 m0, s33, 123904
    v_mfma_f32_16x16x32_bf16 v[144:147], v[52:55], v[32:35], v[144:147]
    v_mfma_f32_16x16x32_bf16 v[148:151], v[52:55], v[36:39], v[148:151]
    buffer_load_dwordx4 v255, s[64:67], s83 offen lds
    s_add_u32 s83, s83, 131072
    s_waitcnt vmcnt(16) lgkmcnt(0)
    s_barrier
    v_mfma_f32_16x16x32_bf16 v[88:91], v[72:75], v[56:59], v[88:91]
    ds_read_b64_tr_b16 v[40:41], v252 offset:16384
    ds_read_b64_tr_b16 v[42:43], v252 offset:16896
    v_mfma_f32_16x16x32_bf16 v[92:95], v[72:75], v[60:63], v[92:95]
    ds_read_b128 v[24:27], v249 offset:0
    s_lshl2_add_u32 m0, s33, 32768
    v_mfma_f32_16x16x32_bf16 v[96:99], v[72:75], v[64:67], v[96:99]
    ds_read_b128 v[28:31], v249 offset:1024
    v_mfma_f32_16x16x32_bf16 v[100:103], v[72:75], v[68:71], v[100:103]
    ds_read_b128 v[32:35], v249 offset:2048
    buffer_load_dwordx4 v18, s[56:59], s82 offen offset:0 sc1 lds
    v_mfma_f32_16x16x32_bf16 v[104:107], v[76:79], v[56:59], v[104:107]
    ds_read_b128 v[36:39], v249 offset:3072
    v_mfma_f32_16x16x32_bf16 v[108:111], v[76:79], v[60:63], v[108:111]
    ds_read_b64_tr_b16 v[44:45], v253 offset:16384
    ds_read_b64_tr_b16 v[46:47], v253 offset:16896
    v_mfma_f32_16x16x32_bf16 v[112:115], v[76:79], v[64:67], v[112:115]
    ds_read_b64_tr_b16 v[48:49], v252 offset:24576
    v_mfma_f32_16x16x32_bf16 v[116:119], v[76:79], v[68:71], v[116:119]
    ds_read_b64_tr_b16 v[50:51], v252 offset:25088
    buffer_load_dwordx4 v18, s[56:59], s82 offen offset:1024 sc1 lds
    v_mfma_f32_16x16x32_bf16 v[120:123], v[80:83], v[56:59], v[120:123]
    ds_read_b64_tr_b16 v[52:53], v253 offset:24576
    v_mfma_f32_16x16x32_bf16 v[124:127], v[80:83], v[60:63], v[124:127]
    ds_read_b64_tr_b16 v[54:55], v253 offset:25088
    v_mfma_f32_16x16x32_bf16 v[128:131], v[80:83], v[64:67], v[128:131]
    v_mfma_f32_16x16x32_bf16 v[132:135], v[80:83], v[68:71], v[132:135]
    buffer_load_dwordx4 v18, s[56:59], s82 offen offset:2048 sc1 lds
    v_mfma_f32_16x16x32_bf16 v[136:139], v[84:87], v[56:59], v[136:139]
    v_mfma_f32_16x16x32_bf16 v[140:143], v[84:87], v[60:63], v[140:143]
    v_mfma_f32_16x16x32_bf16 v[144:147], v[84:87], v[64:67], v[144:147]
    v_mfma_f32_16x16x32_bf16 v[148:151], v[84:87], v[68:71], v[148:151]
    buffer_load_dwordx4 v18, s[56:59], s82 offen offset:3072 sc1 lds
    s_add_u32 s82, s82, 16384
    s_waitcnt lgkmcnt(9)
    v_mfma_f32_16x16x32_bf16 v[88:91], v[40:43], v[24:27], v[88:91]
    ds_read_b64_tr_b16 v[72:73], v252 offset:20480
    ds_read_b64_tr_b16 v[74:75], v252 offset:20992
    s_waitcnt lgkmcnt(10)
    v_mfma_f32_16x16x32_bf16 v[92:95], v[40:43], v[28:31], v[92:95]
    ds_read_b128 v[56:59], v249 offset:8192
    s_lshl1_add_u32 m0, s33, 49152
    s_waitcnt lgkmcnt(10)
    v_mfma_f32_16x16x32_bf16 v[96:99], v[40:43], v[32:35], v[96:99]
    ds_read_b128 v[60:63], v249 offset:9216
    ds_read_b128 v[64:67], v249 offset:10240
    s_waitcnt lgkmcnt(11)
    v_mfma_f32_16x16x32_bf16 v[100:103], v[40:43], v[36:39], v[100:103]
    ds_read_b128 v[68:71], v249 offset:11264
    buffer_load_dwordx4 v254, s[60:63], s83 offen lds
    s_waitcnt lgkmcnt(10)
    v_mfma_f32_16x16x32_bf16 v[104:107], v[44:47], v[24:27], v[104:107]
    ds_read_b64_tr_b16 v[76:77], v253 offset:20480
    ds_read_b64_tr_b16 v[78:79], v253 offset:20992
    v_mfma_f32_16x16x32_bf16 v[108:111], v[44:47], v[28:31], v[108:111]
    ds_read_b64_tr_b16 v[80:81], v252 offset:28672
    s_lshl1_add_u32 m0, s33, 50176
    v_mfma_f32_16x16x32_bf16 v[112:115], v[44:47], v[32:35], v[112:115]
    ds_read_b64_tr_b16 v[82:83], v252 offset:29184
    ds_read_b64_tr_b16 v[84:85], v253 offset:28672
    v_mfma_f32_16x16x32_bf16 v[116:119], v[44:47], v[36:39], v[116:119]
    ds_read_b64_tr_b16 v[86:87], v253 offset:29184
    buffer_load_dwordx4 v255, s[60:63], s83 offen lds
    s_waitcnt lgkmcnt(14)
    v_mfma_f32_16x16x32_bf16 v[120:123], v[48:51], v[24:27], v[120:123]
    v_mfma_f32_16x16x32_bf16 v[124:127], v[48:51], v[28:31], v[124:127]
    s_lshl1_add_u32 m0, s33, 57344
    v_mfma_f32_16x16x32_bf16 v[128:131], v[48:51], v[32:35], v[128:131]
    v_mfma_f32_16x16x32_bf16 v[132:135], v[48:51], v[36:39], v[132:135]
    buffer_load_dwordx4 v254, s[64:67], s83 offen lds
    s_waitcnt lgkmcnt(12)
    v_mfma_f32_16x16x32_bf16 v[136:139], v[52:55], v[24:27], v[136:139]
    v_mfma_f32_16x16x32_bf16 v[140:143], v[52:55], v[28:31], v[140:143]
    s_lshl1_add_u32 m0, s33, 58368
    v_mfma_f32_16x16x32_bf16 v[144:147], v[52:55], v[32:35], v[144:147]
    v_mfma_f32_16x16x32_bf16 v[148:151], v[52:55], v[36:39], v[148:151]
    buffer_load_dwordx4 v255, s[64:67], s83 offen lds
    s_add_u32 s83, s83, 131072
    s_waitcnt vmcnt(16) lgkmcnt(0)
    s_barrier
    v_mfma_f32_16x16x32_bf16 v[88:91], v[72:75], v[56:59], v[88:91]
    ds_read_b64_tr_b16 v[40:41], v250 offset:16384
    ds_read_b64_tr_b16 v[42:43], v250 offset:16896
    v_mfma_f32_16x16x32_bf16 v[92:95], v[72:75], v[60:63], v[92:95]
    ds_read_b128 v[24:27], v248 offset:0
    s_lshl2_add_u32 m0, s33, 65536
    v_mfma_f32_16x16x32_bf16 v[96:99], v[72:75], v[64:67], v[96:99]
    ds_read_b128 v[28:31], v248 offset:1024
    v_mfma_f32_16x16x32_bf16 v[100:103], v[72:75], v[68:71], v[100:103]
    ds_read_b128 v[32:35], v248 offset:2048
    buffer_load_dwordx4 v18, s[56:59], s82 offen offset:0 sc1 lds
    v_mfma_f32_16x16x32_bf16 v[104:107], v[76:79], v[56:59], v[104:107]
    ds_read_b128 v[36:39], v248 offset:3072
    v_mfma_f32_16x16x32_bf16 v[108:111], v[76:79], v[60:63], v[108:111]
    ds_read_b64_tr_b16 v[44:45], v251 offset:16384
    ds_read_b64_tr_b16 v[46:47], v251 offset:16896
    v_mfma_f32_16x16x32_bf16 v[112:115], v[76:79], v[64:67], v[112:115]
    ds_read_b64_tr_b16 v[48:49], v250 offset:24576
    v_mfma_f32_16x16x32_bf16 v[116:119], v[76:79], v[68:71], v[116:119]
    ds_read_b64_tr_b16 v[50:51], v250 offset:25088
    buffer_load_dwordx4 v18, s[56:59], s82 offen offset:1024 sc1 lds
    v_mfma_f32_16x16x32_bf16 v[120:123], v[80:83], v[56:59], v[120:123]
    ds_read_b64_tr_b16 v[52:53], v251 offset:24576
    v_mfma_f32_16x16x32_bf16 v[124:127], v[80:83], v[60:63], v[124:127]
    ds_read_b64_tr_b16 v[54:55], v251 offset:25088
    v_mfma_f32_16x16x32_bf16 v[128:131], v[80:83], v[64:67], v[128:131]
    v_mfma_f32_16x16x32_bf16 v[132:135], v[80:83], v[68:71], v[132:135]
    buffer_load_dwordx4 v18, s[56:59], s82 offen offset:2048 sc1 lds
    v_mfma_f32_16x16x32_bf16 v[136:139], v[84:87], v[56:59], v[136:139]
    v_mfma_f32_16x16x32_bf16 v[140:143], v[84:87], v[60:63], v[140:143]
    v_mfma_f32_16x16x32_bf16 v[144:147], v[84:87], v[64:67], v[144:147]
    v_mfma_f32_16x16x32_bf16 v[148:151], v[84:87], v[68:71], v[148:151]
    buffer_load_dwordx4 v18, s[56:59], s82 offen offset:3072 sc1 lds
    s_add_u32 s82, s82, 16384
    s_waitcnt lgkmcnt(9)
    v_mfma_f32_16x16x32_bf16 v[88:91], v[40:43], v[24:27], v[88:91]
    ds_read_b64_tr_b16 v[72:73], v250 offset:20480
    ds_read_b64_tr_b16 v[74:75], v250 offset:20992
    s_waitcnt lgkmcnt(10)
    v_mfma_f32_16x16x32_bf16 v[92:95], v[40:43], v[28:31], v[92:95]
    ds_read_b128 v[56:59], v248 offset:8192
    s_lshl1_add_u32 m0, s33, 81920
    s_waitcnt lgkmcnt(10)
    v_mfma_f32_16x16x32_bf16 v[96:99], v[40:43], v[32:35], v[96:99]
    ds_read_b128 v[60:63], v248 offset:9216
    ds_read_b128 v[64:67], v248 offset:10240
    s_waitcnt lgkmcnt(11)
    v_mfma_f32_16x16x32_bf16 v[100:103], v[40:43], v[36:39], v[100:103]
    ds_read_b128 v[68:71], v248 offset:11264
L_pad4:
    s_cbranch_execz L_vret2
    buffer_load_dwordx4 v254, s[60:63], s83 offen lds
    s_waitcnt lgkmcnt(10)
    v_mfma_f32_16x16x32_bf16 v[104:107], v[44:47], v[24:27], v[104:107]
    ds_read_b64_tr_b16 v[76:77], v251 offset:20480
    ds_read_b64_tr_b16 v[78:79], v251 offset:20992
    v_mfma_f32_16x16x32_bf16 v[108:111], v[44:47], v[28:31], v[108:111]
    ds_read_b64_tr_b16 v[80:81], v250 offset:28672
    s_lshl1_add_u32 m0, s33, 82944
    v_mfma_f32_16x16x32_bf16 v[112:115], v[44:47], v[32:35], v[112:115]
    ds_read_b64_tr_b16 v[82:83], v250 offset:29184
    ds_read_b64_tr_b16 v[84:85], v251 offset:28672
    v_mfma_f32_16x16x32_bf16 v[116:119], v[44:47], v[36:39], v[116:119]
    ds_read_b64_tr_b16 v[86:87], v251 offset:29184
    buffer_load_dwordx4 v255, s[60:63], s83 offen lds
    s_waitcnt lgkmcnt(14)
    v_mfma_f32_16x16x32_bf16 v[120:123], v[48:51], v[24:27], v[120:123]
    v_mfma_f32_16x16x32_bf16 v[124:127], v[48:51], v[28:31], v[124:127]
    s_lshl1_add_u32 m0, s33, 90112
    v_mfma_f32_16x16x32_bf16 v[128:131], v[48:51], v[32:35], v[128:131]
    v_mfma_f32_16x16x32_bf16 v[132:135], v[48:51], v[36:39], v[132:135]
    buffer_load_dwordx4 v254, s[64:67], s83 offen lds
    s_waitcnt lgkmcnt(12)
    v_mfma_f32_16x16x32_bf16 v[136:139], v[52:55], v[24:27], v[136:139]
    v_mfma_f32_16x16x32_bf16 v[140:143], v[52:55], v[28:31], v[140:143]
    s_lshl1_add_u32 m0, s33, 91136
    v_mfma_f32_16x16x32_bf16 v[144:147], v[52:55], v[32:35], v[144:147]
    v_mfma_f32_16x16x32_bf16 v[148:151], v[52:55], v[36:39], v[148:151]
    buffer_load_dwordx4 v255, s[64:67], s83 offen lds
    s_add_u32 s83, s83, 131072
    s_waitcnt vmcnt(16) lgkmcnt(0)
    s_barrier
    v_mfma_f32_16x16x32_bf16 v[88:91], v[72:75], v[56:59], v[88:91]
    ds_read_b64_tr_b16 v[40:41], v252 offset:49152
    ds_read_b64_tr_b16 v[42:43], v252 offset:49664
    v_mfma_f32_16x16x32_bf16 v[92:95], v[72:75], v[60:63], v[92:95]
    ds_read_b128 v[24:27], v249 offset:32768
    s_lshl_b32 m0, s33, 2
    v_mfma_f32_16x16x32_bf16 v[96:99], v[72:75], v[64:67], v[96:99]
    ds_read_b128 v[28:31], v249 offset:33792
    v_mfma_f32_16x16x32_bf16 v[100:103], v[72:75], v[68:71], v[100:103]
    ds_read_b128 v[32:35], v249 offset:34816
    buffer_load_dwordx4 v18, s[56:59], s82 offen offset:0 sc1 lds
    v_mfma_f32_16x16x32_bf16 v[104:107], v[76:79], v[56:59], v[104:107]
    ds_read_b128 v[36:39], v249 offset:35840
    v_mfma_f32_16x16x32_bf16 v[108:111], v[76:79], v[60:63], v[108:111]
    ds_read_b64_tr_b16 v[44:45], v253 offset:49152
    ds_read_b64_tr_b16 v[46:47], v253 offset:49664
    v_mfma_f32_16x16x32_bf16 v[112:115], v[76:79], v[64:67], v[112:115]
    ds_read_b64_tr_b16 v[48:49], v252 offset:57344
    v_mfma_f32_16x16x32_bf16 v[116:119], v[76:79], v[68:71], v[116:119]
    ds_read_b64_tr_b16 v[50:51], v252 offset:57856
    buffer_load_dwordx4 v18, s[56:59], s82 offen offset:1024 sc1 lds
    v_mfma_f32_16x16x32_bf16 v[120:123], v[80:83], v[56:59], v[120:123]
    ds_read_b64_tr_b16 v[52:53], v253 offset:57344
    v_mfma_f32_16x16x32_bf16 v[124:127], v[80:83], v[60:63], v[124:127]
    ds_read_b64_tr_b16 v[54:55], v253 offset:57856
    v_mfma_f32_16x16x32_bf16 v[128:131], v[80:83], v[64:67], v[128:131]
    v_mfma_f32_16x16x32_bf16 v[132:135], v[80:83], v[68:71], v[132:135]
    buffer_load_dwordx4 v18, s[56:59], s82 offen offset:2048 sc1 lds
    v_mfma_f32_16x16x32_bf16 v[136:139], v[84:87], v[56:59], v[136:139]
    v_mfma_f32_16x16x32_bf16 v[140:143], v[84:87], v[60:63], v[140:143]
    v_mfma_f32_16x16x32_bf16 v[144:147], v[84:87], v[64:67], v[144:147]
    v_mfma_f32_16x16x32_bf16 v[148:151], v[84:87], v[68:71], v[148:151]
    buffer_load_dwordx4 v18, s[56:59], s82 offen offset:3072 sc1 lds
    s_add_u32 s82, s82, 16384
    s_waitcnt lgkmcnt(9)
    v_mfma_f32_16x16x32_bf16 v[88:91], v[40:43], v[24:27], v[88:91]
    ds_read_b64_tr_b16 v[72:73], v252 offset:53248
    ds_read_b64_tr_b16 v[74:75], v252 offset:53760
    s_waitcnt lgkmcnt(10)
    v_mfma_f32_16x16x32_bf16 v[92:95], v[40:43], v[28:31], v[92:95]
    ds_read_b128 v[56:59], v249 offset:40960
    s_lshl1_add_u32 m0, s33, 16384
    s_waitcnt lgkmcnt(10)
    v_mfma_f32_16x16x32_bf16 v[96:99], v[40:43], v[32:35], v[96:99]
    ds_read_b128 v[60:63], v249 offset:41984
    ds_read_b128 v[64:67], v249 offset:43008
    s_waitcnt lgkmcnt(11)
    v_mfma_f32_16x16x32_bf16 v[100:103], v[40:43], v[36:39], v[100:103]
    ds_read_b128 v[68:71], v249 offset:44032
    buffer_load_dwordx4 v254, s[60:63], s83 offen lds
    s_waitcnt lgkmcnt(10)
    v_mfma_f32_16x16x32_bf16 v[104:107], v[44:47], v[24:27], v[104:107]
    ds_read_b64_tr_b16 v[76:77], v253 offset:53248
    ds_read_b64_tr_b16 v[78:79], v253 offset:53760
    v_mfma_f32_16x16x32_bf16 v[108:111], v[44:47], v[28:31], v[108:111]
    ds_read_b64_tr_b16 v[80:81], v252 offset:61440
    s_lshl1_add_u32 m0, s33, 17408
    v_mfma_f32_16x16x32_bf16 v[112:115], v[44:47], v[32:35], v[112:115]
    ds_read_b64_tr_b16 v[82:83], v252 offset:61952
    ds_read_b64_tr_b16 v[84:85], v253 offset:61440
    v_mfma_f32_16x16x32_bf16 v[116:119], v[44:47], v[36:39], v[116:119]
    ds_read_b64_tr_b16 v[86:87], v253 offset:61952
    buffer_load_dwordx4 v255, s[60:63], s83 offen lds
    s_waitcnt lgkmcnt(14)
    v_mfma_f32_16x16x32_bf16 v[120:123], v[48:51], v[24:27], v[120:123]
    v_mfma_f32_16x16x32_bf16 v[124:127], v[48:51], v[28:31], v[124:127]
    s_lshl1_add_u32 m0, s33, 24576
    v_mfma_f32_16x16x32_bf16 v[128:131], v[48:51], v[32:35], v[128:131]
    v_mfma_f32_16x16x32_bf16 v[132:135], v[48:51], v[36:39], v[132:135]
    buffer_load_dwordx4 v254, s[64:67], s83 offen lds
    s_waitcnt lgkmcnt(12)
    v_mfma_f32_16x16x32_bf16 v[136:139], v[52:55], v[24:27], v[136:139]
    v_mfma_f32_16x16x32_bf16 v[140:143], v[52:55], v[28:31], v[140:143]
    s_lshl1_add_u32 m0, s33, 25600
    v_mfma_f32_16x16x32_bf16 v[144:147], v[52:55], v[32:35], v[144:147]
    v_mfma_f32_16x16x32_bf16 v[148:151], v[52:55], v[36:39], v[148:151]
    buffer_load_dwordx4 v255, s[64:67], s83 offen lds
    s_add_u32 s83, s83, 131072
    s_waitcnt vmcnt(16) lgkmcnt(0)
    s_barrier
    v_mfma_f32_16x16x32_bf16 v[88:91], v[72:75], v[56:59], v[88:91]
    ds_read_b64_tr_b16 v[40:41], v250 offset:49152
    ds_read_b64_tr_b16 v[42:43], v250 offset:49664
    v_mfma_f32_16x16x32_bf16 v[92:95], v[72:75], v[60:63], v[92:95]
    ds_read_b128 v[24:27], v248 offset:32768
    s_lshl2_add_u32 m0, s33, 98304
    v_mfma_f32_16x16x32_bf16 v[96:99], v[72:75], v[64:67], v[96:99]
    ds_read_b128 v[28:31], v248 offset:33792
    v_mfma_f32_16x16x32_bf16 v[100:103], v[72:75], v[68:71], v[100:103]
    ds_read_b128 v[32:35], v248 offset:34816
    buffer_load_dwordx4 v18, s[56:59], s82 offen offset:0 sc1 lds
    v_mfma_f32_16x16x32_bf16 v[104:107], v[76:79], v[56:59], v[104:107]
    ds_read_b128 v[36:39], v248 offset:35840
    v_mfma_f32_16x16x32_bf16 v[108:111], v[76:79], v[60:63], v[108:111]
    ds_read_b64_tr_b16 v[44:45], v251 offset:49152
    ds_read_b64_tr_b16 v[46:47], v251 offset:49664
    v_mfma_f32_16x16x32_bf16 v[112:115], v[76:79], v[64:67], v[112:115]
    ds_read_b64_tr_b16 v[48:49], v250 offset:57344
    v_mfma_f32_16x16x32_bf16 v[116:119], v[76:79], v[68:71], v[116:119]
    ds_read_b64_tr_b16 v[50:51], v250 offset:57856
    buffer_load_dwordx4 v18, s[56:59], s82 offen offset:1024 sc1 lds
    v_mfma_f32_16x16x32_bf16 v[120:123], v[80:83], v[56:59], v[120:123]
    ds_read_b64_tr_b16 v[52:53], v251 offset:57344
    v_mfma_f32_16x16x32_bf16 v[124:127], v[80:83], v[60:63], v[124:127]
    ds_read_b64_tr_b16 v[54:55], v251 offset:57856
    v_mfma_f32_16x16x32_bf16 v[128:131], v[80:83], v[64:67], v[128:131]
    v_mfma_f32_16x16x32_bf16 v[132:135], v[80:83], v[68:71], v[132:135]
    buffer_load_dwordx4 v18, s[56:59], s82 offen offset:2048 sc1 lds
    v_mfma_f32_16x16x32_bf16 v[136:139], v[84:87], v[56:59], v[136:139]
    v_mfma_f32_16x16x32_bf16 v[140:143], v[84:87], v[60:63], v[140:143]
    v_mfma_f32_16x16x32_bf16 v[144:147], v[84:87], v[64:67], v[144:147]
    v_mfma_f32_16x16x32_bf16 v[148:151], v[84:87], v[68:71], v[148:151]
    buffer_load_dwordx4 v18, s[56:59], s82 offen offset:3072 sc1 lds
    s_add_u32 s82, s82, 16384
    s_waitcnt lgkmcnt(9)
    v_mfma_f32_16x16x32_bf16 v[88:91], v[40:43], v[24:27], v[88:91]
    ds_read_b64_tr_b16 v[72:73], v250 offset:53248
    ds_read_b64_tr_b16 v[74:75], v250 offset:53760
    s_waitcnt lgkmcnt(10)
    v_mfma_f32_16x16x32_bf16 v[92:95], v[40:43], v[28:31], v[92:95]
    ds_read_b128 v[56:59], v248 offset:40960
    s_lshl1_add_u32 m0, s33, 114688
    s_waitcnt lgkmcnt(10)
    v_mfma_f32_16x16x32_bf16 v[96:99], v[40:43], v[32:35], v[96:99]
    ds_read_b128 v[60:63], v248 offset:41984
    ds_read_b128 v[64:67], v248 offset:43008
    s_waitcnt lgkmcnt(11)
    v_mfma_f32_16x16x32_bf16 v[100:103], v[40:43], v[36:39], v[100:103]
    ds_read_b128 v[68:71], v248 offset:44032
    buffer_load_dwordx4 v254, s[60:63], s83 offen lds
    s_waitcnt lgkmcnt(10)
    v_mfma_f32_16x16x32_bf16 v[104:107], v[44:47], v[24:27], v[104:107]
    ds_read_b64_tr_b16 v[76:77], v251 offset:53248
    ds_read_b64_tr_b16 v[78:79], v251 offset:53760
    v_mfma_f32_16x16x32_bf16 v[108:111], v[44:47], v[28:31], v[108:111]
    ds_read_b64_tr_b16 v[80:81], v250 offset:61440
    s_lshl1_add_u32 m0, s33, 115712
    v_mfma_f32_16x16x32_bf16 v[112:115], v[44:47], v[32:35], v[112:115]
    ds_read_b64_tr_b16 v[82:83], v250 offset:61952
    ds_read_b64_tr_b16 v[84:85], v251 offset:61440
    v_mfma_f32_16x16x32_bf16 v[116:119], v[44:47], v[36:39], v[116:119]
    ds_read_b64_tr_b16 v[86:87], v251 offset:61952
    buffer_load_dwordx4 v255, s[60:63], s83 offen lds
    s_waitcnt lgkmcnt(14)
    v_mfma_f32_16x16x32_bf16 v[120:123], v[48:51], v[24:27], v[120:123]
    v_mfma_f32_16x16x32_bf16 v[124:127], v[48:51], v[28:31], v[124:127]
    s_lshl1_add_u32 m0, s33, 122880
    v_mfma_f32_16x16x32_bf16 v[128:131], v[48:51], v[32:35], v[128:131]
    v_mfma_f32_16x16x32_bf16 v[132:135], v[48:51], v[36:39], v[132:135]
    buffer_load_dwordx4 v254, s[64:67], s83 offen lds
    s_waitcnt lgkmcnt(12)
    v_mfma_f32_16x16x32_bf16 v[136:139], v[52:55], v[24:27], v[136:139]
    v_mfma_f32_16x16x32_bf16 v[140:143], v[52:55], v[28:31], v[140:143]
    s_lshl1_add_u32 m0, s33, 123904
    v_mfma_f32_16x16x32_bf16 v[144:147], v[52:55], v[32:35], v[144:147]
    v_mfma_f32_16x16x32_bf16 v[148:151], v[52:55], v[36:39], v[148:151]
    buffer_load_dwordx4 v255, s[64:67], s83 offen lds
    s_add_u32 s83, s83, 131072
    s_waitcnt vmcnt(16) lgkmcnt(0)
    s_barrier
    v_mfma_f32_16x16x32_bf16 v[88:91], v[72:75], v[56:59], v[88:91]
    ds_read_b64_tr_b16 v[40:41], v252 offset:16384
    ds_read_b64_tr_b16 v[42:43], v252 offset:16896
    v_mfma_f32_16x16x32_bf16 v[92:95], v[72:75], v[60:63], v[92:95]
    ds_read_b128 v[24:27], v249 offset:0
    s_lshl2_add_u32 m0, s33, 32768
    v_mfma_f32_16x16x32_bf16 v[96:99], v[72:75], v[64:67], v[96:99]
    ds_read_b128 v[28:31], v249 offset:1024
    v_mfma_f32_16x16x32_bf16 v[100:103], v[72:75], v[68:71], v[100:103]
    ds_read_b128 v[32:35], v249 offset:2048
    buffer_load_dwordx4 v18, s[56:59], s82 offen offset:0 sc1 lds
    v_mfma_f32_16x16x32_bf16 v[104:107], v[76:79], v[56:59], v[104:107]
    ds_read_b128 v[36:39], v249 offset:3072
    v_mfma_f32_16x16x32_bf16 v[108:111], v[76:79], v[60:63], v[108:111]
    ds_read_b64_tr_b16 v[44:45], v253 offset:16384
    ds_read_b64_tr_b16 v[46:47], v253 offset:16896
    v_mfma_f32_16x16x32_bf16 v[112:115], v[76:79], v[64:67], v[112:115]
    ds_read_b64_tr_b16 v[48:49], v252 offset:24576
    v_mfma_f32_16x16x32_bf16 v[116:119], v[76:79], v[68:71], v[116:119]
    ds_read_b64_tr_b16 v[50:51], v252 offset:25088
    buffer_load_dwordx4 v18, s[56:59], s82 offen offset:1024 sc1 lds
    v_mfma_f32_16x16x32_bf16 v[120:123], v[80:83], v[56:59], v[120:123]
    ds_read_b64_tr_b16 v[52:53], v253 offset:24576
    v_mfma_f32_16x16x32_bf16 v[124:127], v[80:83], v[60:63], v[124:127]
    ds_read_b64_tr_b16 v[54:55], v253 offset:25088
    v_mfma_f32_16x16x32_bf16 v[128:131], v[80:83], v[64:67], v[128:131]
    v_mfma_f32_16x16x32_bf16 v[132:135], v[80:83], v[68:71], v[132:135]
    buffer_load_dwordx4 v18, s[56:59], s82 offen offset:2048 sc1 lds
    v_mfma_f32_16x16x32_bf16 v[136:139], v[84:87], v[56:59], v[136:139]
    v_mfma_f32_16x16x32_bf16 v[140:143], v[84:87], v[60:63], v[140:143]
    v_mfma_f32_16x16x32_bf16 v[144:147], v[84:87], v[64:67], v[144:147]
    v_mfma_f32_16x16x32_bf16 v[148:151], v[84:87], v[68:71], v[148:151]
    buffer_load_dwordx4 v18, s[56:59], s82 offen offset:3072 sc1 lds
    s_add_u32 s82, s82, 16384
    s_waitcnt lgkmcnt(9)
    v_mfma_f32_16x16x32_bf16 v[88:91], v[40:43], v[24:27], v[88:91]
    ds_read_b64_tr_b16 v[72:73], v252 offset:20480
    ds_read_b64_tr_b16 v[74:75], v252 offset:20992
    s_waitcnt lgkmcnt(10)
    v_mfma_f32_16x16x32_bf16 v[92:95], v[40:43], v[28:31], v[92:95]
    ds_read_b128 v[56:59], v249 offset:8192
    s_lshl1_add_u32 m0, s33, 49152
    s_waitcnt lgkmcnt(10)
    v_mfma_f32_16x16x32_bf16 v[96:99], v[40:43], v[32:35], v[96:99]
    ds_read_b128 v[60:63], v249 offset:9216
    ds_read_b128 v[64:67], v249 offset:10240
    s_waitcnt lgkmcnt(11)
    v_mfma_f32_16x16x32_bf16 v[100:103], v[40:43], v[36:39], v[100:103]
    ds_read_b128 v[68:71], v249 offset:11264
    buffer_load_dwordx4 v254, s[60:63], s83 offen lds
    s_waitcnt lgkmcnt(10)
    v_mfma_f32_16x16x32_bf16 v[104:107], v[44:47], v[24:27], v[104:107]
    ds_read_b64_tr_b16 v[76:77], v253 offset:20480
    ds_read_b64_tr_b16 v[78:79], v253 offset:20992
    v_mfma_f32_16x16x32_bf16 v[108:111], v[44:47], v[28:31], v[108:111]
    ds_read_b64_tr_b16 v[80:81], v252 offset:28672
    s_lshl1_add_u32 m0, s33, 50176
    v_mfma_f32_16x16x32_bf16 v[112:115], v[44:47], v[32:35], v[112:115]
    ds_read_b64_tr_b16 v[82:83], v252 offset:29184
    ds_read_b64_tr_b16 v[84:85], v253 offset:28672
    v_mfma_f32_16x16x32_bf16 v[116:119], v[44:47], v[36:39], v[116:119]
    ds_read_b64_tr_b16 v[86:87], v253 offset:29184
    buffer_load_dwordx4 v255, s[60:63], s83 offen lds
    s_waitcnt lgkmcnt(14)
    v_mfma_f32_16x16x32_bf16 v[120:123], v[48:51], v[24:27], v[120:123]
    v_mfma_f32_16x16x32_bf16 v[124:127], v[48:51], v[28:31], v[124:127]
    s_lshl1_add_u32 m0, s33, 57344
    v_mfma_f32_16x16x32_bf16 v[128:131], v[48:51], v[32:35], v[128:131]
    v_mfma_f32_16x16x32_bf16 v[132:135], v[48:51], v[36:39], v[132:135]
    buffer_load_dwordx4 v254, s[64:67], s83 offen lds
    s_waitcnt lgkmcnt(12)
    v_mfma_f32_16x16x32_bf16 v[136:139], v[52:55], v[24:27], v[136:139]
    v_mfma_f32_16x16x32_bf16 v[140:143], v[52:55], v[28:31], v[140:143]
    s_lshl1_add_u32 m0, s33, 58368
    v_mfma_f32_16x16x32_bf16 v[144:147], v[52:55], v[32:35], v[144:147]
    v_mfma_f32_16x16x32_bf16 v[148:151], v[52:55], v[36:39], v[148:151]
    buffer_load_dwordx4 v255, s[64:67], s83 offen lds
    s_add_u32 s83, s83, 131072
    s_waitcnt vmcnt(16) lgkmcnt(0)
    s_barrier
    v_mfma_f32_16x16x32_bf16 v[88:91], v[72:75], v[56:59], v[88:91]
    ds_read_b64_tr_b16 v[40:41], v250 offset:16384
    ds_read_b64_tr_b16 v[42:43], v250 offset:16896
    v_mfma_f32_16x16x32_bf16 v[92:95], v[72:75], v[60:63], v[92:95]
    ds_read_b128 v[24:27], v248 offset:0
    s_lshl2_add_u32 m0, s33, 65536
    v_mfma_f32_16x16x32_bf16 v[96:99], v[72:75], v[64:67], v[96:99]
    ds_read_b128 v[28:31], v248 offset:1024
    v_mfma_f32_16x16x32_bf16 v[100:103], v[72:75], v[68:71], v[100:103]
    ds_read_b128 v[32:35], v248 offset:2048
    buffer_load_dwordx4 v18, s[56:59], s82 offen offset:0 sc1 lds
    v_mfma_f32_16x16x32_bf16 v[104:107], v[76:79], v[56:59], v[104:107]
    ds_read_b128 v[36:39], v248 offset:3072
    v_mfma_f32_16x16x32_bf16 v[108:111], v[76:79], v[60:63], v[108:111]
    ds_read_b64_tr_b16 v[44:45], v251 offset:16384
    ds_read_b64_tr_b16 v[46:47], v251 offset:16896
    v_mfma_f32_16x16x32_bf16 v[112:115], v[76:79], v[64:67], v[112:115]
    ds_read_b64_tr_b16 v[48:49], v250 offset:24576
    v_mfma_f32_16x16x32_bf16 v[116:119], v[76:79], v[68:71], v[116:119]
    ds_read_b64_tr_b16 v[50:51], v250 offset:25088
    buffer_load_dwordx4 v18, s[56:59], s82 offen offset:1024 sc1 lds
    v_mfma_f32_16x16x32_bf16 v[120:123], v[80:83], v[56:59], v[120:123]
    ds_read_b64_tr_b16 v[52:53], v251 offset:24576
    v_mfma_f32_16x16x32_bf16 v[124:127], v[80:83], v[60:63], v[124:127]
    ds_read_b64_tr_b16 v[54:55], v251 offset:25088
    v_mfma_f32_16x16x32_bf16 v[128:131], v[80:83], v[64:67], v[128:131]
    v_mfma_f32_16x16x32_bf16 v[132:135], v[80:83], v[68:71], v[132:135]
    buffer_load_dwordx4 v18, s[56:59], s82 offen offset:2048 sc1 lds
    v_mfma_f32_16x16x32_bf16 v[136:139], v[84:87], v[56:59], v[136:139]
    v_mfma_f32_16x16x32_bf16 v[140:143], v[84:87], v[60:63], v[140:143]
    v_mfma_f32_16x16x32_bf16 v[144:147], v[84:87], v[64:67], v[144:147]
    v_mfma_f32_16x16x32_bf16 v[148:151], v[84:87], v[68:71], v[148:151]
    buffer_load_dwordx4 v18, s[56:59], s82 offen offset:3072 sc1 lds
    s_add_u32 s82, s82, 16384
    s_waitcnt lgkmcnt(9)
    v_mfma_f32_16x16x32_bf16 v[88:91], v[40:43], v[24:27], v[88:91]
    ds_read_b64_tr_b16 v[72:73], v250 offset:20480
    ds_read_b64_tr_b16 v[74:75], v250 offset:20992
    s_waitcnt lgkmcnt(10)
    v_mfma_f32_16x16x32_bf16 v[92:95], v[40:43], v[28:31], v[92:95]
    ds_read_b128 v[56:59], v248 offset:8192
    s_waitcnt lgkmcnt(10)
    v_mfma_f32_16x16x32_bf16 v[96:99], v[40:43], v[32:35], v[96:99]
    ds_read_b128 v[60:63], v248 offset:9216
    ds_read_b128 v[64:67], v248 offset:10240
    s_waitcnt lgkmcnt(11)
    v_mfma_f32_16x16x32_bf16 v[100:103], v[40:43], v[36:39], v[100:103]
    ds_read_b128 v[68:71], v248 offset:11264
    s_waitcnt lgkmcnt(10)
    v_mfma_f32_16x16x32_bf16 v[104:107], v[44:47], v[24:27], v[104:107]
    ds_read_b64_tr_b16 v[76:77], v251 offset:20480
    ds_read_b64_tr_b16 v[78:79], v251 offset:20992
    v_mfma_f32_16x16x32_bf16 v[108:111], v[44:47], v[28:31], v[108:111]
    ds_read_b64_tr_b16 v[80:81], v250 offset:28672
    v_mfma_f32_16x16x32_bf16 v[112:115], v[44:47], v[32:35], v[112:115]
    ds_read_b64_tr_b16 v[82:83], v250 offset:29184
    ds_read_b64_tr_b16 v[84:85], v251 offset:28672
    v_mfma_f32_16x16x32_bf16 v[116:119], v[44:47], v[36:39], v[116:119]
    ds_read_b64_tr_b16 v[86:87], v251 offset:29184
    s_waitcnt lgkmcnt(14)
    v_mfma_f32_16x16x32_bf16 v[120:123], v[48:51], v[24:27], v[120:123]
    v_mfma_f32_16x16x32_bf16 v[124:127], v[48:51], v[28:31], v[124:127]
    v_mfma_f32_16x16x32_bf16 v[128:131], v[48:51], v[32:35], v[128:131]
    v_mfma_f32_16x16x32_bf16 v[132:135], v[48:51], v[36:39], v[132:135]
    s_waitcnt lgkmcnt(12)
    v_mfma_f32_16x16x32_bf16 v[136:139], v[52:55], v[24:27], v[136:139]
    v_mfma_f32_16x16x32_bf16 v[140:143], v[52:55], v[28:31], v[140:143]
    v_mfma_f32_16x16x32_bf16 v[144:147], v[52:55], v[32:35], v[144:147]
    v_mfma_f32_16x16x32_bf16 v[148:151], v[52:55], v[36:39], v[148:151]
    s_waitcnt vmcnt(12) lgkmcnt(0)
    s_barrier
    v_mfma_f32_16x16x32_bf16 v[88:91], v[72:75], v[56:59], v[88:91]
    ds_read_b64_tr_b16 v[40:41], v252 offset:49152
    ds_read_b64_tr_b16 v[42:43], v252 offset:49664
    v_mfma_f32_16x16x32_bf16 v[92:95], v[72:75], v[60:63], v[92:95]
    ds_read_b128 v[24:27], v249 offset:32768
    v_mfma_f32_16x16x32_bf16 v[96:99], v[72:75], v[64:67], v[96:99]
    ds_read_b128 v[28:31], v249 offset:33792
    v_mfma_f32_16x16x32_bf16 v[100:103], v[72:75], v[68:71], v[100:103]
    ds_read_b128 v[32:35], v249 offset:34816
    v_mfma_f32_16x16x32_bf16 v[104:107], v[76:79], v[56:59], v[104:107]
    ds_read_b128 v[36:39], v249 offset:35840
    v_mfma_f32_16x16x32_bf16 v[108:111], v[76:79], v[60:63], v[108:111]
    ds_read_b64_tr_b16 v[44:45], v253 offset:49152
    ds_read_b64_tr_b16 v[46:47], v253 offset:49664
    v_mfma_f32_16x16x32_bf16 v[112:115], v[76:79], v[64:67], v[112:115]
    ds_read_b64_tr_b16 v[48:49], v252 offset:57344
    v_mfma_f32_16x16x32_bf16 v[116:119], v[76:79], v[68:71], v[116:119]
    ds_read_b64_tr_b16 v[50:51], v252 offset:57856
    v_mfma_f32_16x16x32_bf16 v[120:123], v[80:83], v[56:59], v[120:123]
    ds_read_b64_tr_b16 v[52:53], v253 offset:57344
    v_mfma_f32_16x16x32_bf16 v[124:127], v[80:83], v[60:63], v[124:127]
    ds_read_b64_tr_b16 v[54:55], v253 offset:57856
    v_mfma_f32_16x16x32_bf16 v[128:131], v[80:83], v[64:67], v[128:131]
    v_mfma_f32_16x16x32_bf16 v[132:135], v[80:83], v[68:71], v[132:135]
    v_mfma_f32_16x16x32_bf16 v[136:139], v[84:87], v[56:59], v[136:139]
    s_mov_b64 exec, 3
    global_load_dwordx3 v[236:238], v239, s[26:27] sc1
    s_mov_b64 exec, -1
    v_mfma_f32_16x16x32_bf16 v[140:143], v[84:87], v[60:63], v[140:143]
    v_mfma_f32_16x16x32_bf16 v[144:147], v[84:87], v[64:67], v[144:147]
    v_mfma_f32_16x16x32_bf16 v[148:151], v[84:87], v[68:71], v[148:151]
    s_waitcnt lgkmcnt(9)
    v_mfma_f32_16x16x32_bf16 v[88:91], v[40:43], v[24:27], v[88:91]
    ds_read_b64_tr_b16 v[72:73], v252 offset:53248
    ds_read_b64_tr_b16 v[74:75], v252 offset:53760
    s_waitcnt lgkmcnt(10)
    v_mfma_f32_16x16x32_bf16 v[92:95], v[40:43], v[28:31], v[92:95]
    ds_read_b128 v[56:59], v249 offset:40960
    s_waitcnt lgkmcnt(10)
    v_mfma_f32_16x16x32_bf16 v[96:99], v[40:43], v[32:35], v[96:99]
    ds_read_b128 v[60:63], v249 offset:41984
    ds_read_b128 v[64:67], v249 offset:43008
    s_waitcnt lgkmcnt(11)
    v_mfma_f32_16x16x32_bf16 v[100:103], v[40:43], v[36:39], v[100:103]
    ds_read_b128 v[68:71], v249 offset:44032
    s_waitcnt lgkmcnt(10)
    v_mfma_f32_16x16x32_bf16 v[104:107], v[44:47], v[24:27], v[104:107]
    ds_read_b64_tr_b16 v[76:77], v253 offset:53248
    ds_read_b64_tr_b16 v[78:79], v253 offset:53760
    v_mfma_f32_16x16x32_bf16 v[108:111], v[44:47], v[28:31], v[108:111]
    ds_read_b64_tr_b16 v[80:81], v252 offset:61440
    v_mfma_f32_16x16x32_bf16 v[112:115], v[44:47], v[32:35], v[112:115]
    ds_read_b64_tr_b16 v[82:83], v252 offset:61952
    ds_read_b64_tr_b16 v[84:85], v253 offset:61440
    v_mfma_f32_16x16x32_bf16 v[116:119], v[44:47], v[36:39], v[116:119]
    ds_read_b64_tr_b16 v[86:87], v253 offset:61952
    s_waitcnt lgkmcnt(14)
    v_mfma_f32_16x16x32_bf16 v[120:123], v[48:51], v[24:27], v[120:123]
    v_mfma_f32_16x16x32_bf16 v[124:127], v[48:51], v[28:31], v[124:127]
    v_mfma_f32_16x16x32_bf16 v[128:131], v[48:51], v[32:35], v[128:131]
    v_mfma_f32_16x16x32_bf16 v[132:135], v[48:51], v[36:39], v[132:135]
    s_waitcnt lgkmcnt(12)
    v_mfma_f32_16x16x32_bf16 v[136:139], v[52:55], v[24:27], v[136:139]
    v_mfma_f32_16x16x32_bf16 v[140:143], v[52:55], v[28:31], v[140:143]
    v_mfma_f32_16x16x32_bf16 v[144:147], v[52:55], v[32:35], v[144:147]
    v_mfma_f32_16x16x32_bf16 v[148:151], v[52:55], v[36:39], v[148:151]
    s_waitcnt vmcnt(5) lgkmcnt(0)
    s_barrier
    v_mfma_f32_16x16x32_bf16 v[88:91], v[72:75], v[56:59], v[88:91]
    ds_read_b64_tr_b16 v[40:41], v250 offset:49152
    ds_read_b64_tr_b16 v[42:43], v250 offset:49664
    v_mfma_f32_16x16x32_bf16 v[92:95], v[72:75], v[60:63], v[92:95]
    ds_read_b128 v[24:27], v248 offset:32768
    v_mfma_f32_16x16x32_bf16 v[96:99], v[72:75], v[64:67], v[96:99]
    ds_read_b128 v[28:31], v248 offset:33792
    v_mfma_f32_16x16x32_bf16 v[100:103], v[72:75], v[68:71], v[100:103]
    ds_read_b128 v[32:35], v248 offset:34816
    v_mfma_f32_16x16x32_bf16 v[104:107], v[76:79], v[56:59], v[104:107]
    ds_read_b128 v[36:39], v248 offset:35840
    v_mfma_f32_16x16x32_bf16 v[108:111], v[76:79], v[60:63], v[108:111]
    ds_read_b64_tr_b16 v[44:45], v251 offset:49152
    ds_read_b64_tr_b16 v[46:47], v251 offset:49664
    v_mfma_f32_16x16x32_bf16 v[112:115], v[76:79], v[64:67], v[112:115]
    ds_read_b64_tr_b16 v[48:49], v250 offset:57344
    v_mfma_f32_16x16x32_bf16 v[116:119], v[76:79], v[68:71], v[116:119]
    ds_read_b64_tr_b16 v[50:51], v250 offset:57856
    v_mfma_f32_16x16x32_bf16 v[120:123], v[80:83], v[56:59], v[120:123]
    ds_read_b64_tr_b16 v[52:53], v251 offset:57344
    v_mfma_f32_16x16x32_bf16 v[124:127], v[80:83], v[60:63], v[124:127]
    ds_read_b64_tr_b16 v[54:55], v251 offset:57856
    v_mfma_f32_16x16x32_bf16 v[128:131], v[80:83], v[64:67], v[128:131]
    v_mfma_f32_16x16x32_bf16 v[132:135], v[80:83], v[68:71], v[132:135]
    v_mfma_f32_16x16x32_bf16 v[136:139], v[84:87], v[56:59], v[136:139]
    v_mfma_f32_16x16x32_bf16 v[140:143], v[84:87], v[60:63], v[140:143]
    v_mfma_f32_16x16x32_bf16 v[144:147], v[84:87], v[64:67], v[144:147]
    v_mfma_f32_16x16x32_bf16 v[148:151], v[84:87], v[68:71], v[148:151]
    s_waitcnt lgkmcnt(9)
    v_mfma_f32_16x16x32_bf16 v[88:91], v[40:43], v[24:27], v[88:91]
    ds_read_b64_tr_b16 v[72:73], v250 offset:53248
    ds_read_b64_tr_b16 v[74:75], v250 offset:53760
    s_waitcnt lgkmcnt(10)
    v_mfma_f32_16x16x32_bf16 v[92:95], v[40:43], v[28:31], v[92:95]
    ds_read_b128 v[56:59], v248 offset:40960
    s_waitcnt lgkmcnt(10)
    v_mfma_f32_16x16x32_bf16 v[96:99], v[40:43], v[32:35], v[96:99]
    ds_read_b128 v[60:63], v248 offset:41984
    ds_read_b128 v[64:67], v248 offset:43008
    s_waitcnt lgkmcnt(11)
    v_mfma_f32_16x16x32_bf16 v[100:103], v[40:43], v[36:39], v[100:103]
    ds_read_b128 v[68:71], v248 offset:44032
    s_waitcnt lgkmcnt(10)
    v_mfma_f32_16x16x32_bf16 v[104:107], v[44:47], v[24:27], v[104:107]
    ds_read_b64_tr_b16 v[76:77], v251 offset:53248
    ds_read_b64_tr_b16 v[78:79], v251 offset:53760
    v_mfma_f32_16x16x32_bf16 v[108:111], v[44:47], v[28:31], v[108:111]
    ds_read_b64_tr_b16 v[80:81], v250 offset:61440
    v_mfma_f32_16x16x32_bf16 v[112:115], v[44:47], v[32:35], v[112:115]
    ds_read_b64_tr_b16 v[82:83], v250 offset:61952
    ds_read_b64_tr_b16 v[84:85], v251 offset:61440
    v_mfma_f32_16x16x32_bf16 v[116:119], v[44:47], v[36:39], v[116:119]
    ds_read_b64_tr_b16 v[86:87], v251 offset:61952
    s_waitcnt lgkmcnt(14)
    v_mfma_f32_16x16x32_bf16 v[120:123], v[48:51], v[24:27], v[120:123]
    v_mfma_f32_16x16x32_bf16 v[124:127], v[48:51], v[28:31], v[124:127]
    v_mfma_f32_16x16x32_bf16 v[128:131], v[48:51], v[32:35], v[128:131]
    v_mfma_f32_16x16x32_bf16 v[132:135], v[48:51], v[36:39], v[132:135]
    s_waitcnt lgkmcnt(12)
    v_mfma_f32_16x16x32_bf16 v[136:139], v[52:55], v[24:27], v[136:139]
    v_mfma_f32_16x16x32_bf16 v[140:143], v[52:55], v[28:31], v[140:143]
    v_mfma_f32_16x16x32_bf16 v[144:147], v[52:55], v[32:35], v[144:147]
    v_mfma_f32_16x16x32_bf16 v[148:151], v[52:55], v[36:39], v[148:151]
    s_waitcnt vmcnt(0) lgkmcnt(0)
    s_barrier
    v_mfma_f32_16x16x32_bf16 v[88:91], v[72:75], v[56:59], v[88:91]
    ds_read_b64_tr_b16 v[40:41], v252 offset:16384
    ds_read_b64_tr_b16 v[42:43], v252 offset:16896
    v_readlane_b32 s90, v238, 0
    v_readlane_b32 s91, v238, 1
    v_mfma_f32_16x16x32_bf16 v[92:95], v[72:75], v[60:63], v[92:95]
    ds_read_b128 v[24:27], v249 offset:0
    s_nop 1
    s_sub_u32 s90, s91, s90
    v_mfma_f32_16x16x32_bf16 v[96:99], v[72:75], v[64:67], v[96:99]
    ds_read_b128 v[28:31], v249 offset:1024
    s_abs_i32 s91, s90
    v_mfma_f32_16x16x32_bf16 v[100:103], v[72:75], v[68:71], v[100:103]
    ds_read_b128 v[32:35], v249 offset:2048
    s_min_u32 s91, s91, 0x1000
    s_add_u32 s91, s91, 35
    v_mfma_f32_16x16x32_bf16 v[104:107], v[76:79], v[56:59], v[104:107]
    ds_read_b128 v[36:39], v249 offset:3072
    s_mul_i32 s91, s91, 937
    s_lshr_b32 s91, s91, 16
    v_mfma_f32_16x16x32_bf16 v[108:111], v[76:79], v[60:63], v[108:111]
    ds_read_b64_tr_b16 v[44:45], v253 offset:16384
    ds_read_b64_tr_b16 v[46:47], v253 offset:16896
    s_min_u32 s91, s91, 4
    v_mfma_f32_16x16x32_bf16 v[112:115], v[76:79], v[64:67], v[112:115]
    ds_read_b64_tr_b16 v[48:49], v252 offset:24576
    s_sub_u32 s92, 0, s91
    s_cmp_lt_i32 s90, 0
    v_mfma_f32_16x16x32_bf16 v[116:119], v[76:79], v[68:71], v[116:119]
    ds_read_b64_tr_b16 v[50:51], v252 offset:25088
    s_cselect_b32 s91, s92, s91
    v_mfma_f32_16x16x32_bf16 v[120:123], v[80:83], v[56:59], v[120:123]
    ds_read_b64_tr_b16 v[52:53], v253 offset:24576
    s_add_u32 s34, s91, 16
    s_and_b32 s91, s91, 3
    v_mfma_f32_16x16x32_bf16 v[124:127], v[80:83], v[60:63], v[124:127]
    ds_read_b64_tr_b16 v[54:55], v253 offset:25088
    s_mov_b32 s46, 0x9a69a69a
    s_mov_b32 s47, 0x269a69a6
    v_mfma_f32_16x16x32_bf16 v[128:131], v[80:83], v[64:67], v[128:131]
    s_cmp_eq_u32 s91, 1
    v_mfma_f32_16x16x32_bf16 v[132:135], v[80:83], v[68:71], v[132:135]
    s_cselect_b32 s46, 0xd34d34e6, s46
    s_cselect_b32 s47, 0x34d34d34, s47
    v_mfma_f32_16x16x32_bf16 v[136:139], v[84:87], v[56:59], v[136:139]
    s_cmp_eq_u32 s91, 2
    s_cselect_b32 s46, 0x9a7334e6, s46
    v_mfma_f32_16x16x32_bf16 v[140:143], v[84:87], v[60:63], v[140:143]
    s_cselect_b32 s47, 0x269a69a6, s47
    v_mfma_f32_16x16x32_bf16 v[144:147], v[84:87], v[64:67], v[144:147]
    s_cmp_eq_u32 s91, 3
    s_cselect_b32 s46, 0x9a7334e6, s46
    v_mfma_f32_16x16x32_bf16 v[148:151], v[84:87], v[68:71], v[148:151]
    s_cselect_b32 s47, 0x34d34d39, s47
    s_waitcnt lgkmcnt(9)
    v_mfma_f32_16x16x32_bf16 v[88:91], v[40:43], v[24:27], v[88:91]
    ds_read_b64_tr_b16 v[72:73], v252 offset:20480
    ds_read_b64_tr_b16 v[74:75], v252 offset:20992
    s_waitcnt lgkmcnt(10)
    v_mfma_f32_16x16x32_bf16 v[92:95], v[40:43], v[28:31], v[92:95]
    ds_read_b128 v[56:59], v249 offset:8192
    s_waitcnt lgkmcnt(10)
    v_mfma_f32_16x16x32_bf16 v[96:99], v[40:43], v[32:35], v[96:99]
    ds_read_b128 v[60:63], v249 offset:9216
    ds_read_b128 v[64:67], v249 offset:10240
    s_waitcnt lgkmcnt(11)
    v_mfma_f32_16x16x32_bf16 v[100:103], v[40:43], v[36:39], v[100:103]
    ds_read_b128 v[68:71], v249 offset:11264
    s_waitcnt lgkmcnt(10)
    v_mfma_f32_16x16x32_bf16 v[104:107], v[44:47], v[24:27], v[104:107]
    ds_read_b64_tr_b16 v[76:77], v253 offset:20480
    ds_read_b64_tr_b16 v[78:79], v253 offset:20992
    v_mfma_f32_16x16x32_bf16 v[108:111], v[44:47], v[28:31], v[108:111]
    ds_read_b64_tr_b16 v[80:81], v252 offset:28672
    v_mfma_f32_16x16x32_bf16 v[112:115], v[44:47], v[32:35], v[112:115]
    ds_read_b64_tr_b16 v[82:83], v252 offset:29184
    ds_read_b64_tr_b16 v[84:85], v253 offset:28672
L_pad5:
    s_cbranch_execz L_vret2
    v_mfma_f32_16x16x32_bf16 v[116:119], v[44:47], v[36:39], v[116:119]
    ds_read_b64_tr_b16 v[86:87], v253 offset:29184
    s_waitcnt lgkmcnt(14)
    v_mfma_f32_16x16x32_bf16 v[120:123], v[48:51], v[24:27], v[120:123]
    v_mfma_f32_16x16x32_bf16 v[124:127], v[48:51], v[28:31], v[124:127]
    s_lshl_b32 s48, s46, 15
    s_and_b32 s48, s48, 0x38000
    v_mfma_f32_16x16x32_bf16 v[128:131], v[48:51], v[32:35], v[128:131]
    s_lshr_b64 s[46:47], s[46:47], 3
    v_mfma_f32_16x16x32_bf16 v[132:135], v[48:51], v[36:39], v[132:135]
    v_xor_b32 v252, s48, v252
    s_waitcnt lgkmcnt(12)
    v_mfma_f32_16x16x32_bf16 v[136:139], v[52:55], v[24:27], v[136:139]
    v_xor_b32 v249, s48, v249
    v_mfma_f32_16x16x32_bf16 v[140:143], v[52:55], v[28:31], v[140:143]
    v_xor_b32 v253, s48, v253
    v_mfma_f32_16x16x32_bf16 v[144:147], v[52:55], v[32:35], v[144:147]
    s_sub_u32 s34, s34, 1
    v_mfma_f32_16x16x32_bf16 v[148:151], v[52:55], v[36:39], v[148:151]
.p2align 6
L_dl:
    s_waitcnt lgkmcnt(0)
    s_barrier
    v_mfma_f32_16x16x32_bf16 v[88:91], v[72:75], v[56:59], v[88:91]
    ds_read_b64_tr_b16 v[40:41], v252 offset:16384
    ds_read_b64_tr_b16 v[42:43], v252 offset:16896
    v_mfma_f32_16x16x32_bf16 v[92:95], v[72:75], v[60:63], v[92:95]
    ds_read_b128 v[24:27], v249 offset:0
    v_mfma_f32_16x16x32_bf16 v[96:99], v[72:75], v[64:67], v[96:99]
    ds_read_b128 v[28:31], v249 offset:1024
    v_mfma_f32_16x16x32_bf16 v[100:103], v[72:75], v[68:71], v[100:103]
    ds_read_b128 v[32:35], v249 offset:2048
    v_mfma_f32_16x16x32_bf16 v[104:107], v[76:79], v[56:59], v[104:107]
    ds_read_b128 v[36:39], v249 offset:3072
    v_mfma_f32_16x16x32_bf16 v[108:111], v[76:79], v[60:63], v[108:111]
    ds_read_b64_tr_b16 v[44:45], v253 offset:16384
    ds_read_b64_tr_b16 v[46:47], v253 offset:16896
    v_mfma_f32_16x16x32_bf16 v[112:115], v[76:79], v[64:67], v[112:115]
    ds_read_b64_tr_b16 v[48:49], v252 offset:24576
    v_mfma_f32_16x16x32_bf16 v[116:119], v[76:79], v[68:71], v[116:119]
    ds_read_b64_tr_b16 v[50:51], v252 offset:25088
    v_mfma_f32_16x16x32_bf16 v[120:123], v[80:83], v[56:59], v[120:123]
    ds_read_b64_tr_b16 v[52:53], v253 offset:24576
    v_mfma_f32_16x16x32_bf16 v[124:127], v[80:83], v[60:63], v[124:127]
    ds_read_b64_tr_b16 v[54:55], v253 offset:25088
    v_mfma_f32_16x16x32_bf16 v[128:131], v[80:83], v[64:67], v[128:131]
    v_mfma_f32_16x16x32_bf16 v[132:135], v[80:83], v[68:71], v[132:135]
    v_mfma_f32_16x16x32_bf16 v[136:139], v[84:87], v[56:59], v[136:139]
    v_mfma_f32_16x16x32_bf16 v[140:143], v[84:87], v[60:63], v[140:143]
    v_mfma_f32_16x16x32_bf16 v[144:147], v[84:87], v[64:67], v[144:147]
    v_mfma_f32_16x16x32_bf16 v[148:151], v[84:87], v[68:71], v[148:151]
    s_waitcnt lgkmcnt(9)
    v_mfma_f32_16x16x32_bf16 v[88:91], v[40:43], v[24:27], v[88:91]
    ds_read_b64_tr_b16 v[72:73], v252 offset:20480
    ds_read_b64_tr_b16 v[74:75], v252 offset:20992
    s_waitcnt lgkmcnt(10)
    v_mfma_f32_16x16x32_bf16 v[92:95], v[40:43], v[28:31], v[92:95]
    ds_read_b128 v[56:59], v249 offset:8192
    s_waitcnt lgkmcnt(10)
    v_mfma_f32_16x16x32_bf16 v[96:99], v[40:43], v[32:35], v[96:99]
    ds_read_b128 v[60:63], v249 offset:9216
    ds_read_b128 v[64:67], v249 offset:10240
    s_waitcnt lgkmcnt(11)
    v_mfma_f32_16x16x32_bf16 v[100:103], v[40:43], v[36:39], v[100:103]
    ds_read_b128 v[68:71], v249 offset:11264
    s_waitcnt lgkmcnt(10)
    v_mfma_f32_16x16x32_bf16 v[104:107], v[44:47], v[24:27], v[104:107]
    ds_read_b64_tr_b16 v[76:77], v253 offset:20480
    ds_read_b64_tr_b16 v[78:79], v253 offset:20992
    v_mfma_f32_16x16x32_bf16 v[108:111], v[44:47], v[28:31], v[108:111]
    ds_read_b64_tr_b16 v[80:81], v252 offset:28672
    v_mfma_f32_16x16x32_bf16 v[112:115], v[44:47], v[32:35], v[112:115]
    ds_read_b64_tr_b16 v[82:83], v252 offset:29184
    ds_read_b64_tr_b16 v[84:85], v253 offset:28672
    v_mfma_f32_16x16x32_bf16 v[116:119], v[44:47], v[36:39], v[116:119]
    ds_read_b64_tr_b16 v[86:87], v253 offset:29184
    s_waitcnt lgkmcnt(14)
    v_mfma_f32_16x16x32_bf16 v[120:123], v[48:51], v[24:27], v[120:123]
    v_mfma_f32_16x16x32_bf16 v[124:127], v[48:51], v[28:31], v[124:127]
    s_lshl_b32 s48, s46, 15
    s_and_b32 s48, s48, 0x38000
    v_mfma_f32_16x16x32_bf16 v[128:131], v[48:51], v[32:35], v[128:131]
    s_lshr_b64 s[46:47], s[46:47], 3
    v_mfma_f32_16x16x32_bf16 v[132:135], v[48:51], v[36:39], v[132:135]
    v_xor_b32 v252, s48, v252
    s_waitcnt lgkmcnt(12)
    v_mfma_f32_16x16x32_bf16 v[136:139], v[52:55], v[24:27], v[136:139]
    v_xor_b32 v249, s48, v249
    v_mfma_f32_16x16x32_bf16 v[140:143], v[52:55], v[28:31], v[140:143]
    v_xor_b32 v253, s48, v253
    v_mfma_f32_16x16x32_bf16 v[144:147], v[52:55], v[32:35], v[144:147]
    s_sub_u32 s34, s34, 1
    v_mfma_f32_16x16x32_bf16 v[148:151], v[52:55], v[36:39], v[148:151]
    s_cbranch_scc0 L_dl
    s_waitcnt lgkmcnt(0)
    s_barrier
    v_mfma_f32_16x16x32_bf16 v[88:91], v[72:75], v[56:59], v[88:91]
    v_mfma_f32_16x16x32_bf16 v[92:95], v[72:75], v[60:63], v[92:95]
    v_mfma_f32_16x16x32_bf16 v[96:99], v[72:75], v[64:67], v[96:99]
    v_mfma_f32_16x16x32_bf16 v[100:103], v[72:75], v[68:71], v[100:103]
    v_mfma_f32_16x16x32_bf16 v[104:107], v[76:79], v[56:59], v[104:107]
    v_mfma_f32_16x16x32_bf16 v[108:111], v[76:79], v[60:63], v[108:111]
    v_mfma_f32_16x16x32_bf16 v[112:115], v[76:79], v[64:67], v[112:115]
    v_mfma_f32_16x16x32_bf16 v[116:119], v[76:79], v[68:71], v[116:119]
    v_mfma_f32_16x16x32_bf16 v[120:123], v[80:83], v[56:59], v[120:123]
    v_mfma_f32_16x16x32_bf16 v[124:127], v[80:83], v[60:63], v[124:127]
    v_mfma_f32_16x16x32_bf16 v[128:131], v[80:83], v[64:67], v[128:131]
    v_mfma_f32_16x16x32_bf16 v[132:135], v[80:83], v[68:71], v[132:135]
    v_mfma_f32_16x16x32_bf16 v[136:139], v[84:87], v[56:59], v[136:139]
    v_mfma_f32_16x16x32_bf16 v[140:143], v[84:87], v[60:63], v[140:143]
    v_mfma_f32_16x16x32_bf16 v[144:147], v[84:87], v[64:67], v[144:147]
    v_mfma_f32_16x16x32_bf16 v[148:151], v[84:87], v[68:71], v[148:151]
    s_setprio 0
    s_lshl4_add_u32 s91, s28, s29
    s_xor_b32 s91, s91, 136
    s_lshl_b32 s91, s91, 7
    s_add_u32 s91, s91, 0x1ea0000
    v_mov_b32 v13, s91
    s_nop 7
    v_max_f32_e64 v8, |v120|, |v121|
    v_max_f32_e64 v9, |v128|, |v129|
    v_max_f32_e64 v10, |v136|, |v137|
    v_max_f32_e64 v11, |v144|, |v145|
    v_max3_f32 v8, |v122|, |v123|, v8
    v_max3_f32 v9, |v130|, |v131|, v9
    v_max3_f32 v10, |v138|, |v139|, v10
    v_max3_f32 v11, |v146|, |v147|, v11
    v_max3_f32 v8, |v124|, |v125|, v8
    v_max3_f32 v9, |v132|, |v133|, v9
    v_max3_f32 v10, |v140|, |v141|, v10
    v_max3_f32 v11, |v148|, |v149|, v11
    v_max3_f32 v8, |v126|, |v127|, v8
    v_max3_f32 v9, |v134|, |v135|, v9
    v_max3_f32 v10, |v142|, |v143|, v10
    v_max3_f32 v11, |v150|, |v151|, v11
    v_max3_f32 v8, v8, v9, v10
    v_max_f32 v8, v8, v11
    v_min_f32 v8, 0x7f7fffff, v8
    v_frexp_exp_i32_f32 v8, v8
    v_max_i32 v8, -100, v8
    v_sub_u32 v9, 15, v8
    v_add_u32 v8, -15, v8
    v_ldexp_f32 v9, 1.0, v9
    v_ldexp_f32 v8, 1.0, v8
    buffer_store_dword v8, v6, s[68:71], s37 offen sc1
    v_fma_mixlo_f16 v32, v120, v9, 0
    v_fma_mixlo_f16 v33, v122, v9, 0
    v_fma_mixlo_f16 v34, v124, v9, 0
    v_fma_mixlo_f16 v35, v126, v9, 0
    v_fma_mixhi_f16 v32, v121, v9, 0
    v_fma_mixhi_f16 v33, v123, v9, 0
    v_fma_mixhi_f16 v34, v125, v9, 0
    v_fma_mixhi_f16 v35, v127, v9, 0
    s_nop 0
    buffer_store_dwordx4 v[32:35], v4, s[68:71], s36 offen offset:0 sc1
    v_fma_mixlo_f16 v36, v128, v9, 0
    v_fma_mixlo_f16 v37, v130, v9, 0
    v_fma_mixlo_f16 v38, v132, v9, 0
    v_fma_mixlo_f16 v39, v134, v9, 0
    v_fma_mixhi_f16 v36, v129, v9, 0
    v_fma_mixhi_f16 v37, v131, v9, 0
    v_fma_mixhi_f16 v38, v133, v9, 0
    v_fma_mixhi_f16 v39, v135, v9, 0
    s_nop 0
    buffer_store_dwordx4 v[36:39], v4, s[68:71], s36 offen offset:1024 sc1
    s_barrier
    v_fma_mixlo_f16 v40, v136, v9, 0
    v_fma_mixlo_f16 v41, v138, v9, 0
    v_fma_mixlo_f16 v42, v140, v9, 0
    v_fma_mixlo_f16 v43, v142, v9, 0
    v_fma_mixhi_f16 v40, v137, v9, 0
    v_fma_mixhi_f16 v41, v139, v9, 0
    v_fma_mixhi_f16 v42, v141, v9, 0
    v_fma_mixhi_f16 v43, v143, v9, 0
    s_nop 0
    buffer_store_dwordx4 v[40:43], v4, s[68:71], s36 offen offset:2048 sc1
    v_fma_mixlo_f16 v44, v144, v9, 0
    v_fma_mixlo_f16 v45, v146, v9, 0
    v_fma_mixlo_f16 v46, v148, v9, 0
    v_fma_mixlo_f16 v47, v150, v9, 0
    v_fma_mixhi_f16 v44, v145, v9, 0
    v_fma_mixhi_f16 v45, v147, v9, 0
    v_fma_mixhi_f16 v46, v149, v9, 0
    v_fma_mixhi_f16 v47, v151, v9, 0
    s_nop 0
    buffer_store_dwordx4 v[44:47], v4, s[68:71], s36 offen offset:3072 sc1
    s_barrier
    s_barrier
    s_waitcnt vmcnt(0)
    s_barrier
    s_cmp_lg_u32 s4, 0
    s_cbranch_scc1 L_fP
    s_lshl_b32 s91, s28, 4
    s_add_u32 s91, s91, s29
    s_lshl_b32 s91, s91, 7
    s_add_u32 s91, s91, 0x1ea0000
    v_mov_b32 v16, s91
    v_mov_b32 v18, s100
    v_mov_b32 v19, s101
    s_mov_b64 exec, 1
    global_store_dwordx2 v16, v[18:19], s[26:27] sc1
    s_mov_b64 exec, -1
L_fP:
    s_barrier
    s_mov_b64 exec, 1
    global_load_dwordx2 v[14:15], v13, s[26:27] sc1
    s_mov_b64 exec, -1
    s_barrier
    s_barrier
    s_waitcnt vmcnt(0)
    s_mov_b64 exec, 1
    s_movk_i32 s98, 0x4000
L_pP_chk:
    v_cmp_ne_u64 vcc, s[100:101], v[14:15]
    s_nop 1
    s_cmp_eq_u64 vcc, 0
    s_cbranch_scc1 L_pP_ok
    s_sub_u32 s98, s98, 1
    s_cbranch_scc1 L_pP_ok
    s_sleep 1
    global_load_dwordx2 v[14:15], v13, s[26:27] sc1
    s_waitcnt vmcnt(0)
    s_branch L_pP_chk
L_pP_ok:
    s_mov_b64 exec, -1
    buffer_load_dword v168, v6, s[68:71], s39 offen sc1
    buffer_load_dwordx4 v[152:155], v4, s[68:71], s38 offen offset:0 sc1
    buffer_load_dwordx4 v[156:159], v4, s[68:71], s38 offen offset:1024 sc1
    buffer_load_dwordx4 v[160:163], v4, s[68:71], s38 offen offset:2048 sc1
    buffer_load_dwordx4 v[164:167], v4, s[68:71], s38 offen offset:3072 sc1
    s_barrier
    s_barrier
    s_waitcnt vmcnt(3)
    v_fma_mix_f32 v88, v152, v168, v88 op_sel:[0,0,0] op_sel_hi:[1,0,0]
    v_fma_mix_f32 v89, v152, v168, v89 op_sel:[1,0,0] op_sel_hi:[1,0,0]
    v_fma_mix_f32 v90, v153, v168, v90 op_sel:[0,0,0] op_sel_hi:[1,0,0]
    v_fma_mix_f32 v91, v153, v168, v91 op_sel:[1,0,0] op_sel_hi:[1,0,0]
    v_cvt_pk_bf16_f32 v28, v88, v89
    v_cvt_pk_bf16_f32 v29, v90, v91
    v_lshlrev_b32 v88, 16, v28
    v_and_b32 v89, 0xffff0000, v28
    v_lshlrev_b32 v90, 16, v29
    v_and_b32 v91, 0xffff0000, v29
    v_mul_f32 v24, 0xbfb8aa3b, v88
    v_mul_f32 v25, 0xbfb8aa3b, v89
    v_mul_f32 v26, 0xbfb8aa3b, v90
    v_mul_f32 v27, 0xbfb8aa3b, v91
    v_exp_f32 v24, v24
    v_exp_f32 v25, v25
    v_exp_f32 v26, v26
    v_exp_f32 v27, v27
    s_nop 0
    v_add_f32 v24, 1.0, v24
    v_add_f32 v25, 1.0, v25
    v_add_f32 v26, 1.0, v26
    v_add_f32 v27, 1.0, v27
    v_rcp_f32 v24, v24
    v_rcp_f32 v25, v25
    v_rcp_f32 v26, v26
    v_rcp_f32 v27, v27
    s_nop 0
    v_mul_f32 v24, v24, v88
    v_mul_f32 v25, v25, v89
    v_mul_f32 v26, v26, v90
    v_mul_f32 v27, v27, v91
    v_cvt_pk_bf16_f32 v88, v24, v25
    v_cvt_pk_bf16_f32 v89, v26, v27
    ds_write_b64 v5, v[88:89] offset:0
    v_fma_mix_f32 v92, v154, v168, v92 op_sel:[0,0,0] op_sel_hi:[1,0,0]
    v_fma_mix_f32 v93, v154, v168, v93 op_sel:[1,0,0] op_sel_hi:[1,0,0]
    v_fma_mix_f32 v94, v155, v168, v94 op_sel:[0,0,0] op_sel_hi:[1,0,0]
    v_fma_mix_f32 v95, v155, v168, v95 op_sel:[1,0,0] op_sel_hi:[1,0,0]
    v_cvt_pk_bf16_f32 v28, v92, v93
    v_cvt_pk_bf16_f32 v29, v94, v95
    v_lshlrev_b32 v92, 16, v28
    v_and_b32 v93, 0xffff0000, v28
    v_lshlrev_b32 v94, 16, v29
    v_and_b32 v95, 0xffff0000, v29
    v_mul_f32 v24, 0xbfb8aa3b, v92
    v_mul_f32 v25, 0xbfb8aa3b, v93
    v_mul_f32 v26, 0xbfb8aa3b, v94
    v_mul_f32 v27, 0xbfb8aa3b, v95
    v_exp_f32 v24, v24
    v_exp_f32 v25, v25
    v_exp_f32 v26, v26
    v_exp_f32 v27, v27
    s_nop 0
    v_add_f32 v24, 1.0, v24
    v_add_f32 v25, 1.0, v25
    s_barrier
    v_add_f32 v26, 1.0, v26
    v_add_f32 v27, 1.0, v27
    v_rcp_f32 v24, v24
    v_rcp_f32 v25, v25
    v_rcp_f32 v26, v26
    v_rcp_f32 v27, v27
    s_nop 0
    v_mul_f32 v24, v24, v92
    v_mul_f32 v25, v25, v93
    v_mul_f32 v26, v26, v94
    v_mul_f32 v27, v27, v95
    v_cvt_pk_bf16_f32 v92, v24, v25
    v_cvt_pk_bf16_f32 v93, v26, v27
    ds_write_b64 v5, v[92:93] offset:512
    s_waitcnt vmcnt(2)
    v_fma_mix_f32 v96, v156, v168, v96 op_sel:[0,0,0] op_sel_hi:[1,0,0]
    v_fma_mix_f32 v97, v156, v168, v97 op_sel:[1,0,0] op_sel_hi:[1,0,0]
    v_fma_mix_f32 v98, v157, v168, v98 op_sel:[0,0,0] op_sel_hi:[1,0,0]
    v_fma_mix_f32 v99, v157, v168, v99 op_sel:[1,0,0] op_sel_hi:[1,0,0]
    v_cvt_pk_bf16_f32 v28, v96, v97
    v_cvt_pk_bf16_f32 v29, v98, v99
    v_lshlrev_b32 v96, 16, v28
    v_and_b32 v97, 0xffff0000, v28
    v_lshlrev_b32 v98, 16, v29
    v_and_b32 v99, 0xffff0000, v29
    v_mul_f32 v24, 0xbfb8aa3b, v96
    v_mul_f32 v25, 0xbfb8aa3b, v97
    v_mul_f32 v26, 0xbfb8aa3b, v98
    v_mul_f32 v27, 0xbfb8aa3b, v99
    v_exp_f32 v24, v24
    v_exp_f32 v25, v25
    v_exp_f32 v26, v26
    v_exp_f32 v27, v27
    s_nop 0
    v_add_f32 v24, 1.0, v24
    v_add_f32 v25, 1.0, v25
    v_add_f32 v26, 1.0, v26
    v_add_f32 v27, 1.0, v27
    v_rcp_f32 v24, v24
    v_rcp_f32 v25, v25
    v_rcp_f32 v26, v26
    v_rcp_f32 v27, v27
    s_nop 0
    v_mul_f32 v24, v24, v96
    v_mul_f32 v25, v25, v97
    v_mul_f32 v26, v26, v98
    v_mul_f32 v27, v27, v99
    v_cvt_pk_bf16_f32 v96, v24, v25
    v_cvt_pk_bf16_f32 v97, v26, v27
    ds_write_b64 v5, v[96:97] offset:1024
    s_barrier
    v_fma_mix_f32 v100, v158, v168, v100 op_sel:[0,0,0] op_sel_hi:[1,0,0]
    v_fma_mix_f32 v101, v158, v168, v101 op_sel:[1,0,0] op_sel_hi:[1,0,0]
    v_fma_mix_f32 v102, v159, v168, v102 op_sel:[0,0,0] op_sel_hi:[1,0,0]
    v_fma_mix_f32 v103, v159, v168, v103 op_sel:[1,0,0] op_sel_hi:[1,0,0]
    v_cvt_pk_bf16_f32 v28, v100, v101
    v_cvt_pk_bf16_f32 v29, v102, v103
    v_lshlrev_b32 v100, 16, v28
    v_and_b32 v101, 0xffff0000, v28
    v_lshlrev_b32 v102, 16, v29
    v_and_b32 v103, 0xffff0000, v29
    v_mul_f32 v24, 0xbfb8aa3b, v100
    v_mul_f32 v25, 0xbfb8aa3b, v101
    v_mul_f32 v26, 0xbfb8aa3b, v102
    v_mul_f32 v27, 0xbfb8aa3b, v103
    v_exp_f32 v24, v24
    v_exp_f32 v25, v25
    v_exp_f32 v26, v26
    v_exp_f32 v27, v27
    s_nop 0
    v_add_f32 v24, 1.0, v24
    v_add_f32 v25, 1.0, v25
    v_add_f32 v26, 1.0, v26
    v_add_f32 v27, 1.0, v27
    v_rcp_f32 v24, v24
    v_rcp_f32 v25, v25
    v_rcp_f32 v26, v26
    v_rcp_f32 v27, v27
    s_nop 0
    v_mul_f32 v24, v24, v100
    v_mul_f32 v25, v25, v101
    v_mul_f32 v26, v26, v102
    v_mul_f32 v27, v27, v103
    v_cvt_pk_bf16_f32 v100, v24, v25
    v_cvt_pk_bf16_f32 v101, v26, v27
    ds_write_b64 v5, v[100:101] offset:1536
    s_waitcnt vmcnt(1)
    v_fma_mix_f32 v104, v160, v168, v104 op_sel:[0,0,0] op_sel_hi:[1,0,0]
    v_fma_mix_f32 v105, v160, v168, v105 op_sel:[1,0,0] op_sel_hi:[1,0,0]
    v_fma_mix_f32 v106, v161, v168, v106 op_sel:[0,0,0] op_sel_hi:[1,0,0]
    v_fma_mix_f32 v107, v161, v168, v107 op_sel:[1,0,0] op_sel_hi:[1,0,0]
    v_cvt_pk_bf16_f32 v28, v104, v105
    v_cvt_pk_bf16_f32 v29, v106, v107
    v_lshlrev_b32 v104, 16, v28
    v_and_b32 v105, 0xffff0000, v28
    v_lshlrev_b32 v106, 16, v29
    v_and_b32 v107, 0xffff0000, v29
    v_mul_f32 v24, 0xbfb8aa3b, v104
    v_mul_f32 v25, 0xbfb8aa3b, v105
    v_mul_f32 v26, 0xbfb8aa3b, v106
    v_mul_f32 v27, 0xbfb8aa3b, v107
    v_exp_f32 v24, v24
    v_exp_f32 v25, v25
    v_exp_f32 v26, v26
    v_exp_f32 v27, v27
    s_nop 0
    v_add_f32 v24, 1.0, v24
    v_add_f32 v25, 1.0, v25
    s_barrier
    v_add_f32 v26, 1.0, v26
    v_add_f32 v27, 1.0, v27
    v_rcp_f32 v24, v24
    v_rcp_f32 v25, v25
    v_rcp_f32 v26, v26
    v_rcp_f32 v27, v27
    s_nop 0
    v_mul_f32 v24, v24, v104
    v_mul_f32 v25, v25, v105
    v_mul_f32 v26, v26, v106
    v_mul_f32 v27, v27, v107
    v_cvt_pk_bf16_f32 v104, v24, v25
    v_cvt_pk_bf16_f32 v105, v26, v27
    ds_write_b64 v5, v[104:105] offset:2048
    v_fma_mix_f32 v108, v162, v168, v108 op_sel:[0,0,0] op_sel_hi:[1,0,0]
    v_fma_mix_f32 v109, v162, v168, v109 op_sel:[1,0,0] op_sel_hi:[1,0,0]
    v_fma_mix_f32 v110, v163, v168, v110 op_sel:[0,0,0] op_sel_hi:[1,0,0]
    v_fma_mix_f32 v111, v163, v168, v111 op_sel:[1,0,0] op_sel_hi:[1,0,0]
    v_cvt_pk_bf16_f32 v28, v108, v109
    v_cvt_pk_bf16_f32 v29, v110, v111
    v_lshlrev_b32 v108, 16, v28
    v_and_b32 v109, 0xffff0000, v28
    v_lshlrev_b32 v110, 16, v29
    v_and_b32 v111, 0xffff0000, v29
    v_mul_f32 v24, 0xbfb8aa3b, v108
    v_mul_f32 v25, 0xbfb8aa3b, v109
    v_mul_f32 v26, 0xbfb8aa3b, v110
    v_mul_f32 v27, 0xbfb8aa3b, v111
    v_exp_f32 v24, v24
    v_exp_f32 v25, v25
    v_exp_f32 v26, v26
    v_exp_f32 v27, v27
    s_nop 0
    v_add_f32 v24, 1.0, v24
    v_add_f32 v25, 1.0, v25
    v_add_f32 v26, 1.0, v26
    v_add_f32 v27, 1.0, v27
    v_rcp_f32 v24, v24
    v_rcp_f32 v25, v25
    v_rcp_f32 v26, v26
    v_rcp_f32 v27, v27
    s_nop 0
    v_mul_f32 v24, v24, v108
    v_mul_f32 v25, v25, v109
    v_mul_f32 v26, v26, v110
    v_mul_f32 v27, v27, v111
    v_cvt_pk_bf16_f32 v108, v24, v25
    v_cvt_pk_bf16_f32 v109, v26, v27
    ds_write_b64 v5, v[108:109] offset:2560
    s_barrier
    s_waitcnt vmcnt(0)
    v_fma_mix_f32 v112, v164, v168, v112 op_sel:[0,0,0] op_sel_hi:[1,0,0]
    v_fma_mix_f32 v113, v164, v168, v113 op_sel:[1,0,0] op_sel_hi:[1,0,0]
    v_fma_mix_f32 v114, v165, v168, v114 op_sel:[0,0,0] op_sel_hi:[1,0,0]
    v_fma_mix_f32 v115, v165, v168, v115 op_sel:[1,0,0] op_sel_hi:[1,0,0]
    v_cvt_pk_bf16_f32 v28, v112, v113
    v_cvt_pk_bf16_f32 v29, v114, v115
    v_lshlrev_b32 v112, 16, v28
    v_and_b32 v113, 0xffff0000, v28
    v_lshlrev_b32 v114, 16, v29
    v_and_b32 v115, 0xffff0000, v29
    v_mul_f32 v24, 0xbfb8aa3b, v112
    v_mul_f32 v25, 0xbfb8aa3b, v113
    v_mul_f32 v26, 0xbfb8aa3b, v114
    v_mul_f32 v27, 0xbfb8aa3b, v115
    v_exp_f32 v24, v24
    v_exp_f32 v25, v25
    v_exp_f32 v26, v26
    v_exp_f32 v27, v27
    s_nop 0
    v_add_f32 v24, 1.0, v24
    v_add_f32 v25, 1.0, v25
    v_add_f32 v26, 1.0, v26
    v_add_f32 v27, 1.0, v27
    v_rcp_f32 v24, v24
    v_rcp_f32 v25, v25
    v_rcp_f32 v26, v26
    v_rcp_f32 v27, v27
    s_nop 0
    v_mul_f32 v24, v24, v112
    v_mul_f32 v25, v25, v113
    v_mul_f32 v26, v26, v114
    v_mul_f32 v27, v27, v115
    v_cvt_pk_bf16_f32 v112, v24, v25
    v_cvt_pk_bf16_f32 v113, v26, v27
    ds_write_b64 v5, v[112:113] offset:3072
    v_fma_mix_f32 v116, v166, v168, v116 op_sel:[0,0,0] op_sel_hi:[1,0,0]
    v_fma_mix_f32 v117, v166, v168, v117 op_sel:[1,0,0] op_sel_hi:[1,0,0]
    v_fma_mix_f32 v118, v167, v168, v118 op_sel:[0,0,0] op_sel_hi:[1,0,0]
    v_fma_mix_f32 v119, v167, v168, v119 op_sel:[1,0,0] op_sel_hi:[1,0,0]
    v_cvt_pk_bf16_f32 v28, v116, v117
    v_cvt_pk_bf16_f32 v29, v118, v119
    v_lshlrev_b32 v116, 16, v28
    v_and_b32 v117, 0xffff0000, v28
    v_lshlrev_b32 v118, 16, v29
    v_and_b32 v119, 0xffff0000, v29
    v_mul_f32 v24, 0xbfb8aa3b, v116
    v_mul_f32 v25, 0xbfb8aa3b, v117
    v_mul_f32 v26, 0xbfb8aa3b, v118
    v_mul_f32 v27, 0xbfb8aa3b, v119
    v_exp_f32 v24, v24
    v_exp_f32 v25, v25
    v_exp_f32 v26, v26
    v_exp_f32 v27, v27
    s_nop 0
    v_add_f32 v24, 1.0, v24
    v_add_f32 v25, 1.0, v25
    s_barrier
    v_add_f32 v26, 1.0, v26
    v_add_f32 v27, 1.0, v27
    v_rcp_f32 v24, v24
    v_rcp_f32 v25, v25
    v_rcp_f32 v26, v26
    v_rcp_f32 v27, v27
    s_nop 0
    v_mul_f32 v24, v24, v116
    v_mul_f32 v25, v25, v117
    v_mul_f32 v26, v26, v118
    v_mul_f32 v27, v27, v119
    v_cvt_pk_bf16_f32 v116, v24, v25
    v_cvt_pk_bf16_f32 v117, v26, v27
    ds_write_b64 v5, v[116:117] offset:3584
    s_waitcnt lgkmcnt(0)
    s_barrier
    s_branch L_fin
.p2align 12
L_teamB:
    s_mov_b64 exec, -1
    s_setprio 3
    v_lshrrev_b32 v64, 4, v1
    v_bfe_u32 v65, v1, 2, 2
    v_and_b32 v66, 3, v1
    v_and_b32 v67, 15, v1
    v_lshrrev_b32 v68, 3, v1
    v_and_b32 v69, 7, v1
    s_lshl_b32 s85, s28, 7
    s_lshl_b32 s86, s4, 5
    s_add_u32 s86, s85, s86
    v_add_u32 v71, s86, v68
    v_xor_b32 v70, v69, v64
    v_lshlrev_b32 v70, 4, v70
    v_lshl_add_u32 v20, v71, 11, v70
    v_xor_b32 v21, 64, v20
    v_add_u32 v21, 16384, v21
    s_lshl_b32 s79, s4, 12
    s_and_b32 s72, s28, 3
    s_bitcmp1_b32 s28, 3
    s_cselect_b32 s91, 4, 0
    s_add_u32 s72, s72, s91
    s_mul_i32 s72, s72, 256
    s_waitcnt lgkmcnt(0)
    s_mov_b32 s36, s8
    s_mov_b32 s37, s9
    s_mov_b32 s38, 0x400000
    s_mov_b32 s39, 0x20000
    s_add_u32 m0, s79, 135168
    s_add_u32 s72, s72, 128
    s_and_b32 s78, s72, 0x7ff
    buffer_load_dwordx4 v20, s[36:39], s78 offen lds
    s_add_u32 m0, s79, 136192
    s_nop 0
    buffer_load_dwordx4 v21, s[36:39], s78 offen lds
    s_add_u32 m0, s79, 137216
    s_add_u32 s78, s78, 32768
    buffer_load_dwordx4 v20, s[36:39], s78 offen lds
    s_add_u32 m0, s79, 138240
    s_nop 0
    buffer_load_dwordx4 v21, s[36:39], s78 offen lds
    s_setprio 0
    s_mov_b32 s68, s26
    s_mov_b32 s69, s27
    s_mov_b32 s70, 0x10000000
    s_mov_b32 s71, 0x20000
L_fan5:
    s_cbranch_execz L_teamB
    s_lshl_b32 s85, s4, 3
    s_and_b32 s86, s4, 1
    s_lshl_b32 s86, s86, 2
    v_and_b32 v70, 2, v68
    v_xor_b32 v70, v70, v69
    v_xor_b32 v70, s86, v70
    v_add_u32 v71, s85, v68
    v_mul_u32_u24 v71, 7168, v71
    v_lshl_add_u32 v22, v70, 4, v71
    v_lshrrev_b32 v71, 2, v1
    s_lshl_b32 s86, s86, 2
    v_add_u32 v71, s86, v71
    v_mul_u32_u24 v71, 7168, v71
    v_and_b32 v70, 2, v64
    v_xor_b32 v70, v70, v66
    v_lshl_add_u32 v9, v70, 4, v71
    s_mul_i32 s85, s29, 320
    s_and_b32 s86, s29, 1
    s_lshl_b32 s87, s86, 6
    s_add_u32 s87, s87, s85
    s_add_u32 s40, s16, s87
    s_addc_u32 s41, s17, 0
    s_sub_u32 s42, 7340032, s87
    s_mov_b32 s43, 0x20000
    s_add_u32 s44, s18, s87
    s_addc_u32 s45, s19, 0
    s_sub_u32 s46, 7340032, s87
    s_mov_b32 s47, 0x20000
    s_xor_b32 s86, s86, 1
    s_lshl_b32 s86, s86, 8
    s_add_u32 s87, s86, s85
    s_cmp_lt_u32 s4, 2
    s_cselect_b32 s88, s16, s18
    s_cselect_b32 s89, s17, s19
    s_add_u32 s48, s88, s87
    s_addc_u32 s49, s89, 0
    s_sub_u32 s50, 7340032, s87
    s_mov_b32 s51, 0x20000
    s_and_b32 s77, s28, 3
    s_bitcmp1_b32 s28, 3
    s_cselect_b32 s91, 4, 0
    s_add_u32 s77, s77, s91
    s_mul_i32 s77, s77, 917504
    s_add_u32 s77, s77, 0x38000
    s_add_u32 m0, s33, 57344
    s_add_u32 s77, s77, 229376
    s_cmp_eq_u32 s77, 7340032
    s_cselect_b32 s77, 0, s77
L_fan6:
    s_cbranch_execz L_teamB
    buffer_load_dwordx4 v22, s[40:43], s77 offen offset:0 lds
    s_add_u32 m0, s33, 61312
    s_nop 0
    buffer_load_dwordx4 v22, s[40:43], s77 offen offset:128 lds
    s_add_u32 m0, s33, 65536
    s_nop 0
    buffer_load_dwordx4 v22, s[44:47], s77 offen offset:0 lds
    s_add_u32 m0, s33, 69504
    s_nop 0
    buffer_load_dwordx4 v22, s[44:47], s77 offen offset:128 lds
    s_add_u32 m0, s33, 73728
    s_nop 0
    buffer_load_dwordx4 v9, s[48:51], s77 offen lds
    s_lshl_b32 s84, s28, 7
    s_lshl_b32 s85, s29, 3
    s_add_u32 s84, s84, s85
    s_lshl1_add_u32 s84, s4, s84
    s_lshl_b32 s90, s84, 3
    s_lshl_b32 s84, s84, 11
    v_lshl_add_u32 v86, v1, 4, s84
    v_and_b32 v70, 1, v67
    v_lshlrev_b32 v70, 4, v70
    v_mov_b32 v71, 0x3f80
    v_lshlrev_b32 v70, v70, v71
    v_lshrrev_b32 v71, 1, v67
    v_cmp_eq_u32 vcc, 0, v71
    s_nop 1
    v_cndmask_b32 v144, 0, v70, vcc
    v_cmp_eq_u32 vcc, 1, v71
    s_nop 1
    v_cndmask_b32 v145, 0, v70, vcc
    v_cmp_eq_u32 vcc, 2, v71
    s_nop 1
    v_cndmask_b32 v146, 0, v70, vcc
    v_cmp_eq_u32 vcc, 3, v71
    s_nop 1
    v_cndmask_b32 v147, 0, v70, vcc
    s_lshl_b32 s91, s4, 12
    s_add_u32 s91, s91, 16384
    v_lshlrev_b32 v70, 1, v64
    v_xor_b32 v71, v69, v70
    v_lshl_add_u32 v71, v71, 4, s91
    v_and_b32 v148, 4, v70
    v_add_u32 v70, v70, v148
    v_and_b32 v148, 1, v68
    v_add_u32 v70, v70, v148
    v_lshl_add_u32 v148, v70, 7, v71
    s_lshl_b32 s91, s5, 11
    s_add_u32 s91, s91, 32768
L_fan7:
    s_cbranch_execz L_teamB
    v_and_b32 v70, 2, v64
    v_xor_b32 v70, v66, v70
    v_lshl_add_u32 v70, v70, 4, s91
    v_lshrrev_b32 v71, 2, v1
    v_lshl_add_u32 v149, v71, 6, v70
    s_lshl2_add_u32 s91, s2, s4
    s_lshl_b32 s52, s91, 9
    s_lshr_b32 s92, s91, 2
    s_mul_i32 s92, s92, 7168
    s_and_b32 s91, s91, 3
    s_lshl_b32 s91, s91, 9
    s_add_u32 s92, s92, s91
    s_add_u32 s53, s92, 5120
    s_barrier
    s_and_b32 s91, s28, 4
    s_cmp_eq_u32 s91, 0
    s_cbranch_scc0 L_cr0
    ds_read_b128 v[112:115], v148 offset:0
    ds_read_b128 v[116:119], v148 offset:512
    ds_read_b128 v[120:123], v148 offset:2048
    ds_read_b128 v[124:127], v148 offset:2560
    ds_read_b128 v[128:131], v149 offset:0
    ds_read_b128 v[132:135], v149 offset:1024
L_cr0:
    s_add_u32 m0, s33, 77824
    s_add_u32 s77, s77, 229376
    buffer_load_dwordx4 v22, s[40:43], s77 offen offset:0 lds
    s_add_u32 m0, s33, 81792
    s_nop 0
    buffer_load_dwordx4 v22, s[40:43], s77 offen offset:128 lds
    s_add_u32 m0, s33, 86016
    s_nop 0
    buffer_load_dwordx4 v22, s[44:47], s77 offen offset:0 lds
    s_add_u32 m0, s33, 89984
    s_nop 0
    buffer_load_dwordx4 v22, s[44:47], s77 offen offset:128 lds
    s_add_u32 m0, s33, 94208
    s_nop 0
    buffer_load_dwordx4 v9, s[48:51], s77 offen lds
    s_add_u32 m0, s79, 98304
    s_add_u32 s72, s72, 128
    s_and_b32 s78, s72, 0x7ff
    buffer_load_dwordx4 v20, s[36:39], s78 offen lds
    s_add_u32 m0, s79, 99328
    s_nop 0
    buffer_load_dwordx4 v21, s[36:39], s78 offen lds
    s_and_b32 s91, s28, 4
    s_cmp_eq_u32 s91, 0
    s_cbranch_scc0 L_cm0
    s_waitcnt lgkmcnt(0)
    s_setprio 2
    v_mfma_f32_16x16x32_bf16 v[136:139], v[144:147], v[112:115], 0
    v_mfma_f32_16x16x32_bf16 v[140:143], v[144:147], v[128:131], 0
    v_mfma_f32_16x16x32_bf16 v[136:139], v[144:147], v[116:119], v[136:139]
    v_mfma_f32_16x16x32_bf16 v[140:143], v[144:147], v[132:135], v[140:143]
    v_mfma_f32_16x16x32_bf16 v[136:139], v[144:147], v[120:123], v[136:139]
    v_mfma_f32_16x16x32_bf16 v[136:139], v[144:147], v[124:127], v[136:139]
    s_setprio 0
L_cm0:
    s_barrier
    s_and_b32 s91, s28, 4
    s_cmp_eq_u32 s91, 0
    s_cbranch_scc0 L_cr1
    ds_read_b128 v[112:115], v148 offset:20480
    ds_read_b128 v[116:119], v148 offset:20992
    ds_read_b128 v[120:123], v148 offset:22528
    ds_read_b128 v[124:127], v148 offset:23040
    ds_read_b128 v[128:131], v149 offset:20480
    ds_read_b128 v[132:135], v149 offset:21504
L_cr1:
    s_add_u32 m0, s79, 100352
    s_add_u32 s78, s78, 32768
    buffer_load_dwordx4 v20, s[36:39], s78 offen lds
    s_add_u32 m0, s79, 101376
    s_nop 0
    buffer_load_dwordx4 v21, s[36:39], s78 offen lds
    s_add_u32 m0, s33, 16384
    s_add_u32 s77, s77, 229376
    s_cmp_eq_u32 s77, 7340032
    s_cselect_b32 s77, 0, s77
    buffer_load_dwordx4 v22, s[40:43], s77 offen offset:0 lds
    s_add_u32 m0, s33, 20352
    s_nop 0
    buffer_load_dwordx4 v22, s[40:43], s77 offen offset:128 lds
    s_add_u32 m0, s33, 24576
    s_nop 0
    buffer_load_dwordx4 v22, s[44:47], s77 offen offset:0 lds
    s_add_u32 m0, s33, 28544
    s_nop 0
    buffer_load_dwordx4 v22, s[44:47], s77 offen offset:128 lds
    s_add_u32 m0, s33, 32768
    s_nop 0
    buffer_load_dwordx4 v9, s[48:51], s77 offen lds
    s_and_b32 s91, s28, 4
    s_cmp_eq_u32 s91, 0
    s_cbranch_scc0 L_cm1
    s_waitcnt lgkmcnt(0)
    s_setprio 2
    v_mfma_f32_16x16x32_bf16 v[136:139], v[144:147], v[112:115], v[136:139]
    v_mfma_f32_16x16x32_bf16 v[140:143], v[144:147], v[128:131], v[140:143]
    v_mfma_f32_16x16x32_bf16 v[136:139], v[144:147], v[116:119], v[136:139]
    v_mfma_f32_16x16x32_bf16 v[140:143], v[144:147], v[132:135], v[140:143]
    v_mfma_f32_16x16x32_bf16 v[136:139], v[144:147], v[120:123], v[136:139]
    v_mfma_f32_16x16x32_bf16 v[136:139], v[144:147], v[124:127], v[136:139]
    s_setprio 0
L_cm1:
    s_waitcnt vmcnt(14)
    s_barrier
    s_and_b32 s91, s28, 4
    s_cmp_eq_u32 s91, 4
    s_cbranch_scc0 L_cr2
    ds_read_b128 v[112:115], v148 offset:40960
    ds_read_b128 v[116:119], v148 offset:41472
    ds_read_b128 v[120:123], v148 offset:43008
    ds_read_b128 v[124:127], v148 offset:43520
    ds_read_b128 v[128:131], v149 offset:40960
    ds_read_b128 v[132:135], v149 offset:41984
L_cr2:
    global_load_dwordx4 v[24:27], v86, s[8:9] offset:0
    global_load_dwordx4 v[32:35], v86, s[8:9] offset:2048
    global_load_dwordx4 v[28:31], v86, s[8:9] offset:1024
    global_load_dwordx4 v[36:39], v86, s[8:9] offset:3072
    s_add_u32 m0, s79, 116736
    s_add_u32 s72, s72, 128
    s_and_b32 s78, s72, 0x7ff
    buffer_load_dwordx4 v20, s[36:39], s78 offen lds
    s_add_u32 m0, s79, 117760
    s_nop 0
    buffer_load_dwordx4 v21, s[36:39], s78 offen lds
    s_add_u32 m0, s33, 36864
    s_add_u32 s77, s77, 229376
    buffer_load_dwordx4 v22, s[40:43], s77 offen offset:0 lds
    s_add_u32 m0, s33, 40832
    s_nop 0
    buffer_load_dwordx4 v22, s[40:43], s77 offen offset:128 lds
    s_add_u32 m0, s33, 45056
    s_nop 0
    buffer_load_dwordx4 v22, s[44:47], s77 offen offset:0 lds
    s_add_u32 m0, s33, 49024
    s_nop 0
    buffer_load_dwordx4 v22, s[44:47], s77 offen offset:128 lds
    s_add_u32 m0, s33, 53248
    s_nop 0
    buffer_load_dwordx4 v9, s[48:51], s77 offen lds
    s_and_b32 s91, s28, 4
    s_cmp_eq_u32 s91, 4
    s_cbranch_scc0 L_cm2
    s_waitcnt lgkmcnt(0)
    s_setprio 2
    v_mfma_f32_16x16x32_bf16 v[136:139], v[144:147], v[112:115], 0
    v_mfma_f32_16x16x32_bf16 v[140:143], v[144:147], v[128:131], 0
    v_mfma_f32_16x16x32_bf16 v[136:139], v[144:147], v[116:119], v[136:139]
    v_mfma_f32_16x16x32_bf16 v[140:143], v[144:147], v[132:135], v[140:143]
    v_mfma_f32_16x16x32_bf16 v[136:139], v[144:147], v[120:123], v[136:139]
    v_mfma_f32_16x16x32_bf16 v[136:139], v[144:147], v[124:127], v[136:139]
    s_setprio 0
L_cm2:
    s_waitcnt vmcnt(20)
    s_barrier
    s_and_b32 s91, s28, 4
    s_cmp_eq_u32 s91, 4
    s_cbranch_scc0 L_cr3
    ds_read_b128 v[112:115], v148 offset:61440
    ds_read_b128 v[116:119], v148 offset:61952
    ds_read_b128 v[120:123], v148 offset:63488
    ds_read_b128 v[124:127], v148 offset:64000
    ds_read_b128 v[128:131], v149 offset:61440
    ds_read_b128 v[132:135], v149 offset:62464
L_cr3:
    s_add_u32 m0, s79, 118784
    s_add_u32 s78, s78, 32768
    buffer_load_dwordx4 v20, s[36:39], s78 offen lds
    s_add_u32 m0, s79, 119808
    s_nop 0
    buffer_load_dwordx4 v21, s[36:39], s78 offen lds
    s_add_u32 m0, s33, 57344
    s_add_u32 s77, s77, 229376
    s_cmp_eq_u32 s77, 7340032
    s_cselect_b32 s77, 0, s77
    buffer_load_dwordx4 v22, s[40:43], s77 offen offset:0 lds
    s_add_u32 m0, s33, 61312
    s_nop 0
    buffer_load_dwordx4 v22, s[40:43], s77 offen offset:128 lds
    s_add_u32 m0, s33, 65536
    s_nop 0
    buffer_load_dwordx4 v22, s[44:47], s77 offen offset:0 lds
    s_add_u32 m0, s33, 69504
    s_nop 0
    buffer_load_dwordx4 v22, s[44:47], s77 offen offset:128 lds
    s_add_u32 m0, s33, 73728
    s_nop 0
    buffer_load_dwordx4 v9, s[48:51], s77 offen lds
    s_and_b32 s91, s28, 4
    s_cmp_eq_u32 s91, 4
    s_cbranch_scc0 L_cm3
    s_waitcnt lgkmcnt(0)
    s_setprio 2
    v_mfma_f32_16x16x32_bf16 v[136:139], v[144:147], v[112:115], v[136:139]
    v_mfma_f32_16x16x32_bf16 v[140:143], v[144:147], v[128:131], v[140:143]
    v_mfma_f32_16x16x32_bf16 v[136:139], v[144:147], v[116:119], v[136:139]
    v_mfma_f32_16x16x32_bf16 v[140:143], v[144:147], v[132:135], v[140:143]
    v_mfma_f32_16x16x32_bf16 v[136:139], v[144:147], v[120:123], v[136:139]
    v_mfma_f32_16x16x32_bf16 v[136:139], v[144:147], v[124:127], v[136:139]
    s_setprio 0
L_cm3:
    s_sub_u32 s91, s2, 224
    s_lshl1_add_u32 s91, s91, 1
    s_cmp_ge_u32 s2, 224
    s_cselect_b32 s91, s91, s2
    s_cselect_b32 s88, s12, s20
    s_cselect_b32 s89, s13, s21
    s_cselect_b32 s34, 0x800000, 0
    s_lshr_b32 s92, s91, 2
    s_lshl_b32 s92, s92, 17
    s_add_u32 s34, s34, s92
    s_and_b32 s93, s91, 3
    s_lshl_b32 s93, s93, 13
    s_add_u32 s34, s34, s93
    s_and_b32 s93, s91, 1
    s_lshl_b32 s93, s93, 7
    s_add_u32 s92, s92, s93
    s_and_b32 s93, s91, 2
    s_lshl_b32 s93, s93, 9
    s_add_u32 s92, s92, s93
    s_add_u32 s92, s92, 256
    s_add_u32 s88, s88, s92
    s_addc_u32 s89, s89, 0
    s_lshl_b32 s76, s4, 15
    s_waitcnt vmcnt(18)
    s_barrier
    s_add_u32 m0, s79, 135168
    s_add_u32 s72, s72, 128
    s_and_b32 s78, s72, 0x7ff
    buffer_load_dwordx4 v20, s[36:39], s78 offen lds
    s_add_u32 m0, s79, 136192
    s_nop 0
    buffer_load_dwordx4 v21, s[36:39], s78 offen lds
    s_add_u32 m0, s33, 77824
    s_add_u32 s77, s77, 229376
    buffer_load_dwordx4 v22, s[40:43], s77 offen offset:0 lds
    s_add_u32 m0, s33, 81792
    s_nop 0
    buffer_load_dwordx4 v22, s[40:43], s77 offen offset:128 lds
    s_add_u32 m0, s33, 86016
    s_nop 0
    buffer_load_dwordx4 v22, s[44:47], s77 offen offset:0 lds
    s_add_u32 m0, s33, 89984
    s_nop 0
    buffer_load_dwordx4 v22, s[44:47], s77 offen offset:128 lds
    s_add_u32 m0, s33, 94208
    s_nop 0
    buffer_load_dwordx4 v9, s[48:51], s77 offen lds
    v_add_f32_dpp v136, v136, v136 row_ror:8 row_mask:0xf bank_mask:0xf
    v_add_f32_dpp v137, v137, v137 row_ror:8 row_mask:0xf bank_mask:0xf
    v_add_f32_dpp v138, v138, v138 row_ror:8 row_mask:0xf bank_mask:0xf
    v_add_f32_dpp v139, v139, v139 row_ror:8 row_mask:0xf bank_mask:0xf
    v_add_f32_dpp v140, v140, v140 row_ror:8 row_mask:0xf bank_mask:0xf
    v_add_f32_dpp v141, v141, v141 row_ror:8 row_mask:0xf bank_mask:0xf
    v_add_f32_dpp v142, v142, v142 row_ror:8 row_mask:0xf bank_mask:0xf
    v_add_f32_dpp v143, v143, v143 row_ror:8 row_mask:0xf bank_mask:0xf
    v_add_f32_dpp v140, v140, v140 row_ror:4 row_mask:0xf bank_mask:0xf
    v_add_f32_dpp v141, v141, v141 row_ror:4 row_mask:0xf bank_mask:0xf
    v_add_f32_dpp v142, v142, v142 row_ror:4 row_mask:0xf bank_mask:0xf
    v_add_f32_dpp v143, v143, v143 row_ror:4 row_mask:0xf bank_mask:0xf
    s_lshl_b32 s91, s29, 4
    s_add_u32 s91, s91, s28
    s_mul_i32 s91, s91, 1280
    s_mul_i32 s92, s5, 640
    s_add_u32 s91, s91, s92
    s_add_u32 s91, s91, 0x1e10000
    s_lshl_b32 s92, s6, 8
    v_and_b32 v112, 8, v1
    v_cmp_eq_u32 vcc, 0, v112
    v_mov_b32 v112, s92
    v_mov_b32 v113, 256
    v_cndmask_b32 v112, v113, v112, vcc
    v_cndmask_b32 v136, v140, v136, vcc
    v_cndmask_b32 v137, v141, v137, vcc
    v_cndmask_b32 v138, v142, v138, vcc
    v_cndmask_b32 v139, v143, v139, vcc
    v_and_b32 v113, 15, v1
    v_lshl_add_u32 v112, v113, 5, v112
    v_and_b32 v113, 16, v1
    v_add3_u32 v112, v112, v113, s91
    s_mov_b64 exec, 0x0fff0fff
    global_store_dwordx4 v112, v[136:139], s[26:27] sc1
    s_mov_b64 exec, -1
    s_load_dword s94, s[88:89], s76 offset:0
    s_load_dword s94, s[88:89], s76 offset:64
    s_load_dword s94, s[88:89], s76 offset:2048
    s_load_dword s94, s[88:89], s76 offset:2112
    s_waitcnt vmcnt(15)
    s_barrier
    s_add_u32 m0, s79, 137216
    s_add_u32 s78, s78, 32768
    buffer_load_dwordx4 v20, s[36:39], s78 offen lds
    s_waitcnt vmcnt(23)
    v_lshlrev_b32 v40, 16, v24
    v_and_b32 v41, 0xffff0000, v24
    v_lshlrev_b32 v42, 16, v25
    v_and_b32 v43, 0xffff0000, v25
    v_lshlrev_b32 v44, 16, v26
    v_and_b32 v45, 0xffff0000, v26
    v_lshlrev_b32 v46, 16, v27
    v_and_b32 v47, 0xffff0000, v27
    s_add_u32 m0, s79, 138240
    s_nop 0
    buffer_load_dwordx4 v21, s[36:39], s78 offen lds
    v_lshlrev_b32 v48, 16, v28
    v_and_b32 v49, 0xffff0000, v28
    v_lshlrev_b32 v50, 16, v29
    v_and_b32 v51, 0xffff0000, v29
    v_lshlrev_b32 v52, 16, v30
    v_and_b32 v53, 0xffff0000, v30
    v_lshlrev_b32 v54, 16, v31
    v_and_b32 v55, 0xffff0000, v31
    s_add_u32 m0, s33, 16384
    s_add_u32 s77, s77, 229376
    s_cmp_eq_u32 s77, 7340032
    s_cselect_b32 s77, 0, s77
    buffer_load_dwordx4 v22, s[40:43], s77 offen offset:0 lds
    v_lshlrev_b32 v56, 16, v32
    v_and_b32 v57, 0xffff0000, v32
    v_lshlrev_b32 v58, 16, v33
    v_and_b32 v59, 0xffff0000, v33
    v_lshlrev_b32 v60, 16, v34
    v_and_b32 v61, 0xffff0000, v34
    v_lshlrev_b32 v62, 16, v35
    v_and_b32 v63, 0xffff0000, v35
    s_add_u32 m0, s33, 20352
    s_nop 0
    buffer_load_dwordx4 v22, s[40:43], s77 offen offset:128 lds
    v_lshlrev_b32 v64, 16, v36
    v_and_b32 v65, 0xffff0000, v36
    v_lshlrev_b32 v66, 16, v37
    v_and_b32 v67, 0xffff0000, v37
    v_lshlrev_b32 v68, 16, v38
    v_and_b32 v69, 0xffff0000, v38
    v_lshlrev_b32 v70, 16, v39
    v_and_b32 v71, 0xffff0000, v39
    s_add_u32 m0, s33, 24576
    s_nop 0
    buffer_load_dwordx4 v22, s[44:47], s77 offen offset:0 lds
    v_add_f32 v72, v40, v41
    v_add_f32 v74, v56, v57
    v_add_f32 v72, v72, v42
    v_add_f32 v74, v74, v58
    v_add_f32 v72, v72, v43
    v_add_f32 v74, v74, v59
    v_add_f32 v72, v72, v44
    v_add_f32 v74, v74, v60
    s_add_u32 m0, s33, 28544
    s_nop 0
    buffer_load_dwordx4 v22, s[44:47], s77 offen offset:128 lds
    s_add_u32 m0, s33, 32768
    s_nop 0
    buffer_load_dwordx4 v9, s[48:51], s77 offen lds
    v_add_f32 v72, v72, v45
    v_add_f32 v74, v74, v61
    v_add_f32 v72, v72, v46
    v_add_f32 v74, v74, v62
    v_add_f32 v72, v72, v47
    v_add_f32 v74, v74, v63
    v_add_f32 v72, v72, v48
    v_add_f32 v74, v74, v64
    s_load_dword s94, s[88:89], s76 offset:4096
    s_load_dword s94, s[88:89], s76 offset:4160
    s_load_dword s94, s[88:89], s76 offset:6144
    s_load_dword s94, s[88:89], s76 offset:6208
    s_waitcnt vmcnt(15)
    s_barrier
    s_add_u32 m0, s79, 98304
    s_add_u32 s72, s72, 128
    s_and_b32 s78, s72, 0x7ff
    buffer_load_dwordx4 v20, s[36:39], s78 offen lds
    v_add_f32 v72, v72, v49
    v_add_f32 v74, v74, v65
    v_add_f32 v72, v72, v50
    v_add_f32 v74, v74, v66
    v_add_f32 v72, v72, v51
    v_add_f32 v74, v74, v67
    v_add_f32 v72, v72, v52
    v_add_f32 v74, v74, v68
    s_add_u32 m0, s79, 99328
    s_nop 0
    buffer_load_dwordx4 v21, s[36:39], s78 offen lds
    v_add_f32 v72, v72, v53
    v_add_f32 v74, v74, v69
    v_add_f32 v72, v72, v54
    v_add_f32 v74, v74, v70
    v_add_f32 v72, v72, v55
    v_add_f32 v74, v74, v71
    s_nop 0
    v_add_f32_dpp v72, v72, v72 quad_perm:[1,0,3,2] row_mask:0xf bank_mask:0xf
    v_add_f32_dpp v74, v74, v74 quad_perm:[1,0,3,2] row_mask:0xf bank_mask:0xf
    s_add_u32 m0, s33, 36864
    s_add_u32 s77, s77, 229376
    buffer_load_dwordx4 v22, s[40:43], s77 offen offset:0 lds
    s_nop 0
    v_add_f32_dpp v72, v72, v72 quad_perm:[2,3,0,1] row_mask:0xf bank_mask:0xf
    v_add_f32_dpp v74, v74, v74 quad_perm:[2,3,0,1] row_mask:0xf bank_mask:0xf
    s_nop 0
    v_add_f32_dpp v72, v72, v72 row_half_mirror row_mask:0xf bank_mask:0xf
    v_add_f32_dpp v74, v74, v74 row_half_mirror row_mask:0xf bank_mask:0xf
    s_nop 0
    v_add_f32_dpp v72, v72, v72 row_mirror row_mask:0xf bank_mask:0xf
    v_add_f32_dpp v74, v74, v74 row_mirror row_mask:0xf bank_mask:0xf
    v_mov_b32 v78, v72
    s_add_u32 m0, s33, 40832
    s_nop 0
    buffer_load_dwordx4 v22, s[40:43], s77 offen offset:128 lds
    v_mov_b32 v79, v74
    s_nop 0
    v_permlane16_swap_b32 v72, v78
    v_permlane16_swap_b32 v74, v79
    v_add_f32 v72, v72, v78
    v_add_f32 v74, v74, v79
    v_mov_b32 v78, v72
    v_mov_b32 v79, v74
    s_nop 0
    v_permlane32_swap_b32 v72, v78
    s_add_u32 m0, s33, 45056
    s_nop 0
    buffer_load_dwordx4 v22, s[44:47], s77 offen offset:0 lds
    s_add_u32 m0, s33, 49024
    s_nop 0
    buffer_load_dwordx4 v22, s[44:47], s77 offen offset:128 lds
    v_permlane32_swap_b32 v74, v79
    v_add_f32 v72, v72, v78
    v_add_f32 v74, v74, v79
    v_mul_f32 v72, 0x3a800000, v72
    v_mul_f32 v74, 0x3a800000, v74
    v_sub_f32 v78, v40, v72
    v_sub_f32 v79, v56, v74
    v_mul_f32 v73, v78, v78
    s_add_u32 m0, s33, 53248
    s_nop 0
    buffer_load_dwordx4 v9, s[48:51], s77 offen lds
    v_mul_f32 v75, v79, v79
    v_sub_f32 v78, v41, v72
    v_sub_f32 v79, v57, v74
    v_fmac_f32 v73, v78, v78
    v_fmac_f32 v75, v79, v79
    v_sub_f32 v78, v42, v72
    v_sub_f32 v79, v58, v74
    v_fmac_f32 v73, v78, v78
    s_load_dword s94, s[88:89], s76 offset:8192
    s_load_dword s94, s[88:89], s76 offset:8256
    s_load_dword s94, s[88:89], s76 offset:10240
    s_load_dword s94, s[88:89], s76 offset:10304
    s_waitcnt vmcnt(15)
    s_barrier
    s_add_u32 m0, s79, 100352
    s_add_u32 s78, s78, 32768
    buffer_load_dwordx4 v20, s[36:39], s78 offen lds
    v_fmac_f32 v75, v79, v79
    v_sub_f32 v78, v43, v72
    v_sub_f32 v79, v59, v74
    v_fmac_f32 v73, v78, v78
    v_fmac_f32 v75, v79, v79
    v_sub_f32 v78, v44, v72
    v_sub_f32 v79, v60, v74
    v_fmac_f32 v73, v78, v78
    s_add_u32 m0, s79, 101376
    s_nop 0
    buffer_load_dwordx4 v21, s[36:39], s78 offen lds
    v_fmac_f32 v75, v79, v79
    v_sub_f32 v78, v45, v72
    v_sub_f32 v79, v61, v74
    v_fmac_f32 v73, v78, v78
    v_fmac_f32 v75, v79, v79
    v_sub_f32 v78, v46, v72
    v_sub_f32 v79, v62, v74
    v_fmac_f32 v73, v78, v78
    s_add_u32 m0, s33, 57344
    s_add_u32 s77, s77, 229376
    s_cmp_eq_u32 s77, 7340032
    s_cselect_b32 s77, 0, s77
    buffer_load_dwordx4 v22, s[40:43], s77 offen offset:0 lds
    v_fmac_f32 v75, v79, v79
    v_sub_f32 v78, v47, v72
    v_sub_f32 v79, v63, v74
    v_fmac_f32 v73, v78, v78
    v_fmac_f32 v75, v79, v79
    v_sub_f32 v78, v48, v72
    v_sub_f32 v79, v64, v74
    v_fmac_f32 v73, v78, v78
    s_add_u32 m0, s33, 61312
    s_nop 0
    buffer_load_dwordx4 v22, s[40:43], s77 offen offset:128 lds
    v_fmac_f32 v75, v79, v79
    v_sub_f32 v78, v49, v72
    v_sub_f32 v79, v65, v74
    v_fmac_f32 v73, v78, v78
    v_fmac_f32 v75, v79, v79
    v_sub_f32 v78, v50, v72
    v_sub_f32 v79, v66, v74
    v_fmac_f32 v73, v78, v78
    s_add_u32 m0, s33, 65536
    s_nop 0
    buffer_load_dwordx4 v22, s[44:47], s77 offen offset:0 lds
    v_fmac_f32 v75, v79, v79
    v_sub_f32 v78, v51, v72
    v_sub_f32 v79, v67, v74
    v_fmac_f32 v73, v78, v78
    v_fmac_f32 v75, v79, v79
    v_sub_f32 v78, v52, v72
    v_sub_f32 v79, v68, v74
    v_fmac_f32 v73, v78, v78
    s_add_u32 m0, s33, 69504
    s_nop 0
    buffer_load_dwordx4 v22, s[44:47], s77 offen offset:128 lds
    s_add_u32 m0, s33, 73728
    s_nop 0
    buffer_load_dwordx4 v9, s[48:51], s77 offen lds
    v_fmac_f32 v75, v79, v79
    v_sub_f32 v78, v53, v72
    v_sub_f32 v79, v69, v74
    v_fmac_f32 v73, v78, v78
    v_fmac_f32 v75, v79, v79
    v_sub_f32 v78, v54, v72
    v_sub_f32 v79, v70, v74
    v_fmac_f32 v73, v78, v78
    s_load_dword s94, s[88:89], s76 offset:12288
    s_load_dword s94, s[88:89], s76 offset:12352
    s_load_dword s94, s[88:89], s76 offset:14336
    s_load_dword s94, s[88:89], s76 offset:14400
    s_waitcnt vmcnt(14)
    s_barrier
    s_add_u32 m0, s79, 116736
    s_add_u32 s72, s72, 128
    s_and_b32 s78, s72, 0x7ff
    buffer_load_dwordx4 v20, s[36:39], s78 offen lds
    v_fmac_f32 v75, v79, v79
    v_sub_f32 v78, v55, v72
    v_sub_f32 v79, v71, v74
    v_fmac_f32 v73, v78, v78
    v_fmac_f32 v75, v79, v79
    s_nop 0
    v_add_f32_dpp v73, v73, v73 quad_perm:[1,0,3,2] row_mask:0xf bank_mask:0xf
    v_add_f32_dpp v75, v75, v75 quad_perm:[1,0,3,2] row_mask:0xf bank_mask:0xf
    s_nop 0
    v_add_f32_dpp v73, v73, v73 quad_perm:[2,3,0,1] row_mask:0xf bank_mask:0xf
    s_add_u32 m0, s79, 117760
    s_nop 0
    buffer_load_dwordx4 v21, s[36:39], s78 offen lds
    v_add_f32_dpp v75, v75, v75 quad_perm:[2,3,0,1] row_mask:0xf bank_mask:0xf
    s_nop 0
    v_add_f32_dpp v73, v73, v73 row_half_mirror row_mask:0xf bank_mask:0xf
    v_add_f32_dpp v75, v75, v75 row_half_mirror row_mask:0xf bank_mask:0xf
    s_nop 0
    v_add_f32_dpp v73, v73, v73 row_mirror row_mask:0xf bank_mask:0xf
    v_add_f32_dpp v75, v75, v75 row_mirror row_mask:0xf bank_mask:0xf
    v_mov_b32 v78, v73
    v_mov_b32 v79, v75
    s_add_u32 m0, s33, 77824
    s_add_u32 s77, s77, 229376
    buffer_load_dwordx4 v22, s[40:43], s77 offen offset:0 lds
    s_nop 0
    v_permlane16_swap_b32 v73, v78
    v_permlane16_swap_b32 v75, v79
L_pad6:
    s_cbranch_execz L_vret0
    v_add_f32 v73, v73, v78
    v_add_f32 v75, v75, v79
    v_mov_b32 v78, v73
    v_mov_b32 v79, v75
    s_nop 0
    v_permlane32_swap_b32 v73, v78
    s_add_u32 m0, s33, 81792
    s_nop 0
    buffer_load_dwordx4 v22, s[40:43], s77 offen offset:128 lds
    v_permlane32_swap_b32 v75, v79
    v_add_f32 v73, v73, v78
    v_add_f32 v75, v75, v79
    v_mul_f32 v73, 0x3a800000, v73
    v_mul_f32 v75, 0x3a800000, v75
    v_cvt_pk_bf16_f32 v72, v72, v72
    v_lshlrev_b32 v72, 16, v72
    v_cvt_pk_bf16_f32 v73, v73, v73
    s_add_u32 m0, s33, 86016
    s_nop 0
    buffer_load_dwordx4 v22, s[44:47], s77 offen offset:0 lds
    s_add_u32 m0, s33, 89984
    s_nop 0
    buffer_load_dwordx4 v22, s[44:47], s77 offen offset:128 lds
    v_lshlrev_b32 v73, 16, v73
    v_add_f32 v73, 0x3727c5ac, v73
    v_cvt_pk_bf16_f32 v73, v73, v73
    v_lshlrev_b32 v73, 16, v73
    v_sqrt_f32 v73, v73
    v_cvt_pk_bf16_f32 v74, v74, v74
    v_lshlrev_b32 v74, 16, v74
    s_add_u32 m0, s33, 94208
    s_nop 0
    buffer_load_dwordx4 v9, s[48:51], s77 offen lds
    v_cvt_pk_bf16_f32 v75, v75, v75
    v_lshlrev_b32 v75, 16, v75
    v_add_f32 v75, 0x3727c5ac, v75
    v_cvt_pk_bf16_f32 v75, v75, v75
    v_lshlrev_b32 v75, 16, v75
    v_sqrt_f32 v75, v75
    s_nop 0
    v_cvt_pk_bf16_f32 v73, v73, v73
    s_load_dword s94, s[88:89], s76 offset:16384
    s_load_dword s94, s[88:89], s76 offset:16448
    s_load_dword s94, s[88:89], s76 offset:18432
    s_load_dword s94, s[88:89], s76 offset:18496
    s_waitcnt vmcnt(14)
    s_barrier
    s_add_u32 m0, s79, 118784
    s_add_u32 s78, s78, 32768
    buffer_load_dwordx4 v20, s[36:39], s78 offen lds
    v_lshlrev_b32 v73, 16, v73
    v_rcp_f32 v76, v73
    s_nop 0
    v_cvt_pk_bf16_f32 v75, v75, v75
    v_lshlrev_b32 v75, 16, v75
    v_rcp_f32 v77, v75
    s_nop 0
    v_fma_f32 v78, -v73, v76, 1.0
    s_add_u32 m0, s79, 119808
    s_nop 0
    buffer_load_dwordx4 v21, s[36:39], s78 offen lds
    v_fma_f32 v76, v78, v76, v76
    s_nop 0
    v_fma_f32 v79, -v75, v77, 1.0
    v_fma_f32 v77, v79, v77, v77
    v_sub_f32 v80, v40, v72
    v_sub_f32 v81, v41, v72
    v_cvt_pk_bf16_f32 v80, v80, v81
    v_and_b32 v81, 0xffff0000, v80
    v_lshlrev_b32 v80, 16, v80
    s_add_u32 m0, s33, 16384
    s_add_u32 s77, s77, 229376
    s_cmp_eq_u32 s77, 7340032
    s_cselect_b32 s77, 0, s77
    buffer_load_dwordx4 v22, s[40:43], s77 offen offset:0 lds
    v_mul_f32 v80, v80, v76
    v_mul_f32 v81, v81, v76
    v_cvt_pk_bf16_f32 v24, v80, v81
    v_sub_f32 v80, v42, v72
    v_sub_f32 v81, v43, v72
    v_cvt_pk_bf16_f32 v80, v80, v81
    v_and_b32 v81, 0xffff0000, v80
    v_lshlrev_b32 v80, 16, v80
    s_add_u32 m0, s33, 20352
    s_nop 0
    buffer_load_dwordx4 v22, s[40:43], s77 offen offset:128 lds
    v_mul_f32 v80, v80, v76
    v_mul_f32 v81, v81, v76
    v_cvt_pk_bf16_f32 v25, v80, v81
    v_sub_f32 v80, v44, v72
    v_sub_f32 v81, v45, v72
    v_cvt_pk_bf16_f32 v80, v80, v81
    v_and_b32 v81, 0xffff0000, v80
    v_lshlrev_b32 v80, 16, v80
    s_add_u32 m0, s33, 24576
    s_nop 0
    buffer_load_dwordx4 v22, s[44:47], s77 offen offset:0 lds
    s_add_u32 m0, s33, 28544
    s_nop 0
    buffer_load_dwordx4 v22, s[44:47], s77 offen offset:128 lds
    v_mul_f32 v80, v80, v76
    v_mul_f32 v81, v81, v76
    v_cvt_pk_bf16_f32 v26, v80, v81
    v_sub_f32 v80, v46, v72
    v_sub_f32 v81, v47, v72
    v_cvt_pk_bf16_f32 v80, v80, v81
    v_and_b32 v81, 0xffff0000, v80
    v_lshlrev_b32 v80, 16, v80
    s_add_u32 m0, s33, 32768
    s_nop 0
    buffer_load_dwordx4 v9, s[48:51], s77 offen lds
    v_mul_f32 v80, v80, v76
    v_mul_f32 v81, v81, v76
    v_cvt_pk_bf16_f32 v27, v80, v81
    v_sub_f32 v80, v48, v72
    v_sub_f32 v81, v49, v72
    v_cvt_pk_bf16_f32 v80, v80, v81
    v_and_b32 v81, 0xffff0000, v80
    v_lshlrev_b32 v80, 16, v80
    s_load_dword s94, s[88:89], s76 offset:20480
    s_load_dword s94, s[88:89], s76 offset:20544
    s_load_dword s94, s[88:89], s76 offset:22528
    s_load_dword s94, s[88:89], s76 offset:22592
    s_waitcnt vmcnt(14)
    s_barrier
    s_add_u32 m0, s79, 135168
    s_add_u32 s72, s72, 128
    s_and_b32 s78, s72, 0x7ff
    buffer_load_dwordx4 v20, s[36:39], s78 offen lds
    v_mul_f32 v80, v80, v76
    v_mul_f32 v81, v81, v76
    v_cvt_pk_bf16_f32 v28, v80, v81
    v_sub_f32 v80, v50, v72
    v_sub_f32 v81, v51, v72
    v_cvt_pk_bf16_f32 v80, v80, v81
    v_and_b32 v81, 0xffff0000, v80
    v_lshlrev_b32 v80, 16, v80
    s_add_u32 m0, s79, 136192
    s_nop 0
    buffer_load_dwordx4 v21, s[36:39], s78 offen lds
    v_mul_f32 v80, v80, v76
    v_mul_f32 v81, v81, v76
    v_cvt_pk_bf16_f32 v29, v80, v81
    v_sub_f32 v80, v52, v72
    v_sub_f32 v81, v53, v72
    v_cvt_pk_bf16_f32 v80, v80, v81
    v_and_b32 v81, 0xffff0000, v80
    v_lshlrev_b32 v80, 16, v80
    s_add_u32 m0, s33, 36864
    s_add_u32 s77, s77, 229376
    buffer_load_dwordx4 v22, s[40:43], s77 offen offset:0 lds
    v_mul_f32 v80, v80, v76
    v_mul_f32 v81, v81, v76
    v_cvt_pk_bf16_f32 v30, v80, v81
    v_sub_f32 v80, v54, v72
    v_sub_f32 v81, v55, v72
    v_cvt_pk_bf16_f32 v80, v80, v81
    v_and_b32 v81, 0xffff0000, v80
    v_lshlrev_b32 v80, 16, v80
    s_add_u32 m0, s33, 40832
    s_nop 0
    buffer_load_dwordx4 v22, s[40:43], s77 offen offset:128 lds
    v_mul_f32 v80, v80, v76
    v_mul_f32 v81, v81, v76
    v_cvt_pk_bf16_f32 v31, v80, v81
    v_sub_f32 v80, v56, v74
    v_sub_f32 v81, v57, v74
    v_cvt_pk_bf16_f32 v80, v80, v81
    v_and_b32 v81, 0xffff0000, v80
    v_lshlrev_b32 v80, 16, v80
    s_add_u32 m0, s33, 45056
    s_nop 0
    buffer_load_dwordx4 v22, s[44:47], s77 offen offset:0 lds
    v_mul_f32 v80, v80, v77
    v_mul_f32 v81, v81, v77
    v_cvt_pk_bf16_f32 v32, v80, v81
    v_sub_f32 v80, v58, v74
    v_sub_f32 v81, v59, v74
    v_cvt_pk_bf16_f32 v80, v80, v81
    v_and_b32 v81, 0xffff0000, v80
    v_lshlrev_b32 v80, 16, v80
    s_add_u32 m0, s33, 49024
    s_nop 0
    buffer_load_dwordx4 v22, s[44:47], s77 offen offset:128 lds
    s_add_u32 m0, s33, 53248
    s_nop 0
    buffer_load_dwordx4 v9, s[48:51], s77 offen lds
    v_mul_f32 v80, v80, v77
    v_mul_f32 v81, v81, v77
    v_cvt_pk_bf16_f32 v33, v80, v81
    v_sub_f32 v80, v60, v74
    v_sub_f32 v81, v61, v74
    v_cvt_pk_bf16_f32 v80, v80, v81
    v_and_b32 v81, 0xffff0000, v80
    v_lshlrev_b32 v80, 16, v80
    s_load_dword s94, s[88:89], s76 offset:24576
    s_load_dword s94, s[88:89], s76 offset:24640
    s_load_dword s94, s[88:89], s76 offset:26624
    s_load_dword s94, s[88:89], s76 offset:26688
    s_waitcnt vmcnt(14)
    s_barrier
    s_add_u32 m0, s79, 137216
    s_add_u32 s78, s78, 32768
    buffer_load_dwordx4 v20, s[36:39], s78 offen lds
    v_mul_f32 v80, v80, v77
    v_mul_f32 v81, v81, v77
    v_cvt_pk_bf16_f32 v34, v80, v81
    v_sub_f32 v80, v62, v74
    v_sub_f32 v81, v63, v74
    v_cvt_pk_bf16_f32 v80, v80, v81
    v_and_b32 v81, 0xffff0000, v80
    v_lshlrev_b32 v80, 16, v80
    s_add_u32 m0, s79, 138240
    s_nop 0
    buffer_load_dwordx4 v21, s[36:39], s78 offen lds
    v_mul_f32 v80, v80, v77
    v_mul_f32 v81, v81, v77
    v_cvt_pk_bf16_f32 v35, v80, v81
    v_sub_f32 v80, v64, v74
    v_sub_f32 v81, v65, v74
    v_cvt_pk_bf16_f32 v80, v80, v81
    v_and_b32 v81, 0xffff0000, v80
    v_lshlrev_b32 v80, 16, v80
    s_add_u32 m0, s33, 57344
    s_add_u32 s77, s77, 229376
    s_cmp_eq_u32 s77, 7340032
    s_cselect_b32 s77, 0, s77
    buffer_load_dwordx4 v22, s[40:43], s77 offen offset:0 lds
    v_mul_f32 v80, v80, v77
    v_mul_f32 v81, v81, v77
    v_cvt_pk_bf16_f32 v36, v80, v81
    v_sub_f32 v80, v66, v74
    v_sub_f32 v81, v67, v74
    v_cvt_pk_bf16_f32 v80, v80, v81
    v_and_b32 v81, 0xffff0000, v80
    v_lshlrev_b32 v80, 16, v80
    s_add_u32 m0, s33, 61312
    s_nop 0
    buffer_load_dwordx4 v22, s[40:43], s77 offen offset:128 lds
    v_mul_f32 v80, v80, v77
    v_mul_f32 v81, v81, v77
    v_cvt_pk_bf16_f32 v37, v80, v81
    v_sub_f32 v80, v68, v74
    v_sub_f32 v81, v69, v74
    v_cvt_pk_bf16_f32 v80, v80, v81
    v_and_b32 v81, 0xffff0000, v80
    v_lshlrev_b32 v80, 16, v80
    s_add_u32 m0, s33, 65536
    s_nop 0
    buffer_load_dwordx4 v22, s[44:47], s77 offen offset:0 lds
    v_mul_f32 v80, v80, v77
    v_mul_f32 v81, v81, v77
    v_cvt_pk_bf16_f32 v38, v80, v81
    v_sub_f32 v80, v70, v74
    v_sub_f32 v81, v71, v74
    v_cvt_pk_bf16_f32 v80, v80, v81
    v_and_b32 v81, 0xffff0000, v80
    v_lshlrev_b32 v80, 16, v80
    s_add_u32 m0, s33, 69504
    s_nop 0
    buffer_load_dwordx4 v22, s[44:47], s77 offen offset:128 lds
    s_add_u32 m0, s33, 73728
    s_nop 0
    buffer_load_dwordx4 v9, s[48:51], s77 offen lds
    v_mul_f32 v80, v80, v77
    v_mul_f32 v81, v81, v77
    v_cvt_pk_bf16_f32 v39, v80, v81
    s_add_u32 s90, s90, 0x1e00000
    v_mov_b32 v7, s90
    s_mov_b64 exec, 1
    global_store_dwordx4 v7, v[72:75], s[26:27] sc1
    s_mov_b64 exec, -1
    v_lshrrev_b32 v64, 4, v1
    v_bfe_u32 v65, v1, 2, 2
    v_and_b32 v66, 3, v1
    v_and_b32 v67, 15, v1
    v_lshrrev_b32 v68, 3, v1
    v_and_b32 v69, 7, v1
    s_lshl_b32 s85, s6, 2
    s_lshl_b32 s86, s5, 1
    s_or_b32 s85, s85, s86
    v_lshl_add_u32 v70, v64, 3, v65
    v_lshlrev_b32 v70, 7, v70
    global_store_dwordx4 v86, v[24:27], s[26:27] offset:0 sc1
    s_load_dword s94, s[88:89], s76 offset:28672
    s_load_dword s94, s[88:89], s76 offset:28736
    s_load_dword s94, s[88:89], s76 offset:30720
    s_load_dword s94, s[88:89], s76 offset:30784
    s_waitcnt vmcnt(16)
    s_barrier
    s_add_u32 m0, s79, 98304
    s_add_u32 s72, s72, 128
    s_and_b32 s78, s72, 0x7ff
    buffer_load_dwordx4 v20, s[36:39], s78 offen lds
    v_and_b32 v71, 1, v66
    v_lshl_add_u32 v70, v71, 3, v70
    v_add_u32 v70, 16384, v70
    v_and_b32 v71, 2, v65
    v_and_b32 v72, 1, v64
    v_lshl_add_u32 v71, v72, 2, v71
    v_lshrrev_b32 v72, 1, v66
    v_xor_b32 v71, v71, v72
    s_add_u32 m0, s79, 99328
    s_nop 0
    buffer_load_dwordx4 v21, s[36:39], s78 offen lds
    v_xor_b32 v71, s85, v71
    v_xor_b32 v72, 0, v71
    v_lshl_add_u32 v4, v72, 4, v70
    v_add_u32 v6, 40960, v4
    v_xor_b32 v72, 2, v71
    v_lshl_add_u32 v5, v72, 4, v70
    v_add_u32 v7, 40960, v5
    v_lshrrev_b32 v70, 1, v67
    s_add_u32 m0, s33, 77824
    s_add_u32 s77, s77, 229376
    buffer_load_dwordx4 v22, s[40:43], s77 offen offset:0 lds
    v_xor_b32 v70, v70, v64
    v_lshlrev_b32 v70, 4, v70
    v_lshl_add_u32 v70, v67, 7, v70
    s_lshl_b32 s85, s5, 13
    v_add_u32 v16, s85, v70
    v_xor_b32 v17, 64, v16
    s_sub_u32 s95, 16384, s85
    s_mov_b32 s80, 135168
    s_lshl_b32 s86, s28, 7
    s_sub_u32 s86, s86, 16
    s_max_i32 s86, s86, 0
    s_lshl_b32 s87, s4, 2
    v_add_u32 v71, s87, v68
    s_add_u32 m0, s33, 81792
    s_nop 0
    buffer_load_dwordx4 v22, s[40:43], s77 offen offset:128 lds
    v_lshrrev_b32 v70, 1, v71
    v_and_b32 v70, 7, v70
    v_xor_b32 v70, v70, v69
    v_lshlrev_b32 v70, 4, v70
    v_add_u32 v71, s86, v71
    v_lshl_add_u32 v3, v71, 11, v70
    s_lshl_b32 s81, s4, 9
    s_lshl_b32 s85, s4, 3
    s_and_b32 s86, s4, 1
    s_lshl_b32 s86, s86, 2
    v_and_b32 v70, 2, v68
    s_add_u32 m0, s33, 86016
    s_nop 0
    buffer_load_dwordx4 v22, s[44:47], s77 offen offset:0 lds
    v_xor_b32 v70, v70, v69
    v_xor_b32 v70, s86, v70
    v_add_u32 v71, s85, v68
    v_mul_u32_u24 v71, 6144, v71
    v_lshl_add_u32 v23, v70, 4, v71
    s_lshl_b32 s85, s4, 12
    v_lshl_add_u32 v10, v1, 4, s85
    s_lshl_b32 s85, s4, 4
    v_and_b32 v70, 2, v68
    v_xor_b32 v70, v70, v69
    s_add_u32 m0, s33, 89984
    s_nop 0
    buffer_load_dwordx4 v22, s[44:47], s77 offen offset:128 lds
    s_add_u32 m0, s33, 94208
    s_nop 0
    buffer_load_dwordx4 v9, s[48:51], s77 offen lds
    v_xor_b32 v70, 0, v70
    v_add_u32 v71, s85, v68
    v_mul_u32_u24 v71, 2048, v71
    v_lshl_add_u32 v11, v70, 4, v71
    s_add_u32 s85, s85, 8
    v_and_b32 v70, 2, v68
    v_xor_b32 v70, v70, v69
    v_xor_b32 v70, 4, v70
    v_add_u32 v71, s85, v68
    s_load_dword s94, s[10:11], s52 offset:0x0
    s_load_dword s94, s[10:11], s52 offset:0x40
    s_load_dword s94, s[10:11], s52 offset:0x80
    s_load_dword s94, s[10:11], s52 offset:0xc0
    s_load_dword s94, s[10:11], s52 offset:0x100
    global_store_dwordx4 v86, v[28:31], s[26:27] offset:1024 sc1
    v_mov_b32 v87, 0
    s_mov_b64 exec, 1
    global_load_dwordx2 v[18:19], v87, s[24:25] sc1
    s_mov_b64 exec, -1
    s_waitcnt vmcnt(18)
    s_barrier
    s_add_u32 m0, s79, 100352
    s_add_u32 s78, s78, 32768
    buffer_load_dwordx4 v20, s[36:39], s78 offen lds
    v_mul_u32_u24 v71, 2048, v71
    v_lshl_add_u32 v12, v70, 4, v71
    s_lshl_b32 s85, s31, 8
    s_lshl_b32 s86, s32, 7
    s_add_u32 s86, s85, s86
    s_xor_b32 s87, s86, 128
    s_lshr_b32 s91, s31, 2
    s_lshl1_add_u32 s91, s91, s32
    s_lshl_b32 s91, s91, 13
    s_add_u32 s91, s91, 0x2000000
    s_xor_b32 s85, s91, 8192
    s_and_b32 s92, s31, 3
    s_cmp_eq_u32 s92, 1
    s_cselect_b32 s86, s91, s86
    s_cselect_b32 s87, s85, s87
    s_cselect_b32 s91, 0x2a00000, 0
    s_cselect_b32 s92, s26, s20
    s_cselect_b32 s93, s27, s21
    s_max_u32 s91, s91, 7340032
    s_add_u32 s60, s92, s86
    s_addc_u32 s61, s93, 0
    s_sub_u32 s62, s91, s86
    s_mov_b32 s63, 0x20000
    s_add_u32 m0, s79, 101376
    s_nop 0
    buffer_load_dwordx4 v21, s[36:39], s78 offen lds
    s_add_u32 s64, s92, s87
    s_addc_u32 s65, s93, 0
    s_sub_u32 s66, s91, s87
    s_mov_b32 s67, 0x20000
    s_add_u32 s56, s26, 0x400000
    s_addc_u32 s57, s27, 0
    s_mov_b32 s58, 0xe00000
    s_mov_b32 s59, 0x20000
    s_mul_i32 s82, s30, 917504
    s_mul_i32 s85, s32, 327680
    s_add_u32 s82, s82, s85
    s_mul_i32 s83, s32, 2621440
    s_mul_i32 s85, s32, 10
    s_sub_u32 s85, 40, s85
    s_lshl_b32 s14, s85, 13
    s_lshl_b32 s35, s85, 16
    s_add_u32 s83, s83, 1441792
    s_add_u32 s82, s82, 196608
    s_lshl_b32 s84, s30, 7
    s_lshl_b32 s85, s5, 6
    s_add_u32 s84, s84, s85
    s_lshl_b32 s84, s84, 11
    s_lshl_b32 s85, s31, 8
    s_add_u32 s84, s84, s85
    s_lshl_b32 s85, s32, 7
    s_add_u32 s84, s84, s85
    s_lshl_b32 s85, s6, 6
    s_add_u32 m0, s33, 16384
    s_add_u32 s77, s77, 229376
    s_cmp_eq_u32 s77, 7340032
    s_cselect_b32 s77, 0, s77
    buffer_load_dwordx4 v22, s[40:43], s77 offen offset:0 lds
    s_add_u32 s84, s84, s85
    v_lshrrev_b32 v70, 2, v1
    v_lshl_add_u32 v71, v66, 4, s84
    v_lshl_add_u32 v13, v70, 11, v71
    v_lshrrev_b32 v72, 4, v1
    v_and_b32 v73, 15, v1
    v_and_b32 v74, 1, v72
    v_xor_b32 v74, s5, v74
    v_lshrrev_b32 v75, 1, v72
    s_add_u32 m0, s33, 20352
    s_nop 0
    buffer_load_dwordx4 v22, s[40:43], s77 offen offset:128 lds
    v_lshl_add_u32 v74, v74, 1, v75
    v_lshlrev_b32 v74, 8, v74
    v_lshl_add_u32 v0, v73, 4, v74
    v_lshrrev_b32 v72, 4, v1
    v_and_b32 v73, 1, v72
    v_lshrrev_b32 v72, 1, v72
    v_lshlrev_b32 v72, 8, v72
    v_lshl_add_u32 v72, v73, 10, v72
    s_add_u32 m0, s33, 24576
    s_nop 0
    buffer_load_dwordx4 v22, s[44:47], s77 offen offset:0 lds
    v_and_b32 v73, 15, v1
    v_lshl_add_u32 v8, v73, 4, v72
    s_mov_b32 s54, 7332992
    s_mov_b32 s55, 0x20000
    s_mul_i32 s84, s6, 3072
    s_add_u32 s84, s84, 153600
    v_lshl_add_u32 v85, v1, 3, s84
    s_mul_i32 s84, s28, 112
    s_lshl1_add_u32 s85, s29, s6
    s_add_u32 s86, s85, 2
    s_and_b32 s86, s86, 31
    s_add_u32 s84, s84, s86
    s_add_u32 s84, s84, 80
    s_lshl_b32 s84, s84, 13
    s_lshl_b32 s86, s5, 12
    s_add_u32 s84, s84, s86
    s_add_u32 s84, s84, 0x400000
    s_lshl_b32 s87, s5, 9
    s_add_u32 s73, s84, s87
    s_xor_b32 s87, s87, 512
    s_add_u32 m0, s33, 28544
    s_nop 0
    buffer_load_dwordx4 v22, s[44:47], s77 offen offset:128 lds
    s_add_u32 m0, s33, 32768
    s_nop 0
    buffer_load_dwordx4 v9, s[48:51], s77 offen lds
    s_add_u32 s74, s84, s87
    s_lshl_b32 s84, s28, 5
    s_add_u32 s84, s84, s85
    s_lshl_b32 s84, s84, 13
    s_add_u32 s84, s84, s86
    s_add_u32 s75, s84, 0x1200000
    v_mov_b32 v84, 0xc0135761
    v_mov_b32 v152, 0
    v_mov_b32 v153, 0
    v_mov_b32 v154, 0
    v_mov_b32 v155, 0
    v_mov_b32 v156, 0
    v_mov_b32 v157, 0
    s_load_dword s94, s[10:11], s52 offset:0x140
    s_load_dword s94, s[10:11], s52 offset:0x180
    s_load_dword s94, s[10:11], s52 offset:0x1c0
    s_load_dword s94, s[16:17], s53 offset:0x0
    s_load_dword s94, s[16:17], s53 offset:0x40
    global_store_dwordx4 v86, v[32:35], s[26:27] offset:2048 sc1
    s_waitcnt vmcnt(19)
    s_barrier
    s_add_u32 m0, s79, 116736
    s_add_u32 s72, s72, 128
    s_and_b32 s78, s72, 0x7ff
    buffer_load_dwordx4 v20, s[36:39], s78 offen lds
    v_mov_b32 v158, 0
    v_mov_b32 v159, 0
    v_mov_b32 v160, 0
    v_mov_b32 v161, 0
    v_mov_b32 v162, 0
    v_mov_b32 v163, 0
    v_mov_b32 v164, 0
    v_mov_b32 v165, 0
    s_add_u32 m0, s79, 117760
    s_nop 0
    buffer_load_dwordx4 v21, s[36:39], s78 offen lds
    v_mov_b32 v166, 0
    v_mov_b32 v167, 0
    v_mov_b32 v168, 0
    v_mov_b32 v169, 0
    v_mov_b32 v170, 0
    v_mov_b32 v171, 0
    v_mov_b32 v172, 0
    v_mov_b32 v173, 0
    s_add_u32 m0, s33, 36864
    s_add_u32 s77, s77, 229376
    buffer_load_dwordx4 v22, s[40:43], s77 offen offset:0 lds
    v_mov_b32 v174, 0
    v_mov_b32 v175, 0
    v_mov_b32 v176, 0
    v_mov_b32 v177, 0
    v_mov_b32 v178, 0
    v_mov_b32 v179, 0
    v_mov_b32 v180, 0
    v_mov_b32 v181, 0
    s_add_u32 m0, s33, 40832
    s_nop 0
    buffer_load_dwordx4 v22, s[40:43], s77 offen offset:128 lds
    v_mov_b32 v182, 0
    v_mov_b32 v183, 0
    v_mov_b32 v184, 0
    v_mov_b32 v185, 0
    v_mov_b32 v186, 0
    v_mov_b32 v187, 0
    v_mov_b32 v188, 0
    v_mov_b32 v189, 0
    s_add_u32 m0, s33, 45056
    s_nop 0
    buffer_load_dwordx4 v22, s[44:47], s77 offen offset:0 lds
    v_mov_b32 v190, 0
    v_mov_b32 v191, 0
    v_mov_b32 v192, 0
    v_mov_b32 v193, 0
    v_mov_b32 v194, 0
    v_mov_b32 v195, 0
    v_mov_b32 v196, 0
    v_mov_b32 v197, 0
    s_add_u32 m0, s33, 49024
    s_nop 0
    buffer_load_dwordx4 v22, s[44:47], s77 offen offset:128 lds
    s_add_u32 m0, s33, 53248
    s_nop 0
    buffer_load_dwordx4 v9, s[48:51], s77 offen lds
    v_mov_b32 v198, 0
    v_mov_b32 v199, 0
    v_mov_b32 v200, 0
    v_mov_b32 v201, 0
    v_mov_b32 v202, 0
    v_mov_b32 v203, 0
    v_mov_b32 v204, 0
    v_mov_b32 v205, 0
    s_load_dword s94, s[16:17], s53 offset:0x80
    s_load_dword s94, s[16:17], s53 offset:0xc0
    s_load_dword s94, s[16:17], s53 offset:0x100
    s_load_dword s94, s[16:17], s53 offset:0x140
    s_load_dword s94, s[16:17], s53 offset:0x180
    global_store_dwordx4 v86, v[36:39], s[26:27] offset:3072 sc1
    s_waitcnt vmcnt(18)
    s_barrier
    s_add_u32 m0, s79, 118784
    s_add_u32 s78, s78, 32768
    buffer_load_dwordx4 v20, s[36:39], s78 offen lds
    v_mov_b32 v206, 0
    v_mov_b32 v207, 0
    v_mov_b32 v208, 0
    v_mov_b32 v209, 0
    v_mov_b32 v210, 0
    v_mov_b32 v211, 0
    v_mov_b32 v212, 0
    v_mov_b32 v213, 0
    s_add_u32 m0, s79, 119808
    s_nop 0
    buffer_load_dwordx4 v21, s[36:39], s78 offen lds
    v_mov_b32 v214, 0
    v_mov_b32 v215, 0
    v_mov_b32 v216, 0
    v_mov_b32 v217, 0
    v_mov_b32 v218, 0
    v_mov_b32 v219, 0
    v_mov_b32 v220, 0
    v_mov_b32 v221, 0
    s_add_u32 m0, s33, 57344
    s_add_u32 s77, s77, 229376
    s_cmp_eq_u32 s77, 7340032
    s_cselect_b32 s77, 0, s77
    buffer_load_dwordx4 v22, s[40:43], s77 offen offset:0 lds
    v_mov_b32 v222, 0
    v_mov_b32 v223, 0
    v_mov_b32 v224, 0
    v_mov_b32 v225, 0
    v_mov_b32 v226, 0
    v_mov_b32 v227, 0
    v_mov_b32 v228, 0
    v_mov_b32 v229, 0
    s_add_u32 m0, s33, 61312
    s_nop 0
    buffer_load_dwordx4 v22, s[40:43], s77 offen offset:128 lds
    v_mov_b32 v230, 0
    v_mov_b32 v231, 0
    v_mov_b32 v232, 0
    v_mov_b32 v233, 0
    v_mov_b32 v234, 0
    v_mov_b32 v235, 0
    v_mov_b32 v236, 0
    v_mov_b32 v237, 0
    s_add_u32 m0, s33, 65536
    s_nop 0
    buffer_load_dwordx4 v22, s[44:47], s77 offen offset:0 lds
    v_mov_b32 v238, 0
    v_mov_b32 v239, 0
    v_mov_b32 v240, 0
    v_mov_b32 v241, 0
    v_mov_b32 v242, 0
    v_mov_b32 v243, 0
    v_mov_b32 v244, 0
    v_mov_b32 v245, 0
    s_add_u32 m0, s33, 69504
    s_nop 0
    buffer_load_dwordx4 v22, s[44:47], s77 offen offset:128 lds
    s_add_u32 m0, s33, 73728
    s_nop 0
    buffer_load_dwordx4 v9, s[48:51], s77 offen lds
    v_mov_b32 v246, 0
    v_mov_b32 v247, 0
    v_mov_b32 v248, 0
    v_mov_b32 v249, 0
    v_mov_b32 v250, 0
    v_mov_b32 v251, 0
    v_mov_b32 v252, 0
    v_mov_b32 v253, 0
    s_load_dword s94, s[16:17], s53 offset:0x1c0
    s_load_dword s94, s[18:19], s53 offset:0x0
    s_load_dword s94, s[18:19], s53 offset:0x40
    s_load_dword s94, s[18:19], s53 offset:0x80
    s_load_dword s94, s[18:19], s53 offset:0xc0
    s_waitcnt vmcnt(16)
    s_barrier
    s_add_u32 m0, s79, 135168
    s_add_u32 s72, s72, 128
    s_and_b32 s78, s72, 0x7ff
    buffer_load_dwordx4 v20, s[36:39], s78 offen lds
    v_mov_b32 v254, 0
    v_mov_b32 v255, 0
    v_mov_b32 v112, 0
    v_mov_b32 v113, 0
    v_mov_b32 v114, 0
    v_mov_b32 v115, 0
    v_mov_b32 v116, 0
    v_mov_b32 v117, 0
    v_mov_b32 v118, 0
    v_mov_b32 v119, 0
    s_add_u32 m0, s79, 136192
    s_nop 0
    buffer_load_dwordx4 v21, s[36:39], s78 offen lds
    v_mov_b32 v120, 0
    v_mov_b32 v121, 0
    v_mov_b32 v122, 0
    v_mov_b32 v123, 0
    v_mov_b32 v124, 0
    v_mov_b32 v125, 0
    v_mov_b32 v126, 0
    v_mov_b32 v127, 0
    s_add_u32 m0, s33, 77824
    s_add_u32 s77, s77, 229376
    buffer_load_dwordx4 v22, s[40:43], s77 offen offset:0 lds
    v_mov_b32 v128, 0
    v_mov_b32 v129, 0
    v_mov_b32 v130, 0
    v_mov_b32 v131, 0
    v_mov_b32 v132, 0
    v_mov_b32 v133, 0
    v_mov_b32 v134, 0
    v_mov_b32 v135, 0
    s_add_u32 m0, s33, 81792
    s_nop 0
    buffer_load_dwordx4 v22, s[40:43], s77 offen offset:128 lds
    v_mov_b32 v136, 0
    v_mov_b32 v137, 0
    v_mov_b32 v138, 0
    v_mov_b32 v139, 0
    v_mov_b32 v140, 0
    v_mov_b32 v141, 0
    v_mov_b32 v142, 0
    v_mov_b32 v143, 0
    s_add_u32 m0, s33, 86016
    s_nop 0
    buffer_load_dwordx4 v22, s[44:47], s77 offen offset:0 lds
    s_add_u32 m0, s33, 89984
    s_nop 0
    buffer_load_dwordx4 v22, s[44:47], s77 offen offset:128 lds
L_pad7:
    s_cbranch_execz L_vret0
    v_mov_b32 v144, 0
    v_mov_b32 v145, 0
    v_mov_b32 v146, 0
    v_mov_b32 v147, 0
    v_mov_b32 v148, 0
    v_mov_b32 v149, 0
    v_mov_b32 v150, 0
    v_mov_b32 v151, 0
    s_add_u32 m0, s33, 94208
    s_nop 0
    buffer_load_dwordx4 v9, s[48:51], s77 offen lds
    s_load_dword s94, s[18:19], s53 offset:0x100
    s_load_dword s94, s[18:19], s53 offset:0x140
    s_load_dword s94, s[18:19], s53 offset:0x180
    s_load_dword s94, s[18:19], s53 offset:0x1c0
    s_load_dword s94, s[10:11], s52 offset:0x80000
    s_waitcnt vmcnt(30)
    s_movk_i32 s98, 0x4000
L_tokB_chk:
    v_readfirstlane_b32 s100, v18
    v_readfirstlane_b32 s101, v19
    s_nop 1
    s_cmp_lg_u32 s100, 0
    s_cbranch_scc1 L_tokB_ok
    s_sub_u32 s98, s98, 1
    s_cbranch_scc1 L_tokB_ok
    s_sleep 1
    global_load_dwordx2 v[18:19], v87, s[24:25] sc1
    s_waitcnt vmcnt(0)
    s_branch L_tokB_chk
L_tokB_ok:
    s_waitcnt vmcnt(14)
    s_waitcnt vmcnt(15)
    s_barrier
    s_add_u32 m0, s79, 137216
    s_add_u32 s78, s78, 32768
    buffer_load_dwordx4 v20, s[36:39], s78 offen lds
    s_add_u32 m0, s79, 138240
    s_nop 0
    buffer_load_dwordx4 v21, s[36:39], s78 offen lds
    s_add_u32 m0, s33, 16384
    s_add_u32 s77, s77, 229376
    s_cmp_eq_u32 s77, 7340032
    s_cselect_b32 s77, 0, s77
    buffer_load_dwordx4 v22, s[40:43], s77 offen offset:0 lds
    s_add_u32 m0, s33, 20352
    s_nop 0
    buffer_load_dwordx4 v22, s[40:43], s77 offen offset:128 lds
    s_add_u32 m0, s33, 24576
    s_nop 0
    buffer_load_dwordx4 v22, s[44:47], s77 offen offset:0 lds
    s_add_u32 m0, s33, 28544
    s_nop 0
    buffer_load_dwordx4 v22, s[44:47], s77 offen offset:128 lds
    s_add_u32 m0, s33, 32768
    s_nop 0
    buffer_load_dwordx4 v9, s[48:51], s77 offen lds
    s_load_dword s94, s[10:11], s52 offset:0x80040
    s_load_dword s94, s[10:11], s52 offset:0x80080
    s_load_dword s94, s[10:11], s52 offset:0x800c0
    s_load_dword s94, s[10:11], s52 offset:0x80100
    s_load_dword s94, s[10:11], s52 offset:0x80140
    s_cmp_lg_u32 s4, 0
    s_cbranch_scc1 L_fLN
    s_lshl_b32 s91, s28, 4
    s_add_u32 s91, s91, s29
    s_lshl_b32 s91, s91, 7
    s_add_u32 s91, s91, 0x1e80000
    v_mov_b32 v24, s91
    v_mov_b32 v26, s100
    v_mov_b32 v27, s101
    s_mov_b64 exec, 1
    global_store_dwordx2 v24, v[26:27], s[26:27] sc1
    s_mov_b64 exec, -1
L_fLN:
    s_waitcnt vmcnt(14)
    s_barrier
    s_add_u32 m0, s79, 98304
    s_add_u32 s72, s72, 128
    s_and_b32 s78, s72, 0x7ff
    buffer_load_dwordx4 v20, s[36:39], s78 offen lds
    s_add_u32 m0, s79, 99328
    s_nop 0
    buffer_load_dwordx4 v21, s[36:39], s78 offen lds
    s_add_u32 m0, s33, 36864
    s_add_u32 s77, s77, 229376
    buffer_load_dwordx4 v22, s[40:43], s77 offen offset:0 lds
    s_add_u32 m0, s33, 40832
    s_nop 0
    buffer_load_dwordx4 v22, s[40:43], s77 offen offset:128 lds
    s_add_u32 m0, s33, 45056
    s_nop 0
    buffer_load_dwordx4 v22, s[44:47], s77 offen offset:0 lds
    s_add_u32 m0, s33, 49024
    s_nop 0
    buffer_load_dwordx4 v22, s[44:47], s77 offen offset:128 lds
    s_add_u32 m0, s33, 53248
    s_nop 0
    buffer_load_dwordx4 v9, s[48:51], s77 offen lds
    s_load_dword s94, s[10:11], s52 offset:0x80180
    s_load_dword s94, s[10:11], s52 offset:0x801c0
    s_add_u32 s52, s52, 0x100000
    s_load_dword s94, s[10:11], s52 offset:0x0
    s_load_dword s94, s[10:11], s52 offset:0x40
    s_load_dword s94, s[10:11], s52 offset:0x80
    global_load_dwordx4 v[24:27], v11, s[88:89]
    s_waitcnt vmcnt(15)
    s_barrier
    s_add_u32 m0, s79, 100352
    s_add_u32 s78, s78, 32768
    buffer_load_dwordx4 v20, s[36:39], s78 offen lds
    s_add_u32 m0, s79, 101376
    s_nop 0
    buffer_load_dwordx4 v21, s[36:39], s78 offen lds
    s_add_u32 m0, s33, 57344
    s_add_u32 s77, s77, 229376
    s_cmp_eq_u32 s77, 7340032
    s_cselect_b32 s77, 0, s77
    buffer_load_dwordx4 v22, s[40:43], s77 offen offset:0 lds
    s_add_u32 m0, s33, 61312
    s_nop 0
    buffer_load_dwordx4 v22, s[40:43], s77 offen offset:128 lds
    s_add_u32 m0, s33, 65536
    s_nop 0
    buffer_load_dwordx4 v22, s[44:47], s77 offen offset:0 lds
    s_add_u32 m0, s33, 69504
    s_nop 0
    buffer_load_dwordx4 v22, s[44:47], s77 offen offset:128 lds
    s_add_u32 m0, s33, 73728
    s_nop 0
    buffer_load_dwordx4 v9, s[48:51], s77 offen lds
    s_load_dword s94, s[10:11], s52 offset:0xc0
    s_load_dword s94, s[10:11], s52 offset:0x100
    s_load_dword s94, s[10:11], s52 offset:0x140
    s_load_dword s94, s[10:11], s52 offset:0x180
    s_load_dword s94, s[10:11], s52 offset:0x1c0
    global_load_dwordx4 v[28:31], v12, s[88:89]
    s_waitcnt vmcnt(16)
    s_barrier
    s_add_u32 m0, s79, 116736
    s_add_u32 s72, s72, 128
    s_and_b32 s78, s72, 0x7ff
    buffer_load_dwordx4 v20, s[36:39], s78 offen lds
    s_add_u32 m0, s79, 117760
    s_nop 0
    buffer_load_dwordx4 v21, s[36:39], s78 offen lds
    s_add_u32 m0, s33, 77824
    s_add_u32 s77, s77, 229376
    buffer_load_dwordx4 v22, s[40:43], s77 offen offset:0 lds
    s_add_u32 m0, s33, 81792
    s_nop 0
    buffer_load_dwordx4 v22, s[40:43], s77 offen offset:128 lds
    s_add_u32 m0, s33, 86016
    s_nop 0
    buffer_load_dwordx4 v22, s[44:47], s77 offen offset:0 lds
    s_add_u32 m0, s33, 89984
    s_nop 0
    buffer_load_dwordx4 v22, s[44:47], s77 offen offset:128 lds
    s_add_u32 m0, s33, 94208
    s_nop 0
    buffer_load_dwordx4 v9, s[48:51], s77 offen lds
    s_load_dword s94, s[10:11], s52 offset:0x80000
    s_load_dword s94, s[10:11], s52 offset:0x80040
    s_load_dword s94, s[10:11], s52 offset:0x80080
    s_load_dword s94, s[10:11], s52 offset:0x800c0
    s_load_dword s94, s[10:11], s52 offset:0x80100
    s_lshl1_add_u32 s91, s33, s34
    s_add_u32 s91, s91, 0x2000000
    v_lshl_add_u32 v32, v1, 4, s91
    s_and_b32 s85, s31, 3
    s_cmp_eq_u32 s85, 1
    s_cselect_b64 vcc, -1, 0
    s_lshl_b32 s85, s4, 11
    v_lshl_add_u32 v70, v1, 4, s85
    v_add_u32 v71, 1024, v70
    v_cndmask_b32 v11, v11, v70, vcc
    v_cndmask_b32 v12, v12, v71, vcc
    s_waitcnt vmcnt(15)
    global_store_dwordx4 v32, v[24:27], s[26:27] offset:0 sc1
    s_waitcnt vmcnt(17)
    s_barrier
    s_add_u32 m0, s79, 118784
    s_add_u32 s78, s78, 32768
    buffer_load_dwordx4 v20, s[36:39], s78 offen lds
    s_add_u32 m0, s79, 119808
    s_nop 0
    buffer_load_dwordx4 v21, s[36:39], s78 offen lds
    s_add_u32 m0, s33, 16384
    s_add_u32 s77, s77, 229376
    s_cmp_eq_u32 s77, 7340032
    s_cselect_b32 s77, 0, s77
    buffer_load_dwordx4 v22, s[40:43], s77 offen offset:0 lds
    s_add_u32 m0, s33, 20352
    s_nop 0
    buffer_load_dwordx4 v22, s[40:43], s77 offen offset:128 lds
    s_add_u32 m0, s33, 24576
    s_nop 0
    buffer_load_dwordx4 v22, s[44:47], s77 offen offset:0 lds
    s_add_u32 m0, s33, 28544
    s_nop 0
    buffer_load_dwordx4 v22, s[44:47], s77 offen offset:128 lds
    s_add_u32 m0, s33, 32768
    s_nop 0
    buffer_load_dwordx4 v9, s[48:51], s77 offen lds
    s_load_dword s94, s[10:11], s52 offset:0x80140
    s_load_dword s94, s[10:11], s52 offset:0x80180
    s_load_dword s94, s[10:11], s52 offset:0x801c0
    s_add_u32 s53, s53, 0x1c0000
    s_load_dword s94, s[16:17], s53 offset:0x0
    s_load_dword s94, s[16:17], s53 offset:0x40
    s_waitcnt vmcnt(15)
    global_store_dwordx4 v32, v[28:31], s[26:27] offset:1024 sc1
    s_waitcnt vmcnt(17)
    s_barrier
    s_add_u32 m0, s79, 135168
    s_add_u32 s72, s72, 128
    s_and_b32 s78, s72, 0x7ff
    buffer_load_dwordx4 v20, s[36:39], s78 offen lds
    s_add_u32 m0, s79, 136192
    s_nop 0
    buffer_load_dwordx4 v21, s[36:39], s78 offen lds
    s_add_u32 m0, s33, 36864
    s_add_u32 s77, s77, 229376
    buffer_load_dwordx4 v22, s[40:43], s77 offen offset:0 lds
    s_add_u32 m0, s33, 40832
    s_nop 0
    buffer_load_dwordx4 v22, s[40:43], s77 offen offset:128 lds
    s_add_u32 m0, s33, 45056
    s_nop 0
    buffer_load_dwordx4 v22, s[44:47], s77 offen offset:0 lds
    s_add_u32 m0, s33, 49024
    s_nop 0
    buffer_load_dwordx4 v22, s[44:47], s77 offen offset:128 lds
    s_add_u32 m0, s33, 53248
    s_nop 0
    buffer_load_dwordx4 v9, s[48:51], s77 offen lds
    s_load_dword s94, s[16:17], s53 offset:0x80
    s_load_dword s94, s[16:17], s53 offset:0xc0
    s_load_dword s94, s[16:17], s53 offset:0x100
    s_load_dword s94, s[16:17], s53 offset:0x140
    s_load_dword s94, s[16:17], s53 offset:0x180
    s_waitcnt vmcnt(16)
    s_barrier
    s_add_u32 m0, s79, 137216
    s_add_u32 s78, s78, 32768
    buffer_load_dwordx4 v20, s[36:39], s78 offen lds
    s_add_u32 m0, s79, 138240
    s_nop 0
    buffer_load_dwordx4 v21, s[36:39], s78 offen lds
    s_add_u32 m0, s33, 57344
    s_add_u32 s77, s77, 229376
    s_cmp_eq_u32 s77, 7340032
    s_cselect_b32 s77, 0, s77
    buffer_load_dwordx4 v22, s[40:43], s77 offen offset:0 lds
    s_add_u32 m0, s33, 61312
    s_nop 0
    buffer_load_dwordx4 v22, s[40:43], s77 offen offset:128 lds
    s_add_u32 m0, s33, 65536
    s_nop 0
    buffer_load_dwordx4 v22, s[44:47], s77 offen offset:0 lds
    s_add_u32 m0, s33, 69504
    s_nop 0
    buffer_load_dwordx4 v22, s[44:47], s77 offen offset:128 lds
    s_add_u32 m0, s33, 73728
    s_nop 0
    buffer_load_dwordx4 v9, s[48:51], s77 offen lds
    s_load_dword s94, s[16:17], s53 offset:0x1c0
    s_load_dword s94, s[18:19], s53 offset:0x0
    s_load_dword s94, s[18:19], s53 offset:0x40
    s_load_dword s94, s[18:19], s53 offset:0x80
    s_load_dword s94, s[18:19], s53 offset:0xc0
    s_sub_u32 s91, s28, s6
    s_max_i32 s91, s91, 0
    s_lshl_b32 s91, s91, 4
    s_cmp_lg_u32 s5, 0
    s_cselect_b32 s91, s29, s91
    s_cselect_b32 s92, 11, 7
    s_lshl_b32 s91, s91, 7
    s_add_u32 s91, s91, 0x1e80000
    v_lshlrev_b32 v87, s92, v1
    v_add_u32 v87, s91, v87
    s_mov_b64 exec, 0xffff
    global_load_dwordx2 v[18:19], v87, s[26:27] sc1
    s_mov_b64 exec, -1
    s_waitcnt vmcnt(16)
    s_barrier
    s_add_u32 m0, s79, 98304
    s_add_u32 s72, s72, 128
    s_and_b32 s78, s72, 0x7ff
    buffer_load_dwordx4 v20, s[36:39], s78 offen lds
    s_add_u32 m0, s79, 99328
    s_nop 0
    buffer_load_dwordx4 v21, s[36:39], s78 offen lds
    s_add_u32 m0, s33, 77824
    s_add_u32 s77, s77, 229376
    buffer_load_dwordx4 v22, s[40:43], s77 offen offset:0 lds
    s_add_u32 m0, s33, 81792
    s_nop 0
    buffer_load_dwordx4 v22, s[40:43], s77 offen offset:128 lds
    s_add_u32 m0, s33, 86016
    s_nop 0
    buffer_load_dwordx4 v22, s[44:47], s77 offen offset:0 lds
    s_add_u32 m0, s33, 89984
    s_nop 0
    buffer_load_dwordx4 v22, s[44:47], s77 offen offset:128 lds
    s_add_u32 m0, s33, 94208
    s_nop 0
    buffer_load_dwordx4 v9, s[48:51], s77 offen lds
    s_load_dword s94, s[18:19], s53 offset:0x100
    s_load_dword s94, s[18:19], s53 offset:0x140
    s_load_dword s94, s[18:19], s53 offset:0x180
    s_load_dword s94, s[18:19], s53 offset:0x1c0
    s_add_u32 s52, s52, 0x100000
    s_load_dword s94, s[10:11], s52 offset:0x0
    s_waitcnt vmcnt(7)
    s_mov_b64 exec, 0xffff
    s_movk_i32 s98, 0x4000
L_pLN_chk:
    v_cmp_ne_u64 vcc, s[100:101], v[18:19]
    s_nop 1
    s_cmp_eq_u64 vcc, 0
    s_cbranch_scc1 L_pLN_ok
    s_sub_u32 s98, s98, 1
    s_cbranch_scc1 L_pLN_ok
    s_sleep 1
    global_load_dwordx2 v[18:19], v87, s[26:27] sc1
    s_waitcnt vmcnt(0)
    s_branch L_pLN_chk
L_pLN_ok:
    s_mov_b64 exec, -1
    s_waitcnt vmcnt(15)
    s_barrier
    s_mul_i32 s91, s29, 20480
    s_mul_i32 s92, s4, 320
    s_add_u32 s91, s91, s92
    s_add_u32 s91, s91, 0x1e10000
    v_lshrrev_b32 v24, 2, v1
    v_mul_u32_u24 v24, 1280, v24
    v_and_b32 v25, 3, v1
    v_lshlrev_b32 v25, 4, v25
    v_add3_u32 v24, v24, v25, s91
    global_load_dwordx4 v[88:91], v24, s[26:27] offset:0
    global_load_dwordx4 v[92:95], v24, s[26:27] offset:64
    global_load_dwordx4 v[96:99], v24, s[26:27] offset:128
    global_load_dwordx4 v[100:103], v24, s[26:27] offset:192
    global_load_dwordx4 v[104:107], v24, s[26:27] offset:256
    s_add_u32 s92, s92, 159744
    v_lshrrev_b32 v37, 4, v1
    v_add_u32 v25, s92, v25
    v_lshl_add_u32 v36, v37, 2, v25
    v_lshl_add_u32 v25, v37, 6, v25
    s_lshl_b32 s91, s28, 2
    s_add_u32 s91, s91, s4
    s_lshl_b32 s91, s91, 8
    s_add_u32 s91, s91, 0x1e00000
    v_and_b32 v27, 31, v1
    v_lshl_add_u32 v26, v27, 3, s91
    global_load_dwordx2 v[28:29], v26, s[26:27]
    s_lshl_b32 s91, s4, 9
    s_add_u32 s91, s91, 161024
    v_lshl_add_u32 v27, v27, 4, s91
    s_add_u32 m0, s79, 100352
    s_add_u32 s78, s78, 32768
    buffer_load_dwordx4 v20, s[36:39], s78 offen lds
    s_add_u32 m0, s79, 101376
    s_nop 0
    buffer_load_dwordx4 v21, s[36:39], s78 offen lds
    s_add_u32 m0, s33, 16384
    s_add_u32 s77, s77, 229376
    s_cmp_eq_u32 s77, 7340032
    s_cselect_b32 s77, 0, s77
    buffer_load_dwordx4 v22, s[40:43], s77 offen offset:0 lds
    s_add_u32 m0, s33, 20352
    s_nop 0
    buffer_load_dwordx4 v22, s[40:43], s77 offen offset:128 lds
    s_add_u32 m0, s33, 24576
    s_nop 0
    buffer_load_dwordx4 v22, s[44:47], s77 offen offset:0 lds
    s_add_u32 m0, s33, 28544
    s_nop 0
    buffer_load_dwordx4 v22, s[44:47], s77 offen offset:128 lds
    s_add_u32 m0, s33, 32768
    s_nop 0
    buffer_load_dwordx4 v9, s[48:51], s77 offen lds
    s_load_dword s94, s[10:11], s52 offset:0x40
    s_load_dword s94, s[10:11], s52 offset:0x80
    s_load_dword s94, s[10:11], s52 offset:0xc0
    s_load_dword s94, s[10:11], s52 offset:0x100
    s_load_dword s94, s[10:11], s52 offset:0x140
    s_waitcnt vmcnt(35)
    s_waitcnt vmcnt(21)
    s_barrier
    s_add_u32 m0, s79, 116736
    s_add_u32 s72, s72, 128
    s_and_b32 s78, s72, 0x7ff
    buffer_load_dwordx4 v20, s[36:39], s78 offen lds
    s_add_u32 m0, s79, 117760
    s_nop 0
    buffer_load_dwordx4 v21, s[36:39], s78 offen lds
    s_add_u32 m0, s33, 36864
    s_add_u32 s77, s77, 229376
    buffer_load_dwordx4 v22, s[40:43], s77 offen offset:0 lds
    s_add_u32 m0, s33, 40832
    s_nop 0
    buffer_load_dwordx4 v22, s[40:43], s77 offen offset:128 lds
    s_add_u32 m0, s33, 45056
    s_nop 0
    buffer_load_dwordx4 v22, s[44:47], s77 offen offset:0 lds
    s_add_u32 m0, s33, 49024
    s_nop 0
    buffer_load_dwordx4 v22, s[44:47], s77 offen offset:128 lds
    s_add_u32 m0, s33, 53248
    s_nop 0
    buffer_load_dwordx4 v9, s[48:51], s77 offen lds
    s_load_dword s94, s[10:11], s52 offset:0x180
    s_load_dword s94, s[10:11], s52 offset:0x1c0
    s_load_dword s94, s[10:11], s52 offset:0x80000
    s_load_dword s94, s[10:11], s52 offset:0x80040
    s_load_dword s94, s[10:11], s52 offset:0x80080
    s_cmp_lg_u32 s4, 0
    s_cbranch_scc1 L_fC
    s_lshl_b32 s91, s28, 4
    s_add_u32 s91, s91, s29
    s_lshl_b32 s91, s91, 7
    s_add_u32 s91, s91, 0x1eb0000
    v_mov_b32 v32, s91
    v_mov_b32 v34, s100
    v_mov_b32 v35, s101
    s_mov_b64 exec, 1
    global_store_dwordx2 v32, v[34:35], s[26:27] sc1
    s_mov_b64 exec, -1
L_fC:
    s_waitcnt vmcnt(20)
    s_barrier
    s_add_u32 m0, s79, 118784
    s_add_u32 s78, s78, 32768
    buffer_load_dwordx4 v20, s[36:39], s78 offen lds
    s_waitcnt vmcnt(15)
    v_rcp_f32 v30, v29
    v_mul_f32 v32, -1.0, v28
    v_mul_f32 v35, v29, v29
    v_fma_f32 v31, -v29, v30, 1.0
    v_fma_f32 v30, v31, v30, v30
    v_mul_f32 v33, 0xc0135761, v30
    v_mul_f32 v31, v30, v30
    s_add_u32 m0, s79, 119808
    s_nop 0
    buffer_load_dwordx4 v21, s[36:39], s78 offen lds
    v_mul_f32 v31, v31, v30
    v_mul_f32 v34, 0xbdd2d3e8, v31
    ds_write_b128 v27, v[32:35]
    v_permlane16_swap_b32 v88, v92
    v_permlane16_swap_b32 v96, v100
    v_permlane16_swap_b32 v89, v93
    v_permlane16_swap_b32 v97, v101
    v_permlane16_swap_b32 v90, v94
    v_permlane16_swap_b32 v98, v102
    s_add_u32 m0, s33, 57344
    s_add_u32 s77, s77, 229376
    s_cmp_eq_u32 s77, 7340032
    s_cselect_b32 s77, 0, s77
    buffer_load_dwordx4 v22, s[40:43], s77 offen offset:0 lds
    v_permlane16_swap_b32 v91, v95
    v_permlane16_swap_b32 v99, v103
    v_permlane16_swap_b32 v104, v105
    v_permlane16_swap_b32 v106, v107
    v_add_f32 v88, v88, v92
    v_add_f32 v96, v96, v100
    v_add_f32 v89, v89, v93
    v_add_f32 v97, v97, v101
    s_add_u32 m0, s33, 61312
    s_nop 0
    buffer_load_dwordx4 v22, s[40:43], s77 offen offset:128 lds
    v_add_f32 v90, v90, v94
    v_add_f32 v98, v98, v102
    v_add_f32 v91, v91, v95
    v_add_f32 v99, v99, v103
    v_add_f32 v104, v104, v105
    v_add_f32 v106, v106, v107
    s_nop 0
    v_permlane32_swap_b32 v88, v96
    v_permlane32_swap_b32 v89, v97
    s_add_u32 m0, s33, 65536
    s_nop 0
    buffer_load_dwordx4 v22, s[44:47], s77 offen offset:0 lds
    v_permlane32_swap_b32 v90, v98
    v_permlane32_swap_b32 v91, v99
    v_permlane32_swap_b32 v104, v106
    v_add_f32 v88, v88, v96
    v_add_f32 v89, v89, v97
    v_add_f32 v90, v90, v98
    v_add_f32 v91, v91, v99
    v_add_f32 v104, v104, v106
    s_add_u32 m0, s33, 69504
    s_nop 0
    buffer_load_dwordx4 v22, s[44:47], s77 offen offset:128 lds
    s_add_u32 m0, s33, 73728
    s_nop 0
    buffer_load_dwordx4 v9, s[48:51], s77 offen lds
    v_add_f32_dpp v88, v88, v88 row_ror:8 row_mask:0xf bank_mask:0xf
    v_add_f32_dpp v89, v89, v89 row_ror:8 row_mask:0xf bank_mask:0xf
    v_add_f32_dpp v90, v90, v90 row_ror:8 row_mask:0xf bank_mask:0xf
    v_add_f32_dpp v91, v91, v91 row_ror:8 row_mask:0xf bank_mask:0xf
    v_add_f32_dpp v104, v104, v104 row_ror:8 row_mask:0xf bank_mask:0xf
    v_add_f32_dpp v88, v88, v88 row_ror:4 row_mask:0xf bank_mask:0xf
    v_add_f32_dpp v89, v89, v89 row_ror:4 row_mask:0xf bank_mask:0xf
    v_add_f32_dpp v90, v90, v90 row_ror:4 row_mask:0xf bank_mask:0xf
    s_load_dword s94, s[10:11], s52 offset:0x800c0
    s_load_dword s94, s[10:11], s52 offset:0x80100
    s_load_dword s94, s[10:11], s52 offset:0x80140
    s_load_dword s94, s[10:11], s52 offset:0x80180
    s_load_dword s94, s[10:11], s52 offset:0x801c0
    s_waitcnt vmcnt(14)
    s_barrier
    s_mov_b32 s36, s26
    s_mov_b32 s37, s27
    s_mov_b32 s38, 0x400000
    s_mov_b32 s39, 0x20000
    s_add_u32 m0, s33, 77824
    s_add_u32 s77, s77, 229376
    buffer_load_dwordx4 v22, s[40:43], s77 offen offset:0 lds
    v_add_f32_dpp v91, v91, v91 row_ror:4 row_mask:0xf bank_mask:0xf
    v_add_f32_dpp v104, v104, v104 row_ror:4 row_mask:0xf bank_mask:0xf
    s_mov_b32 s92, 0x000f000f
    s_mov_b32 s93, s92
    s_mov_b64 exec, s[92:93]
    ds_write_b128 v25, v[88:91]
    ds_write_b32 v36, v104 offset:256
    s_mov_b64 exec, -1
    v_mov_b32 v88, 0
    v_mov_b32 v89, 0
    v_mov_b32 v90, 0
    v_mov_b32 v91, 0
    v_mov_b32 v92, 0
    v_mov_b32 v93, 0
    v_mov_b32 v94, 0
    v_mov_b32 v95, 0
    s_add_u32 m0, s33, 81792
    s_nop 0
    buffer_load_dwordx4 v22, s[40:43], s77 offen offset:128 lds
    s_add_u32 m0, s33, 86016
    s_nop 0
    buffer_load_dwordx4 v22, s[44:47], s77 offen offset:0 lds
    v_mov_b32 v96, 0
    v_mov_b32 v97, 0
    v_mov_b32 v98, 0
    v_mov_b32 v99, 0
    v_mov_b32 v100, 0
    v_mov_b32 v101, 0
    v_mov_b32 v102, 0
    v_mov_b32 v103, 0
    s_add_u32 m0, s33, 89984
    s_nop 0
    buffer_load_dwordx4 v22, s[44:47], s77 offen offset:128 lds
    v_mov_b32 v104, 0
    v_mov_b32 v105, 0
    v_mov_b32 v106, 0
    v_mov_b32 v107, 0
    v_mov_b32 v108, 0
    v_mov_b32 v109, 0
    v_mov_b32 v110, 0
    v_mov_b32 v111, 0
    s_add_u32 m0, s33, 94208
    s_nop 0
    buffer_load_dwordx4 v9, s[48:51], s77 offen lds
    s_add_u32 m0, s79, 135168
    s_mov_b32 s78, 0
    buffer_load_dwordx4 v20, s[36:39], s78 offen sc1 lds
    s_add_u32 m0, s79, 136192
    s_nop 0
    buffer_load_dwordx4 v21, s[36:39], s78 offen sc1 lds
    s_waitcnt vmcnt(14)
    s_barrier
    s_lshl_b32 s85, s29, 7
    s_add_u32 s86, s85, 4096
    s_add_u32 s87, s85, 128
    s_and_b32 s87, s87, 0x7ff
    s_add_u32 s87, s87, 5120
    s_add_u32 s40, s10, s85
    s_addc_u32 s41, s11, 0
    s_add_u32 s44, s10, s86
    s_addc_u32 s45, s11, 0
    s_add_u32 s48, s16, s87
    s_addc_u32 s49, s17, 0
    s_add_u32 s52, s18, s87
    s_addc_u32 s53, s19, 0
    s_sub_u32 s42, 6291456, s85
    s_sub_u32 s46, 6291456, s86
    s_mov_b32 s50, s54
    s_add_u32 m0, s79, 137216
    s_mov_b32 s78, 32768
    buffer_load_dwordx4 v20, s[36:39], s78 offen sc1 lds
    s_add_u32 m0, s79, 138240
    s_nop 0
    buffer_load_dwordx4 v21, s[36:39], s78 offen sc1 lds
    s_add_u32 m0, s81, 151552
    s_mov_b32 s78, 0
    s_mov_b64 exec, 0xffffffff
    buffer_load_dwordx4 v3, s[36:39], s78 offen sc1 lds
    s_mov_b64 exec, -1
    s_add_u32 m0, s33, 16384
    s_mov_b32 s76, 0
    buffer_load_dwordx4 v23, s[40:43], s76 offen offset:0 lds
    s_add_u32 m0, s33, 18432
    s_nop 0
    buffer_load_dwordx4 v23, s[40:43], s76 offen offset:2048 lds
    s_add_u32 m0, s33, 24576
    s_nop 0
    buffer_load_dwordx4 v23, s[44:47], s76 offen offset:0 lds
    s_add_u32 m0, s33, 28672
    s_mov_b32 s77, 0
    buffer_load_dwordx4 v22, s[48:51], s77 offen offset:0 lds
    s_add_u32 m0, s33, 32768
    s_nop 0
    buffer_load_dwordx4 v22, s[52:55], s77 offen offset:0 lds
    s_waitcnt vmcnt(15)
    s_barrier
    s_add_u32 m0, s79, 98304
    s_mov_b32 s78, 128
    buffer_load_dwordx4 v20, s[36:39], s78 offen sc1 lds
    s_add_u32 m0, s79, 99328
    s_nop 0
    buffer_load_dwordx4 v21, s[36:39], s78 offen sc1 lds
    s_add_u32 m0, s33, 36864
    s_mov_b32 s76, 196608
    buffer_load_dwordx4 v23, s[40:43], s76 offen offset:0 lds
    s_add_u32 m0, s33, 38912
    s_nop 0
    buffer_load_dwordx4 v23, s[40:43], s76 offen offset:2048 lds
    s_add_u32 m0, s33, 45056
    s_nop 0
    buffer_load_dwordx4 v23, s[44:47], s76 offen offset:0 lds
    s_add_u32 m0, s33, 49152
    s_mov_b32 s77, 229376
    buffer_load_dwordx4 v22, s[48:51], s77 offen offset:0 lds
    s_add_u32 m0, s33, 53248
    s_nop 0
    buffer_load_dwordx4 v22, s[52:55], s77 offen offset:0 lds
    s_waitcnt vmcnt(7)
    s_barrier
    s_add_u32 m0, s79, 100352
    s_mov_b32 s78, 32896
    buffer_load_dwordx4 v20, s[36:39], s78 offen sc1 lds
    s_add_u32 m0, s79, 101376
    s_nop 0
    buffer_load_dwordx4 v21, s[36:39], s78 offen sc1 lds
    s_add_u32 m0, s81, 114688
    s_mov_b32 s78, 128
    s_mov_b64 exec, 0xffffffff
    buffer_load_dwordx4 v3, s[36:39], s78 offen sc1 lds
    s_mov_b64 exec, -1
    s_add_u32 m0, s33, 57344
    s_mov_b32 s76, 393216
L_pad8:
    s_cbranch_execz L_vret0
    buffer_load_dwordx4 v23, s[40:43], s76 offen offset:0 lds
    s_add_u32 m0, s33, 59392
    s_nop 0
    buffer_load_dwordx4 v23, s[40:43], s76 offen offset:2048 lds
    s_add_u32 m0, s33, 65536
    s_nop 0
    buffer_load_dwordx4 v23, s[44:47], s76 offen offset:0 lds
    s_add_u32 m0, s33, 69632
    s_mov_b32 s77, 458752
    buffer_load_dwordx4 v22, s[48:51], s77 offen offset:0 lds
    s_add_u32 m0, s33, 73728
    s_nop 0
    buffer_load_dwordx4 v22, s[52:55], s77 offen offset:0 lds
    s_waitcnt lgkmcnt(0)
    v_add_u32 v14, s80, v16
    v_add_u32 v15, s80, v17
    s_add_u32 s84, s80, s95
    v_add_u32 v18, s84, v16
    v_add_u32 v19, s84, v17
    s_add_u32 s80, s80, 18432
    s_cmp_ge_u32 s80, 153600
    s_cselect_b32 s84, 55296, 0
    s_sub_u32 s80, s80, s84
    ds_read_b64_tr_b16 v[64:65], v4 offset:4096
    ds_read_b64_tr_b16 v[66:67], v4 offset:4608
    ds_read_b128 v[24:27], v14 offset:0
    ds_read_b128 v[28:31], v14 offset:2048
    ds_read_b128 v[32:35], v14 offset:4096
    ds_read_b128 v[36:39], v14 offset:6144
    ds_read_b64_tr_b16 v[68:69], v5 offset:4096
    ds_read_b64_tr_b16 v[70:71], v5 offset:4608
    ds_read_b64_tr_b16 v[72:73], v4 offset:8192
    ds_read_b64_tr_b16 v[74:75], v4 offset:8704
    ds_read_b128 v[56:59], v18
    s_barrier
    s_setprio 1
    s_mov_b32 s34, 7
.p2align 6
L_p2:
    s_waitcnt lgkmcnt(8)
    v_mfma_f32_16x16x32_bf16 v[88:91], v[64:67], v[24:27], v[88:91]
    ds_read_b64_tr_b16 v[76:77], v5 offset:8192
    s_waitcnt lgkmcnt(8)
    v_mfma_f32_16x16x32_bf16 v[92:95], v[64:67], v[28:31], v[92:95]
    ds_read_b64_tr_b16 v[78:79], v5 offset:8704
    s_waitcnt lgkmcnt(8)
    v_mfma_f32_16x16x32_bf16 v[96:99], v[64:67], v[32:35], v[96:99]
    ds_read_b64_tr_b16 v[80:81], v4 offset:0
    s_waitcnt lgkmcnt(8)
    v_mfma_f32_16x16x32_bf16 v[100:103], v[64:67], v[36:39], v[100:103]
    ds_read_b64_tr_b16 v[82:83], v4 offset:512
    s_waitcnt lgkmcnt(4)
    v_mfma_f32_16x16x32_bf16 v[248:251], v[64:67], v[56:59], v[248:251]
    v_mfma_f32_16x16x32_bf16 v[104:107], v[68:71], v[24:27], v[104:107]
    ds_read_b64_tr_b16 v[64:65], v5 offset:0
    v_mfma_f32_16x16x32_bf16 v[108:111], v[68:71], v[28:31], v[108:111]
    v_mfma_f32_16x16x32_bf16 v[112:115], v[68:71], v[32:35], v[112:115]
    ds_read_b64_tr_b16 v[66:67], v5 offset:512
    v_mfma_f32_16x16x32_bf16 v[116:119], v[68:71], v[36:39], v[116:119]
    v_mfma_f32_16x16x32_bf16 v[120:123], v[24:27], v[72:75], v[120:123]
    ds_read_b64_tr_b16 v[68:69], v4 offset:12288
    v_mfma_f32_16x16x32_bf16 v[124:127], v[28:31], v[72:75], v[124:127]
    v_mfma_f32_16x16x32_bf16 v[128:131], v[32:35], v[72:75], v[128:131]
    ds_read_b64_tr_b16 v[70:71], v4 offset:12800
    v_mfma_f32_16x16x32_bf16 v[132:135], v[36:39], v[72:75], v[132:135]
    v_mfma_f32_16x16x32_bf16 v[252:255], v[56:59], v[72:75], v[252:255]
    s_waitcnt lgkmcnt(6)
    v_mfma_f32_16x16x32_bf16 v[136:139], v[24:27], v[76:79], v[136:139]
    ds_read_b64_tr_b16 v[72:73], v4 offset:16384
    v_mfma_f32_16x16x32_bf16 v[140:143], v[28:31], v[76:79], v[140:143]
    v_mfma_f32_16x16x32_bf16 v[144:147], v[32:35], v[76:79], v[144:147]
    ds_read_b64_tr_b16 v[74:75], v4 offset:16896
    v_mfma_f32_16x16x32_bf16 v[148:151], v[36:39], v[76:79], v[148:151]
    s_waitcnt lgkmcnt(6)
    v_mfma_f32_16x16x32_bf16 v[152:155], v[80:83], v[24:27], v[152:155]
    ds_read_b64_tr_b16 v[76:77], v5 offset:12288
    v_mfma_f32_16x16x32_bf16 v[156:159], v[80:83], v[28:31], v[156:159]
    v_mfma_f32_16x16x32_bf16 v[160:163], v[80:83], v[32:35], v[160:163]
    ds_read_b64_tr_b16 v[78:79], v5 offset:12800
    v_mfma_f32_16x16x32_bf16 v[164:167], v[80:83], v[36:39], v[164:167]
    s_waitcnt lgkmcnt(6)
    v_mfma_f32_16x16x32_bf16 v[168:171], v[64:67], v[24:27], v[168:171]
    ds_read_b64_tr_b16 v[80:81], v5 offset:16384
    v_mfma_f32_16x16x32_bf16 v[172:175], v[64:67], v[28:31], v[172:175]
    v_mfma_f32_16x16x32_bf16 v[176:179], v[64:67], v[32:35], v[176:179]
    ds_read_b64_tr_b16 v[82:83], v5 offset:16896
    v_mfma_f32_16x16x32_bf16 v[180:183], v[64:67], v[36:39], v[180:183]
    s_waitcnt lgkmcnt(6)
    v_mfma_f32_16x16x32_bf16 v[184:187], v[68:71], v[24:27], v[184:187]
    v_mfma_f32_16x16x32_bf16 v[188:191], v[68:71], v[28:31], v[188:191]
    v_mfma_f32_16x16x32_bf16 v[192:195], v[68:71], v[32:35], v[192:195]
    v_mfma_f32_16x16x32_bf16 v[196:199], v[68:71], v[36:39], v[196:199]
    s_waitcnt vmcnt(8) lgkmcnt(0)
    s_barrier
    v_mfma_f32_16x16x32_bf16 v[200:203], v[72:75], v[24:27], v[200:203]
    ds_read_b64_tr_b16 v[64:65], v4 offset:24576
    v_mfma_f32_16x16x32_bf16 v[204:207], v[72:75], v[28:31], v[204:207]
    ds_read_b64_tr_b16 v[66:67], v4 offset:25088
    v_mfma_f32_16x16x32_bf16 v[208:211], v[72:75], v[32:35], v[208:211]
    ds_read_b128 v[40:43], v15 offset:0
    v_mfma_f32_16x16x32_bf16 v[212:215], v[72:75], v[36:39], v[212:215]
    ds_read_b128 v[44:47], v15 offset:2048
    v_mfma_f32_16x16x32_bf16 v[216:219], v[76:79], v[24:27], v[216:219]
    ds_read_b128 v[48:51], v15 offset:4096
    v_mfma_f32_16x16x32_bf16 v[220:223], v[76:79], v[28:31], v[220:223]
    ds_read_b128 v[52:55], v15 offset:6144
    v_mfma_f32_16x16x32_bf16 v[224:227], v[76:79], v[32:35], v[224:227]
    ds_read_b64_tr_b16 v[68:69], v5 offset:24576
    v_mfma_f32_16x16x32_bf16 v[228:231], v[76:79], v[36:39], v[228:231]
    ds_read_b64_tr_b16 v[70:71], v5 offset:25088
    v_mfma_f32_16x16x32_bf16 v[232:235], v[80:83], v[24:27], v[232:235]
    ds_read_b64_tr_b16 v[72:73], v4 offset:28672
    v_mfma_f32_16x16x32_bf16 v[236:239], v[80:83], v[28:31], v[236:239]
    ds_read_b64_tr_b16 v[74:75], v4 offset:29184
    v_mfma_f32_16x16x32_bf16 v[240:243], v[80:83], v[32:35], v[240:243]
    ds_read_b128 v[60:63], v19
    v_mfma_f32_16x16x32_bf16 v[244:247], v[80:83], v[36:39], v[244:247]
    s_waitcnt lgkmcnt(8)
    v_mfma_f32_16x16x32_bf16 v[88:91], v[64:67], v[40:43], v[88:91]
    ds_read_b64_tr_b16 v[76:77], v5 offset:28672
    s_waitcnt lgkmcnt(8)
    v_mfma_f32_16x16x32_bf16 v[92:95], v[64:67], v[44:47], v[92:95]
    ds_read_b64_tr_b16 v[78:79], v5 offset:29184
    s_waitcnt lgkmcnt(8)
    v_mfma_f32_16x16x32_bf16 v[96:99], v[64:67], v[48:51], v[96:99]
    ds_read_b64_tr_b16 v[80:81], v4 offset:20480
    s_waitcnt lgkmcnt(8)
    v_mfma_f32_16x16x32_bf16 v[100:103], v[64:67], v[52:55], v[100:103]
    ds_read_b64_tr_b16 v[82:83], v4 offset:20992
    s_waitcnt lgkmcnt(4)
    v_mfma_f32_16x16x32_bf16 v[248:251], v[64:67], v[60:63], v[248:251]
    v_mfma_f32_16x16x32_bf16 v[104:107], v[68:71], v[40:43], v[104:107]
    ds_read_b64_tr_b16 v[64:65], v5 offset:20480
    v_mfma_f32_16x16x32_bf16 v[108:111], v[68:71], v[44:47], v[108:111]
    v_add_u32 v14, s80, v16
    v_mfma_f32_16x16x32_bf16 v[112:115], v[68:71], v[48:51], v[112:115]
    ds_read_b64_tr_b16 v[66:67], v5 offset:20992
    v_mfma_f32_16x16x32_bf16 v[116:119], v[68:71], v[52:55], v[116:119]
    v_add_u32 v15, s80, v17
    v_mfma_f32_16x16x32_bf16 v[120:123], v[40:43], v[72:75], v[120:123]
    ds_read_b64_tr_b16 v[68:69], v4 offset:32768
    v_mfma_f32_16x16x32_bf16 v[124:127], v[44:47], v[72:75], v[124:127]
    s_add_u32 s84, s80, s95
    v_mfma_f32_16x16x32_bf16 v[128:131], v[48:51], v[72:75], v[128:131]
    ds_read_b64_tr_b16 v[70:71], v4 offset:33280
    v_mfma_f32_16x16x32_bf16 v[132:135], v[52:55], v[72:75], v[132:135]
    v_add_u32 v18, s84, v16
    v_mfma_f32_16x16x32_bf16 v[252:255], v[60:63], v[72:75], v[252:255]
    s_waitcnt lgkmcnt(6)
    v_mfma_f32_16x16x32_bf16 v[136:139], v[40:43], v[76:79], v[136:139]
    ds_read_b64_tr_b16 v[72:73], v4 offset:36864
    v_mfma_f32_16x16x32_bf16 v[140:143], v[44:47], v[76:79], v[140:143]
    v_add_u32 v19, s84, v17
    v_mfma_f32_16x16x32_bf16 v[144:147], v[48:51], v[76:79], v[144:147]
    ds_read_b64_tr_b16 v[74:75], v4 offset:37376
    v_mfma_f32_16x16x32_bf16 v[148:151], v[52:55], v[76:79], v[148:151]
    s_add_u32 s80, s80, 18432
    s_waitcnt lgkmcnt(6)
    v_mfma_f32_16x16x32_bf16 v[152:155], v[80:83], v[40:43], v[152:155]
    ds_read_b64_tr_b16 v[76:77], v5 offset:32768
    v_mfma_f32_16x16x32_bf16 v[156:159], v[80:83], v[44:47], v[156:159]
    s_cmp_ge_u32 s80, 153600
    s_cselect_b32 s84, 55296, 0
    v_mfma_f32_16x16x32_bf16 v[160:163], v[80:83], v[48:51], v[160:163]
    ds_read_b64_tr_b16 v[78:79], v5 offset:33280
    v_mfma_f32_16x16x32_bf16 v[164:167], v[80:83], v[52:55], v[164:167]
    s_sub_u32 s80, s80, s84
    s_waitcnt lgkmcnt(6)
    v_mfma_f32_16x16x32_bf16 v[168:171], v[64:67], v[40:43], v[168:171]
    ds_read_b64_tr_b16 v[80:81], v5 offset:36864
    v_mfma_f32_16x16x32_bf16 v[172:175], v[64:67], v[44:47], v[172:175]
    v_mfma_f32_16x16x32_bf16 v[176:179], v[64:67], v[48:51], v[176:179]
    ds_read_b64_tr_b16 v[82:83], v5 offset:37376
    v_mfma_f32_16x16x32_bf16 v[180:183], v[64:67], v[52:55], v[180:183]
    s_waitcnt lgkmcnt(6)
    v_mfma_f32_16x16x32_bf16 v[184:187], v[68:71], v[40:43], v[184:187]
    v_mfma_f32_16x16x32_bf16 v[188:191], v[68:71], v[44:47], v[188:191]
    v_mfma_f32_16x16x32_bf16 v[192:195], v[68:71], v[48:51], v[192:195]
    v_mfma_f32_16x16x32_bf16 v[196:199], v[68:71], v[52:55], v[196:199]
    s_waitcnt vmcnt(0) lgkmcnt(0)
    s_barrier
    v_mfma_f32_16x16x32_bf16 v[200:203], v[72:75], v[40:43], v[200:203]
    ds_read_b64_tr_b16 v[64:65], v6 offset:4096
    v_mfma_f32_16x16x32_bf16 v[204:207], v[72:75], v[44:47], v[204:207]
    ds_read_b64_tr_b16 v[66:67], v6 offset:4608
    v_mfma_f32_16x16x32_bf16 v[208:211], v[72:75], v[48:51], v[208:211]
    ds_read_b128 v[24:27], v14 offset:0
    v_mfma_f32_16x16x32_bf16 v[212:215], v[72:75], v[52:55], v[212:215]
    ds_read_b128 v[28:31], v14 offset:2048
    v_mfma_f32_16x16x32_bf16 v[216:219], v[76:79], v[40:43], v[216:219]
    ds_read_b128 v[32:35], v14 offset:4096
    v_mfma_f32_16x16x32_bf16 v[220:223], v[76:79], v[44:47], v[220:223]
    ds_read_b128 v[36:39], v14 offset:6144
    v_mfma_f32_16x16x32_bf16 v[224:227], v[76:79], v[48:51], v[224:227]
    ds_read_b64_tr_b16 v[68:69], v7 offset:4096
    v_mfma_f32_16x16x32_bf16 v[228:231], v[76:79], v[52:55], v[228:231]
    ds_read_b64_tr_b16 v[70:71], v7 offset:4608
    v_mfma_f32_16x16x32_bf16 v[232:235], v[80:83], v[40:43], v[232:235]
    ds_read_b64_tr_b16 v[72:73], v6 offset:8192
    v_mfma_f32_16x16x32_bf16 v[236:239], v[80:83], v[44:47], v[236:239]
    ds_read_b64_tr_b16 v[74:75], v6 offset:8704
    v_mfma_f32_16x16x32_bf16 v[240:243], v[80:83], v[48:51], v[240:243]
    ds_read_b128 v[56:59], v18
    v_mfma_f32_16x16x32_bf16 v[244:247], v[80:83], v[52:55], v[244:247]
    s_waitcnt lgkmcnt(8)
    v_mfma_f32_16x16x32_bf16 v[88:91], v[64:67], v[24:27], v[88:91]
    ds_read_b64_tr_b16 v[76:77], v7 offset:8192
    s_waitcnt lgkmcnt(8)
    v_mfma_f32_16x16x32_bf16 v[92:95], v[64:67], v[28:31], v[92:95]
    ds_read_b64_tr_b16 v[78:79], v7 offset:8704
    s_waitcnt lgkmcnt(8)
    v_mfma_f32_16x16x32_bf16 v[96:99], v[64:67], v[32:35], v[96:99]
    ds_read_b64_tr_b16 v[80:81], v6 offset:0
    s_waitcnt lgkmcnt(8)
    v_mfma_f32_16x16x32_bf16 v[100:103], v[64:67], v[36:39], v[100:103]
    ds_read_b64_tr_b16 v[82:83], v6 offset:512
    s_waitcnt lgkmcnt(4)
    v_mfma_f32_16x16x32_bf16 v[248:251], v[64:67], v[56:59], v[248:251]
    v_mfma_f32_16x16x32_bf16 v[104:107], v[68:71], v[24:27], v[104:107]
    ds_read_b64_tr_b16 v[64:65], v7 offset:0
    v_mfma_f32_16x16x32_bf16 v[108:111], v[68:71], v[28:31], v[108:111]
    v_mfma_f32_16x16x32_bf16 v[112:115], v[68:71], v[32:35], v[112:115]
    ds_read_b64_tr_b16 v[66:67], v7 offset:512
    v_mfma_f32_16x16x32_bf16 v[116:119], v[68:71], v[36:39], v[116:119]
    v_mfma_f32_16x16x32_bf16 v[120:123], v[24:27], v[72:75], v[120:123]
    ds_read_b64_tr_b16 v[68:69], v6 offset:12288
    v_mfma_f32_16x16x32_bf16 v[124:127], v[28:31], v[72:75], v[124:127]
    v_mfma_f32_16x16x32_bf16 v[128:131], v[32:35], v[72:75], v[128:131]
    ds_read_b64_tr_b16 v[70:71], v6 offset:12800
    v_mfma_f32_16x16x32_bf16 v[132:135], v[36:39], v[72:75], v[132:135]
    v_mfma_f32_16x16x32_bf16 v[252:255], v[56:59], v[72:75], v[252:255]
    s_waitcnt lgkmcnt(6)
    v_mfma_f32_16x16x32_bf16 v[136:139], v[24:27], v[76:79], v[136:139]
    ds_read_b64_tr_b16 v[72:73], v6 offset:16384
    v_mfma_f32_16x16x32_bf16 v[140:143], v[28:31], v[76:79], v[140:143]
    v_mfma_f32_16x16x32_bf16 v[144:147], v[32:35], v[76:79], v[144:147]
    ds_read_b64_tr_b16 v[74:75], v6 offset:16896
    v_mfma_f32_16x16x32_bf16 v[148:151], v[36:39], v[76:79], v[148:151]
    s_waitcnt lgkmcnt(6)
    v_mfma_f32_16x16x32_bf16 v[152:155], v[80:83], v[24:27], v[152:155]
    ds_read_b64_tr_b16 v[76:77], v7 offset:12288
    v_mfma_f32_16x16x32_bf16 v[156:159], v[80:83], v[28:31], v[156:159]
    v_mfma_f32_16x16x32_bf16 v[160:163], v[80:83], v[32:35], v[160:163]
    ds_read_b64_tr_b16 v[78:79], v7 offset:12800
    v_mfma_f32_16x16x32_bf16 v[164:167], v[80:83], v[36:39], v[164:167]
    s_waitcnt lgkmcnt(6)
    v_mfma_f32_16x16x32_bf16 v[168:171], v[64:67], v[24:27], v[168:171]
    ds_read_b64_tr_b16 v[80:81], v7 offset:16384
    v_mfma_f32_16x16x32_bf16 v[172:175], v[64:67], v[28:31], v[172:175]
    v_mfma_f32_16x16x32_bf16 v[176:179], v[64:67], v[32:35], v[176:179]
    ds_read_b64_tr_b16 v[82:83], v7 offset:16896
    v_mfma_f32_16x16x32_bf16 v[180:183], v[64:67], v[36:39], v[180:183]
    s_waitcnt lgkmcnt(6)
    v_mfma_f32_16x16x32_bf16 v[184:187], v[68:71], v[24:27], v[184:187]
    v_mfma_f32_16x16x32_bf16 v[188:191], v[68:71], v[28:31], v[188:191]
    v_mfma_f32_16x16x32_bf16 v[192:195], v[68:71], v[32:35], v[192:195]
    v_mfma_f32_16x16x32_bf16 v[196:199], v[68:71], v[36:39], v[196:199]
    s_waitcnt lgkmcnt(0)
    s_barrier
    v_mfma_f32_16x16x32_bf16 v[200:203], v[72:75], v[24:27], v[200:203]
    ds_read_b64_tr_b16 v[64:65], v6 offset:24576
    v_mfma_f32_16x16x32_bf16 v[204:207], v[72:75], v[28:31], v[204:207]
    ds_read_b64_tr_b16 v[66:67], v6 offset:25088
    v_mfma_f32_16x16x32_bf16 v[208:211], v[72:75], v[32:35], v[208:211]
    ds_read_b128 v[40:43], v15 offset:0
    v_mfma_f32_16x16x32_bf16 v[212:215], v[72:75], v[36:39], v[212:215]
    ds_read_b128 v[44:47], v15 offset:2048
    v_mfma_f32_16x16x32_bf16 v[216:219], v[76:79], v[24:27], v[216:219]
    ds_read_b128 v[48:51], v15 offset:4096
    v_mfma_f32_16x16x32_bf16 v[220:223], v[76:79], v[28:31], v[220:223]
    ds_read_b128 v[52:55], v15 offset:6144
    v_mfma_f32_16x16x32_bf16 v[224:227], v[76:79], v[32:35], v[224:227]
    ds_read_b64_tr_b16 v[68:69], v7 offset:24576
    v_mfma_f32_16x16x32_bf16 v[228:231], v[76:79], v[36:39], v[228:231]
    ds_read_b64_tr_b16 v[70:71], v7 offset:25088
    v_mfma_f32_16x16x32_bf16 v[232:235], v[80:83], v[24:27], v[232:235]
    ds_read_b64_tr_b16 v[72:73], v6 offset:28672
    v_mfma_f32_16x16x32_bf16 v[236:239], v[80:83], v[28:31], v[236:239]
    ds_read_b64_tr_b16 v[74:75], v6 offset:29184
    v_mfma_f32_16x16x32_bf16 v[240:243], v[80:83], v[32:35], v[240:243]
    ds_read_b128 v[60:63], v19
    v_mfma_f32_16x16x32_bf16 v[244:247], v[80:83], v[36:39], v[244:247]
    s_waitcnt lgkmcnt(8)
    v_mfma_f32_16x16x32_bf16 v[88:91], v[64:67], v[40:43], v[88:91]
    ds_read_b64_tr_b16 v[76:77], v7 offset:28672
    s_waitcnt lgkmcnt(8)
    v_mfma_f32_16x16x32_bf16 v[92:95], v[64:67], v[44:47], v[92:95]
    ds_read_b64_tr_b16 v[78:79], v7 offset:29184
    s_waitcnt lgkmcnt(8)
    v_mfma_f32_16x16x32_bf16 v[96:99], v[64:67], v[48:51], v[96:99]
    ds_read_b64_tr_b16 v[80:81], v6 offset:20480
    s_waitcnt lgkmcnt(8)
    v_mfma_f32_16x16x32_bf16 v[100:103], v[64:67], v[52:55], v[100:103]
    ds_read_b64_tr_b16 v[82:83], v6 offset:20992
    s_waitcnt lgkmcnt(4)
    v_mfma_f32_16x16x32_bf16 v[248:251], v[64:67], v[60:63], v[248:251]
    v_mfma_f32_16x16x32_bf16 v[104:107], v[68:71], v[40:43], v[104:107]
    ds_read_b64_tr_b16 v[64:65], v7 offset:20480
    v_mfma_f32_16x16x32_bf16 v[108:111], v[68:71], v[44:47], v[108:111]
    v_add_u32 v14, s80, v16
    v_mfma_f32_16x16x32_bf16 v[112:115], v[68:71], v[48:51], v[112:115]
    ds_read_b64_tr_b16 v[66:67], v7 offset:20992
    v_mfma_f32_16x16x32_bf16 v[116:119], v[68:71], v[52:55], v[116:119]
    v_add_u32 v15, s80, v17
    v_mfma_f32_16x16x32_bf16 v[120:123], v[40:43], v[72:75], v[120:123]
    ds_read_b64_tr_b16 v[68:69], v6 offset:32768
    v_mfma_f32_16x16x32_bf16 v[124:127], v[44:47], v[72:75], v[124:127]
    s_add_u32 s84, s80, s95
    v_mfma_f32_16x16x32_bf16 v[128:131], v[48:51], v[72:75], v[128:131]
    ds_read_b64_tr_b16 v[70:71], v6 offset:33280
    v_mfma_f32_16x16x32_bf16 v[132:135], v[52:55], v[72:75], v[132:135]
    v_add_u32 v18, s84, v16
    v_mfma_f32_16x16x32_bf16 v[252:255], v[60:63], v[72:75], v[252:255]
    s_waitcnt lgkmcnt(6)
    v_mfma_f32_16x16x32_bf16 v[136:139], v[40:43], v[76:79], v[136:139]
    ds_read_b64_tr_b16 v[72:73], v6 offset:36864
    v_mfma_f32_16x16x32_bf16 v[140:143], v[44:47], v[76:79], v[140:143]
    v_add_u32 v19, s84, v17
    v_mfma_f32_16x16x32_bf16 v[144:147], v[48:51], v[76:79], v[144:147]
    ds_read_b64_tr_b16 v[74:75], v6 offset:37376
    v_mfma_f32_16x16x32_bf16 v[148:151], v[52:55], v[76:79], v[148:151]
    s_add_u32 s80, s80, 18432
    s_waitcnt lgkmcnt(6)
    v_mfma_f32_16x16x32_bf16 v[152:155], v[80:83], v[40:43], v[152:155]
    ds_read_b64_tr_b16 v[76:77], v7 offset:32768
    v_mfma_f32_16x16x32_bf16 v[156:159], v[80:83], v[44:47], v[156:159]
    s_cmp_ge_u32 s80, 153600
    s_cselect_b32 s84, 55296, 0
    v_mfma_f32_16x16x32_bf16 v[160:163], v[80:83], v[48:51], v[160:163]
    ds_read_b64_tr_b16 v[78:79], v7 offset:33280
    v_mfma_f32_16x16x32_bf16 v[164:167], v[80:83], v[52:55], v[164:167]
    s_sub_u32 s80, s80, s84
    s_waitcnt lgkmcnt(6)
    v_mfma_f32_16x16x32_bf16 v[168:171], v[64:67], v[40:43], v[168:171]
    ds_read_b64_tr_b16 v[80:81], v7 offset:36864
    v_mfma_f32_16x16x32_bf16 v[172:175], v[64:67], v[44:47], v[172:175]
    v_mfma_f32_16x16x32_bf16 v[176:179], v[64:67], v[48:51], v[176:179]
    ds_read_b64_tr_b16 v[82:83], v7 offset:37376
    v_mfma_f32_16x16x32_bf16 v[180:183], v[64:67], v[52:55], v[180:183]
    s_waitcnt lgkmcnt(6)
    v_mfma_f32_16x16x32_bf16 v[184:187], v[68:71], v[40:43], v[184:187]
    v_mfma_f32_16x16x32_bf16 v[188:191], v[68:71], v[44:47], v[188:191]
    v_mfma_f32_16x16x32_bf16 v[192:195], v[68:71], v[48:51], v[192:195]
    v_mfma_f32_16x16x32_bf16 v[196:199], v[68:71], v[52:55], v[196:199]
    s_waitcnt lgkmcnt(0)
    s_barrier
    v_mfma_f32_16x16x32_bf16 v[200:203], v[72:75], v[40:43], v[200:203]
    ds_read_b64_tr_b16 v[64:65], v4 offset:4096
    v_mfma_f32_16x16x32_bf16 v[204:207], v[72:75], v[44:47], v[204:207]
    ds_read_b64_tr_b16 v[66:67], v4 offset:4608
    v_mfma_f32_16x16x32_bf16 v[208:211], v[72:75], v[48:51], v[208:211]
    ds_read_b128 v[24:27], v14 offset:0
    v_mfma_f32_16x16x32_bf16 v[212:215], v[72:75], v[52:55], v[212:215]
    ds_read_b128 v[28:31], v14 offset:2048
    v_mfma_f32_16x16x32_bf16 v[216:219], v[76:79], v[40:43], v[216:219]
    ds_read_b128 v[32:35], v14 offset:4096
    v_mfma_f32_16x16x32_bf16 v[220:223], v[76:79], v[44:47], v[220:223]
    ds_read_b128 v[36:39], v14 offset:6144
    v_mfma_f32_16x16x32_bf16 v[224:227], v[76:79], v[48:51], v[224:227]
    ds_read_b64_tr_b16 v[68:69], v5 offset:4096
    v_mfma_f32_16x16x32_bf16 v[228:231], v[76:79], v[52:55], v[228:231]
    ds_read_b64_tr_b16 v[70:71], v5 offset:4608
    v_mfma_f32_16x16x32_bf16 v[232:235], v[80:83], v[40:43], v[232:235]
    ds_read_b64_tr_b16 v[72:73], v4 offset:8192
    v_mfma_f32_16x16x32_bf16 v[236:239], v[80:83], v[44:47], v[236:239]
    ds_read_b64_tr_b16 v[74:75], v4 offset:8704
    v_mfma_f32_16x16x32_bf16 v[240:243], v[80:83], v[48:51], v[240:243]
    ds_read_b128 v[56:59], v18
    v_mfma_f32_16x16x32_bf16 v[244:247], v[80:83], v[52:55], v[244:247]
    s_sub_u32 s34, s34, 1
    s_cmp_lg_u32 s34, 0
    s_cbranch_scc1 L_p2
    s_waitcnt lgkmcnt(8)
    v_mfma_f32_16x16x32_bf16 v[88:91], v[64:67], v[24:27], v[88:91]
    ds_read_b64_tr_b16 v[76:77], v5 offset:8192
    s_waitcnt lgkmcnt(8)
    v_mfma_f32_16x16x32_bf16 v[92:95], v[64:67], v[28:31], v[92:95]
    ds_read_b64_tr_b16 v[78:79], v5 offset:8704
    s_waitcnt lgkmcnt(8)
    v_mfma_f32_16x16x32_bf16 v[96:99], v[64:67], v[32:35], v[96:99]
    ds_read_b64_tr_b16 v[80:81], v4 offset:0
    s_waitcnt lgkmcnt(8)
    v_mfma_f32_16x16x32_bf16 v[100:103], v[64:67], v[36:39], v[100:103]
    ds_read_b64_tr_b16 v[82:83], v4 offset:512
    s_waitcnt lgkmcnt(4)
    v_mfma_f32_16x16x32_bf16 v[248:251], v[64:67], v[56:59], v[248:251]
    v_mfma_f32_16x16x32_bf16 v[104:107], v[68:71], v[24:27], v[104:107]
    ds_read_b64_tr_b16 v[64:65], v5 offset:0
    v_mfma_f32_16x16x32_bf16 v[108:111], v[68:71], v[28:31], v[108:111]
    v_mfma_f32_16x16x32_bf16 v[112:115], v[68:71], v[32:35], v[112:115]
    ds_read_b64_tr_b16 v[66:67], v5 offset:512
    v_mfma_f32_16x16x32_bf16 v[116:119], v[68:71], v[36:39], v[116:119]
    v_mfma_f32_16x16x32_bf16 v[120:123], v[24:27], v[72:75], v[120:123]
    ds_read_b64_tr_b16 v[68:69], v4 offset:12288
    v_mfma_f32_16x16x32_bf16 v[124:127], v[28:31], v[72:75], v[124:127]
    v_mfma_f32_16x16x32_bf16 v[128:131], v[32:35], v[72:75], v[128:131]
    ds_read_b64_tr_b16 v[70:71], v4 offset:12800
    v_mfma_f32_16x16x32_bf16 v[132:135], v[36:39], v[72:75], v[132:135]
    v_mfma_f32_16x16x32_bf16 v[252:255], v[56:59], v[72:75], v[252:255]
    s_waitcnt lgkmcnt(6)
    v_mfma_f32_16x16x32_bf16 v[136:139], v[24:27], v[76:79], v[136:139]
    ds_read_b64_tr_b16 v[72:73], v4 offset:16384
    v_mfma_f32_16x16x32_bf16 v[140:143], v[28:31], v[76:79], v[140:143]
    v_mfma_f32_16x16x32_bf16 v[144:147], v[32:35], v[76:79], v[144:147]
    ds_read_b64_tr_b16 v[74:75], v4 offset:16896
    v_mfma_f32_16x16x32_bf16 v[148:151], v[36:39], v[76:79], v[148:151]
    s_waitcnt lgkmcnt(6)
    v_mfma_f32_16x16x32_bf16 v[152:155], v[80:83], v[24:27], v[152:155]
    ds_read_b64_tr_b16 v[76:77], v5 offset:12288
    v_mfma_f32_16x16x32_bf16 v[156:159], v[80:83], v[28:31], v[156:159]
    v_mfma_f32_16x16x32_bf16 v[160:163], v[80:83], v[32:35], v[160:163]
    ds_read_b64_tr_b16 v[78:79], v5 offset:12800
    v_mfma_f32_16x16x32_bf16 v[164:167], v[80:83], v[36:39], v[164:167]
    s_waitcnt lgkmcnt(6)
    v_mfma_f32_16x16x32_bf16 v[168:171], v[64:67], v[24:27], v[168:171]
    ds_read_b64_tr_b16 v[80:81], v5 offset:16384
    v_mfma_f32_16x16x32_bf16 v[172:175], v[64:67], v[28:31], v[172:175]
    v_mfma_f32_16x16x32_bf16 v[176:179], v[64:67], v[32:35], v[176:179]
    ds_read_b64_tr_b16 v[82:83], v5 offset:16896
    v_mfma_f32_16x16x32_bf16 v[180:183], v[64:67], v[36:39], v[180:183]
    s_waitcnt lgkmcnt(6)
    v_mfma_f32_16x16x32_bf16 v[184:187], v[68:71], v[24:27], v[184:187]
    v_mfma_f32_16x16x32_bf16 v[188:191], v[68:71], v[28:31], v[188:191]
    v_mfma_f32_16x16x32_bf16 v[192:195], v[68:71], v[32:35], v[192:195]
    v_mfma_f32_16x16x32_bf16 v[196:199], v[68:71], v[36:39], v[196:199]
    s_waitcnt lgkmcnt(0)
    s_barrier
    v_mfma_f32_16x16x32_bf16 v[200:203], v[72:75], v[24:27], v[200:203]
    ds_read_b64_tr_b16 v[64:65], v4 offset:24576
    v_mfma_f32_16x16x32_bf16 v[204:207], v[72:75], v[28:31], v[204:207]
    ds_read_b64_tr_b16 v[66:67], v4 offset:25088
    v_mfma_f32_16x16x32_bf16 v[208:211], v[72:75], v[32:35], v[208:211]
    ds_read_b128 v[40:43], v15 offset:0
    v_mfma_f32_16x16x32_bf16 v[212:215], v[72:75], v[36:39], v[212:215]
    ds_read_b128 v[44:47], v15 offset:2048
    v_mfma_f32_16x16x32_bf16 v[216:219], v[76:79], v[24:27], v[216:219]
    ds_read_b128 v[48:51], v15 offset:4096
    v_mfma_f32_16x16x32_bf16 v[220:223], v[76:79], v[28:31], v[220:223]
    ds_read_b128 v[52:55], v15 offset:6144
    v_mfma_f32_16x16x32_bf16 v[224:227], v[76:79], v[32:35], v[224:227]
    ds_read_b64_tr_b16 v[68:69], v5 offset:24576
    v_mfma_f32_16x16x32_bf16 v[228:231], v[76:79], v[36:39], v[228:231]
    ds_read_b64_tr_b16 v[70:71], v5 offset:25088
    v_mfma_f32_16x16x32_bf16 v[232:235], v[80:83], v[24:27], v[232:235]
    ds_read_b64_tr_b16 v[72:73], v4 offset:28672
    v_mfma_f32_16x16x32_bf16 v[236:239], v[80:83], v[28:31], v[236:239]
    ds_read_b64_tr_b16 v[74:75], v4 offset:29184
    v_mfma_f32_16x16x32_bf16 v[240:243], v[80:83], v[32:35], v[240:243]
    ds_read_b128 v[60:63], v19
    v_mfma_f32_16x16x32_bf16 v[244:247], v[80:83], v[36:39], v[244:247]
    s_waitcnt lgkmcnt(8)
    v_mfma_f32_16x16x32_bf16 v[88:91], v[64:67], v[40:43], v[88:91]
    ds_read_b64_tr_b16 v[76:77], v5 offset:28672
    s_waitcnt lgkmcnt(8)
    v_mfma_f32_16x16x32_bf16 v[92:95], v[64:67], v[44:47], v[92:95]
    ds_read_b64_tr_b16 v[78:79], v5 offset:29184
    s_waitcnt lgkmcnt(8)
    v_mfma_f32_16x16x32_bf16 v[96:99], v[64:67], v[48:51], v[96:99]
    ds_read_b64_tr_b16 v[80:81], v4 offset:20480
    s_waitcnt lgkmcnt(8)
    v_mfma_f32_16x16x32_bf16 v[100:103], v[64:67], v[52:55], v[100:103]
    ds_read_b64_tr_b16 v[82:83], v4 offset:20992
    s_waitcnt lgkmcnt(4)
    v_mfma_f32_16x16x32_bf16 v[248:251], v[64:67], v[60:63], v[248:251]
    v_mfma_f32_16x16x32_bf16 v[104:107], v[68:71], v[40:43], v[104:107]
    ds_read_b64_tr_b16 v[64:65], v5 offset:20480
    v_mfma_f32_16x16x32_bf16 v[108:111], v[68:71], v[44:47], v[108:111]
    v_add_u32 v14, s80, v16
    v_mfma_f32_16x16x32_bf16 v[112:115], v[68:71], v[48:51], v[112:115]
    ds_read_b64_tr_b16 v[66:67], v5 offset:20992
    v_mfma_f32_16x16x32_bf16 v[116:119], v[68:71], v[52:55], v[116:119]
    v_add_u32 v15, s80, v17
    v_mfma_f32_16x16x32_bf16 v[120:123], v[40:43], v[72:75], v[120:123]
    ds_read_b64_tr_b16 v[68:69], v4 offset:32768
    v_mfma_f32_16x16x32_bf16 v[124:127], v[44:47], v[72:75], v[124:127]
    s_add_u32 s84, s80, s95
    v_mfma_f32_16x16x32_bf16 v[128:131], v[48:51], v[72:75], v[128:131]
    ds_read_b64_tr_b16 v[70:71], v4 offset:33280
    v_mfma_f32_16x16x32_bf16 v[132:135], v[52:55], v[72:75], v[132:135]
    v_add_u32 v18, s84, v16
    v_mfma_f32_16x16x32_bf16 v[252:255], v[60:63], v[72:75], v[252:255]
    s_waitcnt lgkmcnt(6)
    v_mfma_f32_16x16x32_bf16 v[136:139], v[40:43], v[76:79], v[136:139]
    ds_read_b64_tr_b16 v[72:73], v4 offset:36864
    v_mfma_f32_16x16x32_bf16 v[140:143], v[44:47], v[76:79], v[140:143]
    v_add_u32 v19, s84, v17
    v_mfma_f32_16x16x32_bf16 v[144:147], v[48:51], v[76:79], v[144:147]
    ds_read_b64_tr_b16 v[74:75], v4 offset:37376
    v_mfma_f32_16x16x32_bf16 v[148:151], v[52:55], v[76:79], v[148:151]
    s_add_u32 s80, s80, 18432
    s_waitcnt lgkmcnt(6)
    v_mfma_f32_16x16x32_bf16 v[152:155], v[80:83], v[40:43], v[152:155]
    ds_read_b64_tr_b16 v[76:77], v5 offset:32768
    v_mfma_f32_16x16x32_bf16 v[156:159], v[80:83], v[44:47], v[156:159]
    s_cmp_ge_u32 s80, 153600
    s_cselect_b32 s84, 55296, 0
    v_mfma_f32_16x16x32_bf16 v[160:163], v[80:83], v[48:51], v[160:163]
    ds_read_b64_tr_b16 v[78:79], v5 offset:33280
    v_mfma_f32_16x16x32_bf16 v[164:167], v[80:83], v[52:55], v[164:167]
    s_sub_u32 s80, s80, s84
    s_waitcnt lgkmcnt(6)
    v_mfma_f32_16x16x32_bf16 v[168:171], v[64:67], v[40:43], v[168:171]
    ds_read_b64_tr_b16 v[80:81], v5 offset:36864
    v_mfma_f32_16x16x32_bf16 v[172:175], v[64:67], v[44:47], v[172:175]
    v_mfma_f32_16x16x32_bf16 v[176:179], v[64:67], v[48:51], v[176:179]
    ds_read_b64_tr_b16 v[82:83], v5 offset:37376
    v_mfma_f32_16x16x32_bf16 v[180:183], v[64:67], v[52:55], v[180:183]
    s_waitcnt lgkmcnt(6)
    v_mfma_f32_16x16x32_bf16 v[184:187], v[68:71], v[40:43], v[184:187]
    v_mfma_f32_16x16x32_bf16 v[188:191], v[68:71], v[44:47], v[188:191]
    v_mfma_f32_16x16x32_bf16 v[192:195], v[68:71], v[48:51], v[192:195]
    v_mfma_f32_16x16x32_bf16 v[196:199], v[68:71], v[52:55], v[196:199]
    s_waitcnt lgkmcnt(0)
    s_barrier
    v_mfma_f32_16x16x32_bf16 v[200:203], v[72:75], v[40:43], v[200:203]
    ds_read_b64_tr_b16 v[64:65], v6 offset:4096
    v_mfma_f32_16x16x32_bf16 v[204:207], v[72:75], v[44:47], v[204:207]
    ds_read_b64_tr_b16 v[66:67], v6 offset:4608
    v_mfma_f32_16x16x32_bf16 v[208:211], v[72:75], v[48:51], v[208:211]
    ds_read_b128 v[24:27], v14 offset:0
    v_mfma_f32_16x16x32_bf16 v[212:215], v[72:75], v[52:55], v[212:215]
    ds_read_b128 v[28:31], v14 offset:2048
    v_mfma_f32_16x16x32_bf16 v[216:219], v[76:79], v[40:43], v[216:219]
    ds_read_b128 v[32:35], v14 offset:4096
    v_mfma_f32_16x16x32_bf16 v[220:223], v[76:79], v[44:47], v[220:223]
    ds_read_b128 v[36:39], v14 offset:6144
    v_mfma_f32_16x16x32_bf16 v[224:227], v[76:79], v[48:51], v[224:227]
    ds_read_b64_tr_b16 v[68:69], v7 offset:4096
    v_mfma_f32_16x16x32_bf16 v[228:231], v[76:79], v[52:55], v[228:231]
    ds_read_b64_tr_b16 v[70:71], v7 offset:4608
    v_mfma_f32_16x16x32_bf16 v[232:235], v[80:83], v[40:43], v[232:235]
    ds_read_b64_tr_b16 v[72:73], v6 offset:8192
    v_mfma_f32_16x16x32_bf16 v[236:239], v[80:83], v[44:47], v[236:239]
    ds_read_b64_tr_b16 v[74:75], v6 offset:8704
    v_mfma_f32_16x16x32_bf16 v[240:243], v[80:83], v[48:51], v[240:243]
    ds_read_b128 v[56:59], v18
    v_mfma_f32_16x16x32_bf16 v[244:247], v[80:83], v[52:55], v[244:247]
    s_waitcnt lgkmcnt(8)
    v_mfma_f32_16x16x32_bf16 v[88:91], v[64:67], v[24:27], v[88:91]
    ds_read_b64_tr_b16 v[76:77], v7 offset:8192
    s_waitcnt lgkmcnt(8)
    v_mfma_f32_16x16x32_bf16 v[92:95], v[64:67], v[28:31], v[92:95]
    ds_read_b64_tr_b16 v[78:79], v7 offset:8704
    s_waitcnt lgkmcnt(8)
    v_mfma_f32_16x16x32_bf16 v[96:99], v[64:67], v[32:35], v[96:99]
    ds_read_b64_tr_b16 v[80:81], v6 offset:0
    s_waitcnt lgkmcnt(8)
    v_mfma_f32_16x16x32_bf16 v[100:103], v[64:67], v[36:39], v[100:103]
    ds_read_b64_tr_b16 v[82:83], v6 offset:512
    s_waitcnt lgkmcnt(4)
    v_mfma_f32_16x16x32_bf16 v[248:251], v[64:67], v[56:59], v[248:251]
    v_mfma_f32_16x16x32_bf16 v[104:107], v[68:71], v[24:27], v[104:107]
    ds_read_b64_tr_b16 v[64:65], v7 offset:0
    v_mfma_f32_16x16x32_bf16 v[108:111], v[68:71], v[28:31], v[108:111]
    v_mfma_f32_16x16x32_bf16 v[112:115], v[68:71], v[32:35], v[112:115]
    ds_read_b64_tr_b16 v[66:67], v7 offset:512
    v_mfma_f32_16x16x32_bf16 v[116:119], v[68:71], v[36:39], v[116:119]
    v_mfma_f32_16x16x32_bf16 v[120:123], v[24:27], v[72:75], v[120:123]
    ds_read_b64_tr_b16 v[68:69], v6 offset:12288
    v_mfma_f32_16x16x32_bf16 v[124:127], v[28:31], v[72:75], v[124:127]
    v_mfma_f32_16x16x32_bf16 v[128:131], v[32:35], v[72:75], v[128:131]
    ds_read_b64_tr_b16 v[70:71], v6 offset:12800
    v_mfma_f32_16x16x32_bf16 v[132:135], v[36:39], v[72:75], v[132:135]
    v_mfma_f32_16x16x32_bf16 v[252:255], v[56:59], v[72:75], v[252:255]
    s_waitcnt lgkmcnt(6)
    v_mfma_f32_16x16x32_bf16 v[136:139], v[24:27], v[76:79], v[136:139]
L_pad9:
    s_cbranch_execz L_vret1
    ds_read_b64_tr_b16 v[72:73], v6 offset:16384
    v_mfma_f32_16x16x32_bf16 v[140:143], v[28:31], v[76:79], v[140:143]
    v_mfma_f32_16x16x32_bf16 v[144:147], v[32:35], v[76:79], v[144:147]
    ds_read_b64_tr_b16 v[74:75], v6 offset:16896
    v_mfma_f32_16x16x32_bf16 v[148:151], v[36:39], v[76:79], v[148:151]
    s_waitcnt lgkmcnt(6)
    v_mfma_f32_16x16x32_bf16 v[152:155], v[80:83], v[24:27], v[152:155]
    ds_read_b64_tr_b16 v[76:77], v7 offset:12288
    v_mfma_f32_16x16x32_bf16 v[156:159], v[80:83], v[28:31], v[156:159]
    v_mfma_f32_16x16x32_bf16 v[160:163], v[80:83], v[32:35], v[160:163]
    ds_read_b64_tr_b16 v[78:79], v7 offset:12800
    v_mfma_f32_16x16x32_bf16 v[164:167], v[80:83], v[36:39], v[164:167]
    s_waitcnt lgkmcnt(6)
    v_mfma_f32_16x16x32_bf16 v[168:171], v[64:67], v[24:27], v[168:171]
    ds_read_b64_tr_b16 v[80:81], v7 offset:16384
    v_mfma_f32_16x16x32_bf16 v[172:175], v[64:67], v[28:31], v[172:175]
    v_mfma_f32_16x16x32_bf16 v[176:179], v[64:67], v[32:35], v[176:179]
    ds_read_b64_tr_b16 v[82:83], v7 offset:16896
    v_mfma_f32_16x16x32_bf16 v[180:183], v[64:67], v[36:39], v[180:183]
    s_waitcnt lgkmcnt(6)
    v_mfma_f32_16x16x32_bf16 v[184:187], v[68:71], v[24:27], v[184:187]
    v_mfma_f32_16x16x32_bf16 v[188:191], v[68:71], v[28:31], v[188:191]
    v_mfma_f32_16x16x32_bf16 v[192:195], v[68:71], v[32:35], v[192:195]
    v_mfma_f32_16x16x32_bf16 v[196:199], v[68:71], v[36:39], v[196:199]
    s_waitcnt lgkmcnt(0)
    s_barrier
    v_mfma_f32_16x16x32_bf16 v[200:203], v[72:75], v[24:27], v[200:203]
    ds_read_b64_tr_b16 v[64:65], v6 offset:24576
    v_mfma_f32_16x16x32_bf16 v[204:207], v[72:75], v[28:31], v[204:207]
    ds_read_b64_tr_b16 v[66:67], v6 offset:25088
    v_mfma_f32_16x16x32_bf16 v[208:211], v[72:75], v[32:35], v[208:211]
    ds_read_b128 v[40:43], v15 offset:0
    v_mfma_f32_16x16x32_bf16 v[212:215], v[72:75], v[36:39], v[212:215]
    ds_read_b128 v[44:47], v15 offset:2048
    v_mfma_f32_16x16x32_bf16 v[216:219], v[76:79], v[24:27], v[216:219]
    ds_read_b128 v[48:51], v15 offset:4096
    v_mfma_f32_16x16x32_bf16 v[220:223], v[76:79], v[28:31], v[220:223]
    ds_read_b128 v[52:55], v15 offset:6144
    v_mfma_f32_16x16x32_bf16 v[224:227], v[76:79], v[32:35], v[224:227]
    ds_read_b64_tr_b16 v[68:69], v7 offset:24576
    v_mfma_f32_16x16x32_bf16 v[228:231], v[76:79], v[36:39], v[228:231]
    ds_read_b64_tr_b16 v[70:71], v7 offset:25088
    v_mfma_f32_16x16x32_bf16 v[232:235], v[80:83], v[24:27], v[232:235]
    ds_read_b64_tr_b16 v[72:73], v6 offset:28672
    v_mfma_f32_16x16x32_bf16 v[236:239], v[80:83], v[28:31], v[236:239]
    ds_read_b64_tr_b16 v[74:75], v6 offset:29184
    v_mfma_f32_16x16x32_bf16 v[240:243], v[80:83], v[32:35], v[240:243]
    ds_read_b128 v[60:63], v19
    v_mfma_f32_16x16x32_bf16 v[244:247], v[80:83], v[36:39], v[244:247]
    s_waitcnt lgkmcnt(8)
    v_mfma_f32_16x16x32_bf16 v[88:91], v[64:67], v[40:43], v[88:91]
    ds_read_b64_tr_b16 v[76:77], v7 offset:28672
    s_waitcnt lgkmcnt(8)
    v_mfma_f32_16x16x32_bf16 v[92:95], v[64:67], v[44:47], v[92:95]
    ds_read_b64_tr_b16 v[78:79], v7 offset:29184
    s_waitcnt lgkmcnt(8)
    v_mfma_f32_16x16x32_bf16 v[96:99], v[64:67], v[48:51], v[96:99]
    ds_read_b64_tr_b16 v[80:81], v6 offset:20480
    s_waitcnt lgkmcnt(8)
    v_mfma_f32_16x16x32_bf16 v[100:103], v[64:67], v[52:55], v[100:103]
    ds_read_b64_tr_b16 v[82:83], v6 offset:20992
    s_waitcnt lgkmcnt(4)
    v_mfma_f32_16x16x32_bf16 v[248:251], v[64:67], v[60:63], v[248:251]
    v_mfma_f32_16x16x32_bf16 v[104:107], v[68:71], v[40:43], v[104:107]
    ds_read_b64_tr_b16 v[64:65], v7 offset:20480
    v_mfma_f32_16x16x32_bf16 v[108:111], v[68:71], v[44:47], v[108:111]
    v_mfma_f32_16x16x32_bf16 v[112:115], v[68:71], v[48:51], v[112:115]
    ds_read_b64_tr_b16 v[66:67], v7 offset:20992
    v_mfma_f32_16x16x32_bf16 v[116:119], v[68:71], v[52:55], v[116:119]
    v_mfma_f32_16x16x32_bf16 v[120:123], v[40:43], v[72:75], v[120:123]
    ds_read_b64_tr_b16 v[68:69], v6 offset:32768
    v_mfma_f32_16x16x32_bf16 v[124:127], v[44:47], v[72:75], v[124:127]
    v_mfma_f32_16x16x32_bf16 v[128:131], v[48:51], v[72:75], v[128:131]
    ds_read_b64_tr_b16 v[70:71], v6 offset:33280
    v_mfma_f32_16x16x32_bf16 v[132:135], v[52:55], v[72:75], v[132:135]
    v_mfma_f32_16x16x32_bf16 v[252:255], v[60:63], v[72:75], v[252:255]
    s_waitcnt lgkmcnt(6)
    v_mfma_f32_16x16x32_bf16 v[136:139], v[40:43], v[76:79], v[136:139]
    ds_read_b64_tr_b16 v[72:73], v6 offset:36864
    v_mfma_f32_16x16x32_bf16 v[140:143], v[44:47], v[76:79], v[140:143]
    v_mfma_f32_16x16x32_bf16 v[144:147], v[48:51], v[76:79], v[144:147]
    ds_read_b64_tr_b16 v[74:75], v6 offset:37376
    v_mfma_f32_16x16x32_bf16 v[148:151], v[52:55], v[76:79], v[148:151]
    s_waitcnt lgkmcnt(6)
    v_mfma_f32_16x16x32_bf16 v[152:155], v[80:83], v[40:43], v[152:155]
    ds_read_b64_tr_b16 v[76:77], v7 offset:32768
    v_mfma_f32_16x16x32_bf16 v[156:159], v[80:83], v[44:47], v[156:159]
    v_mfma_f32_16x16x32_bf16 v[160:163], v[80:83], v[48:51], v[160:163]
    ds_read_b64_tr_b16 v[78:79], v7 offset:33280
    v_mfma_f32_16x16x32_bf16 v[164:167], v[80:83], v[52:55], v[164:167]
    s_waitcnt lgkmcnt(6)
    v_mfma_f32_16x16x32_bf16 v[168:171], v[64:67], v[40:43], v[168:171]
    ds_read_b64_tr_b16 v[80:81], v7 offset:36864
    v_mfma_f32_16x16x32_bf16 v[172:175], v[64:67], v[44:47], v[172:175]
    v_mfma_f32_16x16x32_bf16 v[176:179], v[64:67], v[48:51], v[176:179]
    ds_read_b64_tr_b16 v[82:83], v7 offset:37376
    v_mfma_f32_16x16x32_bf16 v[180:183], v[64:67], v[52:55], v[180:183]
    s_waitcnt lgkmcnt(6)
    v_mfma_f32_16x16x32_bf16 v[184:187], v[68:71], v[40:43], v[184:187]
    v_mfma_f32_16x16x32_bf16 v[188:191], v[68:71], v[44:47], v[188:191]
    v_mfma_f32_16x16x32_bf16 v[192:195], v[68:71], v[48:51], v[192:195]
    v_mfma_f32_16x16x32_bf16 v[196:199], v[68:71], v[52:55], v[196:199]
    s_waitcnt lgkmcnt(0)
    s_barrier
    v_mfma_f32_16x16x32_bf16 v[200:203], v[72:75], v[40:43], v[200:203]
    v_mfma_f32_16x16x32_bf16 v[204:207], v[72:75], v[44:47], v[204:207]
    v_mfma_f32_16x16x32_bf16 v[208:211], v[72:75], v[48:51], v[208:211]
    v_mfma_f32_16x16x32_bf16 v[212:215], v[72:75], v[52:55], v[212:215]
    v_mfma_f32_16x16x32_bf16 v[216:219], v[76:79], v[40:43], v[216:219]
    v_mfma_f32_16x16x32_bf16 v[220:223], v[76:79], v[44:47], v[220:223]
    v_mfma_f32_16x16x32_bf16 v[224:227], v[76:79], v[48:51], v[224:227]
    v_mfma_f32_16x16x32_bf16 v[228:231], v[76:79], v[52:55], v[228:231]
    v_mfma_f32_16x16x32_bf16 v[232:235], v[80:83], v[40:43], v[232:235]
    v_mfma_f32_16x16x32_bf16 v[236:239], v[80:83], v[44:47], v[236:239]
    v_mfma_f32_16x16x32_bf16 v[240:243], v[80:83], v[48:51], v[240:243]
    v_mfma_f32_16x16x32_bf16 v[244:247], v[80:83], v[52:55], v[244:247]
    s_setprio 0
    s_mov_b32 s76, 0xbdd2d3e8
    v_cvt_pk_bf16_f32 v100, v100, v101
    v_cvt_pk_bf16_f32 v101, v102, v103
    v_cvt_pk_bf16_f32 v102, v116, v117
    v_cvt_pk_bf16_f32 v103, v118, v119
    v_cvt_pk_bf16_f32 v32, v132, v133
    v_cvt_pk_bf16_f32 v33, v134, v135
    v_cvt_pk_bf16_f32 v42, v148, v149
    v_cvt_pk_bf16_f32 v43, v150, v151
    v_cvt_pk_bf16_f32 v44, v248, v249
    v_cvt_pk_bf16_f32 v45, v250, v251
    v_cvt_pk_bf16_f32 v24, v252, v253
    v_cvt_pk_bf16_f32 v25, v254, v255
    s_cmp_lg_u32 s5, 0
    s_cbranch_scc1 L_hx1
    ds_write_b64 v85, v[100:101]
    ds_write_b64 v85, v[102:103] offset:512
    ds_write_b64 v85, v[32:33] offset:1024
    ds_write_b64 v85, v[42:43] offset:1536
    s_branch L_hx2
L_hx1:
    ds_write_b64 v85, v[44:45] offset:2048
    ds_write_b64 v85, v[24:25] offset:2560
L_hx2:
    s_waitcnt lgkmcnt(0)
    v_mul_f32 v80, v184, v184
    v_mul_f32 v81, v185, v185
    v_mul_f32 v82, v186, v186
    v_mul_f32 v83, v187, v187
    v_fma_f32 v80, v80, s76, v84
    v_fma_f32 v81, v81, s76, v84
    v_fma_f32 v82, v82, s76, v84
    v_fma_f32 v83, v83, s76, v84
    v_mul_f32 v80, v80, v184
    v_mul_f32 v81, v81, v185
    v_mul_f32 v82, v82, v186
    v_mul_f32 v83, v83, v187
    v_exp_f32 v80, v80
    v_mul_f32 v184, v184, v200
    v_exp_f32 v81, v81
    v_mul_f32 v185, v185, v201
    v_exp_f32 v82, v82
    v_mul_f32 v186, v186, v202
    v_exp_f32 v83, v83
    v_mul_f32 v187, v187, v203
    v_add_f32 v80, 1.0, v80
    v_add_f32 v81, 1.0, v81
    v_add_f32 v82, 1.0, v82
    v_add_f32 v83, 1.0, v83
    v_rcp_f32 v80, v80
    v_rcp_f32 v81, v81
    v_rcp_f32 v82, v82
    v_rcp_f32 v83, v83
    s_nop 0
    v_mul_f32 v184, v184, v80
    v_mul_f32 v185, v185, v81
    v_mul_f32 v186, v186, v82
    v_mul_f32 v187, v187, v83
    v_cvt_pk_bf16_f32 v184, v184, v185
    v_cvt_pk_bf16_f32 v185, v186, v187
    v_mul_f32 v80, v188, v188
    v_mul_f32 v81, v189, v189
    v_mul_f32 v82, v190, v190
    v_mul_f32 v83, v191, v191
    v_fma_f32 v80, v80, s76, v84
    v_fma_f32 v81, v81, s76, v84
    v_fma_f32 v82, v82, s76, v84
    v_fma_f32 v83, v83, s76, v84
    v_mul_f32 v80, v80, v188
    v_mul_f32 v81, v81, v189
    v_mul_f32 v82, v82, v190
    v_mul_f32 v83, v83, v191
    v_exp_f32 v80, v80
    v_mul_f32 v188, v188, v204
    v_exp_f32 v81, v81
    v_mul_f32 v189, v189, v205
    v_exp_f32 v82, v82
    v_mul_f32 v190, v190, v206
    v_exp_f32 v83, v83
    v_mul_f32 v191, v191, v207
    v_add_f32 v80, 1.0, v80
    v_add_f32 v81, 1.0, v81
    v_add_f32 v82, 1.0, v82
    v_add_f32 v83, 1.0, v83
    v_rcp_f32 v80, v80
    v_rcp_f32 v81, v81
    v_rcp_f32 v82, v82
    s_barrier
    s_cmp_lg_u32 s5, 0
    s_cbranch_scc1 L_hx3
    ds_read_b64 v[46:47], v85 offset:2048
    ds_read_b64 v[34:35], v85 offset:2560
    s_branch L_hx4
L_hx3:
    ds_read_b64 v[44:45], v85 offset:512
    ds_read_b64 v[46:47], v85
    ds_read_b64 v[24:25], v85 offset:1536
    ds_read_b64 v[34:35], v85 offset:1024
L_hx4:
    v_rcp_f32 v83, v83
    s_nop 0
    v_mul_f32 v188, v188, v80
    v_mul_f32 v189, v189, v81
    v_mul_f32 v190, v190, v82
    v_mul_f32 v191, v191, v83
    v_cvt_pk_bf16_f32 v186, v188, v189
    v_cvt_pk_bf16_f32 v187, v190, v191
    s_nop 1
    v_permlane16_swap_b32 v184, v186
    v_permlane16_swap_b32 v185, v187
    buffer_store_dwordx4 v[184:187], v8, s[68:71], s73 offen offset:0 sc1
    v_mul_f32 v80, v192, v192
    v_mul_f32 v81, v193, v193
    v_mul_f32 v82, v194, v194
    v_mul_f32 v83, v195, v195
    v_fma_f32 v80, v80, s76, v84
    v_fma_f32 v81, v81, s76, v84
    v_fma_f32 v82, v82, s76, v84
    v_fma_f32 v83, v83, s76, v84
    v_mul_f32 v80, v80, v192
    v_mul_f32 v81, v81, v193
    v_mul_f32 v82, v82, v194
    v_mul_f32 v83, v83, v195
    v_exp_f32 v80, v80
    v_mul_f32 v192, v192, v208
    v_exp_f32 v81, v81
    v_mul_f32 v193, v193, v209
    v_exp_f32 v82, v82
    v_mul_f32 v194, v194, v210
    v_exp_f32 v83, v83
    v_mul_f32 v195, v195, v211
    v_add_f32 v80, 1.0, v80
    v_add_f32 v81, 1.0, v81
    v_add_f32 v82, 1.0, v82
    v_add_f32 v83, 1.0, v83
    v_rcp_f32 v80, v80
    v_rcp_f32 v81, v81
    v_rcp_f32 v82, v82
    v_rcp_f32 v83, v83
    s_nop 0
    v_mul_f32 v192, v192, v80
    v_mul_f32 v193, v193, v81
    v_mul_f32 v194, v194, v82
    v_mul_f32 v195, v195, v83
    v_cvt_pk_bf16_f32 v192, v192, v193
    v_cvt_pk_bf16_f32 v193, v194, v195
    v_mul_f32 v80, v196, v196
    v_mul_f32 v81, v197, v197
    v_mul_f32 v82, v198, v198
    v_mul_f32 v83, v199, v199
    v_fma_f32 v80, v80, s76, v84
    v_fma_f32 v81, v81, s76, v84
    v_fma_f32 v82, v82, s76, v84
    v_fma_f32 v83, v83, s76, v84
    v_mul_f32 v80, v80, v196
    v_mul_f32 v81, v81, v197
    v_mul_f32 v82, v82, v198
    v_mul_f32 v83, v83, v199
    v_exp_f32 v80, v80
    v_mul_f32 v196, v196, v212
    v_exp_f32 v81, v81
    v_mul_f32 v197, v197, v213
    v_exp_f32 v82, v82
    v_mul_f32 v198, v198, v214
    v_exp_f32 v83, v83
    v_mul_f32 v199, v199, v215
    v_add_f32 v80, 1.0, v80
    s_barrier
    s_waitcnt lgkmcnt(0)
    v_add_f32 v81, 1.0, v81
    v_add_f32 v82, 1.0, v82
    v_add_f32 v83, 1.0, v83
    v_rcp_f32 v80, v80
    v_rcp_f32 v81, v81
    v_rcp_f32 v82, v82
    v_rcp_f32 v83, v83
    s_nop 0
    v_mul_f32 v196, v196, v80
    v_mul_f32 v197, v197, v81
    v_mul_f32 v198, v198, v82
    v_mul_f32 v199, v199, v83
    v_cvt_pk_bf16_f32 v194, v196, v197
    v_cvt_pk_bf16_f32 v195, v198, v199
    s_nop 1
    v_permlane16_swap_b32 v192, v194
    v_permlane16_swap_b32 v193, v195
    buffer_store_dwordx4 v[192:195], v8, s[68:71], s73 offen offset:2048 sc1
    v_mul_f32 v80, v216, v216
    v_mul_f32 v81, v217, v217
    v_mul_f32 v82, v218, v218
    v_mul_f32 v83, v219, v219
    v_fma_f32 v80, v80, s76, v84
    v_fma_f32 v81, v81, s76, v84
    v_fma_f32 v82, v82, s76, v84
    v_fma_f32 v83, v83, s76, v84
    v_mul_f32 v80, v80, v216
    v_mul_f32 v81, v81, v217
    v_mul_f32 v82, v82, v218
    v_mul_f32 v83, v83, v219
    v_exp_f32 v80, v80
    v_mul_f32 v216, v216, v232
    v_exp_f32 v81, v81
    v_mul_f32 v217, v217, v233
    v_exp_f32 v82, v82
    v_mul_f32 v218, v218, v234
    v_exp_f32 v83, v83
    v_mul_f32 v219, v219, v235
    v_add_f32 v80, 1.0, v80
    v_add_f32 v81, 1.0, v81
    v_add_f32 v82, 1.0, v82
    v_add_f32 v83, 1.0, v83
    v_rcp_f32 v80, v80
    v_rcp_f32 v81, v81
    v_rcp_f32 v82, v82
    v_rcp_f32 v83, v83
    s_nop 0
    v_mul_f32 v216, v216, v80
    v_mul_f32 v217, v217, v81
    v_mul_f32 v218, v218, v82
    v_mul_f32 v219, v219, v83
    v_cvt_pk_bf16_f32 v216, v216, v217
    v_cvt_pk_bf16_f32 v217, v218, v219
    v_mul_f32 v80, v220, v220
    v_mul_f32 v81, v221, v221
    v_mul_f32 v82, v222, v222
    v_mul_f32 v83, v223, v223
    v_fma_f32 v80, v80, s76, v84
    v_fma_f32 v81, v81, s76, v84
    v_fma_f32 v82, v82, s76, v84
    v_fma_f32 v83, v83, s76, v84
    v_mul_f32 v80, v80, v220
    v_mul_f32 v81, v81, v221
    v_mul_f32 v82, v82, v222
    v_mul_f32 v83, v83, v223
    v_exp_f32 v80, v80
    v_mul_f32 v220, v220, v236
    v_exp_f32 v81, v81
    s_lshl2_add_u32 s91, s2, s4
    s_lshl_b32 s39, s91, 9
    s_lshr_b32 s92, s91, 2
    s_mul_i32 s92, s92, 7168
    s_and_b32 s91, s91, 3
    s_lshl_b32 s91, s91, 9
    s_add_u32 s92, s92, s91
    s_add_u32 s34, s92, 5120
    s_add_u32 s39, s39, 0x180080
    s_load_dword s94, s[20:21], s39 offset:0x0
    s_load_dword s94, s[20:21], s39 offset:0x40
    s_load_dword s94, s[20:21], s39 offset:0x80
    s_load_dword s94, s[20:21], s39 offset:0xc0
    s_load_dword s94, s[20:21], s39 offset:0x100
    s_barrier
    v_mul_f32 v221, v221, v237
    v_exp_f32 v82, v82
    v_mul_f32 v222, v222, v238
    v_exp_f32 v83, v83
    v_mul_f32 v223, v223, v239
    v_add_f32 v80, 1.0, v80
    v_add_f32 v81, 1.0, v81
    v_add_f32 v82, 1.0, v82
    v_add_f32 v83, 1.0, v83
    v_rcp_f32 v80, v80
    v_rcp_f32 v81, v81
    v_rcp_f32 v82, v82
    v_rcp_f32 v83, v83
    s_nop 0
    v_mul_f32 v220, v220, v80
    v_mul_f32 v221, v221, v81
    v_mul_f32 v222, v222, v82
    v_mul_f32 v223, v223, v83
    v_cvt_pk_bf16_f32 v218, v220, v221
    v_cvt_pk_bf16_f32 v219, v222, v223
    s_nop 1
    v_permlane16_swap_b32 v216, v218
    v_permlane16_swap_b32 v217, v219
    buffer_store_dwordx4 v[216:219], v8, s[68:71], s74 offen offset:0 sc1
    v_mul_f32 v80, v224, v224
    v_mul_f32 v81, v225, v225
    v_mul_f32 v82, v226, v226
    v_mul_f32 v83, v227, v227
    v_fma_f32 v80, v80, s76, v84
    v_fma_f32 v81, v81, s76, v84
    v_fma_f32 v82, v82, s76, v84
    v_fma_f32 v83, v83, s76, v84
    v_mul_f32 v80, v80, v224
    v_mul_f32 v81, v81, v225
    v_mul_f32 v82, v82, v226
    v_mul_f32 v83, v83, v227
    v_exp_f32 v80, v80
    v_mul_f32 v224, v224, v240
    v_exp_f32 v81, v81
    v_mul_f32 v225, v225, v241
    v_exp_f32 v82, v82
    v_mul_f32 v226, v226, v242
    v_exp_f32 v83, v83
    v_mul_f32 v227, v227, v243
    v_add_f32 v80, 1.0, v80
    v_add_f32 v81, 1.0, v81
    v_add_f32 v82, 1.0, v82
    v_add_f32 v83, 1.0, v83
    v_rcp_f32 v80, v80
    v_rcp_f32 v81, v81
    v_rcp_f32 v82, v82
    v_rcp_f32 v83, v83
    s_nop 0
    v_mul_f32 v224, v224, v80
    v_mul_f32 v225, v225, v81
    v_mul_f32 v226, v226, v82
    v_mul_f32 v227, v227, v83
    v_cvt_pk_bf16_f32 v224, v224, v225
    v_cvt_pk_bf16_f32 v225, v226, v227
    v_mul_f32 v80, v228, v228
    v_mul_f32 v81, v229, v229
    v_mul_f32 v82, v230, v230
    v_mul_f32 v83, v231, v231
    v_fma_f32 v80, v80, s76, v84
    v_fma_f32 v81, v81, s76, v84
    v_fma_f32 v82, v82, s76, v84
    v_fma_f32 v83, v83, s76, v84
    s_load_dword s94, s[20:21], s39 offset:0x140
    s_add_u32 s39, s39, 0x27ff80
    s_load_dword s94, s[20:21], s39 offset:0x0
    s_load_dword s94, s[20:21], s39 offset:0x40
    s_load_dword s94, s[20:21], s39 offset:0x80
    s_load_dword s94, s[20:21], s39 offset:0xc0
    s_barrier
    v_mul_f32 v80, v80, v228
    v_mul_f32 v81, v81, v229
    v_mul_f32 v82, v82, v230
    v_mul_f32 v83, v83, v231
    v_exp_f32 v80, v80
    v_mul_f32 v228, v228, v244
    v_exp_f32 v81, v81
    v_mul_f32 v229, v229, v245
    v_exp_f32 v82, v82
    v_mul_f32 v230, v230, v246
    v_exp_f32 v83, v83
    v_mul_f32 v231, v231, v247
    v_add_f32 v80, 1.0, v80
    v_add_f32 v81, 1.0, v81
    v_add_f32 v82, 1.0, v82
    v_add_f32 v83, 1.0, v83
    v_rcp_f32 v80, v80
    v_rcp_f32 v81, v81
    v_rcp_f32 v82, v82
    v_rcp_f32 v83, v83
    s_nop 0
    v_mul_f32 v228, v228, v80
    v_mul_f32 v229, v229, v81
    v_mul_f32 v230, v230, v82
    v_mul_f32 v231, v231, v83
    v_cvt_pk_bf16_f32 v226, v228, v229
    v_cvt_pk_bf16_f32 v227, v230, v231
    s_nop 1
    v_permlane16_swap_b32 v224, v226
    v_permlane16_swap_b32 v225, v227
    buffer_store_dwordx4 v[224:227], v8, s[68:71], s74 offen offset:2048 sc1
    v_lshrrev_b32 v64, 4, v1
    v_and_b32 v66, 14, v1
    v_lshlrev_b32 v64, 2, v64
    v_sub_u32 v64, v66, v64
    v_and_b32 v65, 1, v1
    v_cmp_le_i32 s[40:41], 0, v64
    v_cmp_le_i32 s[42:43], 2, v64
    v_mul_u32_u24 v66, 0x202, v65
    s_mov_b32 s80, 0x01000c0c
    v_lshl_add_u32 v66, v66, 16, s80
    v_add_u32 v67, 0x04040000, v66
    v_cndmask_b32 v76, v66, v67, s[40:41]
    v_cndmask_b32 v77, v66, v67, s[42:43]
    v_lshlrev_b32 v65, 4, v65
    v_mov_b32 v68, 0x0c0c0c0c
    v_mov_b32 v66, 0xc0c0100
    v_alignbit_b32 v66, v66, v66, v65
    v_cndmask_b32 v78, v66, v68, s[40:41]
    v_cndmask_b32 v86, v68, v66, s[40:41]
    v_mov_b32 v66, 0xc0c0302
    v_alignbit_b32 v66, v66, v66, v65
    v_cndmask_b32 v79, v66, v68, s[42:43]
    v_cndmask_b32 v87, v68, v66, s[42:43]
    s_or_b32 s80, s28, s5
    s_cmp_eq_u32 s80, 0
    s_cselect_b64 s[80:81], 0, -1
    s_or_b64 s[40:41], s[40:41], s[80:81]
    s_or_b64 s[42:43], s[42:43], s[80:81]
    v_mov_b32 v7, 0xce6e6b28
    s_mov_b32 s77, 0x3e3504f3
    s_mov_b32 s78, 0x3fb8aa3b
    v_cvt_pk_bf16_f32 v88, v88, v89
    v_cvt_pk_bf16_f32 v89, v90, v91
    v_cvt_pk_bf16_f32 v90, v104, v105
    v_cvt_pk_bf16_f32 v91, v106, v107
    v_cvt_pk_bf16_f32 v152, v152, v153
    v_cvt_pk_bf16_f32 v153, v154, v155
    v_cvt_pk_bf16_f32 v154, v168, v169
    v_cvt_pk_bf16_f32 v155, v170, v171
    v_cvt_pk_bf16_f32 v92, v92, v93
    v_cvt_pk_bf16_f32 v93, v94, v95
    v_cvt_pk_bf16_f32 v94, v108, v109
    v_cvt_pk_bf16_f32 v95, v110, v111
    v_cvt_pk_bf16_f32 v156, v156, v157
    v_cvt_pk_bf16_f32 v157, v158, v159
    v_cvt_pk_bf16_f32 v158, v172, v173
    v_cvt_pk_bf16_f32 v159, v174, v175
    s_load_dword s94, s[20:21], s39 offset:0x100
    s_load_dword s94, s[20:21], s39 offset:0x140
    s_load_dword s94, s[20:21], s39 offset:0x180
    s_load_dword s94, s[20:21], s39 offset:0x1c0
    s_add_u32 s39, s39, 0xffe00000
    s_load_dword s94, s[20:21], s39 offset:0x0
    s_barrier
    s_setprio 3
    v_mfma_f32_16x16x32_bf16 v[48:51], v[44:47], v[152:155], 0
    v_mfma_f32_16x16x32_bf16 v[52:55], v[88:91], v[152:155], 0
    s_setprio 0
    v_cvt_pk_bf16_f32 v96, v96, v97
    v_cvt_pk_bf16_f32 v97, v98, v99
    v_cvt_pk_bf16_f32 v98, v112, v113
    v_cvt_pk_bf16_f32 v99, v114, v115
    v_cvt_pk_bf16_f32 v160, v160, v161
    v_cvt_pk_bf16_f32 v161, v162, v163
    v_cvt_pk_bf16_f32 v162, v176, v177
    v_cvt_pk_bf16_f32 v163, v178, v179
    s_setprio 3
    v_mfma_f32_16x16x32_bf16 v[56:59], v[88:91], v[156:159], 0
    v_mfma_f32_16x16x32_bf16 v[60:63], v[92:95], v[156:159], 0
    s_setprio 0
    v_cvt_pk_bf16_f32 v48, v48, v49
    v_cvt_pk_bf16_f32 v49, v50, v51
    v_cvt_pk_bf16_f32 v50, v52, v53
    v_cvt_pk_bf16_f32 v51, v54, v55
    v_perm_b32 v64, v50, v48, v76
    v_perm_b32 v65, v51, v49, v77
    v_mul_f32 v64, s77, v64
    v_mul_f32 v65, s77, v65
    v_cvt_pk_bf16_f32 v65, v64, v65
    v_lshlrev_b32 v64, 16, v65
    v_and_b32 v65, 0xffff0000, v65
    v_cndmask_b32 v64, v7, v64, s[40:41]
    v_cndmask_b32 v65, v7, v65, s[42:43]
    v_max_f32 v72, v64, v65
    v_cvt_pk_bf16_f32 v164, v164, v165
    v_cvt_pk_bf16_f32 v165, v166, v167
    v_cvt_pk_bf16_f32 v166, v180, v181
    v_cvt_pk_bf16_f32 v167, v182, v183
    s_setprio 3
    v_mfma_f32_16x16x32_bf16 v[48:51], v[92:95], v[160:163], 0
    v_mfma_f32_16x16x32_bf16 v[52:55], v[96:99], v[160:163], 0
    s_setprio 0
    v_cvt_pk_bf16_f32 v56, v56, v57
    v_cvt_pk_bf16_f32 v57, v58, v59
    v_cvt_pk_bf16_f32 v58, v60, v61
    v_cvt_pk_bf16_f32 v59, v62, v63
    v_perm_b32 v66, v58, v56, v76
    v_perm_b32 v67, v59, v57, v77
    v_mul_f32 v66, s77, v66
    v_mul_f32 v67, s77, v67
    v_cvt_pk_bf16_f32 v67, v66, v67
    v_lshlrev_b32 v66, 16, v67
    v_and_b32 v67, 0xffff0000, v67
    v_max_f32 v73, v66, v67
    s_setprio 3
    v_mfma_f32_16x16x32_bf16 v[56:59], v[96:99], v[164:167], 0
    v_mfma_f32_16x16x32_bf16 v[60:63], v[100:103], v[164:167], 0
    s_setprio 0
    v_cvt_pk_bf16_f32 v26, v120, v121
    v_cvt_pk_bf16_f32 v27, v122, v123
    v_cvt_pk_bf16_f32 v36, v136, v137
    v_cvt_pk_bf16_f32 v37, v138, v139
    s_load_dword s94, s[20:21], s39 offset:0x40
    s_load_dword s94, s[20:21], s39 offset:0x80
    s_load_dword s94, s[20:21], s39 offset:0xc0
    s_load_dword s94, s[20:21], s39 offset:0x100
    s_load_dword s94, s[20:21], s39 offset:0x140
    s_barrier
    v_cvt_pk_bf16_f32 v28, v124, v125
    v_cvt_pk_bf16_f32 v29, v126, v127
    v_cvt_pk_bf16_f32 v38, v140, v141
    v_cvt_pk_bf16_f32 v39, v142, v143
    v_cvt_pk_bf16_f32 v30, v128, v129
    v_cvt_pk_bf16_f32 v31, v130, v131
    v_cvt_pk_bf16_f32 v40, v144, v145
    v_cvt_pk_bf16_f32 v41, v146, v147
    v_cvt_pk_bf16_f32 v48, v48, v49
    v_cvt_pk_bf16_f32 v49, v50, v51
    v_cvt_pk_bf16_f32 v50, v52, v53
    v_cvt_pk_bf16_f32 v51, v54, v55
    v_perm_b32 v68, v50, v48, v76
    v_perm_b32 v69, v51, v49, v77
    v_mul_f32 v68, s77, v68
    v_mul_f32 v69, s77, v69
    v_cvt_pk_bf16_f32 v69, v68, v69
    v_lshlrev_b32 v68, 16, v69
    v_and_b32 v69, 0xffff0000, v69
    v_max_f32 v74, v68, v69
    v_cvt_pk_bf16_f32 v56, v56, v57
    v_cvt_pk_bf16_f32 v57, v58, v59
    v_cvt_pk_bf16_f32 v58, v60, v61
    v_cvt_pk_bf16_f32 v59, v62, v63
    v_perm_b32 v70, v58, v56, v76
    v_perm_b32 v71, v59, v57, v77
    v_mul_f32 v70, s77, v70
    v_mul_f32 v71, s77, v71
    v_cvt_pk_bf16_f32 v71, v70, v71
    v_lshlrev_b32 v70, 16, v71
    v_and_b32 v71, 0xffff0000, v71
    v_max_f32 v75, v70, v71
    v_permlane32_swap_b32 v72, v73
    v_max_f32 v72, v72, v73
    v_permlane32_swap_b32 v74, v75
    v_max_f32 v74, v74, v75
    s_nop 1
    v_permlane16_swap_b32 v72, v74
    v_max_f32 v72, v72, v74
    v_mov_b32 v74, v72
    s_nop 1
    v_permlane16_swap_b32 v72, v74
    v_mov_b32 v73, v72
    v_mov_b32 v75, v74
    s_nop 0
    v_permlane32_swap_b32 v72, v73
    v_permlane32_swap_b32 v74, v75
    v_sub_f32 v64, v64, v72
    v_sub_f32 v65, v65, v72
    v_sub_f32 v66, v66, v73
    v_sub_f32 v67, v67, v73
    v_sub_f32 v68, v68, v74
    v_sub_f32 v69, v69, v74
    v_sub_f32 v70, v70, v75
    v_sub_f32 v71, v71, v75
    v_mul_f32 v64, s78, v64
    v_mul_f32 v65, s78, v65
    v_mul_f32 v66, s78, v66
    v_mul_f32 v67, s78, v67
    v_mul_f32 v68, s78, v68
    v_mul_f32 v69, s78, v69
    v_mul_f32 v70, s78, v70
    v_mul_f32 v71, s78, v71
    v_exp_f32 v64, v64
    v_exp_f32 v65, v65
    v_exp_f32 v66, v66
    v_exp_f32 v67, v67
    v_exp_f32 v68, v68
    v_exp_f32 v69, v69
    v_exp_f32 v70, v70
    v_exp_f32 v71, v71
    v_add_f32 v72, v64, v65
    v_add_f32 v73, v66, v67
    s_load_dword s94, s[20:21], s39 offset:0x180
    s_load_dword s94, s[20:21], s39 offset:0x1c0
    s_add_u32 s39, s39, 0x280000
    s_load_dword s94, s[20:21], s39 offset:0x0
    s_load_dword s94, s[20:21], s39 offset:0x40
    s_load_dword s94, s[20:21], s39 offset:0x80
    s_lshl4_add_u32 s91, s28, s29
    s_lshl_b32 s91, s91, 7
    s_add_u32 s92, s91, 0x1ea8000
    s_xor_b32 s91, s91, 17408
    s_add_u32 s91, s91, 0x1ea8000
    v_mov_b32 v23, s92
    v_writelane_b32 v23, s91, 1
    s_mov_b64 exec, 3
    global_load_dwordx3 v[20:22], v23, s[26:27] sc1
    s_mov_b64 exec, -1
    s_barrier
    v_add_f32 v74, v68, v69
    v_add_f32 v75, v70, v71
    v_permlane32_swap_b32 v72, v73
    v_add_f32 v72, v72, v73
    v_permlane32_swap_b32 v74, v75
    v_add_f32 v74, v74, v75
    s_nop 1
    v_permlane16_swap_b32 v72, v74
    v_add_f32 v72, v72, v74
    v_rcp_f32 v72, v72
    s_nop 0
    v_mov_b32 v74, v72
    s_nop 1
    v_permlane16_swap_b32 v72, v74
    v_mov_b32 v73, v72
    v_mov_b32 v75, v74
    s_nop 0
    v_permlane32_swap_b32 v72, v73
    v_permlane32_swap_b32 v74, v75
    v_mul_f32 v64, v64, v72
    v_mul_f32 v65, v65, v72
    v_mul_f32 v66, v66, v73
    v_mul_f32 v67, v67, v73
    v_mul_f32 v68, v68, v74
    v_mul_f32 v69, v69, v74
    v_mul_f32 v70, v70, v75
    v_mul_f32 v71, v71, v75
    v_cvt_pk_bf16_f32 v72, v64, v65
L_pad10:
    s_cbranch_execz L_vret2
    v_cvt_pk_bf16_f32 v73, v66, v67
    v_cvt_pk_bf16_f32 v74, v68, v69
    v_cvt_pk_bf16_f32 v75, v70, v71
    v_perm_b32 v152, v72, v72, v78
    v_perm_b32 v153, v72, v72, v79
    v_perm_b32 v154, v72, v72, v86
    v_perm_b32 v155, v72, v72, v87
    v_perm_b32 v156, v73, v73, v78
    v_perm_b32 v157, v73, v73, v79
    v_perm_b32 v158, v73, v73, v86
    v_perm_b32 v159, v73, v73, v87
    s_setprio 3
    v_mfma_f32_16x16x32_bf16 v[48:51], v[24:27], v[152:155], 0
    v_mfma_f32_16x16x32_bf16 v[52:55], v[34:37], v[152:155], 0
    s_setprio 0
    v_perm_b32 v160, v74, v74, v78
    v_perm_b32 v161, v74, v74, v79
    v_perm_b32 v162, v74, v74, v86
    v_perm_b32 v163, v74, v74, v87
    s_setprio 3
    v_mfma_f32_16x16x32_bf16 v[56:59], v[26:29], v[156:159], 0
    v_mfma_f32_16x16x32_bf16 v[60:63], v[36:39], v[156:159], 0
    s_setprio 0
    v_perm_b32 v164, v75, v75, v78
    v_perm_b32 v165, v75, v75, v79
    v_perm_b32 v166, v75, v75, v86
    v_perm_b32 v167, v75, v75, v87
    v_cvt_pk_bf16_f32 v168, v48, v49
    v_cvt_pk_bf16_f32 v169, v50, v51
    v_cvt_pk_bf16_f32 v170, v52, v53
    v_cvt_pk_bf16_f32 v171, v54, v55
    s_setprio 3
    v_mfma_f32_16x16x32_bf16 v[48:51], v[28:31], v[160:163], 0
    v_mfma_f32_16x16x32_bf16 v[52:55], v[38:41], v[160:163], 0
    s_load_dword s94, s[20:21], s39 offset:0xc0
    s_load_dword s94, s[20:21], s39 offset:0x100
    s_load_dword s94, s[20:21], s39 offset:0x140
    s_load_dword s94, s[20:21], s39 offset:0x180
    s_load_dword s94, s[20:21], s39 offset:0x1c0
    s_waitcnt vmcnt(1)
    s_barrier
    s_lshl1_add_u32 m0, s33, 81920
    s_nop 0
    buffer_load_dwordx4 v11, s[60:63], s83 offen lds
    s_setprio 0
    v_cvt_pk_bf16_f32 v172, v56, v57
    v_cvt_pk_bf16_f32 v173, v58, v59
    v_cvt_pk_bf16_f32 v174, v60, v61
    v_cvt_pk_bf16_f32 v175, v62, v63
    s_setprio 3
    v_mfma_f32_16x16x32_bf16 v[56:59], v[30:33], v[164:167], 0
    v_mfma_f32_16x16x32_bf16 v[60:63], v[40:43], v[164:167], 0
    s_setprio 0
    v_permlane16_swap_b32 v168, v170
    v_permlane16_swap_b32 v169, v171
    buffer_store_dwordx4 v[168:171], v0, s[68:71], s75 offen offset:0 sc1
    v_permlane16_swap_b32 v172, v174
    v_permlane16_swap_b32 v173, v175
    buffer_store_dwordx4 v[172:175], v0, s[68:71], s75 offen offset:1024 sc1
    s_lshl1_add_u32 m0, s33, 82944
    s_nop 0
    buffer_load_dwordx4 v12, s[60:63], s83 offen lds
    v_cvt_pk_bf16_f32 v176, v48, v49
    v_cvt_pk_bf16_f32 v177, v50, v51
    v_cvt_pk_bf16_f32 v178, v52, v53
    v_cvt_pk_bf16_f32 v179, v54, v55
    v_cvt_pk_bf16_f32 v180, v56, v57
    v_cvt_pk_bf16_f32 v181, v58, v59
    v_cvt_pk_bf16_f32 v182, v60, v61
    v_cvt_pk_bf16_f32 v183, v62, v63
    v_permlane16_swap_b32 v176, v178
    v_permlane16_swap_b32 v177, v179
    buffer_store_dwordx4 v[176:179], v0, s[68:71], s75 offen offset:2048 sc1
    v_permlane16_swap_b32 v180, v182
    v_permlane16_swap_b32 v181, v183
    buffer_store_dwordx4 v[180:183], v0, s[68:71], s75 offen offset:3072 sc1
    v_lshrrev_b32 v64, 4, v1
    v_bfe_u32 v65, v1, 2, 2
    v_and_b32 v66, 3, v1
    v_and_b32 v67, 15, v1
    v_lshrrev_b32 v68, 3, v1
    v_and_b32 v69, 7, v1
    s_lshl_b32 s85, s6, 2
    v_lshl_add_u32 v70, v64, 3, v65
    v_lshlrev_b32 v70, 7, v70
    s_lshl1_add_u32 m0, s33, 90112
    s_nop 0
    buffer_load_dwordx4 v11, s[64:67], s83 offen lds
    v_and_b32 v71, 1, v66
    v_lshl_add_u32 v70, v71, 3, v70
    v_add_u32 v70, 0, v70
    v_and_b32 v71, 2, v65
    v_and_b32 v72, 1, v64
    v_lshl_add_u32 v71, v72, 2, v71
    v_lshrrev_b32 v72, 1, v66
    v_xor_b32 v71, v71, v72
    v_xor_b32 v71, s85, v71
    v_xor_b32 v72, 0, v71
    v_lshl_add_u32 v80, v72, 4, v70
    v_add_u32 v82, 49152, v80
    v_add_u32 v84, 98304, v80
    v_xor_b32 v72, 2, v71
    v_lshl_add_u32 v81, v72, 4, v70
    v_add_u32 v83, 49152, v81
    s_lshl1_add_u32 m0, s33, 91136
    s_nop 0
    buffer_load_dwordx4 v12, s[64:67], s83 offen lds
    s_add_u32 s83, s83, 131072
    v_add_u32 v85, 98304, v81
    s_lshl_b32 s85, s5, 12
    v_lshl_add_u32 v48, v1, 4, s85
    v_add_u32 v49, 49152, v48
    v_add_u32 v50, 98304, v48
    v_mov_b32 v88, 0
    v_mov_b32 v89, 0
    v_mov_b32 v90, 0
    v_mov_b32 v91, 0
    v_mov_b32 v92, 0
    v_mov_b32 v93, 0
    v_mov_b32 v94, 0
    v_mov_b32 v95, 0
    v_mov_b32 v96, 0
    v_mov_b32 v97, 0
    v_mov_b32 v98, 0
    v_mov_b32 v99, 0
    v_mov_b32 v100, 0
    v_mov_b32 v101, 0
    v_mov_b32 v102, 0
    v_mov_b32 v103, 0
    v_mov_b32 v104, 0
    v_mov_b32 v105, 0
    v_mov_b32 v106, 0
    v_mov_b32 v107, 0
    s_load_dword s94, s[20:21], s39 offset:0x80000
    s_load_dword s94, s[20:21], s39 offset:0x80040
    s_load_dword s94, s[20:21], s39 offset:0x80080
    s_load_dword s94, s[20:21], s39 offset:0x800c0
    s_load_dword s94, s[20:21], s39 offset:0x80100
    s_cmp_lg_u32 s4, 0
    s_cbranch_scc1 L_fH2
    s_lshl_b32 s91, s28, 4
    s_add_u32 s91, s91, s29
    s_lshl_b32 s91, s91, 7
    s_add_u32 s91, s91, 0x1e90000
    v_mov_b32 v16, s91
    v_mov_b32 v18, s100
    v_mov_b32 v19, s101
    s_mov_b64 exec, 1
    global_store_dwordx2 v16, v[18:19], s[26:27] sc1
    s_mov_b64 exec, -1
L_fH2:
    s_waitcnt vmcnt(8)
    s_mov_b64 exec, 3
    s_movk_i32 s98, 0x4000
L_pT_chk:
    v_cmp_ne_u64 vcc, s[100:101], v[20:21]
    s_nop 1
    s_cmp_eq_u64 vcc, 0
    s_cbranch_scc1 L_pT_ok
    s_sub_u32 s98, s98, 1
    s_cbranch_scc1 L_pT_ok
    s_sleep 1
    global_load_dwordx3 v[20:22], v23, s[26:27] sc1
    s_waitcnt vmcnt(0)
    s_branch L_pT_chk
L_pT_ok:
    s_mov_b64 exec, -1
    v_readlane_b32 s90, v22, 0
    v_readlane_b32 s91, v22, 1
    s_nop 1
    s_sub_u32 s90, s91, s90
    s_abs_i32 s91, s90
    s_min_u32 s91, s91, 0x1000
    s_add_u32 s91, s91, 35
    s_mul_i32 s91, s91, 937
    s_lshr_b32 s91, s91, 16
    s_min_u32 s91, s91, 4
    s_sub_u32 s92, 0, s91
    s_cmp_lt_i32 s90, 0
    s_cselect_b32 s91, s92, s91
    s_add_u32 s50, s91, 4
    s_and_b32 s91, s91, 3
    s_mov_b32 s46, 0x58458458
    s_mov_b32 s47, 0x4584584
    s_cmp_eq_u32 s91, 1
    s_cselect_b32 s46, 0xc22c22c4, s46
    s_cselect_b32 s47, 0x22c22c22, s47
    s_cmp_eq_u32 s91, 2
    s_cselect_b32 s46, 0x116222c4, s46
    s_cselect_b32 s47, 0x16116116, s47
    s_cmp_eq_u32 s91, 3
    s_cselect_b32 s46, 0x116222c4, s46
    s_cselect_b32 s47, 0x308b08b1, s47
    s_movk_i32 s44, 0x4000
    s_mov_b32 s45, 131072
    s_barrier
    s_lshl_b32 s48, s46, 15
    s_and_b32 s48, s48, 0x38000
    s_lshr_b64 s[46:47], s[46:47], 3
    s_lshl2_add_u32 m0, s33, s48
    s_lshl1_add_u32 s49, s33, s48
    buffer_load_dwordx4 v10, s[56:59], s82 offen offset:0 sc1 lds
    v_mov_b32 v108, 0
    v_mov_b32 v109, 0
    v_mov_b32 v110, 0
    v_mov_b32 v111, 0
    v_mov_b32 v112, 0
    v_mov_b32 v113, 0
    v_mov_b32 v114, 0
    v_mov_b32 v115, 0
    v_mov_b32 v116, 0
    v_mov_b32 v117, 0
    v_mov_b32 v118, 0
    v_mov_b32 v119, 0
    s_lshl_b32 s84, s4, 12
    s_add_u32 s84, s84, 147456
    v_lshl_add_u32 v3, v1, 3, s84
    v_lshrrev_b32 v70, 1, v64
    v_xor_b32 v70, v70, v65
    v_lshl_add_u32 v70, v70, 4, s84
    buffer_load_dwordx4 v10, s[56:59], s82 offen offset:1024 sc1 lds
    v_lshl_add_u32 v70, v67, 6, v70
    v_and_b32 v71, 1, v64
    v_lshl_add_u32 v14, v71, 3, v70
    v_xor_b32 v15, 32, v14
    v_xor_b32 v70, v66, v64
    v_lshl_add_u32 v70, v70, 4, s84
    v_lshrrev_b32 v71, 2, v1
    v_lshl_add_u32 v17, v71, 6, v70
    buffer_load_dwordx4 v10, s[56:59], s82 offen offset:2048 sc1 lds
    s_lshl_b32 s85, s4, 12
    v_lshl_add_u32 v72, v1, 4, s85
    s_lshl_b32 s85, s4, 4
    v_and_b32 v70, 2, v68
    v_xor_b32 v70, v70, v69
    v_xor_b32 v70, 0, v70
    v_add_u32 v71, s85, v68
    v_mul_u32_u24 v71, 2048, v71
    v_lshl_add_u32 v4, v70, 4, v71
    s_add_u32 s85, s85, 8
    v_and_b32 v70, 2, v68
    buffer_load_dwordx4 v10, s[56:59], s82 offen offset:3072 sc1 lds
    s_add_u32 s82, s82, s44
    v_xor_b32 v70, v70, v69
    v_xor_b32 v70, 4, v70
    v_add_u32 v71, s85, v68
    v_mul_u32_u24 v71, 2048, v71
    v_lshl_add_u32 v5, v70, 4, v71
    s_and_b32 s85, s31, 3
    s_lshl1_add_u32 s85, s85, s32
    s_cmp_eq_u32 s85, 3
    s_cselect_b64 vcc, -1, 0
    s_lshl_b32 s85, s4, 11
    v_lshl_add_u32 v70, v1, 4, s85
    v_add_u32 v71, 1024, v70
    s_add_u32 m0, s49, 16384
    s_nop 0
    buffer_load_dwordx4 v11, s[60:63], s83 offen lds
    v_cndmask_b32 v4, v4, v70, vcc
    v_cndmask_b32 v5, v5, v71, vcc
    s_mov_b32 s72, s8
    s_mov_b32 s73, s9
    s_mov_b32 s74, 0x400000
    s_mov_b32 s75, 0x20000
    s_add_u32 m0, s49, 17408
    s_nop 0
    buffer_load_dwordx4 v12, s[60:63], s83 offen lds
    s_add_u32 m0, s49, 24576
    s_nop 0
    buffer_load_dwordx4 v11, s[64:67], s83 offen lds
    s_add_u32 m0, s49, 25600
    s_nop 0
    buffer_load_dwordx4 v12, s[64:67], s83 offen lds
    s_add_u32 s83, s83, s45
    s_load_dword s94, s[20:21], s39 offset:0x80140
    s_load_dword s94, s[20:21], s39 offset:0x80180
    s_load_dword s94, s[20:21], s39 offset:0x801c0
    s_add_u32 s39, s39, 0x180000
    s_load_dword s94, s[20:21], s39 offset:0x0
    s_load_dword s94, s[20:21], s39 offset:0x40
    s_barrier
    s_lshl_b32 s48, s46, 15
    s_and_b32 s48, s48, 0x38000
    s_lshr_b64 s[46:47], s[46:47], 3
    s_lshl2_add_u32 m0, s33, s48
    s_lshl1_add_u32 s49, s33, s48
    buffer_load_dwordx4 v10, s[56:59], s82 offen offset:0 sc1 lds
    buffer_load_dwordx4 v10, s[56:59], s82 offen offset:1024 sc1 lds
    buffer_load_dwordx4 v10, s[56:59], s82 offen offset:2048 sc1 lds
    buffer_load_dwordx4 v10, s[56:59], s82 offen offset:3072 sc1 lds
    s_add_u32 s82, s82, s44
    s_add_u32 m0, s49, 16384
    s_nop 0
    buffer_load_dwordx4 v11, s[60:63], s83 offen lds
    s_add_u32 m0, s49, 17408
    s_nop 0
    buffer_load_dwordx4 v12, s[60:63], s83 offen lds
    s_add_u32 m0, s49, 24576
    s_nop 0
    buffer_load_dwordx4 v11, s[64:67], s83 offen lds
    s_add_u32 m0, s49, 25600
    s_nop 0
    buffer_load_dwordx4 v12, s[64:67], s83 offen lds
    s_add_u32 s83, s83, s45
    s_load_dword s94, s[20:21], s39 offset:0x80
    s_load_dword s94, s[20:21], s39 offset:0xc0
    s_load_dword s94, s[20:21], s39 offset:0x100
    s_load_dword s94, s[20:21], s39 offset:0x140
    s_load_dword s94, s[20:21], s39 offset:0x180
    s_waitcnt vmcnt(16)
    s_barrier
    s_lshl_b32 s48, s46, 15
    s_and_b32 s48, s48, 0x38000
    s_lshr_b64 s[46:47], s[46:47], 3
    s_lshl2_add_u32 m0, s33, s48
    s_lshl1_add_u32 s49, s33, s48
    buffer_load_dwordx4 v10, s[56:59], s82 offen offset:0 sc1 lds
    buffer_load_dwordx4 v10, s[56:59], s82 offen offset:1024 sc1 lds
    buffer_load_dwordx4 v10, s[56:59], s82 offen offset:2048 sc1 lds
    buffer_load_dwordx4 v10, s[56:59], s82 offen offset:3072 sc1 lds
    s_add_u32 s82, s82, s44
    s_add_u32 m0, s49, 16384
    s_nop 0
    buffer_load_dwordx4 v11, s[60:63], s83 offen lds
    s_add_u32 m0, s49, 17408
    s_nop 0
    buffer_load_dwordx4 v12, s[60:63], s83 offen lds
    s_add_u32 m0, s49, 24576
    s_nop 0
    buffer_load_dwordx4 v11, s[64:67], s83 offen lds
    s_add_u32 m0, s49, 25600
    s_nop 0
    buffer_load_dwordx4 v12, s[64:67], s83 offen lds
    s_add_u32 s83, s83, s45
    s_load_dword s94, s[20:21], s39 offset:0x1c0
    s_add_u32 s39, s39, 0xfff80000
    s_load_dword s94, s[20:21], s39 offset:0x0
    s_load_dword s94, s[20:21], s39 offset:0x40
    s_load_dword s94, s[20:21], s39 offset:0x80
    s_load_dword s94, s[20:21], s39 offset:0xc0
    s_waitcnt vmcnt(16)
    s_barrier
    s_lshl_b32 s48, s46, 15
    s_and_b32 s48, s48, 0x38000
    s_lshr_b64 s[46:47], s[46:47], 3
    s_lshl2_add_u32 m0, s33, s48
    s_lshl1_add_u32 s49, s33, s48
    buffer_load_dwordx4 v10, s[56:59], s82 offen offset:0 sc1 lds
    buffer_load_dwordx4 v10, s[56:59], s82 offen offset:1024 sc1 lds
    buffer_load_dwordx4 v10, s[56:59], s82 offen offset:2048 sc1 lds
    buffer_load_dwordx4 v10, s[56:59], s82 offen offset:3072 sc1 lds
    s_add_u32 s82, s82, s44
    s_add_u32 m0, s49, 16384
    s_nop 0
    buffer_load_dwordx4 v11, s[60:63], s83 offen lds
    s_add_u32 m0, s49, 17408
    s_nop 0
    buffer_load_dwordx4 v12, s[60:63], s83 offen lds
    s_add_u32 m0, s49, 24576
    s_nop 0
    buffer_load_dwordx4 v11, s[64:67], s83 offen lds
    s_add_u32 m0, s49, 25600
    s_nop 0
    buffer_load_dwordx4 v12, s[64:67], s83 offen lds
    s_add_u32 s83, s83, s45
    s_load_dword s94, s[20:21], s39 offset:0x100
    s_load_dword s94, s[20:21], s39 offset:0x140
    s_load_dword s94, s[20:21], s39 offset:0x180
    s_load_dword s94, s[20:21], s39 offset:0x1c0
    s_add_u32 s39, s39, 0x100000
    s_load_dword s94, s[20:21], s39 offset:0x0
    s_waitcnt vmcnt(16)
    s_barrier
    s_lshl_b32 s48, s46, 15
    s_and_b32 s48, s48, 0x38000
    s_lshr_b64 s[46:47], s[46:47], 3
    s_lshl2_add_u32 m0, s33, s48
    s_lshl1_add_u32 s49, s33, s48
    buffer_load_dwordx4 v10, s[56:59], s82 offen offset:0 sc1 lds
    buffer_load_dwordx4 v10, s[56:59], s82 offen offset:1024 sc1 lds
    buffer_load_dwordx4 v10, s[56:59], s82 offen offset:2048 sc1 lds
    buffer_load_dwordx4 v10, s[56:59], s82 offen offset:3072 sc1 lds
    s_add_u32 s82, s82, s44
    s_add_u32 m0, s49, 16384
    s_nop 0
    buffer_load_dwordx4 v11, s[60:63], s83 offen lds
    s_add_u32 m0, s49, 17408
    s_nop 0
    buffer_load_dwordx4 v12, s[60:63], s83 offen lds
    s_add_u32 m0, s49, 24576
    s_nop 0
    buffer_load_dwordx4 v11, s[64:67], s83 offen lds
    s_add_u32 m0, s49, 25600
    s_nop 0
    buffer_load_dwordx4 v12, s[64:67], s83 offen lds
    s_add_u32 s83, s83, s45
    s_load_dword s94, s[20:21], s39 offset:0x40
    s_load_dword s94, s[20:21], s39 offset:0x80
    s_load_dword s94, s[20:21], s39 offset:0xc0
    s_load_dword s94, s[20:21], s39 offset:0x100
    s_load_dword s94, s[20:21], s39 offset:0x140
    s_waitcnt vmcnt(42)
    s_waitcnt vmcnt(16)
    s_barrier
    s_lshl_b32 s48, s46, 15
    s_and_b32 s48, s48, 0x38000
    s_lshr_b64 s[46:47], s[46:47], 3
    s_lshl2_add_u32 m0, s33, s48
    s_lshl1_add_u32 s49, s33, s48
    buffer_load_dwordx4 v10, s[56:59], s82 offen offset:0 sc1 lds
    buffer_load_dwordx4 v10, s[56:59], s82 offen offset:1024 sc1 lds
    buffer_load_dwordx4 v10, s[56:59], s82 offen offset:2048 sc1 lds
    buffer_load_dwordx4 v10, s[56:59], s82 offen offset:3072 sc1 lds
    s_add_u32 s82, s82, s44
    s_add_u32 m0, s49, 16384
    s_nop 0
    buffer_load_dwordx4 v11, s[60:63], s83 offen lds
    s_add_u32 m0, s49, 17408
    s_nop 0
    buffer_load_dwordx4 v12, s[60:63], s83 offen lds
    s_add_u32 m0, s49, 24576
    s_nop 0
    buffer_load_dwordx4 v11, s[64:67], s83 offen lds
    s_add_u32 m0, s49, 25600
    s_nop 0
    buffer_load_dwordx4 v12, s[64:67], s83 offen lds
    s_add_u32 s83, s83, s45
    s_load_dword s94, s[20:21], s39 offset:0x180
    s_load_dword s94, s[20:21], s39 offset:0x1c0
    s_add_u32 s39, s39, 0xff980000
    s_load_dword s94, s[12:13], s39 offset:0x0
    s_load_dword s94, s[12:13], s39 offset:0x40
    s_load_dword s94, s[12:13], s39 offset:0x80
    s_lshl2_add_u32 s91, s30, s4
    s_lshl_b32 s91, s91, 9
    s_add_u32 s91, s91, 0x1e90000
    v_lshl_add_u32 v20, v1, 7, s91
    s_mov_b64 exec, 15
    global_load_dwordx2 v[22:23], v20, s[26:27] sc1
    s_mov_b64 exec, -1
    s_cmp_lg_u32 s4, 0
    s_cbranch_scc1 L_fO
    s_lshl_b32 s91, s28, 4
    s_add_u32 s91, s91, s29
    s_lshl_b32 s91, s91, 7
    s_add_u32 s91, s91, 0x1e98000
    v_mov_b32 v16, s91
    v_mov_b32 v18, s100
    v_mov_b32 v19, s101
    s_mov_b64 exec, 1
    global_store_dwordx2 v16, v[18:19], s[26:27] sc1
    s_mov_b64 exec, -1
L_fO:
    s_waitcnt vmcnt(17)
    s_barrier
    s_lshl_b32 s48, s46, 15
    s_and_b32 s48, s48, 0x38000
    s_lshr_b64 s[46:47], s[46:47], 3
    s_lshl2_add_u32 m0, s33, s48
    s_lshl1_add_u32 s49, s33, s48
    buffer_load_dwordx4 v10, s[56:59], s82 offen offset:0 sc1 lds
    buffer_load_dwordx4 v10, s[56:59], s82 offen offset:1024 sc1 lds
    buffer_load_dwordx4 v10, s[56:59], s82 offen offset:2048 sc1 lds
    buffer_load_dwordx4 v10, s[56:59], s82 offen offset:3072 sc1 lds
    s_add_u32 s82, s82, s44
    s_add_u32 m0, s49, 16384
    s_nop 0
    buffer_load_dwordx4 v11, s[60:63], s83 offen lds
    s_add_u32 m0, s49, 17408
    s_nop 0
    buffer_load_dwordx4 v12, s[60:63], s83 offen lds
    s_add_u32 m0, s49, 24576
    s_nop 0
    buffer_load_dwordx4 v11, s[64:67], s83 offen lds
    s_add_u32 m0, s49, 25600
    s_nop 0
    buffer_load_dwordx4 v12, s[64:67], s83 offen lds
    s_add_u32 s83, s83, s45
    s_load_dword s94, s[12:13], s39 offset:0xc0
    s_load_dword s94, s[12:13], s39 offset:0x100
    s_load_dword s94, s[12:13], s39 offset:0x140
    s_load_dword s94, s[12:13], s39 offset:0x180
    s_load_dword s94, s[12:13], s39 offset:0x1c0
    s_waitcnt vmcnt(17)
    s_barrier
    s_lshl_b32 s48, s46, 15
    s_and_b32 s48, s48, 0x38000
    s_lshr_b64 s[46:47], s[46:47], 3
    s_lshl2_add_u32 m0, s33, s48
    s_lshl1_add_u32 s49, s33, s48
    buffer_load_dwordx4 v10, s[56:59], s82 offen offset:0 sc1 lds
    buffer_load_dwordx4 v10, s[56:59], s82 offen offset:1024 sc1 lds
    buffer_load_dwordx4 v10, s[56:59], s82 offen offset:2048 sc1 lds
    buffer_load_dwordx4 v10, s[56:59], s82 offen offset:3072 sc1 lds
    s_add_u32 s82, s82, s44
    s_add_u32 m0, s49, 16384
    s_nop 0
    buffer_load_dwordx4 v11, s[60:63], s83 offen lds
    s_add_u32 m0, s49, 17408
    s_nop 0
    buffer_load_dwordx4 v12, s[60:63], s83 offen lds
    s_add_u32 m0, s49, 24576
    s_nop 0
    buffer_load_dwordx4 v11, s[64:67], s83 offen lds
    s_add_u32 m0, s49, 25600
    s_nop 0
    buffer_load_dwordx4 v12, s[64:67], s83 offen lds
    s_add_u32 s83, s83, s45
    s_load_dword s94, s[12:13], s39 offset:0x80000
    s_load_dword s94, s[12:13], s39 offset:0x80040
    s_load_dword s94, s[12:13], s39 offset:0x80080
    s_load_dword s94, s[12:13], s39 offset:0x800c0
    s_load_dword s94, s[12:13], s39 offset:0x80100
    s_waitcnt vmcnt(16)
    s_mov_b64 exec, 15
    s_movk_i32 s98, 0x4000
L_pH2_chk:
    v_cmp_ne_u64 vcc, s[100:101], v[22:23]
    s_nop 1
    s_cmp_eq_u64 vcc, 0
    s_cbranch_scc1 L_pH2_ok
    s_sub_u32 s98, s98, 1
    s_cbranch_scc1 L_pH2_ok
    s_sleep 1
    global_load_dwordx2 v[22:23], v20, s[26:27] sc1
    s_waitcnt vmcnt(0)
    s_branch L_pH2_chk
L_pH2_ok:
    s_mov_b64 exec, -1
    s_add_u32 s82, s82, s14
    s_add_u32 s83, s83, s35
    s_cmp_lg_u32 s32, 0
    s_cselect_b32 s44, 0xffffc000, s44
    s_lshl_b32 s45, s44, 3
    s_waitcnt vmcnt(17)
    s_barrier
    s_cmp_eq_u32 s50, 0
    s_cbranch_scc1 L_bl_end
L_bl:
    s_lshl_b32 s48, s46, 15
    s_and_b32 s48, s48, 0x38000
    s_lshr_b64 s[46:47], s[46:47], 3
    s_lshl2_add_u32 m0, s33, s48
    s_lshl1_add_u32 s49, s33, s48
    buffer_load_dwordx4 v10, s[56:59], s82 offen offset:0 sc1 lds
    buffer_load_dwordx4 v10, s[56:59], s82 offen offset:1024 sc1 lds
    buffer_load_dwordx4 v10, s[56:59], s82 offen offset:2048 sc1 lds
    buffer_load_dwordx4 v10, s[56:59], s82 offen offset:3072 sc1 lds
    s_add_u32 s82, s82, s44
    s_add_u32 m0, s49, 16384
    s_nop 0
    buffer_load_dwordx4 v11, s[60:63], s83 offen lds
    s_add_u32 m0, s49, 17408
    s_nop 0
    buffer_load_dwordx4 v12, s[60:63], s83 offen lds
    s_add_u32 m0, s49, 24576
    s_nop 0
    buffer_load_dwordx4 v11, s[64:67], s83 offen lds
    s_add_u32 m0, s49, 25600
    s_nop 0
    buffer_load_dwordx4 v12, s[64:67], s83 offen lds
    s_add_u32 s83, s83, s45
    s_sub_u32 s50, s50, 1
    s_cmp_lg_u32 s50, 0
    s_waitcnt vmcnt(16)
    s_barrier
    s_cbranch_scc1 L_bl
L_bl_end:
    s_lshl_b32 m0, s33, 2
    s_nop 0
    buffer_load_dwordx4 v10, s[56:59], s82 offen offset:0 sc1 lds
    buffer_load_dwordx4 v10, s[56:59], s82 offen offset:1024 sc1 lds
    buffer_load_dwordx4 v10, s[56:59], s82 offen offset:2048 sc1 lds
    buffer_load_dwordx4 v10, s[56:59], s82 offen offset:3072 sc1 lds
    s_add_u32 s82, s82, s44
    s_lshl1_add_u32 m0, s33, 16384
    s_nop 0
    buffer_load_dwordx4 v11, s[60:63], s83 offen lds
    s_lshl1_add_u32 m0, s33, 17408
    s_nop 0
    buffer_load_dwordx4 v12, s[60:63], s83 offen lds
    s_lshl1_add_u32 m0, s33, 24576
    s_nop 0
    buffer_load_dwordx4 v11, s[64:67], s83 offen lds
    s_lshl1_add_u32 m0, s33, 25600
    s_nop 0
    buffer_load_dwordx4 v12, s[64:67], s83 offen lds
    s_add_u32 s83, s83, s45
    s_load_dword s94, s[12:13], s39 offset:0x80140
    s_load_dword s94, s[12:13], s39 offset:0x80180
    s_load_dword s94, s[12:13], s39 offset:0x801c0
    s_add_u32 s39, s39, 0x100000
    s_load_dword s94, s[12:13], s39 offset:0x0
    s_load_dword s94, s[12:13], s39 offset:0x40
    s_waitcnt vmcnt(16)
    s_barrier
    s_lshl2_add_u32 m0, s33, 98304
    s_nop 0
    buffer_load_dwordx4 v10, s[56:59], s82 offen offset:0 sc1 lds
    buffer_load_dwordx4 v10, s[56:59], s82 offen offset:1024 sc1 lds
    buffer_load_dwordx4 v10, s[56:59], s82 offen offset:2048 sc1 lds
    buffer_load_dwordx4 v10, s[56:59], s82 offen offset:3072 sc1 lds
    s_add_u32 s82, s82, s44
    s_lshl1_add_u32 m0, s33, 114688
    s_nop 0
    buffer_load_dwordx4 v11, s[60:63], s83 offen lds
    s_lshl1_add_u32 m0, s33, 115712
    s_nop 0
    buffer_load_dwordx4 v12, s[60:63], s83 offen lds
    s_lshl1_add_u32 m0, s33, 122880
    s_nop 0
    buffer_load_dwordx4 v11, s[64:67], s83 offen lds
    s_lshl1_add_u32 m0, s33, 123904
    s_nop 0
    buffer_load_dwordx4 v12, s[64:67], s83 offen lds
    s_add_u32 s83, s83, s45
    s_load_dword s94, s[12:13], s39 offset:0x80
    s_load_dword s94, s[12:13], s39 offset:0xc0
    s_load_dword s94, s[12:13], s39 offset:0x100
    s_load_dword s94, s[12:13], s39 offset:0x140
    s_load_dword s94, s[12:13], s39 offset:0x180
    s_lshl2_add_u32 s91, s30, s4
    s_lshl_b32 s91, s91, 9
    s_add_u32 s91, s91, 0x1e98000
    v_lshl_add_u32 v20, v1, 7, s91
    s_mov_b64 exec, 15
    global_load_dwordx2 v[22:23], v20, s[26:27] sc1
    s_mov_b64 exec, -1
    s_waitcnt vmcnt(17)
    s_barrier
    s_lshl2_add_u32 m0, s33, 32768
    s_nop 0
    buffer_load_dwordx4 v10, s[56:59], s82 offen offset:0 sc1 lds
    buffer_load_dwordx4 v10, s[56:59], s82 offen offset:1024 sc1 lds
    buffer_load_dwordx4 v10, s[56:59], s82 offen offset:2048 sc1 lds
    buffer_load_dwordx4 v10, s[56:59], s82 offen offset:3072 sc1 lds
    s_add_u32 s82, s82, s44
    s_lshl1_add_u32 m0, s33, 49152
    s_nop 0
    buffer_load_dwordx4 v11, s[60:63], s83 offen lds
    s_lshl1_add_u32 m0, s33, 50176
    s_nop 0
    buffer_load_dwordx4 v12, s[60:63], s83 offen lds
    s_lshl1_add_u32 m0, s33, 57344
    s_nop 0
    buffer_load_dwordx4 v11, s[64:67], s83 offen lds
    s_lshl1_add_u32 m0, s33, 58368
    s_nop 0
    buffer_load_dwordx4 v12, s[64:67], s83 offen lds
    s_add_u32 s83, s83, s45
    s_load_dword s94, s[12:13], s39 offset:0x1c0
    s_load_dword s94, s[12:13], s39 offset:0x80000
    s_load_dword s94, s[12:13], s39 offset:0x80040
    s_load_dword s94, s[12:13], s39 offset:0x80080
    s_load_dword s94, s[12:13], s39 offset:0x800c0
    s_waitcnt vmcnt(17)
    s_barrier
    s_lshl2_add_u32 m0, s33, 65536
    s_nop 0
    buffer_load_dwordx4 v10, s[56:59], s82 offen offset:0 sc1 lds
    buffer_load_dwordx4 v10, s[56:59], s82 offen offset:1024 sc1 lds
    buffer_load_dwordx4 v10, s[56:59], s82 offen offset:2048 sc1 lds
    buffer_load_dwordx4 v10, s[56:59], s82 offen offset:3072 sc1 lds
    s_add_u32 s82, s82, s44
    s_lshl1_add_u32 m0, s33, 81920
    s_nop 0
    buffer_load_dwordx4 v11, s[60:63], s83 offen lds
    s_lshl1_add_u32 m0, s33, 82944
    s_nop 0
    buffer_load_dwordx4 v12, s[60:63], s83 offen lds
    s_lshl1_add_u32 m0, s33, 90112
    s_nop 0
    buffer_load_dwordx4 v11, s[64:67], s83 offen lds
    s_lshl1_add_u32 m0, s33, 91136
    s_nop 0
    buffer_load_dwordx4 v12, s[64:67], s83 offen lds
    s_add_u32 s83, s83, s45
    s_load_dword s94, s[12:13], s39 offset:0x80100
    s_load_dword s94, s[12:13], s39 offset:0x80140
    s_load_dword s94, s[12:13], s39 offset:0x80180
L_pad11:
    s_cbranch_execz L_vret2
    s_load_dword s94, s[12:13], s39 offset:0x801c0
    s_waitcnt vmcnt(16)
    s_mov_b64 exec, 15
    s_movk_i32 s98, 0x4000
L_pO_chk:
    v_cmp_ne_u64 vcc, s[100:101], v[22:23]
    s_nop 1
    s_cmp_eq_u64 vcc, 0
    s_cbranch_scc1 L_pO_ok
    s_sub_u32 s98, s98, 1
    s_cbranch_scc1 L_pO_ok
    s_sleep 1
    global_load_dwordx2 v[22:23], v20, s[26:27] sc1
    s_waitcnt vmcnt(0)
    s_branch L_pO_chk
L_pO_ok:
    s_mov_b64 exec, -1
    s_waitcnt vmcnt(17)
    s_barrier
    s_lshl_b32 s85, s31, 8
    s_lshl_b32 s86, s32, 7
    s_add_u32 s86, s85, s86
    s_xor_b32 s87, s86, 128
    s_lshr_b32 s91, s31, 2
    s_lshl1_add_u32 s91, s91, s32
    s_lshl_b32 s91, s91, 13
    s_add_u32 s91, s91, 0x2800000
    s_xor_b32 s85, s91, 8192
    s_and_b32 s92, s31, 3
    s_lshl1_add_u32 s92, s92, s32
    s_cmp_eq_u32 s92, 3
    s_cselect_b32 s86, s91, s86
    s_cselect_b32 s87, s85, s87
    s_cselect_b32 s91, 0x2a00000, 0
    s_cselect_b32 s92, s26, s12
    s_cselect_b32 s93, s27, s13
    s_max_u32 s91, s91, 2097152
    s_add_u32 s60, s92, s86
    s_addc_u32 s61, s93, 0
    s_sub_u32 s62, s91, s86
    s_mov_b32 s63, 0x20000
    s_add_u32 s56, s26, 0x1200000
    s_addc_u32 s57, s27, 0
    s_mov_b32 s58, 0x400000
    s_mov_b32 s59, 0x20000
    s_lshl_b32 s82, s30, 18
    s_mov_b32 s83, 0
    s_lshl_b32 m0, s33, 2
    s_nop 0
    buffer_load_dwordx4 v10, s[56:59], s82 offen offset:0 sc1 lds
    buffer_load_dwordx4 v10, s[56:59], s82 offen offset:1024 sc1 lds
    buffer_load_dwordx4 v10, s[56:59], s82 offen offset:2048 sc1 lds
    buffer_load_dwordx4 v10, s[56:59], s82 offen offset:3072 sc1 lds
    s_add_u32 s82, s82, 16384
    s_lshl1_add_u32 m0, s33, 16384
    s_nop 0
    buffer_load_dwordx4 v4, s[60:63], s83 offen lds
    s_lshl1_add_u32 m0, s33, 17408
    s_nop 0
    buffer_load_dwordx4 v5, s[60:63], s83 offen lds
    s_add_u32 s83, s83, 131072
    s_waitcnt vmcnt(14)
    s_barrier
    s_lshl2_add_u32 m0, s33, 98304
    s_nop 0
    buffer_load_dwordx4 v10, s[56:59], s82 offen offset:0 sc1 lds
    buffer_load_dwordx4 v10, s[56:59], s82 offen offset:1024 sc1 lds
    buffer_load_dwordx4 v10, s[56:59], s82 offen offset:2048 sc1 lds
    buffer_load_dwordx4 v10, s[56:59], s82 offen offset:3072 sc1 lds
    s_add_u32 s82, s82, 16384
    s_lshl1_add_u32 m0, s33, 114688
    s_nop 0
    buffer_load_dwordx4 v4, s[60:63], s83 offen lds
    s_lshl1_add_u32 m0, s33, 115712
    s_nop 0
    buffer_load_dwordx4 v5, s[60:63], s83 offen lds
    s_add_u32 s83, s83, 131072
    s_lshl2_add_u32 m0, s33, 122880
    s_nop 0
    buffer_load_dwordx4 v10, s[56:59], s82 offen offset:0 sc1 lds
    buffer_load_dwordx4 v10, s[56:59], s82 offen offset:1024 sc1 lds
    buffer_load_dwordx4 v10, s[56:59], s82 offen offset:2048 sc1 lds
    buffer_load_dwordx4 v10, s[56:59], s82 offen offset:3072 sc1 lds
    s_add_u32 s82, s82, 16384
    s_lshl1_add_u32 m0, s33, 139264
    s_nop 0
    buffer_load_dwordx4 v4, s[60:63], s83 offen lds
    s_lshl1_add_u32 m0, s33, 140288
    s_nop 0
    buffer_load_dwordx4 v5, s[60:63], s83 offen lds
    s_add_u32 s83, s83, 131072
    s_waitcnt vmcnt(12)
    s_barrier
    s_lshl2_add_u32 m0, s33, 24576
    s_nop 0
    buffer_load_dwordx4 v10, s[56:59], s82 offen offset:0 sc1 lds
    buffer_load_dwordx4 v10, s[56:59], s82 offen offset:1024 sc1 lds
    buffer_load_dwordx4 v10, s[56:59], s82 offen offset:2048 sc1 lds
    buffer_load_dwordx4 v10, s[56:59], s82 offen offset:3072 sc1 lds
    s_add_u32 s82, s82, 16384
    s_lshl1_add_u32 m0, s33, 40960
    s_nop 0
    buffer_load_dwordx4 v4, s[60:63], s83 offen lds
    s_lshl1_add_u32 m0, s33, 41984
    s_nop 0
    buffer_load_dwordx4 v5, s[60:63], s83 offen lds
    s_add_u32 s83, s83, 131072
    s_waitcnt lgkmcnt(0)
    ds_read_b64_tr_b16 v[40:41], v80 offset:16384
    ds_read_b64_tr_b16 v[42:43], v80 offset:16896
    ds_read_b128 v[24:27], v48 offset:0
    ds_read_b128 v[28:31], v48 offset:1024
    ds_read_b128 v[32:35], v48 offset:2048
    ds_read_b128 v[36:39], v48 offset:3072
    ds_read_b64_tr_b16 v[44:45], v81 offset:16384
    ds_read_b64_tr_b16 v[46:47], v81 offset:16896
    s_barrier
    s_setprio 1
    s_waitcnt lgkmcnt(5)
    v_mfma_f32_16x16x32_bf16 v[88:91], v[40:43], v[24:27], v[88:91]
    ds_read_b64_tr_b16 v[72:73], v80 offset:20480
    ds_read_b64_tr_b16 v[74:75], v80 offset:20992
    s_lshl2_add_u32 m0, s33, 49152
    s_waitcnt lgkmcnt(6)
    v_mfma_f32_16x16x32_bf16 v[92:95], v[40:43], v[28:31], v[92:95]
    buffer_load_dwordx4 v10, s[56:59], s82 offen offset:0 sc1 lds
    ds_read_b128 v[56:59], v48 offset:8192
    ds_read_b128 v[60:63], v48 offset:9216
    s_waitcnt lgkmcnt(7)
    v_mfma_f32_16x16x32_bf16 v[96:99], v[40:43], v[32:35], v[96:99]
    ds_read_b128 v[64:67], v48 offset:10240
    ds_read_b128 v[68:71], v48 offset:11264
    s_waitcnt lgkmcnt(8)
    v_mfma_f32_16x16x32_bf16 v[100:103], v[40:43], v[36:39], v[100:103]
    ds_read_b64_tr_b16 v[76:77], v81 offset:20480
    ds_read_b64_tr_b16 v[78:79], v81 offset:20992
    s_waitcnt lgkmcnt(8)
    v_mfma_f32_16x16x32_bf16 v[104:107], v[44:47], v[24:27], v[104:107]
    buffer_load_dwordx4 v10, s[56:59], s82 offen offset:1024 sc1 lds
    v_mfma_f32_16x16x32_bf16 v[108:111], v[44:47], v[28:31], v[108:111]
    v_mfma_f32_16x16x32_bf16 v[112:115], v[44:47], v[32:35], v[112:115]
    v_mfma_f32_16x16x32_bf16 v[116:119], v[44:47], v[36:39], v[116:119]
    s_waitcnt vmcnt(14) lgkmcnt(0)
    s_barrier
    v_mfma_f32_16x16x32_bf16 v[88:91], v[72:75], v[56:59], v[88:91]
    ds_read_b64_tr_b16 v[40:41], v84 offset:16384
    ds_read_b64_tr_b16 v[42:43], v84 offset:16896
    v_mfma_f32_16x16x32_bf16 v[92:95], v[72:75], v[60:63], v[92:95]
    buffer_load_dwordx4 v10, s[56:59], s82 offen offset:2048 sc1 lds
    ds_read_b128 v[24:27], v50 offset:0
    ds_read_b128 v[28:31], v50 offset:1024
    v_mfma_f32_16x16x32_bf16 v[96:99], v[72:75], v[64:67], v[96:99]
    ds_read_b128 v[32:35], v50 offset:2048
    v_mfma_f32_16x16x32_bf16 v[100:103], v[72:75], v[68:71], v[100:103]
    ds_read_b128 v[36:39], v50 offset:3072
    ds_read_b64_tr_b16 v[44:45], v85 offset:16384
    v_mfma_f32_16x16x32_bf16 v[104:107], v[76:79], v[56:59], v[104:107]
    buffer_load_dwordx4 v10, s[56:59], s82 offen offset:3072 sc1 lds
    s_add_u32 s82, s82, 16384
    ds_read_b64_tr_b16 v[46:47], v85 offset:16896
    v_mfma_f32_16x16x32_bf16 v[108:111], v[76:79], v[60:63], v[108:111]
    v_mfma_f32_16x16x32_bf16 v[112:115], v[76:79], v[64:67], v[112:115]
    v_mfma_f32_16x16x32_bf16 v[116:119], v[76:79], v[68:71], v[116:119]
    s_waitcnt lgkmcnt(5)
    v_mfma_f32_16x16x32_bf16 v[88:91], v[40:43], v[24:27], v[88:91]
    ds_read_b64_tr_b16 v[72:73], v84 offset:20480
    ds_read_b64_tr_b16 v[74:75], v84 offset:20992
    s_lshl1_add_u32 m0, s33, 65536
    s_waitcnt lgkmcnt(6)
    v_mfma_f32_16x16x32_bf16 v[92:95], v[40:43], v[28:31], v[92:95]
    buffer_load_dwordx4 v4, s[60:63], s83 offen lds
    ds_read_b128 v[56:59], v50 offset:8192
    ds_read_b128 v[60:63], v50 offset:9216
    s_waitcnt lgkmcnt(7)
    v_mfma_f32_16x16x32_bf16 v[96:99], v[40:43], v[32:35], v[96:99]
    ds_read_b128 v[64:67], v50 offset:10240
    ds_read_b128 v[68:71], v50 offset:11264
    s_waitcnt lgkmcnt(8)
    v_mfma_f32_16x16x32_bf16 v[100:103], v[40:43], v[36:39], v[100:103]
    ds_read_b64_tr_b16 v[76:77], v85 offset:20480
    ds_read_b64_tr_b16 v[78:79], v85 offset:20992
    s_lshl1_add_u32 m0, s33, 66560
    s_waitcnt lgkmcnt(8)
    v_mfma_f32_16x16x32_bf16 v[104:107], v[44:47], v[24:27], v[104:107]
    buffer_load_dwordx4 v5, s[60:63], s83 offen lds
    s_add_u32 s83, s83, 131072
    v_mfma_f32_16x16x32_bf16 v[108:111], v[44:47], v[28:31], v[108:111]
    v_mfma_f32_16x16x32_bf16 v[112:115], v[44:47], v[32:35], v[112:115]
    v_mfma_f32_16x16x32_bf16 v[116:119], v[44:47], v[36:39], v[116:119]
    s_waitcnt vmcnt(12) lgkmcnt(0)
    s_barrier
    v_mfma_f32_16x16x32_bf16 v[88:91], v[72:75], v[56:59], v[88:91]
    ds_read_b64_tr_b16 v[40:41], v84 offset:40960
    ds_read_b64_tr_b16 v[42:43], v84 offset:41472
    s_lshl2_add_u32 m0, s33, 73728
    v_mfma_f32_16x16x32_bf16 v[92:95], v[72:75], v[60:63], v[92:95]
    buffer_load_dwordx4 v10, s[56:59], s82 offen offset:0 sc1 lds
    ds_read_b128 v[24:27], v50 offset:24576
    ds_read_b128 v[28:31], v50 offset:25600
    v_mfma_f32_16x16x32_bf16 v[96:99], v[72:75], v[64:67], v[96:99]
    ds_read_b128 v[32:35], v50 offset:26624
    v_mfma_f32_16x16x32_bf16 v[100:103], v[72:75], v[68:71], v[100:103]
    ds_read_b128 v[36:39], v50 offset:27648
    ds_read_b64_tr_b16 v[44:45], v85 offset:40960
    v_mfma_f32_16x16x32_bf16 v[104:107], v[76:79], v[56:59], v[104:107]
    buffer_load_dwordx4 v10, s[56:59], s82 offen offset:1024 sc1 lds
    ds_read_b64_tr_b16 v[46:47], v85 offset:41472
    v_mfma_f32_16x16x32_bf16 v[108:111], v[76:79], v[60:63], v[108:111]
    v_mfma_f32_16x16x32_bf16 v[112:115], v[76:79], v[64:67], v[112:115]
    v_mfma_f32_16x16x32_bf16 v[116:119], v[76:79], v[68:71], v[116:119]
    s_waitcnt lgkmcnt(5)
    v_mfma_f32_16x16x32_bf16 v[88:91], v[40:43], v[24:27], v[88:91]
    ds_read_b64_tr_b16 v[72:73], v84 offset:45056
    ds_read_b64_tr_b16 v[74:75], v84 offset:45568
    s_waitcnt lgkmcnt(6)
    v_mfma_f32_16x16x32_bf16 v[92:95], v[40:43], v[28:31], v[92:95]
    buffer_load_dwordx4 v10, s[56:59], s82 offen offset:2048 sc1 lds
    ds_read_b128 v[56:59], v50 offset:32768
    ds_read_b128 v[60:63], v50 offset:33792
    s_waitcnt lgkmcnt(7)
    v_mfma_f32_16x16x32_bf16 v[96:99], v[40:43], v[32:35], v[96:99]
    ds_read_b128 v[64:67], v50 offset:34816
    ds_read_b128 v[68:71], v50 offset:35840
    s_waitcnt lgkmcnt(8)
    v_mfma_f32_16x16x32_bf16 v[100:103], v[40:43], v[36:39], v[100:103]
    ds_read_b64_tr_b16 v[76:77], v85 offset:45056
    ds_read_b64_tr_b16 v[78:79], v85 offset:45568
    s_waitcnt lgkmcnt(8)
    v_mfma_f32_16x16x32_bf16 v[104:107], v[44:47], v[24:27], v[104:107]
    buffer_load_dwordx4 v10, s[56:59], s82 offen offset:3072 sc1 lds
    s_add_u32 s82, s82, 16384
    v_mfma_f32_16x16x32_bf16 v[108:111], v[44:47], v[28:31], v[108:111]
    v_mfma_f32_16x16x32_bf16 v[112:115], v[44:47], v[32:35], v[112:115]
    v_mfma_f32_16x16x32_bf16 v[116:119], v[44:47], v[36:39], v[116:119]
    s_waitcnt vmcnt(10) lgkmcnt(0)
    s_barrier
    v_mfma_f32_16x16x32_bf16 v[88:91], v[72:75], v[56:59], v[88:91]
    ds_read_b64_tr_b16 v[40:41], v80 offset:40960
    ds_read_b64_tr_b16 v[42:43], v80 offset:41472
    s_lshl1_add_u32 m0, s33, 90112
    v_mfma_f32_16x16x32_bf16 v[92:95], v[72:75], v[60:63], v[92:95]
    buffer_load_dwordx4 v4, s[60:63], s83 offen lds
    ds_read_b128 v[24:27], v48 offset:24576
    ds_read_b128 v[28:31], v48 offset:25600
    v_mfma_f32_16x16x32_bf16 v[96:99], v[72:75], v[64:67], v[96:99]
    ds_read_b128 v[32:35], v48 offset:26624
    v_mfma_f32_16x16x32_bf16 v[100:103], v[72:75], v[68:71], v[100:103]
    ds_read_b128 v[36:39], v48 offset:27648
    ds_read_b64_tr_b16 v[44:45], v81 offset:40960
    s_lshl1_add_u32 m0, s33, 91136
    v_mfma_f32_16x16x32_bf16 v[104:107], v[76:79], v[56:59], v[104:107]
    buffer_load_dwordx4 v5, s[60:63], s83 offen lds
    s_add_u32 s83, s83, 131072
    ds_read_b64_tr_b16 v[46:47], v81 offset:41472
    v_mfma_f32_16x16x32_bf16 v[108:111], v[76:79], v[60:63], v[108:111]
    v_mfma_f32_16x16x32_bf16 v[112:115], v[76:79], v[64:67], v[112:115]
    v_mfma_f32_16x16x32_bf16 v[116:119], v[76:79], v[68:71], v[116:119]
    s_waitcnt lgkmcnt(5)
    v_mfma_f32_16x16x32_bf16 v[88:91], v[40:43], v[24:27], v[88:91]
    ds_read_b64_tr_b16 v[72:73], v80 offset:45056
    ds_read_b64_tr_b16 v[74:75], v80 offset:45568
    s_lshl_b32 m0, s33, 2
    s_waitcnt lgkmcnt(6)
    v_mfma_f32_16x16x32_bf16 v[92:95], v[40:43], v[28:31], v[92:95]
    buffer_load_dwordx4 v10, s[56:59], s82 offen offset:0 sc1 lds
    ds_read_b128 v[56:59], v48 offset:32768
    ds_read_b128 v[60:63], v48 offset:33792
    s_waitcnt lgkmcnt(7)
    v_mfma_f32_16x16x32_bf16 v[96:99], v[40:43], v[32:35], v[96:99]
    ds_read_b128 v[64:67], v48 offset:34816
    ds_read_b128 v[68:71], v48 offset:35840
    s_waitcnt lgkmcnt(8)
    v_mfma_f32_16x16x32_bf16 v[100:103], v[40:43], v[36:39], v[100:103]
    buffer_load_dwordx4 v10, s[56:59], s82 offen offset:1024 sc1 lds
    ds_read_b64_tr_b16 v[76:77], v81 offset:45056
    ds_read_b64_tr_b16 v[78:79], v81 offset:45568
    s_waitcnt lgkmcnt(8)
    v_mfma_f32_16x16x32_bf16 v[104:107], v[44:47], v[24:27], v[104:107]
    v_mfma_f32_16x16x32_bf16 v[108:111], v[44:47], v[28:31], v[108:111]
    buffer_load_dwordx4 v10, s[56:59], s82 offen offset:2048 sc1 lds
    v_mfma_f32_16x16x32_bf16 v[112:115], v[44:47], v[32:35], v[112:115]
    v_mfma_f32_16x16x32_bf16 v[116:119], v[44:47], v[36:39], v[116:119]
    s_waitcnt vmcnt(9) lgkmcnt(0)
    s_barrier
    v_mfma_f32_16x16x32_bf16 v[88:91], v[72:75], v[56:59], v[88:91]
    ds_read_b64_tr_b16 v[40:41], v82 offset:16384
    ds_read_b64_tr_b16 v[42:43], v82 offset:16896
    v_mfma_f32_16x16x32_bf16 v[92:95], v[72:75], v[60:63], v[92:95]
    buffer_load_dwordx4 v10, s[56:59], s82 offen offset:3072 sc1 lds
    s_add_u32 s82, s82, 16384
    ds_read_b128 v[24:27], v49 offset:0
    ds_read_b128 v[28:31], v49 offset:1024
    v_mfma_f32_16x16x32_bf16 v[96:99], v[72:75], v[64:67], v[96:99]
    ds_read_b128 v[32:35], v49 offset:2048
    s_lshl1_add_u32 m0, s33, 16384
    v_mfma_f32_16x16x32_bf16 v[100:103], v[72:75], v[68:71], v[100:103]
    buffer_load_dwordx4 v4, s[60:63], s83 offen lds
    ds_read_b128 v[36:39], v49 offset:3072
    ds_read_b64_tr_b16 v[44:45], v83 offset:16384
    v_mfma_f32_16x16x32_bf16 v[104:107], v[76:79], v[56:59], v[104:107]
    ds_read_b64_tr_b16 v[46:47], v83 offset:16896
    s_lshl1_add_u32 m0, s33, 17408
    v_mfma_f32_16x16x32_bf16 v[108:111], v[76:79], v[60:63], v[108:111]
    buffer_load_dwordx4 v5, s[60:63], s83 offen lds
    s_add_u32 s83, s83, 131072
    v_mfma_f32_16x16x32_bf16 v[112:115], v[76:79], v[64:67], v[112:115]
    v_mfma_f32_16x16x32_bf16 v[116:119], v[76:79], v[68:71], v[116:119]
    s_waitcnt lgkmcnt(5)
    v_mfma_f32_16x16x32_bf16 v[88:91], v[40:43], v[24:27], v[88:91]
    ds_read_b64_tr_b16 v[72:73], v82 offset:20480
    ds_read_b64_tr_b16 v[74:75], v82 offset:20992
    s_lshl2_add_u32 m0, s33, 98304
    s_waitcnt lgkmcnt(6)
    v_mfma_f32_16x16x32_bf16 v[92:95], v[40:43], v[28:31], v[92:95]
    buffer_load_dwordx4 v10, s[56:59], s82 offen offset:0 sc1 lds
    ds_read_b128 v[56:59], v49 offset:8192
    ds_read_b128 v[60:63], v49 offset:9216
    s_waitcnt lgkmcnt(7)
    v_mfma_f32_16x16x32_bf16 v[96:99], v[40:43], v[32:35], v[96:99]
    ds_read_b128 v[64:67], v49 offset:10240
    ds_read_b128 v[68:71], v49 offset:11264
    s_waitcnt lgkmcnt(8)
    v_mfma_f32_16x16x32_bf16 v[100:103], v[40:43], v[36:39], v[100:103]
    buffer_load_dwordx4 v10, s[56:59], s82 offen offset:1024 sc1 lds
    ds_read_b64_tr_b16 v[76:77], v83 offset:20480
    ds_read_b64_tr_b16 v[78:79], v83 offset:20992
    s_waitcnt lgkmcnt(8)
    v_mfma_f32_16x16x32_bf16 v[104:107], v[44:47], v[24:27], v[104:107]
    v_mfma_f32_16x16x32_bf16 v[108:111], v[44:47], v[28:31], v[108:111]
    buffer_load_dwordx4 v10, s[56:59], s82 offen offset:2048 sc1 lds
    v_mfma_f32_16x16x32_bf16 v[112:115], v[44:47], v[32:35], v[112:115]
    v_mfma_f32_16x16x32_bf16 v[116:119], v[44:47], v[36:39], v[116:119]
    s_waitcnt vmcnt(9) lgkmcnt(0)
    s_barrier
    v_mfma_f32_16x16x32_bf16 v[88:91], v[72:75], v[56:59], v[88:91]
    ds_read_b64_tr_b16 v[40:41], v82 offset:40960
    ds_read_b64_tr_b16 v[42:43], v82 offset:41472
    v_mfma_f32_16x16x32_bf16 v[92:95], v[72:75], v[60:63], v[92:95]
    buffer_load_dwordx4 v10, s[56:59], s82 offen offset:3072 sc1 lds
    s_add_u32 s82, s82, 16384
    ds_read_b128 v[24:27], v49 offset:24576
    ds_read_b128 v[28:31], v49 offset:25600
    v_mfma_f32_16x16x32_bf16 v[96:99], v[72:75], v[64:67], v[96:99]
    ds_read_b128 v[32:35], v49 offset:26624
    s_lshl1_add_u32 m0, s33, 114688
    v_mfma_f32_16x16x32_bf16 v[100:103], v[72:75], v[68:71], v[100:103]
    buffer_load_dwordx4 v4, s[60:63], s83 offen lds
    ds_read_b128 v[36:39], v49 offset:27648
    ds_read_b64_tr_b16 v[44:45], v83 offset:40960
    v_mfma_f32_16x16x32_bf16 v[104:107], v[76:79], v[56:59], v[104:107]
    ds_read_b64_tr_b16 v[46:47], v83 offset:41472
    s_lshl1_add_u32 m0, s33, 115712
    v_mfma_f32_16x16x32_bf16 v[108:111], v[76:79], v[60:63], v[108:111]
    buffer_load_dwordx4 v5, s[60:63], s83 offen lds
    s_add_u32 s83, s83, 131072
    v_mfma_f32_16x16x32_bf16 v[112:115], v[76:79], v[64:67], v[112:115]
    v_mfma_f32_16x16x32_bf16 v[116:119], v[76:79], v[68:71], v[116:119]
    s_waitcnt lgkmcnt(5)
    v_mfma_f32_16x16x32_bf16 v[88:91], v[40:43], v[24:27], v[88:91]
    ds_read_b64_tr_b16 v[72:73], v82 offset:45056
    ds_read_b64_tr_b16 v[74:75], v82 offset:45568
    s_lshl2_add_u32 m0, s33, 122880
    s_waitcnt lgkmcnt(6)
    v_mfma_f32_16x16x32_bf16 v[92:95], v[40:43], v[28:31], v[92:95]
    buffer_load_dwordx4 v10, s[56:59], s82 offen offset:0 sc1 lds
    ds_read_b128 v[56:59], v49 offset:32768
    ds_read_b128 v[60:63], v49 offset:33792
    s_waitcnt lgkmcnt(7)
    v_mfma_f32_16x16x32_bf16 v[96:99], v[40:43], v[32:35], v[96:99]
    ds_read_b128 v[64:67], v49 offset:34816
    ds_read_b128 v[68:71], v49 offset:35840
    s_waitcnt lgkmcnt(8)
    v_mfma_f32_16x16x32_bf16 v[100:103], v[40:43], v[36:39], v[100:103]
    buffer_load_dwordx4 v10, s[56:59], s82 offen offset:1024 sc1 lds
    ds_read_b64_tr_b16 v[76:77], v83 offset:45056
    ds_read_b64_tr_b16 v[78:79], v83 offset:45568
    s_waitcnt lgkmcnt(8)
    v_mfma_f32_16x16x32_bf16 v[104:107], v[44:47], v[24:27], v[104:107]
    v_mfma_f32_16x16x32_bf16 v[108:111], v[44:47], v[28:31], v[108:111]
    buffer_load_dwordx4 v10, s[56:59], s82 offen offset:2048 sc1 lds
    v_mfma_f32_16x16x32_bf16 v[112:115], v[44:47], v[32:35], v[112:115]
    v_mfma_f32_16x16x32_bf16 v[116:119], v[44:47], v[36:39], v[116:119]
    s_waitcnt vmcnt(9) lgkmcnt(0)
    s_barrier
    v_mfma_f32_16x16x32_bf16 v[88:91], v[72:75], v[56:59], v[88:91]
    ds_read_b64_tr_b16 v[40:41], v80 offset:16384
    ds_read_b64_tr_b16 v[42:43], v80 offset:16896
    v_mfma_f32_16x16x32_bf16 v[92:95], v[72:75], v[60:63], v[92:95]
    buffer_load_dwordx4 v10, s[56:59], s82 offen offset:3072 sc1 lds
    s_add_u32 s82, s82, 16384
    ds_read_b128 v[24:27], v48 offset:0
    ds_read_b128 v[28:31], v48 offset:1024
    v_mfma_f32_16x16x32_bf16 v[96:99], v[72:75], v[64:67], v[96:99]
    ds_read_b128 v[32:35], v48 offset:2048
    s_lshl1_add_u32 m0, s33, 139264
    v_mfma_f32_16x16x32_bf16 v[100:103], v[72:75], v[68:71], v[100:103]
    buffer_load_dwordx4 v4, s[60:63], s83 offen lds
    ds_read_b128 v[36:39], v48 offset:3072
    ds_read_b64_tr_b16 v[44:45], v81 offset:16384
    v_mfma_f32_16x16x32_bf16 v[104:107], v[76:79], v[56:59], v[104:107]
    ds_read_b64_tr_b16 v[46:47], v81 offset:16896
    s_lshl1_add_u32 m0, s33, 140288
    v_mfma_f32_16x16x32_bf16 v[108:111], v[76:79], v[60:63], v[108:111]
    buffer_load_dwordx4 v5, s[60:63], s83 offen lds
    s_add_u32 s83, s83, 131072
    v_mfma_f32_16x16x32_bf16 v[112:115], v[76:79], v[64:67], v[112:115]
    v_mfma_f32_16x16x32_bf16 v[116:119], v[76:79], v[68:71], v[116:119]
    s_waitcnt lgkmcnt(5)
    v_mfma_f32_16x16x32_bf16 v[88:91], v[40:43], v[24:27], v[88:91]
    ds_read_b64_tr_b16 v[72:73], v80 offset:20480
    ds_read_b64_tr_b16 v[74:75], v80 offset:20992
    s_lshl2_add_u32 m0, s33, 24576
    s_waitcnt lgkmcnt(6)
    v_mfma_f32_16x16x32_bf16 v[92:95], v[40:43], v[28:31], v[92:95]
    buffer_load_dwordx4 v10, s[56:59], s82 offen offset:0 sc1 lds
    ds_read_b128 v[56:59], v48 offset:8192
    ds_read_b128 v[60:63], v48 offset:9216
    s_waitcnt lgkmcnt(7)
    v_mfma_f32_16x16x32_bf16 v[96:99], v[40:43], v[32:35], v[96:99]
    ds_read_b128 v[64:67], v48 offset:10240
    ds_read_b128 v[68:71], v48 offset:11264
    s_waitcnt lgkmcnt(8)
    v_mfma_f32_16x16x32_bf16 v[100:103], v[40:43], v[36:39], v[100:103]
    buffer_load_dwordx4 v10, s[56:59], s82 offen offset:1024 sc1 lds
    ds_read_b64_tr_b16 v[76:77], v81 offset:20480
    ds_read_b64_tr_b16 v[78:79], v81 offset:20992
    s_waitcnt lgkmcnt(8)
    v_mfma_f32_16x16x32_bf16 v[104:107], v[44:47], v[24:27], v[104:107]
    v_mfma_f32_16x16x32_bf16 v[108:111], v[44:47], v[28:31], v[108:111]
    buffer_load_dwordx4 v10, s[56:59], s82 offen offset:2048 sc1 lds
    v_mfma_f32_16x16x32_bf16 v[112:115], v[44:47], v[32:35], v[112:115]
    v_mfma_f32_16x16x32_bf16 v[116:119], v[44:47], v[36:39], v[116:119]
    s_waitcnt vmcnt(9) lgkmcnt(0)
    s_barrier
    v_mfma_f32_16x16x32_bf16 v[88:91], v[72:75], v[56:59], v[88:91]
    ds_read_b64_tr_b16 v[40:41], v84 offset:16384
    ds_read_b64_tr_b16 v[42:43], v84 offset:16896
    v_mfma_f32_16x16x32_bf16 v[92:95], v[72:75], v[60:63], v[92:95]
    buffer_load_dwordx4 v10, s[56:59], s82 offen offset:3072 sc1 lds
    s_add_u32 s82, s82, 16384
    ds_read_b128 v[24:27], v50 offset:0
    ds_read_b128 v[28:31], v50 offset:1024
    v_mfma_f32_16x16x32_bf16 v[96:99], v[72:75], v[64:67], v[96:99]
    ds_read_b128 v[32:35], v50 offset:2048
    s_lshl1_add_u32 m0, s33, 40960
    v_mfma_f32_16x16x32_bf16 v[100:103], v[72:75], v[68:71], v[100:103]
    buffer_load_dwordx4 v4, s[60:63], s83 offen lds
    ds_read_b128 v[36:39], v50 offset:3072
    ds_read_b64_tr_b16 v[44:45], v85 offset:16384
    v_mfma_f32_16x16x32_bf16 v[104:107], v[76:79], v[56:59], v[104:107]
    ds_read_b64_tr_b16 v[46:47], v85 offset:16896
    s_lshl1_add_u32 m0, s33, 41984
    v_mfma_f32_16x16x32_bf16 v[108:111], v[76:79], v[60:63], v[108:111]
    buffer_load_dwordx4 v5, s[60:63], s83 offen lds
    s_add_u32 s83, s83, 131072
    v_mfma_f32_16x16x32_bf16 v[112:115], v[76:79], v[64:67], v[112:115]
    v_mfma_f32_16x16x32_bf16 v[116:119], v[76:79], v[68:71], v[116:119]
    s_waitcnt lgkmcnt(5)
    v_mfma_f32_16x16x32_bf16 v[88:91], v[40:43], v[24:27], v[88:91]
    ds_read_b64_tr_b16 v[72:73], v84 offset:20480
    ds_read_b64_tr_b16 v[74:75], v84 offset:20992
    s_lshl2_add_u32 m0, s33, 49152
    s_waitcnt lgkmcnt(6)
    v_mfma_f32_16x16x32_bf16 v[92:95], v[40:43], v[28:31], v[92:95]
    buffer_load_dwordx4 v10, s[56:59], s82 offen offset:0 sc1 lds
    ds_read_b128 v[56:59], v50 offset:8192
    ds_read_b128 v[60:63], v50 offset:9216
    s_waitcnt lgkmcnt(7)
    v_mfma_f32_16x16x32_bf16 v[96:99], v[40:43], v[32:35], v[96:99]
    ds_read_b128 v[64:67], v50 offset:10240
    ds_read_b128 v[68:71], v50 offset:11264
    s_waitcnt lgkmcnt(8)
    v_mfma_f32_16x16x32_bf16 v[100:103], v[40:43], v[36:39], v[100:103]
    buffer_load_dwordx4 v10, s[56:59], s82 offen offset:1024 sc1 lds
    ds_read_b64_tr_b16 v[76:77], v85 offset:20480
    ds_read_b64_tr_b16 v[78:79], v85 offset:20992
    s_waitcnt lgkmcnt(8)
    v_mfma_f32_16x16x32_bf16 v[104:107], v[44:47], v[24:27], v[104:107]
    v_mfma_f32_16x16x32_bf16 v[108:111], v[44:47], v[28:31], v[108:111]
    buffer_load_dwordx4 v10, s[56:59], s82 offen offset:2048 sc1 lds
    v_mfma_f32_16x16x32_bf16 v[112:115], v[44:47], v[32:35], v[112:115]
    v_mfma_f32_16x16x32_bf16 v[116:119], v[44:47], v[36:39], v[116:119]
    s_waitcnt vmcnt(9) lgkmcnt(0)
    s_barrier
    v_mfma_f32_16x16x32_bf16 v[88:91], v[72:75], v[56:59], v[88:91]
    ds_read_b64_tr_b16 v[40:41], v84 offset:40960
    ds_read_b64_tr_b16 v[42:43], v84 offset:41472
    v_mfma_f32_16x16x32_bf16 v[92:95], v[72:75], v[60:63], v[92:95]
    buffer_load_dwordx4 v10, s[56:59], s82 offen offset:3072 sc1 lds
    s_add_u32 s82, s82, 16384
    ds_read_b128 v[24:27], v50 offset:24576
    ds_read_b128 v[28:31], v50 offset:25600
    v_mfma_f32_16x16x32_bf16 v[96:99], v[72:75], v[64:67], v[96:99]
    ds_read_b128 v[32:35], v50 offset:26624
    s_lshl1_add_u32 m0, s33, 65536
    v_mfma_f32_16x16x32_bf16 v[100:103], v[72:75], v[68:71], v[100:103]
    buffer_load_dwordx4 v4, s[60:63], s83 offen lds
    ds_read_b128 v[36:39], v50 offset:27648
    ds_read_b64_tr_b16 v[44:45], v85 offset:40960
    v_mfma_f32_16x16x32_bf16 v[104:107], v[76:79], v[56:59], v[104:107]
    ds_read_b64_tr_b16 v[46:47], v85 offset:41472
    s_lshl1_add_u32 m0, s33, 66560
    v_mfma_f32_16x16x32_bf16 v[108:111], v[76:79], v[60:63], v[108:111]
    buffer_load_dwordx4 v5, s[60:63], s83 offen lds
    s_add_u32 s83, s83, 131072
    v_mfma_f32_16x16x32_bf16 v[112:115], v[76:79], v[64:67], v[112:115]
    v_mfma_f32_16x16x32_bf16 v[116:119], v[76:79], v[68:71], v[116:119]
    s_waitcnt lgkmcnt(5)
    v_mfma_f32_16x16x32_bf16 v[88:91], v[40:43], v[24:27], v[88:91]
    ds_read_b64_tr_b16 v[72:73], v84 offset:45056
    ds_read_b64_tr_b16 v[74:75], v84 offset:45568
    s_lshl2_add_u32 m0, s33, 73728
    s_waitcnt lgkmcnt(6)
    v_mfma_f32_16x16x32_bf16 v[92:95], v[40:43], v[28:31], v[92:95]
    buffer_load_dwordx4 v10, s[56:59], s82 offen offset:0 sc1 lds
    ds_read_b128 v[56:59], v50 offset:32768
    ds_read_b128 v[60:63], v50 offset:33792
    s_waitcnt lgkmcnt(7)
    v_mfma_f32_16x16x32_bf16 v[96:99], v[40:43], v[32:35], v[96:99]
    ds_read_b128 v[64:67], v50 offset:34816
    ds_read_b128 v[68:71], v50 offset:35840
    s_waitcnt lgkmcnt(8)
    v_mfma_f32_16x16x32_bf16 v[100:103], v[40:43], v[36:39], v[100:103]
    buffer_load_dwordx4 v10, s[56:59], s82 offen offset:1024 sc1 lds
    ds_read_b64_tr_b16 v[76:77], v85 offset:45056
    ds_read_b64_tr_b16 v[78:79], v85 offset:45568
    s_waitcnt lgkmcnt(8)
    v_mfma_f32_16x16x32_bf16 v[104:107], v[44:47], v[24:27], v[104:107]
    v_mfma_f32_16x16x32_bf16 v[108:111], v[44:47], v[28:31], v[108:111]
    buffer_load_dwordx4 v10, s[56:59], s82 offen offset:2048 sc1 lds
    v_mfma_f32_16x16x32_bf16 v[112:115], v[44:47], v[32:35], v[112:115]
    v_mfma_f32_16x16x32_bf16 v[116:119], v[44:47], v[36:39], v[116:119]
    s_waitcnt vmcnt(9) lgkmcnt(0)
    s_barrier
    v_mfma_f32_16x16x32_bf16 v[88:91], v[72:75], v[56:59], v[88:91]
    ds_read_b64_tr_b16 v[40:41], v80 offset:40960
    ds_read_b64_tr_b16 v[42:43], v80 offset:41472
    v_mfma_f32_16x16x32_bf16 v[92:95], v[72:75], v[60:63], v[92:95]
    buffer_load_dwordx4 v10, s[56:59], s82 offen offset:3072 sc1 lds
    s_add_u32 s82, s82, 16384
    ds_read_b128 v[24:27], v48 offset:24576
    ds_read_b128 v[28:31], v48 offset:25600
    v_mfma_f32_16x16x32_bf16 v[96:99], v[72:75], v[64:67], v[96:99]
    ds_read_b128 v[32:35], v48 offset:26624
    s_lshl1_add_u32 m0, s33, 90112
    v_mfma_f32_16x16x32_bf16 v[100:103], v[72:75], v[68:71], v[100:103]
    buffer_load_dwordx4 v4, s[60:63], s83 offen lds
    ds_read_b128 v[36:39], v48 offset:27648
    ds_read_b64_tr_b16 v[44:45], v81 offset:40960
    v_mfma_f32_16x16x32_bf16 v[104:107], v[76:79], v[56:59], v[104:107]
    ds_read_b64_tr_b16 v[46:47], v81 offset:41472
    s_lshl1_add_u32 m0, s33, 91136
    v_mfma_f32_16x16x32_bf16 v[108:111], v[76:79], v[60:63], v[108:111]
    buffer_load_dwordx4 v5, s[60:63], s83 offen lds
    s_add_u32 s83, s83, 131072
    v_mfma_f32_16x16x32_bf16 v[112:115], v[76:79], v[64:67], v[112:115]
    v_mfma_f32_16x16x32_bf16 v[116:119], v[76:79], v[68:71], v[116:119]
    s_waitcnt lgkmcnt(5)
    v_mfma_f32_16x16x32_bf16 v[88:91], v[40:43], v[24:27], v[88:91]
    ds_read_b64_tr_b16 v[72:73], v80 offset:45056
    ds_read_b64_tr_b16 v[74:75], v80 offset:45568
    s_lshl_b32 m0, s33, 2
    s_waitcnt lgkmcnt(6)
    v_mfma_f32_16x16x32_bf16 v[92:95], v[40:43], v[28:31], v[92:95]
    buffer_load_dwordx4 v10, s[56:59], s82 offen offset:0 sc1 lds
    ds_read_b128 v[56:59], v48 offset:32768
    ds_read_b128 v[60:63], v48 offset:33792
    s_waitcnt lgkmcnt(7)
    v_mfma_f32_16x16x32_bf16 v[96:99], v[40:43], v[32:35], v[96:99]
    ds_read_b128 v[64:67], v48 offset:34816
    ds_read_b128 v[68:71], v48 offset:35840
    s_waitcnt lgkmcnt(8)
    v_mfma_f32_16x16x32_bf16 v[100:103], v[40:43], v[36:39], v[100:103]
    buffer_load_dwordx4 v10, s[56:59], s82 offen offset:1024 sc1 lds
    ds_read_b64_tr_b16 v[76:77], v81 offset:45056
L_pad12:
    s_cbranch_execz L_vret3
    ds_read_b64_tr_b16 v[78:79], v81 offset:45568
    s_waitcnt lgkmcnt(8)
    v_mfma_f32_16x16x32_bf16 v[104:107], v[44:47], v[24:27], v[104:107]
    v_mfma_f32_16x16x32_bf16 v[108:111], v[44:47], v[28:31], v[108:111]
    buffer_load_dwordx4 v10, s[56:59], s82 offen offset:2048 sc1 lds
    v_mfma_f32_16x16x32_bf16 v[112:115], v[44:47], v[32:35], v[112:115]
    v_mfma_f32_16x16x32_bf16 v[116:119], v[44:47], v[36:39], v[116:119]
    s_waitcnt vmcnt(9) lgkmcnt(0)
    s_barrier
    v_mfma_f32_16x16x32_bf16 v[88:91], v[72:75], v[56:59], v[88:91]
    ds_read_b64_tr_b16 v[40:41], v82 offset:16384
    ds_read_b64_tr_b16 v[42:43], v82 offset:16896
    v_mfma_f32_16x16x32_bf16 v[92:95], v[72:75], v[60:63], v[92:95]
    buffer_load_dwordx4 v10, s[56:59], s82 offen offset:3072 sc1 lds
    s_add_u32 s82, s82, 16384
    ds_read_b128 v[24:27], v49 offset:0
    ds_read_b128 v[28:31], v49 offset:1024
    v_mfma_f32_16x16x32_bf16 v[96:99], v[72:75], v[64:67], v[96:99]
    ds_read_b128 v[32:35], v49 offset:2048
    s_lshl1_add_u32 m0, s33, 16384
    v_mfma_f32_16x16x32_bf16 v[100:103], v[72:75], v[68:71], v[100:103]
    buffer_load_dwordx4 v4, s[60:63], s83 offen lds
    ds_read_b128 v[36:39], v49 offset:3072
    ds_read_b64_tr_b16 v[44:45], v83 offset:16384
    v_mfma_f32_16x16x32_bf16 v[104:107], v[76:79], v[56:59], v[104:107]
    ds_read_b64_tr_b16 v[46:47], v83 offset:16896
    s_lshl1_add_u32 m0, s33, 17408
    v_mfma_f32_16x16x32_bf16 v[108:111], v[76:79], v[60:63], v[108:111]
    buffer_load_dwordx4 v5, s[60:63], s83 offen lds
    s_add_u32 s83, s83, 131072
    v_mfma_f32_16x16x32_bf16 v[112:115], v[76:79], v[64:67], v[112:115]
    v_mfma_f32_16x16x32_bf16 v[116:119], v[76:79], v[68:71], v[116:119]
    s_waitcnt lgkmcnt(5)
    v_mfma_f32_16x16x32_bf16 v[88:91], v[40:43], v[24:27], v[88:91]
    ds_read_b64_tr_b16 v[72:73], v82 offset:20480
    ds_read_b64_tr_b16 v[74:75], v82 offset:20992
    s_lshl2_add_u32 m0, s33, 98304
    s_waitcnt lgkmcnt(6)
    v_mfma_f32_16x16x32_bf16 v[92:95], v[40:43], v[28:31], v[92:95]
    buffer_load_dwordx4 v10, s[56:59], s82 offen offset:0 sc1 lds
    ds_read_b128 v[56:59], v49 offset:8192
    ds_read_b128 v[60:63], v49 offset:9216
    s_waitcnt lgkmcnt(7)
    v_mfma_f32_16x16x32_bf16 v[96:99], v[40:43], v[32:35], v[96:99]
    ds_read_b128 v[64:67], v49 offset:10240
    ds_read_b128 v[68:71], v49 offset:11264
    s_waitcnt lgkmcnt(8)
    v_mfma_f32_16x16x32_bf16 v[100:103], v[40:43], v[36:39], v[100:103]
    buffer_load_dwordx4 v10, s[56:59], s82 offen offset:1024 sc1 lds
    ds_read_b64_tr_b16 v[76:77], v83 offset:20480
    ds_read_b64_tr_b16 v[78:79], v83 offset:20992
    s_waitcnt lgkmcnt(8)
    v_mfma_f32_16x16x32_bf16 v[104:107], v[44:47], v[24:27], v[104:107]
    v_mfma_f32_16x16x32_bf16 v[108:111], v[44:47], v[28:31], v[108:111]
    buffer_load_dwordx4 v10, s[56:59], s82 offen offset:2048 sc1 lds
    v_mfma_f32_16x16x32_bf16 v[112:115], v[44:47], v[32:35], v[112:115]
    v_mfma_f32_16x16x32_bf16 v[116:119], v[44:47], v[36:39], v[116:119]
    s_waitcnt vmcnt(9) lgkmcnt(0)
    s_barrier
    v_mfma_f32_16x16x32_bf16 v[88:91], v[72:75], v[56:59], v[88:91]
    ds_read_b64_tr_b16 v[40:41], v82 offset:40960
    ds_read_b64_tr_b16 v[42:43], v82 offset:41472
    v_mfma_f32_16x16x32_bf16 v[92:95], v[72:75], v[60:63], v[92:95]
    buffer_load_dwordx4 v10, s[56:59], s82 offen offset:3072 sc1 lds
    s_add_u32 s82, s82, 16384
    ds_read_b128 v[24:27], v49 offset:24576
    ds_read_b128 v[28:31], v49 offset:25600
    v_mfma_f32_16x16x32_bf16 v[96:99], v[72:75], v[64:67], v[96:99]
    ds_read_b128 v[32:35], v49 offset:26624
    s_lshl1_add_u32 m0, s33, 114688
    v_mfma_f32_16x16x32_bf16 v[100:103], v[72:75], v[68:71], v[100:103]
    buffer_load_dwordx4 v4, s[60:63], s83 offen lds
    ds_read_b128 v[36:39], v49 offset:27648
    ds_read_b64_tr_b16 v[44:45], v83 offset:40960
    v_mfma_f32_16x16x32_bf16 v[104:107], v[76:79], v[56:59], v[104:107]
    ds_read_b64_tr_b16 v[46:47], v83 offset:41472
    s_lshl1_add_u32 m0, s33, 115712
    v_mfma_f32_16x16x32_bf16 v[108:111], v[76:79], v[60:63], v[108:111]
    buffer_load_dwordx4 v5, s[60:63], s83 offen lds
    s_add_u32 s83, s83, 131072
    v_mfma_f32_16x16x32_bf16 v[112:115], v[76:79], v[64:67], v[112:115]
    v_mfma_f32_16x16x32_bf16 v[116:119], v[76:79], v[68:71], v[116:119]
    s_waitcnt lgkmcnt(5)
    v_mfma_f32_16x16x32_bf16 v[88:91], v[40:43], v[24:27], v[88:91]
    ds_read_b64_tr_b16 v[72:73], v82 offset:45056
    ds_read_b64_tr_b16 v[74:75], v82 offset:45568
    s_lshl2_add_u32 m0, s33, 122880
    s_waitcnt lgkmcnt(6)
    v_mfma_f32_16x16x32_bf16 v[92:95], v[40:43], v[28:31], v[92:95]
    buffer_load_dwordx4 v10, s[56:59], s82 offen offset:0 sc1 lds
    ds_read_b128 v[56:59], v49 offset:32768
    ds_read_b128 v[60:63], v49 offset:33792
    s_waitcnt lgkmcnt(7)
    v_mfma_f32_16x16x32_bf16 v[96:99], v[40:43], v[32:35], v[96:99]
    ds_read_b128 v[64:67], v49 offset:34816
    ds_read_b128 v[68:71], v49 offset:35840
    s_waitcnt lgkmcnt(8)
    v_mfma_f32_16x16x32_bf16 v[100:103], v[40:43], v[36:39], v[100:103]
    buffer_load_dwordx4 v10, s[56:59], s82 offen offset:1024 sc1 lds
    ds_read_b64_tr_b16 v[76:77], v83 offset:45056
    ds_read_b64_tr_b16 v[78:79], v83 offset:45568
    s_waitcnt lgkmcnt(8)
    v_mfma_f32_16x16x32_bf16 v[104:107], v[44:47], v[24:27], v[104:107]
    v_mfma_f32_16x16x32_bf16 v[108:111], v[44:47], v[28:31], v[108:111]
    buffer_load_dwordx4 v10, s[56:59], s82 offen offset:2048 sc1 lds
    v_mfma_f32_16x16x32_bf16 v[112:115], v[44:47], v[32:35], v[112:115]
    v_mfma_f32_16x16x32_bf16 v[116:119], v[44:47], v[36:39], v[116:119]
    s_waitcnt vmcnt(9) lgkmcnt(0)
    s_barrier
    v_mfma_f32_16x16x32_bf16 v[88:91], v[72:75], v[56:59], v[88:91]
    ds_read_b64_tr_b16 v[40:41], v80 offset:16384
    ds_read_b64_tr_b16 v[42:43], v80 offset:16896
    v_mfma_f32_16x16x32_bf16 v[92:95], v[72:75], v[60:63], v[92:95]
    buffer_load_dwordx4 v10, s[56:59], s82 offen offset:3072 sc1 lds
    s_add_u32 s82, s82, 16384
    ds_read_b128 v[24:27], v48 offset:0
    ds_read_b128 v[28:31], v48 offset:1024
    v_mfma_f32_16x16x32_bf16 v[96:99], v[72:75], v[64:67], v[96:99]
    ds_read_b128 v[32:35], v48 offset:2048
    s_lshl1_add_u32 m0, s33, 139264
    v_mfma_f32_16x16x32_bf16 v[100:103], v[72:75], v[68:71], v[100:103]
    buffer_load_dwordx4 v4, s[60:63], s83 offen lds
    ds_read_b128 v[36:39], v48 offset:3072
    ds_read_b64_tr_b16 v[44:45], v81 offset:16384
    v_mfma_f32_16x16x32_bf16 v[104:107], v[76:79], v[56:59], v[104:107]
    ds_read_b64_tr_b16 v[46:47], v81 offset:16896
    s_lshl1_add_u32 m0, s33, 140288
    v_mfma_f32_16x16x32_bf16 v[108:111], v[76:79], v[60:63], v[108:111]
    buffer_load_dwordx4 v5, s[60:63], s83 offen lds
    s_add_u32 s83, s83, 131072
    v_mfma_f32_16x16x32_bf16 v[112:115], v[76:79], v[64:67], v[112:115]
    v_mfma_f32_16x16x32_bf16 v[116:119], v[76:79], v[68:71], v[116:119]
    s_waitcnt lgkmcnt(5)
    v_mfma_f32_16x16x32_bf16 v[88:91], v[40:43], v[24:27], v[88:91]
    ds_read_b64_tr_b16 v[72:73], v80 offset:20480
    ds_read_b64_tr_b16 v[74:75], v80 offset:20992
    s_lshl2_add_u32 m0, s33, 24576
    s_waitcnt lgkmcnt(6)
    v_mfma_f32_16x16x32_bf16 v[92:95], v[40:43], v[28:31], v[92:95]
    buffer_load_dwordx4 v10, s[56:59], s82 offen offset:0 sc1 lds
    ds_read_b128 v[56:59], v48 offset:8192
    ds_read_b128 v[60:63], v48 offset:9216
    s_waitcnt lgkmcnt(7)
    v_mfma_f32_16x16x32_bf16 v[96:99], v[40:43], v[32:35], v[96:99]
    ds_read_b128 v[64:67], v48 offset:10240
    ds_read_b128 v[68:71], v48 offset:11264
    s_waitcnt lgkmcnt(8)
    v_mfma_f32_16x16x32_bf16 v[100:103], v[40:43], v[36:39], v[100:103]
    buffer_load_dwordx4 v10, s[56:59], s82 offen offset:1024 sc1 lds
    ds_read_b64_tr_b16 v[76:77], v81 offset:20480
    ds_read_b64_tr_b16 v[78:79], v81 offset:20992
    s_waitcnt lgkmcnt(8)
    v_mfma_f32_16x16x32_bf16 v[104:107], v[44:47], v[24:27], v[104:107]
    v_mfma_f32_16x16x32_bf16 v[108:111], v[44:47], v[28:31], v[108:111]
    buffer_load_dwordx4 v10, s[56:59], s82 offen offset:2048 sc1 lds
    v_mfma_f32_16x16x32_bf16 v[112:115], v[44:47], v[32:35], v[112:115]
    v_mfma_f32_16x16x32_bf16 v[116:119], v[44:47], v[36:39], v[116:119]
    s_waitcnt vmcnt(9) lgkmcnt(0)
    s_barrier
    v_mfma_f32_16x16x32_bf16 v[88:91], v[72:75], v[56:59], v[88:91]
    ds_read_b64_tr_b16 v[40:41], v84 offset:16384
    ds_read_b64_tr_b16 v[42:43], v84 offset:16896
    v_mfma_f32_16x16x32_bf16 v[92:95], v[72:75], v[60:63], v[92:95]
    buffer_load_dwordx4 v10, s[56:59], s82 offen offset:3072 sc1 lds
    s_add_u32 s82, s82, 16384
    ds_read_b128 v[24:27], v50 offset:0
    ds_read_b128 v[28:31], v50 offset:1024
    v_mfma_f32_16x16x32_bf16 v[96:99], v[72:75], v[64:67], v[96:99]
    ds_read_b128 v[32:35], v50 offset:2048
    s_lshl1_add_u32 m0, s33, 40960
    v_mfma_f32_16x16x32_bf16 v[100:103], v[72:75], v[68:71], v[100:103]
    buffer_load_dwordx4 v4, s[60:63], s83 offen lds
    ds_read_b128 v[36:39], v50 offset:3072
    ds_read_b64_tr_b16 v[44:45], v85 offset:16384
    v_mfma_f32_16x16x32_bf16 v[104:107], v[76:79], v[56:59], v[104:107]
    ds_read_b64_tr_b16 v[46:47], v85 offset:16896
    s_lshl1_add_u32 m0, s33, 41984
    v_mfma_f32_16x16x32_bf16 v[108:111], v[76:79], v[60:63], v[108:111]
    buffer_load_dwordx4 v5, s[60:63], s83 offen lds
    s_add_u32 s83, s83, 131072
    v_mfma_f32_16x16x32_bf16 v[112:115], v[76:79], v[64:67], v[112:115]
    v_mfma_f32_16x16x32_bf16 v[116:119], v[76:79], v[68:71], v[116:119]
    s_waitcnt lgkmcnt(5)
    v_mfma_f32_16x16x32_bf16 v[88:91], v[40:43], v[24:27], v[88:91]
    ds_read_b64_tr_b16 v[72:73], v84 offset:20480
    ds_read_b64_tr_b16 v[74:75], v84 offset:20992
    s_waitcnt lgkmcnt(6)
    v_mfma_f32_16x16x32_bf16 v[92:95], v[40:43], v[28:31], v[92:95]
    ds_read_b128 v[56:59], v50 offset:8192
    ds_read_b128 v[60:63], v50 offset:9216
    s_waitcnt lgkmcnt(7)
    v_mfma_f32_16x16x32_bf16 v[96:99], v[40:43], v[32:35], v[96:99]
    ds_read_b128 v[64:67], v50 offset:10240
    ds_read_b128 v[68:71], v50 offset:11264
    s_waitcnt lgkmcnt(8)
    v_mfma_f32_16x16x32_bf16 v[100:103], v[40:43], v[36:39], v[100:103]
    ds_read_b64_tr_b16 v[76:77], v85 offset:20480
    ds_read_b64_tr_b16 v[78:79], v85 offset:20992
    s_mov_b32 s84, 0
    s_waitcnt lgkmcnt(8)
    v_mfma_f32_16x16x32_bf16 v[104:107], v[44:47], v[24:27], v[104:107]
    buffer_load_dwordx4 v[120:123], v13, s[72:75], s84 offen
    v_mfma_f32_16x16x32_bf16 v[108:111], v[44:47], v[28:31], v[108:111]
    v_mfma_f32_16x16x32_bf16 v[112:115], v[44:47], v[32:35], v[112:115]
    s_mov_b32 s84, 32768
    v_mfma_f32_16x16x32_bf16 v[116:119], v[44:47], v[36:39], v[116:119]
    buffer_load_dwordx4 v[124:127], v13, s[72:75], s84 offen
    s_waitcnt vmcnt(8) lgkmcnt(0)
    s_barrier
    v_mfma_f32_16x16x32_bf16 v[88:91], v[72:75], v[56:59], v[88:91]
    ds_read_b64_tr_b16 v[40:41], v84 offset:40960
    ds_read_b64_tr_b16 v[42:43], v84 offset:41472
    v_mfma_f32_16x16x32_bf16 v[92:95], v[72:75], v[60:63], v[92:95]
    ds_read_b128 v[24:27], v50 offset:24576
    ds_read_b128 v[28:31], v50 offset:25600
    v_mfma_f32_16x16x32_bf16 v[96:99], v[72:75], v[64:67], v[96:99]
    ds_read_b128 v[32:35], v50 offset:26624
    v_mfma_f32_16x16x32_bf16 v[100:103], v[72:75], v[68:71], v[100:103]
    ds_read_b128 v[36:39], v50 offset:27648
    ds_read_b64_tr_b16 v[44:45], v85 offset:40960
    s_mov_b32 s84, 65536
    v_mfma_f32_16x16x32_bf16 v[104:107], v[76:79], v[56:59], v[104:107]
    ds_read_b64_tr_b16 v[46:47], v85 offset:41472
    buffer_load_dwordx4 v[128:131], v13, s[72:75], s84 offen
    v_mfma_f32_16x16x32_bf16 v[108:111], v[76:79], v[60:63], v[108:111]
    v_mfma_f32_16x16x32_bf16 v[112:115], v[76:79], v[64:67], v[112:115]
    s_mov_b32 s84, 98304
    v_mfma_f32_16x16x32_bf16 v[116:119], v[76:79], v[68:71], v[116:119]
    buffer_load_dwordx4 v[132:135], v13, s[72:75], s84 offen
    s_waitcnt lgkmcnt(5)
    v_mfma_f32_16x16x32_bf16 v[88:91], v[40:43], v[24:27], v[88:91]
    ds_read_b64_tr_b16 v[72:73], v84 offset:45056
    ds_read_b64_tr_b16 v[74:75], v84 offset:45568
    s_waitcnt lgkmcnt(6)
    v_mfma_f32_16x16x32_bf16 v[92:95], v[40:43], v[28:31], v[92:95]
    ds_read_b128 v[56:59], v50 offset:32768
    ds_read_b128 v[60:63], v50 offset:33792
    s_waitcnt lgkmcnt(7)
    v_mfma_f32_16x16x32_bf16 v[96:99], v[40:43], v[32:35], v[96:99]
    ds_read_b128 v[64:67], v50 offset:34816
    ds_read_b128 v[68:71], v50 offset:35840
    s_waitcnt lgkmcnt(8)
    v_mfma_f32_16x16x32_bf16 v[100:103], v[40:43], v[36:39], v[100:103]
    ds_read_b64_tr_b16 v[76:77], v85 offset:45056
    ds_read_b64_tr_b16 v[78:79], v85 offset:45568
    s_waitcnt lgkmcnt(8)
    v_mfma_f32_16x16x32_bf16 v[104:107], v[44:47], v[24:27], v[104:107]
    v_mfma_f32_16x16x32_bf16 v[108:111], v[44:47], v[28:31], v[108:111]
    v_mfma_f32_16x16x32_bf16 v[112:115], v[44:47], v[32:35], v[112:115]
    v_mfma_f32_16x16x32_bf16 v[116:119], v[44:47], v[36:39], v[116:119]
    s_waitcnt vmcnt(4) lgkmcnt(0)
    s_barrier
    v_mfma_f32_16x16x32_bf16 v[88:91], v[72:75], v[56:59], v[88:91]
    ds_read_b64_tr_b16 v[40:41], v80 offset:40960
    ds_read_b64_tr_b16 v[42:43], v80 offset:41472
    v_mfma_f32_16x16x32_bf16 v[92:95], v[72:75], v[60:63], v[92:95]
    ds_read_b128 v[24:27], v48 offset:24576
    ds_read_b128 v[28:31], v48 offset:25600
    v_mfma_f32_16x16x32_bf16 v[96:99], v[72:75], v[64:67], v[96:99]
    ds_read_b128 v[32:35], v48 offset:26624
    v_mfma_f32_16x16x32_bf16 v[100:103], v[72:75], v[68:71], v[100:103]
    ds_read_b128 v[36:39], v48 offset:27648
    ds_read_b64_tr_b16 v[44:45], v81 offset:40960
    v_mfma_f32_16x16x32_bf16 v[104:107], v[76:79], v[56:59], v[104:107]
    ds_read_b64_tr_b16 v[46:47], v81 offset:41472
    v_mfma_f32_16x16x32_bf16 v[108:111], v[76:79], v[60:63], v[108:111]
    ds_read_b64 v[168:169], v3 offset:0
    ds_read_b64 v[170:171], v3 offset:512
    ds_read_b64 v[172:173], v3 offset:1024
    v_mfma_f32_16x16x32_bf16 v[112:115], v[76:79], v[64:67], v[112:115]
    ds_read_b64 v[174:175], v3 offset:1536
    ds_read_b64 v[176:177], v3 offset:2048
    ds_read_b64 v[178:179], v3 offset:2560
    v_mfma_f32_16x16x32_bf16 v[116:119], v[76:79], v[68:71], v[116:119]
    ds_read_b64 v[180:181], v3 offset:3072
    ds_read_b64 v[182:183], v3 offset:3584
    s_waitcnt lgkmcnt(13)
    v_mfma_f32_16x16x32_bf16 v[88:91], v[40:43], v[24:27], v[88:91]
    ds_read_b64_tr_b16 v[72:73], v80 offset:45056
    ds_read_b64_tr_b16 v[74:75], v80 offset:45568
    s_waitcnt lgkmcnt(14)
    v_mfma_f32_16x16x32_bf16 v[92:95], v[40:43], v[28:31], v[92:95]
    ds_read_b128 v[56:59], v48 offset:32768
    ds_read_b128 v[60:63], v48 offset:33792
    s_waitcnt lgkmcnt(15)
    v_mfma_f32_16x16x32_bf16 v[96:99], v[40:43], v[32:35], v[96:99]
    ds_read_b128 v[64:67], v48 offset:34816
    ds_read_b128 v[68:71], v48 offset:35840
    s_waitcnt lgkmcnt(15)
    v_mfma_f32_16x16x32_bf16 v[100:103], v[40:43], v[36:39], v[100:103]
    ds_read_b64_tr_b16 v[76:77], v81 offset:45056
    ds_read_b64_tr_b16 v[78:79], v81 offset:45568
    s_waitcnt lgkmcnt(15)
    v_mfma_f32_16x16x32_bf16 v[104:107], v[44:47], v[24:27], v[104:107]
    v_lshlrev_b32 v184, 16, v168
    v_and_b32 v185, 0xffff0000, v168
    v_mfma_f32_16x16x32_bf16 v[108:111], v[44:47], v[28:31], v[108:111]
    v_lshlrev_b32 v186, 16, v169
    v_and_b32 v187, 0xffff0000, v169
    v_mfma_f32_16x16x32_bf16 v[112:115], v[44:47], v[32:35], v[112:115]
    s_waitcnt lgkmcnt(14)
    v_lshlrev_b32 v188, 16, v170
    v_and_b32 v189, 0xffff0000, v170
    v_mfma_f32_16x16x32_bf16 v[116:119], v[44:47], v[36:39], v[116:119]
    v_lshlrev_b32 v190, 16, v171
    v_and_b32 v191, 0xffff0000, v171
    s_waitcnt lgkmcnt(5)
    v_mfma_f32_16x16x32_bf16 v[88:91], v[72:75], v[56:59], v[88:91]
    v_lshlrev_b32 v192, 16, v172
    v_and_b32 v193, 0xffff0000, v172
    s_waitcnt lgkmcnt(4)
    v_mfma_f32_16x16x32_bf16 v[92:95], v[72:75], v[60:63], v[92:95]
    v_lshlrev_b32 v194, 16, v173
    v_and_b32 v195, 0xffff0000, v173
    s_waitcnt lgkmcnt(3)
    v_mfma_f32_16x16x32_bf16 v[96:99], v[72:75], v[64:67], v[96:99]
    v_lshlrev_b32 v196, 16, v174
    v_and_b32 v197, 0xffff0000, v174
    s_waitcnt lgkmcnt(2)
    v_mfma_f32_16x16x32_bf16 v[100:103], v[72:75], v[68:71], v[100:103]
    v_lshlrev_b32 v198, 16, v175
    v_and_b32 v199, 0xffff0000, v175
    s_waitcnt lgkmcnt(0)
    v_mfma_f32_16x16x32_bf16 v[104:107], v[76:79], v[56:59], v[104:107]
    s_mov_b32 s72, s22
    v_lshlrev_b32 v200, 16, v176
    v_and_b32 v201, 0xffff0000, v176
    v_mfma_f32_16x16x32_bf16 v[108:111], v[76:79], v[60:63], v[108:111]
    s_mov_b32 s73, s23
    v_lshlrev_b32 v202, 16, v177
    v_and_b32 v203, 0xffff0000, v177
    v_mfma_f32_16x16x32_bf16 v[112:115], v[76:79], v[64:67], v[112:115]
    s_mov_b32 s74, 0x400000
    v_lshlrev_b32 v204, 16, v178
    v_and_b32 v205, 0xffff0000, v178
    v_mfma_f32_16x16x32_bf16 v[116:119], v[76:79], v[68:71], v[116:119]
    s_mov_b32 s75, 0x20000
    v_lshlrev_b32 v206, 16, v179
    v_and_b32 v207, 0xffff0000, v179
    v_lshlrev_b32 v208, 16, v180
    v_and_b32 v209, 0xffff0000, v180
    v_lshlrev_b32 v210, 16, v181
    v_and_b32 v211, 0xffff0000, v181
    v_lshlrev_b32 v212, 16, v182
    v_and_b32 v213, 0xffff0000, v182
    v_lshlrev_b32 v214, 16, v183
    v_and_b32 v215, 0xffff0000, v183
    v_cvt_pk_bf16_f32 v40, v88, v89
    v_cvt_pk_bf16_f32 v41, v90, v91
    v_lshlrev_b32 v88, 16, v40
    v_and_b32 v89, 0xffff0000, v40
    v_lshlrev_b32 v90, 16, v41
    v_and_b32 v91, 0xffff0000, v41
    v_cvt_pk_bf16_f32 v42, v104, v105
    v_cvt_pk_bf16_f32 v43, v106, v107
    v_lshlrev_b32 v104, 16, v42
    v_and_b32 v105, 0xffff0000, v42
    v_lshlrev_b32 v106, 16, v43
    v_and_b32 v107, 0xffff0000, v43
    v_pk_mul_f32 v[88:89], v[88:89], v[184:185]
    v_pk_mul_f32 v[90:91], v[90:91], v[186:187]
    v_pk_mul_f32 v[104:105], v[104:105], v[200:201]
    v_pk_mul_f32 v[106:107], v[106:107], v[202:203]
    v_cvt_pk_bf16_f32 v88, v88, v89
    v_cvt_pk_bf16_f32 v89, v90, v91
    ds_write_b64 v14, v[88:89] offset:0
    v_cvt_pk_bf16_f32 v104, v104, v105
    v_cvt_pk_bf16_f32 v105, v106, v107
    ds_write_b64 v15, v[104:105] offset:0
    ds_read_b128 v[48:51], v17 offset:0
    v_cvt_pk_bf16_f32 v40, v92, v93
    v_cvt_pk_bf16_f32 v41, v94, v95
    v_lshlrev_b32 v92, 16, v40
    v_and_b32 v93, 0xffff0000, v40
    v_lshlrev_b32 v94, 16, v41
    v_and_b32 v95, 0xffff0000, v41
    v_cvt_pk_bf16_f32 v42, v108, v109
    v_cvt_pk_bf16_f32 v43, v110, v111
    v_lshlrev_b32 v108, 16, v42
    v_and_b32 v109, 0xffff0000, v42
    v_lshlrev_b32 v110, 16, v43
    v_and_b32 v111, 0xffff0000, v43
    v_pk_mul_f32 v[92:93], v[92:93], v[188:189]
    v_pk_mul_f32 v[94:95], v[94:95], v[190:191]
    v_pk_mul_f32 v[108:109], v[108:109], v[204:205]
    v_pk_mul_f32 v[110:111], v[110:111], v[206:207]
    v_cvt_pk_bf16_f32 v92, v92, v93
    v_cvt_pk_bf16_f32 v93, v94, v95
    ds_write_b64 v14, v[92:93] offset:1024
    v_cvt_pk_bf16_f32 v108, v108, v109
    v_cvt_pk_bf16_f32 v109, v110, v111
    ds_write_b64 v15, v[108:109] offset:1024
    ds_read_b128 v[52:55], v17 offset:1024
    s_waitcnt vmcnt(0)
    v_lshlrev_b32 v136, 16, v120
    v_and_b32 v137, 0xffff0000, v120
    v_lshlrev_b32 v138, 16, v121
    v_and_b32 v139, 0xffff0000, v121
    v_lshlrev_b32 v140, 16, v122
    v_and_b32 v141, 0xffff0000, v122
    v_lshlrev_b32 v142, 16, v123
    v_and_b32 v143, 0xffff0000, v123
    s_waitcnt lgkmcnt(3)
    v_lshlrev_b32 v24, 16, v48
    v_and_b32 v25, 0xffff0000, v48
    v_lshlrev_b32 v26, 16, v49
    v_and_b32 v27, 0xffff0000, v49
    v_lshlrev_b32 v28, 16, v50
    v_and_b32 v29, 0xffff0000, v50
    v_lshlrev_b32 v30, 16, v51
    v_and_b32 v31, 0xffff0000, v51
    v_pk_add_f32 v[24:25], v[24:25], v[136:137]
    v_pk_add_f32 v[26:27], v[26:27], v[138:139]
    v_pk_add_f32 v[28:29], v[28:29], v[140:141]
    v_pk_add_f32 v[30:31], v[30:31], v[142:143]
    v_cvt_pk_bf16_f32 v48, v24, v25
    v_cvt_pk_bf16_f32 v49, v26, v27
    v_cvt_pk_bf16_f32 v50, v28, v29
    v_cvt_pk_bf16_f32 v51, v30, v31
    s_mov_b32 s84, 0
    buffer_store_dwordx4 v[48:51], v13, s[72:75], s84 offen
    v_cvt_pk_bf16_f32 v40, v96, v97
    v_cvt_pk_bf16_f32 v41, v98, v99
    v_lshlrev_b32 v96, 16, v40
    v_and_b32 v97, 0xffff0000, v40
    v_lshlrev_b32 v98, 16, v41
    v_and_b32 v99, 0xffff0000, v41
    v_cvt_pk_bf16_f32 v42, v112, v113
    v_cvt_pk_bf16_f32 v43, v114, v115
    v_lshlrev_b32 v112, 16, v42
    v_and_b32 v113, 0xffff0000, v42
    v_lshlrev_b32 v114, 16, v43
    v_and_b32 v115, 0xffff0000, v43
    v_pk_mul_f32 v[96:97], v[96:97], v[192:193]
    v_pk_mul_f32 v[98:99], v[98:99], v[194:195]
    v_pk_mul_f32 v[112:113], v[112:113], v[208:209]
    v_pk_mul_f32 v[114:115], v[114:115], v[210:211]
    v_cvt_pk_bf16_f32 v96, v96, v97
    v_cvt_pk_bf16_f32 v97, v98, v99
    ds_write_b64 v14, v[96:97] offset:2048
    v_cvt_pk_bf16_f32 v112, v112, v113
    v_cvt_pk_bf16_f32 v113, v114, v115
    ds_write_b64 v15, v[112:113] offset:2048
    ds_read_b128 v[56:59], v17 offset:2048
    v_lshlrev_b32 v144, 16, v124
    v_and_b32 v145, 0xffff0000, v124
    v_lshlrev_b32 v146, 16, v125
    v_and_b32 v147, 0xffff0000, v125
    v_lshlrev_b32 v148, 16, v126
    v_and_b32 v149, 0xffff0000, v126
    v_lshlrev_b32 v150, 16, v127
    v_and_b32 v151, 0xffff0000, v127
    s_waitcnt lgkmcnt(3)
    v_lshlrev_b32 v24, 16, v52
    v_and_b32 v25, 0xffff0000, v52
    v_lshlrev_b32 v26, 16, v53
    v_and_b32 v27, 0xffff0000, v53
    v_lshlrev_b32 v28, 16, v54
    v_and_b32 v29, 0xffff0000, v54
    v_lshlrev_b32 v30, 16, v55
    v_and_b32 v31, 0xffff0000, v55
    v_pk_add_f32 v[24:25], v[24:25], v[144:145]
    v_pk_add_f32 v[26:27], v[26:27], v[146:147]
    v_pk_add_f32 v[28:29], v[28:29], v[148:149]
    v_pk_add_f32 v[30:31], v[30:31], v[150:151]
    v_cvt_pk_bf16_f32 v52, v24, v25
    v_cvt_pk_bf16_f32 v53, v26, v27
    v_cvt_pk_bf16_f32 v54, v28, v29
    v_cvt_pk_bf16_f32 v55, v30, v31
    s_mov_b32 s84, 32768
    buffer_store_dwordx4 v[52:55], v13, s[72:75], s84 offen
    v_cvt_pk_bf16_f32 v40, v100, v101
    v_cvt_pk_bf16_f32 v41, v102, v103
    v_lshlrev_b32 v100, 16, v40
    v_and_b32 v101, 0xffff0000, v40
    v_lshlrev_b32 v102, 16, v41
    v_and_b32 v103, 0xffff0000, v41
    v_cvt_pk_bf16_f32 v42, v116, v117
    v_cvt_pk_bf16_f32 v43, v118, v119
    v_lshlrev_b32 v116, 16, v42
    v_and_b32 v117, 0xffff0000, v42
    v_lshlrev_b32 v118, 16, v43
    v_and_b32 v119, 0xffff0000, v43
    v_pk_mul_f32 v[100:101], v[100:101], v[196:197]
    v_pk_mul_f32 v[102:103], v[102:103], v[198:199]
    v_pk_mul_f32 v[116:117], v[116:117], v[212:213]
    v_pk_mul_f32 v[118:119], v[118:119], v[214:215]
    v_cvt_pk_bf16_f32 v100, v100, v101
    v_cvt_pk_bf16_f32 v101, v102, v103
    ds_write_b64 v14, v[100:101] offset:3072
    v_cvt_pk_bf16_f32 v116, v116, v117
    v_cvt_pk_bf16_f32 v117, v118, v119
    ds_write_b64 v15, v[116:117] offset:3072
    ds_read_b128 v[60:63], v17 offset:3072
    v_lshlrev_b32 v152, 16, v128
    v_and_b32 v153, 0xffff0000, v128
    v_lshlrev_b32 v154, 16, v129
    v_and_b32 v155, 0xffff0000, v129
    v_lshlrev_b32 v156, 16, v130
    v_and_b32 v157, 0xffff0000, v130
    v_lshlrev_b32 v158, 16, v131
    v_and_b32 v159, 0xffff0000, v131
    s_waitcnt lgkmcnt(3)
    v_lshlrev_b32 v24, 16, v56
    v_and_b32 v25, 0xffff0000, v56
    v_lshlrev_b32 v26, 16, v57
    v_and_b32 v27, 0xffff0000, v57
    v_lshlrev_b32 v28, 16, v58
    v_and_b32 v29, 0xffff0000, v58
    v_lshlrev_b32 v30, 16, v59
    v_and_b32 v31, 0xffff0000, v59
    v_pk_add_f32 v[24:25], v[24:25], v[152:153]
    v_pk_add_f32 v[26:27], v[26:27], v[154:155]
    v_pk_add_f32 v[28:29], v[28:29], v[156:157]
    v_pk_add_f32 v[30:31], v[30:31], v[158:159]
    v_cvt_pk_bf16_f32 v56, v24, v25
    v_cvt_pk_bf16_f32 v57, v26, v27
    v_cvt_pk_bf16_f32 v58, v28, v29
    v_cvt_pk_bf16_f32 v59, v30, v31
    s_mov_b32 s84, 65536
    buffer_store_dwordx4 v[56:59], v13, s[72:75], s84 offen
    v_lshlrev_b32 v160, 16, v132
    v_and_b32 v161, 0xffff0000, v132
    v_lshlrev_b32 v162, 16, v133
    v_and_b32 v163, 0xffff0000, v133
    v_lshlrev_b32 v164, 16, v134
    v_and_b32 v165, 0xffff0000, v134
    v_lshlrev_b32 v166, 16, v135
    v_and_b32 v167, 0xffff0000, v135
    s_waitcnt lgkmcnt(0)
    v_lshlrev_b32 v24, 16, v60
    v_and_b32 v25, 0xffff0000, v60
    v_lshlrev_b32 v26, 16, v61
    v_and_b32 v27, 0xffff0000, v61
    v_lshlrev_b32 v28, 16, v62
    v_and_b32 v29, 0xffff0000, v62
    v_lshlrev_b32 v30, 16, v63
    v_and_b32 v31, 0xffff0000, v63
    v_pk_add_f32 v[24:25], v[24:25], v[160:161]
    v_pk_add_f32 v[26:27], v[26:27], v[162:163]
    v_pk_add_f32 v[28:29], v[28:29], v[164:165]
    v_pk_add_f32 v[30:31], v[30:31], v[166:167]
    v_cvt_pk_bf16_f32 v60, v24, v25
    v_cvt_pk_bf16_f32 v61, v26, v27
    v_cvt_pk_bf16_f32 v62, v28, v29
    v_cvt_pk_bf16_f32 v63, v30, v31
    s_mov_b32 s84, 98304
    buffer_store_dwordx4 v[60:63], v13, s[72:75], s84 offen
L_fin:
L_end:
    s_endpgm
L_code_end:
.section .rodata,"a"
.p2align 6
.amdhsa_kernel recurrent_scan__sliding_local_dilated__glu_gated_geglu__prompt_kernel
  .amdhsa_next_free_vgpr 256
  .amdhsa_next_free_sgpr 102
  .amdhsa_accum_offset 256
  .amdhsa_group_segment_fixed_size 0
  .amdhsa_kernarg_size 80
  .amdhsa_user_sgpr_count 2
  .amdhsa_user_sgpr_kernarg_segment_ptr 1
  .amdhsa_system_sgpr_workgroup_id_x 1
.end_amdhsa_kernel
```

```asm
; @launch grid=(256,1,1) block=(512,1,1) lds=163840
.amdgcn_target "amdgcn-amd-amdhsa--gfx950"
.text
.globl recurrent_scan__sliding_local_dilated__glu_gated_geglu__prompt_kernel
.p2align 12
.p2align 8
.type recurrent_scan__sliding_local_dilated__glu_gated_geglu__prompt_kernel,@function
recurrent_scan__sliding_local_dilated__glu_gated_geglu__prompt_kernel:
    s_cmp_ge_u32 s2, 256
    s_cbranch_scc1 L_end
    s_load_dwordx4 s[8:11], s[0:1], 0
    s_load_dwordx2 s[12:13], s[0:1], 16
    s_load_dwordx4 s[16:19], s[0:1], 32
    s_load_dwordx4 s[20:23], s[0:1], 48
    s_load_dwordx4 s[24:27], s[0:1], 64
    v_lshrrev_b32 v3, 6, v0
    v_and_b32 v1, 63, v0
    v_readfirstlane_b32 s3, v3
    s_and_b32 s84, s2, 7
    s_lshr_b32 s85, s2, 3
    s_mov_b32 s15, s85
    s_and_b32 s32, s84, 1
    s_lshl_b32 s86, s32, 3
    s_and_b32 s87, s85, 7
    s_add_u32 s28, s86, s87
    s_lshr_b32 s86, s84, 1
    s_lshl_b32 s86, s86, 2
    s_lshr_b32 s87, s85, 3
    s_add_u32 s29, s86, s87
    s_lshl_b32 s87, s32, 3
    s_xor_b32 s86, s86, s87
    s_and_b32 s87, s85, 3
    s_add_u32 s30, s86, s87
    s_lshr_b32 s31, s85, 2
    s_and_b32 s4, s3, 3
    s_lshr_b32 s5, s4, 1
    s_and_b32 s6, s4, 1
    s_lshr_b32 s7, s3, 2
    s_lshl_b32 s33, s4, 10
    s_mov_b64 exec, 0
    s_cmp_eq_u32 s3, 5
    s_cbranch_scc1 L_fan5
    s_cmp_eq_u32 s3, 6
    s_cbranch_scc1 L_fan6
    s_cmp_eq_u32 s3, 7
    s_cbranch_scc1 L_fan7
    s_cmp_lg_u32 s7, 0
    s_cbranch_scc1 L_teamB
L_teamA:
    s_mov_b64 exec, -1
    v_lshrrev_b32 v64, 4, v1
    v_bfe_u32 v65, v1, 2, 2
    v_and_b32 v66, 3, v1
    v_and_b32 v67, 15, v1
    v_lshrrev_b32 v68, 3, v1
    v_and_b32 v69, 7, v1
    s_lshl_b32 s85, s28, 7
    s_lshl_b32 s86, s4, 5
    s_add_u32 s86, s85, s86
    v_add_u32 v71, s86, v68
    v_xor_b32 v70, v69, v64
    v_lshlrev_b32 v70, 4, v70
    v_lshl_add_u32 v20, v71, 11, v70
    v_xor_b32 v21, 64, v20
    v_add_u32 v21, 16384, v21
    s_lshl_b32 s79, s4, 12
    s_and_b32 s72, s28, 3
    s_bitcmp1_b32 s28, 3
    s_cselect_b32 s91, 4, 0
    s_add_u32 s72, s72, s91
    s_mul_i32 s72, s72, 256
    s_sub_u32 s72, s72, 128
    s_lshl_b32 s85, s4, 3
    s_and_b32 s86, s4, 1
    s_lshl_b32 s86, s86, 2
    v_and_b32 v70, 2, v68
    v_xor_b32 v70, v70, v69
    v_xor_b32 v70, s86, v70
    v_add_u32 v71, s85, v68
    v_mul_u32_u24 v71, 7168, v71
    v_lshl_add_u32 v22, v70, 4, v71
    v_lshrrev_b32 v71, 2, v1
    s_lshl_b32 s86, s86, 2
    v_add_u32 v71, s86, v71
    v_mul_u32_u24 v71, 7168, v71
    v_and_b32 v70, 2, v64
    v_xor_b32 v70, v70, v66
    v_lshl_add_u32 v76, v70, 4, v71
    s_and_b32 s77, s28, 3
    s_bitcmp1_b32 s28, 3
    s_cselect_b32 s91, 4, 0
    s_add_u32 s77, s77, s91
    s_mul_i32 s77, s77, 917504
    s_add_u32 s77, s77, 0xfffc8000
    s_waitcnt lgkmcnt(0)
    s_mov_b32 s36, s8
    s_mov_b32 s37, s9
    s_mov_b32 s38, 0x400000
    s_mov_b32 s39, 0x20000
    s_add_u32 m0, s79, 116736
    s_add_u32 s72, s72, 128
    s_and_b32 s78, s72, 0x7ff
    buffer_load_dwordx4 v20, s[36:39], s78 offen lds
    s_add_u32 m0, s79, 117760
    s_nop 0
    buffer_load_dwordx4 v21, s[36:39], s78 offen lds
    s_add_u32 m0, s79, 118784
    s_add_u32 s78, s78, 32768
    buffer_load_dwordx4 v20, s[36:39], s78 offen lds
    s_add_u32 m0, s79, 119808
    s_nop 0
    buffer_load_dwordx4 v21, s[36:39], s78 offen lds
    s_mul_i32 s85, s29, 320
    s_and_b32 s86, s29, 1
    s_lshl_b32 s87, s86, 6
    s_add_u32 s87, s87, s85
    s_add_u32 s40, s16, s87
    s_addc_u32 s41, s17, 0
    s_sub_u32 s42, 7340032, s87
    s_mov_b32 s43, 0x20000
    s_add_u32 s44, s18, s87
    s_addc_u32 s45, s19, 0
    s_sub_u32 s46, 7340032, s87
    s_mov_b32 s47, 0x20000
    s_xor_b32 s86, s86, 1
    s_lshl_b32 s86, s86, 8
    s_add_u32 s87, s86, s85
    s_cmp_lt_u32 s4, 2
    s_cselect_b32 s88, s16, s18
    s_cselect_b32 s89, s17, s19
    s_add_u32 s48, s88, s87
    s_addc_u32 s49, s89, 0
    s_sub_u32 s50, 7340032, s87
    s_mov_b32 s51, 0x20000
    s_add_u32 m0, s33, 16384
    s_add_u32 s77, s77, 229376
    buffer_load_dwordx4 v22, s[40:43], s77 offen offset:0 lds
    s_add_u32 m0, s33, 20352
    s_nop 0
    buffer_load_dwordx4 v22, s[40:43], s77 offen offset:128 lds
    s_add_u32 m0, s33, 24576
    s_nop 0
    buffer_load_dwordx4 v22, s[44:47], s77 offen offset:0 lds
    s_add_u32 m0, s33, 28544
    s_nop 0
    buffer_load_dwordx4 v22, s[44:47], s77 offen offset:128 lds
    s_add_u32 m0, s33, 32768
    s_nop 0
    buffer_load_dwordx4 v76, s[48:51], s77 offen lds
    s_add_u32 m0, s33, 36864
    s_add_u32 s77, s77, 229376
    buffer_load_dwordx4 v22, s[40:43], s77 offen offset:0 lds
    s_add_u32 m0, s33, 40832
    s_nop 0
    buffer_load_dwordx4 v22, s[40:43], s77 offen offset:128 lds
    s_add_u32 m0, s33, 45056
    s_nop 0
    buffer_load_dwordx4 v22, s[44:47], s77 offen offset:0 lds
    s_add_u32 m0, s33, 49024
    s_nop 0
    buffer_load_dwordx4 v22, s[44:47], s77 offen offset:128 lds
    s_add_u32 m0, s33, 53248
    s_nop 0
    buffer_load_dwordx4 v76, s[48:51], s77 offen lds
    s_mov_b32 s68, s26
    s_mov_b32 s69, s27
    s_mov_b32 s70, 0x10000000
    s_mov_b32 s71, 0x20000
    s_getpc_b64 s[92:93]
L_pc:
    s_lshl2_add_u32 s91, s15, s4
    s_lshl_b32 s91, s91, 9
    s_min_u32 s91, s91, L_code_end - L_pc - 512
    s_load_dword s94, s[92:93], s91 offset:0
    s_load_dword s94, s[92:93], s91 offset:64
    s_load_dword s94, s[92:93], s91 offset:128
    s_load_dword s94, s[92:93], s91 offset:192
    s_load_dword s94, s[92:93], s91 offset:256
    s_load_dword s94, s[92:93], s91 offset:320
    s_load_dword s94, s[92:93], s91 offset:384
    s_load_dword s94, s[92:93], s91 offset:448
    v_lshrrev_b32 v64, 4, v1
    v_bfe_u32 v65, v1, 2, 2
    v_and_b32 v66, 3, v1
    v_and_b32 v67, 15, v1
    v_lshrrev_b32 v68, 3, v1
    v_and_b32 v69, 7, v1
    s_lshl_b32 s85, s6, 12
    s_add_u32 s85, s85, 16384
    v_lshl_add_u32 v70, v64, 3, v65
    v_lshlrev_b32 v70, 7, v70
    v_and_b32 v71, 1, v66
    v_lshl_add_u32 v70, v71, 3, v70
    v_add_u32 v70, s85, v70
    v_and_b32 v71, 2, v65
    v_and_b32 v72, 1, v64
    v_lshl_add_u32 v71, v72, 2, v71
    v_lshrrev_b32 v72, 1, v66
    v_xor_b32 v71, v71, v72
    v_xor_b32 v72, 0, v71
    v_lshl_add_u32 v4, v72, 4, v70
    v_add_u32 v9, 40960, v4
    v_xor_b32 v72, 2, v71
    v_lshl_add_u32 v5, v72, 4, v70
    v_add_u32 v10, 40960, v5
    v_xor_b32 v72, 4, v71
    v_lshl_add_u32 v6, v72, 4, v70
    v_add_u32 v11, 40960, v6
    v_xor_b32 v72, 6, v71
    v_lshl_add_u32 v7, v72, 4, v70
    v_add_u32 v12, 40960, v7
    v_lshl_add_u32 v70, v64, 3, v65
    v_lshlrev_b32 v70, 6, v70
    v_and_b32 v71, 1, v66
    v_lshl_add_u32 v70, v71, 3, v70
    v_and_b32 v71, 1, v64
    v_xor_b32 v71, s6, v71
    v_lshl_add_u32 v70, v71, 5, v70
    v_lshrrev_b32 v71, 1, v66
    v_lshl_add_u32 v70, v71, 4, v70
    v_add_u32 v8, 16384, v70
    v_add_u32 v13, 57344, v70
    v_lshrrev_b32 v70, 1, v67
    v_xor_b32 v70, v70, v64
    v_lshlrev_b32 v70, 4, v70
    v_lshl_add_u32 v70, v67, 7, v70
    s_lshl_b32 s85, s5, 13
    v_add_u32 v16, s85, v70
    v_xor_b32 v17, 64, v16
    s_mov_b32 s80, 116736
    s_lshl_b32 s86, s28, 7
    s_sub_u32 s86, s86, 16
    s_max_i32 s86, s86, 0
    s_lshl_b32 s87, s4, 2
    v_add_u32 v71, s87, v68
    v_lshrrev_b32 v70, 1, v71
    v_and_b32 v70, 7, v70
    v_xor_b32 v70, v70, v69
    v_lshlrev_b32 v70, 4, v70
    v_add_u32 v71, s86, v71
    v_lshl_add_u32 v3, v71, 11, v70
    s_lshl_b32 s81, s4, 9
    s_lshl_b32 s85, s4, 3
    s_and_b32 s86, s4, 1
    s_lshl_b32 s86, s86, 2
    v_and_b32 v70, 2, v68
    v_xor_b32 v70, v70, v69
    v_xor_b32 v70, s86, v70
    v_add_u32 v71, s85, v68
    v_mul_u32_u24 v71, 6144, v71
    v_lshl_add_u32 v23, v70, 4, v71
    s_lshl_b32 s85, s6, 2
    v_lshl_add_u32 v70, v64, 3, v65
    v_lshlrev_b32 v70, 7, v70
    v_and_b32 v71, 1, v66
    v_lshl_add_u32 v70, v71, 3, v70
    v_add_u32 v70, 0, v70
    v_and_b32 v71, 2, v65
    v_and_b32 v72, 1, v64
    v_lshl_add_u32 v71, v72, 2, v71
    v_lshrrev_b32 v72, 1, v66
    v_xor_b32 v71, v71, v72
    v_xor_b32 v71, s85, v71
    v_xor_b32 v72, 0, v71
    v_lshl_add_u32 v250, v72, 4, v70
    v_add_u32 v252, 65536, v250
    v_xor_b32 v72, 2, v71
    v_lshl_add_u32 v251, v72, 4, v70
    v_add_u32 v253, 65536, v251
    s_lshl_b32 s85, s5, 12
    v_lshl_add_u32 v248, v1, 4, s85
    v_add_u32 v249, 65536, v248
    s_lshl_b32 s85, s4, 12
    v_lshl_add_u32 v18, v1, 4, s85
    s_lshl_b32 s85, s4, 4
    v_and_b32 v70, 2, v68
    v_xor_b32 v70, v70, v69
    v_xor_b32 v70, 0, v70
    v_add_u32 v71, s85, v68
    v_mul_u32_u24 v71, 2048, v71
    v_lshl_add_u32 v254, v70, 4, v71
    s_add_u32 s85, s85, 8
    v_and_b32 v70, 2, v68
    v_xor_b32 v70, v70, v69
    v_xor_b32 v70, 4, v70
    v_add_u32 v71, s85, v68
    v_mul_u32_u24 v71, 2048, v71
    v_lshl_add_u32 v255, v70, 4, v71
    s_lshl_b32 s85, s31, 8
    s_lshl_b32 s86, s32, 7
    s_add_u32 s86, s85, s86
    s_xor_b32 s87, s86, 128
    s_lshr_b32 s91, s31, 2
    s_lshl1_add_u32 s91, s91, s32
    s_lshl_b32 s91, s91, 13
    s_add_u32 s91, s91, 0x2000000
    s_xor_b32 s85, s91, 8192
    s_and_b32 s92, s31, 3
    s_cmp_eq_u32 s92, 1
    s_cselect_b32 s86, s91, s86
    s_cselect_b32 s87, s85, s87
    s_cselect_b32 s91, 0x2a00000, 0
    s_cselect_b32 s92, s26, s20
    s_cselect_b32 s93, s27, s21
    s_max_u32 s91, s91, 7340032
    s_add_u32 s60, s92, s86
    s_addc_u32 s61, s93, 0
    s_sub_u32 s62, s91, s86
    s_mov_b32 s63, 0x20000
    s_add_u32 s64, s92, s87
    s_addc_u32 s65, s93, 0
    s_sub_u32 s66, s91, s87
    s_mov_b32 s67, 0x20000
    s_add_u32 s56, s26, 0x400000
    s_addc_u32 s57, s27, 0
    s_mov_b32 s58, 0xe00000
    s_mov_b32 s59, 0x20000
    s_mul_i32 s82, s30, 917504
    s_mul_i32 s85, s32, 327680
    s_add_u32 s82, s82, s85
    s_mul_i32 s83, s32, 2621440
    s_mul_i32 s85, s32, 10
    s_sub_u32 s85, 40, s85
    s_lshl_b32 s14, s85, 13
    s_lshl_b32 s35, s85, 16
    s_and_b32 s85, s31, 3
    s_cmp_eq_u32 s85, 1
    s_cselect_b64 vcc, -1, 0
    s_lshl_b32 s85, s4, 11
    v_lshl_add_u32 v70, v1, 4, s85
    v_add_u32 v71, 1024, v70
    v_cndmask_b32 v254, v254, v70, vcc
    v_cndmask_b32 v255, v255, v71, vcc
    v_lshrrev_b32 v78, 4, v1
    v_and_b32 v79, 1, v78
    v_lshrrev_b32 v78, 1, v78
    v_lshlrev_b32 v78, 8, v78
    v_lshl_add_u32 v78, v79, 10, v78
    v_and_b32 v79, 15, v1
    v_lshl_add_u32 v19, v79, 4, v78
    s_mul_i32 s84, s28, 112
    s_mul_i32 s85, s29, 5
    s_add_u32 s84, s84, s85
    s_lshl_b32 s84, s84, 13
    s_lshl_b32 s85, s5, 12
    s_add_u32 s84, s84, s85
    s_add_u32 s84, s84, 0x400000
    s_and_b32 s85, s29, 1
    s_lshl1_add_u32 s86, s6, s85
    s_lshl_b32 s86, s86, 13
    s_add_u32 s72, s84, s86
    s_add_u32 s73, s72, 8192
    s_xor_b32 s85, s85, 1
    s_lshl_b32 s85, s85, 15
    s_add_u32 s84, s84, s85
    s_lshl_b32 s85, s6, 9
    s_add_u32 s74, s84, s85
    s_lshl2_add_u32 s91, s2, s4
    s_lshl_b32 s75, s91, 9
    s_lshr_b32 s92, s91, 2
    s_mul_i32 s92, s92, 7168
    s_and_b32 s91, s91, 3
    s_lshl_b32 s91, s91, 9
    s_add_u32 s92, s92, s91
    s_add_u32 s99, s92, 5120
    s_mov_b32 s36, s26
    s_mov_b32 s37, s27
    s_mov_b32 s38, 0x400000
    s_mov_b32 s39, 0x20000
    s_lshl_b32 s85, s29, 7
    s_add_u32 s40, s10, s85
    s_addc_u32 s41, s11, 0
    s_sub_u32 s42, 6291456, s85
    s_mov_b32 s43, 0x20000
    s_add_u32 s86, s85, 4096
    s_add_u32 s44, s10, s86
    s_addc_u32 s45, s11, 0
    s_sub_u32 s46, 6291456, s86
    s_mov_b32 s47, 0x20000
    s_add_u32 s86, s85, 128
    s_and_b32 s86, s86, 0x7ff
    s_add_u32 s86, s86, 5120
    s_add_u32 s48, s16, s86
    s_addc_u32 s49, s17, 0
    s_sub_u32 s50, 7340032, s86
    s_mov_b32 s51, 0x20000
    s_add_u32 s52, s18, s86
    s_addc_u32 s53, s19, 0
    s_sub_u32 s54, 7340032, s86
    s_mov_b32 s55, 0x20000
    s_mov_b64 exec, 0
    s_cmp_eq_u32 s4, 0
    s_cbranch_scc1 L_pad6
    s_cmp_eq_u32 s4, 1
    s_cbranch_scc1 L_pad7
    s_cmp_eq_u32 s4, 2
    s_cbranch_scc1 L_pad0
    s_cmp_eq_u32 s4, 3
    s_cbranch_scc1 L_pad8
L_vret0:
    s_mov_b64 exec, -1
    s_mov_b64 exec, 0
    s_cmp_eq_u32 s4, 0
    s_cbranch_scc1 L_pad9
    s_cmp_eq_u32 s4, 1
    s_cbranch_scc1 L_pad1
    s_cmp_eq_u32 s4, 2
    s_cbranch_scc1 L_pad2
    s_cmp_eq_u32 s4, 3
    s_cbranch_scc1 L_pad3
L_vret1:
    s_mov_b64 exec, -1
    s_setprio 1
    s_waitcnt vmcnt(5)
    s_barrier
    v_add_u32 v14, s80, v16
    v_add_u32 v15, s80, v17
    s_add_u32 s80, s80, 18432
    s_cmp_ge_u32 s80, 153600
    s_cselect_b32 s84, 55296, 0
    s_sub_u32 s80, s80, s84
    ds_read_b64_tr_b16 v[64:65], v4 offset:0
    ds_read_b64_tr_b16 v[66:67], v4 offset:512
    ds_read_b128 v[24:27], v14 offset:0
    ds_read_b128 v[28:31], v14 offset:2048
    ds_read_b128 v[32:35], v14 offset:4096
    ds_read_b128 v[36:39], v14 offset:6144
    ds_read_b64_tr_b16 v[68:69], v4 offset:8192
    ds_read_b64_tr_b16 v[70:71], v4 offset:8704
    ds_read_b64_tr_b16 v[72:73], v5 offset:0
    ds_read_b64_tr_b16 v[74:75], v5 offset:512
    s_waitcnt lgkmcnt(7)
    v_mfma_f32_16x16x32_bf16 v[88:91], v[64:67], v[24:27], 0
    ds_read_b64_tr_b16 v[76:77], v5 offset:8192
    s_waitcnt lgkmcnt(7)
    v_mfma_f32_16x16x32_bf16 v[92:95], v[64:67], v[28:31], 0
    ds_read_b64_tr_b16 v[78:79], v5 offset:8704
    s_waitcnt lgkmcnt(7)
    v_mfma_f32_16x16x32_bf16 v[96:99], v[64:67], v[32:35], 0
    ds_read_b64_tr_b16 v[80:81], v6 offset:0
    s_waitcnt lgkmcnt(7)
    v_mfma_f32_16x16x32_bf16 v[100:103], v[64:67], v[36:39], 0
    ds_read_b64_tr_b16 v[82:83], v6 offset:512
    s_waitcnt lgkmcnt(6)
    v_mfma_f32_16x16x32_bf16 v[104:107], v[68:71], v[24:27], 0
    ds_read_b64_tr_b16 v[64:65], v6 offset:8192
    v_mfma_f32_16x16x32_bf16 v[108:111], v[68:71], v[28:31], 0
    v_mfma_f32_16x16x32_bf16 v[112:115], v[68:71], v[32:35], 0
    ds_read_b64_tr_b16 v[66:67], v6 offset:8704
    v_mfma_f32_16x16x32_bf16 v[116:119], v[68:71], v[36:39], 0
    s_waitcnt lgkmcnt(6)
    v_mfma_f32_16x16x32_bf16 v[120:123], v[72:75], v[24:27], 0
    ds_read_b64_tr_b16 v[68:69], v7 offset:0
    v_mfma_f32_16x16x32_bf16 v[124:127], v[72:75], v[28:31], 0
    v_mfma_f32_16x16x32_bf16 v[128:131], v[72:75], v[32:35], 0
    ds_read_b64_tr_b16 v[70:71], v7 offset:512
    v_mfma_f32_16x16x32_bf16 v[132:135], v[72:75], v[36:39], 0
    s_waitcnt lgkmcnt(6)
    v_mfma_f32_16x16x32_bf16 v[136:139], v[76:79], v[24:27], 0
    ds_read_b64_tr_b16 v[72:73], v7 offset:8192
    v_mfma_f32_16x16x32_bf16 v[140:143], v[76:79], v[28:31], 0
    v_mfma_f32_16x16x32_bf16 v[144:147], v[76:79], v[32:35], 0
    ds_read_b64_tr_b16 v[74:75], v7 offset:8704
    v_mfma_f32_16x16x32_bf16 v[148:151], v[76:79], v[36:39], 0
    s_waitcnt lgkmcnt(6)
    v_mfma_f32_16x16x32_bf16 v[152:155], v[80:83], v[24:27], 0
    ds_read_b64_tr_b16 v[76:77], v8 offset:16384
    v_mfma_f32_16x16x32_bf16 v[156:159], v[80:83], v[28:31], 0
    v_mfma_f32_16x16x32_bf16 v[160:163], v[80:83], v[32:35], 0
    ds_read_b64_tr_b16 v[78:79], v8 offset:16640
    v_mfma_f32_16x16x32_bf16 v[164:167], v[80:83], v[36:39], 0
    s_waitcnt lgkmcnt(6)
    v_mfma_f32_16x16x32_bf16 v[168:171], v[64:67], v[24:27], 0
    ds_read_b64_tr_b16 v[80:81], v8 offset:18432
    v_mfma_f32_16x16x32_bf16 v[172:175], v[64:67], v[28:31], 0
    v_mfma_f32_16x16x32_bf16 v[176:179], v[64:67], v[32:35], 0
    ds_read_b64_tr_b16 v[82:83], v8 offset:18688
    v_mfma_f32_16x16x32_bf16 v[180:183], v[64:67], v[36:39], 0
    s_waitcnt lgkmcnt(6)
    v_mfma_f32_16x16x32_bf16 v[184:187], v[68:71], v[24:27], 0
    v_mfma_f32_16x16x32_bf16 v[188:191], v[68:71], v[28:31], 0
    v_mfma_f32_16x16x32_bf16 v[192:195], v[68:71], v[32:35], 0
    v_mfma_f32_16x16x32_bf16 v[196:199], v[68:71], v[36:39], 0
    s_waitcnt vmcnt(0) lgkmcnt(0)
    s_barrier
    v_mfma_f32_16x16x32_bf16 v[200:203], v[72:75], v[24:27], 0
    ds_read_b64_tr_b16 v[64:65], v4 offset:20480
    v_mfma_f32_16x16x32_bf16 v[204:207], v[72:75], v[28:31], 0
    ds_read_b64_tr_b16 v[66:67], v4 offset:20992
    v_mfma_f32_16x16x32_bf16 v[208:211], v[72:75], v[32:35], 0
    ds_read_b128 v[40:43], v15 offset:0
    v_mfma_f32_16x16x32_bf16 v[212:215], v[72:75], v[36:39], 0
    ds_read_b128 v[44:47], v15 offset:2048
    v_mfma_f32_16x16x32_bf16 v[216:219], v[76:79], v[24:27], 0
    ds_read_b128 v[48:51], v15 offset:4096
    v_mfma_f32_16x16x32_bf16 v[220:223], v[76:79], v[28:31], 0
    ds_read_b128 v[52:55], v15 offset:6144
    v_mfma_f32_16x16x32_bf16 v[224:227], v[76:79], v[32:35], 0
    ds_read_b64_tr_b16 v[68:69], v4 offset:28672
    v_mfma_f32_16x16x32_bf16 v[228:231], v[76:79], v[36:39], 0
    ds_read_b64_tr_b16 v[70:71], v4 offset:29184
    v_mfma_f32_16x16x32_bf16 v[232:235], v[80:83], v[24:27], 0
    ds_read_b64_tr_b16 v[72:73], v5 offset:20480
    v_mfma_f32_16x16x32_bf16 v[236:239], v[80:83], v[28:31], 0
    v_mfma_f32_16x16x32_bf16 v[240:243], v[80:83], v[32:35], 0
    ds_read_b64_tr_b16 v[74:75], v5 offset:20992
    v_mfma_f32_16x16x32_bf16 v[244:247], v[80:83], v[36:39], 0
    s_waitcnt lgkmcnt(7)
    v_mfma_f32_16x16x32_bf16 v[88:91], v[64:67], v[40:43], v[88:91]
    ds_read_b64_tr_b16 v[76:77], v5 offset:28672
    s_waitcnt lgkmcnt(7)
    v_mfma_f32_16x16x32_bf16 v[92:95], v[64:67], v[44:47], v[92:95]
    ds_read_b64_tr_b16 v[78:79], v5 offset:29184
    s_waitcnt lgkmcnt(7)
    v_mfma_f32_16x16x32_bf16 v[96:99], v[64:67], v[48:51], v[96:99]
    ds_read_b64_tr_b16 v[80:81], v6 offset:20480
    s_waitcnt lgkmcnt(7)
    v_mfma_f32_16x16x32_bf16 v[100:103], v[64:67], v[52:55], v[100:103]
    ds_read_b64_tr_b16 v[82:83], v6 offset:20992
    s_waitcnt lgkmcnt(6)
    v_mfma_f32_16x16x32_bf16 v[104:107], v[68:71], v[40:43], v[104:107]
    ds_read_b64_tr_b16 v[64:65], v6 offset:28672
    v_mfma_f32_16x16x32_bf16 v[108:111], v[68:71], v[44:47], v[108:111]
    v_add_u32 v14, s80, v16
    v_mfma_f32_16x16x32_bf16 v[112:115], v[68:71], v[48:51], v[112:115]
    ds_read_b64_tr_b16 v[66:67], v6 offset:29184
    v_mfma_f32_16x16x32_bf16 v[116:119], v[68:71], v[52:55], v[116:119]
    v_add_u32 v15, s80, v17
    s_waitcnt lgkmcnt(6)
    v_mfma_f32_16x16x32_bf16 v[120:123], v[72:75], v[40:43], v[120:123]
    ds_read_b64_tr_b16 v[68:69], v7 offset:20480
    v_mfma_f32_16x16x32_bf16 v[124:127], v[72:75], v[44:47], v[124:127]
    s_add_u32 s80, s80, 18432
    v_mfma_f32_16x16x32_bf16 v[128:131], v[72:75], v[48:51], v[128:131]
    ds_read_b64_tr_b16 v[70:71], v7 offset:20992
    v_mfma_f32_16x16x32_bf16 v[132:135], v[72:75], v[52:55], v[132:135]
    s_cmp_ge_u32 s80, 153600
    s_cselect_b32 s84, 55296, 0
    s_waitcnt lgkmcnt(6)
    v_mfma_f32_16x16x32_bf16 v[136:139], v[76:79], v[40:43], v[136:139]
    ds_read_b64_tr_b16 v[72:73], v7 offset:28672
    v_mfma_f32_16x16x32_bf16 v[140:143], v[76:79], v[44:47], v[140:143]
    s_sub_u32 s80, s80, s84
    v_mfma_f32_16x16x32_bf16 v[144:147], v[76:79], v[48:51], v[144:147]
    ds_read_b64_tr_b16 v[74:75], v7 offset:29184
    v_mfma_f32_16x16x32_bf16 v[148:151], v[76:79], v[52:55], v[148:151]
    s_waitcnt lgkmcnt(6)
    v_mfma_f32_16x16x32_bf16 v[152:155], v[80:83], v[40:43], v[152:155]
    ds_read_b64_tr_b16 v[76:77], v8 offset:36864
    v_mfma_f32_16x16x32_bf16 v[156:159], v[80:83], v[44:47], v[156:159]
    v_mfma_f32_16x16x32_bf16 v[160:163], v[80:83], v[48:51], v[160:163]
    ds_read_b64_tr_b16 v[78:79], v8 offset:37120
    v_mfma_f32_16x16x32_bf16 v[164:167], v[80:83], v[52:55], v[164:167]
    s_waitcnt lgkmcnt(6)
    v_mfma_f32_16x16x32_bf16 v[168:171], v[64:67], v[40:43], v[168:171]
    ds_read_b64_tr_b16 v[80:81], v8 offset:38912
    v_mfma_f32_16x16x32_bf16 v[172:175], v[64:67], v[44:47], v[172:175]
    v_mfma_f32_16x16x32_bf16 v[176:179], v[64:67], v[48:51], v[176:179]
    ds_read_b64_tr_b16 v[82:83], v8 offset:39168
    v_mfma_f32_16x16x32_bf16 v[180:183], v[64:67], v[52:55], v[180:183]
    s_waitcnt lgkmcnt(6)
    v_mfma_f32_16x16x32_bf16 v[184:187], v[68:71], v[40:43], v[184:187]
    v_mfma_f32_16x16x32_bf16 v[188:191], v[68:71], v[44:47], v[188:191]
    v_mfma_f32_16x16x32_bf16 v[192:195], v[68:71], v[48:51], v[192:195]
    v_mfma_f32_16x16x32_bf16 v[196:199], v[68:71], v[52:55], v[196:199]
    s_waitcnt lgkmcnt(0)
    s_barrier
    v_mfma_f32_16x16x32_bf16 v[200:203], v[72:75], v[40:43], v[200:203]
    ds_read_b64_tr_b16 v[64:65], v9 offset:0
    v_mfma_f32_16x16x32_bf16 v[204:207], v[72:75], v[44:47], v[204:207]
    ds_read_b64_tr_b16 v[66:67], v9 offset:512
    v_mfma_f32_16x16x32_bf16 v[208:211], v[72:75], v[48:51], v[208:211]
    ds_read_b128 v[24:27], v14 offset:0
    v_mfma_f32_16x16x32_bf16 v[212:215], v[72:75], v[52:55], v[212:215]
    ds_read_b128 v[28:31], v14 offset:2048
    v_mfma_f32_16x16x32_bf16 v[216:219], v[76:79], v[40:43], v[216:219]
    ds_read_b128 v[32:35], v14 offset:4096
    v_mfma_f32_16x16x32_bf16 v[220:223], v[76:79], v[44:47], v[220:223]
    ds_read_b128 v[36:39], v14 offset:6144
    v_mfma_f32_16x16x32_bf16 v[224:227], v[76:79], v[48:51], v[224:227]
    ds_read_b64_tr_b16 v[68:69], v9 offset:8192
    v_mfma_f32_16x16x32_bf16 v[228:231], v[76:79], v[52:55], v[228:231]
    ds_read_b64_tr_b16 v[70:71], v9 offset:8704
    v_mfma_f32_16x16x32_bf16 v[232:235], v[80:83], v[40:43], v[232:235]
    ds_read_b64_tr_b16 v[72:73], v10 offset:0
    v_mfma_f32_16x16x32_bf16 v[236:239], v[80:83], v[44:47], v[236:239]
    v_mfma_f32_16x16x32_bf16 v[240:243], v[80:83], v[48:51], v[240:243]
    ds_read_b64_tr_b16 v[74:75], v10 offset:512
    v_mfma_f32_16x16x32_bf16 v[244:247], v[80:83], v[52:55], v[244:247]
    s_waitcnt lgkmcnt(7)
    v_mfma_f32_16x16x32_bf16 v[88:91], v[64:67], v[24:27], v[88:91]
    ds_read_b64_tr_b16 v[76:77], v10 offset:8192
    s_waitcnt lgkmcnt(7)
    v_mfma_f32_16x16x32_bf16 v[92:95], v[64:67], v[28:31], v[92:95]
    ds_read_b64_tr_b16 v[78:79], v10 offset:8704
    s_waitcnt lgkmcnt(7)
    v_mfma_f32_16x16x32_bf16 v[96:99], v[64:67], v[32:35], v[96:99]
    ds_read_b64_tr_b16 v[80:81], v11 offset:0
    s_waitcnt lgkmcnt(7)
    v_mfma_f32_16x16x32_bf16 v[100:103], v[64:67], v[36:39], v[100:103]
    ds_read_b64_tr_b16 v[82:83], v11 offset:512
    s_waitcnt lgkmcnt(6)
    v_mfma_f32_16x16x32_bf16 v[104:107], v[68:71], v[24:27], v[104:107]
    ds_read_b64_tr_b16 v[64:65], v11 offset:8192
    v_mfma_f32_16x16x32_bf16 v[108:111], v[68:71], v[28:31], v[108:111]
    v_mfma_f32_16x16x32_bf16 v[112:115], v[68:71], v[32:35], v[112:115]
    ds_read_b64_tr_b16 v[66:67], v11 offset:8704
    v_mfma_f32_16x16x32_bf16 v[116:119], v[68:71], v[36:39], v[116:119]
    s_waitcnt lgkmcnt(6)
    v_mfma_f32_16x16x32_bf16 v[120:123], v[72:75], v[24:27], v[120:123]
    ds_read_b64_tr_b16 v[68:69], v12 offset:0
    v_mfma_f32_16x16x32_bf16 v[124:127], v[72:75], v[28:31], v[124:127]
    v_mfma_f32_16x16x32_bf16 v[128:131], v[72:75], v[32:35], v[128:131]
    ds_read_b64_tr_b16 v[70:71], v12 offset:512
    v_mfma_f32_16x16x32_bf16 v[132:135], v[72:75], v[36:39], v[132:135]
    s_waitcnt lgkmcnt(6)
    v_mfma_f32_16x16x32_bf16 v[136:139], v[76:79], v[24:27], v[136:139]
    ds_read_b64_tr_b16 v[72:73], v12 offset:8192
    v_mfma_f32_16x16x32_bf16 v[140:143], v[76:79], v[28:31], v[140:143]
    v_mfma_f32_16x16x32_bf16 v[144:147], v[76:79], v[32:35], v[144:147]
    ds_read_b64_tr_b16 v[74:75], v12 offset:8704
    v_mfma_f32_16x16x32_bf16 v[148:151], v[76:79], v[36:39], v[148:151]
    s_waitcnt lgkmcnt(6)
    v_mfma_f32_16x16x32_bf16 v[152:155], v[80:83], v[24:27], v[152:155]
    ds_read_b64_tr_b16 v[76:77], v13 offset:16384
    v_mfma_f32_16x16x32_bf16 v[156:159], v[80:83], v[28:31], v[156:159]
    v_mfma_f32_16x16x32_bf16 v[160:163], v[80:83], v[32:35], v[160:163]
    ds_read_b64_tr_b16 v[78:79], v13 offset:16640
    v_mfma_f32_16x16x32_bf16 v[164:167], v[80:83], v[36:39], v[164:167]
    s_waitcnt lgkmcnt(6)
    v_mfma_f32_16x16x32_bf16 v[168:171], v[64:67], v[24:27], v[168:171]
    ds_read_b64_tr_b16 v[80:81], v13 offset:18432
    v_mfma_f32_16x16x32_bf16 v[172:175], v[64:67], v[28:31], v[172:175]
    v_mfma_f32_16x16x32_bf16 v[176:179], v[64:67], v[32:35], v[176:179]
    ds_read_b64_tr_b16 v[82:83], v13 offset:18688
    v_mfma_f32_16x16x32_bf16 v[180:183], v[64:67], v[36:39], v[180:183]
    s_waitcnt lgkmcnt(6)
    v_mfma_f32_16x16x32_bf16 v[184:187], v[68:71], v[24:27], v[184:187]
    v_mfma_f32_16x16x32_bf16 v[188:191], v[68:71], v[28:31], v[188:191]
    v_mfma_f32_16x16x32_bf16 v[192:195], v[68:71], v[32:35], v[192:195]
    v_mfma_f32_16x16x32_bf16 v[196:199], v[68:71], v[36:39], v[196:199]
    s_waitcnt lgkmcnt(0)
    s_barrier
    v_mfma_f32_16x16x32_bf16 v[200:203], v[72:75], v[24:27], v[200:203]
    ds_read_b64_tr_b16 v[64:65], v9 offset:20480
    v_mfma_f32_16x16x32_bf16 v[204:207], v[72:75], v[28:31], v[204:207]
    ds_read_b64_tr_b16 v[66:67], v9 offset:20992
    v_mfma_f32_16x16x32_bf16 v[208:211], v[72:75], v[32:35], v[208:211]
    ds_read_b128 v[40:43], v15 offset:0
    v_mfma_f32_16x16x32_bf16 v[212:215], v[72:75], v[36:39], v[212:215]
    ds_read_b128 v[44:47], v15 offset:2048
    v_mfma_f32_16x16x32_bf16 v[216:219], v[76:79], v[24:27], v[216:219]
    ds_read_b128 v[48:51], v15 offset:4096
    v_mfma_f32_16x16x32_bf16 v[220:223], v[76:79], v[28:31], v[220:223]
    ds_read_b128 v[52:55], v15 offset:6144
    v_mfma_f32_16x16x32_bf16 v[224:227], v[76:79], v[32:35], v[224:227]
    ds_read_b64_tr_b16 v[68:69], v9 offset:28672
    v_mfma_f32_16x16x32_bf16 v[228:231], v[76:79], v[36:39], v[228:231]
    ds_read_b64_tr_b16 v[70:71], v9 offset:29184
    v_mfma_f32_16x16x32_bf16 v[232:235], v[80:83], v[24:27], v[232:235]
    ds_read_b64_tr_b16 v[72:73], v10 offset:20480
    v_mfma_f32_16x16x32_bf16 v[236:239], v[80:83], v[28:31], v[236:239]
    v_mfma_f32_16x16x32_bf16 v[240:243], v[80:83], v[32:35], v[240:243]
    ds_read_b64_tr_b16 v[74:75], v10 offset:20992
    v_mfma_f32_16x16x32_bf16 v[244:247], v[80:83], v[36:39], v[244:247]
    s_waitcnt lgkmcnt(7)
    v_mfma_f32_16x16x32_bf16 v[88:91], v[64:67], v[40:43], v[88:91]
    ds_read_b64_tr_b16 v[76:77], v10 offset:28672
    s_waitcnt lgkmcnt(7)
    v_mfma_f32_16x16x32_bf16 v[92:95], v[64:67], v[44:47], v[92:95]
    ds_read_b64_tr_b16 v[78:79], v10 offset:29184
    s_waitcnt lgkmcnt(7)
    v_mfma_f32_16x16x32_bf16 v[96:99], v[64:67], v[48:51], v[96:99]
    ds_read_b64_tr_b16 v[80:81], v11 offset:20480
    s_waitcnt lgkmcnt(7)
    v_mfma_f32_16x16x32_bf16 v[100:103], v[64:67], v[52:55], v[100:103]
    ds_read_b64_tr_b16 v[82:83], v11 offset:20992
    s_waitcnt lgkmcnt(6)
    v_mfma_f32_16x16x32_bf16 v[104:107], v[68:71], v[40:43], v[104:107]
    ds_read_b64_tr_b16 v[64:65], v11 offset:28672
    v_mfma_f32_16x16x32_bf16 v[108:111], v[68:71], v[44:47], v[108:111]
    v_add_u32 v14, s80, v16
    v_mfma_f32_16x16x32_bf16 v[112:115], v[68:71], v[48:51], v[112:115]
    ds_read_b64_tr_b16 v[66:67], v11 offset:29184
    v_mfma_f32_16x16x32_bf16 v[116:119], v[68:71], v[52:55], v[116:119]
    v_add_u32 v15, s80, v17
    s_waitcnt lgkmcnt(6)
    v_mfma_f32_16x16x32_bf16 v[120:123], v[72:75], v[40:43], v[120:123]
    ds_read_b64_tr_b16 v[68:69], v12 offset:20480
    v_mfma_f32_16x16x32_bf16 v[124:127], v[72:75], v[44:47], v[124:127]
    s_add_u32 s80, s80, 18432
    v_mfma_f32_16x16x32_bf16 v[128:131], v[72:75], v[48:51], v[128:131]
    ds_read_b64_tr_b16 v[70:71], v12 offset:20992
    v_mfma_f32_16x16x32_bf16 v[132:135], v[72:75], v[52:55], v[132:135]
    s_cmp_ge_u32 s80, 153600
    s_cselect_b32 s84, 55296, 0
    s_waitcnt lgkmcnt(6)
    v_mfma_f32_16x16x32_bf16 v[136:139], v[76:79], v[40:43], v[136:139]
    ds_read_b64_tr_b16 v[72:73], v12 offset:28672
    v_mfma_f32_16x16x32_bf16 v[140:143], v[76:79], v[44:47], v[140:143]
    s_sub_u32 s80, s80, s84
    v_mfma_f32_16x16x32_bf16 v[144:147], v[76:79], v[48:51], v[144:147]
    ds_read_b64_tr_b16 v[74:75], v12 offset:29184
    v_mfma_f32_16x16x32_bf16 v[148:151], v[76:79], v[52:55], v[148:151]
    s_waitcnt lgkmcnt(6)
    v_mfma_f32_16x16x32_bf16 v[152:155], v[80:83], v[40:43], v[152:155]
    ds_read_b64_tr_b16 v[76:77], v13 offset:36864
    v_mfma_f32_16x16x32_bf16 v[156:159], v[80:83], v[44:47], v[156:159]
    v_mfma_f32_16x16x32_bf16 v[160:163], v[80:83], v[48:51], v[160:163]
    ds_read_b64_tr_b16 v[78:79], v13 offset:37120
    v_mfma_f32_16x16x32_bf16 v[164:167], v[80:83], v[52:55], v[164:167]
    s_waitcnt lgkmcnt(6)
    v_mfma_f32_16x16x32_bf16 v[168:171], v[64:67], v[40:43], v[168:171]
    ds_read_b64_tr_b16 v[80:81], v13 offset:38912
    v_mfma_f32_16x16x32_bf16 v[172:175], v[64:67], v[44:47], v[172:175]
    v_mfma_f32_16x16x32_bf16 v[176:179], v[64:67], v[48:51], v[176:179]
    ds_read_b64_tr_b16 v[82:83], v13 offset:39168
    v_mfma_f32_16x16x32_bf16 v[180:183], v[64:67], v[52:55], v[180:183]
    s_waitcnt lgkmcnt(6)
    v_mfma_f32_16x16x32_bf16 v[184:187], v[68:71], v[40:43], v[184:187]
    v_mfma_f32_16x16x32_bf16 v[188:191], v[68:71], v[44:47], v[188:191]
    v_mfma_f32_16x16x32_bf16 v[192:195], v[68:71], v[48:51], v[192:195]
    v_mfma_f32_16x16x32_bf16 v[196:199], v[68:71], v[52:55], v[196:199]
    s_waitcnt lgkmcnt(0)
    s_barrier
    v_mfma_f32_16x16x32_bf16 v[200:203], v[72:75], v[40:43], v[200:203]
    ds_read_b64_tr_b16 v[64:65], v4 offset:0
    v_mfma_f32_16x16x32_bf16 v[204:207], v[72:75], v[44:47], v[204:207]
    ds_read_b64_tr_b16 v[66:67], v4 offset:512
    v_mfma_f32_16x16x32_bf16 v[208:211], v[72:75], v[48:51], v[208:211]
    ds_read_b128 v[24:27], v14 offset:0
    v_mfma_f32_16x16x32_bf16 v[212:215], v[72:75], v[52:55], v[212:215]
    ds_read_b128 v[28:31], v14 offset:2048
    v_mfma_f32_16x16x32_bf16 v[216:219], v[76:79], v[40:43], v[216:219]
    ds_read_b128 v[32:35], v14 offset:4096
    v_mfma_f32_16x16x32_bf16 v[220:223], v[76:79], v[44:47], v[220:223]
    ds_read_b128 v[36:39], v14 offset:6144
    v_mfma_f32_16x16x32_bf16 v[224:227], v[76:79], v[48:51], v[224:227]
    ds_read_b64_tr_b16 v[68:69], v4 offset:8192
    v_mfma_f32_16x16x32_bf16 v[228:231], v[76:79], v[52:55], v[228:231]
    ds_read_b64_tr_b16 v[70:71], v4 offset:8704
    v_mfma_f32_16x16x32_bf16 v[232:235], v[80:83], v[40:43], v[232:235]
    ds_read_b64_tr_b16 v[72:73], v5 offset:0
    v_mfma_f32_16x16x32_bf16 v[236:239], v[80:83], v[44:47], v[236:239]
    v_mfma_f32_16x16x32_bf16 v[240:243], v[80:83], v[48:51], v[240:243]
    ds_read_b64_tr_b16 v[74:75], v5 offset:512
    v_mfma_f32_16x16x32_bf16 v[244:247], v[80:83], v[52:55], v[244:247]
    s_or_b32 s91, s2, s4
    s_cbranch_scc1 L_notok
    s_memrealtime s[92:93]
    v_mov_b32 v60, 0
    s_waitcnt lgkmcnt(0)
    s_or_b32 s92, s92, 1
    v_mov_b32 v62, s92
    v_mov_b32 v63, s93
    s_mov_b64 exec, 1
    global_store_dwordx2 v60, v[62:63], s[24:25] sc1
    s_mov_b64 exec, -1
L_notok:
    s_mov_b32 s34, 6
.p2align 6
L_p1:
    s_waitcnt lgkmcnt(7)
    v_mfma_f32_16x16x32_bf16 v[88:91], v[64:67], v[24:27], v[88:91]
    ds_read_b64_tr_b16 v[76:77], v5 offset:8192
    s_waitcnt lgkmcnt(7)
    v_mfma_f32_16x16x32_bf16 v[92:95], v[64:67], v[28:31], v[92:95]
    ds_read_b64_tr_b16 v[78:79], v5 offset:8704
    s_waitcnt lgkmcnt(7)
    v_mfma_f32_16x16x32_bf16 v[96:99], v[64:67], v[32:35], v[96:99]
    ds_read_b64_tr_b16 v[80:81], v6 offset:0
    s_waitcnt lgkmcnt(7)
    v_mfma_f32_16x16x32_bf16 v[100:103], v[64:67], v[36:39], v[100:103]
    ds_read_b64_tr_b16 v[82:83], v6 offset:512
    s_waitcnt lgkmcnt(6)
    v_mfma_f32_16x16x32_bf16 v[104:107], v[68:71], v[24:27], v[104:107]
    ds_read_b64_tr_b16 v[64:65], v6 offset:8192
    v_mfma_f32_16x16x32_bf16 v[108:111], v[68:71], v[28:31], v[108:111]
    v_mfma_f32_16x16x32_bf16 v[112:115], v[68:71], v[32:35], v[112:115]
    ds_read_b64_tr_b16 v[66:67], v6 offset:8704
    v_mfma_f32_16x16x32_bf16 v[116:119], v[68:71], v[36:39], v[116:119]
    s_waitcnt lgkmcnt(6)
    v_mfma_f32_16x16x32_bf16 v[120:123], v[72:75], v[24:27], v[120:123]
    ds_read_b64_tr_b16 v[68:69], v7 offset:0
    v_mfma_f32_16x16x32_bf16 v[124:127], v[72:75], v[28:31], v[124:127]
    v_mfma_f32_16x16x32_bf16 v[128:131], v[72:75], v[32:35], v[128:131]
    ds_read_b64_tr_b16 v[70:71], v7 offset:512
    v_mfma_f32_16x16x32_bf16 v[132:135], v[72:75], v[36:39], v[132:135]
    s_waitcnt lgkmcnt(6)
    v_mfma_f32_16x16x32_bf16 v[136:139], v[76:79], v[24:27], v[136:139]
    ds_read_b64_tr_b16 v[72:73], v7 offset:8192
    v_mfma_f32_16x16x32_bf16 v[140:143], v[76:79], v[28:31], v[140:143]
    v_mfma_f32_16x16x32_bf16 v[144:147], v[76:79], v[32:35], v[144:147]
    ds_read_b64_tr_b16 v[74:75], v7 offset:8704
    v_mfma_f32_16x16x32_bf16 v[148:151], v[76:79], v[36:39], v[148:151]
    s_waitcnt lgkmcnt(6)
    v_mfma_f32_16x16x32_bf16 v[152:155], v[80:83], v[24:27], v[152:155]
    ds_read_b64_tr_b16 v[76:77], v8 offset:16384
    v_mfma_f32_16x16x32_bf16 v[156:159], v[80:83], v[28:31], v[156:159]
    v_mfma_f32_16x16x32_bf16 v[160:163], v[80:83], v[32:35], v[160:163]
    ds_read_b64_tr_b16 v[78:79], v8 offset:16640
    v_mfma_f32_16x16x32_bf16 v[164:167], v[80:83], v[36:39], v[164:167]
    s_waitcnt lgkmcnt(6)
    v_mfma_f32_16x16x32_bf16 v[168:171], v[64:67], v[24:27], v[168:171]
    ds_read_b64_tr_b16 v[80:81], v8 offset:18432
    v_mfma_f32_16x16x32_bf16 v[172:175], v[64:67], v[28:31], v[172:175]
    v_mfma_f32_16x16x32_bf16 v[176:179], v[64:67], v[32:35], v[176:179]
    ds_read_b64_tr_b16 v[82:83], v8 offset:18688
    v_mfma_f32_16x16x32_bf16 v[180:183], v[64:67], v[36:39], v[180:183]
    s_waitcnt lgkmcnt(6)
    v_mfma_f32_16x16x32_bf16 v[184:187], v[68:71], v[24:27], v[184:187]
    v_mfma_f32_16x16x32_bf16 v[188:191], v[68:71], v[28:31], v[188:191]
    v_mfma_f32_16x16x32_bf16 v[192:195], v[68:71], v[32:35], v[192:195]
    v_mfma_f32_16x16x32_bf16 v[196:199], v[68:71], v[36:39], v[196:199]
    s_waitcnt lgkmcnt(0)
    s_barrier
    v_mfma_f32_16x16x32_bf16 v[200:203], v[72:75], v[24:27], v[200:203]
    ds_read_b64_tr_b16 v[64:65], v4 offset:20480
    v_mfma_f32_16x16x32_bf16 v[204:207], v[72:75], v[28:31], v[204:207]
    ds_read_b64_tr_b16 v[66:67], v4 offset:20992
    v_mfma_f32_16x16x32_bf16 v[208:211], v[72:75], v[32:35], v[208:211]
    ds_read_b128 v[40:43], v15 offset:0
    v_mfma_f32_16x16x32_bf16 v[212:215], v[72:75], v[36:39], v[212:215]
    ds_read_b128 v[44:47], v15 offset:2048
    v_mfma_f32_16x16x32_bf16 v[216:219], v[76:79], v[24:27], v[216:219]
    ds_read_b128 v[48:51], v15 offset:4096
    v_mfma_f32_16x16x32_bf16 v[220:223], v[76:79], v[28:31], v[220:223]
    ds_read_b128 v[52:55], v15 offset:6144
    v_mfma_f32_16x16x32_bf16 v[224:227], v[76:79], v[32:35], v[224:227]
    ds_read_b64_tr_b16 v[68:69], v4 offset:28672
    v_mfma_f32_16x16x32_bf16 v[228:231], v[76:79], v[36:39], v[228:231]
    ds_read_b64_tr_b16 v[70:71], v4 offset:29184
    v_mfma_f32_16x16x32_bf16 v[232:235], v[80:83], v[24:27], v[232:235]
    ds_read_b64_tr_b16 v[72:73], v5 offset:20480
    v_mfma_f32_16x16x32_bf16 v[236:239], v[80:83], v[28:31], v[236:239]
    v_mfma_f32_16x16x32_bf16 v[240:243], v[80:83], v[32:35], v[240:243]
    ds_read_b64_tr_b16 v[74:75], v5 offset:20992
    v_mfma_f32_16x16x32_bf16 v[244:247], v[80:83], v[36:39], v[244:247]
    s_waitcnt lgkmcnt(7)
    v_mfma_f32_16x16x32_bf16 v[88:91], v[64:67], v[40:43], v[88:91]
    ds_read_b64_tr_b16 v[76:77], v5 offset:28672
    s_waitcnt lgkmcnt(7)
    v_mfma_f32_16x16x32_bf16 v[92:95], v[64:67], v[44:47], v[92:95]
    ds_read_b64_tr_b16 v[78:79], v5 offset:29184
    s_waitcnt lgkmcnt(7)
    v_mfma_f32_16x16x32_bf16 v[96:99], v[64:67], v[48:51], v[96:99]
    ds_read_b64_tr_b16 v[80:81], v6 offset:20480
    s_waitcnt lgkmcnt(7)
    v_mfma_f32_16x16x32_bf16 v[100:103], v[64:67], v[52:55], v[100:103]
    ds_read_b64_tr_b16 v[82:83], v6 offset:20992
    s_waitcnt lgkmcnt(6)
    v_mfma_f32_16x16x32_bf16 v[104:107], v[68:71], v[40:43], v[104:107]
    ds_read_b64_tr_b16 v[64:65], v6 offset:28672
    v_mfma_f32_16x16x32_bf16 v[108:111], v[68:71], v[44:47], v[108:111]
    v_add_u32 v14, s80, v16
    v_mfma_f32_16x16x32_bf16 v[112:115], v[68:71], v[48:51], v[112:115]
    ds_read_b64_tr_b16 v[66:67], v6 offset:29184
    v_mfma_f32_16x16x32_bf16 v[116:119], v[68:71], v[52:55], v[116:119]
    v_add_u32 v15, s80, v17
    s_waitcnt lgkmcnt(6)
    v_mfma_f32_16x16x32_bf16 v[120:123], v[72:75], v[40:43], v[120:123]
    ds_read_b64_tr_b16 v[68:69], v7 offset:20480
    v_mfma_f32_16x16x32_bf16 v[124:127], v[72:75], v[44:47], v[124:127]
    s_add_u32 s80, s80, 18432
    v_mfma_f32_16x16x32_bf16 v[128:131], v[72:75], v[48:51], v[128:131]
    ds_read_b64_tr_b16 v[70:71], v7 offset:20992
    v_mfma_f32_16x16x32_bf16 v[132:135], v[72:75], v[52:55], v[132:135]
    s_cmp_ge_u32 s80, 153600
    s_cselect_b32 s84, 55296, 0
    s_waitcnt lgkmcnt(6)
    v_mfma_f32_16x16x32_bf16 v[136:139], v[76:79], v[40:43], v[136:139]
    ds_read_b64_tr_b16 v[72:73], v7 offset:28672
    v_mfma_f32_16x16x32_bf16 v[140:143], v[76:79], v[44:47], v[140:143]
    s_sub_u32 s80, s80, s84
    v_mfma_f32_16x16x32_bf16 v[144:147], v[76:79], v[48:51], v[144:147]
    ds_read_b64_tr_b16 v[74:75], v7 offset:29184
    v_mfma_f32_16x16x32_bf16 v[148:151], v[76:79], v[52:55], v[148:151]
    s_waitcnt lgkmcnt(6)
    v_mfma_f32_16x16x32_bf16 v[152:155], v[80:83], v[40:43], v[152:155]
    ds_read_b64_tr_b16 v[76:77], v8 offset:36864
    v_mfma_f32_16x16x32_bf16 v[156:159], v[80:83], v[44:47], v[156:159]
    v_mfma_f32_16x16x32_bf16 v[160:163], v[80:83], v[48:51], v[160:163]
    ds_read_b64_tr_b16 v[78:79], v8 offset:37120
    v_mfma_f32_16x16x32_bf16 v[164:167], v[80:83], v[52:55], v[164:167]
    s_waitcnt lgkmcnt(6)
    v_mfma_f32_16x16x32_bf16 v[168:171], v[64:67], v[40:43], v[168:171]
    ds_read_b64_tr_b16 v[80:81], v8 offset:38912
    v_mfma_f32_16x16x32_bf16 v[172:175], v[64:67], v[44:47], v[172:175]
    v_mfma_f32_16x16x32_bf16 v[176:179], v[64:67], v[48:51], v[176:179]
    ds_read_b64_tr_b16 v[82:83], v8 offset:39168
    v_mfma_f32_16x16x32_bf16 v[180:183], v[64:67], v[52:55], v[180:183]
    s_waitcnt lgkmcnt(6)
    v_mfma_f32_16x16x32_bf16 v[184:187], v[68:71], v[40:43], v[184:187]
    v_mfma_f32_16x16x32_bf16 v[188:191], v[68:71], v[44:47], v[188:191]
    v_mfma_f32_16x16x32_bf16 v[192:195], v[68:71], v[48:51], v[192:195]
    v_mfma_f32_16x16x32_bf16 v[196:199], v[68:71], v[52:55], v[196:199]
    s_waitcnt lgkmcnt(0)
    s_barrier
    v_mfma_f32_16x16x32_bf16 v[200:203], v[72:75], v[40:43], v[200:203]
    ds_read_b64_tr_b16 v[64:65], v9 offset:0
    v_mfma_f32_16x16x32_bf16 v[204:207], v[72:75], v[44:47], v[204:207]
    ds_read_b64_tr_b16 v[66:67], v9 offset:512
    v_mfma_f32_16x16x32_bf16 v[208:211], v[72:75], v[48:51], v[208:211]
    ds_read_b128 v[24:27], v14 offset:0
    v_mfma_f32_16x16x32_bf16 v[212:215], v[72:75], v[52:55], v[212:215]
    ds_read_b128 v[28:31], v14 offset:2048
    v_mfma_f32_16x16x32_bf16 v[216:219], v[76:79], v[40:43], v[216:219]
    ds_read_b128 v[32:35], v14 offset:4096
    v_mfma_f32_16x16x32_bf16 v[220:223], v[76:79], v[44:47], v[220:223]
    ds_read_b128 v[36:39], v14 offset:6144
    v_mfma_f32_16x16x32_bf16 v[224:227], v[76:79], v[48:51], v[224:227]
    ds_read_b64_tr_b16 v[68:69], v9 offset:8192
    v_mfma_f32_16x16x32_bf16 v[228:231], v[76:79], v[52:55], v[228:231]
    ds_read_b64_tr_b16 v[70:71], v9 offset:8704
    v_mfma_f32_16x16x32_bf16 v[232:235], v[80:83], v[40:43], v[232:235]
    ds_read_b64_tr_b16 v[72:73], v10 offset:0
    v_mfma_f32_16x16x32_bf16 v[236:239], v[80:83], v[44:47], v[236:239]
    v_mfma_f32_16x16x32_bf16 v[240:243], v[80:83], v[48:51], v[240:243]
    ds_read_b64_tr_b16 v[74:75], v10 offset:512
    v_mfma_f32_16x16x32_bf16 v[244:247], v[80:83], v[52:55], v[244:247]
    s_waitcnt lgkmcnt(7)
    v_mfma_f32_16x16x32_bf16 v[88:91], v[64:67], v[24:27], v[88:91]
    ds_read_b64_tr_b16 v[76:77], v10 offset:8192
    s_waitcnt lgkmcnt(7)
    v_mfma_f32_16x16x32_bf16 v[92:95], v[64:67], v[28:31], v[92:95]
    ds_read_b64_tr_b16 v[78:79], v10 offset:8704
    s_waitcnt lgkmcnt(7)
    v_mfma_f32_16x16x32_bf16 v[96:99], v[64:67], v[32:35], v[96:99]
    ds_read_b64_tr_b16 v[80:81], v11 offset:0
    s_waitcnt lgkmcnt(7)
    v_mfma_f32_16x16x32_bf16 v[100:103], v[64:67], v[36:39], v[100:103]
    ds_read_b64_tr_b16 v[82:83], v11 offset:512
    s_waitcnt lgkmcnt(6)
    v_mfma_f32_16x16x32_bf16 v[104:107], v[68:71], v[24:27], v[104:107]
    ds_read_b64_tr_b16 v[64:65], v11 offset:8192
    v_mfma_f32_16x16x32_bf16 v[108:111], v[68:71], v[28:31], v[108:111]
    v_mfma_f32_16x16x32_bf16 v[112:115], v[68:71], v[32:35], v[112:115]
    ds_read_b64_tr_b16 v[66:67], v11 offset:8704
    v_mfma_f32_16x16x32_bf16 v[116:119], v[68:71], v[36:39], v[116:119]
    s_waitcnt lgkmcnt(6)
    v_mfma_f32_16x16x32_bf16 v[120:123], v[72:75], v[24:27], v[120:123]
    ds_read_b64_tr_b16 v[68:69], v12 offset:0
    v_mfma_f32_16x16x32_bf16 v[124:127], v[72:75], v[28:31], v[124:127]
    v_mfma_f32_16x16x32_bf16 v[128:131], v[72:75], v[32:35], v[128:131]
    ds_read_b64_tr_b16 v[70:71], v12 offset:512
    v_mfma_f32_16x16x32_bf16 v[132:135], v[72:75], v[36:39], v[132:135]
    s_waitcnt lgkmcnt(6)
    v_mfma_f32_16x16x32_bf16 v[136:139], v[76:79], v[24:27], v[136:139]
    ds_read_b64_tr_b16 v[72:73], v12 offset:8192
    v_mfma_f32_16x16x32_bf16 v[140:143], v[76:79], v[28:31], v[140:143]
    v_mfma_f32_16x16x32_bf16 v[144:147], v[76:79], v[32:35], v[144:147]
    ds_read_b64_tr_b16 v[74:75], v12 offset:8704
    v_mfma_f32_16x16x32_bf16 v[148:151], v[76:79], v[36:39], v[148:151]
    s_waitcnt lgkmcnt(6)
    v_mfma_f32_16x16x32_bf16 v[152:155], v[80:83], v[24:27], v[152:155]
    ds_read_b64_tr_b16 v[76:77], v13 offset:16384
    v_mfma_f32_16x16x32_bf16 v[156:159], v[80:83], v[28:31], v[156:159]
    v_mfma_f32_16x16x32_bf16 v[160:163], v[80:83], v[32:35], v[160:163]
    ds_read_b64_tr_b16 v[78:79], v13 offset:16640
    v_mfma_f32_16x16x32_bf16 v[164:167], v[80:83], v[36:39], v[164:167]
    s_waitcnt lgkmcnt(6)
    v_mfma_f32_16x16x32_bf16 v[168:171], v[64:67], v[24:27], v[168:171]
    ds_read_b64_tr_b16 v[80:81], v13 offset:18432
    v_mfma_f32_16x16x32_bf16 v[172:175], v[64:67], v[28:31], v[172:175]
    v_mfma_f32_16x16x32_bf16 v[176:179], v[64:67], v[32:35], v[176:179]
    ds_read_b64_tr_b16 v[82:83], v13 offset:18688
    v_mfma_f32_16x16x32_bf16 v[180:183], v[64:67], v[36:39], v[180:183]
    s_waitcnt lgkmcnt(6)
    v_mfma_f32_16x16x32_bf16 v[184:187], v[68:71], v[24:27], v[184:187]
    v_mfma_f32_16x16x32_bf16 v[188:191], v[68:71], v[28:31], v[188:191]
    v_mfma_f32_16x16x32_bf16 v[192:195], v[68:71], v[32:35], v[192:195]
    v_mfma_f32_16x16x32_bf16 v[196:199], v[68:71], v[36:39], v[196:199]
    s_waitcnt lgkmcnt(0)
    s_barrier
    v_mfma_f32_16x16x32_bf16 v[200:203], v[72:75], v[24:27], v[200:203]
    ds_read_b64_tr_b16 v[64:65], v9 offset:20480
    v_mfma_f32_16x16x32_bf16 v[204:207], v[72:75], v[28:31], v[204:207]
    ds_read_b64_tr_b16 v[66:67], v9 offset:20992
    v_mfma_f32_16x16x32_bf16 v[208:211], v[72:75], v[32:35], v[208:211]
    ds_read_b128 v[40:43], v15 offset:0
    v_mfma_f32_16x16x32_bf16 v[212:215], v[72:75], v[36:39], v[212:215]
    ds_read_b128 v[44:47], v15 offset:2048
    v_mfma_f32_16x16x32_bf16 v[216:219], v[76:79], v[24:27], v[216:219]
    ds_read_b128 v[48:51], v15 offset:4096
    v_mfma_f32_16x16x32_bf16 v[220:223], v[76:79], v[28:31], v[220:223]
    ds_read_b128 v[52:55], v15 offset:6144
    v_mfma_f32_16x16x32_bf16 v[224:227], v[76:79], v[32:35], v[224:227]
    ds_read_b64_tr_b16 v[68:69], v9 offset:28672
    v_mfma_f32_16x16x32_bf16 v[228:231], v[76:79], v[36:39], v[228:231]
    ds_read_b64_tr_b16 v[70:71], v9 offset:29184
    v_mfma_f32_16x16x32_bf16 v[232:235], v[80:83], v[24:27], v[232:235]
    ds_read_b64_tr_b16 v[72:73], v10 offset:20480
    v_mfma_f32_16x16x32_bf16 v[236:239], v[80:83], v[28:31], v[236:239]
    v_mfma_f32_16x16x32_bf16 v[240:243], v[80:83], v[32:35], v[240:243]
    ds_read_b64_tr_b16 v[74:75], v10 offset:20992
    v_mfma_f32_16x16x32_bf16 v[244:247], v[80:83], v[36:39], v[244:247]
    s_waitcnt lgkmcnt(7)
    v_mfma_f32_16x16x32_bf16 v[88:91], v[64:67], v[40:43], v[88:91]
    ds_read_b64_tr_b16 v[76:77], v10 offset:28672
    s_waitcnt lgkmcnt(7)
    v_mfma_f32_16x16x32_bf16 v[92:95], v[64:67], v[44:47], v[92:95]
    ds_read_b64_tr_b16 v[78:79], v10 offset:29184
    s_waitcnt lgkmcnt(7)
    v_mfma_f32_16x16x32_bf16 v[96:99], v[64:67], v[48:51], v[96:99]
    ds_read_b64_tr_b16 v[80:81], v11 offset:20480
    s_waitcnt lgkmcnt(7)
    v_mfma_f32_16x16x32_bf16 v[100:103], v[64:67], v[52:55], v[100:103]
    ds_read_b64_tr_b16 v[82:83], v11 offset:20992
    s_waitcnt lgkmcnt(6)
    v_mfma_f32_16x16x32_bf16 v[104:107], v[68:71], v[40:43], v[104:107]
    ds_read_b64_tr_b16 v[64:65], v11 offset:28672
    v_mfma_f32_16x16x32_bf16 v[108:111], v[68:71], v[44:47], v[108:111]
    v_add_u32 v14, s80, v16
    v_mfma_f32_16x16x32_bf16 v[112:115], v[68:71], v[48:51], v[112:115]
    ds_read_b64_tr_b16 v[66:67], v11 offset:29184
    v_mfma_f32_16x16x32_bf16 v[116:119], v[68:71], v[52:55], v[116:119]
    v_add_u32 v15, s80, v17
    s_waitcnt lgkmcnt(6)
    v_mfma_f32_16x16x32_bf16 v[120:123], v[72:75], v[40:43], v[120:123]
    ds_read_b64_tr_b16 v[68:69], v12 offset:20480
    v_mfma_f32_16x16x32_bf16 v[124:127], v[72:75], v[44:47], v[124:127]
    s_add_u32 s80, s80, 18432
    v_mfma_f32_16x16x32_bf16 v[128:131], v[72:75], v[48:51], v[128:131]
    ds_read_b64_tr_b16 v[70:71], v12 offset:20992
    v_mfma_f32_16x16x32_bf16 v[132:135], v[72:75], v[52:55], v[132:135]
    s_cmp_ge_u32 s80, 153600
    s_cselect_b32 s84, 55296, 0
    s_waitcnt lgkmcnt(6)
    v_mfma_f32_16x16x32_bf16 v[136:139], v[76:79], v[40:43], v[136:139]
    ds_read_b64_tr_b16 v[72:73], v12 offset:28672
    v_mfma_f32_16x16x32_bf16 v[140:143], v[76:79], v[44:47], v[140:143]
    s_sub_u32 s80, s80, s84
    v_mfma_f32_16x16x32_bf16 v[144:147], v[76:79], v[48:51], v[144:147]
    ds_read_b64_tr_b16 v[74:75], v12 offset:29184
    v_mfma_f32_16x16x32_bf16 v[148:151], v[76:79], v[52:55], v[148:151]
    s_waitcnt lgkmcnt(6)
    v_mfma_f32_16x16x32_bf16 v[152:155], v[80:83], v[40:43], v[152:155]
    ds_read_b64_tr_b16 v[76:77], v13 offset:36864
    v_mfma_f32_16x16x32_bf16 v[156:159], v[80:83], v[44:47], v[156:159]
    v_mfma_f32_16x16x32_bf16 v[160:163], v[80:83], v[48:51], v[160:163]
    ds_read_b64_tr_b16 v[78:79], v13 offset:37120
    v_mfma_f32_16x16x32_bf16 v[164:167], v[80:83], v[52:55], v[164:167]
    s_waitcnt lgkmcnt(6)
    v_mfma_f32_16x16x32_bf16 v[168:171], v[64:67], v[40:43], v[168:171]
    ds_read_b64_tr_b16 v[80:81], v13 offset:38912
    v_mfma_f32_16x16x32_bf16 v[172:175], v[64:67], v[44:47], v[172:175]
    v_mfma_f32_16x16x32_bf16 v[176:179], v[64:67], v[48:51], v[176:179]
    ds_read_b64_tr_b16 v[82:83], v13 offset:39168
    v_mfma_f32_16x16x32_bf16 v[180:183], v[64:67], v[52:55], v[180:183]
    s_waitcnt lgkmcnt(6)
    v_mfma_f32_16x16x32_bf16 v[184:187], v[68:71], v[40:43], v[184:187]
    v_mfma_f32_16x16x32_bf16 v[188:191], v[68:71], v[44:47], v[188:191]
    v_mfma_f32_16x16x32_bf16 v[192:195], v[68:71], v[48:51], v[192:195]
    v_mfma_f32_16x16x32_bf16 v[196:199], v[68:71], v[52:55], v[196:199]
    s_waitcnt lgkmcnt(0)
    s_barrier
    v_mfma_f32_16x16x32_bf16 v[200:203], v[72:75], v[40:43], v[200:203]
    ds_read_b64_tr_b16 v[64:65], v4 offset:0
    v_mfma_f32_16x16x32_bf16 v[204:207], v[72:75], v[44:47], v[204:207]
    ds_read_b64_tr_b16 v[66:67], v4 offset:512
    v_mfma_f32_16x16x32_bf16 v[208:211], v[72:75], v[48:51], v[208:211]
    ds_read_b128 v[24:27], v14 offset:0
    v_mfma_f32_16x16x32_bf16 v[212:215], v[72:75], v[52:55], v[212:215]
    ds_read_b128 v[28:31], v14 offset:2048
    v_mfma_f32_16x16x32_bf16 v[216:219], v[76:79], v[40:43], v[216:219]
    ds_read_b128 v[32:35], v14 offset:4096
    v_mfma_f32_16x16x32_bf16 v[220:223], v[76:79], v[44:47], v[220:223]
    ds_read_b128 v[36:39], v14 offset:6144
    v_mfma_f32_16x16x32_bf16 v[224:227], v[76:79], v[48:51], v[224:227]
    ds_read_b64_tr_b16 v[68:69], v4 offset:8192
    v_mfma_f32_16x16x32_bf16 v[228:231], v[76:79], v[52:55], v[228:231]
    ds_read_b64_tr_b16 v[70:71], v4 offset:8704
    v_mfma_f32_16x16x32_bf16 v[232:235], v[80:83], v[40:43], v[232:235]
    ds_read_b64_tr_b16 v[72:73], v5 offset:0
    v_mfma_f32_16x16x32_bf16 v[236:239], v[80:83], v[44:47], v[236:239]
    v_mfma_f32_16x16x32_bf16 v[240:243], v[80:83], v[48:51], v[240:243]
    ds_read_b64_tr_b16 v[74:75], v5 offset:512
    v_mfma_f32_16x16x32_bf16 v[244:247], v[80:83], v[52:55], v[244:247]
    s_sub_u32 s34, s34, 1
    s_cmp_lg_u32 s34, 0
    s_cbranch_scc1 L_p1
    s_waitcnt lgkmcnt(7)
    v_mfma_f32_16x16x32_bf16 v[88:91], v[64:67], v[24:27], v[88:91]
    ds_read_b64_tr_b16 v[76:77], v5 offset:8192
    s_waitcnt lgkmcnt(7)
    v_mfma_f32_16x16x32_bf16 v[92:95], v[64:67], v[28:31], v[92:95]
    ds_read_b64_tr_b16 v[78:79], v5 offset:8704
    s_waitcnt lgkmcnt(7)
    v_mfma_f32_16x16x32_bf16 v[96:99], v[64:67], v[32:35], v[96:99]
    ds_read_b64_tr_b16 v[80:81], v6 offset:0
    s_waitcnt lgkmcnt(7)
    v_mfma_f32_16x16x32_bf16 v[100:103], v[64:67], v[36:39], v[100:103]
    ds_read_b64_tr_b16 v[82:83], v6 offset:512
    s_waitcnt lgkmcnt(6)
    v_mfma_f32_16x16x32_bf16 v[104:107], v[68:71], v[24:27], v[104:107]
    ds_read_b64_tr_b16 v[64:65], v6 offset:8192
    v_mfma_f32_16x16x32_bf16 v[108:111], v[68:71], v[28:31], v[108:111]
    v_mfma_f32_16x16x32_bf16 v[112:115], v[68:71], v[32:35], v[112:115]
    ds_read_b64_tr_b16 v[66:67], v6 offset:8704
    v_mfma_f32_16x16x32_bf16 v[116:119], v[68:71], v[36:39], v[116:119]
    s_waitcnt lgkmcnt(6)
    v_mfma_f32_16x16x32_bf16 v[120:123], v[72:75], v[24:27], v[120:123]
    ds_read_b64_tr_b16 v[68:69], v7 offset:0
    v_mfma_f32_16x16x32_bf16 v[124:127], v[72:75], v[28:31], v[124:127]
    v_mfma_f32_16x16x32_bf16 v[128:131], v[72:75], v[32:35], v[128:131]
    ds_read_b64_tr_b16 v[70:71], v7 offset:512
    v_mfma_f32_16x16x32_bf16 v[132:135], v[72:75], v[36:39], v[132:135]
    s_waitcnt lgkmcnt(6)
    v_mfma_f32_16x16x32_bf16 v[136:139], v[76:79], v[24:27], v[136:139]
    ds_read_b64_tr_b16 v[72:73], v7 offset:8192
    v_mfma_f32_16x16x32_bf16 v[140:143], v[76:79], v[28:31], v[140:143]
    v_mfma_f32_16x16x32_bf16 v[144:147], v[76:79], v[32:35], v[144:147]
    ds_read_b64_tr_b16 v[74:75], v7 offset:8704
    v_mfma_f32_16x16x32_bf16 v[148:151], v[76:79], v[36:39], v[148:151]
    s_waitcnt lgkmcnt(6)
    v_mfma_f32_16x16x32_bf16 v[152:155], v[80:83], v[24:27], v[152:155]
    ds_read_b64_tr_b16 v[76:77], v8 offset:16384
    v_mfma_f32_16x16x32_bf16 v[156:159], v[80:83], v[28:31], v[156:159]
    v_mfma_f32_16x16x32_bf16 v[160:163], v[80:83], v[32:35], v[160:163]
    ds_read_b64_tr_b16 v[78:79], v8 offset:16640
    v_mfma_f32_16x16x32_bf16 v[164:167], v[80:83], v[36:39], v[164:167]
    s_waitcnt lgkmcnt(6)
    v_mfma_f32_16x16x32_bf16 v[168:171], v[64:67], v[24:27], v[168:171]
    ds_read_b64_tr_b16 v[80:81], v8 offset:18432
    v_mfma_f32_16x16x32_bf16 v[172:175], v[64:67], v[28:31], v[172:175]
    v_mfma_f32_16x16x32_bf16 v[176:179], v[64:67], v[32:35], v[176:179]
    ds_read_b64_tr_b16 v[82:83], v8 offset:18688
    v_mfma_f32_16x16x32_bf16 v[180:183], v[64:67], v[36:39], v[180:183]
    s_waitcnt lgkmcnt(6)
    v_mfma_f32_16x16x32_bf16 v[184:187], v[68:71], v[24:27], v[184:187]
    v_mfma_f32_16x16x32_bf16 v[188:191], v[68:71], v[28:31], v[188:191]
    v_mfma_f32_16x16x32_bf16 v[192:195], v[68:71], v[32:35], v[192:195]
    v_mfma_f32_16x16x32_bf16 v[196:199], v[68:71], v[36:39], v[196:199]
    s_waitcnt lgkmcnt(0)
    s_barrier
    v_mfma_f32_16x16x32_bf16 v[200:203], v[72:75], v[24:27], v[200:203]
    ds_read_b64_tr_b16 v[64:65], v4 offset:20480
    v_mfma_f32_16x16x32_bf16 v[204:207], v[72:75], v[28:31], v[204:207]
    ds_read_b64_tr_b16 v[66:67], v4 offset:20992
    v_mfma_f32_16x16x32_bf16 v[208:211], v[72:75], v[32:35], v[208:211]
    ds_read_b128 v[40:43], v15 offset:0
L_pad0:
    s_cbranch_execz L_vret0
    v_mfma_f32_16x16x32_bf16 v[212:215], v[72:75], v[36:39], v[212:215]
    ds_read_b128 v[44:47], v15 offset:2048
    v_mfma_f32_16x16x32_bf16 v[216:219], v[76:79], v[24:27], v[216:219]
    ds_read_b128 v[48:51], v15 offset:4096
    v_mfma_f32_16x16x32_bf16 v[220:223], v[76:79], v[28:31], v[220:223]
    ds_read_b128 v[52:55], v15 offset:6144
    v_mfma_f32_16x16x32_bf16 v[224:227], v[76:79], v[32:35], v[224:227]
    ds_read_b64_tr_b16 v[68:69], v4 offset:28672
    v_mfma_f32_16x16x32_bf16 v[228:231], v[76:79], v[36:39], v[228:231]
    ds_read_b64_tr_b16 v[70:71], v4 offset:29184
    v_mfma_f32_16x16x32_bf16 v[232:235], v[80:83], v[24:27], v[232:235]
    ds_read_b64_tr_b16 v[72:73], v5 offset:20480
    v_mfma_f32_16x16x32_bf16 v[236:239], v[80:83], v[28:31], v[236:239]
    v_mfma_f32_16x16x32_bf16 v[240:243], v[80:83], v[32:35], v[240:243]
    ds_read_b64_tr_b16 v[74:75], v5 offset:20992
    v_mfma_f32_16x16x32_bf16 v[244:247], v[80:83], v[36:39], v[244:247]
    s_waitcnt lgkmcnt(7)
    v_mfma_f32_16x16x32_bf16 v[88:91], v[64:67], v[40:43], v[88:91]
    ds_read_b64_tr_b16 v[76:77], v5 offset:28672
    s_waitcnt lgkmcnt(7)
    v_mfma_f32_16x16x32_bf16 v[92:95], v[64:67], v[44:47], v[92:95]
    ds_read_b64_tr_b16 v[78:79], v5 offset:29184
    s_waitcnt lgkmcnt(7)
    v_mfma_f32_16x16x32_bf16 v[96:99], v[64:67], v[48:51], v[96:99]
    ds_read_b64_tr_b16 v[80:81], v6 offset:20480
    s_waitcnt lgkmcnt(7)
    v_mfma_f32_16x16x32_bf16 v[100:103], v[64:67], v[52:55], v[100:103]
    ds_read_b64_tr_b16 v[82:83], v6 offset:20992
    s_waitcnt lgkmcnt(6)
    v_mfma_f32_16x16x32_bf16 v[104:107], v[68:71], v[40:43], v[104:107]
    ds_read_b64_tr_b16 v[64:65], v6 offset:28672
    v_mfma_f32_16x16x32_bf16 v[108:111], v[68:71], v[44:47], v[108:111]
    v_add_u32 v14, s80, v16
    v_mfma_f32_16x16x32_bf16 v[112:115], v[68:71], v[48:51], v[112:115]
    ds_read_b64_tr_b16 v[66:67], v6 offset:29184
    v_mfma_f32_16x16x32_bf16 v[116:119], v[68:71], v[52:55], v[116:119]
    v_add_u32 v15, s80, v17
    s_waitcnt lgkmcnt(6)
    v_mfma_f32_16x16x32_bf16 v[120:123], v[72:75], v[40:43], v[120:123]
    ds_read_b64_tr_b16 v[68:69], v7 offset:20480
    v_mfma_f32_16x16x32_bf16 v[124:127], v[72:75], v[44:47], v[124:127]
    s_add_u32 s80, s80, 18432
    v_mfma_f32_16x16x32_bf16 v[128:131], v[72:75], v[48:51], v[128:131]
    ds_read_b64_tr_b16 v[70:71], v7 offset:20992
    v_mfma_f32_16x16x32_bf16 v[132:135], v[72:75], v[52:55], v[132:135]
    s_cmp_ge_u32 s80, 153600
    s_cselect_b32 s84, 55296, 0
    s_waitcnt lgkmcnt(6)
    v_mfma_f32_16x16x32_bf16 v[136:139], v[76:79], v[40:43], v[136:139]
    ds_read_b64_tr_b16 v[72:73], v7 offset:28672
    v_mfma_f32_16x16x32_bf16 v[140:143], v[76:79], v[44:47], v[140:143]
    s_sub_u32 s80, s80, s84
    v_mfma_f32_16x16x32_bf16 v[144:147], v[76:79], v[48:51], v[144:147]
    ds_read_b64_tr_b16 v[74:75], v7 offset:29184
    v_mfma_f32_16x16x32_bf16 v[148:151], v[76:79], v[52:55], v[148:151]
    s_waitcnt lgkmcnt(6)
    v_mfma_f32_16x16x32_bf16 v[152:155], v[80:83], v[40:43], v[152:155]
    ds_read_b64_tr_b16 v[76:77], v8 offset:36864
    v_mfma_f32_16x16x32_bf16 v[156:159], v[80:83], v[44:47], v[156:159]
    v_mfma_f32_16x16x32_bf16 v[160:163], v[80:83], v[48:51], v[160:163]
    ds_read_b64_tr_b16 v[78:79], v8 offset:37120
    v_mfma_f32_16x16x32_bf16 v[164:167], v[80:83], v[52:55], v[164:167]
    s_waitcnt lgkmcnt(6)
    v_mfma_f32_16x16x32_bf16 v[168:171], v[64:67], v[40:43], v[168:171]
    ds_read_b64_tr_b16 v[80:81], v8 offset:38912
    v_mfma_f32_16x16x32_bf16 v[172:175], v[64:67], v[44:47], v[172:175]
    v_mfma_f32_16x16x32_bf16 v[176:179], v[64:67], v[48:51], v[176:179]
    ds_read_b64_tr_b16 v[82:83], v8 offset:39168
    v_mfma_f32_16x16x32_bf16 v[180:183], v[64:67], v[52:55], v[180:183]
    s_waitcnt lgkmcnt(6)
    v_mfma_f32_16x16x32_bf16 v[184:187], v[68:71], v[40:43], v[184:187]
    v_mfma_f32_16x16x32_bf16 v[188:191], v[68:71], v[44:47], v[188:191]
    v_mfma_f32_16x16x32_bf16 v[192:195], v[68:71], v[48:51], v[192:195]
    v_mfma_f32_16x16x32_bf16 v[196:199], v[68:71], v[52:55], v[196:199]
    s_waitcnt lgkmcnt(0)
    s_barrier
    v_mfma_f32_16x16x32_bf16 v[200:203], v[72:75], v[40:43], v[200:203]
    ds_read_b64_tr_b16 v[64:65], v9 offset:0
    v_mfma_f32_16x16x32_bf16 v[204:207], v[72:75], v[44:47], v[204:207]
    ds_read_b64_tr_b16 v[66:67], v9 offset:512
    v_mfma_f32_16x16x32_bf16 v[208:211], v[72:75], v[48:51], v[208:211]
    ds_read_b128 v[24:27], v14 offset:0
    v_mfma_f32_16x16x32_bf16 v[212:215], v[72:75], v[52:55], v[212:215]
    ds_read_b128 v[28:31], v14 offset:2048
    v_mfma_f32_16x16x32_bf16 v[216:219], v[76:79], v[40:43], v[216:219]
    ds_read_b128 v[32:35], v14 offset:4096
    v_mfma_f32_16x16x32_bf16 v[220:223], v[76:79], v[44:47], v[220:223]
    ds_read_b128 v[36:39], v14 offset:6144
    v_mfma_f32_16x16x32_bf16 v[224:227], v[76:79], v[48:51], v[224:227]
    ds_read_b64_tr_b16 v[68:69], v9 offset:8192
    v_mfma_f32_16x16x32_bf16 v[228:231], v[76:79], v[52:55], v[228:231]
    ds_read_b64_tr_b16 v[70:71], v9 offset:8704
    v_mfma_f32_16x16x32_bf16 v[232:235], v[80:83], v[40:43], v[232:235]
    ds_read_b64_tr_b16 v[72:73], v10 offset:0
    v_mfma_f32_16x16x32_bf16 v[236:239], v[80:83], v[44:47], v[236:239]
    v_mfma_f32_16x16x32_bf16 v[240:243], v[80:83], v[48:51], v[240:243]
    ds_read_b64_tr_b16 v[74:75], v10 offset:512
    v_mfma_f32_16x16x32_bf16 v[244:247], v[80:83], v[52:55], v[244:247]
    s_waitcnt lgkmcnt(7)
    v_mfma_f32_16x16x32_bf16 v[88:91], v[64:67], v[24:27], v[88:91]
    ds_read_b64_tr_b16 v[76:77], v10 offset:8192
    s_waitcnt lgkmcnt(7)
    v_mfma_f32_16x16x32_bf16 v[92:95], v[64:67], v[28:31], v[92:95]
    ds_read_b64_tr_b16 v[78:79], v10 offset:8704
    s_waitcnt lgkmcnt(7)
    v_mfma_f32_16x16x32_bf16 v[96:99], v[64:67], v[32:35], v[96:99]
    ds_read_b64_tr_b16 v[80:81], v11 offset:0
    s_waitcnt lgkmcnt(7)
    v_mfma_f32_16x16x32_bf16 v[100:103], v[64:67], v[36:39], v[100:103]
    ds_read_b64_tr_b16 v[82:83], v11 offset:512
    s_waitcnt lgkmcnt(6)
    v_mfma_f32_16x16x32_bf16 v[104:107], v[68:71], v[24:27], v[104:107]
    ds_read_b64_tr_b16 v[64:65], v11 offset:8192
    v_mfma_f32_16x16x32_bf16 v[108:111], v[68:71], v[28:31], v[108:111]
    v_mfma_f32_16x16x32_bf16 v[112:115], v[68:71], v[32:35], v[112:115]
    ds_read_b64_tr_b16 v[66:67], v11 offset:8704
    v_mfma_f32_16x16x32_bf16 v[116:119], v[68:71], v[36:39], v[116:119]
    s_waitcnt lgkmcnt(6)
    v_mfma_f32_16x16x32_bf16 v[120:123], v[72:75], v[24:27], v[120:123]
    ds_read_b64_tr_b16 v[68:69], v12 offset:0
    v_mfma_f32_16x16x32_bf16 v[124:127], v[72:75], v[28:31], v[124:127]
    v_mfma_f32_16x16x32_bf16 v[128:131], v[72:75], v[32:35], v[128:131]
    ds_read_b64_tr_b16 v[70:71], v12 offset:512
    v_mfma_f32_16x16x32_bf16 v[132:135], v[72:75], v[36:39], v[132:135]
    s_waitcnt lgkmcnt(6)
    v_mfma_f32_16x16x32_bf16 v[136:139], v[76:79], v[24:27], v[136:139]
    ds_read_b64_tr_b16 v[72:73], v12 offset:8192
    v_mfma_f32_16x16x32_bf16 v[140:143], v[76:79], v[28:31], v[140:143]
    v_mfma_f32_16x16x32_bf16 v[144:147], v[76:79], v[32:35], v[144:147]
    ds_read_b64_tr_b16 v[74:75], v12 offset:8704
    v_mfma_f32_16x16x32_bf16 v[148:151], v[76:79], v[36:39], v[148:151]
    s_waitcnt lgkmcnt(6)
    v_mfma_f32_16x16x32_bf16 v[152:155], v[80:83], v[24:27], v[152:155]
    ds_read_b64_tr_b16 v[76:77], v13 offset:16384
    v_mfma_f32_16x16x32_bf16 v[156:159], v[80:83], v[28:31], v[156:159]
    v_mfma_f32_16x16x32_bf16 v[160:163], v[80:83], v[32:35], v[160:163]
    ds_read_b64_tr_b16 v[78:79], v13 offset:16640
    v_mfma_f32_16x16x32_bf16 v[164:167], v[80:83], v[36:39], v[164:167]
    s_waitcnt lgkmcnt(6)
    v_mfma_f32_16x16x32_bf16 v[168:171], v[64:67], v[24:27], v[168:171]
    ds_read_b64_tr_b16 v[80:81], v13 offset:18432
    v_mfma_f32_16x16x32_bf16 v[172:175], v[64:67], v[28:31], v[172:175]
    v_mfma_f32_16x16x32_bf16 v[176:179], v[64:67], v[32:35], v[176:179]
    ds_read_b64_tr_b16 v[82:83], v13 offset:18688
    v_mfma_f32_16x16x32_bf16 v[180:183], v[64:67], v[36:39], v[180:183]
    s_waitcnt lgkmcnt(6)
    v_mfma_f32_16x16x32_bf16 v[184:187], v[68:71], v[24:27], v[184:187]
    v_mfma_f32_16x16x32_bf16 v[188:191], v[68:71], v[28:31], v[188:191]
    v_mfma_f32_16x16x32_bf16 v[192:195], v[68:71], v[32:35], v[192:195]
    v_mfma_f32_16x16x32_bf16 v[196:199], v[68:71], v[36:39], v[196:199]
    s_waitcnt lgkmcnt(0)
    s_barrier
    v_mfma_f32_16x16x32_bf16 v[200:203], v[72:75], v[24:27], v[200:203]
    ds_read_b64_tr_b16 v[64:65], v9 offset:20480
    v_mfma_f32_16x16x32_bf16 v[204:207], v[72:75], v[28:31], v[204:207]
    ds_read_b64_tr_b16 v[66:67], v9 offset:20992
    v_mfma_f32_16x16x32_bf16 v[208:211], v[72:75], v[32:35], v[208:211]
    ds_read_b128 v[40:43], v15 offset:0
    v_mfma_f32_16x16x32_bf16 v[212:215], v[72:75], v[36:39], v[212:215]
    ds_read_b128 v[44:47], v15 offset:2048
    v_mfma_f32_16x16x32_bf16 v[216:219], v[76:79], v[24:27], v[216:219]
    ds_read_b128 v[48:51], v15 offset:4096
    v_mfma_f32_16x16x32_bf16 v[220:223], v[76:79], v[28:31], v[220:223]
    ds_read_b128 v[52:55], v15 offset:6144
    v_mfma_f32_16x16x32_bf16 v[224:227], v[76:79], v[32:35], v[224:227]
    ds_read_b64_tr_b16 v[68:69], v9 offset:28672
    v_mfma_f32_16x16x32_bf16 v[228:231], v[76:79], v[36:39], v[228:231]
    ds_read_b64_tr_b16 v[70:71], v9 offset:29184
    v_mfma_f32_16x16x32_bf16 v[232:235], v[80:83], v[24:27], v[232:235]
    ds_read_b64_tr_b16 v[72:73], v10 offset:20480
    v_mfma_f32_16x16x32_bf16 v[236:239], v[80:83], v[28:31], v[236:239]
    v_mfma_f32_16x16x32_bf16 v[240:243], v[80:83], v[32:35], v[240:243]
    ds_read_b64_tr_b16 v[74:75], v10 offset:20992
    v_mfma_f32_16x16x32_bf16 v[244:247], v[80:83], v[36:39], v[244:247]
    s_waitcnt lgkmcnt(7)
    v_mfma_f32_16x16x32_bf16 v[88:91], v[64:67], v[40:43], v[88:91]
    ds_read_b64_tr_b16 v[76:77], v10 offset:28672
    s_waitcnt lgkmcnt(7)
    v_mfma_f32_16x16x32_bf16 v[92:95], v[64:67], v[44:47], v[92:95]
    ds_read_b64_tr_b16 v[78:79], v10 offset:29184
    s_waitcnt lgkmcnt(7)
    v_mfma_f32_16x16x32_bf16 v[96:99], v[64:67], v[48:51], v[96:99]
    ds_read_b64_tr_b16 v[80:81], v11 offset:20480
    s_waitcnt lgkmcnt(7)
    v_mfma_f32_16x16x32_bf16 v[100:103], v[64:67], v[52:55], v[100:103]
    ds_read_b64_tr_b16 v[82:83], v11 offset:20992
    s_waitcnt lgkmcnt(6)
    v_mfma_f32_16x16x32_bf16 v[104:107], v[68:71], v[40:43], v[104:107]
    ds_read_b64_tr_b16 v[64:65], v11 offset:28672
    v_mfma_f32_16x16x32_bf16 v[108:111], v[68:71], v[44:47], v[108:111]
    v_mfma_f32_16x16x32_bf16 v[112:115], v[68:71], v[48:51], v[112:115]
    ds_read_b64_tr_b16 v[66:67], v11 offset:29184
    v_mfma_f32_16x16x32_bf16 v[116:119], v[68:71], v[52:55], v[116:119]
    s_waitcnt lgkmcnt(6)
    v_mfma_f32_16x16x32_bf16 v[120:123], v[72:75], v[40:43], v[120:123]
    ds_read_b64_tr_b16 v[68:69], v12 offset:20480
    v_mfma_f32_16x16x32_bf16 v[124:127], v[72:75], v[44:47], v[124:127]
    v_mfma_f32_16x16x32_bf16 v[128:131], v[72:75], v[48:51], v[128:131]
    ds_read_b64_tr_b16 v[70:71], v12 offset:20992
    v_mfma_f32_16x16x32_bf16 v[132:135], v[72:75], v[52:55], v[132:135]
    s_waitcnt lgkmcnt(6)
    v_mfma_f32_16x16x32_bf16 v[136:139], v[76:79], v[40:43], v[136:139]
    ds_read_b64_tr_b16 v[72:73], v12 offset:28672
    v_mfma_f32_16x16x32_bf16 v[140:143], v[76:79], v[44:47], v[140:143]
    v_mfma_f32_16x16x32_bf16 v[144:147], v[76:79], v[48:51], v[144:147]
    ds_read_b64_tr_b16 v[74:75], v12 offset:29184
    v_mfma_f32_16x16x32_bf16 v[148:151], v[76:79], v[52:55], v[148:151]
    s_waitcnt lgkmcnt(6)
    v_mfma_f32_16x16x32_bf16 v[152:155], v[80:83], v[40:43], v[152:155]
    ds_read_b64_tr_b16 v[76:77], v13 offset:36864
    v_mfma_f32_16x16x32_bf16 v[156:159], v[80:83], v[44:47], v[156:159]
    v_mfma_f32_16x16x32_bf16 v[160:163], v[80:83], v[48:51], v[160:163]
    ds_read_b64_tr_b16 v[78:79], v13 offset:37120
    v_mfma_f32_16x16x32_bf16 v[164:167], v[80:83], v[52:55], v[164:167]
    s_waitcnt lgkmcnt(6)
    v_mfma_f32_16x16x32_bf16 v[168:171], v[64:67], v[40:43], v[168:171]
    ds_read_b64_tr_b16 v[80:81], v13 offset:38912
    v_mfma_f32_16x16x32_bf16 v[172:175], v[64:67], v[44:47], v[172:175]
    v_mfma_f32_16x16x32_bf16 v[176:179], v[64:67], v[48:51], v[176:179]
    ds_read_b64_tr_b16 v[82:83], v13 offset:39168
    v_mfma_f32_16x16x32_bf16 v[180:183], v[64:67], v[52:55], v[180:183]
    s_waitcnt lgkmcnt(6)
    v_mfma_f32_16x16x32_bf16 v[184:187], v[68:71], v[40:43], v[184:187]
    v_mfma_f32_16x16x32_bf16 v[188:191], v[68:71], v[44:47], v[188:191]
    v_mfma_f32_16x16x32_bf16 v[192:195], v[68:71], v[48:51], v[192:195]
    v_mfma_f32_16x16x32_bf16 v[196:199], v[68:71], v[52:55], v[196:199]
    s_waitcnt lgkmcnt(0)
    s_barrier
    v_mfma_f32_16x16x32_bf16 v[200:203], v[72:75], v[40:43], v[200:203]
    v_mfma_f32_16x16x32_bf16 v[204:207], v[72:75], v[44:47], v[204:207]
    v_mfma_f32_16x16x32_bf16 v[208:211], v[72:75], v[48:51], v[208:211]
    v_mfma_f32_16x16x32_bf16 v[212:215], v[72:75], v[52:55], v[212:215]
    v_mfma_f32_16x16x32_bf16 v[216:219], v[76:79], v[40:43], v[216:219]
    v_mfma_f32_16x16x32_bf16 v[220:223], v[76:79], v[44:47], v[220:223]
    v_mfma_f32_16x16x32_bf16 v[224:227], v[76:79], v[48:51], v[224:227]
    v_mfma_f32_16x16x32_bf16 v[228:231], v[76:79], v[52:55], v[228:231]
    v_mfma_f32_16x16x32_bf16 v[232:235], v[80:83], v[40:43], v[232:235]
    v_mfma_f32_16x16x32_bf16 v[236:239], v[80:83], v[44:47], v[236:239]
    v_mfma_f32_16x16x32_bf16 v[240:243], v[80:83], v[48:51], v[240:243]
    v_mfma_f32_16x16x32_bf16 v[244:247], v[80:83], v[52:55], v[244:247]
    s_setprio 0
    s_lshl_b32 s84, s5, 10
    s_add_u32 s84, s84, 161024
    v_and_b32 v16, 15, v1
    v_lshl_add_u32 v16, v16, 4, s84
    ds_read_b128 v[64:67], v16 offset:0
    ds_read_b128 v[68:71], v16 offset:256
    ds_read_b128 v[72:75], v16 offset:512
    ds_read_b128 v[76:79], v16 offset:768
    v_and_b32 v17, 48, v1
    s_lshl_b32 s84, s6, 8
    s_add_u32 s84, s84, 159744
    v_add_u32 v16, s84, v17
    s_lshl_b32 s84, s6, 6
    s_add_u32 s84, s84, 159744
    v_add_u32 v17, s84, v17
    ds_read_b128 v[24:27], v16 offset:0
    ds_read_b128 v[28:31], v16 offset:640
    ds_read_b128 v[32:35], v16 offset:64
    ds_read_b128 v[36:39], v16 offset:704
    ds_read_b128 v[40:43], v16 offset:128
    ds_read_b128 v[44:47], v16 offset:768
    ds_read_b128 v[48:51], v16 offset:192
    ds_read_b128 v[52:55], v16 offset:832
    ds_read_b128 v[56:59], v17 offset:512
    ds_read_b128 v[60:63], v17 offset:1152
    s_memrealtime s[92:93]
    s_memtime s[90:91]
    s_add_u32 m0, s79, 116736
    s_mov_b32 s78, 256
    buffer_load_dwordx4 v20, s[36:39], s78 offen sc1 lds
    s_waitcnt lgkmcnt(0)
    s_mov_b32 s34, s92
    s_mov_b32 s35, s90
    v_fmac_f32 v88, v24, v64
    v_fmac_f32 v89, v25, v64
    v_fmac_f32 v90, v26, v64
    v_fmac_f32 v91, v27, v64
    v_fmac_f32 v104, v28, v64
    v_fmac_f32 v105, v29, v64
    v_fmac_f32 v106, v30, v64
    v_fmac_f32 v107, v31, v64
    s_add_u32 m0, s79, 117760
    s_nop 0
    buffer_load_dwordx4 v21, s[36:39], s78 offen sc1 lds
    s_add_u32 m0, s33, 77824
    s_mov_b32 s76, 589824
    buffer_load_dwordx4 v23, s[40:43], s76 offen offset:0 lds
    s_add_u32 m0, s33, 79872
    s_nop 0
    buffer_load_dwordx4 v23, s[40:43], s76 offen offset:2048 lds
    s_add_u32 m0, s33, 86016
    s_nop 0
    buffer_load_dwordx4 v23, s[44:47], s76 offen offset:0 lds
    v_mul_f32 v80, v88, v88
    v_mul_f32 v81, v89, v89
    v_mul_f32 v82, v90, v90
    v_mul_f32 v83, v91, v91
    v_fma_f32 v80, v80, v66, v65
    v_fma_f32 v81, v81, v66, v65
    v_fma_f32 v82, v82, v66, v65
    v_fma_f32 v83, v83, v66, v65
    s_add_u32 m0, s33, 90112
    s_mov_b32 s77, 688128
    buffer_load_dwordx4 v22, s[48:51], s77 offen offset:0 lds
    s_add_u32 m0, s33, 94208
    s_nop 0
    buffer_load_dwordx4 v22, s[52:55], s77 offen offset:0 lds
    s_barrier
    s_add_u32 m0, s79, 118784
    s_mov_b32 s78, 33024
    buffer_load_dwordx4 v20, s[36:39], s78 offen sc1 lds
    v_mul_f32 v80, v80, v88
    v_mul_f32 v81, v81, v89
    v_mul_f32 v82, v82, v90
    v_mul_f32 v83, v83, v91
    v_exp_f32 v80, v80
    v_mul_f32 v88, v88, v104
    v_exp_f32 v81, v81
    s_add_u32 m0, s79, 119808
    s_nop 0
    buffer_load_dwordx4 v21, s[36:39], s78 offen sc1 lds
    v_mul_f32 v89, v89, v105
    v_exp_f32 v82, v82
    v_mul_f32 v90, v90, v106
    v_exp_f32 v83, v83
    v_mul_f32 v91, v91, v107
    v_fma_f32 v80, v80, v67, v67
    s_add_u32 m0, s81, 133120
    s_mov_b32 s78, 256
    s_mov_b64 exec, 0xffffffff
    buffer_load_dwordx4 v3, s[36:39], s78 offen sc1 lds
    s_mov_b64 exec, -1
    v_fma_f32 v81, v81, v67, v67
    v_fma_f32 v82, v82, v67, v67
    v_fma_f32 v83, v83, v67, v67
    v_rcp_f32 v80, v80
    v_rcp_f32 v81, v81
    v_rcp_f32 v82, v82
    s_add_u32 m0, s33, 16384
    s_mov_b32 s76, 786432
    buffer_load_dwordx4 v23, s[40:43], s76 offen offset:0 lds
    s_add_u32 m0, s33, 18432
    s_nop 0
    buffer_load_dwordx4 v23, s[40:43], s76 offen offset:2048 lds
    v_rcp_f32 v83, v83
    s_nop 0
    v_mul_f32 v88, v88, v80
    v_mul_f32 v89, v89, v81
    v_mul_f32 v90, v90, v82
    v_mul_f32 v91, v91, v83
    v_cvt_pk_bf16_f32 v88, v88, v89
    v_cvt_pk_bf16_f32 v89, v90, v91
    s_add_u32 m0, s33, 24576
    s_nop 0
    buffer_load_dwordx4 v23, s[44:47], s76 offen offset:0 lds
    v_fmac_f32 v92, v24, v68
    v_fmac_f32 v93, v25, v68
    v_fmac_f32 v94, v26, v68
    v_fmac_f32 v95, v27, v68
    v_fmac_f32 v108, v28, v68
    v_fmac_f32 v109, v29, v68
    v_fmac_f32 v110, v30, v68
    v_fmac_f32 v111, v31, v68
    s_add_u32 m0, s33, 28672
    s_mov_b32 s77, 917504
    buffer_load_dwordx4 v22, s[48:51], s77 offen offset:0 lds
    v_mul_f32 v80, v92, v92
    v_mul_f32 v81, v93, v93
    v_mul_f32 v82, v94, v94
    v_mul_f32 v83, v95, v95
    v_fma_f32 v80, v80, v70, v69
    v_fma_f32 v81, v81, v70, v69
    v_fma_f32 v82, v82, v70, v69
    v_fma_f32 v83, v83, v70, v69
    s_add_u32 m0, s33, 32768
    s_nop 0
    buffer_load_dwordx4 v22, s[52:55], s77 offen offset:0 lds
    s_add_u32 s75, s75, 0x300000
    s_load_dword s94, s[10:11], s75 offset:0x0
    s_load_dword s94, s[10:11], s75 offset:0x40
    s_load_dword s94, s[10:11], s75 offset:0x80
    s_load_dword s94, s[10:11], s75 offset:0xc0
    s_load_dword s94, s[10:11], s75 offset:0x100
    v_mov_b32 v5, 0
    s_mov_b64 exec, 1
    global_load_dwordx2 v[6:7], v5, s[24:25] sc1
    s_mov_b64 exec, -1
    s_barrier
    s_add_u32 m0, s79, 135168
    s_mov_b32 s78, 384
    buffer_load_dwordx4 v20, s[36:39], s78 offen sc1 lds
    v_mul_f32 v80, v80, v92
    v_mul_f32 v81, v81, v93
    v_mul_f32 v82, v82, v94
    v_mul_f32 v83, v83, v95
    v_exp_f32 v80, v80
    v_mul_f32 v92, v92, v108
    v_exp_f32 v81, v81
    s_add_u32 m0, s79, 136192
    s_nop 0
    buffer_load_dwordx4 v21, s[36:39], s78 offen sc1 lds
    v_mul_f32 v93, v93, v109
    v_exp_f32 v82, v82
    v_mul_f32 v94, v94, v110
    v_exp_f32 v83, v83
    v_mul_f32 v95, v95, v111
    v_fma_f32 v80, v80, v71, v71
    s_add_u32 m0, s33, 36864
    s_mov_b32 s76, 983040
    buffer_load_dwordx4 v23, s[40:43], s76 offen offset:0 lds
    v_fma_f32 v81, v81, v71, v71
    v_fma_f32 v82, v82, v71, v71
    v_fma_f32 v83, v83, v71, v71
    v_rcp_f32 v80, v80
    v_rcp_f32 v81, v81
    v_rcp_f32 v82, v82
    s_add_u32 m0, s33, 38912
    s_nop 0
    buffer_load_dwordx4 v23, s[40:43], s76 offen offset:2048 lds
    v_rcp_f32 v83, v83
    s_nop 0
    v_mul_f32 v92, v92, v80
    v_mul_f32 v93, v93, v81
    v_mul_f32 v94, v94, v82
    v_mul_f32 v95, v95, v83
    v_cvt_pk_bf16_f32 v90, v92, v93
    v_cvt_pk_bf16_f32 v91, v94, v95
    s_add_u32 m0, s33, 45056
    s_nop 0
    buffer_load_dwordx4 v23, s[44:47], s76 offen offset:0 lds
    s_nop 1
    v_permlane16_swap_b32 v88, v90
    v_permlane16_swap_b32 v89, v91
    s_add_u32 m0, s33, 49152
    s_mov_b32 s77, 1146880
    buffer_load_dwordx4 v22, s[48:51], s77 offen offset:0 lds
    v_fmac_f32 v96, v24, v72
    v_fmac_f32 v97, v25, v72
    v_fmac_f32 v98, v26, v72
    v_fmac_f32 v99, v27, v72
    v_fmac_f32 v112, v28, v72
    v_fmac_f32 v113, v29, v72
    v_fmac_f32 v114, v30, v72
    v_fmac_f32 v115, v31, v72
    s_add_u32 m0, s33, 53248
    s_nop 0
    buffer_load_dwordx4 v22, s[52:55], s77 offen offset:0 lds
    v_mul_f32 v80, v96, v96
    v_mul_f32 v81, v97, v97
    v_mul_f32 v82, v98, v98
    v_mul_f32 v83, v99, v99
    v_fma_f32 v80, v80, v74, v73
    v_fma_f32 v81, v81, v74, v73
    v_fma_f32 v82, v82, v74, v73
    v_fma_f32 v83, v83, v74, v73
    buffer_store_dwordx4 v[88:91], v19, s[68:71], s72 offen offset:0 sc1
    s_load_dword s94, s[10:11], s75 offset:0x140
    s_load_dword s94, s[10:11], s75 offset:0x180
    s_load_dword s94, s[10:11], s75 offset:0x1c0
    s_add_u32 s99, s99, 0x380000
    s_load_dword s94, s[16:17], s99 offset:0x0
    s_load_dword s94, s[16:17], s99 offset:0x40
    s_waitcnt vmcnt(17)
    s_barrier
    s_add_u32 m0, s79, 137216
    s_mov_b32 s78, 33152
    buffer_load_dwordx4 v20, s[36:39], s78 offen sc1 lds
    v_mul_f32 v80, v80, v96
    v_mul_f32 v81, v81, v97
    v_mul_f32 v82, v82, v98
    v_mul_f32 v83, v83, v99
    v_exp_f32 v80, v80
    v_mul_f32 v96, v96, v112
    v_exp_f32 v81, v81
    s_add_u32 m0, s79, 138240
    s_nop 0
    buffer_load_dwordx4 v21, s[36:39], s78 offen sc1 lds
    v_mul_f32 v97, v97, v113
    v_exp_f32 v82, v82
    v_mul_f32 v98, v98, v114
    v_exp_f32 v83, v83
    v_mul_f32 v99, v99, v115
    v_fma_f32 v80, v80, v75, v75
    s_add_u32 m0, s81, 151552
    s_mov_b32 s78, 384
    s_mov_b64 exec, 0xffffffff
    buffer_load_dwordx4 v3, s[36:39], s78 offen sc1 lds
    s_mov_b64 exec, -1
    v_fma_f32 v81, v81, v75, v75
    v_fma_f32 v82, v82, v75, v75
    v_fma_f32 v83, v83, v75, v75
    v_rcp_f32 v80, v80
    v_rcp_f32 v81, v81
    v_rcp_f32 v82, v82
    s_add_u32 m0, s33, 57344
    s_mov_b32 s76, 1179648
    buffer_load_dwordx4 v23, s[40:43], s76 offen offset:0 lds
    s_add_u32 m0, s33, 59392
    s_nop 0
    buffer_load_dwordx4 v23, s[40:43], s76 offen offset:2048 lds
    v_rcp_f32 v83, v83
    s_nop 0
    v_mul_f32 v96, v96, v80
    v_mul_f32 v97, v97, v81
    v_mul_f32 v98, v98, v82
    v_mul_f32 v99, v99, v83
    v_cvt_pk_bf16_f32 v96, v96, v97
    v_cvt_pk_bf16_f32 v97, v98, v99
    s_add_u32 m0, s33, 65536
    s_nop 0
    buffer_load_dwordx4 v23, s[44:47], s76 offen offset:0 lds
    v_fmac_f32 v100, v24, v76
    v_fmac_f32 v101, v25, v76
    v_fmac_f32 v102, v26, v76
    v_fmac_f32 v103, v27, v76
    v_fmac_f32 v116, v28, v76
    v_fmac_f32 v117, v29, v76
    v_fmac_f32 v118, v30, v76
    v_fmac_f32 v119, v31, v76
    s_add_u32 m0, s33, 69632
    s_mov_b32 s77, 1376256
    buffer_load_dwordx4 v22, s[48:51], s77 offen offset:0 lds
    v_mul_f32 v80, v100, v100
    v_mul_f32 v81, v101, v101
    v_mul_f32 v82, v102, v102
    v_mul_f32 v83, v103, v103
    v_fma_f32 v80, v80, v78, v77
    v_fma_f32 v81, v81, v78, v77
    v_fma_f32 v82, v82, v78, v77
    v_fma_f32 v83, v83, v78, v77
    s_add_u32 m0, s33, 73728
    s_nop 0
    buffer_load_dwordx4 v22, s[52:55], s77 offen offset:0 lds
    s_load_dword s94, s[16:17], s99 offset:0x80
    s_load_dword s94, s[16:17], s99 offset:0xc0
    s_load_dword s94, s[16:17], s99 offset:0x100
    s_load_dword s94, s[16:17], s99 offset:0x140
    s_load_dword s94, s[16:17], s99 offset:0x180
    s_waitcnt vmcnt(17)
    s_barrier
    s_add_u32 m0, s79, 98304
    s_mov_b32 s78, 512
    buffer_load_dwordx4 v20, s[36:39], s78 offen sc1 lds
    v_mul_f32 v80, v80, v100
    v_mul_f32 v81, v81, v101
    v_mul_f32 v82, v82, v102
    v_mul_f32 v83, v83, v103
    v_exp_f32 v80, v80
    v_mul_f32 v100, v100, v116
    v_exp_f32 v81, v81
    s_add_u32 m0, s79, 99328
    s_nop 0
    buffer_load_dwordx4 v21, s[36:39], s78 offen sc1 lds
    v_mul_f32 v101, v101, v117
    v_exp_f32 v82, v82
    v_mul_f32 v102, v102, v118
    v_exp_f32 v83, v83
    v_mul_f32 v103, v103, v119
    v_fma_f32 v80, v80, v79, v79
    s_add_u32 m0, s33, 77824
    s_mov_b32 s76, 1376256
    buffer_load_dwordx4 v23, s[40:43], s76 offen offset:0 lds
    v_fma_f32 v81, v81, v79, v79
    v_fma_f32 v82, v82, v79, v79
    v_fma_f32 v83, v83, v79, v79
    v_rcp_f32 v80, v80
    v_rcp_f32 v81, v81
    v_rcp_f32 v82, v82
    s_add_u32 m0, s33, 79872
    s_nop 0
    buffer_load_dwordx4 v23, s[40:43], s76 offen offset:2048 lds
    v_rcp_f32 v83, v83
    s_nop 0
    v_mul_f32 v100, v100, v80
    v_mul_f32 v101, v101, v81
    v_mul_f32 v102, v102, v82
    v_mul_f32 v103, v103, v83
    v_cvt_pk_bf16_f32 v98, v100, v101
    v_cvt_pk_bf16_f32 v99, v102, v103
    s_add_u32 m0, s33, 86016
    s_nop 0
    buffer_load_dwordx4 v23, s[44:47], s76 offen offset:0 lds
    s_nop 1
    v_permlane16_swap_b32 v96, v98
    v_permlane16_swap_b32 v97, v99
    s_add_u32 m0, s33, 90112
    s_mov_b32 s77, 1605632
    buffer_load_dwordx4 v22, s[48:51], s77 offen offset:0 lds
    v_fmac_f32 v120, v32, v64
    v_fmac_f32 v121, v33, v64
    v_fmac_f32 v122, v34, v64
    v_fmac_f32 v123, v35, v64
    v_fmac_f32 v136, v36, v64
    v_fmac_f32 v137, v37, v64
    v_fmac_f32 v138, v38, v64
    v_fmac_f32 v139, v39, v64
    s_add_u32 m0, s33, 94208
    s_nop 0
    buffer_load_dwordx4 v22, s[52:55], s77 offen offset:0 lds
    v_mul_f32 v80, v120, v120
    v_mul_f32 v81, v121, v121
    v_mul_f32 v82, v122, v122
    v_mul_f32 v83, v123, v123
    v_fma_f32 v80, v80, v66, v65
    v_fma_f32 v81, v81, v66, v65
    v_fma_f32 v82, v82, v66, v65
    v_fma_f32 v83, v83, v66, v65
    buffer_store_dwordx4 v[96:99], v19, s[68:71], s72 offen offset:2048 sc1
    s_load_dword s94, s[16:17], s99 offset:0x1c0
    s_load_dword s94, s[18:19], s99 offset:0x0
    s_load_dword s94, s[18:19], s99 offset:0x40
    s_load_dword s94, s[18:19], s99 offset:0x80
    s_load_dword s94, s[18:19], s99 offset:0xc0
    s_waitcnt vmcnt(17)
    s_barrier
    s_add_u32 m0, s79, 100352
    s_mov_b32 s78, 33280
    buffer_load_dwordx4 v20, s[36:39], s78 offen sc1 lds
    v_mul_f32 v80, v80, v120
    v_mul_f32 v81, v81, v121
    v_mul_f32 v82, v82, v122
    v_mul_f32 v83, v83, v123
    v_exp_f32 v80, v80
    v_mul_f32 v120, v120, v136
    v_exp_f32 v81, v81
    s_add_u32 m0, s79, 101376
    s_nop 0
    buffer_load_dwordx4 v21, s[36:39], s78 offen sc1 lds
    v_mul_f32 v121, v121, v137
    v_exp_f32 v82, v82
    v_mul_f32 v122, v122, v138
    v_exp_f32 v83, v83
    v_mul_f32 v123, v123, v139
L_pad1:
    s_cbranch_execz L_vret1
    v_fma_f32 v80, v80, v67, v67
    s_add_u32 m0, s81, 114688
    s_mov_b32 s78, 512
    s_mov_b64 exec, 0xffffffff
    buffer_load_dwordx4 v3, s[36:39], s78 offen sc1 lds
    s_mov_b64 exec, -1
    v_fma_f32 v81, v81, v67, v67
    v_fma_f32 v82, v82, v67, v67
    v_fma_f32 v83, v83, v67, v67
    v_rcp_f32 v80, v80
    v_rcp_f32 v81, v81
    v_rcp_f32 v82, v82
    s_add_u32 m0, s33, 16384
    s_mov_b32 s76, 1572864
    buffer_load_dwordx4 v23, s[40:43], s76 offen offset:0 lds
    s_add_u32 m0, s33, 18432
    s_nop 0
    buffer_load_dwordx4 v23, s[40:43], s76 offen offset:2048 lds
    v_rcp_f32 v83, v83
    s_nop 0
    v_mul_f32 v120, v120, v80
    v_mul_f32 v121, v121, v81
    v_mul_f32 v122, v122, v82
    v_mul_f32 v123, v123, v83
    v_cvt_pk_bf16_f32 v120, v120, v121
    v_cvt_pk_bf16_f32 v121, v122, v123
    s_add_u32 m0, s33, 24576
    s_nop 0
    buffer_load_dwordx4 v23, s[44:47], s76 offen offset:0 lds
    v_fmac_f32 v124, v32, v68
    v_fmac_f32 v125, v33, v68
    v_fmac_f32 v126, v34, v68
    v_fmac_f32 v127, v35, v68
    v_fmac_f32 v140, v36, v68
    v_fmac_f32 v141, v37, v68
    v_fmac_f32 v142, v38, v68
    v_fmac_f32 v143, v39, v68
    s_add_u32 m0, s33, 28672
    s_mov_b32 s77, 1835008
    buffer_load_dwordx4 v22, s[48:51], s77 offen offset:0 lds
    v_mul_f32 v80, v124, v124
    v_mul_f32 v81, v125, v125
    v_mul_f32 v82, v126, v126
    v_mul_f32 v83, v127, v127
    v_fma_f32 v80, v80, v70, v69
    v_fma_f32 v81, v81, v70, v69
    v_fma_f32 v82, v82, v70, v69
    v_fma_f32 v83, v83, v70, v69
    s_add_u32 m0, s33, 32768
    s_nop 0
    buffer_load_dwordx4 v22, s[52:55], s77 offen offset:0 lds
    s_load_dword s94, s[18:19], s99 offset:0x100
    s_load_dword s94, s[18:19], s99 offset:0x140
    s_load_dword s94, s[18:19], s99 offset:0x180
    s_load_dword s94, s[18:19], s99 offset:0x1c0
    s_load_dword s94, s[10:11], s75 offset:0x80000
    s_waitcnt vmcnt(16)
    s_barrier
    s_add_u32 m0, s79, 116736
    s_mov_b32 s78, 640
    buffer_load_dwordx4 v20, s[36:39], s78 offen sc1 lds
    v_mul_f32 v80, v80, v124
    v_mul_f32 v81, v81, v125
    v_mul_f32 v82, v82, v126
    v_mul_f32 v83, v83, v127
    v_exp_f32 v80, v80
    v_mul_f32 v124, v124, v140
    v_exp_f32 v81, v81
    s_add_u32 m0, s79, 117760
    s_nop 0
    buffer_load_dwordx4 v21, s[36:39], s78 offen sc1 lds
    v_mul_f32 v125, v125, v141
    v_exp_f32 v82, v82
    v_mul_f32 v126, v126, v142
    v_exp_f32 v83, v83
    v_mul_f32 v127, v127, v143
    v_fma_f32 v80, v80, v71, v71
    s_add_u32 m0, s33, 36864
    s_mov_b32 s76, 1769472
    buffer_load_dwordx4 v23, s[40:43], s76 offen offset:0 lds
    v_fma_f32 v81, v81, v71, v71
    v_fma_f32 v82, v82, v71, v71
    v_fma_f32 v83, v83, v71, v71
    v_rcp_f32 v80, v80
    v_rcp_f32 v81, v81
    v_rcp_f32 v82, v82
    s_add_u32 m0, s33, 38912
    s_nop 0
    buffer_load_dwordx4 v23, s[40:43], s76 offen offset:2048 lds
    v_rcp_f32 v83, v83
    s_nop 0
    v_mul_f32 v124, v124, v80
    v_mul_f32 v125, v125, v81
    v_mul_f32 v126, v126, v82
    v_mul_f32 v127, v127, v83
    v_cvt_pk_bf16_f32 v122, v124, v125
    v_cvt_pk_bf16_f32 v123, v126, v127
    s_add_u32 m0, s33, 45056
    s_nop 0
    buffer_load_dwordx4 v23, s[44:47], s76 offen offset:0 lds
    s_nop 1
    v_permlane16_swap_b32 v120, v122
    v_permlane16_swap_b32 v121, v123
    s_add_u32 m0, s33, 49152
    s_mov_b32 s77, 2064384
    buffer_load_dwordx4 v22, s[48:51], s77 offen offset:0 lds
    v_fmac_f32 v128, v32, v72
    v_fmac_f32 v129, v33, v72
    v_fmac_f32 v130, v34, v72
    v_fmac_f32 v131, v35, v72
    v_fmac_f32 v144, v36, v72
    v_fmac_f32 v145, v37, v72
    v_fmac_f32 v146, v38, v72
    v_fmac_f32 v147, v39, v72
    s_add_u32 m0, s33, 53248
    s_nop 0
    buffer_load_dwordx4 v22, s[52:55], s77 offen offset:0 lds
    v_mul_f32 v80, v128, v128
    v_mul_f32 v81, v129, v129
    v_mul_f32 v82, v130, v130
    v_mul_f32 v83, v131, v131
    v_fma_f32 v80, v80, v74, v73
    v_fma_f32 v81, v81, v74, v73
    v_fma_f32 v82, v82, v74, v73
    v_fma_f32 v83, v83, v74, v73
    buffer_store_dwordx4 v[120:123], v19, s[68:71], s72 offen offset:512 sc1
    s_load_dword s94, s[10:11], s75 offset:0x80040
    s_load_dword s94, s[10:11], s75 offset:0x80080
    s_load_dword s94, s[10:11], s75 offset:0x800c0
    s_load_dword s94, s[10:11], s75 offset:0x80100
    s_load_dword s94, s[10:11], s75 offset:0x80140
    s_waitcnt vmcnt(17)
    s_barrier
    s_add_u32 m0, s79, 118784
    s_mov_b32 s78, 33408
    buffer_load_dwordx4 v20, s[36:39], s78 offen sc1 lds
    v_mul_f32 v80, v80, v128
    v_mul_f32 v81, v81, v129
    v_mul_f32 v82, v82, v130
    v_mul_f32 v83, v83, v131
    v_exp_f32 v80, v80
    v_mul_f32 v128, v128, v144
    v_exp_f32 v81, v81
    s_add_u32 m0, s79, 119808
    s_nop 0
    buffer_load_dwordx4 v21, s[36:39], s78 offen sc1 lds
    v_mul_f32 v129, v129, v145
    v_exp_f32 v82, v82
    v_mul_f32 v130, v130, v146
    v_exp_f32 v83, v83
    v_mul_f32 v131, v131, v147
    v_fma_f32 v80, v80, v75, v75
    s_add_u32 m0, s81, 133120
    s_mov_b32 s78, 640
    s_mov_b64 exec, 0xffffffff
    buffer_load_dwordx4 v3, s[36:39], s78 offen sc1 lds
    s_mov_b64 exec, -1
    v_fma_f32 v81, v81, v75, v75
    v_fma_f32 v82, v82, v75, v75
    v_fma_f32 v83, v83, v75, v75
    v_rcp_f32 v80, v80
    v_rcp_f32 v81, v81
    v_rcp_f32 v82, v82
    s_add_u32 m0, s33, 57344
    s_mov_b32 s76, 1966080
    buffer_load_dwordx4 v23, s[40:43], s76 offen offset:0 lds
    s_add_u32 m0, s33, 59392
    s_nop 0
    buffer_load_dwordx4 v23, s[40:43], s76 offen offset:2048 lds
    v_rcp_f32 v83, v83
    s_nop 0
    v_mul_f32 v128, v128, v80
    v_mul_f32 v129, v129, v81
    v_mul_f32 v130, v130, v82
    v_mul_f32 v131, v131, v83
    v_cvt_pk_bf16_f32 v128, v128, v129
    v_cvt_pk_bf16_f32 v129, v130, v131
    s_add_u32 m0, s33, 65536
    s_nop 0
    buffer_load_dwordx4 v23, s[44:47], s76 offen offset:0 lds
    v_fmac_f32 v132, v32, v76
    v_fmac_f32 v133, v33, v76
    v_fmac_f32 v134, v34, v76
    v_fmac_f32 v135, v35, v76
    v_fmac_f32 v148, v36, v76
    v_fmac_f32 v149, v37, v76
    v_fmac_f32 v150, v38, v76
    v_fmac_f32 v151, v39, v76
    s_add_u32 m0, s33, 69632
    s_mov_b32 s77, 2293760
    buffer_load_dwordx4 v22, s[48:51], s77 offen offset:0 lds
    v_mul_f32 v80, v132, v132
    v_mul_f32 v81, v133, v133
    v_mul_f32 v82, v134, v134
    v_mul_f32 v83, v135, v135
    v_fma_f32 v80, v80, v78, v77
    v_fma_f32 v81, v81, v78, v77
    v_fma_f32 v82, v82, v78, v77
    v_fma_f32 v83, v83, v78, v77
    s_add_u32 m0, s33, 73728
    s_nop 0
    buffer_load_dwordx4 v22, s[52:55], s77 offen offset:0 lds
    s_load_dword s94, s[10:11], s75 offset:0x80180
    s_load_dword s94, s[10:11], s75 offset:0x801c0
    s_add_u32 s75, s75, 0x100000
    s_load_dword s94, s[10:11], s75 offset:0x0
    s_load_dword s94, s[10:11], s75 offset:0x40
    s_load_dword s94, s[10:11], s75 offset:0x80
    s_waitcnt vmcnt(16)
    s_barrier
    s_add_u32 m0, s79, 135168
    s_mov_b32 s78, 768
    buffer_load_dwordx4 v20, s[36:39], s78 offen sc1 lds
    v_mul_f32 v80, v80, v132
    v_mul_f32 v81, v81, v133
    v_mul_f32 v82, v82, v134
    v_mul_f32 v83, v83, v135
    v_exp_f32 v80, v80
    v_mul_f32 v132, v132, v148
    v_exp_f32 v81, v81
    s_add_u32 m0, s79, 136192
    s_nop 0
    buffer_load_dwordx4 v21, s[36:39], s78 offen sc1 lds
    v_mul_f32 v133, v133, v149
    v_exp_f32 v82, v82
    v_mul_f32 v134, v134, v150
    v_exp_f32 v83, v83
    v_mul_f32 v135, v135, v151
    v_fma_f32 v80, v80, v79, v79
    s_add_u32 m0, s33, 77824
    s_mov_b32 s76, 2162688
    buffer_load_dwordx4 v23, s[40:43], s76 offen offset:0 lds
    v_fma_f32 v81, v81, v79, v79
    v_fma_f32 v82, v82, v79, v79
    v_fma_f32 v83, v83, v79, v79
    v_rcp_f32 v80, v80
    v_rcp_f32 v81, v81
    v_rcp_f32 v82, v82
    s_add_u32 m0, s33, 79872
    s_nop 0
    buffer_load_dwordx4 v23, s[40:43], s76 offen offset:2048 lds
    v_rcp_f32 v83, v83
    s_nop 0
    v_mul_f32 v132, v132, v80
    v_mul_f32 v133, v133, v81
    v_mul_f32 v134, v134, v82
    v_mul_f32 v135, v135, v83
    v_cvt_pk_bf16_f32 v130, v132, v133
    v_cvt_pk_bf16_f32 v131, v134, v135
    s_add_u32 m0, s33, 86016
    s_nop 0
    buffer_load_dwordx4 v23, s[44:47], s76 offen offset:0 lds
    s_nop 1
    v_permlane16_swap_b32 v128, v130
    v_permlane16_swap_b32 v129, v131
    s_add_u32 m0, s33, 90112
    s_mov_b32 s77, 2523136
    buffer_load_dwordx4 v22, s[48:51], s77 offen offset:0 lds
    v_fmac_f32 v152, v40, v64
    v_fmac_f32 v153, v41, v64
    v_fmac_f32 v154, v42, v64
    v_fmac_f32 v155, v43, v64
    v_fmac_f32 v168, v44, v64
    v_fmac_f32 v169, v45, v64
    v_fmac_f32 v170, v46, v64
    v_fmac_f32 v171, v47, v64
    s_add_u32 m0, s33, 94208
    s_nop 0
    buffer_load_dwordx4 v22, s[52:55], s77 offen offset:0 lds
    v_mul_f32 v80, v152, v152
    v_mul_f32 v81, v153, v153
    v_mul_f32 v82, v154, v154
    v_mul_f32 v83, v155, v155
    v_fma_f32 v80, v80, v66, v65
    v_fma_f32 v81, v81, v66, v65
    v_fma_f32 v82, v82, v66, v65
    v_fma_f32 v83, v83, v66, v65
    buffer_store_dwordx4 v[128:131], v19, s[68:71], s72 offen offset:2560 sc1
    s_load_dword s94, s[10:11], s75 offset:0xc0
    s_load_dword s94, s[10:11], s75 offset:0x100
    s_load_dword s94, s[10:11], s75 offset:0x140
    s_load_dword s94, s[10:11], s75 offset:0x180
    s_load_dword s94, s[10:11], s75 offset:0x1c0
    s_waitcnt vmcnt(56)
    s_movk_i32 s98, 0x4000
L_tokA_chk:
    v_readfirstlane_b32 s100, v6
    v_readfirstlane_b32 s101, v7
    s_nop 1
    s_cmp_lg_u32 s100, 0
    s_cbranch_scc1 L_tokA_ok
    s_sub_u32 s98, s98, 1
    s_cbranch_scc1 L_tokA_ok
    s_sleep 1
    global_load_dwordx2 v[6:7], v5, s[24:25] sc1
    s_waitcnt vmcnt(0)
    s_branch L_tokA_chk
L_tokA_ok:
    s_waitcnt vmcnt(17)
    s_barrier
    s_add_u32 m0, s79, 137216
    s_mov_b32 s78, 33536
    buffer_load_dwordx4 v20, s[36:39], s78 offen sc1 lds
    v_mul_f32 v80, v80, v152
    v_mul_f32 v81, v81, v153
    v_mul_f32 v82, v82, v154
    v_mul_f32 v83, v83, v155
    v_exp_f32 v80, v80
    v_mul_f32 v152, v152, v168
    v_exp_f32 v81, v81
    s_add_u32 m0, s79, 138240
    s_nop 0
    buffer_load_dwordx4 v21, s[36:39], s78 offen sc1 lds
    v_mul_f32 v153, v153, v169
    v_exp_f32 v82, v82
    v_mul_f32 v154, v154, v170
    v_exp_f32 v83, v83
    v_mul_f32 v155, v155, v171
    v_fma_f32 v80, v80, v67, v67
    s_add_u32 m0, s81, 151552
    s_mov_b32 s78, 768
    s_mov_b64 exec, 0xffffffff
    buffer_load_dwordx4 v3, s[36:39], s78 offen sc1 lds
    s_mov_b64 exec, -1
    v_fma_f32 v81, v81, v67, v67
    v_fma_f32 v82, v82, v67, v67
    v_fma_f32 v83, v83, v67, v67
    v_rcp_f32 v80, v80
    v_rcp_f32 v81, v81
    v_rcp_f32 v82, v82
    s_add_u32 m0, s33, 16384
    s_mov_b32 s76, 2359296
    buffer_load_dwordx4 v23, s[40:43], s76 offen offset:0 lds
    s_add_u32 m0, s33, 18432
    s_nop 0
    buffer_load_dwordx4 v23, s[40:43], s76 offen offset:2048 lds
    v_rcp_f32 v83, v83
    s_nop 0
    v_mul_f32 v152, v152, v80
    v_mul_f32 v153, v153, v81
    v_mul_f32 v154, v154, v82
    v_mul_f32 v155, v155, v83
    v_cvt_pk_bf16_f32 v152, v152, v153
    v_cvt_pk_bf16_f32 v153, v154, v155
    s_add_u32 m0, s33, 24576
    s_nop 0
    buffer_load_dwordx4 v23, s[44:47], s76 offen offset:0 lds
    v_fmac_f32 v156, v40, v68
    v_fmac_f32 v157, v41, v68
    v_fmac_f32 v158, v42, v68
    v_fmac_f32 v159, v43, v68
    v_fmac_f32 v172, v44, v68
    v_fmac_f32 v173, v45, v68
    v_fmac_f32 v174, v46, v68
    v_fmac_f32 v175, v47, v68
    s_add_u32 m0, s33, 28672
    s_mov_b32 s77, 2752512
    buffer_load_dwordx4 v22, s[48:51], s77 offen offset:0 lds
    v_mul_f32 v80, v156, v156
    v_mul_f32 v81, v157, v157
    v_mul_f32 v82, v158, v158
    v_mul_f32 v83, v159, v159
    v_fma_f32 v80, v80, v70, v69
    v_fma_f32 v81, v81, v70, v69
    v_fma_f32 v82, v82, v70, v69
    v_fma_f32 v83, v83, v70, v69
    s_add_u32 m0, s33, 32768
    s_nop 0
    buffer_load_dwordx4 v22, s[52:55], s77 offen offset:0 lds
    s_load_dword s94, s[10:11], s75 offset:0x80000
    s_load_dword s94, s[10:11], s75 offset:0x80040
    s_load_dword s94, s[10:11], s75 offset:0x80080
    s_load_dword s94, s[10:11], s75 offset:0x800c0
    s_load_dword s94, s[10:11], s75 offset:0x80100
    s_waitcnt vmcnt(16)
    s_barrier
    s_add_u32 m0, s79, 98304
    s_mov_b32 s78, 896
    buffer_load_dwordx4 v20, s[36:39], s78 offen sc1 lds
    v_mul_f32 v80, v80, v156
    v_mul_f32 v81, v81, v157
    v_mul_f32 v82, v82, v158
    v_mul_f32 v83, v83, v159
    v_exp_f32 v80, v80
    v_mul_f32 v156, v156, v172
    v_exp_f32 v81, v81
    s_add_u32 m0, s79, 99328
    s_nop 0
    buffer_load_dwordx4 v21, s[36:39], s78 offen sc1 lds
    v_mul_f32 v157, v157, v173
    v_exp_f32 v82, v82
    v_mul_f32 v158, v158, v174
    v_exp_f32 v83, v83
    v_mul_f32 v159, v159, v175
    v_fma_f32 v80, v80, v71, v71
    s_add_u32 m0, s33, 36864
    s_mov_b32 s76, 2555904
    buffer_load_dwordx4 v23, s[40:43], s76 offen offset:0 lds
    v_fma_f32 v81, v81, v71, v71
    v_fma_f32 v82, v82, v71, v71
    v_fma_f32 v83, v83, v71, v71
    v_rcp_f32 v80, v80
    v_rcp_f32 v81, v81
    v_rcp_f32 v82, v82
    s_add_u32 m0, s33, 38912
    s_nop 0
    buffer_load_dwordx4 v23, s[40:43], s76 offen offset:2048 lds
    v_rcp_f32 v83, v83
    s_nop 0
    v_mul_f32 v156, v156, v80
    v_mul_f32 v157, v157, v81
    v_mul_f32 v158, v158, v82
    v_mul_f32 v159, v159, v83
    v_cvt_pk_bf16_f32 v154, v156, v157
    v_cvt_pk_bf16_f32 v155, v158, v159
    s_add_u32 m0, s33, 45056
    s_nop 0
    buffer_load_dwordx4 v23, s[44:47], s76 offen offset:0 lds
    s_nop 1
    v_permlane16_swap_b32 v152, v154
    v_permlane16_swap_b32 v153, v155
    s_add_u32 m0, s33, 49152
    s_mov_b32 s77, 2981888
    buffer_load_dwordx4 v22, s[48:51], s77 offen offset:0 lds
    v_fmac_f32 v160, v40, v72
    v_fmac_f32 v161, v41, v72
    v_fmac_f32 v162, v42, v72
    v_fmac_f32 v163, v43, v72
    v_fmac_f32 v176, v44, v72
    v_fmac_f32 v177, v45, v72
    v_fmac_f32 v178, v46, v72
    v_fmac_f32 v179, v47, v72
    s_add_u32 m0, s33, 53248
    s_nop 0
    buffer_load_dwordx4 v22, s[52:55], s77 offen offset:0 lds
    v_mul_f32 v80, v160, v160
    v_mul_f32 v81, v161, v161
    v_mul_f32 v82, v162, v162
    v_mul_f32 v83, v163, v163
    v_fma_f32 v80, v80, v74, v73
    v_fma_f32 v81, v81, v74, v73
    v_fma_f32 v82, v82, v74, v73
    v_fma_f32 v83, v83, v74, v73
    buffer_store_dwordx4 v[152:155], v19, s[68:71], s73 offen offset:0 sc1
    s_load_dword s94, s[10:11], s75 offset:0x80140
    s_load_dword s94, s[10:11], s75 offset:0x80180
    s_load_dword s94, s[10:11], s75 offset:0x801c0
    s_add_u32 s99, s99, 0x1c0000
    s_load_dword s94, s[16:17], s99 offset:0x0
    s_load_dword s94, s[16:17], s99 offset:0x40
    s_waitcnt vmcnt(17)
    s_barrier
    s_add_u32 m0, s79, 100352
    s_mov_b32 s78, 33664
    buffer_load_dwordx4 v20, s[36:39], s78 offen sc1 lds
    v_mul_f32 v80, v80, v160
    v_mul_f32 v81, v81, v161
    v_mul_f32 v82, v82, v162
    v_mul_f32 v83, v83, v163
    v_exp_f32 v80, v80
    v_mul_f32 v160, v160, v176
    v_exp_f32 v81, v81
    s_add_u32 m0, s79, 101376
    s_nop 0
    buffer_load_dwordx4 v21, s[36:39], s78 offen sc1 lds
    v_mul_f32 v161, v161, v177
    v_exp_f32 v82, v82
    v_mul_f32 v162, v162, v178
    v_exp_f32 v83, v83
    v_mul_f32 v163, v163, v179
    v_fma_f32 v80, v80, v75, v75
    s_add_u32 m0, s81, 114688
    s_mov_b32 s78, 896
    s_mov_b64 exec, 0xffffffff
    buffer_load_dwordx4 v3, s[36:39], s78 offen sc1 lds
    s_mov_b64 exec, -1
    v_fma_f32 v81, v81, v75, v75
    v_fma_f32 v82, v82, v75, v75
    v_fma_f32 v83, v83, v75, v75
    v_rcp_f32 v80, v80
    v_rcp_f32 v81, v81
    v_rcp_f32 v82, v82
    s_add_u32 m0, s33, 57344
    s_mov_b32 s76, 2752512
    buffer_load_dwordx4 v23, s[40:43], s76 offen offset:0 lds
    s_add_u32 m0, s33, 59392
    s_nop 0
    buffer_load_dwordx4 v23, s[40:43], s76 offen offset:2048 lds
    v_rcp_f32 v83, v83
    s_nop 0
    v_mul_f32 v160, v160, v80
    v_mul_f32 v161, v161, v81
    v_mul_f32 v162, v162, v82
    v_mul_f32 v163, v163, v83
    v_cvt_pk_bf16_f32 v160, v160, v161
    v_cvt_pk_bf16_f32 v161, v162, v163
    s_add_u32 m0, s33, 65536
    s_nop 0
    buffer_load_dwordx4 v23, s[44:47], s76 offen offset:0 lds
    v_fmac_f32 v164, v40, v76
    v_fmac_f32 v165, v41, v76
    v_fmac_f32 v166, v42, v76
    v_fmac_f32 v167, v43, v76
    v_fmac_f32 v180, v44, v76
    v_fmac_f32 v181, v45, v76
    v_fmac_f32 v182, v46, v76
    v_fmac_f32 v183, v47, v76
    s_add_u32 m0, s33, 69632
    s_mov_b32 s77, 3211264
    buffer_load_dwordx4 v22, s[48:51], s77 offen offset:0 lds
    v_mul_f32 v80, v164, v164
    v_mul_f32 v81, v165, v165
    v_mul_f32 v82, v166, v166
    v_mul_f32 v83, v167, v167
    v_fma_f32 v80, v80, v78, v77
    v_fma_f32 v81, v81, v78, v77
    v_fma_f32 v82, v82, v78, v77
    v_fma_f32 v83, v83, v78, v77
    s_add_u32 m0, s33, 73728
    s_nop 0
    buffer_load_dwordx4 v22, s[52:55], s77 offen offset:0 lds
    s_load_dword s94, s[16:17], s99 offset:0x80
    s_load_dword s94, s[16:17], s99 offset:0xc0
    s_load_dword s94, s[16:17], s99 offset:0x100
    s_load_dword s94, s[16:17], s99 offset:0x140
    s_load_dword s94, s[16:17], s99 offset:0x180
    s_waitcnt vmcnt(16)
    s_barrier
    s_add_u32 m0, s79, 116736
    s_mov_b32 s78, 1024
    buffer_load_dwordx4 v20, s[36:39], s78 offen sc1 lds
    v_mul_f32 v80, v80, v164
    v_mul_f32 v81, v81, v165
    v_mul_f32 v82, v82, v166
    v_mul_f32 v83, v83, v167
    v_exp_f32 v80, v80
    v_mul_f32 v164, v164, v180
    v_exp_f32 v81, v81
    s_add_u32 m0, s79, 117760
    s_nop 0
    buffer_load_dwordx4 v21, s[36:39], s78 offen sc1 lds
    v_mul_f32 v165, v165, v181
    v_exp_f32 v82, v82
    v_mul_f32 v166, v166, v182
    v_exp_f32 v83, v83
    v_mul_f32 v167, v167, v183
    v_fma_f32 v80, v80, v79, v79
    s_add_u32 m0, s33, 77824
    s_mov_b32 s76, 2949120
    buffer_load_dwordx4 v23, s[40:43], s76 offen offset:0 lds
    v_fma_f32 v81, v81, v79, v79
    v_fma_f32 v82, v82, v79, v79
    v_fma_f32 v83, v83, v79, v79
    v_rcp_f32 v80, v80
    v_rcp_f32 v81, v81
    v_rcp_f32 v82, v82
    s_add_u32 m0, s33, 79872
    s_nop 0
    buffer_load_dwordx4 v23, s[40:43], s76 offen offset:2048 lds
    v_rcp_f32 v83, v83
    s_nop 0
    v_mul_f32 v164, v164, v80
    v_mul_f32 v165, v165, v81
    v_mul_f32 v166, v166, v82
    v_mul_f32 v167, v167, v83
    v_cvt_pk_bf16_f32 v162, v164, v165
    v_cvt_pk_bf16_f32 v163, v166, v167
    s_add_u32 m0, s33, 86016
    s_nop 0
    buffer_load_dwordx4 v23, s[44:47], s76 offen offset:0 lds
    s_nop 1
    v_permlane16_swap_b32 v160, v162
    v_permlane16_swap_b32 v161, v163
    s_add_u32 m0, s33, 90112
    s_mov_b32 s77, 3440640
    buffer_load_dwordx4 v22, s[48:51], s77 offen offset:0 lds
    v_fmac_f32 v184, v48, v64
    v_fmac_f32 v185, v49, v64
    v_fmac_f32 v186, v50, v64
    v_fmac_f32 v187, v51, v64
    v_fmac_f32 v200, v52, v64
    v_fmac_f32 v201, v53, v64
    v_fmac_f32 v202, v54, v64
    v_fmac_f32 v203, v55, v64
    s_add_u32 m0, s33, 94208
    s_nop 0
    buffer_load_dwordx4 v22, s[52:55], s77 offen offset:0 lds
    v_mul_f32 v80, v184, v184
    v_mul_f32 v81, v185, v185
    v_mul_f32 v82, v186, v186
    v_mul_f32 v83, v187, v187
    v_fma_f32 v80, v80, v66, v65
    v_fma_f32 v81, v81, v66, v65
    v_fma_f32 v82, v82, v66, v65
    v_fma_f32 v83, v83, v66, v65
    buffer_store_dwordx4 v[160:163], v19, s[68:71], s73 offen offset:2048 sc1
    s_load_dword s94, s[16:17], s99 offset:0x1c0
    s_load_dword s94, s[18:19], s99 offset:0x0
    s_load_dword s94, s[18:19], s99 offset:0x40
    s_load_dword s94, s[18:19], s99 offset:0x80
    s_load_dword s94, s[18:19], s99 offset:0xc0
    s_waitcnt vmcnt(17)
    s_barrier
    s_add_u32 m0, s79, 118784
    s_mov_b32 s78, 33792
    buffer_load_dwordx4 v20, s[36:39], s78 offen sc1 lds
    v_mul_f32 v80, v80, v184
    v_mul_f32 v81, v81, v185
    v_mul_f32 v82, v82, v186
    v_mul_f32 v83, v83, v187
    v_exp_f32 v80, v80
    v_mul_f32 v184, v184, v200
    v_exp_f32 v81, v81
    s_add_u32 m0, s79, 119808
    s_nop 0
    buffer_load_dwordx4 v21, s[36:39], s78 offen sc1 lds
    v_mul_f32 v185, v185, v201
    v_exp_f32 v82, v82
    v_mul_f32 v186, v186, v202
    v_exp_f32 v83, v83
    v_mul_f32 v187, v187, v203
    v_fma_f32 v80, v80, v67, v67
    s_add_u32 m0, s81, 133120
    s_mov_b32 s78, 1024
    s_mov_b64 exec, 0xffffffff
    buffer_load_dwordx4 v3, s[36:39], s78 offen sc1 lds
    s_mov_b64 exec, -1
    v_fma_f32 v81, v81, v67, v67
    v_fma_f32 v82, v82, v67, v67
    v_fma_f32 v83, v83, v67, v67
    v_rcp_f32 v80, v80
    v_rcp_f32 v81, v81
    v_rcp_f32 v82, v82
    s_add_u32 m0, s33, 16384
    s_mov_b32 s76, 3145728
    buffer_load_dwordx4 v23, s[40:43], s76 offen offset:0 lds
    s_add_u32 m0, s33, 18432
    s_nop 0
    buffer_load_dwordx4 v23, s[40:43], s76 offen offset:2048 lds
    v_rcp_f32 v83, v83
    s_nop 0
    v_mul_f32 v184, v184, v80
    v_mul_f32 v185, v185, v81
    v_mul_f32 v186, v186, v82
    v_mul_f32 v187, v187, v83
    v_cvt_pk_bf16_f32 v184, v184, v185
    v_cvt_pk_bf16_f32 v185, v186, v187
    s_add_u32 m0, s33, 24576
    s_nop 0
    buffer_load_dwordx4 v23, s[44:47], s76 offen offset:0 lds
    v_fmac_f32 v188, v48, v68
    v_fmac_f32 v189, v49, v68
    v_fmac_f32 v190, v50, v68
    v_fmac_f32 v191, v51, v68
    v_fmac_f32 v204, v52, v68
    v_fmac_f32 v205, v53, v68
    v_fmac_f32 v206, v54, v68
    v_fmac_f32 v207, v55, v68
    s_add_u32 m0, s33, 28672
    s_mov_b32 s77, 3670016
    buffer_load_dwordx4 v22, s[48:51], s77 offen offset:0 lds
    v_mul_f32 v80, v188, v188
    v_mul_f32 v81, v189, v189
    v_mul_f32 v82, v190, v190
    v_mul_f32 v83, v191, v191
    v_fma_f32 v80, v80, v70, v69
    v_fma_f32 v81, v81, v70, v69
    v_fma_f32 v82, v82, v70, v69
    v_fma_f32 v83, v83, v70, v69
    s_add_u32 m0, s33, 32768
    s_nop 0
    buffer_load_dwordx4 v22, s[52:55], s77 offen offset:0 lds
    s_load_dword s94, s[18:19], s99 offset:0x100
    s_load_dword s94, s[18:19], s99 offset:0x140
    s_load_dword s94, s[18:19], s99 offset:0x180
    s_load_dword s94, s[18:19], s99 offset:0x1c0
    s_add_u32 s75, s75, 0x100000
    s_load_dword s94, s[10:11], s75 offset:0x0
    s_waitcnt vmcnt(16)
    s_barrier
    s_add_u32 m0, s79, 135168
    s_mov_b32 s78, 1152
    buffer_load_dwordx4 v20, s[36:39], s78 offen sc1 lds
    v_mul_f32 v80, v80, v188
    v_mul_f32 v81, v81, v189
    v_mul_f32 v82, v82, v190
    v_mul_f32 v83, v83, v191
    v_exp_f32 v80, v80
    v_mul_f32 v188, v188, v204
    v_exp_f32 v81, v81
    s_add_u32 m0, s79, 136192
    s_nop 0
    buffer_load_dwordx4 v21, s[36:39], s78 offen sc1 lds
    v_mul_f32 v189, v189, v205
    v_exp_f32 v82, v82
    v_mul_f32 v190, v190, v206
    v_exp_f32 v83, v83
    v_mul_f32 v191, v191, v207
    v_fma_f32 v80, v80, v71, v71
    s_add_u32 m0, s33, 36864
    s_mov_b32 s76, 3342336
    buffer_load_dwordx4 v23, s[40:43], s76 offen offset:0 lds
    v_fma_f32 v81, v81, v71, v71
    v_fma_f32 v82, v82, v71, v71
L_pad2:
    s_cbranch_execz L_vret1
    v_fma_f32 v83, v83, v71, v71
    v_rcp_f32 v80, v80
    v_rcp_f32 v81, v81
    v_rcp_f32 v82, v82
    s_add_u32 m0, s33, 38912
    s_nop 0
    buffer_load_dwordx4 v23, s[40:43], s76 offen offset:2048 lds
    v_rcp_f32 v83, v83
    s_nop 0
    v_mul_f32 v188, v188, v80
    v_mul_f32 v189, v189, v81
    v_mul_f32 v190, v190, v82
    v_mul_f32 v191, v191, v83
    v_cvt_pk_bf16_f32 v186, v188, v189
    v_cvt_pk_bf16_f32 v187, v190, v191
    s_add_u32 m0, s33, 45056
    s_nop 0
    buffer_load_dwordx4 v23, s[44:47], s76 offen offset:0 lds
    s_nop 1
    v_permlane16_swap_b32 v184, v186
    v_permlane16_swap_b32 v185, v187
    s_add_u32 m0, s33, 49152
    s_mov_b32 s77, 3899392
    buffer_load_dwordx4 v22, s[48:51], s77 offen offset:0 lds
    v_fmac_f32 v192, v48, v72
    v_fmac_f32 v193, v49, v72
    v_fmac_f32 v194, v50, v72
    v_fmac_f32 v195, v51, v72
    v_fmac_f32 v208, v52, v72
    v_fmac_f32 v209, v53, v72
    v_fmac_f32 v210, v54, v72
    v_fmac_f32 v211, v55, v72
    s_add_u32 m0, s33, 53248
    s_nop 0
    buffer_load_dwordx4 v22, s[52:55], s77 offen offset:0 lds
    v_mul_f32 v80, v192, v192
    v_mul_f32 v81, v193, v193
    v_mul_f32 v82, v194, v194
    v_mul_f32 v83, v195, v195
    v_fma_f32 v80, v80, v74, v73
    v_fma_f32 v81, v81, v74, v73
    v_fma_f32 v82, v82, v74, v73
    v_fma_f32 v83, v83, v74, v73
    buffer_store_dwordx4 v[184:187], v19, s[68:71], s73 offen offset:512 sc1
    s_load_dword s94, s[10:11], s75 offset:0x40
    s_load_dword s94, s[10:11], s75 offset:0x80
    s_load_dword s94, s[10:11], s75 offset:0xc0
    s_load_dword s94, s[10:11], s75 offset:0x100
    s_load_dword s94, s[10:11], s75 offset:0x140
    s_waitcnt vmcnt(17)
    s_barrier
    s_add_u32 m0, s79, 137216
    s_mov_b32 s78, 33920
    buffer_load_dwordx4 v20, s[36:39], s78 offen sc1 lds
    v_mul_f32 v80, v80, v192
    v_mul_f32 v81, v81, v193
    v_mul_f32 v82, v82, v194
    v_mul_f32 v83, v83, v195
    v_exp_f32 v80, v80
    v_mul_f32 v192, v192, v208
    v_exp_f32 v81, v81
    s_add_u32 m0, s79, 138240
    s_nop 0
    buffer_load_dwordx4 v21, s[36:39], s78 offen sc1 lds
    v_mul_f32 v193, v193, v209
    v_exp_f32 v82, v82
    v_mul_f32 v194, v194, v210
    v_exp_f32 v83, v83
    v_mul_f32 v195, v195, v211
    v_fma_f32 v80, v80, v75, v75
    s_add_u32 m0, s81, 151552
    s_mov_b32 s78, 1152
    s_mov_b64 exec, 0xffffffff
    buffer_load_dwordx4 v3, s[36:39], s78 offen sc1 lds
    s_mov_b64 exec, -1
    v_fma_f32 v81, v81, v75, v75
    v_fma_f32 v82, v82, v75, v75
    v_fma_f32 v83, v83, v75, v75
    v_rcp_f32 v80, v80
    v_rcp_f32 v81, v81
    v_rcp_f32 v82, v82
    s_add_u32 m0, s33, 57344
    s_mov_b32 s76, 3538944
    buffer_load_dwordx4 v23, s[40:43], s76 offen offset:0 lds
    s_add_u32 m0, s33, 59392
    s_nop 0
    buffer_load_dwordx4 v23, s[40:43], s76 offen offset:2048 lds
    v_rcp_f32 v83, v83
    s_nop 0
    v_mul_f32 v192, v192, v80
    v_mul_f32 v193, v193, v81
    v_mul_f32 v194, v194, v82
    v_mul_f32 v195, v195, v83
    v_cvt_pk_bf16_f32 v192, v192, v193
    v_cvt_pk_bf16_f32 v193, v194, v195
    s_add_u32 m0, s33, 65536
    s_nop 0
    buffer_load_dwordx4 v23, s[44:47], s76 offen offset:0 lds
    v_fmac_f32 v196, v48, v76
    v_fmac_f32 v197, v49, v76
    v_fmac_f32 v198, v50, v76
    v_fmac_f32 v199, v51, v76
    v_fmac_f32 v212, v52, v76
    v_fmac_f32 v213, v53, v76
    v_fmac_f32 v214, v54, v76
    v_fmac_f32 v215, v55, v76
    s_add_u32 m0, s33, 69632
    s_mov_b32 s77, 4128768
    buffer_load_dwordx4 v22, s[48:51], s77 offen offset:0 lds
    v_mul_f32 v80, v196, v196
    v_mul_f32 v81, v197, v197
    v_mul_f32 v82, v198, v198
    v_mul_f32 v83, v199, v199
    v_fma_f32 v80, v80, v78, v77
    v_fma_f32 v81, v81, v78, v77
    v_fma_f32 v82, v82, v78, v77
    v_fma_f32 v83, v83, v78, v77
    s_add_u32 m0, s33, 73728
    s_nop 0
    buffer_load_dwordx4 v22, s[52:55], s77 offen offset:0 lds
    s_load_dword s94, s[10:11], s75 offset:0x180
    s_load_dword s94, s[10:11], s75 offset:0x1c0
    s_load_dword s94, s[10:11], s75 offset:0x80000
    s_load_dword s94, s[10:11], s75 offset:0x80040
    s_load_dword s94, s[10:11], s75 offset:0x80080
    s_waitcnt vmcnt(16)
    s_barrier
    s_add_u32 m0, s79, 98304
    s_mov_b32 s78, 1280
    buffer_load_dwordx4 v20, s[36:39], s78 offen sc1 lds
    v_mul_f32 v80, v80, v196
    v_mul_f32 v81, v81, v197
    v_mul_f32 v82, v82, v198
    v_mul_f32 v83, v83, v199
    v_exp_f32 v80, v80
    v_mul_f32 v196, v196, v212
    v_exp_f32 v81, v81
    s_add_u32 m0, s79, 99328
    s_nop 0
    buffer_load_dwordx4 v21, s[36:39], s78 offen sc1 lds
    v_mul_f32 v197, v197, v213
    v_exp_f32 v82, v82
    v_mul_f32 v198, v198, v214
    v_exp_f32 v83, v83
    v_mul_f32 v199, v199, v215
    v_fma_f32 v80, v80, v79, v79
    s_add_u32 m0, s33, 77824
    s_mov_b32 s76, 3735552
    buffer_load_dwordx4 v23, s[40:43], s76 offen offset:0 lds
    v_fma_f32 v81, v81, v79, v79
    v_fma_f32 v82, v82, v79, v79
    v_fma_f32 v83, v83, v79, v79
    v_rcp_f32 v80, v80
    v_rcp_f32 v81, v81
    v_rcp_f32 v82, v82
    s_add_u32 m0, s33, 79872
    s_nop 0
    buffer_load_dwordx4 v23, s[40:43], s76 offen offset:2048 lds
    v_rcp_f32 v83, v83
    s_nop 0
    v_mul_f32 v196, v196, v80
    v_mul_f32 v197, v197, v81
    v_mul_f32 v198, v198, v82
    v_mul_f32 v199, v199, v83
    v_cvt_pk_bf16_f32 v194, v196, v197
    v_cvt_pk_bf16_f32 v195, v198, v199
    s_add_u32 m0, s33, 86016
    s_nop 0
    buffer_load_dwordx4 v23, s[44:47], s76 offen offset:0 lds
    s_nop 1
    v_permlane16_swap_b32 v192, v194
    v_permlane16_swap_b32 v193, v195
    s_add_u32 m0, s33, 90112
    s_mov_b32 s77, 4358144
    buffer_load_dwordx4 v22, s[48:51], s77 offen offset:0 lds
    v_fmac_f32 v216, v56, v64
    v_fmac_f32 v217, v57, v64
    v_fmac_f32 v218, v58, v64
    v_fmac_f32 v219, v59, v64
    v_fmac_f32 v232, v60, v64
    v_fmac_f32 v233, v61, v64
    v_fmac_f32 v234, v62, v64
    v_fmac_f32 v235, v63, v64
    s_add_u32 m0, s33, 94208
    s_nop 0
    buffer_load_dwordx4 v22, s[52:55], s77 offen offset:0 lds
    v_mul_f32 v80, v216, v216
    v_mul_f32 v81, v217, v217
    v_mul_f32 v82, v218, v218
    v_mul_f32 v83, v219, v219
    v_fma_f32 v80, v80, v66, v65
    v_fma_f32 v81, v81, v66, v65
    v_fma_f32 v82, v82, v66, v65
    v_fma_f32 v83, v83, v66, v65
    buffer_store_dwordx4 v[192:195], v19, s[68:71], s73 offen offset:2560 sc1
    s_load_dword s94, s[10:11], s75 offset:0x800c0
    s_load_dword s94, s[10:11], s75 offset:0x80100
    s_load_dword s94, s[10:11], s75 offset:0x80140
    s_load_dword s94, s[10:11], s75 offset:0x80180
    s_load_dword s94, s[10:11], s75 offset:0x801c0
    s_waitcnt vmcnt(17)
    s_barrier
    s_add_u32 m0, s79, 100352
    s_mov_b32 s78, 34048
    buffer_load_dwordx4 v20, s[36:39], s78 offen sc1 lds
    v_mul_f32 v80, v80, v216
    v_mul_f32 v81, v81, v217
    v_mul_f32 v82, v82, v218
    v_mul_f32 v83, v83, v219
    v_exp_f32 v80, v80
    v_mul_f32 v216, v216, v232
    v_exp_f32 v81, v81
    s_add_u32 m0, s79, 101376
    s_nop 0
    buffer_load_dwordx4 v21, s[36:39], s78 offen sc1 lds
    v_mul_f32 v217, v217, v233
    v_exp_f32 v82, v82
    v_mul_f32 v218, v218, v234
    v_exp_f32 v83, v83
    v_mul_f32 v219, v219, v235
    v_fma_f32 v80, v80, v67, v67
    s_add_u32 m0, s81, 114688
    s_mov_b32 s78, 1280
    s_mov_b64 exec, 0xffffffff
    buffer_load_dwordx4 v3, s[36:39], s78 offen sc1 lds
    s_mov_b64 exec, -1
    v_fma_f32 v81, v81, v67, v67
    v_fma_f32 v82, v82, v67, v67
    v_fma_f32 v83, v83, v67, v67
    v_rcp_f32 v80, v80
    v_rcp_f32 v81, v81
    v_rcp_f32 v82, v82
    s_add_u32 m0, s33, 16384
    s_mov_b32 s76, 3932160
    buffer_load_dwordx4 v23, s[40:43], s76 offen offset:0 lds
    s_add_u32 m0, s33, 18432
    s_nop 0
    buffer_load_dwordx4 v23, s[40:43], s76 offen offset:2048 lds
    v_rcp_f32 v83, v83
    s_nop 0
    v_mul_f32 v216, v216, v80
    v_mul_f32 v217, v217, v81
    v_mul_f32 v218, v218, v82
    v_mul_f32 v219, v219, v83
    v_cvt_pk_bf16_f32 v216, v216, v217
    v_cvt_pk_bf16_f32 v217, v218, v219
    s_add_u32 m0, s33, 24576
    s_nop 0
    buffer_load_dwordx4 v23, s[44:47], s76 offen offset:0 lds
    v_fmac_f32 v220, v56, v68
    v_fmac_f32 v221, v57, v68
    v_fmac_f32 v222, v58, v68
    v_fmac_f32 v223, v59, v68
    v_fmac_f32 v236, v60, v68
    v_fmac_f32 v237, v61, v68
    v_fmac_f32 v238, v62, v68
    v_fmac_f32 v239, v63, v68
    s_add_u32 m0, s33, 28672
    s_mov_b32 s77, 4587520
    buffer_load_dwordx4 v22, s[48:51], s77 offen offset:0 lds
    v_mul_f32 v80, v220, v220
    v_mul_f32 v81, v221, v221
    v_mul_f32 v82, v222, v222
    v_mul_f32 v83, v223, v223
    v_fma_f32 v80, v80, v70, v69
    v_fma_f32 v81, v81, v70, v69
    v_fma_f32 v82, v82, v70, v69
    v_fma_f32 v83, v83, v70, v69
    s_add_u32 m0, s33, 32768
    s_nop 0
    buffer_load_dwordx4 v22, s[52:55], s77 offen offset:0 lds
    s_add_u32 s75, s75, 0xffb00000
    s_load_dword s94, s[20:21], s75 offset:0x0
    s_load_dword s94, s[20:21], s75 offset:0x40
    s_load_dword s94, s[20:21], s75 offset:0x80
    s_load_dword s94, s[20:21], s75 offset:0xc0
    s_load_dword s94, s[20:21], s75 offset:0x100
    s_waitcnt vmcnt(16)
    s_barrier
    s_add_u32 m0, s79, 116736
    s_mov_b32 s78, 1408
    buffer_load_dwordx4 v20, s[36:39], s78 offen sc1 lds
    v_mul_f32 v80, v80, v220
    v_mul_f32 v81, v81, v221
    v_mul_f32 v82, v82, v222
    v_mul_f32 v83, v83, v223
    v_exp_f32 v80, v80
    v_mul_f32 v220, v220, v236
    v_exp_f32 v81, v81
    s_add_u32 m0, s79, 117760
    s_nop 0
    buffer_load_dwordx4 v21, s[36:39], s78 offen sc1 lds
    v_mul_f32 v221, v221, v237
    v_exp_f32 v82, v82
    v_mul_f32 v222, v222, v238
    v_exp_f32 v83, v83
    v_mul_f32 v223, v223, v239
    v_fma_f32 v80, v80, v71, v71
    s_add_u32 m0, s33, 36864
    s_mov_b32 s76, 4128768
    buffer_load_dwordx4 v23, s[40:43], s76 offen offset:0 lds
    v_fma_f32 v81, v81, v71, v71
    v_fma_f32 v82, v82, v71, v71
    v_fma_f32 v83, v83, v71, v71
    v_rcp_f32 v80, v80
    v_rcp_f32 v81, v81
    v_rcp_f32 v82, v82
    s_add_u32 m0, s33, 38912
    s_nop 0
    buffer_load_dwordx4 v23, s[40:43], s76 offen offset:2048 lds
    v_rcp_f32 v83, v83
    s_nop 0
    v_mul_f32 v220, v220, v80
    v_mul_f32 v221, v221, v81
    v_mul_f32 v222, v222, v82
    v_mul_f32 v223, v223, v83
    v_cvt_pk_bf16_f32 v218, v220, v221
    v_cvt_pk_bf16_f32 v219, v222, v223
    s_add_u32 m0, s33, 45056
    s_nop 0
    buffer_load_dwordx4 v23, s[44:47], s76 offen offset:0 lds
    s_nop 1
    v_permlane16_swap_b32 v216, v218
    v_permlane16_swap_b32 v217, v219
    s_add_u32 m0, s33, 49152
    s_mov_b32 s77, 4816896
    buffer_load_dwordx4 v22, s[48:51], s77 offen offset:0 lds
    v_fmac_f32 v224, v56, v72
    v_fmac_f32 v225, v57, v72
    v_fmac_f32 v226, v58, v72
    v_fmac_f32 v227, v59, v72
    v_fmac_f32 v240, v60, v72
    v_fmac_f32 v241, v61, v72
    v_fmac_f32 v242, v62, v72
    v_fmac_f32 v243, v63, v72
    s_add_u32 m0, s33, 53248
    s_nop 0
    buffer_load_dwordx4 v22, s[52:55], s77 offen offset:0 lds
    v_mul_f32 v80, v224, v224
    v_mul_f32 v81, v225, v225
    v_mul_f32 v82, v226, v226
    v_mul_f32 v83, v227, v227
    v_fma_f32 v80, v80, v74, v73
    v_fma_f32 v81, v81, v74, v73
    v_fma_f32 v82, v82, v74, v73
    v_fma_f32 v83, v83, v74, v73
    buffer_store_dwordx4 v[216:219], v19, s[68:71], s74 offen offset:0 sc1
    s_load_dword s94, s[20:21], s75 offset:0x140
    s_load_dword s94, s[20:21], s75 offset:0x180
    s_load_dword s94, s[20:21], s75 offset:0x1c0
    s_add_u32 s75, s75, 0x280000
    s_load_dword s94, s[20:21], s75 offset:0x0
    s_load_dword s94, s[20:21], s75 offset:0x40
    s_waitcnt vmcnt(17)
    s_barrier
    s_add_u32 m0, s79, 118784
    s_mov_b32 s78, 34176
    buffer_load_dwordx4 v20, s[36:39], s78 offen sc1 lds
    v_mul_f32 v80, v80, v224
    v_mul_f32 v81, v81, v225
    v_mul_f32 v82, v82, v226
    v_mul_f32 v83, v83, v227
    v_exp_f32 v80, v80
    v_mul_f32 v224, v224, v240
    v_exp_f32 v81, v81
    s_add_u32 m0, s79, 119808
    s_nop 0
    buffer_load_dwordx4 v21, s[36:39], s78 offen sc1 lds
    v_mul_f32 v225, v225, v241
    v_exp_f32 v82, v82
    v_mul_f32 v226, v226, v242
    v_exp_f32 v83, v83
    v_mul_f32 v227, v227, v243
    v_fma_f32 v80, v80, v75, v75
    s_add_u32 m0, s81, 133120
    s_mov_b32 s78, 1408
    s_mov_b64 exec, 0xffffffff
    buffer_load_dwordx4 v3, s[36:39], s78 offen sc1 lds
    s_mov_b64 exec, -1
    v_fma_f32 v81, v81, v75, v75
    v_fma_f32 v82, v82, v75, v75
    v_fma_f32 v83, v83, v75, v75
    v_rcp_f32 v80, v80
    v_rcp_f32 v81, v81
    v_rcp_f32 v82, v82
    s_add_u32 m0, s33, 57344
    s_mov_b32 s76, 4325376
    buffer_load_dwordx4 v23, s[40:43], s76 offen offset:0 lds
    s_add_u32 m0, s33, 59392
    s_nop 0
    buffer_load_dwordx4 v23, s[40:43], s76 offen offset:2048 lds
    v_rcp_f32 v83, v83
    s_nop 0
    v_mul_f32 v224, v224, v80
    v_mul_f32 v225, v225, v81
    v_mul_f32 v226, v226, v82
    v_mul_f32 v227, v227, v83
    v_cvt_pk_bf16_f32 v224, v224, v225
    v_cvt_pk_bf16_f32 v225, v226, v227
    s_add_u32 m0, s33, 65536
    s_nop 0
    buffer_load_dwordx4 v23, s[44:47], s76 offen offset:0 lds
    v_fmac_f32 v228, v56, v76
    v_fmac_f32 v229, v57, v76
    v_fmac_f32 v230, v58, v76
    v_fmac_f32 v231, v59, v76
    v_fmac_f32 v244, v60, v76
    v_fmac_f32 v245, v61, v76
    v_fmac_f32 v246, v62, v76
    v_fmac_f32 v247, v63, v76
    s_add_u32 m0, s33, 69632
    s_mov_b32 s77, 5046272
    buffer_load_dwordx4 v22, s[48:51], s77 offen offset:0 lds
    v_mul_f32 v80, v228, v228
    v_mul_f32 v81, v229, v229
    v_mul_f32 v82, v230, v230
    v_mul_f32 v83, v231, v231
    v_fma_f32 v80, v80, v78, v77
    v_fma_f32 v81, v81, v78, v77
    v_fma_f32 v82, v82, v78, v77
    v_fma_f32 v83, v83, v78, v77
    s_add_u32 m0, s33, 73728
    s_nop 0
    buffer_load_dwordx4 v22, s[52:55], s77 offen offset:0 lds
    s_load_dword s94, s[20:21], s75 offset:0x80
    s_load_dword s94, s[20:21], s75 offset:0xc0
    s_load_dword s94, s[20:21], s75 offset:0x100
    s_load_dword s94, s[20:21], s75 offset:0x140
    s_load_dword s94, s[20:21], s75 offset:0x180
    s_lshl_b32 s91, s4, 6
    s_add_u32 s91, s91, s29
    s_lshl_b32 s91, s91, 7
    s_add_u32 s91, s91, 0x1eb0000
    v_lshl_add_u32 v13, v1, 11, s91
    s_mov_b64 exec, 15
    global_load_dwordx2 v[14:15], v13, s[26:27] sc1
    s_mov_b64 exec, -1
    s_waitcnt vmcnt(17)
    s_barrier
    s_mov_b64 exec, 0
    s_cmp_eq_u32 s4, 0
    s_cbranch_scc1 L_pad4
    s_cmp_eq_u32 s4, 1
    s_cbranch_scc1 L_pad5
    s_cmp_eq_u32 s4, 2
    s_cbranch_scc1 L_pad10
    s_cmp_eq_u32 s4, 3
    s_cbranch_scc1 L_pad11
L_vret2:
    s_mov_b64 exec, -1
    v_mul_f32 v80, v80, v228
    v_mul_f32 v81, v81, v229
    v_mul_f32 v82, v82, v230
    v_mul_f32 v83, v83, v231
    v_exp_f32 v80, v80
    v_mul_f32 v228, v228, v244
    v_exp_f32 v81, v81
    v_mul_f32 v229, v229, v245
    v_exp_f32 v82, v82
    v_mul_f32 v230, v230, v246
    v_exp_f32 v83, v83
    v_mul_f32 v231, v231, v247
    v_fma_f32 v80, v80, v79, v79
    v_fma_f32 v81, v81, v79, v79
    v_fma_f32 v82, v82, v79, v79
    v_fma_f32 v83, v83, v79, v79
    v_rcp_f32 v80, v80
    v_rcp_f32 v81, v81
    v_rcp_f32 v82, v82
    v_rcp_f32 v83, v83
    s_nop 0
    v_mul_f32 v228, v228, v80
    v_mul_f32 v229, v229, v81
    v_mul_f32 v230, v230, v82
    v_mul_f32 v231, v231, v83
    v_cvt_pk_bf16_f32 v226, v228, v229
    v_cvt_pk_bf16_f32 v227, v230, v231
    s_nop 1
    v_permlane16_swap_b32 v224, v226
    v_permlane16_swap_b32 v225, v227
    buffer_store_dwordx4 v[224:227], v19, s[68:71], s74 offen offset:2048 sc1
    s_load_dword s94, s[20:21], s75 offset:0x1c0
    s_add_u32 s75, s75, 0xffe00000
    s_load_dword s94, s[20:21], s75 offset:0x0
    s_load_dword s94, s[20:21], s75 offset:0x40
    s_load_dword s94, s[20:21], s75 offset:0x80
    s_load_dword s94, s[20:21], s75 offset:0xc0
    s_waitcnt vmcnt(11)
    s_barrier
    s_add_u32 m0, s79, 135168
    s_mov_b32 s78, 1536
    buffer_load_dwordx4 v20, s[36:39], s78 offen sc1 lds
    s_add_u32 m0, s79, 136192
    s_nop 0
    buffer_load_dwordx4 v21, s[36:39], s78 offen sc1 lds
    s_add_u32 m0, s33, 77824
    s_mov_b32 s76, 4521984
    buffer_load_dwordx4 v23, s[40:43], s76 offen offset:0 lds
    s_add_u32 m0, s33, 79872
    s_nop 0
    buffer_load_dwordx4 v23, s[40:43], s76 offen offset:2048 lds
    s_add_u32 m0, s33, 86016
    s_nop 0
    buffer_load_dwordx4 v23, s[44:47], s76 offen offset:0 lds
    s_add_u32 m0, s33, 90112
    s_mov_b32 s77, 5275648
    buffer_load_dwordx4 v22, s[48:51], s77 offen offset:0 lds
    s_add_u32 m0, s33, 94208
    s_nop 0
    buffer_load_dwordx4 v22, s[52:55], s77 offen offset:0 lds
    s_add_u32 m0, s79, 137216
    s_mov_b32 s78, 34304
    buffer_load_dwordx4 v20, s[36:39], s78 offen sc1 lds
    s_add_u32 m0, s79, 138240
    s_nop 0
    buffer_load_dwordx4 v21, s[36:39], s78 offen sc1 lds
    s_add_u32 m0, s81, 151552
    s_mov_b32 s78, 1536
    s_mov_b64 exec, 0xffffffff
    buffer_load_dwordx4 v3, s[36:39], s78 offen sc1 lds
    s_mov_b64 exec, -1
    s_load_dword s94, s[20:21], s75 offset:0x100
    s_load_dword s94, s[20:21], s75 offset:0x140
    s_load_dword s94, s[20:21], s75 offset:0x180
    s_load_dword s94, s[20:21], s75 offset:0x1c0
    s_add_u32 s75, s75, 0x280000
    s_load_dword s94, s[20:21], s75 offset:0x0
    s_waitcnt vmcnt(11)
    s_mov_b64 exec, 15
    s_movk_i32 s98, 0x4000
L_pC_chk:
    v_cmp_ne_u64 vcc, s[100:101], v[14:15]
    s_nop 1
    s_cmp_eq_u64 vcc, 0
    s_cbranch_scc1 L_pC_ok
    s_sub_u32 s98, s98, 1
    s_cbranch_scc1 L_pC_ok
    s_sleep 1
    global_load_dwordx2 v[14:15], v13, s[26:27] sc1
    s_waitcnt vmcnt(0)
    s_branch L_pC_chk
L_pC_ok:
    s_mov_b64 exec, -1
    s_waitcnt vmcnt(12)
    s_barrier
    s_add_u32 m0, s33, 16384
    s_mov_b32 s76, 4718592
    buffer_load_dwordx4 v23, s[40:43], s76 offen offset:0 lds
    s_add_u32 m0, s33, 18432
    s_nop 0
    buffer_load_dwordx4 v23, s[40:43], s76 offen offset:2048 lds
    s_add_u32 m0, s33, 24576
    s_nop 0
    buffer_load_dwordx4 v23, s[44:47], s76 offen offset:0 lds
    s_add_u32 m0, s33, 28672
    s_mov_b32 s77, 5505024
    buffer_load_dwordx4 v22, s[48:51], s77 offen offset:0 lds
    s_add_u32 m0, s33, 32768
    s_nop 0
    buffer_load_dwordx4 v22, s[52:55], s77 offen offset:0 lds
    s_add_u32 m0, s79, 98304
    s_mov_b32 s78, 1664
    buffer_load_dwordx4 v20, s[36:39], s78 offen sc1 lds
    s_add_u32 m0, s79, 99328
    s_nop 0
    buffer_load_dwordx4 v21, s[36:39], s78 offen sc1 lds
    s_add_u32 m0, s33, 36864
    s_mov_b32 s76, 4915200
    buffer_load_dwordx4 v23, s[40:43], s76 offen offset:0 lds
    s_add_u32 m0, s33, 38912
    s_nop 0
    buffer_load_dwordx4 v23, s[40:43], s76 offen offset:2048 lds
    s_add_u32 m0, s33, 45056
    s_nop 0
    buffer_load_dwordx4 v23, s[44:47], s76 offen offset:0 lds
    s_add_u32 m0, s33, 49152
    s_mov_b32 s77, 5734400
    buffer_load_dwordx4 v22, s[48:51], s77 offen offset:0 lds
    s_load_dword s94, s[20:21], s75 offset:0x40
    s_load_dword s94, s[20:21], s75 offset:0x80
    s_load_dword s94, s[20:21], s75 offset:0xc0
    s_load_dword s94, s[20:21], s75 offset:0x100
    s_load_dword s94, s[20:21], s75 offset:0x140
    s_waitcnt vmcnt(14)
    s_barrier
    s_add_u32 m0, s33, 53248
    s_nop 0
    buffer_load_dwordx4 v22, s[52:55], s77 offen offset:0 lds
    s_add_u32 m0, s79, 100352
    s_mov_b32 s78, 34432
    buffer_load_dwordx4 v20, s[36:39], s78 offen sc1 lds
    s_add_u32 m0, s79, 101376
    s_nop 0
    buffer_load_dwordx4 v21, s[36:39], s78 offen sc1 lds
    s_add_u32 m0, s81, 114688
    s_mov_b32 s78, 1664
    s_mov_b64 exec, 0xffffffff
    buffer_load_dwordx4 v3, s[36:39], s78 offen sc1 lds
    s_mov_b64 exec, -1
    s_add_u32 m0, s33, 57344
    s_mov_b32 s76, 5111808
    buffer_load_dwordx4 v23, s[40:43], s76 offen offset:0 lds
    s_add_u32 m0, s33, 59392
    s_nop 0
    buffer_load_dwordx4 v23, s[40:43], s76 offen offset:2048 lds
    s_add_u32 m0, s33, 65536
    s_nop 0
    buffer_load_dwordx4 v23, s[44:47], s76 offen offset:0 lds
    s_add_u32 m0, s33, 69632
    s_mov_b32 s77, 5963776
    buffer_load_dwordx4 v22, s[48:51], s77 offen offset:0 lds
    s_add_u32 m0, s33, 73728
    s_nop 0
    buffer_load_dwordx4 v22, s[52:55], s77 offen offset:0 lds
    s_load_dword s94, s[20:21], s75 offset:0x180
    s_load_dword s94, s[20:21], s75 offset:0x1c0
    s_add_u32 s75, s75, 0xffe00000
    s_load_dword s94, s[20:21], s75 offset:0x0
    s_load_dword s94, s[20:21], s75 offset:0x40
    s_load_dword s94, s[20:21], s75 offset:0x80
    s_waitcnt vmcnt(30)
    s_waitcnt vmcnt(15)
    s_barrier
    s_mov_b64 exec, 0
    s_cmp_eq_u32 s4, 0
    s_cbranch_scc1 L_pad12
L_vret3:
    s_mov_b64 exec, -1
    s_load_dword s94, s[20:21], s75 offset:0xc0
    s_load_dword s94, s[20:21], s75 offset:0x100
    s_load_dword s94, s[20:21], s75 offset:0x140
    s_load_dword s94, s[20:21], s75 offset:0x180
    s_load_dword s94, s[20:21], s75 offset:0x1c0
    s_cmp_lg_u32 s4, 0
    s_cbranch_scc1 L_fH1
    s_lshl_b32 s91, s28, 4
    s_add_u32 s91, s91, s29
    s_lshl_b32 s91, s91, 7
    s_add_u32 s91, s91, 0x1e88000
    v_mov_b32 v12, s91
    v_mov_b32 v14, s100
    v_mov_b32 v15, s101
    s_mov_b64 exec, 1
    global_store_dwordx2 v12, v[14:15], s[26:27] sc1
    s_mov_b64 exec, -1
L_fH1:
    s_waitcnt vmcnt(8)
    s_barrier
    s_add_u32 m0, s79, 116736
    s_mov_b32 s78, 1792
    buffer_load_dwordx4 v20, s[36:39], s78 offen sc1 lds
    s_add_u32 m0, s79, 117760
    s_nop 0
    buffer_load_dwordx4 v21, s[36:39], s78 offen sc1 lds
    s_add_u32 m0, s33, 77824
    s_mov_b32 s76, 5308416
    buffer_load_dwordx4 v23, s[40:43], s76 offen offset:0 lds
    s_add_u32 m0, s33, 79872
    s_nop 0
    buffer_load_dwordx4 v23, s[40:43], s76 offen offset:2048 lds
    s_add_u32 m0, s33, 86016
    s_nop 0
    buffer_load_dwordx4 v23, s[44:47], s76 offen offset:0 lds
    s_add_u32 m0, s33, 90112
    s_mov_b32 s77, 6193152
    buffer_load_dwordx4 v22, s[48:51], s77 offen offset:0 lds
    s_add_u32 m0, s33, 94208
    s_nop 0
    buffer_load_dwordx4 v22, s[52:55], s77 offen offset:0 lds
    s_add_u32 m0, s79, 118784
    s_mov_b32 s78, 34560
    buffer_load_dwordx4 v20, s[36:39], s78 offen sc1 lds
    s_add_u32 m0, s79, 119808
    s_nop 0
    buffer_load_dwordx4 v21, s[36:39], s78 offen sc1 lds
    s_add_u32 m0, s81, 133120
    s_mov_b32 s78, 1792
    s_mov_b64 exec, 0xffffffff
    buffer_load_dwordx4 v3, s[36:39], s78 offen sc1 lds
    s_mov_b64 exec, -1
    s_add_u32 s75, s75, 0x280000
    s_load_dword s94, s[20:21], s75 offset:0x0
    s_load_dword s94, s[20:21], s75 offset:0x40
L_pad3:
    s_cbranch_execz L_vret1
    s_load_dword s94, s[20:21], s75 offset:0x80
    s_load_dword s94, s[20:21], s75 offset:0xc0
    s_load_dword s94, s[20:21], s75 offset:0x100
    s_waitcnt vmcnt(10)
    s_barrier
    s_add_u32 m0, s33, 16384
    s_mov_b32 s76, 5505024
    buffer_load_dwordx4 v23, s[40:43], s76 offen offset:0 lds
    s_add_u32 m0, s33, 18432
    s_nop 0
    buffer_load_dwordx4 v23, s[40:43], s76 offen offset:2048 lds
    s_add_u32 m0, s33, 24576
    s_nop 0
    buffer_load_dwordx4 v23, s[44:47], s76 offen offset:0 lds
    s_add_u32 m0, s33, 28672
    s_mov_b32 s77, 6422528
    buffer_load_dwordx4 v22, s[48:51], s77 offen offset:0 lds
    s_add_u32 m0, s33, 32768
    s_nop 0
    buffer_load_dwordx4 v22, s[52:55], s77 offen offset:0 lds
    s_add_u32 m0, s79, 135168
    s_mov_b32 s78, 1920
    buffer_load_dwordx4 v20, s[36:39], s78 offen sc1 lds
    s_add_u32 m0, s79, 136192
    s_nop 0
    buffer_load_dwordx4 v21, s[36:39], s78 offen sc1 lds
    s_add_u32 m0, s33, 36864
    s_mov_b32 s76, 5701632
    buffer_load_dwordx4 v23, s[40:43], s76 offen offset:0 lds
    s_add_u32 m0, s33, 38912
    s_nop 0
    buffer_load_dwordx4 v23, s[40:43], s76 offen offset:2048 lds
    s_add_u32 m0, s33, 45056
    s_nop 0
    buffer_load_dwordx4 v23, s[44:47], s76 offen offset:0 lds
    s_add_u32 m0, s33, 49152
    s_mov_b32 s77, 6651904
    buffer_load_dwordx4 v22, s[48:51], s77 offen offset:0 lds
    s_load_dword s94, s[20:21], s75 offset:0x140
    s_load_dword s94, s[20:21], s75 offset:0x180
    s_load_dword s94, s[20:21], s75 offset:0x1c0
    s_add_u32 s75, s75, 0xffe00000
    s_load_dword s94, s[20:21], s75 offset:0x0
    s_load_dword s94, s[20:21], s75 offset:0x40
    s_waitcnt vmcnt(14)
    s_barrier
    s_add_u32 m0, s33, 53248
    s_nop 0
    buffer_load_dwordx4 v22, s[52:55], s77 offen offset:0 lds
    s_add_u32 m0, s79, 137216
    s_mov_b32 s78, 34688
    buffer_load_dwordx4 v20, s[36:39], s78 offen sc1 lds
    s_add_u32 m0, s79, 138240
    s_nop 0
    buffer_load_dwordx4 v21, s[36:39], s78 offen sc1 lds
    s_add_u32 m0, s81, 151552
    s_mov_b32 s78, 1920
    s_mov_b64 exec, 0xffffffff
    buffer_load_dwordx4 v3, s[36:39], s78 offen sc1 lds
    s_mov_b64 exec, -1
    s_add_u32 m0, s33, 57344
    s_mov_b32 s76, 5898240
    buffer_load_dwordx4 v23, s[40:43], s76 offen offset:0 lds
    s_add_u32 m0, s33, 59392
    s_nop 0
    buffer_load_dwordx4 v23, s[40:43], s76 offen offset:2048 lds
    s_add_u32 m0, s33, 65536
    s_nop 0
    buffer_load_dwordx4 v23, s[44:47], s76 offen offset:0 lds
    s_add_u32 m0, s33, 69632
    s_mov_b32 s77, 6881280
    buffer_load_dwordx4 v22, s[48:51], s77 offen offset:0 lds
    s_add_u32 m0, s33, 73728
    s_nop 0
    buffer_load_dwordx4 v22, s[52:55], s77 offen offset:0 lds
    s_lshl2_add_u32 s91, s30, s4
    s_lshl_b32 s91, s91, 9
    s_add_u32 s91, s91, 0x1e88000
    v_lshl_add_u32 v13, v1, 7, s91
    s_mov_b64 exec, 15
    global_load_dwordx2 v[14:15], v13, s[26:27] sc1
    s_mov_b64 exec, -1
    s_waitcnt vmcnt(16)
    s_barrier
    s_add_u32 m0, s33, 77824
    s_mov_b32 s76, 6094848
    buffer_load_dwordx4 v23, s[40:43], s76 offen offset:0 lds
    s_add_u32 m0, s33, 79872
    s_nop 0
    buffer_load_dwordx4 v23, s[40:43], s76 offen offset:2048 lds
    s_add_u32 m0, s33, 86016
    s_nop 0
    buffer_load_dwordx4 v23, s[44:47], s76 offen offset:0 lds
    s_add_u32 m0, s33, 90112
    s_mov_b32 s77, 7110656
    buffer_load_dwordx4 v22, s[48:51], s77 offen offset:0 lds
    s_add_u32 m0, s33, 94208
    s_nop 0
    buffer_load_dwordx4 v22, s[52:55], s77 offen offset:0 lds
    s_waitcnt vmcnt(5)
    s_mov_b64 exec, 15
    s_movk_i32 s98, 0x4000
L_pH1_chk:
    v_cmp_ne_u64 vcc, s[100:101], v[14:15]
    s_nop 1
    s_cmp_eq_u64 vcc, 0
    s_cbranch_scc1 L_pH1_ok
    s_sub_u32 s98, s98, 1
    s_cbranch_scc1 L_pH1_ok
    s_sleep 1
    global_load_dwordx2 v[14:15], v13, s[26:27] sc1
    s_waitcnt vmcnt(0)
    s_branch L_pH1_chk
L_pH1_ok:
    s_mov_b64 exec, -1
    s_waitcnt vmcnt(14)
    s_barrier
    s_mov_b32 s40, s34
    s_mov_b32 s42, s35
    s_memrealtime s[44:45]
    s_memtime s[46:47]
    s_lshl4_add_u32 s91, s28, s29
    s_lshl_b32 s91, s91, 7
    s_add_u32 s92, s91, 0x1ea8000
    s_xor_b32 s91, s91, 17408
    s_add_u32 s91, s91, 0x1ea8000
    v_mov_b32 v239, s92
    v_writelane_b32 v239, s91, 1
    s_lshl_b32 m0, s33, 2
    s_nop 0
    buffer_load_dwordx4 v18, s[56:59], s82 offen offset:0 sc1 lds
    buffer_load_dwordx4 v18, s[56:59], s82 offen offset:1024 sc1 lds
    buffer_load_dwordx4 v18, s[56:59], s82 offen offset:2048 sc1 lds
    buffer_load_dwordx4 v18, s[56:59], s82 offen offset:3072 sc1 lds
    s_add_u32 s82, s82, 16384
    s_lshl1_add_u32 m0, s33, 16384
    s_nop 0
    buffer_load_dwordx4 v254, s[60:63], s83 offen lds
    s_lshl1_add_u32 m0, s33, 17408
    s_nop 0
    buffer_load_dwordx4 v255, s[60:63], s83 offen lds
    s_lshl1_add_u32 m0, s33, 24576
    s_nop 0
    buffer_load_dwordx4 v254, s[64:67], s83 offen lds
    s_lshl1_add_u32 m0, s33, 25600
    s_nop 0
    buffer_load_dwordx4 v255, s[64:67], s83 offen lds
    s_add_u32 s83, s83, 131072
    s_lshl_b32 s84, s2, 15
    s_lshl_b32 s85, s4, 13
    s_add_u32 s84, s84, s85
    s_add_u32 s36, s84, 0x1600000
    s_add_u32 s37, s36, 4096
    s_xor_b32 s84, s84, 163840
    s_add_u32 s38, s84, 0x1600000
    s_add_u32 s39, s38, 4096
    v_lshlrev_b32 v4, 4, v1
    s_lshl_b32 s84, s4, 12
    s_add_u32 s84, s84, 147456
    v_lshl_add_u32 v5, v1, 3, s84
    v_lshlrev_b32 v6, 2, v1
    s_waitcnt vmcnt(14)
    s_barrier
    s_lshl2_add_u32 m0, s33, 98304
    s_nop 0
    buffer_load_dwordx4 v18, s[56:59], s82 offen offset:0 sc1 lds
    buffer_load_dwordx4 v18, s[56:59], s82 offen offset:1024 sc1 lds
    buffer_load_dwordx4 v18, s[56:59], s82 offen offset:2048 sc1 lds
    buffer_load_dwordx4 v18, s[56:59], s82 offen offset:3072 sc1 lds
    s_add_u32 s82, s82, 16384
    s_lshl1_add_u32 m0, s33, 114688
    s_nop 0
    buffer_load_dwordx4 v254, s[60:63], s83 offen lds
    s_lshl1_add_u32 m0, s33, 115712
    s_nop 0
    buffer_load_dwordx4 v255, s[60:63], s83 offen lds
    s_lshl1_add_u32 m0, s33, 122880
    s_nop 0
    buffer_load_dwordx4 v254, s[64:67], s83 offen lds
    s_lshl1_add_u32 m0, s33, 123904
    s_nop 0
    buffer_load_dwordx4 v255, s[64:67], s83 offen lds
    s_add_u32 s83, s83, 131072
    s_waitcnt lgkmcnt(0)
    s_sub_u32 s40, s44, s40
    s_sub_u32 s42, s46, s42
    v_cvt_f32_u32 v8, s42
    v_cvt_f32_u32 v9, s40
    v_rcp_f32 v8, v8
    v_mul_f32 v9, 0x463b8000, v9
    v_mul_f32 v8, v8, v9
    v_cvt_u32_f32 v10, v8
    v_add_u32 v10, s44, v10
    v_mov_b32 v8, s100
    v_mov_b32 v9, s101
    s_cmp_eq_u32 s4, 0
    s_cselect_b64 exec, 1, 0
    s_cbranch_execz L_tp
    global_store_dwordx3 v239, v[8:10], s[26:27] sc1
L_tp:
    s_mov_b64 exec, -1
    s_waitcnt vmcnt(8)
    s_barrier
    s_lshl2_add_u32 m0, s33, 32768
    s_nop 0
    buffer_load_dwordx4 v18, s[56:59], s82 offen offset:0 sc1 lds
    buffer_load_dwordx4 v18, s[56:59], s82 offen offset:1024 sc1 lds
    buffer_load_dwordx4 v18, s[56:59], s82 offen offset:2048 sc1 lds
    buffer_load_dwordx4 v18, s[56:59], s82 offen offset:3072 sc1 lds
    s_add_u32 s82, s82, 16384
    s_lshl1_add_u32 m0, s33, 49152
    s_nop 0
    buffer_load_dwordx4 v254, s[60:63], s83 offen lds
    s_lshl1_add_u32 m0, s33, 50176
    s_nop 0
    buffer_load_dwordx4 v255, s[60:63], s83 offen lds
    s_lshl1_add_u32 m0, s33, 57344
    s_nop 0
    buffer_load_dwordx4 v254, s[64:67], s83 offen lds
    s_lshl1_add_u32 m0, s33, 58368
    s_nop 0
    buffer_load_dwordx4 v255, s[64:67], s83 offen lds
    s_add_u32 s83, s83, 131072
    ds_read_b64_tr_b16 v[40:41], v250 offset:16384
    ds_read_b64_tr_b16 v[42:43], v250 offset:16896
    ds_read_b128 v[24:27], v248 offset:0
    ds_read_b128 v[28:31], v248 offset:1024
    ds_read_b128 v[32:35], v248 offset:2048
    ds_read_b128 v[36:39], v248 offset:3072
    ds_read_b64_tr_b16 v[44:45], v251 offset:16384
    ds_read_b64_tr_b16 v[46:47], v251 offset:16896
    ds_read_b64_tr_b16 v[48:49], v250 offset:24576
    ds_read_b64_tr_b16 v[50:51], v250 offset:25088
    ds_read_b64_tr_b16 v[52:53], v251 offset:24576
    ds_read_b64_tr_b16 v[54:55], v251 offset:25088
    s_barrier
    s_setprio 1
    s_lshl2_add_u32 m0, s33, 65536
    s_nop 0
    buffer_load_dwordx4 v18, s[56:59], s82 offen offset:0 sc1 lds
    buffer_load_dwordx4 v18, s[56:59], s82 offen offset:1024 sc1 lds
    buffer_load_dwordx4 v18, s[56:59], s82 offen offset:2048 sc1 lds
    buffer_load_dwordx4 v18, s[56:59], s82 offen offset:3072 sc1 lds
    s_add_u32 s82, s82, 16384
    s_waitcnt lgkmcnt(9)
    v_mfma_f32_16x16x32_bf16 v[88:91], v[40:43], v[24:27], 0
    ds_read_b64_tr_b16 v[72:73], v250 offset:20480
    ds_read_b64_tr_b16 v[74:75], v250 offset:20992
    s_waitcnt lgkmcnt(10)
    v_mfma_f32_16x16x32_bf16 v[92:95], v[40:43], v[28:31], 0
    ds_read_b128 v[56:59], v248 offset:8192
    s_lshl1_add_u32 m0, s33, 81920
    s_waitcnt lgkmcnt(10)
    v_mfma_f32_16x16x32_bf16 v[96:99], v[40:43], v[32:35], 0
    ds_read_b128 v[60:63], v248 offset:9216
    ds_read_b128 v[64:67], v248 offset:10240
    s_waitcnt lgkmcnt(11)
    v_mfma_f32_16x16x32_bf16 v[100:103], v[40:43], v[36:39], 0
    ds_read_b128 v[68:71], v248 offset:11264
    buffer_load_dwordx4 v254, s[60:63], s83 offen lds
    s_waitcnt lgkmcnt(10)
    v_mfma_f32_16x16x32_bf16 v[104:107], v[44:47], v[24:27], 0
    ds_read_b64_tr_b16 v[76:77], v251 offset:20480
    ds_read_b64_tr_b16 v[78:79], v251 offset:20992
    v_mfma_f32_16x16x32_bf16 v[108:111], v[44:47], v[28:31], 0
    ds_read_b64_tr_b16 v[80:81], v250 offset:28672
    s_lshl1_add_u32 m0, s33, 82944
    v_mfma_f32_16x16x32_bf16 v[112:115], v[44:47], v[32:35], 0
    ds_read_b64_tr_b16 v[82:83], v250 offset:29184
    ds_read_b64_tr_b16 v[84:85], v251 offset:28672
    v_mfma_f32_16x16x32_bf16 v[116:119], v[44:47], v[36:39], 0
    ds_read_b64_tr_b16 v[86:87], v251 offset:29184
    buffer_load_dwordx4 v255, s[60:63], s83 offen lds
    s_waitcnt lgkmcnt(14)
    v_mfma_f32_16x16x32_bf16 v[120:123], v[48:51], v[24:27], 0
    v_mfma_f32_16x16x32_bf16 v[124:127], v[48:51], v[28:31], 0
    s_lshl1_add_u32 m0, s33, 90112
    v_mfma_f32_16x16x32_bf16 v[128:131], v[48:51], v[32:35], 0
    v_mfma_f32_16x16x32_bf16 v[132:135], v[48:51], v[36:39], 0
    buffer_load_dwordx4 v254, s[64:67], s83 offen lds
    s_waitcnt lgkmcnt(12)
    v_mfma_f32_16x16x32_bf16 v[136:139], v[52:55], v[24:27], 0
    v_mfma_f32_16x16x32_bf16 v[140:143], v[52:55], v[28:31], 0
    s_lshl1_add_u32 m0, s33, 91136
    v_mfma_f32_16x16x32_bf16 v[144:147], v[52:55], v[32:35], 0
    v_mfma_f32_16x16x32_bf16 v[148:151], v[52:55], v[36:39], 0
    buffer_load_dwordx4 v255, s[64:67], s83 offen lds
    s_add_u32 s83, s83, 131072
    s_waitcnt vmcnt(16) lgkmcnt(0)
    s_barrier
    v_mfma_f32_16x16x32_bf16 v[88:91], v[72:75], v[56:59], v[88:91]
    ds_read_b64_tr_b16 v[40:41], v252 offset:49152
    ds_read_b64_tr_b16 v[42:43], v252 offset:49664
    v_mfma_f32_16x16x32_bf16 v[92:95], v[72:75], v[60:63], v[92:95]
    ds_read_b128 v[24:27], v249 offset:32768
    s_lshl_b32 m0, s33, 2
    v_mfma_f32_16x16x32_bf16 v[96:99], v[72:75], v[64:67], v[96:99]
    ds_read_b128 v[28:31], v249 offset:33792
    v_mfma_f32_16x16x32_bf16 v[100:103], v[72:75], v[68:71], v[100:103]
    ds_read_b128 v[32:35], v249 offset:34816
    buffer_load_dwordx4 v18, s[56:59], s82 offen offset:0 sc1 lds
    v_mfma_f32_16x16x32_bf16 v[104:107], v[76:79], v[56:59], v[104:107]
    ds_read_b128 v[36:39], v249 offset:35840
    v_mfma_f32_16x16x32_bf16 v[108:111], v[76:79], v[60:63], v[108:111]
    ds_read_b64_tr_b16 v[44:45], v253 offset:49152
    ds_read_b64_tr_b16 v[46:47], v253 offset:49664
    v_mfma_f32_16x16x32_bf16 v[112:115], v[76:79], v[64:67], v[112:115]
    ds_read_b64_tr_b16 v[48:49], v252 offset:57344
    v_mfma_f32_16x16x32_bf16 v[116:119], v[76:79], v[68:71], v[116:119]
    ds_read_b64_tr_b16 v[50:51], v252 offset:57856
    buffer_load_dwordx4 v18, s[56:59], s82 offen offset:1024 sc1 lds
    v_mfma_f32_16x16x32_bf16 v[120:123], v[80:83], v[56:59], v[120:123]
    ds_read_b64_tr_b16 v[52:53], v253 offset:57344
    v_mfma_f32_16x16x32_bf16 v[124:127], v[80:83], v[60:63], v[124:127]
    ds_read_b64_tr_b16 v[54:55], v253 offset:57856
    v_mfma_f32_16x16x32_bf16 v[128:131], v[80:83], v[64:67], v[128:131]
    v_mfma_f32_16x16x32_bf16 v[132:135], v[80:83], v[68:71], v[132:135]
    buffer_load_dwordx4 v18, s[56:59], s82 offen offset:2048 sc1 lds
    v_mfma_f32_16x16x32_bf16 v[136:139], v[84:87], v[56:59], v[136:139]
    v_mfma_f32_16x16x32_bf16 v[140:143], v[84:87], v[60:63], v[140:143]
    v_mfma_f32_16x16x32_bf16 v[144:147], v[84:87], v[64:67], v[144:147]
    v_mfma_f32_16x16x32_bf16 v[148:151], v[84:87], v[68:71], v[148:151]
    buffer_load_dwordx4 v18, s[56:59], s82 offen offset:3072 sc1 lds
    s_add_u32 s82, s82, 16384
    s_waitcnt lgkmcnt(9)
    v_mfma_f32_16x16x32_bf16 v[88:91], v[40:43], v[24:27], v[88:91]
    ds_read_b64_tr_b16 v[72:73], v252 offset:53248
    ds_read_b64_tr_b16 v[74:75], v252 offset:53760
    s_waitcnt lgkmcnt(10)
    v_mfma_f32_16x16x32_bf16 v[92:95], v[40:43], v[28:31], v[92:95]
    ds_read_b128 v[56:59], v249 offset:40960
    s_lshl1_add_u32 m0, s33, 16384
    s_waitcnt lgkmcnt(10)
    v_mfma_f32_16x16x32_bf16 v[96:99], v[40:43], v[32:35], v[96:99]
    ds_read_b128 v[60:63], v249 offset:41984
    ds_read_b128 v[64:67], v249 offset:43008
    s_waitcnt lgkmcnt(11)
    v_mfma_f32_16x16x32_bf16 v[100:103], v[40:43], v[36:39], v[100:103]
    ds_read_b128 v[68:71], v249 offset:44032
    buffer_load_dwordx4 v254, s[60:63], s83 offen lds
    s_waitcnt lgkmcnt(10)
    v_mfma_f32_16x16x32_bf16 v[104:107], v[44:47], v[24:27], v[104:107]
    ds_read_b64_tr_b16 v[76:77], v253 offset:53248
    ds_read_b64_tr_b16 v[78:79], v253 offset:53760
    v_mfma_f32_16x16x32_bf16 v[108:111], v[44:47], v[28:31], v[108:111]
    ds_read_b64_tr_b16 v[80:81], v252 offset:61440
    s_lshl1_add_u32 m0, s33, 17408
    v_mfma_f32_16x16x32_bf16 v[112:115], v[44:47], v[32:35], v[112:115]
    ds_read_b64_tr_b16 v[82:83], v252 offset:61952
    ds_read_b64_tr_b16 v[84:85], v253 offset:61440
    v_mfma_f32_16x16x32_bf16 v[116:119], v[44:47], v[36:39], v[116:119]
    ds_read_b64_tr_b16 v[86:87], v253 offset:61952
    buffer_load_dwordx4 v255, s[60:63], s83 offen lds
    s_waitcnt lgkmcnt(14)
    v_mfma_f32_16x16x32_bf16 v[120:123], v[48:51], v[24:27], v[120:123]
    v_mfma_f32_16x16x32_bf16 v[124:127], v[48:51], v[28:31], v[124:127]
    s_lshl1_add_u32 m0, s33, 24576
    v_mfma_f32_16x16x32_bf16 v[128:131], v[48:51], v[32:35], v[128:131]
    v_mfma_f32_16x16x32_bf16 v[132:135], v[48:51], v[36:39], v[132:135]
    buffer_load_dwordx4 v254, s[64:67], s83 offen lds
    s_waitcnt lgkmcnt(12)
    v_mfma_f32_16x16x32_bf16 v[136:139], v[52:55], v[24:27], v[136:139]
    v_mfma_f32_16x16x32_bf16 v[140:143], v[52:55], v[28:31], v[140:143]
    s_lshl1_add_u32 m0, s33, 25600
    v_mfma_f32_16x16x32_bf16 v[144:147], v[52:55], v[32:35], v[144:147]
    v_mfma_f32_16x16x32_bf16 v[148:151], v[52:55], v[36:39], v[148:151]
    buffer_load_dwordx4 v255, s[64:67], s83 offen lds
    s_add_u32 s83, s83, 131072
    s_waitcnt vmcnt(16) lgkmcnt(0)
    s_barrier
    v_mfma_f32_16x16x32_bf16 v[88:91], v[72:75], v[56:59], v[88:91]
    ds_read_b64_tr_b16 v[40:41], v250 offset:49152
    ds_read_b64_tr_b16 v[42:43], v250 offset:49664
    v_mfma_f32_16x16x32_bf16 v[92:95], v[72:75], v[60:63], v[92:95]
    ds_read_b128 v[24:27], v248 offset:32768
    s_lshl2_add_u32 m0, s33, 98304
    v_mfma_f32_16x16x32_bf16 v[96:99], v[72:75], v[64:67], v[96:99]
    ds_read_b128 v[28:31], v248 offset:33792
    v_mfma_f32_16x16x32_bf16 v[100:103], v[72:75], v[68:71], v[100:103]
    ds_read_b128 v[32:35], v248 offset:34816
    buffer_load_dwordx4 v18, s[56:59], s82 offen offset:0 sc1 lds
    v_mfma_f32_16x16x32_bf16 v[104:107], v[76:79], v[56:59], v[104:107]
    ds_read_b128 v[36:39], v248 offset:35840
    v_mfma_f32_16x16x32_bf16 v[108:111], v[76:79], v[60:63], v[108:111]
    ds_read_b64_tr_b16 v[44:45], v251 offset:49152
    ds_read_b64_tr_b16 v[46:47], v251 offset:49664
    v_mfma_f32_16x16x32_bf16 v[112:115], v[76:79], v[64:67], v[112:115]
    ds_read_b64_tr_b16 v[48:49], v250 offset:57344
    v_mfma_f32_16x16x32_bf16 v[116:119], v[76:79], v[68:71], v[116:119]
    ds_read_b64_tr_b16 v[50:51], v250 offset:57856
    buffer_load_dwordx4 v18, s[56:59], s82 offen offset:1024 sc1 lds
    v_mfma_f32_16x16x32_bf16 v[120:123], v[80:83], v[56:59], v[120:123]
    ds_read_b64_tr_b16 v[52:53], v251 offset:57344
    v_mfma_f32_16x16x32_bf16 v[124:127], v[80:83], v[60:63], v[124:127]
    ds_read_b64_tr_b16 v[54:55], v251 offset:57856
    v_mfma_f32_16x16x32_bf16 v[128:131], v[80:83], v[64:67], v[128:131]
    v_mfma_f32_16x16x32_bf16 v[132:135], v[80:83], v[68:71], v[132:135]
    buffer_load_dwordx4 v18, s[56:59], s82 offen offset:2048 sc1 lds
    v_mfma_f32_16x16x32_bf16 v[136:139], v[84:87], v[56:59], v[136:139]
    v_mfma_f32_16x16x32_bf16 v[140:143], v[84:87], v[60:63], v[140:143]
    v_mfma_f32_16x16x32_bf16 v[144:147], v[84:87], v[64:67], v[144:147]
    v_mfma_f32_16x16x32_bf16 v[148:151], v[84:87], v[68:71], v[148:151]
    buffer_load_dwordx4 v18, s[56:59], s82 offen offset:3072 sc1 lds
    s_add_u32 s82, s82, 16384
    s_waitcnt lgkmcnt(9)
    v_mfma_f32_16x16x32_bf16 v[88:91], v[40:43], v[24:27], v[88:91]
    ds_read_b64_tr_b16 v[72:73], v250 offset:53248
    ds_read_b64_tr_b16 v[74:75], v250 offset:53760
    s_waitcnt lgkmcnt(10)
    v_mfma_f32_16x16x32_bf16 v[92:95], v[40:43], v[28:31], v[92:95]
    ds_read_b128 v[56:59], v248 offset:40960
    s_lshl1_add_u32 m0, s33, 114688
    s_waitcnt lgkmcnt(10)
    v_mfma_f32_16x16x32_bf16 v[96:99], v[40:43], v[32:35], v[96:99]
    ds_read_b128 v[60:63], v248 offset:41984
    ds_read_b128 v[64:67], v248 offset:43008
    s_waitcnt lgkmcnt(11)
    v_mfma_f32_16x16x32_bf16 v[100:103], v[40:43], v[36:39], v[100:103]
    ds_read_b128 v[68:71], v248 offset:44032
    buffer_load_dwordx4 v254, s[60:63], s83 offen lds
    s_waitcnt lgkmcnt(10)
    v_mfma_f32_16x16x32_bf16 v[104:107], v[44:47], v[24:27], v[104:107]
    ds_read_b64_tr_b16 v[76:77], v251 offset:53248
    ds_read_b64_tr_b16 v[78:79], v251 offset:53760
    v_mfma_f32_16x16x32_bf16 v[108:111], v[44:47], v[28:31], v[108:111]
    ds_read_b64_tr_b16 v[80:81], v250 offset:61440
    s_lshl1_add_u32 m0, s33, 115712
    v_mfma_f32_16x16x32_bf16 v[112:115], v[44:47], v[32:35], v[112:115]
    ds_read_b64_tr_b16 v[82:83], v250 offset:61952
    ds_read_b64_tr_b16 v[84:85], v251 offset:61440
    v_mfma_f32_16x16x32_bf16 v[116:119], v[44:47], v[36:39], v[116:119]
    ds_read_b64_tr_b16 v[86:87], v251 offset:61952
    buffer_load_dwordx4 v255, s[60:63], s83 offen lds
    s_waitcnt lgkmcnt(14)
    v_mfma_f32_16x16x32_bf16 v[120:123], v[48:51], v[24:27], v[120:123]
    v_mfma_f32_16x16x32_bf16 v[124:127], v[48:51], v[28:31], v[124:127]
    s_lshl1_add_u32 m0, s33, 122880
    v_mfma_f32_16x16x32_bf16 v[128:131], v[48:51], v[32:35], v[128:131]
    v_mfma_f32_16x16x32_bf16 v[132:135], v[48:51], v[36:39], v[132:135]
    buffer_load_dwordx4 v254, s[64:67], s83 offen lds
    s_waitcnt lgkmcnt(12)
    v_mfma_f32_16x16x32_bf16 v[136:139], v[52:55], v[24:27], v[136:139]
    v_mfma_f32_16x16x32_bf16 v[140:143], v[52:55], v[28:31], v[140:143]
    s_lshl1_add_u32 m0, s33, 123904
    v_mfma_f32_16x16x32_bf16 v[144:147], v[52:55], v[32:35], v[144:147]
    v_mfma_f32_16x16x32_bf16 v[148:151], v[52:55], v[36:39], v[148:151]
    buffer_load_dwordx4 v255, s[64:67], s83 offen lds
    s_add_u32 s83, s83, 131072
    s_waitcnt vmcnt(16) lgkmcnt(0)
    s_barrier
    v_mfma_f32_16x16x32_bf16 v[88:91], v[72:75], v[56:59], v[88:91]
    ds_read_b64_tr_b16 v[40:41], v252 offset:16384
    ds_read_b64_tr_b16 v[42:43], v252 offset:16896
    v_mfma_f32_16x16x32_bf16 v[92:95], v[72:75], v[60:63], v[92:95]
    ds_read_b128 v[24:27], v249 offset:0
    s_lshl2_add_u32 m0, s33, 32768
    v_mfma_f32_16x16x32_bf16 v[96:99], v[72:75], v[64:67], v[96:99]
    ds_read_b128 v[28:31], v249 offset:1024
    v_mfma_f32_16x16x32_bf16 v[100:103], v[72:75], v[68:71], v[100:103]
    ds_read_b128 v[32:35], v249 offset:2048
    buffer_load_dwordx4 v18, s[56:59], s82 offen offset:0 sc1 lds
    v_mfma_f32_16x16x32_bf16 v[104:107], v[76:79], v[56:59], v[104:107]
    ds_read_b128 v[36:39], v249 offset:3072
    v_mfma_f32_16x16x32_bf16 v[108:111], v[76:79], v[60:63], v[108:111]
    ds_read_b64_tr_b16 v[44:45], v253 offset:16384
    ds_read_b64_tr_b16 v[46:47], v253 offset:16896
    v_mfma_f32_16x16x32_bf16 v[112:115], v[76:79], v[64:67], v[112:115]
    ds_read_b64_tr_b16 v[48:49], v252 offset:24576
    v_mfma_f32_16x16x32_bf16 v[116:119], v[76:79], v[68:71], v[116:119]
    ds_read_b64_tr_b16 v[50:51], v252 offset:25088
    buffer_load_dwordx4 v18, s[56:59], s82 offen offset:1024 sc1 lds
    v_mfma_f32_16x16x32_bf16 v[120:123], v[80:83], v[56:59], v[120:123]
    ds_read_b64_tr_b16 v[52:53], v253 offset:24576
    v_mfma_f32_16x16x32_bf16 v[124:127], v[80:83], v[60:63], v[124:127]
    ds_read_b64_tr_b16 v[54:55], v253 offset:25088
    v_mfma_f32_16x16x32_bf16 v[128:131], v[80:83], v[64:67], v[128:131]
    v_mfma_f32_16x16x32_bf16 v[132:135], v[80:83], v[68:71], v[132:135]
    buffer_load_dwordx4 v18, s[56:59], s82 offen offset:2048 sc1 lds
    v_mfma_f32_16x16x32_bf16 v[136:139], v[84:87], v[56:59], v[136:139]
    v_mfma_f32_16x16x32_bf16 v[140:143], v[84:87], v[60:63], v[140:143]
    v_mfma_f32_16x16x32_bf16 v[144:147], v[84:87], v[64:67], v[144:147]
    v_mfma_f32_16x16x32_bf16 v[148:151], v[84:87], v[68:71], v[148:151]
    buffer_load_dwordx4 v18, s[56:59], s82 offen offset:3072 sc1 lds
    s_add_u32 s82, s82, 16384
    s_waitcnt lgkmcnt(9)
    v_mfma_f32_16x16x32_bf16 v[88:91], v[40:43], v[24:27], v[88:91]
    ds_read_b64_tr_b16 v[72:73], v252 offset:20480
    ds_read_b64_tr_b16 v[74:75], v252 offset:20992
    s_waitcnt lgkmcnt(10)
    v_mfma_f32_16x16x32_bf16 v[92:95], v[40:43], v[28:31], v[92:95]
    ds_read_b128 v[56:59], v249 offset:8192
    s_lshl1_add_u32 m0, s33, 49152
    s_waitcnt lgkmcnt(10)
    v_mfma_f32_16x16x32_bf16 v[96:99], v[40:43], v[32:35], v[96:99]
    ds_read_b128 v[60:63], v249 offset:9216
    ds_read_b128 v[64:67], v249 offset:10240
    s_waitcnt lgkmcnt(11)
    v_mfma_f32_16x16x32_bf16 v[100:103], v[40:43], v[36:39], v[100:103]
    ds_read_b128 v[68:71], v249 offset:11264
    buffer_load_dwordx4 v254, s[60:63], s83 offen lds
    s_waitcnt lgkmcnt(10)
    v_mfma_f32_16x16x32_bf16 v[104:107], v[44:47], v[24:27], v[104:107]
    ds_read_b64_tr_b16 v[76:77], v253 offset:20480
    ds_read_b64_tr_b16 v[78:79], v253 offset:20992
    v_mfma_f32_16x16x32_bf16 v[108:111], v[44:47], v[28:31], v[108:111]
    ds_read_b64_tr_b16 v[80:81], v252 offset:28672
    s_lshl1_add_u32 m0, s33, 50176
    v_mfma_f32_16x16x32_bf16 v[112:115], v[44:47], v[32:35], v[112:115]
    ds_read_b64_tr_b16 v[82:83], v252 offset:29184
    ds_read_b64_tr_b16 v[84:85], v253 offset:28672
    v_mfma_f32_16x16x32_bf16 v[116:119], v[44:47], v[36:39], v[116:119]
    ds_read_b64_tr_b16 v[86:87], v253 offset:29184
    buffer_load_dwordx4 v255, s[60:63], s83 offen lds
    s_waitcnt lgkmcnt(14)
    v_mfma_f32_16x16x32_bf16 v[120:123], v[48:51], v[24:27], v[120:123]
    v_mfma_f32_16x16x32_bf16 v[124:127], v[48:51], v[28:31], v[124:127]
    s_lshl1_add_u32 m0, s33, 57344
    v_mfma_f32_16x16x32_bf16 v[128:131], v[48:51], v[32:35], v[128:131]
    v_mfma_f32_16x16x32_bf16 v[132:135], v[48:51], v[36:39], v[132:135]
    buffer_load_dwordx4 v254, s[64:67], s83 offen lds
    s_waitcnt lgkmcnt(12)
    v_mfma_f32_16x16x32_bf16 v[136:139], v[52:55], v[24:27], v[136:139]
    v_mfma_f32_16x16x32_bf16 v[140:143], v[52:55], v[28:31], v[140:143]
    s_lshl1_add_u32 m0, s33, 58368
    v_mfma_f32_16x16x32_bf16 v[144:147], v[52:55], v[32:35], v[144:147]
    v_mfma_f32_16x16x32_bf16 v[148:151], v[52:55], v[36:39], v[148:151]
    buffer_load_dwordx4 v255, s[64:67], s83 offen lds
    s_add_u32 s83, s83, 131072
    s_waitcnt vmcnt(16) lgkmcnt(0)
    s_barrier
    v_mfma_f32_16x16x32_bf16 v[88:91], v[72:75], v[56:59], v[88:91]
    ds_read_b64_tr_b16 v[40:41], v250 offset:16384
    ds_read_b64_tr_b16 v[42:43], v250 offset:16896
    v_mfma_f32_16x16x32_bf16 v[92:95], v[72:75], v[60:63], v[92:95]
    ds_read_b128 v[24:27], v248 offset:0
    s_lshl2_add_u32 m0, s33, 65536
    v_mfma_f32_16x16x32_bf16 v[96:99], v[72:75], v[64:67], v[96:99]
    ds_read_b128 v[28:31], v248 offset:1024
    v_mfma_f32_16x16x32_bf16 v[100:103], v[72:75], v[68:71], v[100:103]
    ds_read_b128 v[32:35], v248 offset:2048
    buffer_load_dwordx4 v18, s[56:59], s82 offen offset:0 sc1 lds
    v_mfma_f32_16x16x32_bf16 v[104:107], v[76:79], v[56:59], v[104:107]
    ds_read_b128 v[36:39], v248 offset:3072
    v_mfma_f32_16x16x32_bf16 v[108:111], v[76:79], v[60:63], v[108:111]
    ds_read_b64_tr_b16 v[44:45], v251 offset:16384
    ds_read_b64_tr_b16 v[46:47], v251 offset:16896
    v_mfma_f32_16x16x32_bf16 v[112:115], v[76:79], v[64:67], v[112:115]
    ds_read_b64_tr_b16 v[48:49], v250 offset:24576
    v_mfma_f32_16x16x32_bf16 v[116:119], v[76:79], v[68:71], v[116:119]
    ds_read_b64_tr_b16 v[50:51], v250 offset:25088
    buffer_load_dwordx4 v18, s[56:59], s82 offen offset:1024 sc1 lds
    v_mfma_f32_16x16x32_bf16 v[120:123], v[80:83], v[56:59], v[120:123]
    ds_read_b64_tr_b16 v[52:53], v251 offset:24576
    v_mfma_f32_16x16x32_bf16 v[124:127], v[80:83], v[60:63], v[124:127]
    ds_read_b64_tr_b16 v[54:55], v251 offset:25088
    v_mfma_f32_16x16x32_bf16 v[128:131], v[80:83], v[64:67], v[128:131]
    v_mfma_f32_16x16x32_bf16 v[132:135], v[80:83], v[68:71], v[132:135]
    buffer_load_dwordx4 v18, s[56:59], s82 offen offset:2048 sc1 lds
    v_mfma_f32_16x16x32_bf16 v[136:139], v[84:87], v[56:59], v[136:139]
    v_mfma_f32_16x16x32_bf16 v[140:143], v[84:87], v[60:63], v[140:143]
    v_mfma_f32_16x16x32_bf16 v[144:147], v[84:87], v[64:67], v[144:147]
    v_mfma_f32_16x16x32_bf16 v[148:151], v[84:87], v[68:71], v[148:151]
    buffer_load_dwordx4 v18, s[56:59], s82 offen offset:3072 sc1 lds
    s_add_u32 s82, s82, 16384
    s_waitcnt lgkmcnt(9)
    v_mfma_f32_16x16x32_bf16 v[88:91], v[40:43], v[24:27], v[88:91]
    ds_read_b64_tr_b16 v[72:73], v250 offset:20480
    ds_read_b64_tr_b16 v[74:75], v250 offset:20992
    s_waitcnt lgkmcnt(10)
    v_mfma_f32_16x16x32_bf16 v[92:95], v[40:43], v[28:31], v[92:95]
    ds_read_b128 v[56:59], v248 offset:8192
    s_lshl1_add_u32 m0, s33, 81920
    s_waitcnt lgkmcnt(10)
    v_mfma_f32_16x16x32_bf16 v[96:99], v[40:43], v[32:35], v[96:99]
    ds_read_b128 v[60:63], v248 offset:9216
    ds_read_b128 v[64:67], v248 offset:10240
    s_waitcnt lgkmcnt(11)
    v_mfma_f32_16x16x32_bf16 v[100:103], v[40:43], v[36:39], v[100:103]
    ds_read_b128 v[68:71], v248 offset:11264
    buffer_load_dwordx4 v254, s[60:63], s83 offen lds
L_pad4:
    s_cbranch_execz L_vret2
    s_waitcnt lgkmcnt(10)
    v_mfma_f32_16x16x32_bf16 v[104:107], v[44:47], v[24:27], v[104:107]
    ds_read_b64_tr_b16 v[76:77], v251 offset:20480
    ds_read_b64_tr_b16 v[78:79], v251 offset:20992
    v_mfma_f32_16x16x32_bf16 v[108:111], v[44:47], v[28:31], v[108:111]
    ds_read_b64_tr_b16 v[80:81], v250 offset:28672
    s_lshl1_add_u32 m0, s33, 82944
    v_mfma_f32_16x16x32_bf16 v[112:115], v[44:47], v[32:35], v[112:115]
    ds_read_b64_tr_b16 v[82:83], v250 offset:29184
    ds_read_b64_tr_b16 v[84:85], v251 offset:28672
    v_mfma_f32_16x16x32_bf16 v[116:119], v[44:47], v[36:39], v[116:119]
    ds_read_b64_tr_b16 v[86:87], v251 offset:29184
    buffer_load_dwordx4 v255, s[60:63], s83 offen lds
    s_waitcnt lgkmcnt(14)
    v_mfma_f32_16x16x32_bf16 v[120:123], v[48:51], v[24:27], v[120:123]
    v_mfma_f32_16x16x32_bf16 v[124:127], v[48:51], v[28:31], v[124:127]
    s_lshl1_add_u32 m0, s33, 90112
    v_mfma_f32_16x16x32_bf16 v[128:131], v[48:51], v[32:35], v[128:131]
    v_mfma_f32_16x16x32_bf16 v[132:135], v[48:51], v[36:39], v[132:135]
    buffer_load_dwordx4 v254, s[64:67], s83 offen lds
    s_waitcnt lgkmcnt(12)
    v_mfma_f32_16x16x32_bf16 v[136:139], v[52:55], v[24:27], v[136:139]
    v_mfma_f32_16x16x32_bf16 v[140:143], v[52:55], v[28:31], v[140:143]
    s_lshl1_add_u32 m0, s33, 91136
    v_mfma_f32_16x16x32_bf16 v[144:147], v[52:55], v[32:35], v[144:147]
    v_mfma_f32_16x16x32_bf16 v[148:151], v[52:55], v[36:39], v[148:151]
    buffer_load_dwordx4 v255, s[64:67], s83 offen lds
    s_add_u32 s83, s83, 131072
    s_waitcnt vmcnt(16) lgkmcnt(0)
    s_barrier
    v_mfma_f32_16x16x32_bf16 v[88:91], v[72:75], v[56:59], v[88:91]
    ds_read_b64_tr_b16 v[40:41], v252 offset:49152
    ds_read_b64_tr_b16 v[42:43], v252 offset:49664
    v_mfma_f32_16x16x32_bf16 v[92:95], v[72:75], v[60:63], v[92:95]
    ds_read_b128 v[24:27], v249 offset:32768
    s_lshl_b32 m0, s33, 2
    v_mfma_f32_16x16x32_bf16 v[96:99], v[72:75], v[64:67], v[96:99]
    ds_read_b128 v[28:31], v249 offset:33792
    v_mfma_f32_16x16x32_bf16 v[100:103], v[72:75], v[68:71], v[100:103]
    ds_read_b128 v[32:35], v249 offset:34816
    buffer_load_dwordx4 v18, s[56:59], s82 offen offset:0 sc1 lds
    v_mfma_f32_16x16x32_bf16 v[104:107], v[76:79], v[56:59], v[104:107]
    ds_read_b128 v[36:39], v249 offset:35840
    v_mfma_f32_16x16x32_bf16 v[108:111], v[76:79], v[60:63], v[108:111]
    ds_read_b64_tr_b16 v[44:45], v253 offset:49152
    ds_read_b64_tr_b16 v[46:47], v253 offset:49664
    v_mfma_f32_16x16x32_bf16 v[112:115], v[76:79], v[64:67], v[112:115]
    ds_read_b64_tr_b16 v[48:49], v252 offset:57344
    v_mfma_f32_16x16x32_bf16 v[116:119], v[76:79], v[68:71], v[116:119]
    ds_read_b64_tr_b16 v[50:51], v252 offset:57856
    buffer_load_dwordx4 v18, s[56:59], s82 offen offset:1024 sc1 lds
    v_mfma_f32_16x16x32_bf16 v[120:123], v[80:83], v[56:59], v[120:123]
    ds_read_b64_tr_b16 v[52:53], v253 offset:57344
    v_mfma_f32_16x16x32_bf16 v[124:127], v[80:83], v[60:63], v[124:127]
    ds_read_b64_tr_b16 v[54:55], v253 offset:57856
    v_mfma_f32_16x16x32_bf16 v[128:131], v[80:83], v[64:67], v[128:131]
    v_mfma_f32_16x16x32_bf16 v[132:135], v[80:83], v[68:71], v[132:135]
    buffer_load_dwordx4 v18, s[56:59], s82 offen offset:2048 sc1 lds
    v_mfma_f32_16x16x32_bf16 v[136:139], v[84:87], v[56:59], v[136:139]
    v_mfma_f32_16x16x32_bf16 v[140:143], v[84:87], v[60:63], v[140:143]
    v_mfma_f32_16x16x32_bf16 v[144:147], v[84:87], v[64:67], v[144:147]
    v_mfma_f32_16x16x32_bf16 v[148:151], v[84:87], v[68:71], v[148:151]
    buffer_load_dwordx4 v18, s[56:59], s82 offen offset:3072 sc1 lds
    s_add_u32 s82, s82, 16384
    s_waitcnt lgkmcnt(9)
    v_mfma_f32_16x16x32_bf16 v[88:91], v[40:43], v[24:27], v[88:91]
    ds_read_b64_tr_b16 v[72:73], v252 offset:53248
    ds_read_b64_tr_b16 v[74:75], v252 offset:53760
    s_waitcnt lgkmcnt(10)
    v_mfma_f32_16x16x32_bf16 v[92:95], v[40:43], v[28:31], v[92:95]
    ds_read_b128 v[56:59], v249 offset:40960
    s_lshl1_add_u32 m0, s33, 16384
    s_waitcnt lgkmcnt(10)
    v_mfma_f32_16x16x32_bf16 v[96:99], v[40:43], v[32:35], v[96:99]
    ds_read_b128 v[60:63], v249 offset:41984
    ds_read_b128 v[64:67], v249 offset:43008
    s_waitcnt lgkmcnt(11)
    v_mfma_f32_16x16x32_bf16 v[100:103], v[40:43], v[36:39], v[100:103]
    ds_read_b128 v[68:71], v249 offset:44032
    buffer_load_dwordx4 v254, s[60:63], s83 offen lds
    s_waitcnt lgkmcnt(10)
    v_mfma_f32_16x16x32_bf16 v[104:107], v[44:47], v[24:27], v[104:107]
    ds_read_b64_tr_b16 v[76:77], v253 offset:53248
    ds_read_b64_tr_b16 v[78:79], v253 offset:53760
    v_mfma_f32_16x16x32_bf16 v[108:111], v[44:47], v[28:31], v[108:111]
    ds_read_b64_tr_b16 v[80:81], v252 offset:61440
    s_lshl1_add_u32 m0, s33, 17408
    v_mfma_f32_16x16x32_bf16 v[112:115], v[44:47], v[32:35], v[112:115]
    ds_read_b64_tr_b16 v[82:83], v252 offset:61952
    ds_read_b64_tr_b16 v[84:85], v253 offset:61440
    v_mfma_f32_16x16x32_bf16 v[116:119], v[44:47], v[36:39], v[116:119]
    ds_read_b64_tr_b16 v[86:87], v253 offset:61952
    buffer_load_dwordx4 v255, s[60:63], s83 offen lds
    s_waitcnt lgkmcnt(14)
    v_mfma_f32_16x16x32_bf16 v[120:123], v[48:51], v[24:27], v[120:123]
    v_mfma_f32_16x16x32_bf16 v[124:127], v[48:51], v[28:31], v[124:127]
    s_lshl1_add_u32 m0, s33, 24576
    v_mfma_f32_16x16x32_bf16 v[128:131], v[48:51], v[32:35], v[128:131]
    v_mfma_f32_16x16x32_bf16 v[132:135], v[48:51], v[36:39], v[132:135]
    buffer_load_dwordx4 v254, s[64:67], s83 offen lds
    s_waitcnt lgkmcnt(12)
    v_mfma_f32_16x16x32_bf16 v[136:139], v[52:55], v[24:27], v[136:139]
    v_mfma_f32_16x16x32_bf16 v[140:143], v[52:55], v[28:31], v[140:143]
    s_lshl1_add_u32 m0, s33, 25600
    v_mfma_f32_16x16x32_bf16 v[144:147], v[52:55], v[32:35], v[144:147]
    v_mfma_f32_16x16x32_bf16 v[148:151], v[52:55], v[36:39], v[148:151]
    buffer_load_dwordx4 v255, s[64:67], s83 offen lds
    s_add_u32 s83, s83, 131072
    s_waitcnt vmcnt(16) lgkmcnt(0)
    s_barrier
    v_mfma_f32_16x16x32_bf16 v[88:91], v[72:75], v[56:59], v[88:91]
    ds_read_b64_tr_b16 v[40:41], v250 offset:49152
    ds_read_b64_tr_b16 v[42:43], v250 offset:49664
    v_mfma_f32_16x16x32_bf16 v[92:95], v[72:75], v[60:63], v[92:95]
    ds_read_b128 v[24:27], v248 offset:32768
    s_lshl2_add_u32 m0, s33, 98304
    v_mfma_f32_16x16x32_bf16 v[96:99], v[72:75], v[64:67], v[96:99]
    ds_read_b128 v[28:31], v248 offset:33792
    v_mfma_f32_16x16x32_bf16 v[100:103], v[72:75], v[68:71], v[100:103]
    ds_read_b128 v[32:35], v248 offset:34816
    buffer_load_dwordx4 v18, s[56:59], s82 offen offset:0 sc1 lds
    v_mfma_f32_16x16x32_bf16 v[104:107], v[76:79], v[56:59], v[104:107]
    ds_read_b128 v[36:39], v248 offset:35840
    v_mfma_f32_16x16x32_bf16 v[108:111], v[76:79], v[60:63], v[108:111]
    ds_read_b64_tr_b16 v[44:45], v251 offset:49152
    ds_read_b64_tr_b16 v[46:47], v251 offset:49664
    v_mfma_f32_16x16x32_bf16 v[112:115], v[76:79], v[64:67], v[112:115]
    ds_read_b64_tr_b16 v[48:49], v250 offset:57344
    v_mfma_f32_16x16x32_bf16 v[116:119], v[76:79], v[68:71], v[116:119]
    ds_read_b64_tr_b16 v[50:51], v250 offset:57856
    buffer_load_dwordx4 v18, s[56:59], s82 offen offset:1024 sc1 lds
    v_mfma_f32_16x16x32_bf16 v[120:123], v[80:83], v[56:59], v[120:123]
    ds_read_b64_tr_b16 v[52:53], v251 offset:57344
    v_mfma_f32_16x16x32_bf16 v[124:127], v[80:83], v[60:63], v[124:127]
    ds_read_b64_tr_b16 v[54:55], v251 offset:57856
    v_mfma_f32_16x16x32_bf16 v[128:131], v[80:83], v[64:67], v[128:131]
    v_mfma_f32_16x16x32_bf16 v[132:135], v[80:83], v[68:71], v[132:135]
    buffer_load_dwordx4 v18, s[56:59], s82 offen offset:2048 sc1 lds
    v_mfma_f32_16x16x32_bf16 v[136:139], v[84:87], v[56:59], v[136:139]
    v_mfma_f32_16x16x32_bf16 v[140:143], v[84:87], v[60:63], v[140:143]
    v_mfma_f32_16x16x32_bf16 v[144:147], v[84:87], v[64:67], v[144:147]
    v_mfma_f32_16x16x32_bf16 v[148:151], v[84:87], v[68:71], v[148:151]
    buffer_load_dwordx4 v18, s[56:59], s82 offen offset:3072 sc1 lds
    s_add_u32 s82, s82, 16384
    s_waitcnt lgkmcnt(9)
    v_mfma_f32_16x16x32_bf16 v[88:91], v[40:43], v[24:27], v[88:91]
    ds_read_b64_tr_b16 v[72:73], v250 offset:53248
    ds_read_b64_tr_b16 v[74:75], v250 offset:53760
    s_waitcnt lgkmcnt(10)
    v_mfma_f32_16x16x32_bf16 v[92:95], v[40:43], v[28:31], v[92:95]
    ds_read_b128 v[56:59], v248 offset:40960
    s_lshl1_add_u32 m0, s33, 114688
    s_waitcnt lgkmcnt(10)
    v_mfma_f32_16x16x32_bf16 v[96:99], v[40:43], v[32:35], v[96:99]
    ds_read_b128 v[60:63], v248 offset:41984
    ds_read_b128 v[64:67], v248 offset:43008
    s_waitcnt lgkmcnt(11)
    v_mfma_f32_16x16x32_bf16 v[100:103], v[40:43], v[36:39], v[100:103]
    ds_read_b128 v[68:71], v248 offset:44032
    buffer_load_dwordx4 v254, s[60:63], s83 offen lds
    s_waitcnt lgkmcnt(10)
    v_mfma_f32_16x16x32_bf16 v[104:107], v[44:47], v[24:27], v[104:107]
    ds_read_b64_tr_b16 v[76:77], v251 offset:53248
    ds_read_b64_tr_b16 v[78:79], v251 offset:53760
    v_mfma_f32_16x16x32_bf16 v[108:111], v[44:47], v[28:31], v[108:111]
    ds_read_b64_tr_b16 v[80:81], v250 offset:61440
    s_lshl1_add_u32 m0, s33, 115712
    v_mfma_f32_16x16x32_bf16 v[112:115], v[44:47], v[32:35], v[112:115]
    ds_read_b64_tr_b16 v[82:83], v250 offset:61952
    ds_read_b64_tr_b16 v[84:85], v251 offset:61440
    v_mfma_f32_16x16x32_bf16 v[116:119], v[44:47], v[36:39], v[116:119]
    ds_read_b64_tr_b16 v[86:87], v251 offset:61952
    buffer_load_dwordx4 v255, s[60:63], s83 offen lds
    s_waitcnt lgkmcnt(14)
    v_mfma_f32_16x16x32_bf16 v[120:123], v[48:51], v[24:27], v[120:123]
    v_mfma_f32_16x16x32_bf16 v[124:127], v[48:51], v[28:31], v[124:127]
    s_lshl1_add_u32 m0, s33, 122880
    v_mfma_f32_16x16x32_bf16 v[128:131], v[48:51], v[32:35], v[128:131]
    v_mfma_f32_16x16x32_bf16 v[132:135], v[48:51], v[36:39], v[132:135]
    buffer_load_dwordx4 v254, s[64:67], s83 offen lds
    s_waitcnt lgkmcnt(12)
    v_mfma_f32_16x16x32_bf16 v[136:139], v[52:55], v[24:27], v[136:139]
    v_mfma_f32_16x16x32_bf16 v[140:143], v[52:55], v[28:31], v[140:143]
    s_lshl1_add_u32 m0, s33, 123904
    v_mfma_f32_16x16x32_bf16 v[144:147], v[52:55], v[32:35], v[144:147]
    v_mfma_f32_16x16x32_bf16 v[148:151], v[52:55], v[36:39], v[148:151]
    buffer_load_dwordx4 v255, s[64:67], s83 offen lds
    s_add_u32 s83, s83, 131072
    s_waitcnt vmcnt(16) lgkmcnt(0)
    s_barrier
    v_mfma_f32_16x16x32_bf16 v[88:91], v[72:75], v[56:59], v[88:91]
    ds_read_b64_tr_b16 v[40:41], v252 offset:16384
    ds_read_b64_tr_b16 v[42:43], v252 offset:16896
    v_mfma_f32_16x16x32_bf16 v[92:95], v[72:75], v[60:63], v[92:95]
    ds_read_b128 v[24:27], v249 offset:0
    s_lshl2_add_u32 m0, s33, 32768
    v_mfma_f32_16x16x32_bf16 v[96:99], v[72:75], v[64:67], v[96:99]
    ds_read_b128 v[28:31], v249 offset:1024
    v_mfma_f32_16x16x32_bf16 v[100:103], v[72:75], v[68:71], v[100:103]
    ds_read_b128 v[32:35], v249 offset:2048
    buffer_load_dwordx4 v18, s[56:59], s82 offen offset:0 sc1 lds
    v_mfma_f32_16x16x32_bf16 v[104:107], v[76:79], v[56:59], v[104:107]
    ds_read_b128 v[36:39], v249 offset:3072
    v_mfma_f32_16x16x32_bf16 v[108:111], v[76:79], v[60:63], v[108:111]
    ds_read_b64_tr_b16 v[44:45], v253 offset:16384
    ds_read_b64_tr_b16 v[46:47], v253 offset:16896
    v_mfma_f32_16x16x32_bf16 v[112:115], v[76:79], v[64:67], v[112:115]
    ds_read_b64_tr_b16 v[48:49], v252 offset:24576
    v_mfma_f32_16x16x32_bf16 v[116:119], v[76:79], v[68:71], v[116:119]
    ds_read_b64_tr_b16 v[50:51], v252 offset:25088
    buffer_load_dwordx4 v18, s[56:59], s82 offen offset:1024 sc1 lds
    v_mfma_f32_16x16x32_bf16 v[120:123], v[80:83], v[56:59], v[120:123]
    ds_read_b64_tr_b16 v[52:53], v253 offset:24576
    v_mfma_f32_16x16x32_bf16 v[124:127], v[80:83], v[60:63], v[124:127]
    ds_read_b64_tr_b16 v[54:55], v253 offset:25088
    v_mfma_f32_16x16x32_bf16 v[128:131], v[80:83], v[64:67], v[128:131]
    v_mfma_f32_16x16x32_bf16 v[132:135], v[80:83], v[68:71], v[132:135]
    buffer_load_dwordx4 v18, s[56:59], s82 offen offset:2048 sc1 lds
    v_mfma_f32_16x16x32_bf16 v[136:139], v[84:87], v[56:59], v[136:139]
    v_mfma_f32_16x16x32_bf16 v[140:143], v[84:87], v[60:63], v[140:143]
    v_mfma_f32_16x16x32_bf16 v[144:147], v[84:87], v[64:67], v[144:147]
    v_mfma_f32_16x16x32_bf16 v[148:151], v[84:87], v[68:71], v[148:151]
    buffer_load_dwordx4 v18, s[56:59], s82 offen offset:3072 sc1 lds
    s_add_u32 s82, s82, 16384
    s_waitcnt lgkmcnt(9)
    v_mfma_f32_16x16x32_bf16 v[88:91], v[40:43], v[24:27], v[88:91]
    ds_read_b64_tr_b16 v[72:73], v252 offset:20480
    ds_read_b64_tr_b16 v[74:75], v252 offset:20992
    s_waitcnt lgkmcnt(10)
    v_mfma_f32_16x16x32_bf16 v[92:95], v[40:43], v[28:31], v[92:95]
    ds_read_b128 v[56:59], v249 offset:8192
    s_lshl1_add_u32 m0, s33, 49152
    s_waitcnt lgkmcnt(10)
    v_mfma_f32_16x16x32_bf16 v[96:99], v[40:43], v[32:35], v[96:99]
    ds_read_b128 v[60:63], v249 offset:9216
    ds_read_b128 v[64:67], v249 offset:10240
    s_waitcnt lgkmcnt(11)
    v_mfma_f32_16x16x32_bf16 v[100:103], v[40:43], v[36:39], v[100:103]
    ds_read_b128 v[68:71], v249 offset:11264
    buffer_load_dwordx4 v254, s[60:63], s83 offen lds
    s_waitcnt lgkmcnt(10)
    v_mfma_f32_16x16x32_bf16 v[104:107], v[44:47], v[24:27], v[104:107]
    ds_read_b64_tr_b16 v[76:77], v253 offset:20480
    ds_read_b64_tr_b16 v[78:79], v253 offset:20992
    v_mfma_f32_16x16x32_bf16 v[108:111], v[44:47], v[28:31], v[108:111]
    ds_read_b64_tr_b16 v[80:81], v252 offset:28672
    s_lshl1_add_u32 m0, s33, 50176
    v_mfma_f32_16x16x32_bf16 v[112:115], v[44:47], v[32:35], v[112:115]
    ds_read_b64_tr_b16 v[82:83], v252 offset:29184
    ds_read_b64_tr_b16 v[84:85], v253 offset:28672
    v_mfma_f32_16x16x32_bf16 v[116:119], v[44:47], v[36:39], v[116:119]
    ds_read_b64_tr_b16 v[86:87], v253 offset:29184
    buffer_load_dwordx4 v255, s[60:63], s83 offen lds
    s_waitcnt lgkmcnt(14)
    v_mfma_f32_16x16x32_bf16 v[120:123], v[48:51], v[24:27], v[120:123]
    v_mfma_f32_16x16x32_bf16 v[124:127], v[48:51], v[28:31], v[124:127]
    s_lshl1_add_u32 m0, s33, 57344
    v_mfma_f32_16x16x32_bf16 v[128:131], v[48:51], v[32:35], v[128:131]
    v_mfma_f32_16x16x32_bf16 v[132:135], v[48:51], v[36:39], v[132:135]
    buffer_load_dwordx4 v254, s[64:67], s83 offen lds
    s_waitcnt lgkmcnt(12)
    v_mfma_f32_16x16x32_bf16 v[136:139], v[52:55], v[24:27], v[136:139]
    v_mfma_f32_16x16x32_bf16 v[140:143], v[52:55], v[28:31], v[140:143]
    s_lshl1_add_u32 m0, s33, 58368
    v_mfma_f32_16x16x32_bf16 v[144:147], v[52:55], v[32:35], v[144:147]
    v_mfma_f32_16x16x32_bf16 v[148:151], v[52:55], v[36:39], v[148:151]
    buffer_load_dwordx4 v255, s[64:67], s83 offen lds
    s_add_u32 s83, s83, 131072
    s_waitcnt vmcnt(16) lgkmcnt(0)
    s_barrier
    v_mfma_f32_16x16x32_bf16 v[88:91], v[72:75], v[56:59], v[88:91]
    ds_read_b64_tr_b16 v[40:41], v250 offset:16384
    ds_read_b64_tr_b16 v[42:43], v250 offset:16896
    v_mfma_f32_16x16x32_bf16 v[92:95], v[72:75], v[60:63], v[92:95]
    ds_read_b128 v[24:27], v248 offset:0
    s_lshl2_add_u32 m0, s33, 65536
    v_mfma_f32_16x16x32_bf16 v[96:99], v[72:75], v[64:67], v[96:99]
    ds_read_b128 v[28:31], v248 offset:1024
    v_mfma_f32_16x16x32_bf16 v[100:103], v[72:75], v[68:71], v[100:103]
    ds_read_b128 v[32:35], v248 offset:2048
    buffer_load_dwordx4 v18, s[56:59], s82 offen offset:0 sc1 lds
    v_mfma_f32_16x16x32_bf16 v[104:107], v[76:79], v[56:59], v[104:107]
    ds_read_b128 v[36:39], v248 offset:3072
    v_mfma_f32_16x16x32_bf16 v[108:111], v[76:79], v[60:63], v[108:111]
    ds_read_b64_tr_b16 v[44:45], v251 offset:16384
    ds_read_b64_tr_b16 v[46:47], v251 offset:16896
    v_mfma_f32_16x16x32_bf16 v[112:115], v[76:79], v[64:67], v[112:115]
    ds_read_b64_tr_b16 v[48:49], v250 offset:24576
    v_mfma_f32_16x16x32_bf16 v[116:119], v[76:79], v[68:71], v[116:119]
    ds_read_b64_tr_b16 v[50:51], v250 offset:25088
    buffer_load_dwordx4 v18, s[56:59], s82 offen offset:1024 sc1 lds
    v_mfma_f32_16x16x32_bf16 v[120:123], v[80:83], v[56:59], v[120:123]
    ds_read_b64_tr_b16 v[52:53], v251 offset:24576
    v_mfma_f32_16x16x32_bf16 v[124:127], v[80:83], v[60:63], v[124:127]
    ds_read_b64_tr_b16 v[54:55], v251 offset:25088
    v_mfma_f32_16x16x32_bf16 v[128:131], v[80:83], v[64:67], v[128:131]
    v_mfma_f32_16x16x32_bf16 v[132:135], v[80:83], v[68:71], v[132:135]
    buffer_load_dwordx4 v18, s[56:59], s82 offen offset:2048 sc1 lds
    v_mfma_f32_16x16x32_bf16 v[136:139], v[84:87], v[56:59], v[136:139]
    v_mfma_f32_16x16x32_bf16 v[140:143], v[84:87], v[60:63], v[140:143]
    v_mfma_f32_16x16x32_bf16 v[144:147], v[84:87], v[64:67], v[144:147]
    v_mfma_f32_16x16x32_bf16 v[148:151], v[84:87], v[68:71], v[148:151]
    buffer_load_dwordx4 v18, s[56:59], s82 offen offset:3072 sc1 lds
    s_add_u32 s82, s82, 16384
    s_waitcnt lgkmcnt(9)
    v_mfma_f32_16x16x32_bf16 v[88:91], v[40:43], v[24:27], v[88:91]
    ds_read_b64_tr_b16 v[72:73], v250 offset:20480
    ds_read_b64_tr_b16 v[74:75], v250 offset:20992
    s_waitcnt lgkmcnt(10)
    v_mfma_f32_16x16x32_bf16 v[92:95], v[40:43], v[28:31], v[92:95]
    ds_read_b128 v[56:59], v248 offset:8192
    s_waitcnt lgkmcnt(10)
    v_mfma_f32_16x16x32_bf16 v[96:99], v[40:43], v[32:35], v[96:99]
    ds_read_b128 v[60:63], v248 offset:9216
    ds_read_b128 v[64:67], v248 offset:10240
    s_waitcnt lgkmcnt(11)
    v_mfma_f32_16x16x32_bf16 v[100:103], v[40:43], v[36:39], v[100:103]
    ds_read_b128 v[68:71], v248 offset:11264
    s_waitcnt lgkmcnt(10)
    v_mfma_f32_16x16x32_bf16 v[104:107], v[44:47], v[24:27], v[104:107]
    ds_read_b64_tr_b16 v[76:77], v251 offset:20480
    ds_read_b64_tr_b16 v[78:79], v251 offset:20992
    v_mfma_f32_16x16x32_bf16 v[108:111], v[44:47], v[28:31], v[108:111]
    ds_read_b64_tr_b16 v[80:81], v250 offset:28672
    v_mfma_f32_16x16x32_bf16 v[112:115], v[44:47], v[32:35], v[112:115]
    ds_read_b64_tr_b16 v[82:83], v250 offset:29184
    ds_read_b64_tr_b16 v[84:85], v251 offset:28672
    v_mfma_f32_16x16x32_bf16 v[116:119], v[44:47], v[36:39], v[116:119]
    ds_read_b64_tr_b16 v[86:87], v251 offset:29184
    s_waitcnt lgkmcnt(14)
    v_mfma_f32_16x16x32_bf16 v[120:123], v[48:51], v[24:27], v[120:123]
    v_mfma_f32_16x16x32_bf16 v[124:127], v[48:51], v[28:31], v[124:127]
    v_mfma_f32_16x16x32_bf16 v[128:131], v[48:51], v[32:35], v[128:131]
    v_mfma_f32_16x16x32_bf16 v[132:135], v[48:51], v[36:39], v[132:135]
    s_waitcnt lgkmcnt(12)
    v_mfma_f32_16x16x32_bf16 v[136:139], v[52:55], v[24:27], v[136:139]
    v_mfma_f32_16x16x32_bf16 v[140:143], v[52:55], v[28:31], v[140:143]
    v_mfma_f32_16x16x32_bf16 v[144:147], v[52:55], v[32:35], v[144:147]
    v_mfma_f32_16x16x32_bf16 v[148:151], v[52:55], v[36:39], v[148:151]
    s_waitcnt vmcnt(12) lgkmcnt(0)
    s_barrier
    v_mfma_f32_16x16x32_bf16 v[88:91], v[72:75], v[56:59], v[88:91]
    ds_read_b64_tr_b16 v[40:41], v252 offset:49152
    ds_read_b64_tr_b16 v[42:43], v252 offset:49664
    v_mfma_f32_16x16x32_bf16 v[92:95], v[72:75], v[60:63], v[92:95]
    ds_read_b128 v[24:27], v249 offset:32768
    v_mfma_f32_16x16x32_bf16 v[96:99], v[72:75], v[64:67], v[96:99]
    ds_read_b128 v[28:31], v249 offset:33792
    v_mfma_f32_16x16x32_bf16 v[100:103], v[72:75], v[68:71], v[100:103]
    ds_read_b128 v[32:35], v249 offset:34816
    v_mfma_f32_16x16x32_bf16 v[104:107], v[76:79], v[56:59], v[104:107]
    ds_read_b128 v[36:39], v249 offset:35840
    v_mfma_f32_16x16x32_bf16 v[108:111], v[76:79], v[60:63], v[108:111]
    ds_read_b64_tr_b16 v[44:45], v253 offset:49152
    ds_read_b64_tr_b16 v[46:47], v253 offset:49664
    v_mfma_f32_16x16x32_bf16 v[112:115], v[76:79], v[64:67], v[112:115]
    ds_read_b64_tr_b16 v[48:49], v252 offset:57344
    v_mfma_f32_16x16x32_bf16 v[116:119], v[76:79], v[68:71], v[116:119]
    ds_read_b64_tr_b16 v[50:51], v252 offset:57856
    v_mfma_f32_16x16x32_bf16 v[120:123], v[80:83], v[56:59], v[120:123]
    ds_read_b64_tr_b16 v[52:53], v253 offset:57344
    v_mfma_f32_16x16x32_bf16 v[124:127], v[80:83], v[60:63], v[124:127]
    ds_read_b64_tr_b16 v[54:55], v253 offset:57856
    v_mfma_f32_16x16x32_bf16 v[128:131], v[80:83], v[64:67], v[128:131]
    v_mfma_f32_16x16x32_bf16 v[132:135], v[80:83], v[68:71], v[132:135]
    v_mfma_f32_16x16x32_bf16 v[136:139], v[84:87], v[56:59], v[136:139]
    s_mov_b64 exec, 3
    global_load_dwordx3 v[236:238], v239, s[26:27] sc1
    s_mov_b64 exec, -1
    v_mfma_f32_16x16x32_bf16 v[140:143], v[84:87], v[60:63], v[140:143]
    v_mfma_f32_16x16x32_bf16 v[144:147], v[84:87], v[64:67], v[144:147]
    v_mfma_f32_16x16x32_bf16 v[148:151], v[84:87], v[68:71], v[148:151]
    s_waitcnt lgkmcnt(9)
    v_mfma_f32_16x16x32_bf16 v[88:91], v[40:43], v[24:27], v[88:91]
    ds_read_b64_tr_b16 v[72:73], v252 offset:53248
    ds_read_b64_tr_b16 v[74:75], v252 offset:53760
    s_waitcnt lgkmcnt(10)
    v_mfma_f32_16x16x32_bf16 v[92:95], v[40:43], v[28:31], v[92:95]
    ds_read_b128 v[56:59], v249 offset:40960
    s_waitcnt lgkmcnt(10)
    v_mfma_f32_16x16x32_bf16 v[96:99], v[40:43], v[32:35], v[96:99]
    ds_read_b128 v[60:63], v249 offset:41984
    ds_read_b128 v[64:67], v249 offset:43008
    s_waitcnt lgkmcnt(11)
    v_mfma_f32_16x16x32_bf16 v[100:103], v[40:43], v[36:39], v[100:103]
    ds_read_b128 v[68:71], v249 offset:44032
    s_waitcnt lgkmcnt(10)
    v_mfma_f32_16x16x32_bf16 v[104:107], v[44:47], v[24:27], v[104:107]
    ds_read_b64_tr_b16 v[76:77], v253 offset:53248
    ds_read_b64_tr_b16 v[78:79], v253 offset:53760
    v_mfma_f32_16x16x32_bf16 v[108:111], v[44:47], v[28:31], v[108:111]
    ds_read_b64_tr_b16 v[80:81], v252 offset:61440
    v_mfma_f32_16x16x32_bf16 v[112:115], v[44:47], v[32:35], v[112:115]
    ds_read_b64_tr_b16 v[82:83], v252 offset:61952
    ds_read_b64_tr_b16 v[84:85], v253 offset:61440
    v_mfma_f32_16x16x32_bf16 v[116:119], v[44:47], v[36:39], v[116:119]
    ds_read_b64_tr_b16 v[86:87], v253 offset:61952
    s_waitcnt lgkmcnt(14)
    v_mfma_f32_16x16x32_bf16 v[120:123], v[48:51], v[24:27], v[120:123]
    v_mfma_f32_16x16x32_bf16 v[124:127], v[48:51], v[28:31], v[124:127]
    v_mfma_f32_16x16x32_bf16 v[128:131], v[48:51], v[32:35], v[128:131]
    v_mfma_f32_16x16x32_bf16 v[132:135], v[48:51], v[36:39], v[132:135]
    s_waitcnt lgkmcnt(12)
    v_mfma_f32_16x16x32_bf16 v[136:139], v[52:55], v[24:27], v[136:139]
    v_mfma_f32_16x16x32_bf16 v[140:143], v[52:55], v[28:31], v[140:143]
    v_mfma_f32_16x16x32_bf16 v[144:147], v[52:55], v[32:35], v[144:147]
    v_mfma_f32_16x16x32_bf16 v[148:151], v[52:55], v[36:39], v[148:151]
    s_waitcnt vmcnt(5) lgkmcnt(0)
    s_barrier
    v_mfma_f32_16x16x32_bf16 v[88:91], v[72:75], v[56:59], v[88:91]
    ds_read_b64_tr_b16 v[40:41], v250 offset:49152
    ds_read_b64_tr_b16 v[42:43], v250 offset:49664
    v_mfma_f32_16x16x32_bf16 v[92:95], v[72:75], v[60:63], v[92:95]
    ds_read_b128 v[24:27], v248 offset:32768
    v_mfma_f32_16x16x32_bf16 v[96:99], v[72:75], v[64:67], v[96:99]
    ds_read_b128 v[28:31], v248 offset:33792
    v_mfma_f32_16x16x32_bf16 v[100:103], v[72:75], v[68:71], v[100:103]
    ds_read_b128 v[32:35], v248 offset:34816
    v_mfma_f32_16x16x32_bf16 v[104:107], v[76:79], v[56:59], v[104:107]
    ds_read_b128 v[36:39], v248 offset:35840
    v_mfma_f32_16x16x32_bf16 v[108:111], v[76:79], v[60:63], v[108:111]
    ds_read_b64_tr_b16 v[44:45], v251 offset:49152
    ds_read_b64_tr_b16 v[46:47], v251 offset:49664
    v_mfma_f32_16x16x32_bf16 v[112:115], v[76:79], v[64:67], v[112:115]
    ds_read_b64_tr_b16 v[48:49], v250 offset:57344
    v_mfma_f32_16x16x32_bf16 v[116:119], v[76:79], v[68:71], v[116:119]
    ds_read_b64_tr_b16 v[50:51], v250 offset:57856
    v_mfma_f32_16x16x32_bf16 v[120:123], v[80:83], v[56:59], v[120:123]
    ds_read_b64_tr_b16 v[52:53], v251 offset:57344
    v_mfma_f32_16x16x32_bf16 v[124:127], v[80:83], v[60:63], v[124:127]
    ds_read_b64_tr_b16 v[54:55], v251 offset:57856
    v_mfma_f32_16x16x32_bf16 v[128:131], v[80:83], v[64:67], v[128:131]
    v_mfma_f32_16x16x32_bf16 v[132:135], v[80:83], v[68:71], v[132:135]
    v_mfma_f32_16x16x32_bf16 v[136:139], v[84:87], v[56:59], v[136:139]
    v_mfma_f32_16x16x32_bf16 v[140:143], v[84:87], v[60:63], v[140:143]
    v_mfma_f32_16x16x32_bf16 v[144:147], v[84:87], v[64:67], v[144:147]
    v_mfma_f32_16x16x32_bf16 v[148:151], v[84:87], v[68:71], v[148:151]
    s_waitcnt lgkmcnt(9)
    v_mfma_f32_16x16x32_bf16 v[88:91], v[40:43], v[24:27], v[88:91]
    ds_read_b64_tr_b16 v[72:73], v250 offset:53248
    ds_read_b64_tr_b16 v[74:75], v250 offset:53760
    s_waitcnt lgkmcnt(10)
    v_mfma_f32_16x16x32_bf16 v[92:95], v[40:43], v[28:31], v[92:95]
    ds_read_b128 v[56:59], v248 offset:40960
    s_waitcnt lgkmcnt(10)
    v_mfma_f32_16x16x32_bf16 v[96:99], v[40:43], v[32:35], v[96:99]
    ds_read_b128 v[60:63], v248 offset:41984
    ds_read_b128 v[64:67], v248 offset:43008
    s_waitcnt lgkmcnt(11)
    v_mfma_f32_16x16x32_bf16 v[100:103], v[40:43], v[36:39], v[100:103]
    ds_read_b128 v[68:71], v248 offset:44032
    s_waitcnt lgkmcnt(10)
    v_mfma_f32_16x16x32_bf16 v[104:107], v[44:47], v[24:27], v[104:107]
    ds_read_b64_tr_b16 v[76:77], v251 offset:53248
    ds_read_b64_tr_b16 v[78:79], v251 offset:53760
    v_mfma_f32_16x16x32_bf16 v[108:111], v[44:47], v[28:31], v[108:111]
    ds_read_b64_tr_b16 v[80:81], v250 offset:61440
    v_mfma_f32_16x16x32_bf16 v[112:115], v[44:47], v[32:35], v[112:115]
    ds_read_b64_tr_b16 v[82:83], v250 offset:61952
    ds_read_b64_tr_b16 v[84:85], v251 offset:61440
    v_mfma_f32_16x16x32_bf16 v[116:119], v[44:47], v[36:39], v[116:119]
    ds_read_b64_tr_b16 v[86:87], v251 offset:61952
    s_waitcnt lgkmcnt(14)
    v_mfma_f32_16x16x32_bf16 v[120:123], v[48:51], v[24:27], v[120:123]
    v_mfma_f32_16x16x32_bf16 v[124:127], v[48:51], v[28:31], v[124:127]
    v_mfma_f32_16x16x32_bf16 v[128:131], v[48:51], v[32:35], v[128:131]
    v_mfma_f32_16x16x32_bf16 v[132:135], v[48:51], v[36:39], v[132:135]
    s_waitcnt lgkmcnt(12)
    v_mfma_f32_16x16x32_bf16 v[136:139], v[52:55], v[24:27], v[136:139]
    v_mfma_f32_16x16x32_bf16 v[140:143], v[52:55], v[28:31], v[140:143]
    v_mfma_f32_16x16x32_bf16 v[144:147], v[52:55], v[32:35], v[144:147]
    v_mfma_f32_16x16x32_bf16 v[148:151], v[52:55], v[36:39], v[148:151]
    s_waitcnt vmcnt(0) lgkmcnt(0)
    s_barrier
    v_mfma_f32_16x16x32_bf16 v[88:91], v[72:75], v[56:59], v[88:91]
    ds_read_b64_tr_b16 v[40:41], v252 offset:16384
    ds_read_b64_tr_b16 v[42:43], v252 offset:16896
    v_readlane_b32 s90, v238, 0
    v_readlane_b32 s91, v238, 1
    v_mfma_f32_16x16x32_bf16 v[92:95], v[72:75], v[60:63], v[92:95]
    ds_read_b128 v[24:27], v249 offset:0
    s_nop 1
    s_sub_u32 s90, s91, s90
    v_mfma_f32_16x16x32_bf16 v[96:99], v[72:75], v[64:67], v[96:99]
    ds_read_b128 v[28:31], v249 offset:1024
    s_abs_i32 s91, s90
    v_mfma_f32_16x16x32_bf16 v[100:103], v[72:75], v[68:71], v[100:103]
    ds_read_b128 v[32:35], v249 offset:2048
    s_min_u32 s91, s91, 0x1000
    s_add_u32 s91, s91, 35
    v_mfma_f32_16x16x32_bf16 v[104:107], v[76:79], v[56:59], v[104:107]
    ds_read_b128 v[36:39], v249 offset:3072
    s_mul_i32 s91, s91, 937
    s_lshr_b32 s91, s91, 16
    v_mfma_f32_16x16x32_bf16 v[108:111], v[76:79], v[60:63], v[108:111]
    ds_read_b64_tr_b16 v[44:45], v253 offset:16384
    ds_read_b64_tr_b16 v[46:47], v253 offset:16896
    s_min_u32 s91, s91, 4
    v_mfma_f32_16x16x32_bf16 v[112:115], v[76:79], v[64:67], v[112:115]
    ds_read_b64_tr_b16 v[48:49], v252 offset:24576
    s_sub_u32 s92, 0, s91
    s_cmp_lt_i32 s90, 0
    v_mfma_f32_16x16x32_bf16 v[116:119], v[76:79], v[68:71], v[116:119]
    ds_read_b64_tr_b16 v[50:51], v252 offset:25088
    s_cselect_b32 s91, s92, s91
    v_mfma_f32_16x16x32_bf16 v[120:123], v[80:83], v[56:59], v[120:123]
    ds_read_b64_tr_b16 v[52:53], v253 offset:24576
    s_add_u32 s34, s91, 16
    s_and_b32 s91, s91, 3
    v_mfma_f32_16x16x32_bf16 v[124:127], v[80:83], v[60:63], v[124:127]
    ds_read_b64_tr_b16 v[54:55], v253 offset:25088
    s_mov_b32 s46, 0x9a69a69a
    s_mov_b32 s47, 0x269a69a6
    v_mfma_f32_16x16x32_bf16 v[128:131], v[80:83], v[64:67], v[128:131]
    s_cmp_eq_u32 s91, 1
    v_mfma_f32_16x16x32_bf16 v[132:135], v[80:83], v[68:71], v[132:135]
    s_cselect_b32 s46, 0xd34d34e6, s46
    s_cselect_b32 s47, 0x34d34d34, s47
    v_mfma_f32_16x16x32_bf16 v[136:139], v[84:87], v[56:59], v[136:139]
    s_cmp_eq_u32 s91, 2
    s_cselect_b32 s46, 0x9a7334e6, s46
    v_mfma_f32_16x16x32_bf16 v[140:143], v[84:87], v[60:63], v[140:143]
    s_cselect_b32 s47, 0x269a69a6, s47
    v_mfma_f32_16x16x32_bf16 v[144:147], v[84:87], v[64:67], v[144:147]
    s_cmp_eq_u32 s91, 3
    s_cselect_b32 s46, 0x9a7334e6, s46
    v_mfma_f32_16x16x32_bf16 v[148:151], v[84:87], v[68:71], v[148:151]
    s_cselect_b32 s47, 0x34d34d39, s47
    s_waitcnt lgkmcnt(9)
    v_mfma_f32_16x16x32_bf16 v[88:91], v[40:43], v[24:27], v[88:91]
    ds_read_b64_tr_b16 v[72:73], v252 offset:20480
    ds_read_b64_tr_b16 v[74:75], v252 offset:20992
    s_waitcnt lgkmcnt(10)
    v_mfma_f32_16x16x32_bf16 v[92:95], v[40:43], v[28:31], v[92:95]
    ds_read_b128 v[56:59], v249 offset:8192
    s_waitcnt lgkmcnt(10)
    v_mfma_f32_16x16x32_bf16 v[96:99], v[40:43], v[32:35], v[96:99]
    ds_read_b128 v[60:63], v249 offset:9216
    ds_read_b128 v[64:67], v249 offset:10240
    s_waitcnt lgkmcnt(11)
    v_mfma_f32_16x16x32_bf16 v[100:103], v[40:43], v[36:39], v[100:103]
    ds_read_b128 v[68:71], v249 offset:11264
    s_waitcnt lgkmcnt(10)
    v_mfma_f32_16x16x32_bf16 v[104:107], v[44:47], v[24:27], v[104:107]
    ds_read_b64_tr_b16 v[76:77], v253 offset:20480
    ds_read_b64_tr_b16 v[78:79], v253 offset:20992
    v_mfma_f32_16x16x32_bf16 v[108:111], v[44:47], v[28:31], v[108:111]
    ds_read_b64_tr_b16 v[80:81], v252 offset:28672
    v_mfma_f32_16x16x32_bf16 v[112:115], v[44:47], v[32:35], v[112:115]
    ds_read_b64_tr_b16 v[82:83], v252 offset:29184
    ds_read_b64_tr_b16 v[84:85], v253 offset:28672
    v_mfma_f32_16x16x32_bf16 v[116:119], v[44:47], v[36:39], v[116:119]
L_pad5:
    s_cbranch_execz L_vret2
    ds_read_b64_tr_b16 v[86:87], v253 offset:29184
    s_waitcnt lgkmcnt(14)
    v_mfma_f32_16x16x32_bf16 v[120:123], v[48:51], v[24:27], v[120:123]
    v_mfma_f32_16x16x32_bf16 v[124:127], v[48:51], v[28:31], v[124:127]
    s_lshl_b32 s48, s46, 15
    s_and_b32 s48, s48, 0x38000
    v_mfma_f32_16x16x32_bf16 v[128:131], v[48:51], v[32:35], v[128:131]
    s_lshr_b64 s[46:47], s[46:47], 3
    v_mfma_f32_16x16x32_bf16 v[132:135], v[48:51], v[36:39], v[132:135]
    v_xor_b32 v252, s48, v252
    s_waitcnt lgkmcnt(12)
    v_mfma_f32_16x16x32_bf16 v[136:139], v[52:55], v[24:27], v[136:139]
    v_xor_b32 v249, s48, v249
    v_mfma_f32_16x16x32_bf16 v[140:143], v[52:55], v[28:31], v[140:143]
    v_xor_b32 v253, s48, v253
    v_mfma_f32_16x16x32_bf16 v[144:147], v[52:55], v[32:35], v[144:147]
    s_sub_u32 s34, s34, 1
    v_mfma_f32_16x16x32_bf16 v[148:151], v[52:55], v[36:39], v[148:151]
.p2align 6
L_dl:
    s_waitcnt lgkmcnt(0)
    s_barrier
    v_mfma_f32_16x16x32_bf16 v[88:91], v[72:75], v[56:59], v[88:91]
    ds_read_b64_tr_b16 v[40:41], v252 offset:16384
    ds_read_b64_tr_b16 v[42:43], v252 offset:16896
    v_mfma_f32_16x16x32_bf16 v[92:95], v[72:75], v[60:63], v[92:95]
    ds_read_b128 v[24:27], v249 offset:0
    v_mfma_f32_16x16x32_bf16 v[96:99], v[72:75], v[64:67], v[96:99]
    ds_read_b128 v[28:31], v249 offset:1024
    v_mfma_f32_16x16x32_bf16 v[100:103], v[72:75], v[68:71], v[100:103]
    ds_read_b128 v[32:35], v249 offset:2048
    v_mfma_f32_16x16x32_bf16 v[104:107], v[76:79], v[56:59], v[104:107]
    ds_read_b128 v[36:39], v249 offset:3072
    v_mfma_f32_16x16x32_bf16 v[108:111], v[76:79], v[60:63], v[108:111]
    ds_read_b64_tr_b16 v[44:45], v253 offset:16384
    ds_read_b64_tr_b16 v[46:47], v253 offset:16896
    v_mfma_f32_16x16x32_bf16 v[112:115], v[76:79], v[64:67], v[112:115]
    ds_read_b64_tr_b16 v[48:49], v252 offset:24576
    v_mfma_f32_16x16x32_bf16 v[116:119], v[76:79], v[68:71], v[116:119]
    ds_read_b64_tr_b16 v[50:51], v252 offset:25088
    v_mfma_f32_16x16x32_bf16 v[120:123], v[80:83], v[56:59], v[120:123]
    ds_read_b64_tr_b16 v[52:53], v253 offset:24576
    v_mfma_f32_16x16x32_bf16 v[124:127], v[80:83], v[60:63], v[124:127]
    ds_read_b64_tr_b16 v[54:55], v253 offset:25088
    v_mfma_f32_16x16x32_bf16 v[128:131], v[80:83], v[64:67], v[128:131]
    v_mfma_f32_16x16x32_bf16 v[132:135], v[80:83], v[68:71], v[132:135]
    v_mfma_f32_16x16x32_bf16 v[136:139], v[84:87], v[56:59], v[136:139]
    v_mfma_f32_16x16x32_bf16 v[140:143], v[84:87], v[60:63], v[140:143]
    v_mfma_f32_16x16x32_bf16 v[144:147], v[84:87], v[64:67], v[144:147]
    v_mfma_f32_16x16x32_bf16 v[148:151], v[84:87], v[68:71], v[148:151]
    s_waitcnt lgkmcnt(9)
    v_mfma_f32_16x16x32_bf16 v[88:91], v[40:43], v[24:27], v[88:91]
    ds_read_b64_tr_b16 v[72:73], v252 offset:20480
    ds_read_b64_tr_b16 v[74:75], v252 offset:20992
    s_waitcnt lgkmcnt(10)
    v_mfma_f32_16x16x32_bf16 v[92:95], v[40:43], v[28:31], v[92:95]
    ds_read_b128 v[56:59], v249 offset:8192
    s_waitcnt lgkmcnt(10)
    v_mfma_f32_16x16x32_bf16 v[96:99], v[40:43], v[32:35], v[96:99]
    ds_read_b128 v[60:63], v249 offset:9216
    ds_read_b128 v[64:67], v249 offset:10240
    s_waitcnt lgkmcnt(11)
    v_mfma_f32_16x16x32_bf16 v[100:103], v[40:43], v[36:39], v[100:103]
    ds_read_b128 v[68:71], v249 offset:11264
    s_waitcnt lgkmcnt(10)
    v_mfma_f32_16x16x32_bf16 v[104:107], v[44:47], v[24:27], v[104:107]
    ds_read_b64_tr_b16 v[76:77], v253 offset:20480
    ds_read_b64_tr_b16 v[78:79], v253 offset:20992
    v_mfma_f32_16x16x32_bf16 v[108:111], v[44:47], v[28:31], v[108:111]
    ds_read_b64_tr_b16 v[80:81], v252 offset:28672
    v_mfma_f32_16x16x32_bf16 v[112:115], v[44:47], v[32:35], v[112:115]
    ds_read_b64_tr_b16 v[82:83], v252 offset:29184
    ds_read_b64_tr_b16 v[84:85], v253 offset:28672
    v_mfma_f32_16x16x32_bf16 v[116:119], v[44:47], v[36:39], v[116:119]
    ds_read_b64_tr_b16 v[86:87], v253 offset:29184
    s_waitcnt lgkmcnt(14)
    v_mfma_f32_16x16x32_bf16 v[120:123], v[48:51], v[24:27], v[120:123]
    v_mfma_f32_16x16x32_bf16 v[124:127], v[48:51], v[28:31], v[124:127]
    s_lshl_b32 s48, s46, 15
    s_and_b32 s48, s48, 0x38000
    v_mfma_f32_16x16x32_bf16 v[128:131], v[48:51], v[32:35], v[128:131]
    s_lshr_b64 s[46:47], s[46:47], 3
    v_mfma_f32_16x16x32_bf16 v[132:135], v[48:51], v[36:39], v[132:135]
    v_xor_b32 v252, s48, v252
    s_waitcnt lgkmcnt(12)
    v_mfma_f32_16x16x32_bf16 v[136:139], v[52:55], v[24:27], v[136:139]
    v_xor_b32 v249, s48, v249
    v_mfma_f32_16x16x32_bf16 v[140:143], v[52:55], v[28:31], v[140:143]
    v_xor_b32 v253, s48, v253
    v_mfma_f32_16x16x32_bf16 v[144:147], v[52:55], v[32:35], v[144:147]
    s_sub_u32 s34, s34, 1
    v_mfma_f32_16x16x32_bf16 v[148:151], v[52:55], v[36:39], v[148:151]
    s_cbranch_scc0 L_dl
    s_waitcnt lgkmcnt(0)
    s_barrier
    v_mfma_f32_16x16x32_bf16 v[88:91], v[72:75], v[56:59], v[88:91]
    v_mfma_f32_16x16x32_bf16 v[92:95], v[72:75], v[60:63], v[92:95]
    v_mfma_f32_16x16x32_bf16 v[96:99], v[72:75], v[64:67], v[96:99]
    v_mfma_f32_16x16x32_bf16 v[100:103], v[72:75], v[68:71], v[100:103]
    v_mfma_f32_16x16x32_bf16 v[104:107], v[76:79], v[56:59], v[104:107]
    v_mfma_f32_16x16x32_bf16 v[108:111], v[76:79], v[60:63], v[108:111]
    v_mfma_f32_16x16x32_bf16 v[112:115], v[76:79], v[64:67], v[112:115]
    v_mfma_f32_16x16x32_bf16 v[116:119], v[76:79], v[68:71], v[116:119]
    v_mfma_f32_16x16x32_bf16 v[120:123], v[80:83], v[56:59], v[120:123]
    v_mfma_f32_16x16x32_bf16 v[124:127], v[80:83], v[60:63], v[124:127]
    v_mfma_f32_16x16x32_bf16 v[128:131], v[80:83], v[64:67], v[128:131]
    v_mfma_f32_16x16x32_bf16 v[132:135], v[80:83], v[68:71], v[132:135]
    v_mfma_f32_16x16x32_bf16 v[136:139], v[84:87], v[56:59], v[136:139]
    v_mfma_f32_16x16x32_bf16 v[140:143], v[84:87], v[60:63], v[140:143]
    v_mfma_f32_16x16x32_bf16 v[144:147], v[84:87], v[64:67], v[144:147]
    v_mfma_f32_16x16x32_bf16 v[148:151], v[84:87], v[68:71], v[148:151]
    s_setprio 0
    s_lshl4_add_u32 s91, s28, s29
    s_xor_b32 s91, s91, 136
    s_lshl_b32 s91, s91, 7
    s_add_u32 s91, s91, 0x1ea0000
    v_mov_b32 v13, s91
    s_nop 7
    v_max_f32_e64 v8, |v120|, |v121|
    v_max_f32_e64 v9, |v128|, |v129|
    v_max_f32_e64 v10, |v136|, |v137|
    v_max_f32_e64 v11, |v144|, |v145|
    v_max3_f32 v8, |v122|, |v123|, v8
    v_max3_f32 v9, |v130|, |v131|, v9
    v_max3_f32 v10, |v138|, |v139|, v10
    v_max3_f32 v11, |v146|, |v147|, v11
    v_max3_f32 v8, |v124|, |v125|, v8
    v_max3_f32 v9, |v132|, |v133|, v9
    v_max3_f32 v10, |v140|, |v141|, v10
    v_max3_f32 v11, |v148|, |v149|, v11
    v_max3_f32 v8, |v126|, |v127|, v8
    v_max3_f32 v9, |v134|, |v135|, v9
    v_max3_f32 v10, |v142|, |v143|, v10
    v_max3_f32 v11, |v150|, |v151|, v11
    v_max3_f32 v8, v8, v9, v10
    v_max_f32 v8, v8, v11
    v_min_f32 v8, 0x7f7fffff, v8
    v_frexp_exp_i32_f32 v8, v8
    v_max_i32 v8, -100, v8
    v_sub_u32 v9, 15, v8
    v_add_u32 v8, -15, v8
    v_ldexp_f32 v9, 1.0, v9
    v_ldexp_f32 v8, 1.0, v8
    buffer_store_dword v8, v6, s[68:71], s37 offen sc1
    v_fma_mixlo_f16 v32, v120, v9, 0
    v_fma_mixlo_f16 v33, v122, v9, 0
    v_fma_mixlo_f16 v34, v124, v9, 0
    v_fma_mixlo_f16 v35, v126, v9, 0
    v_fma_mixhi_f16 v32, v121, v9, 0
    v_fma_mixhi_f16 v33, v123, v9, 0
    v_fma_mixhi_f16 v34, v125, v9, 0
    v_fma_mixhi_f16 v35, v127, v9, 0
    s_nop 0
    buffer_store_dwordx4 v[32:35], v4, s[68:71], s36 offen offset:0 sc1
    v_fma_mixlo_f16 v36, v128, v9, 0
    v_fma_mixlo_f16 v37, v130, v9, 0
    v_fma_mixlo_f16 v38, v132, v9, 0
    v_fma_mixlo_f16 v39, v134, v9, 0
    v_fma_mixhi_f16 v36, v129, v9, 0
    v_fma_mixhi_f16 v37, v131, v9, 0
    v_fma_mixhi_f16 v38, v133, v9, 0
    v_fma_mixhi_f16 v39, v135, v9, 0
    s_nop 0
    buffer_store_dwordx4 v[36:39], v4, s[68:71], s36 offen offset:1024 sc1
    s_barrier
    v_fma_mixlo_f16 v40, v136, v9, 0
    v_fma_mixlo_f16 v41, v138, v9, 0
    v_fma_mixlo_f16 v42, v140, v9, 0
    v_fma_mixlo_f16 v43, v142, v9, 0
    v_fma_mixhi_f16 v40, v137, v9, 0
    v_fma_mixhi_f16 v41, v139, v9, 0
    v_fma_mixhi_f16 v42, v141, v9, 0
    v_fma_mixhi_f16 v43, v143, v9, 0
    s_nop 0
    buffer_store_dwordx4 v[40:43], v4, s[68:71], s36 offen offset:2048 sc1
    v_fma_mixlo_f16 v44, v144, v9, 0
    v_fma_mixlo_f16 v45, v146, v9, 0
    v_fma_mixlo_f16 v46, v148, v9, 0
    v_fma_mixlo_f16 v47, v150, v9, 0
    v_fma_mixhi_f16 v44, v145, v9, 0
    v_fma_mixhi_f16 v45, v147, v9, 0
    v_fma_mixhi_f16 v46, v149, v9, 0
    v_fma_mixhi_f16 v47, v151, v9, 0
    s_nop 0
    buffer_store_dwordx4 v[44:47], v4, s[68:71], s36 offen offset:3072 sc1
    s_barrier
    s_barrier
    s_waitcnt vmcnt(0)
    s_barrier
    s_cmp_lg_u32 s4, 0
    s_cbranch_scc1 L_fP
    s_lshl_b32 s91, s28, 4
    s_add_u32 s91, s91, s29
    s_lshl_b32 s91, s91, 7
    s_add_u32 s91, s91, 0x1ea0000
    v_mov_b32 v16, s91
    v_mov_b32 v18, s100
    v_mov_b32 v19, s101
    s_mov_b64 exec, 1
    global_store_dwordx2 v16, v[18:19], s[26:27] sc1
    s_mov_b64 exec, -1
L_fP:
    s_barrier
    s_mov_b64 exec, 1
    global_load_dwordx2 v[14:15], v13, s[26:27] sc1
    s_mov_b64 exec, -1
    s_barrier
    s_barrier
    s_waitcnt vmcnt(0)
    s_mov_b64 exec, 1
    s_movk_i32 s98, 0x4000
L_pP_chk:
    v_cmp_ne_u64 vcc, s[100:101], v[14:15]
    s_nop 1
    s_cmp_eq_u64 vcc, 0
    s_cbranch_scc1 L_pP_ok
    s_sub_u32 s98, s98, 1
    s_cbranch_scc1 L_pP_ok
    s_sleep 1
    global_load_dwordx2 v[14:15], v13, s[26:27] sc1
    s_waitcnt vmcnt(0)
    s_branch L_pP_chk
L_pP_ok:
    s_mov_b64 exec, -1
    buffer_load_dword v168, v6, s[68:71], s39 offen sc1
    buffer_load_dwordx4 v[152:155], v4, s[68:71], s38 offen offset:0 sc1
    buffer_load_dwordx4 v[156:159], v4, s[68:71], s38 offen offset:1024 sc1
    buffer_load_dwordx4 v[160:163], v4, s[68:71], s38 offen offset:2048 sc1
    buffer_load_dwordx4 v[164:167], v4, s[68:71], s38 offen offset:3072 sc1
    s_barrier
    s_barrier
    s_waitcnt vmcnt(3)
    v_fma_mix_f32 v88, v152, v168, v88 op_sel:[0,0,0] op_sel_hi:[1,0,0]
    v_fma_mix_f32 v89, v152, v168, v89 op_sel:[1,0,0] op_sel_hi:[1,0,0]
    v_fma_mix_f32 v90, v153, v168, v90 op_sel:[0,0,0] op_sel_hi:[1,0,0]
    v_fma_mix_f32 v91, v153, v168, v91 op_sel:[1,0,0] op_sel_hi:[1,0,0]
    v_cvt_pk_bf16_f32 v28, v88, v89
    v_cvt_pk_bf16_f32 v29, v90, v91
    v_lshlrev_b32 v88, 16, v28
    v_and_b32 v89, 0xffff0000, v28
    v_lshlrev_b32 v90, 16, v29
    v_and_b32 v91, 0xffff0000, v29
    v_mul_f32 v24, 0xbfb8aa3b, v88
    v_mul_f32 v25, 0xbfb8aa3b, v89
    v_mul_f32 v26, 0xbfb8aa3b, v90
    v_mul_f32 v27, 0xbfb8aa3b, v91
    v_exp_f32 v24, v24
    v_exp_f32 v25, v25
    v_exp_f32 v26, v26
    v_exp_f32 v27, v27
    s_nop 0
    v_add_f32 v24, 1.0, v24
    v_add_f32 v25, 1.0, v25
    v_add_f32 v26, 1.0, v26
    v_add_f32 v27, 1.0, v27
    v_rcp_f32 v24, v24
    v_rcp_f32 v25, v25
    v_rcp_f32 v26, v26
    v_rcp_f32 v27, v27
    s_nop 0
    v_mul_f32 v24, v24, v88
    v_mul_f32 v25, v25, v89
    v_mul_f32 v26, v26, v90
    v_mul_f32 v27, v27, v91
    v_cvt_pk_bf16_f32 v88, v24, v25
    v_cvt_pk_bf16_f32 v89, v26, v27
    ds_write_b64 v5, v[88:89] offset:0
    v_fma_mix_f32 v92, v154, v168, v92 op_sel:[0,0,0] op_sel_hi:[1,0,0]
    v_fma_mix_f32 v93, v154, v168, v93 op_sel:[1,0,0] op_sel_hi:[1,0,0]
    v_fma_mix_f32 v94, v155, v168, v94 op_sel:[0,0,0] op_sel_hi:[1,0,0]
    v_fma_mix_f32 v95, v155, v168, v95 op_sel:[1,0,0] op_sel_hi:[1,0,0]
    v_cvt_pk_bf16_f32 v28, v92, v93
    v_cvt_pk_bf16_f32 v29, v94, v95
    v_lshlrev_b32 v92, 16, v28
    v_and_b32 v93, 0xffff0000, v28
    v_lshlrev_b32 v94, 16, v29
    v_and_b32 v95, 0xffff0000, v29
    v_mul_f32 v24, 0xbfb8aa3b, v92
    v_mul_f32 v25, 0xbfb8aa3b, v93
    v_mul_f32 v26, 0xbfb8aa3b, v94
    v_mul_f32 v27, 0xbfb8aa3b, v95
    v_exp_f32 v24, v24
    v_exp_f32 v25, v25
    v_exp_f32 v26, v26
    v_exp_f32 v27, v27
    s_nop 0
    v_add_f32 v24, 1.0, v24
    v_add_f32 v25, 1.0, v25
    s_barrier
    v_add_f32 v26, 1.0, v26
    v_add_f32 v27, 1.0, v27
    v_rcp_f32 v24, v24
    v_rcp_f32 v25, v25
    v_rcp_f32 v26, v26
    v_rcp_f32 v27, v27
    s_nop 0
    v_mul_f32 v24, v24, v92
    v_mul_f32 v25, v25, v93
    v_mul_f32 v26, v26, v94
    v_mul_f32 v27, v27, v95
    v_cvt_pk_bf16_f32 v92, v24, v25
    v_cvt_pk_bf16_f32 v93, v26, v27
    ds_write_b64 v5, v[92:93] offset:512
    s_waitcnt vmcnt(2)
    v_fma_mix_f32 v96, v156, v168, v96 op_sel:[0,0,0] op_sel_hi:[1,0,0]
    v_fma_mix_f32 v97, v156, v168, v97 op_sel:[1,0,0] op_sel_hi:[1,0,0]
    v_fma_mix_f32 v98, v157, v168, v98 op_sel:[0,0,0] op_sel_hi:[1,0,0]
    v_fma_mix_f32 v99, v157, v168, v99 op_sel:[1,0,0] op_sel_hi:[1,0,0]
    v_cvt_pk_bf16_f32 v28, v96, v97
    v_cvt_pk_bf16_f32 v29, v98, v99
    v_lshlrev_b32 v96, 16, v28
    v_and_b32 v97, 0xffff0000, v28
    v_lshlrev_b32 v98, 16, v29
    v_and_b32 v99, 0xffff0000, v29
    v_mul_f32 v24, 0xbfb8aa3b, v96
    v_mul_f32 v25, 0xbfb8aa3b, v97
    v_mul_f32 v26, 0xbfb8aa3b, v98
    v_mul_f32 v27, 0xbfb8aa3b, v99
    v_exp_f32 v24, v24
    v_exp_f32 v25, v25
    v_exp_f32 v26, v26
    v_exp_f32 v27, v27
    s_nop 0
    v_add_f32 v24, 1.0, v24
    v_add_f32 v25, 1.0, v25
    v_add_f32 v26, 1.0, v26
    v_add_f32 v27, 1.0, v27
    v_rcp_f32 v24, v24
    v_rcp_f32 v25, v25
    v_rcp_f32 v26, v26
    v_rcp_f32 v27, v27
    s_nop 0
    v_mul_f32 v24, v24, v96
    v_mul_f32 v25, v25, v97
    v_mul_f32 v26, v26, v98
    v_mul_f32 v27, v27, v99
    v_cvt_pk_bf16_f32 v96, v24, v25
    v_cvt_pk_bf16_f32 v97, v26, v27
    ds_write_b64 v5, v[96:97] offset:1024
    s_barrier
    v_fma_mix_f32 v100, v158, v168, v100 op_sel:[0,0,0] op_sel_hi:[1,0,0]
    v_fma_mix_f32 v101, v158, v168, v101 op_sel:[1,0,0] op_sel_hi:[1,0,0]
    v_fma_mix_f32 v102, v159, v168, v102 op_sel:[0,0,0] op_sel_hi:[1,0,0]
    v_fma_mix_f32 v103, v159, v168, v103 op_sel:[1,0,0] op_sel_hi:[1,0,0]
    v_cvt_pk_bf16_f32 v28, v100, v101
    v_cvt_pk_bf16_f32 v29, v102, v103
    v_lshlrev_b32 v100, 16, v28
    v_and_b32 v101, 0xffff0000, v28
    v_lshlrev_b32 v102, 16, v29
    v_and_b32 v103, 0xffff0000, v29
    v_mul_f32 v24, 0xbfb8aa3b, v100
    v_mul_f32 v25, 0xbfb8aa3b, v101
    v_mul_f32 v26, 0xbfb8aa3b, v102
    v_mul_f32 v27, 0xbfb8aa3b, v103
    v_exp_f32 v24, v24
    v_exp_f32 v25, v25
    v_exp_f32 v26, v26
    v_exp_f32 v27, v27
    s_nop 0
    v_add_f32 v24, 1.0, v24
    v_add_f32 v25, 1.0, v25
    v_add_f32 v26, 1.0, v26
    v_add_f32 v27, 1.0, v27
    v_rcp_f32 v24, v24
    v_rcp_f32 v25, v25
    v_rcp_f32 v26, v26
    v_rcp_f32 v27, v27
    s_nop 0
    v_mul_f32 v24, v24, v100
    v_mul_f32 v25, v25, v101
    v_mul_f32 v26, v26, v102
    v_mul_f32 v27, v27, v103
    v_cvt_pk_bf16_f32 v100, v24, v25
    v_cvt_pk_bf16_f32 v101, v26, v27
    ds_write_b64 v5, v[100:101] offset:1536
    s_waitcnt vmcnt(1)
    v_fma_mix_f32 v104, v160, v168, v104 op_sel:[0,0,0] op_sel_hi:[1,0,0]
    v_fma_mix_f32 v105, v160, v168, v105 op_sel:[1,0,0] op_sel_hi:[1,0,0]
    v_fma_mix_f32 v106, v161, v168, v106 op_sel:[0,0,0] op_sel_hi:[1,0,0]
    v_fma_mix_f32 v107, v161, v168, v107 op_sel:[1,0,0] op_sel_hi:[1,0,0]
    v_cvt_pk_bf16_f32 v28, v104, v105
    v_cvt_pk_bf16_f32 v29, v106, v107
    v_lshlrev_b32 v104, 16, v28
    v_and_b32 v105, 0xffff0000, v28
    v_lshlrev_b32 v106, 16, v29
    v_and_b32 v107, 0xffff0000, v29
    v_mul_f32 v24, 0xbfb8aa3b, v104
    v_mul_f32 v25, 0xbfb8aa3b, v105
    v_mul_f32 v26, 0xbfb8aa3b, v106
    v_mul_f32 v27, 0xbfb8aa3b, v107
    v_exp_f32 v24, v24
    v_exp_f32 v25, v25
    v_exp_f32 v26, v26
    v_exp_f32 v27, v27
    s_nop 0
    v_add_f32 v24, 1.0, v24
    v_add_f32 v25, 1.0, v25
    s_barrier
    v_add_f32 v26, 1.0, v26
    v_add_f32 v27, 1.0, v27
    v_rcp_f32 v24, v24
    v_rcp_f32 v25, v25
    v_rcp_f32 v26, v26
    v_rcp_f32 v27, v27
    s_nop 0
    v_mul_f32 v24, v24, v104
    v_mul_f32 v25, v25, v105
    v_mul_f32 v26, v26, v106
    v_mul_f32 v27, v27, v107
    v_cvt_pk_bf16_f32 v104, v24, v25
    v_cvt_pk_bf16_f32 v105, v26, v27
    ds_write_b64 v5, v[104:105] offset:2048
    v_fma_mix_f32 v108, v162, v168, v108 op_sel:[0,0,0] op_sel_hi:[1,0,0]
    v_fma_mix_f32 v109, v162, v168, v109 op_sel:[1,0,0] op_sel_hi:[1,0,0]
    v_fma_mix_f32 v110, v163, v168, v110 op_sel:[0,0,0] op_sel_hi:[1,0,0]
    v_fma_mix_f32 v111, v163, v168, v111 op_sel:[1,0,0] op_sel_hi:[1,0,0]
    v_cvt_pk_bf16_f32 v28, v108, v109
    v_cvt_pk_bf16_f32 v29, v110, v111
    v_lshlrev_b32 v108, 16, v28
    v_and_b32 v109, 0xffff0000, v28
    v_lshlrev_b32 v110, 16, v29
    v_and_b32 v111, 0xffff0000, v29
    v_mul_f32 v24, 0xbfb8aa3b, v108
    v_mul_f32 v25, 0xbfb8aa3b, v109
    v_mul_f32 v26, 0xbfb8aa3b, v110
    v_mul_f32 v27, 0xbfb8aa3b, v111
    v_exp_f32 v24, v24
    v_exp_f32 v25, v25
    v_exp_f32 v26, v26
    v_exp_f32 v27, v27
    s_nop 0
    v_add_f32 v24, 1.0, v24
    v_add_f32 v25, 1.0, v25
    v_add_f32 v26, 1.0, v26
    v_add_f32 v27, 1.0, v27
    v_rcp_f32 v24, v24
    v_rcp_f32 v25, v25
    v_rcp_f32 v26, v26
    v_rcp_f32 v27, v27
    s_nop 0
    v_mul_f32 v24, v24, v108
    v_mul_f32 v25, v25, v109
    v_mul_f32 v26, v26, v110
    v_mul_f32 v27, v27, v111
    v_cvt_pk_bf16_f32 v108, v24, v25
    v_cvt_pk_bf16_f32 v109, v26, v27
    ds_write_b64 v5, v[108:109] offset:2560
    s_barrier
    s_waitcnt vmcnt(0)
    v_fma_mix_f32 v112, v164, v168, v112 op_sel:[0,0,0] op_sel_hi:[1,0,0]
    v_fma_mix_f32 v113, v164, v168, v113 op_sel:[1,0,0] op_sel_hi:[1,0,0]
    v_fma_mix_f32 v114, v165, v168, v114 op_sel:[0,0,0] op_sel_hi:[1,0,0]
    v_fma_mix_f32 v115, v165, v168, v115 op_sel:[1,0,0] op_sel_hi:[1,0,0]
    v_cvt_pk_bf16_f32 v28, v112, v113
    v_cvt_pk_bf16_f32 v29, v114, v115
    v_lshlrev_b32 v112, 16, v28
    v_and_b32 v113, 0xffff0000, v28
    v_lshlrev_b32 v114, 16, v29
    v_and_b32 v115, 0xffff0000, v29
    v_mul_f32 v24, 0xbfb8aa3b, v112
    v_mul_f32 v25, 0xbfb8aa3b, v113
    v_mul_f32 v26, 0xbfb8aa3b, v114
    v_mul_f32 v27, 0xbfb8aa3b, v115
    v_exp_f32 v24, v24
    v_exp_f32 v25, v25
    v_exp_f32 v26, v26
    v_exp_f32 v27, v27
    s_nop 0
    v_add_f32 v24, 1.0, v24
    v_add_f32 v25, 1.0, v25
    v_add_f32 v26, 1.0, v26
    v_add_f32 v27, 1.0, v27
    v_rcp_f32 v24, v24
    v_rcp_f32 v25, v25
    v_rcp_f32 v26, v26
    v_rcp_f32 v27, v27
    s_nop 0
    v_mul_f32 v24, v24, v112
    v_mul_f32 v25, v25, v113
    v_mul_f32 v26, v26, v114
    v_mul_f32 v27, v27, v115
    v_cvt_pk_bf16_f32 v112, v24, v25
    v_cvt_pk_bf16_f32 v113, v26, v27
    ds_write_b64 v5, v[112:113] offset:3072
    v_fma_mix_f32 v116, v166, v168, v116 op_sel:[0,0,0] op_sel_hi:[1,0,0]
    v_fma_mix_f32 v117, v166, v168, v117 op_sel:[1,0,0] op_sel_hi:[1,0,0]
    v_fma_mix_f32 v118, v167, v168, v118 op_sel:[0,0,0] op_sel_hi:[1,0,0]
    v_fma_mix_f32 v119, v167, v168, v119 op_sel:[1,0,0] op_sel_hi:[1,0,0]
    v_cvt_pk_bf16_f32 v28, v116, v117
    v_cvt_pk_bf16_f32 v29, v118, v119
    v_lshlrev_b32 v116, 16, v28
    v_and_b32 v117, 0xffff0000, v28
    v_lshlrev_b32 v118, 16, v29
    v_and_b32 v119, 0xffff0000, v29
    v_mul_f32 v24, 0xbfb8aa3b, v116
    v_mul_f32 v25, 0xbfb8aa3b, v117
    v_mul_f32 v26, 0xbfb8aa3b, v118
    v_mul_f32 v27, 0xbfb8aa3b, v119
    v_exp_f32 v24, v24
    v_exp_f32 v25, v25
    v_exp_f32 v26, v26
    v_exp_f32 v27, v27
    s_nop 0
    v_add_f32 v24, 1.0, v24
    v_add_f32 v25, 1.0, v25
    s_barrier
    v_add_f32 v26, 1.0, v26
    v_add_f32 v27, 1.0, v27
    v_rcp_f32 v24, v24
    v_rcp_f32 v25, v25
    v_rcp_f32 v26, v26
    v_rcp_f32 v27, v27
    s_nop 0
    v_mul_f32 v24, v24, v116
    v_mul_f32 v25, v25, v117
    v_mul_f32 v26, v26, v118
    v_mul_f32 v27, v27, v119
    v_cvt_pk_bf16_f32 v116, v24, v25
    v_cvt_pk_bf16_f32 v117, v26, v27
    ds_write_b64 v5, v[116:117] offset:3584
    s_waitcnt lgkmcnt(0)
    s_barrier
    s_branch L_fin
.p2align 12
L_teamB:
    s_mov_b64 exec, -1
    s_setprio 3
    v_lshrrev_b32 v64, 4, v1
    v_bfe_u32 v65, v1, 2, 2
    v_and_b32 v66, 3, v1
    v_and_b32 v67, 15, v1
    v_lshrrev_b32 v68, 3, v1
    v_and_b32 v69, 7, v1
    s_lshl_b32 s85, s28, 7
    s_lshl_b32 s86, s4, 5
    s_add_u32 s86, s85, s86
    v_add_u32 v71, s86, v68
    v_xor_b32 v70, v69, v64
    v_lshlrev_b32 v70, 4, v70
    v_lshl_add_u32 v20, v71, 11, v70
    v_xor_b32 v21, 64, v20
    v_add_u32 v21, 16384, v21
    s_lshl_b32 s79, s4, 12
    s_and_b32 s72, s28, 3
    s_bitcmp1_b32 s28, 3
    s_cselect_b32 s91, 4, 0
    s_add_u32 s72, s72, s91
    s_mul_i32 s72, s72, 256
    s_waitcnt lgkmcnt(0)
    s_mov_b32 s36, s8
    s_mov_b32 s37, s9
    s_mov_b32 s38, 0x400000
    s_mov_b32 s39, 0x20000
    s_add_u32 m0, s79, 135168
    s_add_u32 s72, s72, 128
    s_and_b32 s78, s72, 0x7ff
    buffer_load_dwordx4 v20, s[36:39], s78 offen lds
    s_add_u32 m0, s79, 136192
    s_nop 0
    buffer_load_dwordx4 v21, s[36:39], s78 offen lds
    s_add_u32 m0, s79, 137216
    s_add_u32 s78, s78, 32768
    buffer_load_dwordx4 v20, s[36:39], s78 offen lds
    s_add_u32 m0, s79, 138240
    s_nop 0
    buffer_load_dwordx4 v21, s[36:39], s78 offen lds
    s_setprio 0
    s_mov_b32 s68, s26
    s_mov_b32 s69, s27
    s_mov_b32 s70, 0x10000000
    s_mov_b32 s71, 0x20000
L_fan5:
    s_cbranch_execz L_teamB
    s_lshl_b32 s85, s4, 3
    s_and_b32 s86, s4, 1
    s_lshl_b32 s86, s86, 2
    v_and_b32 v70, 2, v68
    v_xor_b32 v70, v70, v69
    v_xor_b32 v70, s86, v70
    v_add_u32 v71, s85, v68
    v_mul_u32_u24 v71, 7168, v71
    v_lshl_add_u32 v22, v70, 4, v71
    v_lshrrev_b32 v71, 2, v1
    s_lshl_b32 s86, s86, 2
    v_add_u32 v71, s86, v71
    v_mul_u32_u24 v71, 7168, v71
    v_and_b32 v70, 2, v64
    v_xor_b32 v70, v70, v66
    v_lshl_add_u32 v9, v70, 4, v71
    s_mul_i32 s85, s29, 320
    s_and_b32 s86, s29, 1
    s_lshl_b32 s87, s86, 6
    s_add_u32 s87, s87, s85
    s_add_u32 s40, s16, s87
    s_addc_u32 s41, s17, 0
    s_sub_u32 s42, 7340032, s87
    s_mov_b32 s43, 0x20000
    s_add_u32 s44, s18, s87
    s_addc_u32 s45, s19, 0
    s_sub_u32 s46, 7340032, s87
    s_mov_b32 s47, 0x20000
    s_xor_b32 s86, s86, 1
    s_lshl_b32 s86, s86, 8
    s_add_u32 s87, s86, s85
    s_cmp_lt_u32 s4, 2
    s_cselect_b32 s88, s16, s18
    s_cselect_b32 s89, s17, s19
    s_add_u32 s48, s88, s87
    s_addc_u32 s49, s89, 0
    s_sub_u32 s50, 7340032, s87
    s_mov_b32 s51, 0x20000
    s_and_b32 s77, s28, 3
    s_bitcmp1_b32 s28, 3
    s_cselect_b32 s91, 4, 0
    s_add_u32 s77, s77, s91
    s_mul_i32 s77, s77, 917504
    s_add_u32 s77, s77, 0x38000
    s_add_u32 m0, s33, 57344
    s_add_u32 s77, s77, 229376
    s_cmp_eq_u32 s77, 7340032
    s_cselect_b32 s77, 0, s77
L_fan6:
    s_cbranch_execz L_teamB
    buffer_load_dwordx4 v22, s[40:43], s77 offen offset:0 lds
    s_add_u32 m0, s33, 61312
    s_nop 0
    buffer_load_dwordx4 v22, s[40:43], s77 offen offset:128 lds
    s_add_u32 m0, s33, 65536
    s_nop 0
    buffer_load_dwordx4 v22, s[44:47], s77 offen offset:0 lds
    s_add_u32 m0, s33, 69504
    s_nop 0
    buffer_load_dwordx4 v22, s[44:47], s77 offen offset:128 lds
    s_add_u32 m0, s33, 73728
    s_nop 0
    buffer_load_dwordx4 v9, s[48:51], s77 offen lds
    s_lshl_b32 s84, s28, 7
    s_lshl_b32 s85, s29, 3
    s_add_u32 s84, s84, s85
    s_lshl1_add_u32 s84, s4, s84
    s_lshl_b32 s90, s84, 3
    s_lshl_b32 s84, s84, 11
    v_lshl_add_u32 v86, v1, 4, s84
    v_and_b32 v70, 1, v67
    v_lshlrev_b32 v70, 4, v70
    v_mov_b32 v71, 0x3f80
    v_lshlrev_b32 v70, v70, v71
    v_lshrrev_b32 v71, 1, v67
    v_cmp_eq_u32 vcc, 0, v71
    s_nop 1
    v_cndmask_b32 v144, 0, v70, vcc
    v_cmp_eq_u32 vcc, 1, v71
    s_nop 1
    v_cndmask_b32 v145, 0, v70, vcc
    v_cmp_eq_u32 vcc, 2, v71
    s_nop 1
    v_cndmask_b32 v146, 0, v70, vcc
    v_cmp_eq_u32 vcc, 3, v71
    s_nop 1
    v_cndmask_b32 v147, 0, v70, vcc
    s_lshl_b32 s91, s4, 12
    s_add_u32 s91, s91, 16384
    v_lshlrev_b32 v70, 1, v64
    v_xor_b32 v71, v69, v70
    v_lshl_add_u32 v71, v71, 4, s91
    v_and_b32 v148, 4, v70
    v_add_u32 v70, v70, v148
    v_and_b32 v148, 1, v68
    v_add_u32 v70, v70, v148
    v_lshl_add_u32 v148, v70, 7, v71
    s_lshl_b32 s91, s5, 11
    s_add_u32 s91, s91, 32768
L_fan7:
    s_cbranch_execz L_teamB
    v_and_b32 v70, 2, v64
    v_xor_b32 v70, v66, v70
    v_lshl_add_u32 v70, v70, 4, s91
    v_lshrrev_b32 v71, 2, v1
    v_lshl_add_u32 v149, v71, 6, v70
    s_lshl2_add_u32 s91, s2, s4
    s_lshl_b32 s52, s91, 9
    s_lshr_b32 s92, s91, 2
    s_mul_i32 s92, s92, 7168
    s_and_b32 s91, s91, 3
    s_lshl_b32 s91, s91, 9
    s_add_u32 s92, s92, s91
    s_add_u32 s53, s92, 5120
    s_barrier
    s_and_b32 s91, s28, 4
    s_cmp_eq_u32 s91, 0
    s_cbranch_scc0 L_cr0
    ds_read_b128 v[112:115], v148 offset:0
    ds_read_b128 v[116:119], v148 offset:512
    ds_read_b128 v[120:123], v148 offset:2048
    ds_read_b128 v[124:127], v148 offset:2560
    ds_read_b128 v[128:131], v149 offset:0
    ds_read_b128 v[132:135], v149 offset:1024
L_cr0:
    s_add_u32 m0, s33, 77824
    s_add_u32 s77, s77, 229376
    buffer_load_dwordx4 v22, s[40:43], s77 offen offset:0 lds
    s_add_u32 m0, s33, 81792
    s_nop 0
    buffer_load_dwordx4 v22, s[40:43], s77 offen offset:128 lds
    s_add_u32 m0, s33, 86016
    s_nop 0
    buffer_load_dwordx4 v22, s[44:47], s77 offen offset:0 lds
    s_add_u32 m0, s33, 89984
    s_nop 0
    buffer_load_dwordx4 v22, s[44:47], s77 offen offset:128 lds
    s_add_u32 m0, s33, 94208
    s_nop 0
    buffer_load_dwordx4 v9, s[48:51], s77 offen lds
    s_add_u32 m0, s79, 98304
    s_add_u32 s72, s72, 128
    s_and_b32 s78, s72, 0x7ff
    buffer_load_dwordx4 v20, s[36:39], s78 offen lds
    s_add_u32 m0, s79, 99328
    s_nop 0
    buffer_load_dwordx4 v21, s[36:39], s78 offen lds
    s_and_b32 s91, s28, 4
    s_cmp_eq_u32 s91, 0
    s_cbranch_scc0 L_cm0
    s_waitcnt lgkmcnt(0)
    s_setprio 2
    v_mfma_f32_16x16x32_bf16 v[136:139], v[144:147], v[112:115], 0
    v_mfma_f32_16x16x32_bf16 v[140:143], v[144:147], v[128:131], 0
    v_mfma_f32_16x16x32_bf16 v[136:139], v[144:147], v[116:119], v[136:139]
    v_mfma_f32_16x16x32_bf16 v[140:143], v[144:147], v[132:135], v[140:143]
    v_mfma_f32_16x16x32_bf16 v[136:139], v[144:147], v[120:123], v[136:139]
    v_mfma_f32_16x16x32_bf16 v[136:139], v[144:147], v[124:127], v[136:139]
    s_setprio 0
L_cm0:
    s_barrier
    s_and_b32 s91, s28, 4
    s_cmp_eq_u32 s91, 0
    s_cbranch_scc0 L_cr1
    ds_read_b128 v[112:115], v148 offset:20480
    ds_read_b128 v[116:119], v148 offset:20992
    ds_read_b128 v[120:123], v148 offset:22528
    ds_read_b128 v[124:127], v148 offset:23040
    ds_read_b128 v[128:131], v149 offset:20480
    ds_read_b128 v[132:135], v149 offset:21504
L_cr1:
    s_add_u32 m0, s79, 100352
    s_add_u32 s78, s78, 32768
    buffer_load_dwordx4 v20, s[36:39], s78 offen lds
    s_add_u32 m0, s79, 101376
    s_nop 0
    buffer_load_dwordx4 v21, s[36:39], s78 offen lds
    s_add_u32 m0, s33, 16384
    s_add_u32 s77, s77, 229376
    s_cmp_eq_u32 s77, 7340032
    s_cselect_b32 s77, 0, s77
    buffer_load_dwordx4 v22, s[40:43], s77 offen offset:0 lds
    s_add_u32 m0, s33, 20352
    s_nop 0
    buffer_load_dwordx4 v22, s[40:43], s77 offen offset:128 lds
    s_add_u32 m0, s33, 24576
    s_nop 0
    buffer_load_dwordx4 v22, s[44:47], s77 offen offset:0 lds
    s_add_u32 m0, s33, 28544
    s_nop 0
    buffer_load_dwordx4 v22, s[44:47], s77 offen offset:128 lds
    s_add_u32 m0, s33, 32768
    s_nop 0
    buffer_load_dwordx4 v9, s[48:51], s77 offen lds
    s_and_b32 s91, s28, 4
    s_cmp_eq_u32 s91, 0
    s_cbranch_scc0 L_cm1
    s_waitcnt lgkmcnt(0)
    s_setprio 2
    v_mfma_f32_16x16x32_bf16 v[136:139], v[144:147], v[112:115], v[136:139]
    v_mfma_f32_16x16x32_bf16 v[140:143], v[144:147], v[128:131], v[140:143]
    v_mfma_f32_16x16x32_bf16 v[136:139], v[144:147], v[116:119], v[136:139]
    v_mfma_f32_16x16x32_bf16 v[140:143], v[144:147], v[132:135], v[140:143]
    v_mfma_f32_16x16x32_bf16 v[136:139], v[144:147], v[120:123], v[136:139]
    v_mfma_f32_16x16x32_bf16 v[136:139], v[144:147], v[124:127], v[136:139]
    s_setprio 0
L_cm1:
    s_waitcnt vmcnt(14)
    s_barrier
    s_and_b32 s91, s28, 4
    s_cmp_eq_u32 s91, 4
    s_cbranch_scc0 L_cr2
    ds_read_b128 v[112:115], v148 offset:40960
    ds_read_b128 v[116:119], v148 offset:41472
    ds_read_b128 v[120:123], v148 offset:43008
    ds_read_b128 v[124:127], v148 offset:43520
    ds_read_b128 v[128:131], v149 offset:40960
    ds_read_b128 v[132:135], v149 offset:41984
L_cr2:
    global_load_dwordx4 v[24:27], v86, s[8:9] offset:0
    global_load_dwordx4 v[32:35], v86, s[8:9] offset:2048
    global_load_dwordx4 v[28:31], v86, s[8:9] offset:1024
    global_load_dwordx4 v[36:39], v86, s[8:9] offset:3072
    s_add_u32 m0, s79, 116736
    s_add_u32 s72, s72, 128
    s_and_b32 s78, s72, 0x7ff
    buffer_load_dwordx4 v20, s[36:39], s78 offen lds
    s_add_u32 m0, s79, 117760
    s_nop 0
    buffer_load_dwordx4 v21, s[36:39], s78 offen lds
    s_add_u32 m0, s33, 36864
    s_add_u32 s77, s77, 229376
    buffer_load_dwordx4 v22, s[40:43], s77 offen offset:0 lds
    s_add_u32 m0, s33, 40832
    s_nop 0
    buffer_load_dwordx4 v22, s[40:43], s77 offen offset:128 lds
    s_add_u32 m0, s33, 45056
    s_nop 0
    buffer_load_dwordx4 v22, s[44:47], s77 offen offset:0 lds
    s_add_u32 m0, s33, 49024
    s_nop 0
    buffer_load_dwordx4 v22, s[44:47], s77 offen offset:128 lds
    s_add_u32 m0, s33, 53248
    s_nop 0
    buffer_load_dwordx4 v9, s[48:51], s77 offen lds
    s_and_b32 s91, s28, 4
    s_cmp_eq_u32 s91, 4
    s_cbranch_scc0 L_cm2
    s_waitcnt lgkmcnt(0)
    s_setprio 2
    v_mfma_f32_16x16x32_bf16 v[136:139], v[144:147], v[112:115], 0
    v_mfma_f32_16x16x32_bf16 v[140:143], v[144:147], v[128:131], 0
    v_mfma_f32_16x16x32_bf16 v[136:139], v[144:147], v[116:119], v[136:139]
    v_mfma_f32_16x16x32_bf16 v[140:143], v[144:147], v[132:135], v[140:143]
    v_mfma_f32_16x16x32_bf16 v[136:139], v[144:147], v[120:123], v[136:139]
    v_mfma_f32_16x16x32_bf16 v[136:139], v[144:147], v[124:127], v[136:139]
    s_setprio 0
L_cm2:
    s_waitcnt vmcnt(20)
    s_barrier
    s_and_b32 s91, s28, 4
    s_cmp_eq_u32 s91, 4
    s_cbranch_scc0 L_cr3
    ds_read_b128 v[112:115], v148 offset:61440
    ds_read_b128 v[116:119], v148 offset:61952
    ds_read_b128 v[120:123], v148 offset:63488
    ds_read_b128 v[124:127], v148 offset:64000
    ds_read_b128 v[128:131], v149 offset:61440
    ds_read_b128 v[132:135], v149 offset:62464
L_cr3:
    s_add_u32 m0, s79, 118784
    s_add_u32 s78, s78, 32768
    buffer_load_dwordx4 v20, s[36:39], s78 offen lds
    s_add_u32 m0, s79, 119808
    s_nop 0
    buffer_load_dwordx4 v21, s[36:39], s78 offen lds
    s_add_u32 m0, s33, 57344
    s_add_u32 s77, s77, 229376
    s_cmp_eq_u32 s77, 7340032
    s_cselect_b32 s77, 0, s77
    buffer_load_dwordx4 v22, s[40:43], s77 offen offset:0 lds
    s_add_u32 m0, s33, 61312
    s_nop 0
    buffer_load_dwordx4 v22, s[40:43], s77 offen offset:128 lds
    s_add_u32 m0, s33, 65536
    s_nop 0
    buffer_load_dwordx4 v22, s[44:47], s77 offen offset:0 lds
    s_add_u32 m0, s33, 69504
    s_nop 0
    buffer_load_dwordx4 v22, s[44:47], s77 offen offset:128 lds
    s_add_u32 m0, s33, 73728
    s_nop 0
    buffer_load_dwordx4 v9, s[48:51], s77 offen lds
    s_and_b32 s91, s28, 4
    s_cmp_eq_u32 s91, 4
    s_cbranch_scc0 L_cm3
    s_waitcnt lgkmcnt(0)
    s_setprio 2
    v_mfma_f32_16x16x32_bf16 v[136:139], v[144:147], v[112:115], v[136:139]
    v_mfma_f32_16x16x32_bf16 v[140:143], v[144:147], v[128:131], v[140:143]
    v_mfma_f32_16x16x32_bf16 v[136:139], v[144:147], v[116:119], v[136:139]
    v_mfma_f32_16x16x32_bf16 v[140:143], v[144:147], v[132:135], v[140:143]
    v_mfma_f32_16x16x32_bf16 v[136:139], v[144:147], v[120:123], v[136:139]
    v_mfma_f32_16x16x32_bf16 v[136:139], v[144:147], v[124:127], v[136:139]
    s_setprio 0
L_cm3:
    s_sub_u32 s91, s2, 224
    s_lshl1_add_u32 s91, s91, 1
    s_cmp_ge_u32 s2, 224
    s_cselect_b32 s91, s91, s2
    s_cselect_b32 s88, s12, s20
    s_cselect_b32 s89, s13, s21
    s_cselect_b32 s34, 0x800000, 0
    s_lshr_b32 s92, s91, 2
    s_lshl_b32 s92, s92, 17
    s_add_u32 s34, s34, s92
    s_and_b32 s93, s91, 3
    s_lshl_b32 s93, s93, 13
    s_add_u32 s34, s34, s93
    s_and_b32 s93, s91, 1
    s_lshl_b32 s93, s93, 7
    s_add_u32 s92, s92, s93
    s_and_b32 s93, s91, 2
    s_lshl_b32 s93, s93, 9
    s_add_u32 s92, s92, s93
    s_add_u32 s92, s92, 256
    s_add_u32 s88, s88, s92
    s_addc_u32 s89, s89, 0
    s_lshl_b32 s76, s4, 15
    s_waitcnt vmcnt(18)
    s_barrier
    s_add_u32 m0, s79, 135168
    s_add_u32 s72, s72, 128
    s_and_b32 s78, s72, 0x7ff
    buffer_load_dwordx4 v20, s[36:39], s78 offen lds
    s_add_u32 m0, s79, 136192
    s_nop 0
    buffer_load_dwordx4 v21, s[36:39], s78 offen lds
    s_add_u32 m0, s33, 77824
    s_add_u32 s77, s77, 229376
    buffer_load_dwordx4 v22, s[40:43], s77 offen offset:0 lds
    s_add_u32 m0, s33, 81792
    s_nop 0
    buffer_load_dwordx4 v22, s[40:43], s77 offen offset:128 lds
    s_add_u32 m0, s33, 86016
    s_nop 0
    buffer_load_dwordx4 v22, s[44:47], s77 offen offset:0 lds
    s_add_u32 m0, s33, 89984
    s_nop 0
    buffer_load_dwordx4 v22, s[44:47], s77 offen offset:128 lds
    s_add_u32 m0, s33, 94208
    s_nop 0
    buffer_load_dwordx4 v9, s[48:51], s77 offen lds
    v_add_f32_dpp v136, v136, v136 row_ror:8 row_mask:0xf bank_mask:0xf
    v_add_f32_dpp v137, v137, v137 row_ror:8 row_mask:0xf bank_mask:0xf
    v_add_f32_dpp v138, v138, v138 row_ror:8 row_mask:0xf bank_mask:0xf
    v_add_f32_dpp v139, v139, v139 row_ror:8 row_mask:0xf bank_mask:0xf
    v_add_f32_dpp v140, v140, v140 row_ror:8 row_mask:0xf bank_mask:0xf
    v_add_f32_dpp v141, v141, v141 row_ror:8 row_mask:0xf bank_mask:0xf
    v_add_f32_dpp v142, v142, v142 row_ror:8 row_mask:0xf bank_mask:0xf
    v_add_f32_dpp v143, v143, v143 row_ror:8 row_mask:0xf bank_mask:0xf
    v_add_f32_dpp v140, v140, v140 row_ror:4 row_mask:0xf bank_mask:0xf
    v_add_f32_dpp v141, v141, v141 row_ror:4 row_mask:0xf bank_mask:0xf
    v_add_f32_dpp v142, v142, v142 row_ror:4 row_mask:0xf bank_mask:0xf
    v_add_f32_dpp v143, v143, v143 row_ror:4 row_mask:0xf bank_mask:0xf
    s_lshl_b32 s91, s29, 4
    s_add_u32 s91, s91, s28
    s_mul_i32 s91, s91, 1280
    s_mul_i32 s92, s5, 640
    s_add_u32 s91, s91, s92
    s_add_u32 s91, s91, 0x1e10000
    s_lshl_b32 s92, s6, 8
    v_and_b32 v112, 8, v1
    v_cmp_eq_u32 vcc, 0, v112
    v_mov_b32 v112, s92
    v_mov_b32 v113, 256
    v_cndmask_b32 v112, v113, v112, vcc
    v_cndmask_b32 v136, v140, v136, vcc
    v_cndmask_b32 v137, v141, v137, vcc
    v_cndmask_b32 v138, v142, v138, vcc
    v_cndmask_b32 v139, v143, v139, vcc
    v_and_b32 v113, 15, v1
    v_lshl_add_u32 v112, v113, 5, v112
    v_and_b32 v113, 16, v1
    v_add3_u32 v112, v112, v113, s91
    s_mov_b64 exec, 0x0fff0fff
    global_store_dwordx4 v112, v[136:139], s[26:27] sc1
    s_mov_b64 exec, -1
    s_load_dword s94, s[88:89], s76 offset:0
    s_load_dword s94, s[88:89], s76 offset:64
    s_load_dword s94, s[88:89], s76 offset:2048
    s_load_dword s94, s[88:89], s76 offset:2112
    s_waitcnt vmcnt(15)
    s_barrier
    s_add_u32 m0, s79, 137216
    s_add_u32 s78, s78, 32768
    buffer_load_dwordx4 v20, s[36:39], s78 offen lds
    s_waitcnt vmcnt(23)
    v_lshlrev_b32 v40, 16, v24
    v_and_b32 v41, 0xffff0000, v24
    v_lshlrev_b32 v42, 16, v25
    v_and_b32 v43, 0xffff0000, v25
    v_lshlrev_b32 v44, 16, v26
    v_and_b32 v45, 0xffff0000, v26
    v_lshlrev_b32 v46, 16, v27
    v_and_b32 v47, 0xffff0000, v27
    s_add_u32 m0, s79, 138240
    s_nop 0
    buffer_load_dwordx4 v21, s[36:39], s78 offen lds
    v_lshlrev_b32 v48, 16, v28
    v_and_b32 v49, 0xffff0000, v28
    v_lshlrev_b32 v50, 16, v29
    v_and_b32 v51, 0xffff0000, v29
    v_lshlrev_b32 v52, 16, v30
    v_and_b32 v53, 0xffff0000, v30
    v_lshlrev_b32 v54, 16, v31
    v_and_b32 v55, 0xffff0000, v31
    s_add_u32 m0, s33, 16384
    s_add_u32 s77, s77, 229376
    s_cmp_eq_u32 s77, 7340032
    s_cselect_b32 s77, 0, s77
    buffer_load_dwordx4 v22, s[40:43], s77 offen offset:0 lds
    v_lshlrev_b32 v56, 16, v32
    v_and_b32 v57, 0xffff0000, v32
    v_lshlrev_b32 v58, 16, v33
    v_and_b32 v59, 0xffff0000, v33
    v_lshlrev_b32 v60, 16, v34
    v_and_b32 v61, 0xffff0000, v34
    v_lshlrev_b32 v62, 16, v35
    v_and_b32 v63, 0xffff0000, v35
    s_add_u32 m0, s33, 20352
    s_nop 0
    buffer_load_dwordx4 v22, s[40:43], s77 offen offset:128 lds
    v_lshlrev_b32 v64, 16, v36
    v_and_b32 v65, 0xffff0000, v36
    v_lshlrev_b32 v66, 16, v37
    v_and_b32 v67, 0xffff0000, v37
    v_lshlrev_b32 v68, 16, v38
    v_and_b32 v69, 0xffff0000, v38
    v_lshlrev_b32 v70, 16, v39
    v_and_b32 v71, 0xffff0000, v39
    s_add_u32 m0, s33, 24576
    s_nop 0
    buffer_load_dwordx4 v22, s[44:47], s77 offen offset:0 lds
    v_add_f32 v72, v40, v41
    v_add_f32 v74, v56, v57
    v_add_f32 v72, v72, v42
    v_add_f32 v74, v74, v58
    v_add_f32 v72, v72, v43
    v_add_f32 v74, v74, v59
    v_add_f32 v72, v72, v44
    v_add_f32 v74, v74, v60
    s_add_u32 m0, s33, 28544
    s_nop 0
    buffer_load_dwordx4 v22, s[44:47], s77 offen offset:128 lds
    s_add_u32 m0, s33, 32768
    s_nop 0
    buffer_load_dwordx4 v9, s[48:51], s77 offen lds
    v_add_f32 v72, v72, v45
    v_add_f32 v74, v74, v61
    v_add_f32 v72, v72, v46
    v_add_f32 v74, v74, v62
    v_add_f32 v72, v72, v47
    v_add_f32 v74, v74, v63
    v_add_f32 v72, v72, v48
    v_add_f32 v74, v74, v64
    s_load_dword s94, s[88:89], s76 offset:4096
    s_load_dword s94, s[88:89], s76 offset:4160
    s_load_dword s94, s[88:89], s76 offset:6144
    s_load_dword s94, s[88:89], s76 offset:6208
    s_waitcnt vmcnt(15)
    s_barrier
    s_add_u32 m0, s79, 98304
    s_add_u32 s72, s72, 128
    s_and_b32 s78, s72, 0x7ff
    buffer_load_dwordx4 v20, s[36:39], s78 offen lds
    v_add_f32 v72, v72, v49
    v_add_f32 v74, v74, v65
    v_add_f32 v72, v72, v50
    v_add_f32 v74, v74, v66
    v_add_f32 v72, v72, v51
    v_add_f32 v74, v74, v67
    v_add_f32 v72, v72, v52
    v_add_f32 v74, v74, v68
    s_add_u32 m0, s79, 99328
    s_nop 0
    buffer_load_dwordx4 v21, s[36:39], s78 offen lds
    v_add_f32 v72, v72, v53
    v_add_f32 v74, v74, v69
    v_add_f32 v72, v72, v54
    v_add_f32 v74, v74, v70
    v_add_f32 v72, v72, v55
    v_add_f32 v74, v74, v71
    s_nop 0
    v_add_f32_dpp v72, v72, v72 quad_perm:[1,0,3,2] row_mask:0xf bank_mask:0xf
    v_add_f32_dpp v74, v74, v74 quad_perm:[1,0,3,2] row_mask:0xf bank_mask:0xf
    s_add_u32 m0, s33, 36864
    s_add_u32 s77, s77, 229376
    buffer_load_dwordx4 v22, s[40:43], s77 offen offset:0 lds
    s_nop 0
    v_add_f32_dpp v72, v72, v72 quad_perm:[2,3,0,1] row_mask:0xf bank_mask:0xf
    v_add_f32_dpp v74, v74, v74 quad_perm:[2,3,0,1] row_mask:0xf bank_mask:0xf
    s_nop 0
    v_add_f32_dpp v72, v72, v72 row_half_mirror row_mask:0xf bank_mask:0xf
    v_add_f32_dpp v74, v74, v74 row_half_mirror row_mask:0xf bank_mask:0xf
    s_nop 0
    v_add_f32_dpp v72, v72, v72 row_mirror row_mask:0xf bank_mask:0xf
    v_add_f32_dpp v74, v74, v74 row_mirror row_mask:0xf bank_mask:0xf
    v_mov_b32 v78, v72
    s_add_u32 m0, s33, 40832
    s_nop 0
    buffer_load_dwordx4 v22, s[40:43], s77 offen offset:128 lds
    v_mov_b32 v79, v74
    s_nop 0
    v_permlane16_swap_b32 v72, v78
    v_permlane16_swap_b32 v74, v79
    v_add_f32 v72, v72, v78
    v_add_f32 v74, v74, v79
    v_mov_b32 v78, v72
    v_mov_b32 v79, v74
    s_nop 0
    v_permlane32_swap_b32 v72, v78
    s_add_u32 m0, s33, 45056
    s_nop 0
    buffer_load_dwordx4 v22, s[44:47], s77 offen offset:0 lds
    s_add_u32 m0, s33, 49024
    s_nop 0
    buffer_load_dwordx4 v22, s[44:47], s77 offen offset:128 lds
    v_permlane32_swap_b32 v74, v79
    v_add_f32 v72, v72, v78
    v_add_f32 v74, v74, v79
    v_mul_f32 v72, 0x3a800000, v72
    v_mul_f32 v74, 0x3a800000, v74
    v_sub_f32 v78, v40, v72
    v_sub_f32 v79, v56, v74
    v_mul_f32 v73, v78, v78
    s_add_u32 m0, s33, 53248
    s_nop 0
    buffer_load_dwordx4 v9, s[48:51], s77 offen lds
    v_mul_f32 v75, v79, v79
    v_sub_f32 v78, v41, v72
    v_sub_f32 v79, v57, v74
    v_fmac_f32 v73, v78, v78
    v_fmac_f32 v75, v79, v79
    v_sub_f32 v78, v42, v72
    v_sub_f32 v79, v58, v74
    v_fmac_f32 v73, v78, v78
    s_load_dword s94, s[88:89], s76 offset:8192
    s_load_dword s94, s[88:89], s76 offset:8256
    s_load_dword s94, s[88:89], s76 offset:10240
    s_load_dword s94, s[88:89], s76 offset:10304
    s_waitcnt vmcnt(15)
    s_barrier
    s_add_u32 m0, s79, 100352
    s_add_u32 s78, s78, 32768
    buffer_load_dwordx4 v20, s[36:39], s78 offen lds
    v_fmac_f32 v75, v79, v79
    v_sub_f32 v78, v43, v72
    v_sub_f32 v79, v59, v74
    v_fmac_f32 v73, v78, v78
    v_fmac_f32 v75, v79, v79
    v_sub_f32 v78, v44, v72
    v_sub_f32 v79, v60, v74
    v_fmac_f32 v73, v78, v78
    s_add_u32 m0, s79, 101376
    s_nop 0
    buffer_load_dwordx4 v21, s[36:39], s78 offen lds
    v_fmac_f32 v75, v79, v79
    v_sub_f32 v78, v45, v72
    v_sub_f32 v79, v61, v74
    v_fmac_f32 v73, v78, v78
    v_fmac_f32 v75, v79, v79
    v_sub_f32 v78, v46, v72
    v_sub_f32 v79, v62, v74
    v_fmac_f32 v73, v78, v78
    s_add_u32 m0, s33, 57344
    s_add_u32 s77, s77, 229376
    s_cmp_eq_u32 s77, 7340032
    s_cselect_b32 s77, 0, s77
    buffer_load_dwordx4 v22, s[40:43], s77 offen offset:0 lds
    v_fmac_f32 v75, v79, v79
    v_sub_f32 v78, v47, v72
    v_sub_f32 v79, v63, v74
    v_fmac_f32 v73, v78, v78
    v_fmac_f32 v75, v79, v79
    v_sub_f32 v78, v48, v72
    v_sub_f32 v79, v64, v74
    v_fmac_f32 v73, v78, v78
    s_add_u32 m0, s33, 61312
    s_nop 0
    buffer_load_dwordx4 v22, s[40:43], s77 offen offset:128 lds
    v_fmac_f32 v75, v79, v79
    v_sub_f32 v78, v49, v72
    v_sub_f32 v79, v65, v74
    v_fmac_f32 v73, v78, v78
    v_fmac_f32 v75, v79, v79
    v_sub_f32 v78, v50, v72
    v_sub_f32 v79, v66, v74
    v_fmac_f32 v73, v78, v78
    s_add_u32 m0, s33, 65536
    s_nop 0
    buffer_load_dwordx4 v22, s[44:47], s77 offen offset:0 lds
    v_fmac_f32 v75, v79, v79
    v_sub_f32 v78, v51, v72
    v_sub_f32 v79, v67, v74
    v_fmac_f32 v73, v78, v78
    v_fmac_f32 v75, v79, v79
    v_sub_f32 v78, v52, v72
    v_sub_f32 v79, v68, v74
    v_fmac_f32 v73, v78, v78
    s_add_u32 m0, s33, 69504
    s_nop 0
    buffer_load_dwordx4 v22, s[44:47], s77 offen offset:128 lds
    s_add_u32 m0, s33, 73728
    s_nop 0
    buffer_load_dwordx4 v9, s[48:51], s77 offen lds
    v_fmac_f32 v75, v79, v79
    v_sub_f32 v78, v53, v72
    v_sub_f32 v79, v69, v74
    v_fmac_f32 v73, v78, v78
    v_fmac_f32 v75, v79, v79
    v_sub_f32 v78, v54, v72
    v_sub_f32 v79, v70, v74
    v_fmac_f32 v73, v78, v78
    s_load_dword s94, s[88:89], s76 offset:12288
    s_load_dword s94, s[88:89], s76 offset:12352
    s_load_dword s94, s[88:89], s76 offset:14336
    s_load_dword s94, s[88:89], s76 offset:14400
    s_waitcnt vmcnt(14)
    s_barrier
    s_add_u32 m0, s79, 116736
    s_add_u32 s72, s72, 128
    s_and_b32 s78, s72, 0x7ff
    buffer_load_dwordx4 v20, s[36:39], s78 offen lds
    v_fmac_f32 v75, v79, v79
    v_sub_f32 v78, v55, v72
    v_sub_f32 v79, v71, v74
    v_fmac_f32 v73, v78, v78
    v_fmac_f32 v75, v79, v79
    s_nop 0
    v_add_f32_dpp v73, v73, v73 quad_perm:[1,0,3,2] row_mask:0xf bank_mask:0xf
    v_add_f32_dpp v75, v75, v75 quad_perm:[1,0,3,2] row_mask:0xf bank_mask:0xf
    s_nop 0
    v_add_f32_dpp v73, v73, v73 quad_perm:[2,3,0,1] row_mask:0xf bank_mask:0xf
    s_add_u32 m0, s79, 117760
    s_nop 0
    buffer_load_dwordx4 v21, s[36:39], s78 offen lds
    v_add_f32_dpp v75, v75, v75 quad_perm:[2,3,0,1] row_mask:0xf bank_mask:0xf
    s_nop 0
    v_add_f32_dpp v73, v73, v73 row_half_mirror row_mask:0xf bank_mask:0xf
    v_add_f32_dpp v75, v75, v75 row_half_mirror row_mask:0xf bank_mask:0xf
    s_nop 0
    v_add_f32_dpp v73, v73, v73 row_mirror row_mask:0xf bank_mask:0xf
    v_add_f32_dpp v75, v75, v75 row_mirror row_mask:0xf bank_mask:0xf
    v_mov_b32 v78, v73
    v_mov_b32 v79, v75
    s_add_u32 m0, s33, 77824
    s_add_u32 s77, s77, 229376
    buffer_load_dwordx4 v22, s[40:43], s77 offen offset:0 lds
    s_nop 0
    v_permlane16_swap_b32 v73, v78
    v_permlane16_swap_b32 v75, v79
L_pad6:
    s_cbranch_execz L_vret0
    v_add_f32 v73, v73, v78
    v_add_f32 v75, v75, v79
    v_mov_b32 v78, v73
    v_mov_b32 v79, v75
    s_nop 0
    v_permlane32_swap_b32 v73, v78
    s_add_u32 m0, s33, 81792
    s_nop 0
    buffer_load_dwordx4 v22, s[40:43], s77 offen offset:128 lds
    v_permlane32_swap_b32 v75, v79
    v_add_f32 v73, v73, v78
    v_add_f32 v75, v75, v79
    v_mul_f32 v73, 0x3a800000, v73
    v_mul_f32 v75, 0x3a800000, v75
    v_cvt_pk_bf16_f32 v72, v72, v72
    v_lshlrev_b32 v72, 16, v72
    v_cvt_pk_bf16_f32 v73, v73, v73
    s_add_u32 m0, s33, 86016
    s_nop 0
    buffer_load_dwordx4 v22, s[44:47], s77 offen offset:0 lds
    s_add_u32 m0, s33, 89984
    s_nop 0
    buffer_load_dwordx4 v22, s[44:47], s77 offen offset:128 lds
    v_lshlrev_b32 v73, 16, v73
    v_add_f32 v73, 0x3727c5ac, v73
    v_cvt_pk_bf16_f32 v73, v73, v73
    v_lshlrev_b32 v73, 16, v73
    v_sqrt_f32 v73, v73
    v_cvt_pk_bf16_f32 v74, v74, v74
    v_lshlrev_b32 v74, 16, v74
    s_add_u32 m0, s33, 94208
    s_nop 0
    buffer_load_dwordx4 v9, s[48:51], s77 offen lds
    v_cvt_pk_bf16_f32 v75, v75, v75
    v_lshlrev_b32 v75, 16, v75
    v_add_f32 v75, 0x3727c5ac, v75
    v_cvt_pk_bf16_f32 v75, v75, v75
    v_lshlrev_b32 v75, 16, v75
    v_sqrt_f32 v75, v75
    s_nop 0
    v_cvt_pk_bf16_f32 v73, v73, v73
    s_load_dword s94, s[88:89], s76 offset:16384
    s_load_dword s94, s[88:89], s76 offset:16448
    s_load_dword s94, s[88:89], s76 offset:18432
    s_load_dword s94, s[88:89], s76 offset:18496
    s_waitcnt vmcnt(14)
    s_barrier
    s_add_u32 m0, s79, 118784
    s_add_u32 s78, s78, 32768
    buffer_load_dwordx4 v20, s[36:39], s78 offen lds
    v_lshlrev_b32 v73, 16, v73
    v_rcp_f32 v76, v73
    s_nop 0
    v_cvt_pk_bf16_f32 v75, v75, v75
    v_lshlrev_b32 v75, 16, v75
    v_rcp_f32 v77, v75
    s_nop 0
    v_fma_f32 v78, -v73, v76, 1.0
    s_add_u32 m0, s79, 119808
    s_nop 0
    buffer_load_dwordx4 v21, s[36:39], s78 offen lds
    v_fma_f32 v76, v78, v76, v76
    s_nop 0
    v_fma_f32 v79, -v75, v77, 1.0
    v_fma_f32 v77, v79, v77, v77
    v_sub_f32 v80, v40, v72
    v_sub_f32 v81, v41, v72
    v_cvt_pk_bf16_f32 v80, v80, v81
    v_and_b32 v81, 0xffff0000, v80
    v_lshlrev_b32 v80, 16, v80
    s_add_u32 m0, s33, 16384
    s_add_u32 s77, s77, 229376
    s_cmp_eq_u32 s77, 7340032
    s_cselect_b32 s77, 0, s77
    buffer_load_dwordx4 v22, s[40:43], s77 offen offset:0 lds
    v_mul_f32 v80, v80, v76
    v_mul_f32 v81, v81, v76
    v_cvt_pk_bf16_f32 v24, v80, v81
    v_sub_f32 v80, v42, v72
    v_sub_f32 v81, v43, v72
    v_cvt_pk_bf16_f32 v80, v80, v81
    v_and_b32 v81, 0xffff0000, v80
    v_lshlrev_b32 v80, 16, v80
    s_add_u32 m0, s33, 20352
    s_nop 0
    buffer_load_dwordx4 v22, s[40:43], s77 offen offset:128 lds
    v_mul_f32 v80, v80, v76
    v_mul_f32 v81, v81, v76
    v_cvt_pk_bf16_f32 v25, v80, v81
    v_sub_f32 v80, v44, v72
    v_sub_f32 v81, v45, v72
    v_cvt_pk_bf16_f32 v80, v80, v81
    v_and_b32 v81, 0xffff0000, v80
    v_lshlrev_b32 v80, 16, v80
    s_add_u32 m0, s33, 24576
    s_nop 0
    buffer_load_dwordx4 v22, s[44:47], s77 offen offset:0 lds
    s_add_u32 m0, s33, 28544
    s_nop 0
    buffer_load_dwordx4 v22, s[44:47], s77 offen offset:128 lds
    v_mul_f32 v80, v80, v76
    v_mul_f32 v81, v81, v76
    v_cvt_pk_bf16_f32 v26, v80, v81
    v_sub_f32 v80, v46, v72
    v_sub_f32 v81, v47, v72
    v_cvt_pk_bf16_f32 v80, v80, v81
    v_and_b32 v81, 0xffff0000, v80
    v_lshlrev_b32 v80, 16, v80
    s_add_u32 m0, s33, 32768
    s_nop 0
    buffer_load_dwordx4 v9, s[48:51], s77 offen lds
    v_mul_f32 v80, v80, v76
    v_mul_f32 v81, v81, v76
    v_cvt_pk_bf16_f32 v27, v80, v81
    v_sub_f32 v80, v48, v72
    v_sub_f32 v81, v49, v72
    v_cvt_pk_bf16_f32 v80, v80, v81
    v_and_b32 v81, 0xffff0000, v80
    v_lshlrev_b32 v80, 16, v80
    s_load_dword s94, s[88:89], s76 offset:20480
    s_load_dword s94, s[88:89], s76 offset:20544
    s_load_dword s94, s[88:89], s76 offset:22528
    s_load_dword s94, s[88:89], s76 offset:22592
    s_waitcnt vmcnt(14)
    s_barrier
    s_add_u32 m0, s79, 135168
    s_add_u32 s72, s72, 128
    s_and_b32 s78, s72, 0x7ff
    buffer_load_dwordx4 v20, s[36:39], s78 offen lds
    v_mul_f32 v80, v80, v76
    v_mul_f32 v81, v81, v76
    v_cvt_pk_bf16_f32 v28, v80, v81
    v_sub_f32 v80, v50, v72
    v_sub_f32 v81, v51, v72
    v_cvt_pk_bf16_f32 v80, v80, v81
    v_and_b32 v81, 0xffff0000, v80
    v_lshlrev_b32 v80, 16, v80
    s_add_u32 m0, s79, 136192
    s_nop 0
    buffer_load_dwordx4 v21, s[36:39], s78 offen lds
    v_mul_f32 v80, v80, v76
    v_mul_f32 v81, v81, v76
    v_cvt_pk_bf16_f32 v29, v80, v81
    v_sub_f32 v80, v52, v72
    v_sub_f32 v81, v53, v72
    v_cvt_pk_bf16_f32 v80, v80, v81
    v_and_b32 v81, 0xffff0000, v80
    v_lshlrev_b32 v80, 16, v80
    s_add_u32 m0, s33, 36864
    s_add_u32 s77, s77, 229376
    buffer_load_dwordx4 v22, s[40:43], s77 offen offset:0 lds
    v_mul_f32 v80, v80, v76
    v_mul_f32 v81, v81, v76
    v_cvt_pk_bf16_f32 v30, v80, v81
    v_sub_f32 v80, v54, v72
    v_sub_f32 v81, v55, v72
    v_cvt_pk_bf16_f32 v80, v80, v81
    v_and_b32 v81, 0xffff0000, v80
    v_lshlrev_b32 v80, 16, v80
    s_add_u32 m0, s33, 40832
    s_nop 0
    buffer_load_dwordx4 v22, s[40:43], s77 offen offset:128 lds
    v_mul_f32 v80, v80, v76
    v_mul_f32 v81, v81, v76
    v_cvt_pk_bf16_f32 v31, v80, v81
    v_sub_f32 v80, v56, v74
    v_sub_f32 v81, v57, v74
    v_cvt_pk_bf16_f32 v80, v80, v81
    v_and_b32 v81, 0xffff0000, v80
    v_lshlrev_b32 v80, 16, v80
    s_add_u32 m0, s33, 45056
    s_nop 0
    buffer_load_dwordx4 v22, s[44:47], s77 offen offset:0 lds
    v_mul_f32 v80, v80, v77
    v_mul_f32 v81, v81, v77
    v_cvt_pk_bf16_f32 v32, v80, v81
    v_sub_f32 v80, v58, v74
    v_sub_f32 v81, v59, v74
    v_cvt_pk_bf16_f32 v80, v80, v81
    v_and_b32 v81, 0xffff0000, v80
    v_lshlrev_b32 v80, 16, v80
    s_add_u32 m0, s33, 49024
    s_nop 0
    buffer_load_dwordx4 v22, s[44:47], s77 offen offset:128 lds
    s_add_u32 m0, s33, 53248
    s_nop 0
    buffer_load_dwordx4 v9, s[48:51], s77 offen lds
    v_mul_f32 v80, v80, v77
    v_mul_f32 v81, v81, v77
    v_cvt_pk_bf16_f32 v33, v80, v81
    v_sub_f32 v80, v60, v74
    v_sub_f32 v81, v61, v74
    v_cvt_pk_bf16_f32 v80, v80, v81
    v_and_b32 v81, 0xffff0000, v80
    v_lshlrev_b32 v80, 16, v80
    s_load_dword s94, s[88:89], s76 offset:24576
    s_load_dword s94, s[88:89], s76 offset:24640
    s_load_dword s94, s[88:89], s76 offset:26624
    s_load_dword s94, s[88:89], s76 offset:26688
    s_waitcnt vmcnt(14)
    s_barrier
    s_add_u32 m0, s79, 137216
    s_add_u32 s78, s78, 32768
    buffer_load_dwordx4 v20, s[36:39], s78 offen lds
    v_mul_f32 v80, v80, v77
    v_mul_f32 v81, v81, v77
    v_cvt_pk_bf16_f32 v34, v80, v81
    v_sub_f32 v80, v62, v74
    v_sub_f32 v81, v63, v74
    v_cvt_pk_bf16_f32 v80, v80, v81
    v_and_b32 v81, 0xffff0000, v80
    v_lshlrev_b32 v80, 16, v80
    s_add_u32 m0, s79, 138240
    s_nop 0
    buffer_load_dwordx4 v21, s[36:39], s78 offen lds
    v_mul_f32 v80, v80, v77
    v_mul_f32 v81, v81, v77
    v_cvt_pk_bf16_f32 v35, v80, v81
    v_sub_f32 v80, v64, v74
    v_sub_f32 v81, v65, v74
    v_cvt_pk_bf16_f32 v80, v80, v81
    v_and_b32 v81, 0xffff0000, v80
    v_lshlrev_b32 v80, 16, v80
    s_add_u32 m0, s33, 57344
    s_add_u32 s77, s77, 229376
    s_cmp_eq_u32 s77, 7340032
    s_cselect_b32 s77, 0, s77
    buffer_load_dwordx4 v22, s[40:43], s77 offen offset:0 lds
    v_mul_f32 v80, v80, v77
    v_mul_f32 v81, v81, v77
    v_cvt_pk_bf16_f32 v36, v80, v81
    v_sub_f32 v80, v66, v74
    v_sub_f32 v81, v67, v74
    v_cvt_pk_bf16_f32 v80, v80, v81
    v_and_b32 v81, 0xffff0000, v80
    v_lshlrev_b32 v80, 16, v80
    s_add_u32 m0, s33, 61312
    s_nop 0
    buffer_load_dwordx4 v22, s[40:43], s77 offen offset:128 lds
    v_mul_f32 v80, v80, v77
    v_mul_f32 v81, v81, v77
    v_cvt_pk_bf16_f32 v37, v80, v81
    v_sub_f32 v80, v68, v74
    v_sub_f32 v81, v69, v74
    v_cvt_pk_bf16_f32 v80, v80, v81
    v_and_b32 v81, 0xffff0000, v80
    v_lshlrev_b32 v80, 16, v80
    s_add_u32 m0, s33, 65536
    s_nop 0
    buffer_load_dwordx4 v22, s[44:47], s77 offen offset:0 lds
    v_mul_f32 v80, v80, v77
    v_mul_f32 v81, v81, v77
    v_cvt_pk_bf16_f32 v38, v80, v81
    v_sub_f32 v80, v70, v74
    v_sub_f32 v81, v71, v74
    v_cvt_pk_bf16_f32 v80, v80, v81
    v_and_b32 v81, 0xffff0000, v80
    v_lshlrev_b32 v80, 16, v80
    s_add_u32 m0, s33, 69504
    s_nop 0
    buffer_load_dwordx4 v22, s[44:47], s77 offen offset:128 lds
    s_add_u32 m0, s33, 73728
    s_nop 0
    buffer_load_dwordx4 v9, s[48:51], s77 offen lds
    v_mul_f32 v80, v80, v77
    v_mul_f32 v81, v81, v77
    v_cvt_pk_bf16_f32 v39, v80, v81
    s_add_u32 s90, s90, 0x1e00000
    v_mov_b32 v7, s90
    s_mov_b64 exec, 1
    global_store_dwordx4 v7, v[72:75], s[26:27] sc1
    s_mov_b64 exec, -1
    v_lshrrev_b32 v64, 4, v1
    v_bfe_u32 v65, v1, 2, 2
    v_and_b32 v66, 3, v1
    v_and_b32 v67, 15, v1
    v_lshrrev_b32 v68, 3, v1
    v_and_b32 v69, 7, v1
    s_lshl_b32 s85, s6, 2
    s_lshl_b32 s86, s5, 1
    s_or_b32 s85, s85, s86
    v_lshl_add_u32 v70, v64, 3, v65
    v_lshlrev_b32 v70, 7, v70
    global_store_dwordx4 v86, v[24:27], s[26:27] offset:0 sc1
    s_load_dword s94, s[88:89], s76 offset:28672
    s_load_dword s94, s[88:89], s76 offset:28736
    s_load_dword s94, s[88:89], s76 offset:30720
    s_load_dword s94, s[88:89], s76 offset:30784
    s_waitcnt vmcnt(16)
    s_barrier
    s_add_u32 m0, s79, 98304
    s_add_u32 s72, s72, 128
    s_and_b32 s78, s72, 0x7ff
    buffer_load_dwordx4 v20, s[36:39], s78 offen lds
    v_and_b32 v71, 1, v66
    v_lshl_add_u32 v70, v71, 3, v70
    v_add_u32 v70, 16384, v70
    v_and_b32 v71, 2, v65
    v_and_b32 v72, 1, v64
    v_lshl_add_u32 v71, v72, 2, v71
    v_lshrrev_b32 v72, 1, v66
    v_xor_b32 v71, v71, v72
    s_add_u32 m0, s79, 99328
    s_nop 0
    buffer_load_dwordx4 v21, s[36:39], s78 offen lds
    v_xor_b32 v71, s85, v71
    v_xor_b32 v72, 0, v71
    v_lshl_add_u32 v4, v72, 4, v70
    v_add_u32 v6, 40960, v4
    v_xor_b32 v72, 2, v71
    v_lshl_add_u32 v5, v72, 4, v70
    v_add_u32 v7, 40960, v5
    v_lshrrev_b32 v70, 1, v67
    s_add_u32 m0, s33, 77824
    s_add_u32 s77, s77, 229376
    buffer_load_dwordx4 v22, s[40:43], s77 offen offset:0 lds
    v_xor_b32 v70, v70, v64
    v_lshlrev_b32 v70, 4, v70
    v_lshl_add_u32 v70, v67, 7, v70
    s_lshl_b32 s85, s5, 13
    v_add_u32 v16, s85, v70
    v_xor_b32 v17, 64, v16
    s_sub_u32 s95, 16384, s85
    s_mov_b32 s80, 135168
    s_lshl_b32 s86, s28, 7
    s_sub_u32 s86, s86, 16
    s_max_i32 s86, s86, 0
    s_lshl_b32 s87, s4, 2
    v_add_u32 v71, s87, v68
    s_add_u32 m0, s33, 81792
    s_nop 0
    buffer_load_dwordx4 v22, s[40:43], s77 offen offset:128 lds
    v_lshrrev_b32 v70, 1, v71
    v_and_b32 v70, 7, v70
    v_xor_b32 v70, v70, v69
    v_lshlrev_b32 v70, 4, v70
    v_add_u32 v71, s86, v71
    v_lshl_add_u32 v3, v71, 11, v70
    s_lshl_b32 s81, s4, 9
    s_lshl_b32 s85, s4, 3
    s_and_b32 s86, s4, 1
    s_lshl_b32 s86, s86, 2
    v_and_b32 v70, 2, v68
    s_add_u32 m0, s33, 86016
    s_nop 0
    buffer_load_dwordx4 v22, s[44:47], s77 offen offset:0 lds
    v_xor_b32 v70, v70, v69
    v_xor_b32 v70, s86, v70
    v_add_u32 v71, s85, v68
    v_mul_u32_u24 v71, 6144, v71
    v_lshl_add_u32 v23, v70, 4, v71
    s_lshl_b32 s85, s4, 12
    v_lshl_add_u32 v10, v1, 4, s85
    s_lshl_b32 s85, s4, 4
    v_and_b32 v70, 2, v68
    v_xor_b32 v70, v70, v69
    s_add_u32 m0, s33, 89984
    s_nop 0
    buffer_load_dwordx4 v22, s[44:47], s77 offen offset:128 lds
    s_add_u32 m0, s33, 94208
    s_nop 0
    buffer_load_dwordx4 v9, s[48:51], s77 offen lds
    v_xor_b32 v70, 0, v70
    v_add_u32 v71, s85, v68
    v_mul_u32_u24 v71, 2048, v71
    v_lshl_add_u32 v11, v70, 4, v71
    s_add_u32 s85, s85, 8
    v_and_b32 v70, 2, v68
    v_xor_b32 v70, v70, v69
    v_xor_b32 v70, 4, v70
    v_add_u32 v71, s85, v68
    s_load_dword s94, s[10:11], s52 offset:0x0
    s_load_dword s94, s[10:11], s52 offset:0x40
    s_load_dword s94, s[10:11], s52 offset:0x80
    s_load_dword s94, s[10:11], s52 offset:0xc0
    s_load_dword s94, s[10:11], s52 offset:0x100
    global_store_dwordx4 v86, v[28:31], s[26:27] offset:1024 sc1
    v_mov_b32 v87, 0
    s_mov_b64 exec, 1
    global_load_dwordx2 v[18:19], v87, s[24:25] sc1
    s_mov_b64 exec, -1
    s_waitcnt vmcnt(18)
    s_barrier
    s_add_u32 m0, s79, 100352
    s_add_u32 s78, s78, 32768
    buffer_load_dwordx4 v20, s[36:39], s78 offen lds
    v_mul_u32_u24 v71, 2048, v71
    v_lshl_add_u32 v12, v70, 4, v71
    s_lshl_b32 s85, s31, 8
    s_lshl_b32 s86, s32, 7
    s_add_u32 s86, s85, s86
    s_xor_b32 s87, s86, 128
    s_lshr_b32 s91, s31, 2
    s_lshl1_add_u32 s91, s91, s32
    s_lshl_b32 s91, s91, 13
    s_add_u32 s91, s91, 0x2000000
    s_xor_b32 s85, s91, 8192
    s_and_b32 s92, s31, 3
    s_cmp_eq_u32 s92, 1
    s_cselect_b32 s86, s91, s86
    s_cselect_b32 s87, s85, s87
    s_cselect_b32 s91, 0x2a00000, 0
    s_cselect_b32 s92, s26, s20
    s_cselect_b32 s93, s27, s21
    s_max_u32 s91, s91, 7340032
    s_add_u32 s60, s92, s86
    s_addc_u32 s61, s93, 0
    s_sub_u32 s62, s91, s86
    s_mov_b32 s63, 0x20000
    s_add_u32 m0, s79, 101376
    s_nop 0
    buffer_load_dwordx4 v21, s[36:39], s78 offen lds
    s_add_u32 s64, s92, s87
    s_addc_u32 s65, s93, 0
    s_sub_u32 s66, s91, s87
    s_mov_b32 s67, 0x20000
    s_add_u32 s56, s26, 0x400000
    s_addc_u32 s57, s27, 0
    s_mov_b32 s58, 0xe00000
    s_mov_b32 s59, 0x20000
    s_mul_i32 s82, s30, 917504
    s_mul_i32 s85, s32, 327680
    s_add_u32 s82, s82, s85
    s_mul_i32 s83, s32, 2621440
    s_mul_i32 s85, s32, 10
    s_sub_u32 s85, 40, s85
    s_lshl_b32 s14, s85, 13
    s_lshl_b32 s35, s85, 16
    s_add_u32 s83, s83, 1441792
    s_add_u32 s82, s82, 196608
    s_lshl_b32 s84, s30, 7
    s_lshl_b32 s85, s5, 6
    s_add_u32 s84, s84, s85
    s_lshl_b32 s84, s84, 11
    s_lshl_b32 s85, s31, 8
    s_add_u32 s84, s84, s85
    s_lshl_b32 s85, s32, 7
    s_add_u32 s84, s84, s85
    s_lshl_b32 s85, s6, 6
    s_add_u32 m0, s33, 16384
    s_add_u32 s77, s77, 229376
    s_cmp_eq_u32 s77, 7340032
    s_cselect_b32 s77, 0, s77
    buffer_load_dwordx4 v22, s[40:43], s77 offen offset:0 lds
    s_add_u32 s84, s84, s85
    v_lshrrev_b32 v70, 2, v1
    v_lshl_add_u32 v71, v66, 4, s84
    v_lshl_add_u32 v13, v70, 11, v71
    v_lshrrev_b32 v72, 4, v1
    v_and_b32 v73, 15, v1
    v_and_b32 v74, 1, v72
    v_xor_b32 v74, s5, v74
    v_lshrrev_b32 v75, 1, v72
    s_add_u32 m0, s33, 20352
    s_nop 0
    buffer_load_dwordx4 v22, s[40:43], s77 offen offset:128 lds
    v_lshl_add_u32 v74, v74, 1, v75
    v_lshlrev_b32 v74, 8, v74
    v_lshl_add_u32 v0, v73, 4, v74
    v_lshrrev_b32 v72, 4, v1
    v_and_b32 v73, 1, v72
    v_lshrrev_b32 v72, 1, v72
    v_lshlrev_b32 v72, 8, v72
    v_lshl_add_u32 v72, v73, 10, v72
    s_add_u32 m0, s33, 24576
    s_nop 0
    buffer_load_dwordx4 v22, s[44:47], s77 offen offset:0 lds
    v_and_b32 v73, 15, v1
    v_lshl_add_u32 v8, v73, 4, v72
    s_mov_b32 s54, 7332992
    s_mov_b32 s55, 0x20000
    s_mul_i32 s84, s6, 3072
    s_add_u32 s84, s84, 153600
    v_lshl_add_u32 v85, v1, 3, s84
    s_mul_i32 s84, s28, 112
    s_lshl1_add_u32 s85, s29, s6
    s_add_u32 s86, s85, 2
    s_and_b32 s86, s86, 31
    s_add_u32 s84, s84, s86
    s_add_u32 s84, s84, 80
    s_lshl_b32 s84, s84, 13
    s_lshl_b32 s86, s5, 12
    s_add_u32 s84, s84, s86
    s_add_u32 s84, s84, 0x400000
    s_lshl_b32 s87, s5, 9
    s_add_u32 s73, s84, s87
    s_xor_b32 s87, s87, 512
    s_add_u32 m0, s33, 28544
    s_nop 0
    buffer_load_dwordx4 v22, s[44:47], s77 offen offset:128 lds
    s_add_u32 m0, s33, 32768
    s_nop 0
    buffer_load_dwordx4 v9, s[48:51], s77 offen lds
    s_add_u32 s74, s84, s87
    s_lshl_b32 s84, s28, 5
    s_add_u32 s84, s84, s85
    s_lshl_b32 s84, s84, 13
    s_add_u32 s84, s84, s86
    s_add_u32 s75, s84, 0x1200000
    v_mov_b32 v84, 0xc0135761
    v_mov_b32 v152, 0
    v_mov_b32 v153, 0
    v_mov_b32 v154, 0
    v_mov_b32 v155, 0
    v_mov_b32 v156, 0
    v_mov_b32 v157, 0
    s_load_dword s94, s[10:11], s52 offset:0x140
    s_load_dword s94, s[10:11], s52 offset:0x180
    s_load_dword s94, s[10:11], s52 offset:0x1c0
    s_load_dword s94, s[16:17], s53 offset:0x0
    s_load_dword s94, s[16:17], s53 offset:0x40
    global_store_dwordx4 v86, v[32:35], s[26:27] offset:2048 sc1
    s_waitcnt vmcnt(19)
    s_barrier
    s_add_u32 m0, s79, 116736
    s_add_u32 s72, s72, 128
    s_and_b32 s78, s72, 0x7ff
    buffer_load_dwordx4 v20, s[36:39], s78 offen lds
    v_mov_b32 v158, 0
    v_mov_b32 v159, 0
    v_mov_b32 v160, 0
    v_mov_b32 v161, 0
    v_mov_b32 v162, 0
    v_mov_b32 v163, 0
    v_mov_b32 v164, 0
    v_mov_b32 v165, 0
    s_add_u32 m0, s79, 117760
    s_nop 0
    buffer_load_dwordx4 v21, s[36:39], s78 offen lds
    v_mov_b32 v166, 0
    v_mov_b32 v167, 0
    v_mov_b32 v168, 0
    v_mov_b32 v169, 0
    v_mov_b32 v170, 0
    v_mov_b32 v171, 0
    v_mov_b32 v172, 0
    v_mov_b32 v173, 0
    s_add_u32 m0, s33, 36864
    s_add_u32 s77, s77, 229376
    buffer_load_dwordx4 v22, s[40:43], s77 offen offset:0 lds
    v_mov_b32 v174, 0
    v_mov_b32 v175, 0
    v_mov_b32 v176, 0
    v_mov_b32 v177, 0
    v_mov_b32 v178, 0
    v_mov_b32 v179, 0
    v_mov_b32 v180, 0
    v_mov_b32 v181, 0
    s_add_u32 m0, s33, 40832
    s_nop 0
    buffer_load_dwordx4 v22, s[40:43], s77 offen offset:128 lds
    v_mov_b32 v182, 0
    v_mov_b32 v183, 0
    v_mov_b32 v184, 0
    v_mov_b32 v185, 0
    v_mov_b32 v186, 0
    v_mov_b32 v187, 0
    v_mov_b32 v188, 0
    v_mov_b32 v189, 0
    s_add_u32 m0, s33, 45056
    s_nop 0
    buffer_load_dwordx4 v22, s[44:47], s77 offen offset:0 lds
    v_mov_b32 v190, 0
    v_mov_b32 v191, 0
    v_mov_b32 v192, 0
    v_mov_b32 v193, 0
    v_mov_b32 v194, 0
    v_mov_b32 v195, 0
    v_mov_b32 v196, 0
    v_mov_b32 v197, 0
    s_add_u32 m0, s33, 49024
    s_nop 0
    buffer_load_dwordx4 v22, s[44:47], s77 offen offset:128 lds
    s_add_u32 m0, s33, 53248
    s_nop 0
    buffer_load_dwordx4 v9, s[48:51], s77 offen lds
    v_mov_b32 v198, 0
    v_mov_b32 v199, 0
    v_mov_b32 v200, 0
    v_mov_b32 v201, 0
    v_mov_b32 v202, 0
    v_mov_b32 v203, 0
    v_mov_b32 v204, 0
    v_mov_b32 v205, 0
    s_load_dword s94, s[16:17], s53 offset:0x80
    s_load_dword s94, s[16:17], s53 offset:0xc0
    s_load_dword s94, s[16:17], s53 offset:0x100
    s_load_dword s94, s[16:17], s53 offset:0x140
    s_load_dword s94, s[16:17], s53 offset:0x180
    global_store_dwordx4 v86, v[36:39], s[26:27] offset:3072 sc1
    s_waitcnt vmcnt(18)
    s_barrier
    s_add_u32 m0, s79, 118784
    s_add_u32 s78, s78, 32768
    buffer_load_dwordx4 v20, s[36:39], s78 offen lds
    v_mov_b32 v206, 0
    v_mov_b32 v207, 0
    v_mov_b32 v208, 0
    v_mov_b32 v209, 0
    v_mov_b32 v210, 0
    v_mov_b32 v211, 0
    v_mov_b32 v212, 0
    v_mov_b32 v213, 0
    s_add_u32 m0, s79, 119808
    s_nop 0
    buffer_load_dwordx4 v21, s[36:39], s78 offen lds
    v_mov_b32 v214, 0
    v_mov_b32 v215, 0
    v_mov_b32 v216, 0
    v_mov_b32 v217, 0
    v_mov_b32 v218, 0
    v_mov_b32 v219, 0
    v_mov_b32 v220, 0
    v_mov_b32 v221, 0
    s_add_u32 m0, s33, 57344
    s_add_u32 s77, s77, 229376
    s_cmp_eq_u32 s77, 7340032
    s_cselect_b32 s77, 0, s77
    buffer_load_dwordx4 v22, s[40:43], s77 offen offset:0 lds
    v_mov_b32 v222, 0
    v_mov_b32 v223, 0
    v_mov_b32 v224, 0
    v_mov_b32 v225, 0
    v_mov_b32 v226, 0
    v_mov_b32 v227, 0
    v_mov_b32 v228, 0
    v_mov_b32 v229, 0
    s_add_u32 m0, s33, 61312
    s_nop 0
    buffer_load_dwordx4 v22, s[40:43], s77 offen offset:128 lds
    v_mov_b32 v230, 0
    v_mov_b32 v231, 0
    v_mov_b32 v232, 0
    v_mov_b32 v233, 0
    v_mov_b32 v234, 0
    v_mov_b32 v235, 0
    v_mov_b32 v236, 0
    v_mov_b32 v237, 0
    s_add_u32 m0, s33, 65536
    s_nop 0
    buffer_load_dwordx4 v22, s[44:47], s77 offen offset:0 lds
    v_mov_b32 v238, 0
    v_mov_b32 v239, 0
    v_mov_b32 v240, 0
    v_mov_b32 v241, 0
    v_mov_b32 v242, 0
    v_mov_b32 v243, 0
    v_mov_b32 v244, 0
    v_mov_b32 v245, 0
    s_add_u32 m0, s33, 69504
    s_nop 0
    buffer_load_dwordx4 v22, s[44:47], s77 offen offset:128 lds
    s_add_u32 m0, s33, 73728
    s_nop 0
    buffer_load_dwordx4 v9, s[48:51], s77 offen lds
    v_mov_b32 v246, 0
    v_mov_b32 v247, 0
    v_mov_b32 v248, 0
    v_mov_b32 v249, 0
    v_mov_b32 v250, 0
    v_mov_b32 v251, 0
    v_mov_b32 v252, 0
    v_mov_b32 v253, 0
    s_load_dword s94, s[16:17], s53 offset:0x1c0
    s_load_dword s94, s[18:19], s53 offset:0x0
    s_load_dword s94, s[18:19], s53 offset:0x40
    s_load_dword s94, s[18:19], s53 offset:0x80
    s_load_dword s94, s[18:19], s53 offset:0xc0
    s_waitcnt vmcnt(16)
    s_barrier
    s_add_u32 m0, s79, 135168
    s_add_u32 s72, s72, 128
    s_and_b32 s78, s72, 0x7ff
    buffer_load_dwordx4 v20, s[36:39], s78 offen lds
    v_mov_b32 v254, 0
    v_mov_b32 v255, 0
    v_mov_b32 v112, 0
    v_mov_b32 v113, 0
    v_mov_b32 v114, 0
    v_mov_b32 v115, 0
    v_mov_b32 v116, 0
    v_mov_b32 v117, 0
    v_mov_b32 v118, 0
    v_mov_b32 v119, 0
    s_add_u32 m0, s79, 136192
    s_nop 0
    buffer_load_dwordx4 v21, s[36:39], s78 offen lds
    v_mov_b32 v120, 0
    v_mov_b32 v121, 0
    v_mov_b32 v122, 0
    v_mov_b32 v123, 0
    v_mov_b32 v124, 0
    v_mov_b32 v125, 0
    v_mov_b32 v126, 0
    v_mov_b32 v127, 0
    s_add_u32 m0, s33, 77824
    s_add_u32 s77, s77, 229376
    buffer_load_dwordx4 v22, s[40:43], s77 offen offset:0 lds
    v_mov_b32 v128, 0
    v_mov_b32 v129, 0
    v_mov_b32 v130, 0
    v_mov_b32 v131, 0
    v_mov_b32 v132, 0
    v_mov_b32 v133, 0
    v_mov_b32 v134, 0
    v_mov_b32 v135, 0
    s_add_u32 m0, s33, 81792
    s_nop 0
    buffer_load_dwordx4 v22, s[40:43], s77 offen offset:128 lds
    v_mov_b32 v136, 0
    v_mov_b32 v137, 0
    v_mov_b32 v138, 0
    v_mov_b32 v139, 0
    v_mov_b32 v140, 0
    v_mov_b32 v141, 0
    v_mov_b32 v142, 0
    v_mov_b32 v143, 0
    s_add_u32 m0, s33, 86016
    s_nop 0
    buffer_load_dwordx4 v22, s[44:47], s77 offen offset:0 lds
    s_add_u32 m0, s33, 89984
    s_nop 0
    buffer_load_dwordx4 v22, s[44:47], s77 offen offset:128 lds
L_pad7:
    s_cbranch_execz L_vret0
    v_mov_b32 v144, 0
    v_mov_b32 v145, 0
    v_mov_b32 v146, 0
    v_mov_b32 v147, 0
    v_mov_b32 v148, 0
    v_mov_b32 v149, 0
    v_mov_b32 v150, 0
    v_mov_b32 v151, 0
    s_add_u32 m0, s33, 94208
    s_nop 0
    buffer_load_dwordx4 v9, s[48:51], s77 offen lds
    s_load_dword s94, s[18:19], s53 offset:0x100
    s_load_dword s94, s[18:19], s53 offset:0x140
    s_load_dword s94, s[18:19], s53 offset:0x180
    s_load_dword s94, s[18:19], s53 offset:0x1c0
    s_load_dword s94, s[10:11], s52 offset:0x80000
    s_waitcnt vmcnt(30)
    s_movk_i32 s98, 0x4000
L_tokB_chk:
    v_readfirstlane_b32 s100, v18
    v_readfirstlane_b32 s101, v19
    s_nop 1
    s_cmp_lg_u32 s100, 0
    s_cbranch_scc1 L_tokB_ok
    s_sub_u32 s98, s98, 1
    s_cbranch_scc1 L_tokB_ok
    s_sleep 1
    global_load_dwordx2 v[18:19], v87, s[24:25] sc1
    s_waitcnt vmcnt(0)
    s_branch L_tokB_chk
L_tokB_ok:
    s_waitcnt vmcnt(14)
    s_waitcnt vmcnt(15)
    s_barrier
    s_add_u32 m0, s79, 137216
    s_add_u32 s78, s78, 32768
    buffer_load_dwordx4 v20, s[36:39], s78 offen lds
    s_add_u32 m0, s79, 138240
    s_nop 0
    buffer_load_dwordx4 v21, s[36:39], s78 offen lds
    s_add_u32 m0, s33, 16384
    s_add_u32 s77, s77, 229376
    s_cmp_eq_u32 s77, 7340032
    s_cselect_b32 s77, 0, s77
    buffer_load_dwordx4 v22, s[40:43], s77 offen offset:0 lds
    s_add_u32 m0, s33, 20352
    s_nop 0
    buffer_load_dwordx4 v22, s[40:43], s77 offen offset:128 lds
    s_add_u32 m0, s33, 24576
    s_nop 0
    buffer_load_dwordx4 v22, s[44:47], s77 offen offset:0 lds
    s_add_u32 m0, s33, 28544
    s_nop 0
    buffer_load_dwordx4 v22, s[44:47], s77 offen offset:128 lds
    s_add_u32 m0, s33, 32768
    s_nop 0
    buffer_load_dwordx4 v9, s[48:51], s77 offen lds
    s_load_dword s94, s[10:11], s52 offset:0x80040
    s_load_dword s94, s[10:11], s52 offset:0x80080
    s_load_dword s94, s[10:11], s52 offset:0x800c0
    s_load_dword s94, s[10:11], s52 offset:0x80100
    s_load_dword s94, s[10:11], s52 offset:0x80140
    s_cmp_lg_u32 s4, 0
    s_cbranch_scc1 L_fLN
    s_lshl_b32 s91, s28, 4
    s_add_u32 s91, s91, s29
    s_lshl_b32 s91, s91, 7
    s_add_u32 s91, s91, 0x1e80000
    v_mov_b32 v24, s91
    v_mov_b32 v26, s100
    v_mov_b32 v27, s101
    s_mov_b64 exec, 1
    global_store_dwordx2 v24, v[26:27], s[26:27] sc1
    s_mov_b64 exec, -1
L_fLN:
    s_waitcnt vmcnt(14)
    s_barrier
    s_add_u32 m0, s79, 98304
    s_add_u32 s72, s72, 128
    s_and_b32 s78, s72, 0x7ff
    buffer_load_dwordx4 v20, s[36:39], s78 offen lds
    s_add_u32 m0, s79, 99328
    s_nop 0
    buffer_load_dwordx4 v21, s[36:39], s78 offen lds
    s_add_u32 m0, s33, 36864
    s_add_u32 s77, s77, 229376
    buffer_load_dwordx4 v22, s[40:43], s77 offen offset:0 lds
    s_add_u32 m0, s33, 40832
    s_nop 0
    buffer_load_dwordx4 v22, s[40:43], s77 offen offset:128 lds
    s_add_u32 m0, s33, 45056
    s_nop 0
    buffer_load_dwordx4 v22, s[44:47], s77 offen offset:0 lds
    s_add_u32 m0, s33, 49024
    s_nop 0
    buffer_load_dwordx4 v22, s[44:47], s77 offen offset:128 lds
    s_add_u32 m0, s33, 53248
    s_nop 0
    buffer_load_dwordx4 v9, s[48:51], s77 offen lds
    s_load_dword s94, s[10:11], s52 offset:0x80180
    s_load_dword s94, s[10:11], s52 offset:0x801c0
    s_add_u32 s52, s52, 0x100000
    s_load_dword s94, s[10:11], s52 offset:0x0
    s_load_dword s94, s[10:11], s52 offset:0x40
    s_load_dword s94, s[10:11], s52 offset:0x80
    global_load_dwordx4 v[24:27], v11, s[88:89]
    s_waitcnt vmcnt(15)
    s_barrier
    s_add_u32 m0, s79, 100352
    s_add_u32 s78, s78, 32768
    buffer_load_dwordx4 v20, s[36:39], s78 offen lds
    s_add_u32 m0, s79, 101376
    s_nop 0
    buffer_load_dwordx4 v21, s[36:39], s78 offen lds
    s_add_u32 m0, s33, 57344
    s_add_u32 s77, s77, 229376
    s_cmp_eq_u32 s77, 7340032
    s_cselect_b32 s77, 0, s77
    buffer_load_dwordx4 v22, s[40:43], s77 offen offset:0 lds
    s_add_u32 m0, s33, 61312
    s_nop 0
    buffer_load_dwordx4 v22, s[40:43], s77 offen offset:128 lds
    s_add_u32 m0, s33, 65536
    s_nop 0
    buffer_load_dwordx4 v22, s[44:47], s77 offen offset:0 lds
    s_add_u32 m0, s33, 69504
    s_nop 0
    buffer_load_dwordx4 v22, s[44:47], s77 offen offset:128 lds
    s_add_u32 m0, s33, 73728
    s_nop 0
    buffer_load_dwordx4 v9, s[48:51], s77 offen lds
    s_load_dword s94, s[10:11], s52 offset:0xc0
    s_load_dword s94, s[10:11], s52 offset:0x100
    s_load_dword s94, s[10:11], s52 offset:0x140
    s_load_dword s94, s[10:11], s52 offset:0x180
    s_load_dword s94, s[10:11], s52 offset:0x1c0
    global_load_dwordx4 v[28:31], v12, s[88:89]
    s_waitcnt vmcnt(16)
    s_barrier
    s_add_u32 m0, s79, 116736
    s_add_u32 s72, s72, 128
    s_and_b32 s78, s72, 0x7ff
    buffer_load_dwordx4 v20, s[36:39], s78 offen lds
    s_add_u32 m0, s79, 117760
    s_nop 0
    buffer_load_dwordx4 v21, s[36:39], s78 offen lds
    s_add_u32 m0, s33, 77824
    s_add_u32 s77, s77, 229376
    buffer_load_dwordx4 v22, s[40:43], s77 offen offset:0 lds
    s_add_u32 m0, s33, 81792
    s_nop 0
    buffer_load_dwordx4 v22, s[40:43], s77 offen offset:128 lds
    s_add_u32 m0, s33, 86016
    s_nop 0
    buffer_load_dwordx4 v22, s[44:47], s77 offen offset:0 lds
    s_add_u32 m0, s33, 89984
    s_nop 0
    buffer_load_dwordx4 v22, s[44:47], s77 offen offset:128 lds
    s_add_u32 m0, s33, 94208
    s_nop 0
    buffer_load_dwordx4 v9, s[48:51], s77 offen lds
    s_load_dword s94, s[10:11], s52 offset:0x80000
    s_load_dword s94, s[10:11], s52 offset:0x80040
    s_load_dword s94, s[10:11], s52 offset:0x80080
    s_load_dword s94, s[10:11], s52 offset:0x800c0
    s_load_dword s94, s[10:11], s52 offset:0x80100
    s_lshl1_add_u32 s91, s33, s34
    s_add_u32 s91, s91, 0x2000000
    v_lshl_add_u32 v32, v1, 4, s91
    s_and_b32 s85, s31, 3
    s_cmp_eq_u32 s85, 1
    s_cselect_b64 vcc, -1, 0
    s_lshl_b32 s85, s4, 11
    v_lshl_add_u32 v70, v1, 4, s85
    v_add_u32 v71, 1024, v70
    v_cndmask_b32 v11, v11, v70, vcc
    v_cndmask_b32 v12, v12, v71, vcc
    s_waitcnt vmcnt(15)
    global_store_dwordx4 v32, v[24:27], s[26:27] offset:0 sc1
    s_waitcnt vmcnt(17)
    s_barrier
    s_add_u32 m0, s79, 118784
    s_add_u32 s78, s78, 32768
    buffer_load_dwordx4 v20, s[36:39], s78 offen lds
    s_add_u32 m0, s79, 119808
    s_nop 0
    buffer_load_dwordx4 v21, s[36:39], s78 offen lds
    s_add_u32 m0, s33, 16384
    s_add_u32 s77, s77, 229376
    s_cmp_eq_u32 s77, 7340032
    s_cselect_b32 s77, 0, s77
    buffer_load_dwordx4 v22, s[40:43], s77 offen offset:0 lds
    s_add_u32 m0, s33, 20352
    s_nop 0
    buffer_load_dwordx4 v22, s[40:43], s77 offen offset:128 lds
    s_add_u32 m0, s33, 24576
    s_nop 0
    buffer_load_dwordx4 v22, s[44:47], s77 offen offset:0 lds
    s_add_u32 m0, s33, 28544
    s_nop 0
    buffer_load_dwordx4 v22, s[44:47], s77 offen offset:128 lds
    s_add_u32 m0, s33, 32768
    s_nop 0
    buffer_load_dwordx4 v9, s[48:51], s77 offen lds
    s_load_dword s94, s[10:11], s52 offset:0x80140
    s_load_dword s94, s[10:11], s52 offset:0x80180
    s_load_dword s94, s[10:11], s52 offset:0x801c0
    s_add_u32 s53, s53, 0x1c0000
    s_load_dword s94, s[16:17], s53 offset:0x0
    s_load_dword s94, s[16:17], s53 offset:0x40
    s_waitcnt vmcnt(15)
    global_store_dwordx4 v32, v[28:31], s[26:27] offset:1024 sc1
    s_waitcnt vmcnt(17)
    s_barrier
    s_add_u32 m0, s79, 135168
    s_add_u32 s72, s72, 128
    s_and_b32 s78, s72, 0x7ff
    buffer_load_dwordx4 v20, s[36:39], s78 offen lds
    s_add_u32 m0, s79, 136192
    s_nop 0
    buffer_load_dwordx4 v21, s[36:39], s78 offen lds
    s_add_u32 m0, s33, 36864
    s_add_u32 s77, s77, 229376
    buffer_load_dwordx4 v22, s[40:43], s77 offen offset:0 lds
    s_add_u32 m0, s33, 40832
    s_nop 0
    buffer_load_dwordx4 v22, s[40:43], s77 offen offset:128 lds
    s_add_u32 m0, s33, 45056
    s_nop 0
    buffer_load_dwordx4 v22, s[44:47], s77 offen offset:0 lds
    s_add_u32 m0, s33, 49024
    s_nop 0
    buffer_load_dwordx4 v22, s[44:47], s77 offen offset:128 lds
    s_add_u32 m0, s33, 53248
    s_nop 0
    buffer_load_dwordx4 v9, s[48:51], s77 offen lds
    s_load_dword s94, s[16:17], s53 offset:0x80
    s_load_dword s94, s[16:17], s53 offset:0xc0
    s_load_dword s94, s[16:17], s53 offset:0x100
    s_load_dword s94, s[16:17], s53 offset:0x140
    s_load_dword s94, s[16:17], s53 offset:0x180
    s_waitcnt vmcnt(16)
    s_barrier
    s_add_u32 m0, s79, 137216
    s_add_u32 s78, s78, 32768
    buffer_load_dwordx4 v20, s[36:39], s78 offen lds
    s_add_u32 m0, s79, 138240
    s_nop 0
    buffer_load_dwordx4 v21, s[36:39], s78 offen lds
    s_add_u32 m0, s33, 57344
    s_add_u32 s77, s77, 229376
    s_cmp_eq_u32 s77, 7340032
    s_cselect_b32 s77, 0, s77
    buffer_load_dwordx4 v22, s[40:43], s77 offen offset:0 lds
    s_add_u32 m0, s33, 61312
    s_nop 0
    buffer_load_dwordx4 v22, s[40:43], s77 offen offset:128 lds
    s_add_u32 m0, s33, 65536
    s_nop 0
    buffer_load_dwordx4 v22, s[44:47], s77 offen offset:0 lds
    s_add_u32 m0, s33, 69504
    s_nop 0
    buffer_load_dwordx4 v22, s[44:47], s77 offen offset:128 lds
    s_add_u32 m0, s33, 73728
    s_nop 0
    buffer_load_dwordx4 v9, s[48:51], s77 offen lds
    s_load_dword s94, s[16:17], s53 offset:0x1c0
    s_load_dword s94, s[18:19], s53 offset:0x0
    s_load_dword s94, s[18:19], s53 offset:0x40
    s_load_dword s94, s[18:19], s53 offset:0x80
    s_load_dword s94, s[18:19], s53 offset:0xc0
    s_sub_u32 s91, s28, s6
    s_max_i32 s91, s91, 0
    s_lshl_b32 s91, s91, 4
    s_cmp_lg_u32 s5, 0
    s_cselect_b32 s91, s29, s91
    s_cselect_b32 s92, 11, 7
    s_lshl_b32 s91, s91, 7
    s_add_u32 s91, s91, 0x1e80000
    v_lshlrev_b32 v87, s92, v1
    v_add_u32 v87, s91, v87
    s_mov_b64 exec, 0xffff
    global_load_dwordx2 v[18:19], v87, s[26:27] sc1
    s_mov_b64 exec, -1
    s_waitcnt vmcnt(16)
    s_barrier
    s_add_u32 m0, s79, 98304
    s_add_u32 s72, s72, 128
    s_and_b32 s78, s72, 0x7ff
    buffer_load_dwordx4 v20, s[36:39], s78 offen lds
    s_add_u32 m0, s79, 99328
    s_nop 0
    buffer_load_dwordx4 v21, s[36:39], s78 offen lds
    s_add_u32 m0, s33, 77824
    s_add_u32 s77, s77, 229376
    buffer_load_dwordx4 v22, s[40:43], s77 offen offset:0 lds
    s_add_u32 m0, s33, 81792
    s_nop 0
    buffer_load_dwordx4 v22, s[40:43], s77 offen offset:128 lds
    s_add_u32 m0, s33, 86016
    s_nop 0
    buffer_load_dwordx4 v22, s[44:47], s77 offen offset:0 lds
    s_add_u32 m0, s33, 89984
    s_nop 0
    buffer_load_dwordx4 v22, s[44:47], s77 offen offset:128 lds
    s_add_u32 m0, s33, 94208
    s_nop 0
    buffer_load_dwordx4 v9, s[48:51], s77 offen lds
    s_load_dword s94, s[18:19], s53 offset:0x100
    s_load_dword s94, s[18:19], s53 offset:0x140
    s_load_dword s94, s[18:19], s53 offset:0x180
    s_load_dword s94, s[18:19], s53 offset:0x1c0
    s_add_u32 s52, s52, 0x100000
    s_load_dword s94, s[10:11], s52 offset:0x0
    s_waitcnt vmcnt(7)
    s_mov_b64 exec, 0xffff
    s_movk_i32 s98, 0x4000
L_pLN_chk:
    v_cmp_ne_u64 vcc, s[100:101], v[18:19]
    s_nop 1
    s_cmp_eq_u64 vcc, 0
    s_cbranch_scc1 L_pLN_ok
    s_sub_u32 s98, s98, 1
    s_cbranch_scc1 L_pLN_ok
    s_sleep 1
    global_load_dwordx2 v[18:19], v87, s[26:27] sc1
    s_waitcnt vmcnt(0)
    s_branch L_pLN_chk
L_pLN_ok:
    s_mov_b64 exec, -1
    s_waitcnt vmcnt(15)
    s_barrier
    s_mul_i32 s91, s29, 20480
    s_mul_i32 s92, s4, 320
    s_add_u32 s91, s91, s92
    s_add_u32 s91, s91, 0x1e10000
    v_lshrrev_b32 v24, 2, v1
    v_mul_u32_u24 v24, 1280, v24
    v_and_b32 v25, 3, v1
    v_lshlrev_b32 v25, 4, v25
    v_add3_u32 v24, v24, v25, s91
    global_load_dwordx4 v[88:91], v24, s[26:27] offset:0
    global_load_dwordx4 v[92:95], v24, s[26:27] offset:64
    global_load_dwordx4 v[96:99], v24, s[26:27] offset:128
    global_load_dwordx4 v[100:103], v24, s[26:27] offset:192
    global_load_dwordx4 v[104:107], v24, s[26:27] offset:256
    s_add_u32 s92, s92, 159744
    v_lshrrev_b32 v37, 4, v1
    v_add_u32 v25, s92, v25
    v_lshl_add_u32 v36, v37, 2, v25
    v_lshl_add_u32 v25, v37, 6, v25
    s_lshl_b32 s91, s28, 2
    s_add_u32 s91, s91, s4
    s_lshl_b32 s91, s91, 8
    s_add_u32 s91, s91, 0x1e00000
    v_and_b32 v27, 31, v1
    v_lshl_add_u32 v26, v27, 3, s91
    global_load_dwordx2 v[28:29], v26, s[26:27]
    s_lshl_b32 s91, s4, 9
    s_add_u32 s91, s91, 161024
    v_lshl_add_u32 v27, v27, 4, s91
    s_add_u32 m0, s79, 100352
    s_add_u32 s78, s78, 32768
    buffer_load_dwordx4 v20, s[36:39], s78 offen lds
    s_add_u32 m0, s79, 101376
    s_nop 0
    buffer_load_dwordx4 v21, s[36:39], s78 offen lds
    s_add_u32 m0, s33, 16384
    s_add_u32 s77, s77, 229376
    s_cmp_eq_u32 s77, 7340032
    s_cselect_b32 s77, 0, s77
    buffer_load_dwordx4 v22, s[40:43], s77 offen offset:0 lds
    s_add_u32 m0, s33, 20352
    s_nop 0
    buffer_load_dwordx4 v22, s[40:43], s77 offen offset:128 lds
    s_add_u32 m0, s33, 24576
    s_nop 0
    buffer_load_dwordx4 v22, s[44:47], s77 offen offset:0 lds
    s_add_u32 m0, s33, 28544
    s_nop 0
    buffer_load_dwordx4 v22, s[44:47], s77 offen offset:128 lds
    s_add_u32 m0, s33, 32768
    s_nop 0
    buffer_load_dwordx4 v9, s[48:51], s77 offen lds
    s_load_dword s94, s[10:11], s52 offset:0x40
    s_load_dword s94, s[10:11], s52 offset:0x80
    s_load_dword s94, s[10:11], s52 offset:0xc0
    s_load_dword s94, s[10:11], s52 offset:0x100
    s_load_dword s94, s[10:11], s52 offset:0x140
    s_waitcnt vmcnt(35)
    s_waitcnt vmcnt(21)
    s_barrier
    s_add_u32 m0, s79, 116736
    s_add_u32 s72, s72, 128
    s_and_b32 s78, s72, 0x7ff
    buffer_load_dwordx4 v20, s[36:39], s78 offen lds
    s_add_u32 m0, s79, 117760
    s_nop 0
    buffer_load_dwordx4 v21, s[36:39], s78 offen lds
    s_add_u32 m0, s33, 36864
    s_add_u32 s77, s77, 229376
    buffer_load_dwordx4 v22, s[40:43], s77 offen offset:0 lds
    s_add_u32 m0, s33, 40832
    s_nop 0
    buffer_load_dwordx4 v22, s[40:43], s77 offen offset:128 lds
    s_add_u32 m0, s33, 45056
    s_nop 0
    buffer_load_dwordx4 v22, s[44:47], s77 offen offset:0 lds
    s_add_u32 m0, s33, 49024
    s_nop 0
    buffer_load_dwordx4 v22, s[44:47], s77 offen offset:128 lds
    s_add_u32 m0, s33, 53248
    s_nop 0
    buffer_load_dwordx4 v9, s[48:51], s77 offen lds
    s_load_dword s94, s[10:11], s52 offset:0x180
    s_load_dword s94, s[10:11], s52 offset:0x1c0
    s_load_dword s94, s[10:11], s52 offset:0x80000
    s_load_dword s94, s[10:11], s52 offset:0x80040
    s_load_dword s94, s[10:11], s52 offset:0x80080
    s_cmp_lg_u32 s4, 0
    s_cbranch_scc1 L_fC
    s_lshl_b32 s91, s28, 4
    s_add_u32 s91, s91, s29
    s_lshl_b32 s91, s91, 7
    s_add_u32 s91, s91, 0x1eb0000
    v_mov_b32 v32, s91
    v_mov_b32 v34, s100
    v_mov_b32 v35, s101
    s_mov_b64 exec, 1
    global_store_dwordx2 v32, v[34:35], s[26:27] sc1
    s_mov_b64 exec, -1
L_fC:
    s_waitcnt vmcnt(20)
    s_barrier
    s_add_u32 m0, s79, 118784
    s_add_u32 s78, s78, 32768
    buffer_load_dwordx4 v20, s[36:39], s78 offen lds
    s_waitcnt vmcnt(15)
    v_rcp_f32 v30, v29
    v_mul_f32 v32, -1.0, v28
    v_mul_f32 v35, v29, v29
    v_fma_f32 v31, -v29, v30, 1.0
    v_fma_f32 v30, v31, v30, v30
    v_mul_f32 v33, 0xc0135761, v30
    v_mul_f32 v31, v30, v30
    s_add_u32 m0, s79, 119808
    s_nop 0
    buffer_load_dwordx4 v21, s[36:39], s78 offen lds
    v_mul_f32 v31, v31, v30
    v_mul_f32 v34, 0xbdd2d3e8, v31
    ds_write_b128 v27, v[32:35]
    v_permlane16_swap_b32 v88, v92
    v_permlane16_swap_b32 v96, v100
    v_permlane16_swap_b32 v89, v93
    v_permlane16_swap_b32 v97, v101
    v_permlane16_swap_b32 v90, v94
    v_permlane16_swap_b32 v98, v102
    s_add_u32 m0, s33, 57344
    s_add_u32 s77, s77, 229376
    s_cmp_eq_u32 s77, 7340032
    s_cselect_b32 s77, 0, s77
    buffer_load_dwordx4 v22, s[40:43], s77 offen offset:0 lds
    v_permlane16_swap_b32 v91, v95
    v_permlane16_swap_b32 v99, v103
    v_permlane16_swap_b32 v104, v105
    v_permlane16_swap_b32 v106, v107
    v_add_f32 v88, v88, v92
    v_add_f32 v96, v96, v100
    v_add_f32 v89, v89, v93
    v_add_f32 v97, v97, v101
    s_add_u32 m0, s33, 61312
    s_nop 0
    buffer_load_dwordx4 v22, s[40:43], s77 offen offset:128 lds
    v_add_f32 v90, v90, v94
    v_add_f32 v98, v98, v102
    v_add_f32 v91, v91, v95
    v_add_f32 v99, v99, v103
    v_add_f32 v104, v104, v105
    v_add_f32 v106, v106, v107
    s_nop 0
    v_permlane32_swap_b32 v88, v96
    v_permlane32_swap_b32 v89, v97
    s_add_u32 m0, s33, 65536
    s_nop 0
    buffer_load_dwordx4 v22, s[44:47], s77 offen offset:0 lds
    v_permlane32_swap_b32 v90, v98
    v_permlane32_swap_b32 v91, v99
    v_permlane32_swap_b32 v104, v106
    v_add_f32 v88, v88, v96
    v_add_f32 v89, v89, v97
    v_add_f32 v90, v90, v98
    v_add_f32 v91, v91, v99
    v_add_f32 v104, v104, v106
    s_add_u32 m0, s33, 69504
    s_nop 0
    buffer_load_dwordx4 v22, s[44:47], s77 offen offset:128 lds
    s_add_u32 m0, s33, 73728
    s_nop 0
    buffer_load_dwordx4 v9, s[48:51], s77 offen lds
    v_add_f32_dpp v88, v88, v88 row_ror:8 row_mask:0xf bank_mask:0xf
    v_add_f32_dpp v89, v89, v89 row_ror:8 row_mask:0xf bank_mask:0xf
    v_add_f32_dpp v90, v90, v90 row_ror:8 row_mask:0xf bank_mask:0xf
    v_add_f32_dpp v91, v91, v91 row_ror:8 row_mask:0xf bank_mask:0xf
    v_add_f32_dpp v104, v104, v104 row_ror:8 row_mask:0xf bank_mask:0xf
    v_add_f32_dpp v88, v88, v88 row_ror:4 row_mask:0xf bank_mask:0xf
    v_add_f32_dpp v89, v89, v89 row_ror:4 row_mask:0xf bank_mask:0xf
    v_add_f32_dpp v90, v90, v90 row_ror:4 row_mask:0xf bank_mask:0xf
    s_load_dword s94, s[10:11], s52 offset:0x800c0
    s_load_dword s94, s[10:11], s52 offset:0x80100
    s_load_dword s94, s[10:11], s52 offset:0x80140
    s_load_dword s94, s[10:11], s52 offset:0x80180
    s_load_dword s94, s[10:11], s52 offset:0x801c0
    s_waitcnt vmcnt(14)
    s_barrier
    s_mov_b32 s36, s26
    s_mov_b32 s37, s27
    s_mov_b32 s38, 0x400000
    s_mov_b32 s39, 0x20000
    s_add_u32 m0, s33, 77824
    s_add_u32 s77, s77, 229376
    buffer_load_dwordx4 v22, s[40:43], s77 offen offset:0 lds
    v_add_f32_dpp v91, v91, v91 row_ror:4 row_mask:0xf bank_mask:0xf
    v_add_f32_dpp v104, v104, v104 row_ror:4 row_mask:0xf bank_mask:0xf
    s_mov_b32 s92, 0x000f000f
    s_mov_b32 s93, s92
    s_mov_b64 exec, s[92:93]
    ds_write_b128 v25, v[88:91]
    ds_write_b32 v36, v104 offset:256
    s_mov_b64 exec, -1
    v_mov_b32 v88, 0
    v_mov_b32 v89, 0
    v_mov_b32 v90, 0
    v_mov_b32 v91, 0
    v_mov_b32 v92, 0
    v_mov_b32 v93, 0
    v_mov_b32 v94, 0
    v_mov_b32 v95, 0
    s_add_u32 m0, s33, 81792
    s_nop 0
    buffer_load_dwordx4 v22, s[40:43], s77 offen offset:128 lds
    s_add_u32 m0, s33, 86016
    s_nop 0
    buffer_load_dwordx4 v22, s[44:47], s77 offen offset:0 lds
    v_mov_b32 v96, 0
    v_mov_b32 v97, 0
    v_mov_b32 v98, 0
    v_mov_b32 v99, 0
    v_mov_b32 v100, 0
    v_mov_b32 v101, 0
    v_mov_b32 v102, 0
    v_mov_b32 v103, 0
    s_add_u32 m0, s33, 89984
    s_nop 0
    buffer_load_dwordx4 v22, s[44:47], s77 offen offset:128 lds
    v_mov_b32 v104, 0
    v_mov_b32 v105, 0
    v_mov_b32 v106, 0
    v_mov_b32 v107, 0
    v_mov_b32 v108, 0
    v_mov_b32 v109, 0
    v_mov_b32 v110, 0
    v_mov_b32 v111, 0
    s_add_u32 m0, s33, 94208
    s_nop 0
    buffer_load_dwordx4 v9, s[48:51], s77 offen lds
    s_add_u32 m0, s79, 135168
    s_mov_b32 s78, 0
    buffer_load_dwordx4 v20, s[36:39], s78 offen sc1 lds
    s_add_u32 m0, s79, 136192
    s_nop 0
    buffer_load_dwordx4 v21, s[36:39], s78 offen sc1 lds
    s_waitcnt vmcnt(14)
    s_barrier
    s_lshl_b32 s85, s29, 7
    s_add_u32 s86, s85, 4096
    s_add_u32 s87, s85, 128
    s_and_b32 s87, s87, 0x7ff
    s_add_u32 s87, s87, 5120
    s_add_u32 s40, s10, s85
    s_addc_u32 s41, s11, 0
    s_add_u32 s44, s10, s86
    s_addc_u32 s45, s11, 0
    s_add_u32 s48, s16, s87
    s_addc_u32 s49, s17, 0
    s_add_u32 s52, s18, s87
    s_addc_u32 s53, s19, 0
    s_sub_u32 s42, 6291456, s85
    s_sub_u32 s46, 6291456, s86
    s_mov_b32 s50, s54
    s_add_u32 m0, s79, 137216
    s_mov_b32 s78, 32768
    buffer_load_dwordx4 v20, s[36:39], s78 offen sc1 lds
    s_add_u32 m0, s79, 138240
    s_nop 0
    buffer_load_dwordx4 v21, s[36:39], s78 offen sc1 lds
    s_add_u32 m0, s81, 151552
    s_mov_b32 s78, 0
    s_mov_b64 exec, 0xffffffff
    buffer_load_dwordx4 v3, s[36:39], s78 offen sc1 lds
    s_mov_b64 exec, -1
    s_add_u32 m0, s33, 16384
    s_mov_b32 s76, 0
    buffer_load_dwordx4 v23, s[40:43], s76 offen offset:0 lds
    s_add_u32 m0, s33, 18432
    s_nop 0
    buffer_load_dwordx4 v23, s[40:43], s76 offen offset:2048 lds
    s_add_u32 m0, s33, 24576
    s_nop 0
    buffer_load_dwordx4 v23, s[44:47], s76 offen offset:0 lds
    s_add_u32 m0, s33, 28672
    s_mov_b32 s77, 0
    buffer_load_dwordx4 v22, s[48:51], s77 offen offset:0 lds
    s_add_u32 m0, s33, 32768
    s_nop 0
    buffer_load_dwordx4 v22, s[52:55], s77 offen offset:0 lds
    s_waitcnt vmcnt(15)
    s_barrier
    s_add_u32 m0, s79, 98304
    s_mov_b32 s78, 128
    buffer_load_dwordx4 v20, s[36:39], s78 offen sc1 lds
    s_add_u32 m0, s79, 99328
    s_nop 0
    buffer_load_dwordx4 v21, s[36:39], s78 offen sc1 lds
    s_add_u32 m0, s33, 36864
    s_mov_b32 s76, 196608
    buffer_load_dwordx4 v23, s[40:43], s76 offen offset:0 lds
    s_add_u32 m0, s33, 38912
    s_nop 0
    buffer_load_dwordx4 v23, s[40:43], s76 offen offset:2048 lds
    s_add_u32 m0, s33, 45056
    s_nop 0
    buffer_load_dwordx4 v23, s[44:47], s76 offen offset:0 lds
    s_add_u32 m0, s33, 49152
    s_mov_b32 s77, 229376
    buffer_load_dwordx4 v22, s[48:51], s77 offen offset:0 lds
    s_add_u32 m0, s33, 53248
    s_nop 0
    buffer_load_dwordx4 v22, s[52:55], s77 offen offset:0 lds
    s_waitcnt vmcnt(7)
    s_barrier
    s_add_u32 m0, s79, 100352
    s_mov_b32 s78, 32896
    buffer_load_dwordx4 v20, s[36:39], s78 offen sc1 lds
    s_add_u32 m0, s79, 101376
    s_nop 0
    buffer_load_dwordx4 v21, s[36:39], s78 offen sc1 lds
    s_add_u32 m0, s81, 114688
    s_mov_b32 s78, 128
    s_mov_b64 exec, 0xffffffff
    buffer_load_dwordx4 v3, s[36:39], s78 offen sc1 lds
    s_mov_b64 exec, -1
    s_add_u32 m0, s33, 57344
    s_mov_b32 s76, 393216
L_pad8:
    s_cbranch_execz L_vret0
    buffer_load_dwordx4 v23, s[40:43], s76 offen offset:0 lds
    s_add_u32 m0, s33, 59392
    s_nop 0
    buffer_load_dwordx4 v23, s[40:43], s76 offen offset:2048 lds
    s_add_u32 m0, s33, 65536
    s_nop 0
    buffer_load_dwordx4 v23, s[44:47], s76 offen offset:0 lds
    s_add_u32 m0, s33, 69632
    s_mov_b32 s77, 458752
    buffer_load_dwordx4 v22, s[48:51], s77 offen offset:0 lds
    s_add_u32 m0, s33, 73728
    s_nop 0
    buffer_load_dwordx4 v22, s[52:55], s77 offen offset:0 lds
    s_waitcnt lgkmcnt(0)
    v_add_u32 v14, s80, v16
    v_add_u32 v15, s80, v17
    s_add_u32 s84, s80, s95
    v_add_u32 v18, s84, v16
    v_add_u32 v19, s84, v17
    s_add_u32 s80, s80, 18432
    s_cmp_ge_u32 s80, 153600
    s_cselect_b32 s84, 55296, 0
    s_sub_u32 s80, s80, s84
    ds_read_b64_tr_b16 v[64:65], v4 offset:4096
    ds_read_b64_tr_b16 v[66:67], v4 offset:4608
    ds_read_b128 v[24:27], v14 offset:0
    ds_read_b128 v[28:31], v14 offset:2048
    ds_read_b128 v[32:35], v14 offset:4096
    ds_read_b128 v[36:39], v14 offset:6144
    ds_read_b64_tr_b16 v[68:69], v5 offset:4096
    ds_read_b64_tr_b16 v[70:71], v5 offset:4608
    ds_read_b64_tr_b16 v[72:73], v4 offset:8192
    ds_read_b64_tr_b16 v[74:75], v4 offset:8704
    ds_read_b128 v[56:59], v18
    s_barrier
    s_setprio 1
    s_mov_b32 s34, 7
.p2align 6
L_p2:
    s_waitcnt lgkmcnt(8)
    v_mfma_f32_16x16x32_bf16 v[88:91], v[64:67], v[24:27], v[88:91]
    ds_read_b64_tr_b16 v[76:77], v5 offset:8192
    s_waitcnt lgkmcnt(8)
    v_mfma_f32_16x16x32_bf16 v[92:95], v[64:67], v[28:31], v[92:95]
    ds_read_b64_tr_b16 v[78:79], v5 offset:8704
    s_waitcnt lgkmcnt(8)
    v_mfma_f32_16x16x32_bf16 v[96:99], v[64:67], v[32:35], v[96:99]
    ds_read_b64_tr_b16 v[80:81], v4 offset:0
    s_waitcnt lgkmcnt(8)
    v_mfma_f32_16x16x32_bf16 v[100:103], v[64:67], v[36:39], v[100:103]
    ds_read_b64_tr_b16 v[82:83], v4 offset:512
    s_waitcnt lgkmcnt(4)
    v_mfma_f32_16x16x32_bf16 v[248:251], v[64:67], v[56:59], v[248:251]
    v_mfma_f32_16x16x32_bf16 v[104:107], v[68:71], v[24:27], v[104:107]
    ds_read_b64_tr_b16 v[64:65], v5 offset:0
    v_mfma_f32_16x16x32_bf16 v[108:111], v[68:71], v[28:31], v[108:111]
    v_mfma_f32_16x16x32_bf16 v[112:115], v[68:71], v[32:35], v[112:115]
    ds_read_b64_tr_b16 v[66:67], v5 offset:512
    v_mfma_f32_16x16x32_bf16 v[116:119], v[68:71], v[36:39], v[116:119]
    v_mfma_f32_16x16x32_bf16 v[120:123], v[24:27], v[72:75], v[120:123]
    ds_read_b64_tr_b16 v[68:69], v4 offset:12288
    v_mfma_f32_16x16x32_bf16 v[124:127], v[28:31], v[72:75], v[124:127]
    v_mfma_f32_16x16x32_bf16 v[128:131], v[32:35], v[72:75], v[128:131]
    ds_read_b64_tr_b16 v[70:71], v4 offset:12800
    v_mfma_f32_16x16x32_bf16 v[132:135], v[36:39], v[72:75], v[132:135]
    v_mfma_f32_16x16x32_bf16 v[252:255], v[56:59], v[72:75], v[252:255]
    s_waitcnt lgkmcnt(6)
    v_mfma_f32_16x16x32_bf16 v[136:139], v[24:27], v[76:79], v[136:139]
    ds_read_b64_tr_b16 v[72:73], v4 offset:16384
    v_mfma_f32_16x16x32_bf16 v[140:143], v[28:31], v[76:79], v[140:143]
    v_mfma_f32_16x16x32_bf16 v[144:147], v[32:35], v[76:79], v[144:147]
    ds_read_b64_tr_b16 v[74:75], v4 offset:16896
    v_mfma_f32_16x16x32_bf16 v[148:151], v[36:39], v[76:79], v[148:151]
    s_waitcnt lgkmcnt(6)
    v_mfma_f32_16x16x32_bf16 v[152:155], v[80:83], v[24:27], v[152:155]
    ds_read_b64_tr_b16 v[76:77], v5 offset:12288
    v_mfma_f32_16x16x32_bf16 v[156:159], v[80:83], v[28:31], v[156:159]
    v_mfma_f32_16x16x32_bf16 v[160:163], v[80:83], v[32:35], v[160:163]
    ds_read_b64_tr_b16 v[78:79], v5 offset:12800
    v_mfma_f32_16x16x32_bf16 v[164:167], v[80:83], v[36:39], v[164:167]
    s_waitcnt lgkmcnt(6)
    v_mfma_f32_16x16x32_bf16 v[168:171], v[64:67], v[24:27], v[168:171]
    ds_read_b64_tr_b16 v[80:81], v5 offset:16384
    v_mfma_f32_16x16x32_bf16 v[172:175], v[64:67], v[28:31], v[172:175]
    v_mfma_f32_16x16x32_bf16 v[176:179], v[64:67], v[32:35], v[176:179]
    ds_read_b64_tr_b16 v[82:83], v5 offset:16896
    v_mfma_f32_16x16x32_bf16 v[180:183], v[64:67], v[36:39], v[180:183]
    s_waitcnt lgkmcnt(6)
    v_mfma_f32_16x16x32_bf16 v[184:187], v[68:71], v[24:27], v[184:187]
    v_mfma_f32_16x16x32_bf16 v[188:191], v[68:71], v[28:31], v[188:191]
    v_mfma_f32_16x16x32_bf16 v[192:195], v[68:71], v[32:35], v[192:195]
    v_mfma_f32_16x16x32_bf16 v[196:199], v[68:71], v[36:39], v[196:199]
    s_waitcnt vmcnt(8) lgkmcnt(0)
    s_barrier
    v_mfma_f32_16x16x32_bf16 v[200:203], v[72:75], v[24:27], v[200:203]
    ds_read_b64_tr_b16 v[64:65], v4 offset:24576
    v_mfma_f32_16x16x32_bf16 v[204:207], v[72:75], v[28:31], v[204:207]
    ds_read_b64_tr_b16 v[66:67], v4 offset:25088
    v_mfma_f32_16x16x32_bf16 v[208:211], v[72:75], v[32:35], v[208:211]
    ds_read_b128 v[40:43], v15 offset:0
    v_mfma_f32_16x16x32_bf16 v[212:215], v[72:75], v[36:39], v[212:215]
    ds_read_b128 v[44:47], v15 offset:2048
    v_mfma_f32_16x16x32_bf16 v[216:219], v[76:79], v[24:27], v[216:219]
    ds_read_b128 v[48:51], v15 offset:4096
    v_mfma_f32_16x16x32_bf16 v[220:223], v[76:79], v[28:31], v[220:223]
    ds_read_b128 v[52:55], v15 offset:6144
    v_mfma_f32_16x16x32_bf16 v[224:227], v[76:79], v[32:35], v[224:227]
    ds_read_b64_tr_b16 v[68:69], v5 offset:24576
    v_mfma_f32_16x16x32_bf16 v[228:231], v[76:79], v[36:39], v[228:231]
    ds_read_b64_tr_b16 v[70:71], v5 offset:25088
    v_mfma_f32_16x16x32_bf16 v[232:235], v[80:83], v[24:27], v[232:235]
    ds_read_b64_tr_b16 v[72:73], v4 offset:28672
    v_mfma_f32_16x16x32_bf16 v[236:239], v[80:83], v[28:31], v[236:239]
    ds_read_b64_tr_b16 v[74:75], v4 offset:29184
    v_mfma_f32_16x16x32_bf16 v[240:243], v[80:83], v[32:35], v[240:243]
    ds_read_b128 v[60:63], v19
    v_mfma_f32_16x16x32_bf16 v[244:247], v[80:83], v[36:39], v[244:247]
    s_waitcnt lgkmcnt(8)
    v_mfma_f32_16x16x32_bf16 v[88:91], v[64:67], v[40:43], v[88:91]
    ds_read_b64_tr_b16 v[76:77], v5 offset:28672
    s_waitcnt lgkmcnt(8)
    v_mfma_f32_16x16x32_bf16 v[92:95], v[64:67], v[44:47], v[92:95]
    ds_read_b64_tr_b16 v[78:79], v5 offset:29184
    s_waitcnt lgkmcnt(8)
    v_mfma_f32_16x16x32_bf16 v[96:99], v[64:67], v[48:51], v[96:99]
    ds_read_b64_tr_b16 v[80:81], v4 offset:20480
    s_waitcnt lgkmcnt(8)
    v_mfma_f32_16x16x32_bf16 v[100:103], v[64:67], v[52:55], v[100:103]
    ds_read_b64_tr_b16 v[82:83], v4 offset:20992
    s_waitcnt lgkmcnt(4)
    v_mfma_f32_16x16x32_bf16 v[248:251], v[64:67], v[60:63], v[248:251]
    v_mfma_f32_16x16x32_bf16 v[104:107], v[68:71], v[40:43], v[104:107]
    ds_read_b64_tr_b16 v[64:65], v5 offset:20480
    v_mfma_f32_16x16x32_bf16 v[108:111], v[68:71], v[44:47], v[108:111]
    v_add_u32 v14, s80, v16
    v_mfma_f32_16x16x32_bf16 v[112:115], v[68:71], v[48:51], v[112:115]
    ds_read_b64_tr_b16 v[66:67], v5 offset:20992
    v_mfma_f32_16x16x32_bf16 v[116:119], v[68:71], v[52:55], v[116:119]
    v_add_u32 v15, s80, v17
    v_mfma_f32_16x16x32_bf16 v[120:123], v[40:43], v[72:75], v[120:123]
    ds_read_b64_tr_b16 v[68:69], v4 offset:32768
    v_mfma_f32_16x16x32_bf16 v[124:127], v[44:47], v[72:75], v[124:127]
    s_add_u32 s84, s80, s95
    v_mfma_f32_16x16x32_bf16 v[128:131], v[48:51], v[72:75], v[128:131]
    ds_read_b64_tr_b16 v[70:71], v4 offset:33280
    v_mfma_f32_16x16x32_bf16 v[132:135], v[52:55], v[72:75], v[132:135]
    v_add_u32 v18, s84, v16
    v_mfma_f32_16x16x32_bf16 v[252:255], v[60:63], v[72:75], v[252:255]
    s_waitcnt lgkmcnt(6)
    v_mfma_f32_16x16x32_bf16 v[136:139], v[40:43], v[76:79], v[136:139]
    ds_read_b64_tr_b16 v[72:73], v4 offset:36864
    v_mfma_f32_16x16x32_bf16 v[140:143], v[44:47], v[76:79], v[140:143]
    v_add_u32 v19, s84, v17
    v_mfma_f32_16x16x32_bf16 v[144:147], v[48:51], v[76:79], v[144:147]
    ds_read_b64_tr_b16 v[74:75], v4 offset:37376
    v_mfma_f32_16x16x32_bf16 v[148:151], v[52:55], v[76:79], v[148:151]
    s_add_u32 s80, s80, 18432
    s_waitcnt lgkmcnt(6)
    v_mfma_f32_16x16x32_bf16 v[152:155], v[80:83], v[40:43], v[152:155]
    ds_read_b64_tr_b16 v[76:77], v5 offset:32768
    v_mfma_f32_16x16x32_bf16 v[156:159], v[80:83], v[44:47], v[156:159]
    s_cmp_ge_u32 s80, 153600
    s_cselect_b32 s84, 55296, 0
    v_mfma_f32_16x16x32_bf16 v[160:163], v[80:83], v[48:51], v[160:163]
    ds_read_b64_tr_b16 v[78:79], v5 offset:33280
    v_mfma_f32_16x16x32_bf16 v[164:167], v[80:83], v[52:55], v[164:167]
    s_sub_u32 s80, s80, s84
    s_waitcnt lgkmcnt(6)
    v_mfma_f32_16x16x32_bf16 v[168:171], v[64:67], v[40:43], v[168:171]
    ds_read_b64_tr_b16 v[80:81], v5 offset:36864
    v_mfma_f32_16x16x32_bf16 v[172:175], v[64:67], v[44:47], v[172:175]
    v_mfma_f32_16x16x32_bf16 v[176:179], v[64:67], v[48:51], v[176:179]
    ds_read_b64_tr_b16 v[82:83], v5 offset:37376
    v_mfma_f32_16x16x32_bf16 v[180:183], v[64:67], v[52:55], v[180:183]
    s_waitcnt lgkmcnt(6)
    v_mfma_f32_16x16x32_bf16 v[184:187], v[68:71], v[40:43], v[184:187]
    v_mfma_f32_16x16x32_bf16 v[188:191], v[68:71], v[44:47], v[188:191]
    v_mfma_f32_16x16x32_bf16 v[192:195], v[68:71], v[48:51], v[192:195]
    v_mfma_f32_16x16x32_bf16 v[196:199], v[68:71], v[52:55], v[196:199]
    s_waitcnt vmcnt(0) lgkmcnt(0)
    s_barrier
    v_mfma_f32_16x16x32_bf16 v[200:203], v[72:75], v[40:43], v[200:203]
    ds_read_b64_tr_b16 v[64:65], v6 offset:4096
    v_mfma_f32_16x16x32_bf16 v[204:207], v[72:75], v[44:47], v[204:207]
    ds_read_b64_tr_b16 v[66:67], v6 offset:4608
    v_mfma_f32_16x16x32_bf16 v[208:211], v[72:75], v[48:51], v[208:211]
    ds_read_b128 v[24:27], v14 offset:0
    v_mfma_f32_16x16x32_bf16 v[212:215], v[72:75], v[52:55], v[212:215]
    ds_read_b128 v[28:31], v14 offset:2048
    v_mfma_f32_16x16x32_bf16 v[216:219], v[76:79], v[40:43], v[216:219]
    ds_read_b128 v[32:35], v14 offset:4096
    v_mfma_f32_16x16x32_bf16 v[220:223], v[76:79], v[44:47], v[220:223]
    ds_read_b128 v[36:39], v14 offset:6144
    v_mfma_f32_16x16x32_bf16 v[224:227], v[76:79], v[48:51], v[224:227]
    ds_read_b64_tr_b16 v[68:69], v7 offset:4096
    v_mfma_f32_16x16x32_bf16 v[228:231], v[76:79], v[52:55], v[228:231]
    ds_read_b64_tr_b16 v[70:71], v7 offset:4608
    v_mfma_f32_16x16x32_bf16 v[232:235], v[80:83], v[40:43], v[232:235]
    ds_read_b64_tr_b16 v[72:73], v6 offset:8192
    v_mfma_f32_16x16x32_bf16 v[236:239], v[80:83], v[44:47], v[236:239]
    ds_read_b64_tr_b16 v[74:75], v6 offset:8704
    v_mfma_f32_16x16x32_bf16 v[240:243], v[80:83], v[48:51], v[240:243]
    ds_read_b128 v[56:59], v18
    v_mfma_f32_16x16x32_bf16 v[244:247], v[80:83], v[52:55], v[244:247]
    s_waitcnt lgkmcnt(8)
    v_mfma_f32_16x16x32_bf16 v[88:91], v[64:67], v[24:27], v[88:91]
    ds_read_b64_tr_b16 v[76:77], v7 offset:8192
    s_waitcnt lgkmcnt(8)
    v_mfma_f32_16x16x32_bf16 v[92:95], v[64:67], v[28:31], v[92:95]
    ds_read_b64_tr_b16 v[78:79], v7 offset:8704
    s_waitcnt lgkmcnt(8)
    v_mfma_f32_16x16x32_bf16 v[96:99], v[64:67], v[32:35], v[96:99]
    ds_read_b64_tr_b16 v[80:81], v6 offset:0
    s_waitcnt lgkmcnt(8)
    v_mfma_f32_16x16x32_bf16 v[100:103], v[64:67], v[36:39], v[100:103]
    ds_read_b64_tr_b16 v[82:83], v6 offset:512
    s_waitcnt lgkmcnt(4)
    v_mfma_f32_16x16x32_bf16 v[248:251], v[64:67], v[56:59], v[248:251]
    v_mfma_f32_16x16x32_bf16 v[104:107], v[68:71], v[24:27], v[104:107]
    ds_read_b64_tr_b16 v[64:65], v7 offset:0
    v_mfma_f32_16x16x32_bf16 v[108:111], v[68:71], v[28:31], v[108:111]
    v_mfma_f32_16x16x32_bf16 v[112:115], v[68:71], v[32:35], v[112:115]
    ds_read_b64_tr_b16 v[66:67], v7 offset:512
    v_mfma_f32_16x16x32_bf16 v[116:119], v[68:71], v[36:39], v[116:119]
    v_mfma_f32_16x16x32_bf16 v[120:123], v[24:27], v[72:75], v[120:123]
    ds_read_b64_tr_b16 v[68:69], v6 offset:12288
    v_mfma_f32_16x16x32_bf16 v[124:127], v[28:31], v[72:75], v[124:127]
    v_mfma_f32_16x16x32_bf16 v[128:131], v[32:35], v[72:75], v[128:131]
    ds_read_b64_tr_b16 v[70:71], v6 offset:12800
    v_mfma_f32_16x16x32_bf16 v[132:135], v[36:39], v[72:75], v[132:135]
    v_mfma_f32_16x16x32_bf16 v[252:255], v[56:59], v[72:75], v[252:255]
    s_waitcnt lgkmcnt(6)
    v_mfma_f32_16x16x32_bf16 v[136:139], v[24:27], v[76:79], v[136:139]
    ds_read_b64_tr_b16 v[72:73], v6 offset:16384
    v_mfma_f32_16x16x32_bf16 v[140:143], v[28:31], v[76:79], v[140:143]
    v_mfma_f32_16x16x32_bf16 v[144:147], v[32:35], v[76:79], v[144:147]
    ds_read_b64_tr_b16 v[74:75], v6 offset:16896
    v_mfma_f32_16x16x32_bf16 v[148:151], v[36:39], v[76:79], v[148:151]
    s_waitcnt lgkmcnt(6)
    v_mfma_f32_16x16x32_bf16 v[152:155], v[80:83], v[24:27], v[152:155]
    ds_read_b64_tr_b16 v[76:77], v7 offset:12288
    v_mfma_f32_16x16x32_bf16 v[156:159], v[80:83], v[28:31], v[156:159]
    v_mfma_f32_16x16x32_bf16 v[160:163], v[80:83], v[32:35], v[160:163]
    ds_read_b64_tr_b16 v[78:79], v7 offset:12800
    v_mfma_f32_16x16x32_bf16 v[164:167], v[80:83], v[36:39], v[164:167]
    s_waitcnt lgkmcnt(6)
    v_mfma_f32_16x16x32_bf16 v[168:171], v[64:67], v[24:27], v[168:171]
    ds_read_b64_tr_b16 v[80:81], v7 offset:16384
    v_mfma_f32_16x16x32_bf16 v[172:175], v[64:67], v[28:31], v[172:175]
    v_mfma_f32_16x16x32_bf16 v[176:179], v[64:67], v[32:35], v[176:179]
    ds_read_b64_tr_b16 v[82:83], v7 offset:16896
    v_mfma_f32_16x16x32_bf16 v[180:183], v[64:67], v[36:39], v[180:183]
    s_waitcnt lgkmcnt(6)
    v_mfma_f32_16x16x32_bf16 v[184:187], v[68:71], v[24:27], v[184:187]
    v_mfma_f32_16x16x32_bf16 v[188:191], v[68:71], v[28:31], v[188:191]
    v_mfma_f32_16x16x32_bf16 v[192:195], v[68:71], v[32:35], v[192:195]
    v_mfma_f32_16x16x32_bf16 v[196:199], v[68:71], v[36:39], v[196:199]
    s_waitcnt lgkmcnt(0)
    s_barrier
    v_mfma_f32_16x16x32_bf16 v[200:203], v[72:75], v[24:27], v[200:203]
    ds_read_b64_tr_b16 v[64:65], v6 offset:24576
    v_mfma_f32_16x16x32_bf16 v[204:207], v[72:75], v[28:31], v[204:207]
    ds_read_b64_tr_b16 v[66:67], v6 offset:25088
    v_mfma_f32_16x16x32_bf16 v[208:211], v[72:75], v[32:35], v[208:211]
    ds_read_b128 v[40:43], v15 offset:0
    v_mfma_f32_16x16x32_bf16 v[212:215], v[72:75], v[36:39], v[212:215]
    ds_read_b128 v[44:47], v15 offset:2048
    v_mfma_f32_16x16x32_bf16 v[216:219], v[76:79], v[24:27], v[216:219]
    ds_read_b128 v[48:51], v15 offset:4096
    v_mfma_f32_16x16x32_bf16 v[220:223], v[76:79], v[28:31], v[220:223]
    ds_read_b128 v[52:55], v15 offset:6144
    v_mfma_f32_16x16x32_bf16 v[224:227], v[76:79], v[32:35], v[224:227]
    ds_read_b64_tr_b16 v[68:69], v7 offset:24576
    v_mfma_f32_16x16x32_bf16 v[228:231], v[76:79], v[36:39], v[228:231]
    ds_read_b64_tr_b16 v[70:71], v7 offset:25088
    v_mfma_f32_16x16x32_bf16 v[232:235], v[80:83], v[24:27], v[232:235]
    ds_read_b64_tr_b16 v[72:73], v6 offset:28672
    v_mfma_f32_16x16x32_bf16 v[236:239], v[80:83], v[28:31], v[236:239]
    ds_read_b64_tr_b16 v[74:75], v6 offset:29184
    v_mfma_f32_16x16x32_bf16 v[240:243], v[80:83], v[32:35], v[240:243]
    ds_read_b128 v[60:63], v19
    v_mfma_f32_16x16x32_bf16 v[244:247], v[80:83], v[36:39], v[244:247]
    s_waitcnt lgkmcnt(8)
    v_mfma_f32_16x16x32_bf16 v[88:91], v[64:67], v[40:43], v[88:91]
    ds_read_b64_tr_b16 v[76:77], v7 offset:28672
    s_waitcnt lgkmcnt(8)
    v_mfma_f32_16x16x32_bf16 v[92:95], v[64:67], v[44:47], v[92:95]
    ds_read_b64_tr_b16 v[78:79], v7 offset:29184
    s_waitcnt lgkmcnt(8)
    v_mfma_f32_16x16x32_bf16 v[96:99], v[64:67], v[48:51], v[96:99]
    ds_read_b64_tr_b16 v[80:81], v6 offset:20480
    s_waitcnt lgkmcnt(8)
    v_mfma_f32_16x16x32_bf16 v[100:103], v[64:67], v[52:55], v[100:103]
    ds_read_b64_tr_b16 v[82:83], v6 offset:20992
    s_waitcnt lgkmcnt(4)
    v_mfma_f32_16x16x32_bf16 v[248:251], v[64:67], v[60:63], v[248:251]
    v_mfma_f32_16x16x32_bf16 v[104:107], v[68:71], v[40:43], v[104:107]
    ds_read_b64_tr_b16 v[64:65], v7 offset:20480
    v_mfma_f32_16x16x32_bf16 v[108:111], v[68:71], v[44:47], v[108:111]
    v_add_u32 v14, s80, v16
    v_mfma_f32_16x16x32_bf16 v[112:115], v[68:71], v[48:51], v[112:115]
    ds_read_b64_tr_b16 v[66:67], v7 offset:20992
    v_mfma_f32_16x16x32_bf16 v[116:119], v[68:71], v[52:55], v[116:119]
    v_add_u32 v15, s80, v17
    v_mfma_f32_16x16x32_bf16 v[120:123], v[40:43], v[72:75], v[120:123]
    ds_read_b64_tr_b16 v[68:69], v6 offset:32768
    v_mfma_f32_16x16x32_bf16 v[124:127], v[44:47], v[72:75], v[124:127]
    s_add_u32 s84, s80, s95
    v_mfma_f32_16x16x32_bf16 v[128:131], v[48:51], v[72:75], v[128:131]
    ds_read_b64_tr_b16 v[70:71], v6 offset:33280
    v_mfma_f32_16x16x32_bf16 v[132:135], v[52:55], v[72:75], v[132:135]
    v_add_u32 v18, s84, v16
    v_mfma_f32_16x16x32_bf16 v[252:255], v[60:63], v[72:75], v[252:255]
    s_waitcnt lgkmcnt(6)
    v_mfma_f32_16x16x32_bf16 v[136:139], v[40:43], v[76:79], v[136:139]
    ds_read_b64_tr_b16 v[72:73], v6 offset:36864
    v_mfma_f32_16x16x32_bf16 v[140:143], v[44:47], v[76:79], v[140:143]
    v_add_u32 v19, s84, v17
    v_mfma_f32_16x16x32_bf16 v[144:147], v[48:51], v[76:79], v[144:147]
    ds_read_b64_tr_b16 v[74:75], v6 offset:37376
    v_mfma_f32_16x16x32_bf16 v[148:151], v[52:55], v[76:79], v[148:151]
    s_add_u32 s80, s80, 18432
    s_waitcnt lgkmcnt(6)
    v_mfma_f32_16x16x32_bf16 v[152:155], v[80:83], v[40:43], v[152:155]
    ds_read_b64_tr_b16 v[76:77], v7 offset:32768
    v_mfma_f32_16x16x32_bf16 v[156:159], v[80:83], v[44:47], v[156:159]
    s_cmp_ge_u32 s80, 153600
    s_cselect_b32 s84, 55296, 0
    v_mfma_f32_16x16x32_bf16 v[160:163], v[80:83], v[48:51], v[160:163]
    ds_read_b64_tr_b16 v[78:79], v7 offset:33280
    v_mfma_f32_16x16x32_bf16 v[164:167], v[80:83], v[52:55], v[164:167]
    s_sub_u32 s80, s80, s84
    s_waitcnt lgkmcnt(6)
    v_mfma_f32_16x16x32_bf16 v[168:171], v[64:67], v[40:43], v[168:171]
    ds_read_b64_tr_b16 v[80:81], v7 offset:36864
    v_mfma_f32_16x16x32_bf16 v[172:175], v[64:67], v[44:47], v[172:175]
    v_mfma_f32_16x16x32_bf16 v[176:179], v[64:67], v[48:51], v[176:179]
    ds_read_b64_tr_b16 v[82:83], v7 offset:37376
    v_mfma_f32_16x16x32_bf16 v[180:183], v[64:67], v[52:55], v[180:183]
    s_waitcnt lgkmcnt(6)
    v_mfma_f32_16x16x32_bf16 v[184:187], v[68:71], v[40:43], v[184:187]
    v_mfma_f32_16x16x32_bf16 v[188:191], v[68:71], v[44:47], v[188:191]
    v_mfma_f32_16x16x32_bf16 v[192:195], v[68:71], v[48:51], v[192:195]
    v_mfma_f32_16x16x32_bf16 v[196:199], v[68:71], v[52:55], v[196:199]
    s_waitcnt lgkmcnt(0)
    s_barrier
    v_mfma_f32_16x16x32_bf16 v[200:203], v[72:75], v[40:43], v[200:203]
    ds_read_b64_tr_b16 v[64:65], v4 offset:4096
    v_mfma_f32_16x16x32_bf16 v[204:207], v[72:75], v[44:47], v[204:207]
    ds_read_b64_tr_b16 v[66:67], v4 offset:4608
    v_mfma_f32_16x16x32_bf16 v[208:211], v[72:75], v[48:51], v[208:211]
    ds_read_b128 v[24:27], v14 offset:0
    v_mfma_f32_16x16x32_bf16 v[212:215], v[72:75], v[52:55], v[212:215]
    ds_read_b128 v[28:31], v14 offset:2048
    v_mfma_f32_16x16x32_bf16 v[216:219], v[76:79], v[40:43], v[216:219]
    ds_read_b128 v[32:35], v14 offset:4096
    v_mfma_f32_16x16x32_bf16 v[220:223], v[76:79], v[44:47], v[220:223]
    ds_read_b128 v[36:39], v14 offset:6144
    v_mfma_f32_16x16x32_bf16 v[224:227], v[76:79], v[48:51], v[224:227]
    ds_read_b64_tr_b16 v[68:69], v5 offset:4096
    v_mfma_f32_16x16x32_bf16 v[228:231], v[76:79], v[52:55], v[228:231]
    ds_read_b64_tr_b16 v[70:71], v5 offset:4608
    v_mfma_f32_16x16x32_bf16 v[232:235], v[80:83], v[40:43], v[232:235]
    ds_read_b64_tr_b16 v[72:73], v4 offset:8192
    v_mfma_f32_16x16x32_bf16 v[236:239], v[80:83], v[44:47], v[236:239]
    ds_read_b64_tr_b16 v[74:75], v4 offset:8704
    v_mfma_f32_16x16x32_bf16 v[240:243], v[80:83], v[48:51], v[240:243]
    ds_read_b128 v[56:59], v18
    v_mfma_f32_16x16x32_bf16 v[244:247], v[80:83], v[52:55], v[244:247]
    s_sub_u32 s34, s34, 1
    s_cmp_lg_u32 s34, 0
    s_cbranch_scc1 L_p2
    s_waitcnt lgkmcnt(8)
    v_mfma_f32_16x16x32_bf16 v[88:91], v[64:67], v[24:27], v[88:91]
    ds_read_b64_tr_b16 v[76:77], v5 offset:8192
    s_waitcnt lgkmcnt(8)
    v_mfma_f32_16x16x32_bf16 v[92:95], v[64:67], v[28:31], v[92:95]
    ds_read_b64_tr_b16 v[78:79], v5 offset:8704
    s_waitcnt lgkmcnt(8)
    v_mfma_f32_16x16x32_bf16 v[96:99], v[64:67], v[32:35], v[96:99]
    ds_read_b64_tr_b16 v[80:81], v4 offset:0
    s_waitcnt lgkmcnt(8)
    v_mfma_f32_16x16x32_bf16 v[100:103], v[64:67], v[36:39], v[100:103]
    ds_read_b64_tr_b16 v[82:83], v4 offset:512
    s_waitcnt lgkmcnt(4)
    v_mfma_f32_16x16x32_bf16 v[248:251], v[64:67], v[56:59], v[248:251]
    v_mfma_f32_16x16x32_bf16 v[104:107], v[68:71], v[24:27], v[104:107]
    ds_read_b64_tr_b16 v[64:65], v5 offset:0
    v_mfma_f32_16x16x32_bf16 v[108:111], v[68:71], v[28:31], v[108:111]
    v_mfma_f32_16x16x32_bf16 v[112:115], v[68:71], v[32:35], v[112:115]
    ds_read_b64_tr_b16 v[66:67], v5 offset:512
    v_mfma_f32_16x16x32_bf16 v[116:119], v[68:71], v[36:39], v[116:119]
    v_mfma_f32_16x16x32_bf16 v[120:123], v[24:27], v[72:75], v[120:123]
    ds_read_b64_tr_b16 v[68:69], v4 offset:12288
    v_mfma_f32_16x16x32_bf16 v[124:127], v[28:31], v[72:75], v[124:127]
    v_mfma_f32_16x16x32_bf16 v[128:131], v[32:35], v[72:75], v[128:131]
    ds_read_b64_tr_b16 v[70:71], v4 offset:12800
    v_mfma_f32_16x16x32_bf16 v[132:135], v[36:39], v[72:75], v[132:135]
    v_mfma_f32_16x16x32_bf16 v[252:255], v[56:59], v[72:75], v[252:255]
    s_waitcnt lgkmcnt(6)
    v_mfma_f32_16x16x32_bf16 v[136:139], v[24:27], v[76:79], v[136:139]
    ds_read_b64_tr_b16 v[72:73], v4 offset:16384
    v_mfma_f32_16x16x32_bf16 v[140:143], v[28:31], v[76:79], v[140:143]
    v_mfma_f32_16x16x32_bf16 v[144:147], v[32:35], v[76:79], v[144:147]
    ds_read_b64_tr_b16 v[74:75], v4 offset:16896
    v_mfma_f32_16x16x32_bf16 v[148:151], v[36:39], v[76:79], v[148:151]
    s_waitcnt lgkmcnt(6)
    v_mfma_f32_16x16x32_bf16 v[152:155], v[80:83], v[24:27], v[152:155]
    ds_read_b64_tr_b16 v[76:77], v5 offset:12288
    v_mfma_f32_16x16x32_bf16 v[156:159], v[80:83], v[28:31], v[156:159]
    v_mfma_f32_16x16x32_bf16 v[160:163], v[80:83], v[32:35], v[160:163]
    ds_read_b64_tr_b16 v[78:79], v5 offset:12800
    v_mfma_f32_16x16x32_bf16 v[164:167], v[80:83], v[36:39], v[164:167]
    s_waitcnt lgkmcnt(6)
    v_mfma_f32_16x16x32_bf16 v[168:171], v[64:67], v[24:27], v[168:171]
    ds_read_b64_tr_b16 v[80:81], v5 offset:16384
    v_mfma_f32_16x16x32_bf16 v[172:175], v[64:67], v[28:31], v[172:175]
    v_mfma_f32_16x16x32_bf16 v[176:179], v[64:67], v[32:35], v[176:179]
    ds_read_b64_tr_b16 v[82:83], v5 offset:16896
    v_mfma_f32_16x16x32_bf16 v[180:183], v[64:67], v[36:39], v[180:183]
    s_waitcnt lgkmcnt(6)
    v_mfma_f32_16x16x32_bf16 v[184:187], v[68:71], v[24:27], v[184:187]
    v_mfma_f32_16x16x32_bf16 v[188:191], v[68:71], v[28:31], v[188:191]
    v_mfma_f32_16x16x32_bf16 v[192:195], v[68:71], v[32:35], v[192:195]
    v_mfma_f32_16x16x32_bf16 v[196:199], v[68:71], v[36:39], v[196:199]
    s_waitcnt lgkmcnt(0)
    s_barrier
    v_mfma_f32_16x16x32_bf16 v[200:203], v[72:75], v[24:27], v[200:203]
    ds_read_b64_tr_b16 v[64:65], v4 offset:24576
    v_mfma_f32_16x16x32_bf16 v[204:207], v[72:75], v[28:31], v[204:207]
    ds_read_b64_tr_b16 v[66:67], v4 offset:25088
    v_mfma_f32_16x16x32_bf16 v[208:211], v[72:75], v[32:35], v[208:211]
    ds_read_b128 v[40:43], v15 offset:0
    v_mfma_f32_16x16x32_bf16 v[212:215], v[72:75], v[36:39], v[212:215]
    ds_read_b128 v[44:47], v15 offset:2048
    v_mfma_f32_16x16x32_bf16 v[216:219], v[76:79], v[24:27], v[216:219]
    ds_read_b128 v[48:51], v15 offset:4096
    v_mfma_f32_16x16x32_bf16 v[220:223], v[76:79], v[28:31], v[220:223]
    ds_read_b128 v[52:55], v15 offset:6144
    v_mfma_f32_16x16x32_bf16 v[224:227], v[76:79], v[32:35], v[224:227]
    ds_read_b64_tr_b16 v[68:69], v5 offset:24576
    v_mfma_f32_16x16x32_bf16 v[228:231], v[76:79], v[36:39], v[228:231]
    ds_read_b64_tr_b16 v[70:71], v5 offset:25088
    v_mfma_f32_16x16x32_bf16 v[232:235], v[80:83], v[24:27], v[232:235]
    ds_read_b64_tr_b16 v[72:73], v4 offset:28672
    v_mfma_f32_16x16x32_bf16 v[236:239], v[80:83], v[28:31], v[236:239]
    ds_read_b64_tr_b16 v[74:75], v4 offset:29184
    v_mfma_f32_16x16x32_bf16 v[240:243], v[80:83], v[32:35], v[240:243]
    ds_read_b128 v[60:63], v19
    v_mfma_f32_16x16x32_bf16 v[244:247], v[80:83], v[36:39], v[244:247]
    s_waitcnt lgkmcnt(8)
    v_mfma_f32_16x16x32_bf16 v[88:91], v[64:67], v[40:43], v[88:91]
    ds_read_b64_tr_b16 v[76:77], v5 offset:28672
    s_waitcnt lgkmcnt(8)
    v_mfma_f32_16x16x32_bf16 v[92:95], v[64:67], v[44:47], v[92:95]
    ds_read_b64_tr_b16 v[78:79], v5 offset:29184
    s_waitcnt lgkmcnt(8)
    v_mfma_f32_16x16x32_bf16 v[96:99], v[64:67], v[48:51], v[96:99]
    ds_read_b64_tr_b16 v[80:81], v4 offset:20480
    s_waitcnt lgkmcnt(8)
    v_mfma_f32_16x16x32_bf16 v[100:103], v[64:67], v[52:55], v[100:103]
    ds_read_b64_tr_b16 v[82:83], v4 offset:20992
    s_waitcnt lgkmcnt(4)
    v_mfma_f32_16x16x32_bf16 v[248:251], v[64:67], v[60:63], v[248:251]
    v_mfma_f32_16x16x32_bf16 v[104:107], v[68:71], v[40:43], v[104:107]
    ds_read_b64_tr_b16 v[64:65], v5 offset:20480
    v_mfma_f32_16x16x32_bf16 v[108:111], v[68:71], v[44:47], v[108:111]
    v_add_u32 v14, s80, v16
    v_mfma_f32_16x16x32_bf16 v[112:115], v[68:71], v[48:51], v[112:115]
    ds_read_b64_tr_b16 v[66:67], v5 offset:20992
    v_mfma_f32_16x16x32_bf16 v[116:119], v[68:71], v[52:55], v[116:119]
    v_add_u32 v15, s80, v17
    v_mfma_f32_16x16x32_bf16 v[120:123], v[40:43], v[72:75], v[120:123]
    ds_read_b64_tr_b16 v[68:69], v4 offset:32768
    v_mfma_f32_16x16x32_bf16 v[124:127], v[44:47], v[72:75], v[124:127]
    s_add_u32 s84, s80, s95
    v_mfma_f32_16x16x32_bf16 v[128:131], v[48:51], v[72:75], v[128:131]
    ds_read_b64_tr_b16 v[70:71], v4 offset:33280
    v_mfma_f32_16x16x32_bf16 v[132:135], v[52:55], v[72:75], v[132:135]
    v_add_u32 v18, s84, v16
    v_mfma_f32_16x16x32_bf16 v[252:255], v[60:63], v[72:75], v[252:255]
    s_waitcnt lgkmcnt(6)
    v_mfma_f32_16x16x32_bf16 v[136:139], v[40:43], v[76:79], v[136:139]
    ds_read_b64_tr_b16 v[72:73], v4 offset:36864
    v_mfma_f32_16x16x32_bf16 v[140:143], v[44:47], v[76:79], v[140:143]
    v_add_u32 v19, s84, v17
    v_mfma_f32_16x16x32_bf16 v[144:147], v[48:51], v[76:79], v[144:147]
    ds_read_b64_tr_b16 v[74:75], v4 offset:37376
    v_mfma_f32_16x16x32_bf16 v[148:151], v[52:55], v[76:79], v[148:151]
    s_add_u32 s80, s80, 18432
    s_waitcnt lgkmcnt(6)
    v_mfma_f32_16x16x32_bf16 v[152:155], v[80:83], v[40:43], v[152:155]
    ds_read_b64_tr_b16 v[76:77], v5 offset:32768
    v_mfma_f32_16x16x32_bf16 v[156:159], v[80:83], v[44:47], v[156:159]
    s_cmp_ge_u32 s80, 153600
    s_cselect_b32 s84, 55296, 0
    v_mfma_f32_16x16x32_bf16 v[160:163], v[80:83], v[48:51], v[160:163]
    ds_read_b64_tr_b16 v[78:79], v5 offset:33280
    v_mfma_f32_16x16x32_bf16 v[164:167], v[80:83], v[52:55], v[164:167]
    s_sub_u32 s80, s80, s84
    s_waitcnt lgkmcnt(6)
    v_mfma_f32_16x16x32_bf16 v[168:171], v[64:67], v[40:43], v[168:171]
    ds_read_b64_tr_b16 v[80:81], v5 offset:36864
    v_mfma_f32_16x16x32_bf16 v[172:175], v[64:67], v[44:47], v[172:175]
    v_mfma_f32_16x16x32_bf16 v[176:179], v[64:67], v[48:51], v[176:179]
    ds_read_b64_tr_b16 v[82:83], v5 offset:37376
    v_mfma_f32_16x16x32_bf16 v[180:183], v[64:67], v[52:55], v[180:183]
    s_waitcnt lgkmcnt(6)
    v_mfma_f32_16x16x32_bf16 v[184:187], v[68:71], v[40:43], v[184:187]
    v_mfma_f32_16x16x32_bf16 v[188:191], v[68:71], v[44:47], v[188:191]
    v_mfma_f32_16x16x32_bf16 v[192:195], v[68:71], v[48:51], v[192:195]
    v_mfma_f32_16x16x32_bf16 v[196:199], v[68:71], v[52:55], v[196:199]
    s_waitcnt lgkmcnt(0)
    s_barrier
    v_mfma_f32_16x16x32_bf16 v[200:203], v[72:75], v[40:43], v[200:203]
    ds_read_b64_tr_b16 v[64:65], v6 offset:4096
    v_mfma_f32_16x16x32_bf16 v[204:207], v[72:75], v[44:47], v[204:207]
    ds_read_b64_tr_b16 v[66:67], v6 offset:4608
    v_mfma_f32_16x16x32_bf16 v[208:211], v[72:75], v[48:51], v[208:211]
    ds_read_b128 v[24:27], v14 offset:0
    v_mfma_f32_16x16x32_bf16 v[212:215], v[72:75], v[52:55], v[212:215]
    ds_read_b128 v[28:31], v14 offset:2048
    v_mfma_f32_16x16x32_bf16 v[216:219], v[76:79], v[40:43], v[216:219]
    ds_read_b128 v[32:35], v14 offset:4096
    v_mfma_f32_16x16x32_bf16 v[220:223], v[76:79], v[44:47], v[220:223]
    ds_read_b128 v[36:39], v14 offset:6144
    v_mfma_f32_16x16x32_bf16 v[224:227], v[76:79], v[48:51], v[224:227]
    ds_read_b64_tr_b16 v[68:69], v7 offset:4096
    v_mfma_f32_16x16x32_bf16 v[228:231], v[76:79], v[52:55], v[228:231]
    ds_read_b64_tr_b16 v[70:71], v7 offset:4608
    v_mfma_f32_16x16x32_bf16 v[232:235], v[80:83], v[40:43], v[232:235]
    ds_read_b64_tr_b16 v[72:73], v6 offset:8192
    v_mfma_f32_16x16x32_bf16 v[236:239], v[80:83], v[44:47], v[236:239]
    ds_read_b64_tr_b16 v[74:75], v6 offset:8704
    v_mfma_f32_16x16x32_bf16 v[240:243], v[80:83], v[48:51], v[240:243]
    ds_read_b128 v[56:59], v18
    v_mfma_f32_16x16x32_bf16 v[244:247], v[80:83], v[52:55], v[244:247]
    s_waitcnt lgkmcnt(8)
    v_mfma_f32_16x16x32_bf16 v[88:91], v[64:67], v[24:27], v[88:91]
    ds_read_b64_tr_b16 v[76:77], v7 offset:8192
    s_waitcnt lgkmcnt(8)
    v_mfma_f32_16x16x32_bf16 v[92:95], v[64:67], v[28:31], v[92:95]
    ds_read_b64_tr_b16 v[78:79], v7 offset:8704
    s_waitcnt lgkmcnt(8)
    v_mfma_f32_16x16x32_bf16 v[96:99], v[64:67], v[32:35], v[96:99]
    ds_read_b64_tr_b16 v[80:81], v6 offset:0
    s_waitcnt lgkmcnt(8)
    v_mfma_f32_16x16x32_bf16 v[100:103], v[64:67], v[36:39], v[100:103]
    ds_read_b64_tr_b16 v[82:83], v6 offset:512
    s_waitcnt lgkmcnt(4)
    v_mfma_f32_16x16x32_bf16 v[248:251], v[64:67], v[56:59], v[248:251]
    v_mfma_f32_16x16x32_bf16 v[104:107], v[68:71], v[24:27], v[104:107]
    ds_read_b64_tr_b16 v[64:65], v7 offset:0
    v_mfma_f32_16x16x32_bf16 v[108:111], v[68:71], v[28:31], v[108:111]
    v_mfma_f32_16x16x32_bf16 v[112:115], v[68:71], v[32:35], v[112:115]
    ds_read_b64_tr_b16 v[66:67], v7 offset:512
    v_mfma_f32_16x16x32_bf16 v[116:119], v[68:71], v[36:39], v[116:119]
    v_mfma_f32_16x16x32_bf16 v[120:123], v[24:27], v[72:75], v[120:123]
    ds_read_b64_tr_b16 v[68:69], v6 offset:12288
    v_mfma_f32_16x16x32_bf16 v[124:127], v[28:31], v[72:75], v[124:127]
    v_mfma_f32_16x16x32_bf16 v[128:131], v[32:35], v[72:75], v[128:131]
    ds_read_b64_tr_b16 v[70:71], v6 offset:12800
    v_mfma_f32_16x16x32_bf16 v[132:135], v[36:39], v[72:75], v[132:135]
    v_mfma_f32_16x16x32_bf16 v[252:255], v[56:59], v[72:75], v[252:255]
    s_waitcnt lgkmcnt(6)
    v_mfma_f32_16x16x32_bf16 v[136:139], v[24:27], v[76:79], v[136:139]
L_pad9:
    s_cbranch_execz L_vret1
    ds_read_b64_tr_b16 v[72:73], v6 offset:16384
    v_mfma_f32_16x16x32_bf16 v[140:143], v[28:31], v[76:79], v[140:143]
    v_mfma_f32_16x16x32_bf16 v[144:147], v[32:35], v[76:79], v[144:147]
    ds_read_b64_tr_b16 v[74:75], v6 offset:16896
    v_mfma_f32_16x16x32_bf16 v[148:151], v[36:39], v[76:79], v[148:151]
    s_waitcnt lgkmcnt(6)
    v_mfma_f32_16x16x32_bf16 v[152:155], v[80:83], v[24:27], v[152:155]
    ds_read_b64_tr_b16 v[76:77], v7 offset:12288
    v_mfma_f32_16x16x32_bf16 v[156:159], v[80:83], v[28:31], v[156:159]
    v_mfma_f32_16x16x32_bf16 v[160:163], v[80:83], v[32:35], v[160:163]
    ds_read_b64_tr_b16 v[78:79], v7 offset:12800
    v_mfma_f32_16x16x32_bf16 v[164:167], v[80:83], v[36:39], v[164:167]
    s_waitcnt lgkmcnt(6)
    v_mfma_f32_16x16x32_bf16 v[168:171], v[64:67], v[24:27], v[168:171]
    ds_read_b64_tr_b16 v[80:81], v7 offset:16384
    v_mfma_f32_16x16x32_bf16 v[172:175], v[64:67], v[28:31], v[172:175]
    v_mfma_f32_16x16x32_bf16 v[176:179], v[64:67], v[32:35], v[176:179]
    ds_read_b64_tr_b16 v[82:83], v7 offset:16896
    v_mfma_f32_16x16x32_bf16 v[180:183], v[64:67], v[36:39], v[180:183]
    s_waitcnt lgkmcnt(6)
    v_mfma_f32_16x16x32_bf16 v[184:187], v[68:71], v[24:27], v[184:187]
    v_mfma_f32_16x16x32_bf16 v[188:191], v[68:71], v[28:31], v[188:191]
    v_mfma_f32_16x16x32_bf16 v[192:195], v[68:71], v[32:35], v[192:195]
    v_mfma_f32_16x16x32_bf16 v[196:199], v[68:71], v[36:39], v[196:199]
    s_waitcnt lgkmcnt(0)
    s_barrier
    v_mfma_f32_16x16x32_bf16 v[200:203], v[72:75], v[24:27], v[200:203]
    ds_read_b64_tr_b16 v[64:65], v6 offset:24576
    v_mfma_f32_16x16x32_bf16 v[204:207], v[72:75], v[28:31], v[204:207]
    ds_read_b64_tr_b16 v[66:67], v6 offset:25088
    v_mfma_f32_16x16x32_bf16 v[208:211], v[72:75], v[32:35], v[208:211]
    ds_read_b128 v[40:43], v15 offset:0
    v_mfma_f32_16x16x32_bf16 v[212:215], v[72:75], v[36:39], v[212:215]
    ds_read_b128 v[44:47], v15 offset:2048
    v_mfma_f32_16x16x32_bf16 v[216:219], v[76:79], v[24:27], v[216:219]
    ds_read_b128 v[48:51], v15 offset:4096
    v_mfma_f32_16x16x32_bf16 v[220:223], v[76:79], v[28:31], v[220:223]
    ds_read_b128 v[52:55], v15 offset:6144
    v_mfma_f32_16x16x32_bf16 v[224:227], v[76:79], v[32:35], v[224:227]
    ds_read_b64_tr_b16 v[68:69], v7 offset:24576
    v_mfma_f32_16x16x32_bf16 v[228:231], v[76:79], v[36:39], v[228:231]
    ds_read_b64_tr_b16 v[70:71], v7 offset:25088
    v_mfma_f32_16x16x32_bf16 v[232:235], v[80:83], v[24:27], v[232:235]
    ds_read_b64_tr_b16 v[72:73], v6 offset:28672
    v_mfma_f32_16x16x32_bf16 v[236:239], v[80:83], v[28:31], v[236:239]
    ds_read_b64_tr_b16 v[74:75], v6 offset:29184
    v_mfma_f32_16x16x32_bf16 v[240:243], v[80:83], v[32:35], v[240:243]
    ds_read_b128 v[60:63], v19
    v_mfma_f32_16x16x32_bf16 v[244:247], v[80:83], v[36:39], v[244:247]
    s_waitcnt lgkmcnt(8)
    v_mfma_f32_16x16x32_bf16 v[88:91], v[64:67], v[40:43], v[88:91]
    ds_read_b64_tr_b16 v[76:77], v7 offset:28672
    s_waitcnt lgkmcnt(8)
    v_mfma_f32_16x16x32_bf16 v[92:95], v[64:67], v[44:47], v[92:95]
    ds_read_b64_tr_b16 v[78:79], v7 offset:29184
    s_waitcnt lgkmcnt(8)
    v_mfma_f32_16x16x32_bf16 v[96:99], v[64:67], v[48:51], v[96:99]
    ds_read_b64_tr_b16 v[80:81], v6 offset:20480
    s_waitcnt lgkmcnt(8)
    v_mfma_f32_16x16x32_bf16 v[100:103], v[64:67], v[52:55], v[100:103]
    ds_read_b64_tr_b16 v[82:83], v6 offset:20992
    s_waitcnt lgkmcnt(4)
    v_mfma_f32_16x16x32_bf16 v[248:251], v[64:67], v[60:63], v[248:251]
    v_mfma_f32_16x16x32_bf16 v[104:107], v[68:71], v[40:43], v[104:107]
    ds_read_b64_tr_b16 v[64:65], v7 offset:20480
    v_mfma_f32_16x16x32_bf16 v[108:111], v[68:71], v[44:47], v[108:111]
    v_mfma_f32_16x16x32_bf16 v[112:115], v[68:71], v[48:51], v[112:115]
    ds_read_b64_tr_b16 v[66:67], v7 offset:20992
    v_mfma_f32_16x16x32_bf16 v[116:119], v[68:71], v[52:55], v[116:119]
    v_mfma_f32_16x16x32_bf16 v[120:123], v[40:43], v[72:75], v[120:123]
    ds_read_b64_tr_b16 v[68:69], v6 offset:32768
    v_mfma_f32_16x16x32_bf16 v[124:127], v[44:47], v[72:75], v[124:127]
    v_mfma_f32_16x16x32_bf16 v[128:131], v[48:51], v[72:75], v[128:131]
    ds_read_b64_tr_b16 v[70:71], v6 offset:33280
    v_mfma_f32_16x16x32_bf16 v[132:135], v[52:55], v[72:75], v[132:135]
    v_mfma_f32_16x16x32_bf16 v[252:255], v[60:63], v[72:75], v[252:255]
    s_waitcnt lgkmcnt(6)
    v_mfma_f32_16x16x32_bf16 v[136:139], v[40:43], v[76:79], v[136:139]
    ds_read_b64_tr_b16 v[72:73], v6 offset:36864
    v_mfma_f32_16x16x32_bf16 v[140:143], v[44:47], v[76:79], v[140:143]
    v_mfma_f32_16x16x32_bf16 v[144:147], v[48:51], v[76:79], v[144:147]
    ds_read_b64_tr_b16 v[74:75], v6 offset:37376
    v_mfma_f32_16x16x32_bf16 v[148:151], v[52:55], v[76:79], v[148:151]
    s_waitcnt lgkmcnt(6)
    v_mfma_f32_16x16x32_bf16 v[152:155], v[80:83], v[40:43], v[152:155]
    ds_read_b64_tr_b16 v[76:77], v7 offset:32768
    v_mfma_f32_16x16x32_bf16 v[156:159], v[80:83], v[44:47], v[156:159]
    v_mfma_f32_16x16x32_bf16 v[160:163], v[80:83], v[48:51], v[160:163]
    ds_read_b64_tr_b16 v[78:79], v7 offset:33280
    v_mfma_f32_16x16x32_bf16 v[164:167], v[80:83], v[52:55], v[164:167]
    s_waitcnt lgkmcnt(6)
    v_mfma_f32_16x16x32_bf16 v[168:171], v[64:67], v[40:43], v[168:171]
    ds_read_b64_tr_b16 v[80:81], v7 offset:36864
    v_mfma_f32_16x16x32_bf16 v[172:175], v[64:67], v[44:47], v[172:175]
    v_mfma_f32_16x16x32_bf16 v[176:179], v[64:67], v[48:51], v[176:179]
    ds_read_b64_tr_b16 v[82:83], v7 offset:37376
    v_mfma_f32_16x16x32_bf16 v[180:183], v[64:67], v[52:55], v[180:183]
    s_waitcnt lgkmcnt(6)
    v_mfma_f32_16x16x32_bf16 v[184:187], v[68:71], v[40:43], v[184:187]
    v_mfma_f32_16x16x32_bf16 v[188:191], v[68:71], v[44:47], v[188:191]
    v_mfma_f32_16x16x32_bf16 v[192:195], v[68:71], v[48:51], v[192:195]
    v_mfma_f32_16x16x32_bf16 v[196:199], v[68:71], v[52:55], v[196:199]
    s_waitcnt lgkmcnt(0)
    s_barrier
    v_mfma_f32_16x16x32_bf16 v[200:203], v[72:75], v[40:43], v[200:203]
    v_mfma_f32_16x16x32_bf16 v[204:207], v[72:75], v[44:47], v[204:207]
    v_mfma_f32_16x16x32_bf16 v[208:211], v[72:75], v[48:51], v[208:211]
    v_mfma_f32_16x16x32_bf16 v[212:215], v[72:75], v[52:55], v[212:215]
    v_mfma_f32_16x16x32_bf16 v[216:219], v[76:79], v[40:43], v[216:219]
    v_mfma_f32_16x16x32_bf16 v[220:223], v[76:79], v[44:47], v[220:223]
    v_mfma_f32_16x16x32_bf16 v[224:227], v[76:79], v[48:51], v[224:227]
    v_mfma_f32_16x16x32_bf16 v[228:231], v[76:79], v[52:55], v[228:231]
    v_mfma_f32_16x16x32_bf16 v[232:235], v[80:83], v[40:43], v[232:235]
    v_mfma_f32_16x16x32_bf16 v[236:239], v[80:83], v[44:47], v[236:239]
    v_mfma_f32_16x16x32_bf16 v[240:243], v[80:83], v[48:51], v[240:243]
    v_mfma_f32_16x16x32_bf16 v[244:247], v[80:83], v[52:55], v[244:247]
    s_setprio 0
    s_mov_b32 s76, 0xbdd2d3e8
    v_cvt_pk_bf16_f32 v100, v100, v101
    v_cvt_pk_bf16_f32 v101, v102, v103
    v_cvt_pk_bf16_f32 v102, v116, v117
    v_cvt_pk_bf16_f32 v103, v118, v119
    v_cvt_pk_bf16_f32 v32, v132, v133
    v_cvt_pk_bf16_f32 v33, v134, v135
    v_cvt_pk_bf16_f32 v42, v148, v149
    v_cvt_pk_bf16_f32 v43, v150, v151
    v_cvt_pk_bf16_f32 v44, v248, v249
    v_cvt_pk_bf16_f32 v45, v250, v251
    v_cvt_pk_bf16_f32 v24, v252, v253
    v_cvt_pk_bf16_f32 v25, v254, v255
    s_cmp_lg_u32 s5, 0
    s_cbranch_scc1 L_hx1
    ds_write_b64 v85, v[100:101]
    ds_write_b64 v85, v[102:103] offset:512
    ds_write_b64 v85, v[32:33] offset:1024
    ds_write_b64 v85, v[42:43] offset:1536
    s_branch L_hx2
L_hx1:
    ds_write_b64 v85, v[44:45] offset:2048
    ds_write_b64 v85, v[24:25] offset:2560
L_hx2:
    s_waitcnt lgkmcnt(0)
    v_mul_f32 v80, v184, v184
    v_mul_f32 v81, v185, v185
    v_mul_f32 v82, v186, v186
    v_mul_f32 v83, v187, v187
    v_fma_f32 v80, v80, s76, v84
    v_fma_f32 v81, v81, s76, v84
    v_fma_f32 v82, v82, s76, v84
    v_fma_f32 v83, v83, s76, v84
    v_mul_f32 v80, v80, v184
    v_mul_f32 v81, v81, v185
    v_mul_f32 v82, v82, v186
    v_mul_f32 v83, v83, v187
    v_exp_f32 v80, v80
    v_mul_f32 v184, v184, v200
    v_exp_f32 v81, v81
    v_mul_f32 v185, v185, v201
    v_exp_f32 v82, v82
    v_mul_f32 v186, v186, v202
    v_exp_f32 v83, v83
    v_mul_f32 v187, v187, v203
    v_add_f32 v80, 1.0, v80
    v_add_f32 v81, 1.0, v81
    v_add_f32 v82, 1.0, v82
    v_add_f32 v83, 1.0, v83
    v_rcp_f32 v80, v80
    v_rcp_f32 v81, v81
    v_rcp_f32 v82, v82
    v_rcp_f32 v83, v83
    s_nop 0
    v_mul_f32 v184, v184, v80
    v_mul_f32 v185, v185, v81
    v_mul_f32 v186, v186, v82
    v_mul_f32 v187, v187, v83
    v_cvt_pk_bf16_f32 v184, v184, v185
    v_cvt_pk_bf16_f32 v185, v186, v187
    v_mul_f32 v80, v188, v188
    v_mul_f32 v81, v189, v189
    v_mul_f32 v82, v190, v190
    v_mul_f32 v83, v191, v191
    v_fma_f32 v80, v80, s76, v84
    v_fma_f32 v81, v81, s76, v84
    v_fma_f32 v82, v82, s76, v84
    v_fma_f32 v83, v83, s76, v84
    v_mul_f32 v80, v80, v188
    v_mul_f32 v81, v81, v189
    v_mul_f32 v82, v82, v190
    v_mul_f32 v83, v83, v191
    v_exp_f32 v80, v80
    v_mul_f32 v188, v188, v204
    v_exp_f32 v81, v81
    v_mul_f32 v189, v189, v205
    v_exp_f32 v82, v82
    v_mul_f32 v190, v190, v206
    v_exp_f32 v83, v83
    v_mul_f32 v191, v191, v207
    v_add_f32 v80, 1.0, v80
    v_add_f32 v81, 1.0, v81
    v_add_f32 v82, 1.0, v82
    v_add_f32 v83, 1.0, v83
    v_rcp_f32 v80, v80
    v_rcp_f32 v81, v81
    v_rcp_f32 v82, v82
    s_barrier
    s_cmp_lg_u32 s5, 0
    s_cbranch_scc1 L_hx3
    ds_read_b64 v[46:47], v85 offset:2048
    ds_read_b64 v[34:35], v85 offset:2560
    s_branch L_hx4
L_hx3:
    ds_read_b64 v[44:45], v85 offset:512
    ds_read_b64 v[46:47], v85
    ds_read_b64 v[24:25], v85 offset:1536
    ds_read_b64 v[34:35], v85 offset:1024
L_hx4:
    v_rcp_f32 v83, v83
    s_nop 0
    v_mul_f32 v188, v188, v80
    v_mul_f32 v189, v189, v81
    v_mul_f32 v190, v190, v82
    v_mul_f32 v191, v191, v83
    v_cvt_pk_bf16_f32 v186, v188, v189
    v_cvt_pk_bf16_f32 v187, v190, v191
    s_nop 1
    v_permlane16_swap_b32 v184, v186
    v_permlane16_swap_b32 v185, v187
    buffer_store_dwordx4 v[184:187], v8, s[68:71], s73 offen offset:0 sc1
    v_mul_f32 v80, v192, v192
    v_mul_f32 v81, v193, v193
    v_mul_f32 v82, v194, v194
    v_mul_f32 v83, v195, v195
    v_fma_f32 v80, v80, s76, v84
    v_fma_f32 v81, v81, s76, v84
    v_fma_f32 v82, v82, s76, v84
    v_fma_f32 v83, v83, s76, v84
    v_mul_f32 v80, v80, v192
    v_mul_f32 v81, v81, v193
    v_mul_f32 v82, v82, v194
    v_mul_f32 v83, v83, v195
    v_exp_f32 v80, v80
    v_mul_f32 v192, v192, v208
    v_exp_f32 v81, v81
    v_mul_f32 v193, v193, v209
    v_exp_f32 v82, v82
    v_mul_f32 v194, v194, v210
    v_exp_f32 v83, v83
    v_mul_f32 v195, v195, v211
    v_add_f32 v80, 1.0, v80
    v_add_f32 v81, 1.0, v81
    v_add_f32 v82, 1.0, v82
    v_add_f32 v83, 1.0, v83
    v_rcp_f32 v80, v80
    v_rcp_f32 v81, v81
    v_rcp_f32 v82, v82
    v_rcp_f32 v83, v83
    s_nop 0
    v_mul_f32 v192, v192, v80
    v_mul_f32 v193, v193, v81
    v_mul_f32 v194, v194, v82
    v_mul_f32 v195, v195, v83
    v_cvt_pk_bf16_f32 v192, v192, v193
    v_cvt_pk_bf16_f32 v193, v194, v195
    v_mul_f32 v80, v196, v196
    v_mul_f32 v81, v197, v197
    v_mul_f32 v82, v198, v198
    v_mul_f32 v83, v199, v199
    v_fma_f32 v80, v80, s76, v84
    v_fma_f32 v81, v81, s76, v84
    v_fma_f32 v82, v82, s76, v84
    v_fma_f32 v83, v83, s76, v84
    v_mul_f32 v80, v80, v196
    v_mul_f32 v81, v81, v197
    v_mul_f32 v82, v82, v198
    v_mul_f32 v83, v83, v199
    v_exp_f32 v80, v80
    v_mul_f32 v196, v196, v212
    v_exp_f32 v81, v81
    v_mul_f32 v197, v197, v213
    v_exp_f32 v82, v82
    v_mul_f32 v198, v198, v214
    v_exp_f32 v83, v83
    v_mul_f32 v199, v199, v215
    v_add_f32 v80, 1.0, v80
    s_barrier
    s_waitcnt lgkmcnt(0)
    v_add_f32 v81, 1.0, v81
    v_add_f32 v82, 1.0, v82
    v_add_f32 v83, 1.0, v83
    v_rcp_f32 v80, v80
    v_rcp_f32 v81, v81
    v_rcp_f32 v82, v82
    v_rcp_f32 v83, v83
    s_nop 0
    v_mul_f32 v196, v196, v80
    v_mul_f32 v197, v197, v81
    v_mul_f32 v198, v198, v82
    v_mul_f32 v199, v199, v83
    v_cvt_pk_bf16_f32 v194, v196, v197
    v_cvt_pk_bf16_f32 v195, v198, v199
    s_nop 1
    v_permlane16_swap_b32 v192, v194
    v_permlane16_swap_b32 v193, v195
    buffer_store_dwordx4 v[192:195], v8, s[68:71], s73 offen offset:2048 sc1
    v_mul_f32 v80, v216, v216
    v_mul_f32 v81, v217, v217
    v_mul_f32 v82, v218, v218
    v_mul_f32 v83, v219, v219
    v_fma_f32 v80, v80, s76, v84
    v_fma_f32 v81, v81, s76, v84
    v_fma_f32 v82, v82, s76, v84
    v_fma_f32 v83, v83, s76, v84
    v_mul_f32 v80, v80, v216
    v_mul_f32 v81, v81, v217
    v_mul_f32 v82, v82, v218
    v_mul_f32 v83, v83, v219
    v_exp_f32 v80, v80
    v_mul_f32 v216, v216, v232
    v_exp_f32 v81, v81
    v_mul_f32 v217, v217, v233
    v_exp_f32 v82, v82
    v_mul_f32 v218, v218, v234
    v_exp_f32 v83, v83
    v_mul_f32 v219, v219, v235
    v_add_f32 v80, 1.0, v80
    v_add_f32 v81, 1.0, v81
    v_add_f32 v82, 1.0, v82
    v_add_f32 v83, 1.0, v83
    v_rcp_f32 v80, v80
    v_rcp_f32 v81, v81
    v_rcp_f32 v82, v82
    v_rcp_f32 v83, v83
    s_nop 0
    v_mul_f32 v216, v216, v80
    v_mul_f32 v217, v217, v81
    v_mul_f32 v218, v218, v82
    v_mul_f32 v219, v219, v83
    v_cvt_pk_bf16_f32 v216, v216, v217
    v_cvt_pk_bf16_f32 v217, v218, v219
    v_mul_f32 v80, v220, v220
    v_mul_f32 v81, v221, v221
    v_mul_f32 v82, v222, v222
    v_mul_f32 v83, v223, v223
    v_fma_f32 v80, v80, s76, v84
    v_fma_f32 v81, v81, s76, v84
    v_fma_f32 v82, v82, s76, v84
    v_fma_f32 v83, v83, s76, v84
    v_mul_f32 v80, v80, v220
    v_mul_f32 v81, v81, v221
    v_mul_f32 v82, v82, v222
    v_mul_f32 v83, v83, v223
    v_exp_f32 v80, v80
    v_mul_f32 v220, v220, v236
    v_exp_f32 v81, v81
    s_lshl2_add_u32 s91, s2, s4
    s_lshl_b32 s39, s91, 9
    s_lshr_b32 s92, s91, 2
    s_mul_i32 s92, s92, 7168
    s_and_b32 s91, s91, 3
    s_lshl_b32 s91, s91, 9
    s_add_u32 s92, s92, s91
    s_add_u32 s34, s92, 5120
    s_add_u32 s39, s39, 0x180080
    s_load_dword s94, s[20:21], s39 offset:0x0
    s_load_dword s94, s[20:21], s39 offset:0x40
    s_load_dword s94, s[20:21], s39 offset:0x80
    s_load_dword s94, s[20:21], s39 offset:0xc0
    s_load_dword s94, s[20:21], s39 offset:0x100
    s_barrier
    v_mul_f32 v221, v221, v237
    v_exp_f32 v82, v82
    v_mul_f32 v222, v222, v238
    v_exp_f32 v83, v83
    v_mul_f32 v223, v223, v239
    v_add_f32 v80, 1.0, v80
    v_add_f32 v81, 1.0, v81
    v_add_f32 v82, 1.0, v82
    v_add_f32 v83, 1.0, v83
    v_rcp_f32 v80, v80
    v_rcp_f32 v81, v81
    v_rcp_f32 v82, v82
    v_rcp_f32 v83, v83
    s_nop 0
    v_mul_f32 v220, v220, v80
    v_mul_f32 v221, v221, v81
    v_mul_f32 v222, v222, v82
    v_mul_f32 v223, v223, v83
    v_cvt_pk_bf16_f32 v218, v220, v221
    v_cvt_pk_bf16_f32 v219, v222, v223
    s_nop 1
    v_permlane16_swap_b32 v216, v218
    v_permlane16_swap_b32 v217, v219
    buffer_store_dwordx4 v[216:219], v8, s[68:71], s74 offen offset:0 sc1
    v_mul_f32 v80, v224, v224
    v_mul_f32 v81, v225, v225
    v_mul_f32 v82, v226, v226
    v_mul_f32 v83, v227, v227
    v_fma_f32 v80, v80, s76, v84
    v_fma_f32 v81, v81, s76, v84
    v_fma_f32 v82, v82, s76, v84
    v_fma_f32 v83, v83, s76, v84
    v_mul_f32 v80, v80, v224
    v_mul_f32 v81, v81, v225
    v_mul_f32 v82, v82, v226
    v_mul_f32 v83, v83, v227
    v_exp_f32 v80, v80
    v_mul_f32 v224, v224, v240
    v_exp_f32 v81, v81
    v_mul_f32 v225, v225, v241
    v_exp_f32 v82, v82
    v_mul_f32 v226, v226, v242
    v_exp_f32 v83, v83
    v_mul_f32 v227, v227, v243
    v_add_f32 v80, 1.0, v80
    v_add_f32 v81, 1.0, v81
    v_add_f32 v82, 1.0, v82
    v_add_f32 v83, 1.0, v83
    v_rcp_f32 v80, v80
    v_rcp_f32 v81, v81
    v_rcp_f32 v82, v82
    v_rcp_f32 v83, v83
    s_nop 0
    v_mul_f32 v224, v224, v80
    v_mul_f32 v225, v225, v81
    v_mul_f32 v226, v226, v82
    v_mul_f32 v227, v227, v83
    v_cvt_pk_bf16_f32 v224, v224, v225
    v_cvt_pk_bf16_f32 v225, v226, v227
    v_mul_f32 v80, v228, v228
    v_mul_f32 v81, v229, v229
    v_mul_f32 v82, v230, v230
    v_mul_f32 v83, v231, v231
    v_fma_f32 v80, v80, s76, v84
    v_fma_f32 v81, v81, s76, v84
    v_fma_f32 v82, v82, s76, v84
    v_fma_f32 v83, v83, s76, v84
    s_load_dword s94, s[20:21], s39 offset:0x140
    s_add_u32 s39, s39, 0x27ff80
    s_load_dword s94, s[20:21], s39 offset:0x0
    s_load_dword s94, s[20:21], s39 offset:0x40
    s_load_dword s94, s[20:21], s39 offset:0x80
    s_load_dword s94, s[20:21], s39 offset:0xc0
    s_barrier
    v_mul_f32 v80, v80, v228
    v_mul_f32 v81, v81, v229
    v_mul_f32 v82, v82, v230
    v_mul_f32 v83, v83, v231
    v_exp_f32 v80, v80
    v_mul_f32 v228, v228, v244
    v_exp_f32 v81, v81
    v_mul_f32 v229, v229, v245
    v_exp_f32 v82, v82
    v_mul_f32 v230, v230, v246
    v_exp_f32 v83, v83
    v_mul_f32 v231, v231, v247
    v_add_f32 v80, 1.0, v80
    v_add_f32 v81, 1.0, v81
    v_add_f32 v82, 1.0, v82
    v_add_f32 v83, 1.0, v83
    v_rcp_f32 v80, v80
    v_rcp_f32 v81, v81
    v_rcp_f32 v82, v82
    v_rcp_f32 v83, v83
    s_nop 0
    v_mul_f32 v228, v228, v80
    v_mul_f32 v229, v229, v81
    v_mul_f32 v230, v230, v82
    v_mul_f32 v231, v231, v83
    v_cvt_pk_bf16_f32 v226, v228, v229
    v_cvt_pk_bf16_f32 v227, v230, v231
    s_nop 1
    v_permlane16_swap_b32 v224, v226
    v_permlane16_swap_b32 v225, v227
    buffer_store_dwordx4 v[224:227], v8, s[68:71], s74 offen offset:2048 sc1
    v_lshrrev_b32 v64, 4, v1
    v_and_b32 v66, 14, v1
    v_lshlrev_b32 v64, 2, v64
    v_sub_u32 v64, v66, v64
    v_and_b32 v65, 1, v1
    v_cmp_le_i32 s[40:41], 0, v64
    v_cmp_le_i32 s[42:43], 2, v64
    v_mul_u32_u24 v66, 0x202, v65
    s_mov_b32 s80, 0x01000c0c
    v_lshl_add_u32 v66, v66, 16, s80
    v_add_u32 v67, 0x04040000, v66
    v_cndmask_b32 v76, v66, v67, s[40:41]
    v_cndmask_b32 v77, v66, v67, s[42:43]
    v_lshlrev_b32 v65, 4, v65
    v_mov_b32 v68, 0x0c0c0c0c
    v_mov_b32 v66, 0xc0c0100
    v_alignbit_b32 v66, v66, v66, v65
    v_cndmask_b32 v78, v66, v68, s[40:41]
    v_cndmask_b32 v86, v68, v66, s[40:41]
    v_mov_b32 v66, 0xc0c0302
    v_alignbit_b32 v66, v66, v66, v65
    v_cndmask_b32 v79, v66, v68, s[42:43]
    v_cndmask_b32 v87, v68, v66, s[42:43]
    s_or_b32 s80, s28, s5
    s_cmp_eq_u32 s80, 0
    s_cselect_b64 s[80:81], 0, -1
    s_or_b64 s[40:41], s[40:41], s[80:81]
    s_or_b64 s[42:43], s[42:43], s[80:81]
    v_mov_b32 v7, 0xce6e6b28
    s_mov_b32 s77, 0x3e3504f3
    s_mov_b32 s78, 0x3fb8aa3b
    v_cvt_pk_bf16_f32 v88, v88, v89
    v_cvt_pk_bf16_f32 v89, v90, v91
    v_cvt_pk_bf16_f32 v90, v104, v105
    v_cvt_pk_bf16_f32 v91, v106, v107
    v_cvt_pk_bf16_f32 v152, v152, v153
    v_cvt_pk_bf16_f32 v153, v154, v155
    v_cvt_pk_bf16_f32 v154, v168, v169
    v_cvt_pk_bf16_f32 v155, v170, v171
    v_cvt_pk_bf16_f32 v92, v92, v93
    v_cvt_pk_bf16_f32 v93, v94, v95
    v_cvt_pk_bf16_f32 v94, v108, v109
    v_cvt_pk_bf16_f32 v95, v110, v111
    v_cvt_pk_bf16_f32 v156, v156, v157
    v_cvt_pk_bf16_f32 v157, v158, v159
    v_cvt_pk_bf16_f32 v158, v172, v173
    v_cvt_pk_bf16_f32 v159, v174, v175
    s_load_dword s94, s[20:21], s39 offset:0x100
    s_load_dword s94, s[20:21], s39 offset:0x140
    s_load_dword s94, s[20:21], s39 offset:0x180
    s_load_dword s94, s[20:21], s39 offset:0x1c0
    s_add_u32 s39, s39, 0xffe00000
    s_load_dword s94, s[20:21], s39 offset:0x0
    s_barrier
    s_setprio 3
    v_mfma_f32_16x16x32_bf16 v[48:51], v[44:47], v[152:155], 0
    v_mfma_f32_16x16x32_bf16 v[52:55], v[88:91], v[152:155], 0
    s_setprio 0
    v_cvt_pk_bf16_f32 v96, v96, v97
    v_cvt_pk_bf16_f32 v97, v98, v99
    v_cvt_pk_bf16_f32 v98, v112, v113
    v_cvt_pk_bf16_f32 v99, v114, v115
    v_cvt_pk_bf16_f32 v160, v160, v161
    v_cvt_pk_bf16_f32 v161, v162, v163
    v_cvt_pk_bf16_f32 v162, v176, v177
    v_cvt_pk_bf16_f32 v163, v178, v179
    s_setprio 3
    v_mfma_f32_16x16x32_bf16 v[56:59], v[88:91], v[156:159], 0
    v_mfma_f32_16x16x32_bf16 v[60:63], v[92:95], v[156:159], 0
    s_setprio 0
    v_cvt_pk_bf16_f32 v48, v48, v49
    v_cvt_pk_bf16_f32 v49, v50, v51
    v_cvt_pk_bf16_f32 v50, v52, v53
    v_cvt_pk_bf16_f32 v51, v54, v55
    v_perm_b32 v64, v50, v48, v76
    v_perm_b32 v65, v51, v49, v77
    v_mul_f32 v64, s77, v64
    v_mul_f32 v65, s77, v65
    v_cvt_pk_bf16_f32 v65, v64, v65
    v_lshlrev_b32 v64, 16, v65
    v_and_b32 v65, 0xffff0000, v65
    v_cndmask_b32 v64, v7, v64, s[40:41]
    v_cndmask_b32 v65, v7, v65, s[42:43]
    v_max_f32 v72, v64, v65
    v_cvt_pk_bf16_f32 v164, v164, v165
    v_cvt_pk_bf16_f32 v165, v166, v167
    v_cvt_pk_bf16_f32 v166, v180, v181
    v_cvt_pk_bf16_f32 v167, v182, v183
    s_setprio 3
    v_mfma_f32_16x16x32_bf16 v[48:51], v[92:95], v[160:163], 0
    v_mfma_f32_16x16x32_bf16 v[52:55], v[96:99], v[160:163], 0
    s_setprio 0
    v_cvt_pk_bf16_f32 v56, v56, v57
    v_cvt_pk_bf16_f32 v57, v58, v59
    v_cvt_pk_bf16_f32 v58, v60, v61
    v_cvt_pk_bf16_f32 v59, v62, v63
    v_perm_b32 v66, v58, v56, v76
    v_perm_b32 v67, v59, v57, v77
    v_mul_f32 v66, s77, v66
    v_mul_f32 v67, s77, v67
    v_cvt_pk_bf16_f32 v67, v66, v67
    v_lshlrev_b32 v66, 16, v67
    v_and_b32 v67, 0xffff0000, v67
    v_max_f32 v73, v66, v67
    s_setprio 3
    v_mfma_f32_16x16x32_bf16 v[56:59], v[96:99], v[164:167], 0
    v_mfma_f32_16x16x32_bf16 v[60:63], v[100:103], v[164:167], 0
    s_setprio 0
    v_cvt_pk_bf16_f32 v26, v120, v121
    v_cvt_pk_bf16_f32 v27, v122, v123
    v_cvt_pk_bf16_f32 v36, v136, v137
    v_cvt_pk_bf16_f32 v37, v138, v139
    s_load_dword s94, s[20:21], s39 offset:0x40
    s_load_dword s94, s[20:21], s39 offset:0x80
    s_load_dword s94, s[20:21], s39 offset:0xc0
    s_load_dword s94, s[20:21], s39 offset:0x100
    s_load_dword s94, s[20:21], s39 offset:0x140
    s_barrier
    v_cvt_pk_bf16_f32 v28, v124, v125
    v_cvt_pk_bf16_f32 v29, v126, v127
    v_cvt_pk_bf16_f32 v38, v140, v141
    v_cvt_pk_bf16_f32 v39, v142, v143
    v_cvt_pk_bf16_f32 v30, v128, v129
    v_cvt_pk_bf16_f32 v31, v130, v131
    v_cvt_pk_bf16_f32 v40, v144, v145
    v_cvt_pk_bf16_f32 v41, v146, v147
    v_cvt_pk_bf16_f32 v48, v48, v49
    v_cvt_pk_bf16_f32 v49, v50, v51
    v_cvt_pk_bf16_f32 v50, v52, v53
    v_cvt_pk_bf16_f32 v51, v54, v55
    v_perm_b32 v68, v50, v48, v76
    v_perm_b32 v69, v51, v49, v77
    v_mul_f32 v68, s77, v68
    v_mul_f32 v69, s77, v69
    v_cvt_pk_bf16_f32 v69, v68, v69
    v_lshlrev_b32 v68, 16, v69
    v_and_b32 v69, 0xffff0000, v69
    v_max_f32 v74, v68, v69
    v_cvt_pk_bf16_f32 v56, v56, v57
    v_cvt_pk_bf16_f32 v57, v58, v59
    v_cvt_pk_bf16_f32 v58, v60, v61
    v_cvt_pk_bf16_f32 v59, v62, v63
    v_perm_b32 v70, v58, v56, v76
    v_perm_b32 v71, v59, v57, v77
    v_mul_f32 v70, s77, v70
    v_mul_f32 v71, s77, v71
    v_cvt_pk_bf16_f32 v71, v70, v71
    v_lshlrev_b32 v70, 16, v71
    v_and_b32 v71, 0xffff0000, v71
    v_max_f32 v75, v70, v71
    v_permlane32_swap_b32 v72, v73
    v_max_f32 v72, v72, v73
    v_permlane32_swap_b32 v74, v75
    v_max_f32 v74, v74, v75
    s_nop 1
    v_permlane16_swap_b32 v72, v74
    v_max_f32 v72, v72, v74
    v_mov_b32 v74, v72
    s_nop 1
    v_permlane16_swap_b32 v72, v74
    v_mov_b32 v73, v72
    v_mov_b32 v75, v74
    s_nop 0
    v_permlane32_swap_b32 v72, v73
    v_permlane32_swap_b32 v74, v75
    v_sub_f32 v64, v64, v72
    v_sub_f32 v65, v65, v72
    v_sub_f32 v66, v66, v73
    v_sub_f32 v67, v67, v73
    v_sub_f32 v68, v68, v74
    v_sub_f32 v69, v69, v74
    v_sub_f32 v70, v70, v75
    v_sub_f32 v71, v71, v75
    v_mul_f32 v64, s78, v64
    v_mul_f32 v65, s78, v65
    v_mul_f32 v66, s78, v66
    v_mul_f32 v67, s78, v67
    v_mul_f32 v68, s78, v68
    v_mul_f32 v69, s78, v69
    v_mul_f32 v70, s78, v70
    v_mul_f32 v71, s78, v71
    v_exp_f32 v64, v64
    v_exp_f32 v65, v65
    v_exp_f32 v66, v66
    v_exp_f32 v67, v67
    v_exp_f32 v68, v68
    v_exp_f32 v69, v69
    v_exp_f32 v70, v70
    v_exp_f32 v71, v71
    v_add_f32 v72, v64, v65
    v_add_f32 v73, v66, v67
    s_load_dword s94, s[20:21], s39 offset:0x180
    s_load_dword s94, s[20:21], s39 offset:0x1c0
    s_add_u32 s39, s39, 0x280000
    s_load_dword s94, s[20:21], s39 offset:0x0
    s_load_dword s94, s[20:21], s39 offset:0x40
    s_load_dword s94, s[20:21], s39 offset:0x80
    s_lshl4_add_u32 s91, s28, s29
    s_lshl_b32 s91, s91, 7
    s_add_u32 s92, s91, 0x1ea8000
    s_xor_b32 s91, s91, 17408
    s_add_u32 s91, s91, 0x1ea8000
    v_mov_b32 v23, s92
    v_writelane_b32 v23, s91, 1
    s_mov_b64 exec, 3
    global_load_dwordx3 v[20:22], v23, s[26:27] sc1
    s_mov_b64 exec, -1
    s_barrier
    v_add_f32 v74, v68, v69
    v_add_f32 v75, v70, v71
    v_permlane32_swap_b32 v72, v73
    v_add_f32 v72, v72, v73
    v_permlane32_swap_b32 v74, v75
    v_add_f32 v74, v74, v75
    s_nop 1
    v_permlane16_swap_b32 v72, v74
    v_add_f32 v72, v72, v74
    v_rcp_f32 v72, v72
    s_nop 0
    v_mov_b32 v74, v72
    s_nop 1
    v_permlane16_swap_b32 v72, v74
    v_mov_b32 v73, v72
    v_mov_b32 v75, v74
    s_nop 0
    v_permlane32_swap_b32 v72, v73
    v_permlane32_swap_b32 v74, v75
    v_mul_f32 v64, v64, v72
    v_mul_f32 v65, v65, v72
    v_mul_f32 v66, v66, v73
    v_mul_f32 v67, v67, v73
    v_mul_f32 v68, v68, v74
    v_mul_f32 v69, v69, v74
    v_mul_f32 v70, v70, v75
    v_mul_f32 v71, v71, v75
    v_cvt_pk_bf16_f32 v72, v64, v65
L_pad10:
    s_cbranch_execz L_vret2
    v_cvt_pk_bf16_f32 v73, v66, v67
    v_cvt_pk_bf16_f32 v74, v68, v69
    v_cvt_pk_bf16_f32 v75, v70, v71
    v_perm_b32 v152, v72, v72, v78
    v_perm_b32 v153, v72, v72, v79
    v_perm_b32 v154, v72, v72, v86
    v_perm_b32 v155, v72, v72, v87
    v_perm_b32 v156, v73, v73, v78
    v_perm_b32 v157, v73, v73, v79
    v_perm_b32 v158, v73, v73, v86
    v_perm_b32 v159, v73, v73, v87
    s_setprio 3
    v_mfma_f32_16x16x32_bf16 v[48:51], v[24:27], v[152:155], 0
    v_mfma_f32_16x16x32_bf16 v[52:55], v[34:37], v[152:155], 0
    s_setprio 0
    v_perm_b32 v160, v74, v74, v78
    v_perm_b32 v161, v74, v74, v79
    v_perm_b32 v162, v74, v74, v86
    v_perm_b32 v163, v74, v74, v87
    s_setprio 3
    v_mfma_f32_16x16x32_bf16 v[56:59], v[26:29], v[156:159], 0
    v_mfma_f32_16x16x32_bf16 v[60:63], v[36:39], v[156:159], 0
    s_setprio 0
    v_perm_b32 v164, v75, v75, v78
    v_perm_b32 v165, v75, v75, v79
    v_perm_b32 v166, v75, v75, v86
    v_perm_b32 v167, v75, v75, v87
    v_cvt_pk_bf16_f32 v168, v48, v49
    v_cvt_pk_bf16_f32 v169, v50, v51
    v_cvt_pk_bf16_f32 v170, v52, v53
    v_cvt_pk_bf16_f32 v171, v54, v55
    s_setprio 3
    v_mfma_f32_16x16x32_bf16 v[48:51], v[28:31], v[160:163], 0
    v_mfma_f32_16x16x32_bf16 v[52:55], v[38:41], v[160:163], 0
    s_load_dword s94, s[20:21], s39 offset:0xc0
    s_load_dword s94, s[20:21], s39 offset:0x100
    s_load_dword s94, s[20:21], s39 offset:0x140
    s_load_dword s94, s[20:21], s39 offset:0x180
    s_load_dword s94, s[20:21], s39 offset:0x1c0
    s_waitcnt vmcnt(1)
    s_barrier
    s_lshl1_add_u32 m0, s33, 81920
    s_nop 0
    buffer_load_dwordx4 v11, s[60:63], s83 offen lds
    s_setprio 0
    v_cvt_pk_bf16_f32 v172, v56, v57
    v_cvt_pk_bf16_f32 v173, v58, v59
    v_cvt_pk_bf16_f32 v174, v60, v61
    v_cvt_pk_bf16_f32 v175, v62, v63
    s_setprio 3
    v_mfma_f32_16x16x32_bf16 v[56:59], v[30:33], v[164:167], 0
    v_mfma_f32_16x16x32_bf16 v[60:63], v[40:43], v[164:167], 0
    s_setprio 0
    v_permlane16_swap_b32 v168, v170
    v_permlane16_swap_b32 v169, v171
    buffer_store_dwordx4 v[168:171], v0, s[68:71], s75 offen offset:0 sc1
    v_permlane16_swap_b32 v172, v174
    v_permlane16_swap_b32 v173, v175
    buffer_store_dwordx4 v[172:175], v0, s[68:71], s75 offen offset:1024 sc1
    s_lshl1_add_u32 m0, s33, 82944
    s_nop 0
    buffer_load_dwordx4 v12, s[60:63], s83 offen lds
    v_cvt_pk_bf16_f32 v176, v48, v49
    v_cvt_pk_bf16_f32 v177, v50, v51
    v_cvt_pk_bf16_f32 v178, v52, v53
    v_cvt_pk_bf16_f32 v179, v54, v55
    v_cvt_pk_bf16_f32 v180, v56, v57
    v_cvt_pk_bf16_f32 v181, v58, v59
    v_cvt_pk_bf16_f32 v182, v60, v61
    v_cvt_pk_bf16_f32 v183, v62, v63
    v_permlane16_swap_b32 v176, v178
    v_permlane16_swap_b32 v177, v179
    buffer_store_dwordx4 v[176:179], v0, s[68:71], s75 offen offset:2048 sc1
    v_permlane16_swap_b32 v180, v182
    v_permlane16_swap_b32 v181, v183
    buffer_store_dwordx4 v[180:183], v0, s[68:71], s75 offen offset:3072 sc1
    v_lshrrev_b32 v64, 4, v1
    v_bfe_u32 v65, v1, 2, 2
    v_and_b32 v66, 3, v1
    v_and_b32 v67, 15, v1
    v_lshrrev_b32 v68, 3, v1
    v_and_b32 v69, 7, v1
    s_lshl_b32 s85, s6, 2
    v_lshl_add_u32 v70, v64, 3, v65
    v_lshlrev_b32 v70, 7, v70
    s_lshl1_add_u32 m0, s33, 90112
    s_nop 0
    buffer_load_dwordx4 v11, s[64:67], s83 offen lds
    v_and_b32 v71, 1, v66
    v_lshl_add_u32 v70, v71, 3, v70
    v_add_u32 v70, 0, v70
    v_and_b32 v71, 2, v65
    v_and_b32 v72, 1, v64
    v_lshl_add_u32 v71, v72, 2, v71
    v_lshrrev_b32 v72, 1, v66
    v_xor_b32 v71, v71, v72
    v_xor_b32 v71, s85, v71
    v_xor_b32 v72, 0, v71
    v_lshl_add_u32 v80, v72, 4, v70
    v_add_u32 v82, 49152, v80
    v_add_u32 v84, 98304, v80
    v_xor_b32 v72, 2, v71
    v_lshl_add_u32 v81, v72, 4, v70
    v_add_u32 v83, 49152, v81
    s_lshl1_add_u32 m0, s33, 91136
    s_nop 0
    buffer_load_dwordx4 v12, s[64:67], s83 offen lds
    s_add_u32 s83, s83, 131072
    v_add_u32 v85, 98304, v81
    s_lshl_b32 s85, s5, 12
    v_lshl_add_u32 v48, v1, 4, s85
    v_add_u32 v49, 49152, v48
    v_add_u32 v50, 98304, v48
    v_mov_b32 v88, 0
    v_mov_b32 v89, 0
    v_mov_b32 v90, 0
    v_mov_b32 v91, 0
    v_mov_b32 v92, 0
    v_mov_b32 v93, 0
    v_mov_b32 v94, 0
    v_mov_b32 v95, 0
    v_mov_b32 v96, 0
    v_mov_b32 v97, 0
    v_mov_b32 v98, 0
    v_mov_b32 v99, 0
    v_mov_b32 v100, 0
    v_mov_b32 v101, 0
    v_mov_b32 v102, 0
    v_mov_b32 v103, 0
    v_mov_b32 v104, 0
    v_mov_b32 v105, 0
    v_mov_b32 v106, 0
    v_mov_b32 v107, 0
    s_load_dword s94, s[20:21], s39 offset:0x80000
    s_load_dword s94, s[20:21], s39 offset:0x80040
    s_load_dword s94, s[20:21], s39 offset:0x80080
    s_load_dword s94, s[20:21], s39 offset:0x800c0
    s_load_dword s94, s[20:21], s39 offset:0x80100
    s_cmp_lg_u32 s4, 0
    s_cbranch_scc1 L_fH2
    s_lshl_b32 s91, s28, 4
    s_add_u32 s91, s91, s29
    s_lshl_b32 s91, s91, 7
    s_add_u32 s91, s91, 0x1e90000
    v_mov_b32 v16, s91
    v_mov_b32 v18, s100
    v_mov_b32 v19, s101
    s_mov_b64 exec, 1
    global_store_dwordx2 v16, v[18:19], s[26:27] sc1
    s_mov_b64 exec, -1
L_fH2:
    s_waitcnt vmcnt(8)
    s_mov_b64 exec, 3
    s_movk_i32 s98, 0x4000
L_pT_chk:
    v_cmp_ne_u64 vcc, s[100:101], v[20:21]
    s_nop 1
    s_cmp_eq_u64 vcc, 0
    s_cbranch_scc1 L_pT_ok
    s_sub_u32 s98, s98, 1
    s_cbranch_scc1 L_pT_ok
    s_sleep 1
    global_load_dwordx3 v[20:22], v23, s[26:27] sc1
    s_waitcnt vmcnt(0)
    s_branch L_pT_chk
L_pT_ok:
    s_mov_b64 exec, -1
    v_readlane_b32 s90, v22, 0
    v_readlane_b32 s91, v22, 1
    s_nop 1
    s_sub_u32 s90, s91, s90
    s_abs_i32 s91, s90
    s_min_u32 s91, s91, 0x1000
    s_add_u32 s91, s91, 35
    s_mul_i32 s91, s91, 937
    s_lshr_b32 s91, s91, 16
    s_min_u32 s91, s91, 4
    s_sub_u32 s92, 0, s91
    s_cmp_lt_i32 s90, 0
    s_cselect_b32 s91, s92, s91
    s_add_u32 s50, s91, 4
    s_and_b32 s91, s91, 3
    s_mov_b32 s46, 0x58458458
    s_mov_b32 s47, 0x4584584
    s_cmp_eq_u32 s91, 1
    s_cselect_b32 s46, 0xc22c22c4, s46
    s_cselect_b32 s47, 0x22c22c22, s47
    s_cmp_eq_u32 s91, 2
    s_cselect_b32 s46, 0x116222c4, s46
    s_cselect_b32 s47, 0x16116116, s47
    s_cmp_eq_u32 s91, 3
    s_cselect_b32 s46, 0x116222c4, s46
    s_cselect_b32 s47, 0x308b08b1, s47
    s_movk_i32 s44, 0x4000
    s_mov_b32 s45, 131072
    s_barrier
    s_lshl_b32 s48, s46, 15
    s_and_b32 s48, s48, 0x38000
    s_lshr_b64 s[46:47], s[46:47], 3
    s_lshl2_add_u32 m0, s33, s48
    s_lshl1_add_u32 s49, s33, s48
    buffer_load_dwordx4 v10, s[56:59], s82 offen offset:0 sc1 lds
    v_mov_b32 v108, 0
    v_mov_b32 v109, 0
    v_mov_b32 v110, 0
    v_mov_b32 v111, 0
    v_mov_b32 v112, 0
    v_mov_b32 v113, 0
    v_mov_b32 v114, 0
    v_mov_b32 v115, 0
    v_mov_b32 v116, 0
    v_mov_b32 v117, 0
    v_mov_b32 v118, 0
    v_mov_b32 v119, 0
    s_lshl_b32 s84, s4, 12
    s_add_u32 s84, s84, 147456
    v_lshl_add_u32 v3, v1, 3, s84
    v_lshrrev_b32 v70, 1, v64
    v_xor_b32 v70, v70, v65
    v_lshl_add_u32 v70, v70, 4, s84
    buffer_load_dwordx4 v10, s[56:59], s82 offen offset:1024 sc1 lds
    v_lshl_add_u32 v70, v67, 6, v70
    v_and_b32 v71, 1, v64
    v_lshl_add_u32 v14, v71, 3, v70
    v_xor_b32 v15, 32, v14
    v_xor_b32 v70, v66, v64
    v_lshl_add_u32 v70, v70, 4, s84
    v_lshrrev_b32 v71, 2, v1
    v_lshl_add_u32 v17, v71, 6, v70
    buffer_load_dwordx4 v10, s[56:59], s82 offen offset:2048 sc1 lds
    s_lshl_b32 s85, s4, 12
    v_lshl_add_u32 v72, v1, 4, s85
    s_lshl_b32 s85, s4, 4
    v_and_b32 v70, 2, v68
    v_xor_b32 v70, v70, v69
    v_xor_b32 v70, 0, v70
    v_add_u32 v71, s85, v68
    v_mul_u32_u24 v71, 2048, v71
    v_lshl_add_u32 v4, v70, 4, v71
    s_add_u32 s85, s85, 8
    v_and_b32 v70, 2, v68
    buffer_load_dwordx4 v10, s[56:59], s82 offen offset:3072 sc1 lds
    s_add_u32 s82, s82, s44
    v_xor_b32 v70, v70, v69
    v_xor_b32 v70, 4, v70
    v_add_u32 v71, s85, v68
    v_mul_u32_u24 v71, 2048, v71
    v_lshl_add_u32 v5, v70, 4, v71
    s_and_b32 s85, s31, 3
    s_lshl1_add_u32 s85, s85, s32
    s_cmp_eq_u32 s85, 3
    s_cselect_b64 vcc, -1, 0
    s_lshl_b32 s85, s4, 11
    v_lshl_add_u32 v70, v1, 4, s85
    v_add_u32 v71, 1024, v70
    s_add_u32 m0, s49, 16384
    s_nop 0
    buffer_load_dwordx4 v11, s[60:63], s83 offen lds
    v_cndmask_b32 v4, v4, v70, vcc
    v_cndmask_b32 v5, v5, v71, vcc
    s_mov_b32 s72, s8
    s_mov_b32 s73, s9
    s_mov_b32 s74, 0x400000
    s_mov_b32 s75, 0x20000
    s_add_u32 m0, s49, 17408
    s_nop 0
    buffer_load_dwordx4 v12, s[60:63], s83 offen lds
    s_add_u32 m0, s49, 24576
    s_nop 0
    buffer_load_dwordx4 v11, s[64:67], s83 offen lds
    s_add_u32 m0, s49, 25600
    s_nop 0
    buffer_load_dwordx4 v12, s[64:67], s83 offen lds
    s_add_u32 s83, s83, s45
    s_load_dword s94, s[20:21], s39 offset:0x80140
    s_load_dword s94, s[20:21], s39 offset:0x80180
    s_load_dword s94, s[20:21], s39 offset:0x801c0
    s_add_u32 s39, s39, 0x180000
    s_load_dword s94, s[20:21], s39 offset:0x0
    s_load_dword s94, s[20:21], s39 offset:0x40
    s_barrier
    s_lshl_b32 s48, s46, 15
    s_and_b32 s48, s48, 0x38000
    s_lshr_b64 s[46:47], s[46:47], 3
    s_lshl2_add_u32 m0, s33, s48
    s_lshl1_add_u32 s49, s33, s48
    buffer_load_dwordx4 v10, s[56:59], s82 offen offset:0 sc1 lds
    buffer_load_dwordx4 v10, s[56:59], s82 offen offset:1024 sc1 lds
    buffer_load_dwordx4 v10, s[56:59], s82 offen offset:2048 sc1 lds
    buffer_load_dwordx4 v10, s[56:59], s82 offen offset:3072 sc1 lds
    s_add_u32 s82, s82, s44
    s_add_u32 m0, s49, 16384
    s_nop 0
    buffer_load_dwordx4 v11, s[60:63], s83 offen lds
    s_add_u32 m0, s49, 17408
    s_nop 0
    buffer_load_dwordx4 v12, s[60:63], s83 offen lds
    s_add_u32 m0, s49, 24576
    s_nop 0
    buffer_load_dwordx4 v11, s[64:67], s83 offen lds
    s_add_u32 m0, s49, 25600
    s_nop 0
    buffer_load_dwordx4 v12, s[64:67], s83 offen lds
    s_add_u32 s83, s83, s45
    s_load_dword s94, s[20:21], s39 offset:0x80
    s_load_dword s94, s[20:21], s39 offset:0xc0
    s_load_dword s94, s[20:21], s39 offset:0x100
    s_load_dword s94, s[20:21], s39 offset:0x140
    s_load_dword s94, s[20:21], s39 offset:0x180
    s_waitcnt vmcnt(16)
    s_barrier
    s_lshl_b32 s48, s46, 15
    s_and_b32 s48, s48, 0x38000
    s_lshr_b64 s[46:47], s[46:47], 3
    s_lshl2_add_u32 m0, s33, s48
    s_lshl1_add_u32 s49, s33, s48
    buffer_load_dwordx4 v10, s[56:59], s82 offen offset:0 sc1 lds
    buffer_load_dwordx4 v10, s[56:59], s82 offen offset:1024 sc1 lds
    buffer_load_dwordx4 v10, s[56:59], s82 offen offset:2048 sc1 lds
    buffer_load_dwordx4 v10, s[56:59], s82 offen offset:3072 sc1 lds
    s_add_u32 s82, s82, s44
    s_add_u32 m0, s49, 16384
    s_nop 0
    buffer_load_dwordx4 v11, s[60:63], s83 offen lds
    s_add_u32 m0, s49, 17408
    s_nop 0
    buffer_load_dwordx4 v12, s[60:63], s83 offen lds
    s_add_u32 m0, s49, 24576
    s_nop 0
    buffer_load_dwordx4 v11, s[64:67], s83 offen lds
    s_add_u32 m0, s49, 25600
    s_nop 0
    buffer_load_dwordx4 v12, s[64:67], s83 offen lds
    s_add_u32 s83, s83, s45
    s_load_dword s94, s[20:21], s39 offset:0x1c0
    s_add_u32 s39, s39, 0xfff80000
    s_load_dword s94, s[20:21], s39 offset:0x0
    s_load_dword s94, s[20:21], s39 offset:0x40
    s_load_dword s94, s[20:21], s39 offset:0x80
    s_load_dword s94, s[20:21], s39 offset:0xc0
    s_waitcnt vmcnt(16)
    s_barrier
    s_lshl_b32 s48, s46, 15
    s_and_b32 s48, s48, 0x38000
    s_lshr_b64 s[46:47], s[46:47], 3
    s_lshl2_add_u32 m0, s33, s48
    s_lshl1_add_u32 s49, s33, s48
    buffer_load_dwordx4 v10, s[56:59], s82 offen offset:0 sc1 lds
    buffer_load_dwordx4 v10, s[56:59], s82 offen offset:1024 sc1 lds
    buffer_load_dwordx4 v10, s[56:59], s82 offen offset:2048 sc1 lds
    buffer_load_dwordx4 v10, s[56:59], s82 offen offset:3072 sc1 lds
    s_add_u32 s82, s82, s44
    s_add_u32 m0, s49, 16384
    s_nop 0
    buffer_load_dwordx4 v11, s[60:63], s83 offen lds
    s_add_u32 m0, s49, 17408
    s_nop 0
    buffer_load_dwordx4 v12, s[60:63], s83 offen lds
    s_add_u32 m0, s49, 24576
    s_nop 0
    buffer_load_dwordx4 v11, s[64:67], s83 offen lds
    s_add_u32 m0, s49, 25600
    s_nop 0
    buffer_load_dwordx4 v12, s[64:67], s83 offen lds
    s_add_u32 s83, s83, s45
    s_load_dword s94, s[20:21], s39 offset:0x100
    s_load_dword s94, s[20:21], s39 offset:0x140
    s_load_dword s94, s[20:21], s39 offset:0x180
    s_load_dword s94, s[20:21], s39 offset:0x1c0
    s_add_u32 s39, s39, 0x100000
    s_load_dword s94, s[20:21], s39 offset:0x0
    s_waitcnt vmcnt(16)
    s_barrier
    s_lshl_b32 s48, s46, 15
    s_and_b32 s48, s48, 0x38000
    s_lshr_b64 s[46:47], s[46:47], 3
    s_lshl2_add_u32 m0, s33, s48
    s_lshl1_add_u32 s49, s33, s48
    buffer_load_dwordx4 v10, s[56:59], s82 offen offset:0 sc1 lds
    buffer_load_dwordx4 v10, s[56:59], s82 offen offset:1024 sc1 lds
    buffer_load_dwordx4 v10, s[56:59], s82 offen offset:2048 sc1 lds
    buffer_load_dwordx4 v10, s[56:59], s82 offen offset:3072 sc1 lds
    s_add_u32 s82, s82, s44
    s_add_u32 m0, s49, 16384
    s_nop 0
    buffer_load_dwordx4 v11, s[60:63], s83 offen lds
    s_add_u32 m0, s49, 17408
    s_nop 0
    buffer_load_dwordx4 v12, s[60:63], s83 offen lds
    s_add_u32 m0, s49, 24576
    s_nop 0
    buffer_load_dwordx4 v11, s[64:67], s83 offen lds
    s_add_u32 m0, s49, 25600
    s_nop 0
    buffer_load_dwordx4 v12, s[64:67], s83 offen lds
    s_add_u32 s83, s83, s45
    s_load_dword s94, s[20:21], s39 offset:0x40
    s_load_dword s94, s[20:21], s39 offset:0x80
    s_load_dword s94, s[20:21], s39 offset:0xc0
    s_load_dword s94, s[20:21], s39 offset:0x100
    s_load_dword s94, s[20:21], s39 offset:0x140
    s_waitcnt vmcnt(42)
    s_waitcnt vmcnt(16)
    s_barrier
    s_lshl_b32 s48, s46, 15
    s_and_b32 s48, s48, 0x38000
    s_lshr_b64 s[46:47], s[46:47], 3
    s_lshl2_add_u32 m0, s33, s48
    s_lshl1_add_u32 s49, s33, s48
    buffer_load_dwordx4 v10, s[56:59], s82 offen offset:0 sc1 lds
    buffer_load_dwordx4 v10, s[56:59], s82 offen offset:1024 sc1 lds
    buffer_load_dwordx4 v10, s[56:59], s82 offen offset:2048 sc1 lds
    buffer_load_dwordx4 v10, s[56:59], s82 offen offset:3072 sc1 lds
    s_add_u32 s82, s82, s44
    s_add_u32 m0, s49, 16384
    s_nop 0
    buffer_load_dwordx4 v11, s[60:63], s83 offen lds
    s_add_u32 m0, s49, 17408
    s_nop 0
    buffer_load_dwordx4 v12, s[60:63], s83 offen lds
    s_add_u32 m0, s49, 24576
    s_nop 0
    buffer_load_dwordx4 v11, s[64:67], s83 offen lds
    s_add_u32 m0, s49, 25600
    s_nop 0
    buffer_load_dwordx4 v12, s[64:67], s83 offen lds
    s_add_u32 s83, s83, s45
    s_load_dword s94, s[20:21], s39 offset:0x180
    s_load_dword s94, s[20:21], s39 offset:0x1c0
    s_add_u32 s39, s39, 0xff980000
    s_load_dword s94, s[12:13], s39 offset:0x0
    s_load_dword s94, s[12:13], s39 offset:0x40
    s_load_dword s94, s[12:13], s39 offset:0x80
    s_lshl2_add_u32 s91, s30, s4
    s_lshl_b32 s91, s91, 9
    s_add_u32 s91, s91, 0x1e90000
    v_lshl_add_u32 v20, v1, 7, s91
    s_mov_b64 exec, 15
    global_load_dwordx2 v[22:23], v20, s[26:27] sc1
    s_mov_b64 exec, -1
    s_cmp_lg_u32 s4, 0
    s_cbranch_scc1 L_fO
    s_lshl_b32 s91, s28, 4
    s_add_u32 s91, s91, s29
    s_lshl_b32 s91, s91, 7
    s_add_u32 s91, s91, 0x1e98000
    v_mov_b32 v16, s91
    v_mov_b32 v18, s100
    v_mov_b32 v19, s101
    s_mov_b64 exec, 1
    global_store_dwordx2 v16, v[18:19], s[26:27] sc1
    s_mov_b64 exec, -1
L_fO:
    s_waitcnt vmcnt(17)
    s_barrier
    s_lshl_b32 s48, s46, 15
    s_and_b32 s48, s48, 0x38000
    s_lshr_b64 s[46:47], s[46:47], 3
    s_lshl2_add_u32 m0, s33, s48
    s_lshl1_add_u32 s49, s33, s48
    buffer_load_dwordx4 v10, s[56:59], s82 offen offset:0 sc1 lds
    buffer_load_dwordx4 v10, s[56:59], s82 offen offset:1024 sc1 lds
    buffer_load_dwordx4 v10, s[56:59], s82 offen offset:2048 sc1 lds
    buffer_load_dwordx4 v10, s[56:59], s82 offen offset:3072 sc1 lds
    s_add_u32 s82, s82, s44
    s_add_u32 m0, s49, 16384
    s_nop 0
    buffer_load_dwordx4 v11, s[60:63], s83 offen lds
    s_add_u32 m0, s49, 17408
    s_nop 0
    buffer_load_dwordx4 v12, s[60:63], s83 offen lds
    s_add_u32 m0, s49, 24576
    s_nop 0
    buffer_load_dwordx4 v11, s[64:67], s83 offen lds
    s_add_u32 m0, s49, 25600
    s_nop 0
    buffer_load_dwordx4 v12, s[64:67], s83 offen lds
    s_add_u32 s83, s83, s45
    s_load_dword s94, s[12:13], s39 offset:0xc0
    s_load_dword s94, s[12:13], s39 offset:0x100
    s_load_dword s94, s[12:13], s39 offset:0x140
    s_load_dword s94, s[12:13], s39 offset:0x180
    s_load_dword s94, s[12:13], s39 offset:0x1c0
    s_waitcnt vmcnt(17)
    s_barrier
    s_lshl_b32 s48, s46, 15
    s_and_b32 s48, s48, 0x38000
    s_lshr_b64 s[46:47], s[46:47], 3
    s_lshl2_add_u32 m0, s33, s48
    s_lshl1_add_u32 s49, s33, s48
    buffer_load_dwordx4 v10, s[56:59], s82 offen offset:0 sc1 lds
    buffer_load_dwordx4 v10, s[56:59], s82 offen offset:1024 sc1 lds
    buffer_load_dwordx4 v10, s[56:59], s82 offen offset:2048 sc1 lds
    buffer_load_dwordx4 v10, s[56:59], s82 offen offset:3072 sc1 lds
    s_add_u32 s82, s82, s44
    s_add_u32 m0, s49, 16384
    s_nop 0
    buffer_load_dwordx4 v11, s[60:63], s83 offen lds
    s_add_u32 m0, s49, 17408
    s_nop 0
    buffer_load_dwordx4 v12, s[60:63], s83 offen lds
    s_add_u32 m0, s49, 24576
    s_nop 0
    buffer_load_dwordx4 v11, s[64:67], s83 offen lds
    s_add_u32 m0, s49, 25600
    s_nop 0
    buffer_load_dwordx4 v12, s[64:67], s83 offen lds
    s_add_u32 s83, s83, s45
    s_load_dword s94, s[12:13], s39 offset:0x80000
    s_load_dword s94, s[12:13], s39 offset:0x80040
    s_load_dword s94, s[12:13], s39 offset:0x80080
    s_load_dword s94, s[12:13], s39 offset:0x800c0
    s_load_dword s94, s[12:13], s39 offset:0x80100
    s_waitcnt vmcnt(16)
    s_mov_b64 exec, 15
    s_movk_i32 s98, 0x4000
L_pH2_chk:
    v_cmp_ne_u64 vcc, s[100:101], v[22:23]
    s_nop 1
    s_cmp_eq_u64 vcc, 0
    s_cbranch_scc1 L_pH2_ok
    s_sub_u32 s98, s98, 1
    s_cbranch_scc1 L_pH2_ok
    s_sleep 1
    global_load_dwordx2 v[22:23], v20, s[26:27] sc1
    s_waitcnt vmcnt(0)
    s_branch L_pH2_chk
L_pH2_ok:
    s_mov_b64 exec, -1
    s_add_u32 s82, s82, s14
    s_add_u32 s83, s83, s35
    s_cmp_lg_u32 s32, 0
    s_cselect_b32 s44, 0xffffc000, s44
    s_lshl_b32 s45, s44, 3
    s_waitcnt vmcnt(17)
    s_barrier
    s_cmp_eq_u32 s50, 0
    s_cbranch_scc1 L_bl_end
L_bl:
    s_lshl_b32 s48, s46, 15
    s_and_b32 s48, s48, 0x38000
    s_lshr_b64 s[46:47], s[46:47], 3
    s_lshl2_add_u32 m0, s33, s48
    s_lshl1_add_u32 s49, s33, s48
    buffer_load_dwordx4 v10, s[56:59], s82 offen offset:0 sc1 lds
    buffer_load_dwordx4 v10, s[56:59], s82 offen offset:1024 sc1 lds
    buffer_load_dwordx4 v10, s[56:59], s82 offen offset:2048 sc1 lds
    buffer_load_dwordx4 v10, s[56:59], s82 offen offset:3072 sc1 lds
    s_add_u32 s82, s82, s44
    s_add_u32 m0, s49, 16384
    s_nop 0
    buffer_load_dwordx4 v11, s[60:63], s83 offen lds
    s_add_u32 m0, s49, 17408
    s_nop 0
    buffer_load_dwordx4 v12, s[60:63], s83 offen lds
    s_add_u32 m0, s49, 24576
    s_nop 0
    buffer_load_dwordx4 v11, s[64:67], s83 offen lds
    s_add_u32 m0, s49, 25600
    s_nop 0
    buffer_load_dwordx4 v12, s[64:67], s83 offen lds
    s_add_u32 s83, s83, s45
    s_sub_u32 s50, s50, 1
    s_cmp_lg_u32 s50, 0
    s_waitcnt vmcnt(16)
    s_barrier
    s_cbranch_scc1 L_bl
L_bl_end:
    s_lshl_b32 m0, s33, 2
    s_nop 0
    buffer_load_dwordx4 v10, s[56:59], s82 offen offset:0 sc1 lds
    buffer_load_dwordx4 v10, s[56:59], s82 offen offset:1024 sc1 lds
    buffer_load_dwordx4 v10, s[56:59], s82 offen offset:2048 sc1 lds
    buffer_load_dwordx4 v10, s[56:59], s82 offen offset:3072 sc1 lds
    s_add_u32 s82, s82, s44
    s_lshl1_add_u32 m0, s33, 16384
    s_nop 0
    buffer_load_dwordx4 v11, s[60:63], s83 offen lds
    s_lshl1_add_u32 m0, s33, 17408
    s_nop 0
    buffer_load_dwordx4 v12, s[60:63], s83 offen lds
    s_lshl1_add_u32 m0, s33, 24576
    s_nop 0
    buffer_load_dwordx4 v11, s[64:67], s83 offen lds
    s_lshl1_add_u32 m0, s33, 25600
    s_nop 0
    buffer_load_dwordx4 v12, s[64:67], s83 offen lds
    s_add_u32 s83, s83, s45
    s_load_dword s94, s[12:13], s39 offset:0x80140
    s_load_dword s94, s[12:13], s39 offset:0x80180
    s_load_dword s94, s[12:13], s39 offset:0x801c0
    s_add_u32 s39, s39, 0x100000
    s_load_dword s94, s[12:13], s39 offset:0x0
    s_load_dword s94, s[12:13], s39 offset:0x40
    s_waitcnt vmcnt(16)
    s_barrier
    s_lshl2_add_u32 m0, s33, 98304
    s_nop 0
    buffer_load_dwordx4 v10, s[56:59], s82 offen offset:0 sc1 lds
    buffer_load_dwordx4 v10, s[56:59], s82 offen offset:1024 sc1 lds
    buffer_load_dwordx4 v10, s[56:59], s82 offen offset:2048 sc1 lds
    buffer_load_dwordx4 v10, s[56:59], s82 offen offset:3072 sc1 lds
    s_add_u32 s82, s82, s44
    s_lshl1_add_u32 m0, s33, 114688
    s_nop 0
    buffer_load_dwordx4 v11, s[60:63], s83 offen lds
    s_lshl1_add_u32 m0, s33, 115712
    s_nop 0
    buffer_load_dwordx4 v12, s[60:63], s83 offen lds
    s_lshl1_add_u32 m0, s33, 122880
    s_nop 0
    buffer_load_dwordx4 v11, s[64:67], s83 offen lds
    s_lshl1_add_u32 m0, s33, 123904
    s_nop 0
    buffer_load_dwordx4 v12, s[64:67], s83 offen lds
    s_add_u32 s83, s83, s45
    s_load_dword s94, s[12:13], s39 offset:0x80
    s_load_dword s94, s[12:13], s39 offset:0xc0
    s_load_dword s94, s[12:13], s39 offset:0x100
    s_load_dword s94, s[12:13], s39 offset:0x140
    s_load_dword s94, s[12:13], s39 offset:0x180
    s_lshl2_add_u32 s91, s30, s4
    s_lshl_b32 s91, s91, 9
    s_add_u32 s91, s91, 0x1e98000
    v_lshl_add_u32 v20, v1, 7, s91
    s_mov_b64 exec, 15
    global_load_dwordx2 v[22:23], v20, s[26:27] sc1
    s_mov_b64 exec, -1
    s_waitcnt vmcnt(17)
    s_barrier
    s_lshl2_add_u32 m0, s33, 32768
    s_nop 0
    buffer_load_dwordx4 v10, s[56:59], s82 offen offset:0 sc1 lds
    buffer_load_dwordx4 v10, s[56:59], s82 offen offset:1024 sc1 lds
    buffer_load_dwordx4 v10, s[56:59], s82 offen offset:2048 sc1 lds
    buffer_load_dwordx4 v10, s[56:59], s82 offen offset:3072 sc1 lds
    s_add_u32 s82, s82, s44
    s_lshl1_add_u32 m0, s33, 49152
    s_nop 0
    buffer_load_dwordx4 v11, s[60:63], s83 offen lds
    s_lshl1_add_u32 m0, s33, 50176
    s_nop 0
    buffer_load_dwordx4 v12, s[60:63], s83 offen lds
    s_lshl1_add_u32 m0, s33, 57344
    s_nop 0
    buffer_load_dwordx4 v11, s[64:67], s83 offen lds
    s_lshl1_add_u32 m0, s33, 58368
    s_nop 0
    buffer_load_dwordx4 v12, s[64:67], s83 offen lds
    s_add_u32 s83, s83, s45
    s_load_dword s94, s[12:13], s39 offset:0x1c0
    s_load_dword s94, s[12:13], s39 offset:0x80000
    s_load_dword s94, s[12:13], s39 offset:0x80040
    s_load_dword s94, s[12:13], s39 offset:0x80080
    s_load_dword s94, s[12:13], s39 offset:0x800c0
    s_waitcnt vmcnt(17)
    s_barrier
    s_lshl2_add_u32 m0, s33, 65536
    s_nop 0
    buffer_load_dwordx4 v10, s[56:59], s82 offen offset:0 sc1 lds
    buffer_load_dwordx4 v10, s[56:59], s82 offen offset:1024 sc1 lds
    buffer_load_dwordx4 v10, s[56:59], s82 offen offset:2048 sc1 lds
    buffer_load_dwordx4 v10, s[56:59], s82 offen offset:3072 sc1 lds
    s_add_u32 s82, s82, s44
    s_lshl1_add_u32 m0, s33, 81920
    s_nop 0
    buffer_load_dwordx4 v11, s[60:63], s83 offen lds
    s_lshl1_add_u32 m0, s33, 82944
    s_nop 0
    buffer_load_dwordx4 v12, s[60:63], s83 offen lds
    s_lshl1_add_u32 m0, s33, 90112
    s_nop 0
    buffer_load_dwordx4 v11, s[64:67], s83 offen lds
    s_lshl1_add_u32 m0, s33, 91136
    s_nop 0
    buffer_load_dwordx4 v12, s[64:67], s83 offen lds
    s_add_u32 s83, s83, s45
    s_load_dword s94, s[12:13], s39 offset:0x80100
    s_load_dword s94, s[12:13], s39 offset:0x80140
    s_load_dword s94, s[12:13], s39 offset:0x80180
L_pad11:
    s_cbranch_execz L_vret2
    s_load_dword s94, s[12:13], s39 offset:0x801c0
    s_waitcnt vmcnt(16)
    s_mov_b64 exec, 15
    s_movk_i32 s98, 0x4000
L_pO_chk:
    v_cmp_ne_u64 vcc, s[100:101], v[22:23]
    s_nop 1
    s_cmp_eq_u64 vcc, 0
    s_cbranch_scc1 L_pO_ok
    s_sub_u32 s98, s98, 1
    s_cbranch_scc1 L_pO_ok
    s_sleep 1
    global_load_dwordx2 v[22:23], v20, s[26:27] sc1
    s_waitcnt vmcnt(0)
    s_branch L_pO_chk
L_pO_ok:
    s_mov_b64 exec, -1
    s_waitcnt vmcnt(17)
    s_barrier
    s_lshl_b32 s85, s31, 8
    s_lshl_b32 s86, s32, 7
    s_add_u32 s86, s85, s86
    s_xor_b32 s87, s86, 128
    s_lshr_b32 s91, s31, 2
    s_lshl1_add_u32 s91, s91, s32
    s_lshl_b32 s91, s91, 13
    s_add_u32 s91, s91, 0x2800000
    s_xor_b32 s85, s91, 8192
    s_and_b32 s92, s31, 3
    s_lshl1_add_u32 s92, s92, s32
    s_cmp_eq_u32 s92, 3
    s_cselect_b32 s86, s91, s86
    s_cselect_b32 s87, s85, s87
    s_cselect_b32 s91, 0x2a00000, 0
    s_cselect_b32 s92, s26, s12
    s_cselect_b32 s93, s27, s13
    s_max_u32 s91, s91, 2097152
    s_add_u32 s60, s92, s86
    s_addc_u32 s61, s93, 0
    s_sub_u32 s62, s91, s86
    s_mov_b32 s63, 0x20000
    s_add_u32 s56, s26, 0x1200000
    s_addc_u32 s57, s27, 0
    s_mov_b32 s58, 0x400000
    s_mov_b32 s59, 0x20000
    s_lshl_b32 s82, s30, 18
    s_mov_b32 s83, 0
    s_lshl_b32 m0, s33, 2
    s_nop 0
    buffer_load_dwordx4 v10, s[56:59], s82 offen offset:0 sc1 lds
    buffer_load_dwordx4 v10, s[56:59], s82 offen offset:1024 sc1 lds
    buffer_load_dwordx4 v10, s[56:59], s82 offen offset:2048 sc1 lds
    buffer_load_dwordx4 v10, s[56:59], s82 offen offset:3072 sc1 lds
    s_add_u32 s82, s82, 16384
    s_lshl1_add_u32 m0, s33, 16384
    s_nop 0
    buffer_load_dwordx4 v4, s[60:63], s83 offen lds
    s_lshl1_add_u32 m0, s33, 17408
    s_nop 0
    buffer_load_dwordx4 v5, s[60:63], s83 offen lds
    s_add_u32 s83, s83, 131072
    s_waitcnt vmcnt(14)
    s_barrier
    s_lshl2_add_u32 m0, s33, 98304
    s_nop 0
    buffer_load_dwordx4 v10, s[56:59], s82 offen offset:0 sc1 lds
    buffer_load_dwordx4 v10, s[56:59], s82 offen offset:1024 sc1 lds
    buffer_load_dwordx4 v10, s[56:59], s82 offen offset:2048 sc1 lds
    buffer_load_dwordx4 v10, s[56:59], s82 offen offset:3072 sc1 lds
    s_add_u32 s82, s82, 16384
    s_lshl1_add_u32 m0, s33, 114688
    s_nop 0
    buffer_load_dwordx4 v4, s[60:63], s83 offen lds
    s_lshl1_add_u32 m0, s33, 115712
    s_nop 0
    buffer_load_dwordx4 v5, s[60:63], s83 offen lds
    s_add_u32 s83, s83, 131072
    s_lshl2_add_u32 m0, s33, 122880
    s_nop 0
    buffer_load_dwordx4 v10, s[56:59], s82 offen offset:0 sc1 lds
    buffer_load_dwordx4 v10, s[56:59], s82 offen offset:1024 sc1 lds
    buffer_load_dwordx4 v10, s[56:59], s82 offen offset:2048 sc1 lds
    buffer_load_dwordx4 v10, s[56:59], s82 offen offset:3072 sc1 lds
    s_add_u32 s82, s82, 16384
    s_lshl1_add_u32 m0, s33, 139264
    s_nop 0
    buffer_load_dwordx4 v4, s[60:63], s83 offen lds
    s_lshl1_add_u32 m0, s33, 140288
    s_nop 0
    buffer_load_dwordx4 v5, s[60:63], s83 offen lds
    s_add_u32 s83, s83, 131072
    s_waitcnt vmcnt(12)
    s_barrier
    s_lshl2_add_u32 m0, s33, 24576
    s_nop 0
    buffer_load_dwordx4 v10, s[56:59], s82 offen offset:0 sc1 lds
    buffer_load_dwordx4 v10, s[56:59], s82 offen offset:1024 sc1 lds
    buffer_load_dwordx4 v10, s[56:59], s82 offen offset:2048 sc1 lds
    buffer_load_dwordx4 v10, s[56:59], s82 offen offset:3072 sc1 lds
    s_add_u32 s82, s82, 16384
    s_lshl1_add_u32 m0, s33, 40960
    s_nop 0
    buffer_load_dwordx4 v4, s[60:63], s83 offen lds
    s_lshl1_add_u32 m0, s33, 41984
    s_nop 0
    buffer_load_dwordx4 v5, s[60:63], s83 offen lds
    s_add_u32 s83, s83, 131072
    s_waitcnt lgkmcnt(0)
    ds_read_b64_tr_b16 v[40:41], v80 offset:16384
    ds_read_b64_tr_b16 v[42:43], v80 offset:16896
    ds_read_b128 v[24:27], v48 offset:0
    ds_read_b128 v[28:31], v48 offset:1024
    ds_read_b128 v[32:35], v48 offset:2048
    ds_read_b128 v[36:39], v48 offset:3072
    ds_read_b64_tr_b16 v[44:45], v81 offset:16384
    ds_read_b64_tr_b16 v[46:47], v81 offset:16896
    s_barrier
    s_setprio 1
    s_waitcnt lgkmcnt(5)
    v_mfma_f32_16x16x32_bf16 v[88:91], v[40:43], v[24:27], v[88:91]
    ds_read_b64_tr_b16 v[72:73], v80 offset:20480
    ds_read_b64_tr_b16 v[74:75], v80 offset:20992
    s_lshl2_add_u32 m0, s33, 49152
    s_waitcnt lgkmcnt(6)
    v_mfma_f32_16x16x32_bf16 v[92:95], v[40:43], v[28:31], v[92:95]
    buffer_load_dwordx4 v10, s[56:59], s82 offen offset:0 sc1 lds
    ds_read_b128 v[56:59], v48 offset:8192
    ds_read_b128 v[60:63], v48 offset:9216
    s_waitcnt lgkmcnt(7)
    v_mfma_f32_16x16x32_bf16 v[96:99], v[40:43], v[32:35], v[96:99]
    ds_read_b128 v[64:67], v48 offset:10240
    ds_read_b128 v[68:71], v48 offset:11264
    s_waitcnt lgkmcnt(8)
    v_mfma_f32_16x16x32_bf16 v[100:103], v[40:43], v[36:39], v[100:103]
    ds_read_b64_tr_b16 v[76:77], v81 offset:20480
    ds_read_b64_tr_b16 v[78:79], v81 offset:20992
    s_waitcnt lgkmcnt(8)
    v_mfma_f32_16x16x32_bf16 v[104:107], v[44:47], v[24:27], v[104:107]
    buffer_load_dwordx4 v10, s[56:59], s82 offen offset:1024 sc1 lds
    v_mfma_f32_16x16x32_bf16 v[108:111], v[44:47], v[28:31], v[108:111]
    v_mfma_f32_16x16x32_bf16 v[112:115], v[44:47], v[32:35], v[112:115]
    v_mfma_f32_16x16x32_bf16 v[116:119], v[44:47], v[36:39], v[116:119]
    s_waitcnt vmcnt(14) lgkmcnt(0)
    s_barrier
    v_mfma_f32_16x16x32_bf16 v[88:91], v[72:75], v[56:59], v[88:91]
    ds_read_b64_tr_b16 v[40:41], v84 offset:16384
    ds_read_b64_tr_b16 v[42:43], v84 offset:16896
    v_mfma_f32_16x16x32_bf16 v[92:95], v[72:75], v[60:63], v[92:95]
    buffer_load_dwordx4 v10, s[56:59], s82 offen offset:2048 sc1 lds
    ds_read_b128 v[24:27], v50 offset:0
    ds_read_b128 v[28:31], v50 offset:1024
    v_mfma_f32_16x16x32_bf16 v[96:99], v[72:75], v[64:67], v[96:99]
    ds_read_b128 v[32:35], v50 offset:2048
    v_mfma_f32_16x16x32_bf16 v[100:103], v[72:75], v[68:71], v[100:103]
    ds_read_b128 v[36:39], v50 offset:3072
    ds_read_b64_tr_b16 v[44:45], v85 offset:16384
    v_mfma_f32_16x16x32_bf16 v[104:107], v[76:79], v[56:59], v[104:107]
    buffer_load_dwordx4 v10, s[56:59], s82 offen offset:3072 sc1 lds
    s_add_u32 s82, s82, 16384
    ds_read_b64_tr_b16 v[46:47], v85 offset:16896
    v_mfma_f32_16x16x32_bf16 v[108:111], v[76:79], v[60:63], v[108:111]
    v_mfma_f32_16x16x32_bf16 v[112:115], v[76:79], v[64:67], v[112:115]
    v_mfma_f32_16x16x32_bf16 v[116:119], v[76:79], v[68:71], v[116:119]
    s_waitcnt lgkmcnt(5)
    v_mfma_f32_16x16x32_bf16 v[88:91], v[40:43], v[24:27], v[88:91]
    ds_read_b64_tr_b16 v[72:73], v84 offset:20480
    ds_read_b64_tr_b16 v[74:75], v84 offset:20992
    s_lshl1_add_u32 m0, s33, 65536
    s_waitcnt lgkmcnt(6)
    v_mfma_f32_16x16x32_bf16 v[92:95], v[40:43], v[28:31], v[92:95]
    buffer_load_dwordx4 v4, s[60:63], s83 offen lds
    ds_read_b128 v[56:59], v50 offset:8192
    ds_read_b128 v[60:63], v50 offset:9216
    s_waitcnt lgkmcnt(7)
    v_mfma_f32_16x16x32_bf16 v[96:99], v[40:43], v[32:35], v[96:99]
    ds_read_b128 v[64:67], v50 offset:10240
    ds_read_b128 v[68:71], v50 offset:11264
    s_waitcnt lgkmcnt(8)
    v_mfma_f32_16x16x32_bf16 v[100:103], v[40:43], v[36:39], v[100:103]
    ds_read_b64_tr_b16 v[76:77], v85 offset:20480
    ds_read_b64_tr_b16 v[78:79], v85 offset:20992
    s_lshl1_add_u32 m0, s33, 66560
    s_waitcnt lgkmcnt(8)
    v_mfma_f32_16x16x32_bf16 v[104:107], v[44:47], v[24:27], v[104:107]
    buffer_load_dwordx4 v5, s[60:63], s83 offen lds
    s_add_u32 s83, s83, 131072
    v_mfma_f32_16x16x32_bf16 v[108:111], v[44:47], v[28:31], v[108:111]
    v_mfma_f32_16x16x32_bf16 v[112:115], v[44:47], v[32:35], v[112:115]
    v_mfma_f32_16x16x32_bf16 v[116:119], v[44:47], v[36:39], v[116:119]
    s_waitcnt vmcnt(12) lgkmcnt(0)
    s_barrier
    v_mfma_f32_16x16x32_bf16 v[88:91], v[72:75], v[56:59], v[88:91]
    ds_read_b64_tr_b16 v[40:41], v84 offset:40960
    ds_read_b64_tr_b16 v[42:43], v84 offset:41472
    s_lshl2_add_u32 m0, s33, 73728
    v_mfma_f32_16x16x32_bf16 v[92:95], v[72:75], v[60:63], v[92:95]
    buffer_load_dwordx4 v10, s[56:59], s82 offen offset:0 sc1 lds
    ds_read_b128 v[24:27], v50 offset:24576
    ds_read_b128 v[28:31], v50 offset:25600
    v_mfma_f32_16x16x32_bf16 v[96:99], v[72:75], v[64:67], v[96:99]
    ds_read_b128 v[32:35], v50 offset:26624
    v_mfma_f32_16x16x32_bf16 v[100:103], v[72:75], v[68:71], v[100:103]
    ds_read_b128 v[36:39], v50 offset:27648
    ds_read_b64_tr_b16 v[44:45], v85 offset:40960
    v_mfma_f32_16x16x32_bf16 v[104:107], v[76:79], v[56:59], v[104:107]
    buffer_load_dwordx4 v10, s[56:59], s82 offen offset:1024 sc1 lds
    ds_read_b64_tr_b16 v[46:47], v85 offset:41472
    v_mfma_f32_16x16x32_bf16 v[108:111], v[76:79], v[60:63], v[108:111]
    v_mfma_f32_16x16x32_bf16 v[112:115], v[76:79], v[64:67], v[112:115]
    v_mfma_f32_16x16x32_bf16 v[116:119], v[76:79], v[68:71], v[116:119]
    s_waitcnt lgkmcnt(5)
    v_mfma_f32_16x16x32_bf16 v[88:91], v[40:43], v[24:27], v[88:91]
    ds_read_b64_tr_b16 v[72:73], v84 offset:45056
    ds_read_b64_tr_b16 v[74:75], v84 offset:45568
    s_waitcnt lgkmcnt(6)
    v_mfma_f32_16x16x32_bf16 v[92:95], v[40:43], v[28:31], v[92:95]
    buffer_load_dwordx4 v10, s[56:59], s82 offen offset:2048 sc1 lds
    ds_read_b128 v[56:59], v50 offset:32768
    ds_read_b128 v[60:63], v50 offset:33792
    s_waitcnt lgkmcnt(7)
    v_mfma_f32_16x16x32_bf16 v[96:99], v[40:43], v[32:35], v[96:99]
    ds_read_b128 v[64:67], v50 offset:34816
    ds_read_b128 v[68:71], v50 offset:35840
    s_waitcnt lgkmcnt(8)
    v_mfma_f32_16x16x32_bf16 v[100:103], v[40:43], v[36:39], v[100:103]
    ds_read_b64_tr_b16 v[76:77], v85 offset:45056
    ds_read_b64_tr_b16 v[78:79], v85 offset:45568
    s_waitcnt lgkmcnt(8)
    v_mfma_f32_16x16x32_bf16 v[104:107], v[44:47], v[24:27], v[104:107]
    buffer_load_dwordx4 v10, s[56:59], s82 offen offset:3072 sc1 lds
    s_add_u32 s82, s82, 16384
    v_mfma_f32_16x16x32_bf16 v[108:111], v[44:47], v[28:31], v[108:111]
    v_mfma_f32_16x16x32_bf16 v[112:115], v[44:47], v[32:35], v[112:115]
    v_mfma_f32_16x16x32_bf16 v[116:119], v[44:47], v[36:39], v[116:119]
    s_waitcnt vmcnt(10) lgkmcnt(0)
    s_barrier
    v_mfma_f32_16x16x32_bf16 v[88:91], v[72:75], v[56:59], v[88:91]
    ds_read_b64_tr_b16 v[40:41], v80 offset:40960
    ds_read_b64_tr_b16 v[42:43], v80 offset:41472
    s_lshl1_add_u32 m0, s33, 90112
    v_mfma_f32_16x16x32_bf16 v[92:95], v[72:75], v[60:63], v[92:95]
    buffer_load_dwordx4 v4, s[60:63], s83 offen lds
    ds_read_b128 v[24:27], v48 offset:24576
    ds_read_b128 v[28:31], v48 offset:25600
    v_mfma_f32_16x16x32_bf16 v[96:99], v[72:75], v[64:67], v[96:99]
    ds_read_b128 v[32:35], v48 offset:26624
    v_mfma_f32_16x16x32_bf16 v[100:103], v[72:75], v[68:71], v[100:103]
    ds_read_b128 v[36:39], v48 offset:27648
    ds_read_b64_tr_b16 v[44:45], v81 offset:40960
    s_lshl1_add_u32 m0, s33, 91136
    v_mfma_f32_16x16x32_bf16 v[104:107], v[76:79], v[56:59], v[104:107]
    buffer_load_dwordx4 v5, s[60:63], s83 offen lds
    s_add_u32 s83, s83, 131072
    ds_read_b64_tr_b16 v[46:47], v81 offset:41472
    v_mfma_f32_16x16x32_bf16 v[108:111], v[76:79], v[60:63], v[108:111]
    v_mfma_f32_16x16x32_bf16 v[112:115], v[76:79], v[64:67], v[112:115]
    v_mfma_f32_16x16x32_bf16 v[116:119], v[76:79], v[68:71], v[116:119]
    s_waitcnt lgkmcnt(5)
    v_mfma_f32_16x16x32_bf16 v[88:91], v[40:43], v[24:27], v[88:91]
    ds_read_b64_tr_b16 v[72:73], v80 offset:45056
    ds_read_b64_tr_b16 v[74:75], v80 offset:45568
    s_lshl_b32 m0, s33, 2
    s_waitcnt lgkmcnt(6)
    v_mfma_f32_16x16x32_bf16 v[92:95], v[40:43], v[28:31], v[92:95]
    buffer_load_dwordx4 v10, s[56:59], s82 offen offset:0 sc1 lds
    ds_read_b128 v[56:59], v48 offset:32768
    ds_read_b128 v[60:63], v48 offset:33792
    s_waitcnt lgkmcnt(7)
    v_mfma_f32_16x16x32_bf16 v[96:99], v[40:43], v[32:35], v[96:99]
    ds_read_b128 v[64:67], v48 offset:34816
    ds_read_b128 v[68:71], v48 offset:35840
    s_waitcnt lgkmcnt(8)
    v_mfma_f32_16x16x32_bf16 v[100:103], v[40:43], v[36:39], v[100:103]
    buffer_load_dwordx4 v10, s[56:59], s82 offen offset:1024 sc1 lds
    ds_read_b64_tr_b16 v[76:77], v81 offset:45056
    ds_read_b64_tr_b16 v[78:79], v81 offset:45568
    s_waitcnt lgkmcnt(8)
    v_mfma_f32_16x16x32_bf16 v[104:107], v[44:47], v[24:27], v[104:107]
    v_mfma_f32_16x16x32_bf16 v[108:111], v[44:47], v[28:31], v[108:111]
    buffer_load_dwordx4 v10, s[56:59], s82 offen offset:2048 sc1 lds
    v_mfma_f32_16x16x32_bf16 v[112:115], v[44:47], v[32:35], v[112:115]
    v_mfma_f32_16x16x32_bf16 v[116:119], v[44:47], v[36:39], v[116:119]
    s_waitcnt vmcnt(9) lgkmcnt(0)
    s_barrier
    v_mfma_f32_16x16x32_bf16 v[88:91], v[72:75], v[56:59], v[88:91]
    ds_read_b64_tr_b16 v[40:41], v82 offset:16384
    ds_read_b64_tr_b16 v[42:43], v82 offset:16896
    v_mfma_f32_16x16x32_bf16 v[92:95], v[72:75], v[60:63], v[92:95]
    buffer_load_dwordx4 v10, s[56:59], s82 offen offset:3072 sc1 lds
    s_add_u32 s82, s82, 16384
    ds_read_b128 v[24:27], v49 offset:0
    ds_read_b128 v[28:31], v49 offset:1024
    v_mfma_f32_16x16x32_bf16 v[96:99], v[72:75], v[64:67], v[96:99]
    ds_read_b128 v[32:35], v49 offset:2048
    s_lshl1_add_u32 m0, s33, 16384
    v_mfma_f32_16x16x32_bf16 v[100:103], v[72:75], v[68:71], v[100:103]
    buffer_load_dwordx4 v4, s[60:63], s83 offen lds
    ds_read_b128 v[36:39], v49 offset:3072
    ds_read_b64_tr_b16 v[44:45], v83 offset:16384
    v_mfma_f32_16x16x32_bf16 v[104:107], v[76:79], v[56:59], v[104:107]
    ds_read_b64_tr_b16 v[46:47], v83 offset:16896
    s_lshl1_add_u32 m0, s33, 17408
    v_mfma_f32_16x16x32_bf16 v[108:111], v[76:79], v[60:63], v[108:111]
    buffer_load_dwordx4 v5, s[60:63], s83 offen lds
    s_add_u32 s83, s83, 131072
    v_mfma_f32_16x16x32_bf16 v[112:115], v[76:79], v[64:67], v[112:115]
    v_mfma_f32_16x16x32_bf16 v[116:119], v[76:79], v[68:71], v[116:119]
    s_waitcnt lgkmcnt(5)
    v_mfma_f32_16x16x32_bf16 v[88:91], v[40:43], v[24:27], v[88:91]
    ds_read_b64_tr_b16 v[72:73], v82 offset:20480
    ds_read_b64_tr_b16 v[74:75], v82 offset:20992
    s_lshl2_add_u32 m0, s33, 98304
    s_waitcnt lgkmcnt(6)
    v_mfma_f32_16x16x32_bf16 v[92:95], v[40:43], v[28:31], v[92:95]
    buffer_load_dwordx4 v10, s[56:59], s82 offen offset:0 sc1 lds
    ds_read_b128 v[56:59], v49 offset:8192
    ds_read_b128 v[60:63], v49 offset:9216
    s_waitcnt lgkmcnt(7)
    v_mfma_f32_16x16x32_bf16 v[96:99], v[40:43], v[32:35], v[96:99]
    ds_read_b128 v[64:67], v49 offset:10240
    ds_read_b128 v[68:71], v49 offset:11264
    s_waitcnt lgkmcnt(8)
    v_mfma_f32_16x16x32_bf16 v[100:103], v[40:43], v[36:39], v[100:103]
    buffer_load_dwordx4 v10, s[56:59], s82 offen offset:1024 sc1 lds
    ds_read_b64_tr_b16 v[76:77], v83 offset:20480
    ds_read_b64_tr_b16 v[78:79], v83 offset:20992
    s_waitcnt lgkmcnt(8)
    v_mfma_f32_16x16x32_bf16 v[104:107], v[44:47], v[24:27], v[104:107]
    v_mfma_f32_16x16x32_bf16 v[108:111], v[44:47], v[28:31], v[108:111]
    buffer_load_dwordx4 v10, s[56:59], s82 offen offset:2048 sc1 lds
    v_mfma_f32_16x16x32_bf16 v[112:115], v[44:47], v[32:35], v[112:115]
    v_mfma_f32_16x16x32_bf16 v[116:119], v[44:47], v[36:39], v[116:119]
    s_waitcnt vmcnt(9) lgkmcnt(0)
    s_barrier
    v_mfma_f32_16x16x32_bf16 v[88:91], v[72:75], v[56:59], v[88:91]
    ds_read_b64_tr_b16 v[40:41], v82 offset:40960
    ds_read_b64_tr_b16 v[42:43], v82 offset:41472
    v_mfma_f32_16x16x32_bf16 v[92:95], v[72:75], v[60:63], v[92:95]
    buffer_load_dwordx4 v10, s[56:59], s82 offen offset:3072 sc1 lds
    s_add_u32 s82, s82, 16384
    ds_read_b128 v[24:27], v49 offset:24576
    ds_read_b128 v[28:31], v49 offset:25600
    v_mfma_f32_16x16x32_bf16 v[96:99], v[72:75], v[64:67], v[96:99]
    ds_read_b128 v[32:35], v49 offset:26624
    s_lshl1_add_u32 m0, s33, 114688
    v_mfma_f32_16x16x32_bf16 v[100:103], v[72:75], v[68:71], v[100:103]
    buffer_load_dwordx4 v4, s[60:63], s83 offen lds
    ds_read_b128 v[36:39], v49 offset:27648
    ds_read_b64_tr_b16 v[44:45], v83 offset:40960
    v_mfma_f32_16x16x32_bf16 v[104:107], v[76:79], v[56:59], v[104:107]
    ds_read_b64_tr_b16 v[46:47], v83 offset:41472
    s_lshl1_add_u32 m0, s33, 115712
    v_mfma_f32_16x16x32_bf16 v[108:111], v[76:79], v[60:63], v[108:111]
    buffer_load_dwordx4 v5, s[60:63], s83 offen lds
    s_add_u32 s83, s83, 131072
    v_mfma_f32_16x16x32_bf16 v[112:115], v[76:79], v[64:67], v[112:115]
    v_mfma_f32_16x16x32_bf16 v[116:119], v[76:79], v[68:71], v[116:119]
    s_waitcnt lgkmcnt(5)
    v_mfma_f32_16x16x32_bf16 v[88:91], v[40:43], v[24:27], v[88:91]
    ds_read_b64_tr_b16 v[72:73], v82 offset:45056
    ds_read_b64_tr_b16 v[74:75], v82 offset:45568
    s_lshl2_add_u32 m0, s33, 122880
    s_waitcnt lgkmcnt(6)
    v_mfma_f32_16x16x32_bf16 v[92:95], v[40:43], v[28:31], v[92:95]
    buffer_load_dwordx4 v10, s[56:59], s82 offen offset:0 sc1 lds
    ds_read_b128 v[56:59], v49 offset:32768
    ds_read_b128 v[60:63], v49 offset:33792
    s_waitcnt lgkmcnt(7)
    v_mfma_f32_16x16x32_bf16 v[96:99], v[40:43], v[32:35], v[96:99]
    ds_read_b128 v[64:67], v49 offset:34816
    ds_read_b128 v[68:71], v49 offset:35840
    s_waitcnt lgkmcnt(8)
    v_mfma_f32_16x16x32_bf16 v[100:103], v[40:43], v[36:39], v[100:103]
    buffer_load_dwordx4 v10, s[56:59], s82 offen offset:1024 sc1 lds
    ds_read_b64_tr_b16 v[76:77], v83 offset:45056
    ds_read_b64_tr_b16 v[78:79], v83 offset:45568
    s_waitcnt lgkmcnt(8)
    v_mfma_f32_16x16x32_bf16 v[104:107], v[44:47], v[24:27], v[104:107]
    v_mfma_f32_16x16x32_bf16 v[108:111], v[44:47], v[28:31], v[108:111]
    buffer_load_dwordx4 v10, s[56:59], s82 offen offset:2048 sc1 lds
    v_mfma_f32_16x16x32_bf16 v[112:115], v[44:47], v[32:35], v[112:115]
    v_mfma_f32_16x16x32_bf16 v[116:119], v[44:47], v[36:39], v[116:119]
    s_waitcnt vmcnt(9) lgkmcnt(0)
    s_barrier
    v_mfma_f32_16x16x32_bf16 v[88:91], v[72:75], v[56:59], v[88:91]
    ds_read_b64_tr_b16 v[40:41], v80 offset:16384
    ds_read_b64_tr_b16 v[42:43], v80 offset:16896
    v_mfma_f32_16x16x32_bf16 v[92:95], v[72:75], v[60:63], v[92:95]
    buffer_load_dwordx4 v10, s[56:59], s82 offen offset:3072 sc1 lds
    s_add_u32 s82, s82, 16384
    ds_read_b128 v[24:27], v48 offset:0
    ds_read_b128 v[28:31], v48 offset:1024
    v_mfma_f32_16x16x32_bf16 v[96:99], v[72:75], v[64:67], v[96:99]
    ds_read_b128 v[32:35], v48 offset:2048
    s_lshl1_add_u32 m0, s33, 139264
    v_mfma_f32_16x16x32_bf16 v[100:103], v[72:75], v[68:71], v[100:103]
    buffer_load_dwordx4 v4, s[60:63], s83 offen lds
    ds_read_b128 v[36:39], v48 offset:3072
    ds_read_b64_tr_b16 v[44:45], v81 offset:16384
    v_mfma_f32_16x16x32_bf16 v[104:107], v[76:79], v[56:59], v[104:107]
    ds_read_b64_tr_b16 v[46:47], v81 offset:16896
    s_lshl1_add_u32 m0, s33, 140288
    v_mfma_f32_16x16x32_bf16 v[108:111], v[76:79], v[60:63], v[108:111]
    buffer_load_dwordx4 v5, s[60:63], s83 offen lds
    s_add_u32 s83, s83, 131072
    v_mfma_f32_16x16x32_bf16 v[112:115], v[76:79], v[64:67], v[112:115]
    v_mfma_f32_16x16x32_bf16 v[116:119], v[76:79], v[68:71], v[116:119]
    s_waitcnt lgkmcnt(5)
    v_mfma_f32_16x16x32_bf16 v[88:91], v[40:43], v[24:27], v[88:91]
    ds_read_b64_tr_b16 v[72:73], v80 offset:20480
    ds_read_b64_tr_b16 v[74:75], v80 offset:20992
    s_lshl2_add_u32 m0, s33, 24576
    s_waitcnt lgkmcnt(6)
    v_mfma_f32_16x16x32_bf16 v[92:95], v[40:43], v[28:31], v[92:95]
    buffer_load_dwordx4 v10, s[56:59], s82 offen offset:0 sc1 lds
    ds_read_b128 v[56:59], v48 offset:8192
    ds_read_b128 v[60:63], v48 offset:9216
    s_waitcnt lgkmcnt(7)
    v_mfma_f32_16x16x32_bf16 v[96:99], v[40:43], v[32:35], v[96:99]
    ds_read_b128 v[64:67], v48 offset:10240
    ds_read_b128 v[68:71], v48 offset:11264
    s_waitcnt lgkmcnt(8)
    v_mfma_f32_16x16x32_bf16 v[100:103], v[40:43], v[36:39], v[100:103]
    buffer_load_dwordx4 v10, s[56:59], s82 offen offset:1024 sc1 lds
    ds_read_b64_tr_b16 v[76:77], v81 offset:20480
    ds_read_b64_tr_b16 v[78:79], v81 offset:20992
    s_waitcnt lgkmcnt(8)
    v_mfma_f32_16x16x32_bf16 v[104:107], v[44:47], v[24:27], v[104:107]
    v_mfma_f32_16x16x32_bf16 v[108:111], v[44:47], v[28:31], v[108:111]
    buffer_load_dwordx4 v10, s[56:59], s82 offen offset:2048 sc1 lds
    v_mfma_f32_16x16x32_bf16 v[112:115], v[44:47], v[32:35], v[112:115]
    v_mfma_f32_16x16x32_bf16 v[116:119], v[44:47], v[36:39], v[116:119]
    s_waitcnt vmcnt(9) lgkmcnt(0)
    s_barrier
    v_mfma_f32_16x16x32_bf16 v[88:91], v[72:75], v[56:59], v[88:91]
    ds_read_b64_tr_b16 v[40:41], v84 offset:16384
    ds_read_b64_tr_b16 v[42:43], v84 offset:16896
    v_mfma_f32_16x16x32_bf16 v[92:95], v[72:75], v[60:63], v[92:95]
    buffer_load_dwordx4 v10, s[56:59], s82 offen offset:3072 sc1 lds
    s_add_u32 s82, s82, 16384
    ds_read_b128 v[24:27], v50 offset:0
    ds_read_b128 v[28:31], v50 offset:1024
    v_mfma_f32_16x16x32_bf16 v[96:99], v[72:75], v[64:67], v[96:99]
    ds_read_b128 v[32:35], v50 offset:2048
    s_lshl1_add_u32 m0, s33, 40960
    v_mfma_f32_16x16x32_bf16 v[100:103], v[72:75], v[68:71], v[100:103]
    buffer_load_dwordx4 v4, s[60:63], s83 offen lds
    ds_read_b128 v[36:39], v50 offset:3072
    ds_read_b64_tr_b16 v[44:45], v85 offset:16384
    v_mfma_f32_16x16x32_bf16 v[104:107], v[76:79], v[56:59], v[104:107]
    ds_read_b64_tr_b16 v[46:47], v85 offset:16896
    s_lshl1_add_u32 m0, s33, 41984
    v_mfma_f32_16x16x32_bf16 v[108:111], v[76:79], v[60:63], v[108:111]
    buffer_load_dwordx4 v5, s[60:63], s83 offen lds
    s_add_u32 s83, s83, 131072
    v_mfma_f32_16x16x32_bf16 v[112:115], v[76:79], v[64:67], v[112:115]
    v_mfma_f32_16x16x32_bf16 v[116:119], v[76:79], v[68:71], v[116:119]
    s_waitcnt lgkmcnt(5)
    v_mfma_f32_16x16x32_bf16 v[88:91], v[40:43], v[24:27], v[88:91]
    ds_read_b64_tr_b16 v[72:73], v84 offset:20480
    ds_read_b64_tr_b16 v[74:75], v84 offset:20992
    s_lshl2_add_u32 m0, s33, 49152
    s_waitcnt lgkmcnt(6)
    v_mfma_f32_16x16x32_bf16 v[92:95], v[40:43], v[28:31], v[92:95]
    buffer_load_dwordx4 v10, s[56:59], s82 offen offset:0 sc1 lds
    ds_read_b128 v[56:59], v50 offset:8192
    ds_read_b128 v[60:63], v50 offset:9216
    s_waitcnt lgkmcnt(7)
    v_mfma_f32_16x16x32_bf16 v[96:99], v[40:43], v[32:35], v[96:99]
    ds_read_b128 v[64:67], v50 offset:10240
    ds_read_b128 v[68:71], v50 offset:11264
    s_waitcnt lgkmcnt(8)
    v_mfma_f32_16x16x32_bf16 v[100:103], v[40:43], v[36:39], v[100:103]
    buffer_load_dwordx4 v10, s[56:59], s82 offen offset:1024 sc1 lds
    ds_read_b64_tr_b16 v[76:77], v85 offset:20480
    ds_read_b64_tr_b16 v[78:79], v85 offset:20992
    s_waitcnt lgkmcnt(8)
    v_mfma_f32_16x16x32_bf16 v[104:107], v[44:47], v[24:27], v[104:107]
    v_mfma_f32_16x16x32_bf16 v[108:111], v[44:47], v[28:31], v[108:111]
    buffer_load_dwordx4 v10, s[56:59], s82 offen offset:2048 sc1 lds
    v_mfma_f32_16x16x32_bf16 v[112:115], v[44:47], v[32:35], v[112:115]
    v_mfma_f32_16x16x32_bf16 v[116:119], v[44:47], v[36:39], v[116:119]
    s_waitcnt vmcnt(9) lgkmcnt(0)
    s_barrier
    v_mfma_f32_16x16x32_bf16 v[88:91], v[72:75], v[56:59], v[88:91]
    ds_read_b64_tr_b16 v[40:41], v84 offset:40960
    ds_read_b64_tr_b16 v[42:43], v84 offset:41472
    v_mfma_f32_16x16x32_bf16 v[92:95], v[72:75], v[60:63], v[92:95]
    buffer_load_dwordx4 v10, s[56:59], s82 offen offset:3072 sc1 lds
    s_add_u32 s82, s82, 16384
    ds_read_b128 v[24:27], v50 offset:24576
    ds_read_b128 v[28:31], v50 offset:25600
    v_mfma_f32_16x16x32_bf16 v[96:99], v[72:75], v[64:67], v[96:99]
    ds_read_b128 v[32:35], v50 offset:26624
    s_lshl1_add_u32 m0, s33, 65536
    v_mfma_f32_16x16x32_bf16 v[100:103], v[72:75], v[68:71], v[100:103]
    buffer_load_dwordx4 v4, s[60:63], s83 offen lds
    ds_read_b128 v[36:39], v50 offset:27648
    ds_read_b64_tr_b16 v[44:45], v85 offset:40960
    v_mfma_f32_16x16x32_bf16 v[104:107], v[76:79], v[56:59], v[104:107]
    ds_read_b64_tr_b16 v[46:47], v85 offset:41472
    s_lshl1_add_u32 m0, s33, 66560
    v_mfma_f32_16x16x32_bf16 v[108:111], v[76:79], v[60:63], v[108:111]
    buffer_load_dwordx4 v5, s[60:63], s83 offen lds
    s_add_u32 s83, s83, 131072
    v_mfma_f32_16x16x32_bf16 v[112:115], v[76:79], v[64:67], v[112:115]
    v_mfma_f32_16x16x32_bf16 v[116:119], v[76:79], v[68:71], v[116:119]
    s_waitcnt lgkmcnt(5)
    v_mfma_f32_16x16x32_bf16 v[88:91], v[40:43], v[24:27], v[88:91]
    ds_read_b64_tr_b16 v[72:73], v84 offset:45056
    ds_read_b64_tr_b16 v[74:75], v84 offset:45568
    s_lshl2_add_u32 m0, s33, 73728
    s_waitcnt lgkmcnt(6)
    v_mfma_f32_16x16x32_bf16 v[92:95], v[40:43], v[28:31], v[92:95]
    buffer_load_dwordx4 v10, s[56:59], s82 offen offset:0 sc1 lds
    ds_read_b128 v[56:59], v50 offset:32768
    ds_read_b128 v[60:63], v50 offset:33792
    s_waitcnt lgkmcnt(7)
    v_mfma_f32_16x16x32_bf16 v[96:99], v[40:43], v[32:35], v[96:99]
    ds_read_b128 v[64:67], v50 offset:34816
    ds_read_b128 v[68:71], v50 offset:35840
    s_waitcnt lgkmcnt(8)
    v_mfma_f32_16x16x32_bf16 v[100:103], v[40:43], v[36:39], v[100:103]
    buffer_load_dwordx4 v10, s[56:59], s82 offen offset:1024 sc1 lds
    ds_read_b64_tr_b16 v[76:77], v85 offset:45056
    ds_read_b64_tr_b16 v[78:79], v85 offset:45568
    s_waitcnt lgkmcnt(8)
    v_mfma_f32_16x16x32_bf16 v[104:107], v[44:47], v[24:27], v[104:107]
    v_mfma_f32_16x16x32_bf16 v[108:111], v[44:47], v[28:31], v[108:111]
    buffer_load_dwordx4 v10, s[56:59], s82 offen offset:2048 sc1 lds
    v_mfma_f32_16x16x32_bf16 v[112:115], v[44:47], v[32:35], v[112:115]
    v_mfma_f32_16x16x32_bf16 v[116:119], v[44:47], v[36:39], v[116:119]
    s_waitcnt vmcnt(9) lgkmcnt(0)
    s_barrier
    v_mfma_f32_16x16x32_bf16 v[88:91], v[72:75], v[56:59], v[88:91]
    ds_read_b64_tr_b16 v[40:41], v80 offset:40960
    ds_read_b64_tr_b16 v[42:43], v80 offset:41472
    v_mfma_f32_16x16x32_bf16 v[92:95], v[72:75], v[60:63], v[92:95]
    buffer_load_dwordx4 v10, s[56:59], s82 offen offset:3072 sc1 lds
    s_add_u32 s82, s82, 16384
    ds_read_b128 v[24:27], v48 offset:24576
    ds_read_b128 v[28:31], v48 offset:25600
    v_mfma_f32_16x16x32_bf16 v[96:99], v[72:75], v[64:67], v[96:99]
    ds_read_b128 v[32:35], v48 offset:26624
    s_lshl1_add_u32 m0, s33, 90112
    v_mfma_f32_16x16x32_bf16 v[100:103], v[72:75], v[68:71], v[100:103]
    buffer_load_dwordx4 v4, s[60:63], s83 offen lds
    ds_read_b128 v[36:39], v48 offset:27648
    ds_read_b64_tr_b16 v[44:45], v81 offset:40960
    v_mfma_f32_16x16x32_bf16 v[104:107], v[76:79], v[56:59], v[104:107]
    ds_read_b64_tr_b16 v[46:47], v81 offset:41472
    s_lshl1_add_u32 m0, s33, 91136
    v_mfma_f32_16x16x32_bf16 v[108:111], v[76:79], v[60:63], v[108:111]
    buffer_load_dwordx4 v5, s[60:63], s83 offen lds
    s_add_u32 s83, s83, 131072
    v_mfma_f32_16x16x32_bf16 v[112:115], v[76:79], v[64:67], v[112:115]
    v_mfma_f32_16x16x32_bf16 v[116:119], v[76:79], v[68:71], v[116:119]
    s_waitcnt lgkmcnt(5)
    v_mfma_f32_16x16x32_bf16 v[88:91], v[40:43], v[24:27], v[88:91]
    ds_read_b64_tr_b16 v[72:73], v80 offset:45056
    ds_read_b64_tr_b16 v[74:75], v80 offset:45568
    s_lshl_b32 m0, s33, 2
    s_waitcnt lgkmcnt(6)
    v_mfma_f32_16x16x32_bf16 v[92:95], v[40:43], v[28:31], v[92:95]
    buffer_load_dwordx4 v10, s[56:59], s82 offen offset:0 sc1 lds
    ds_read_b128 v[56:59], v48 offset:32768
    ds_read_b128 v[60:63], v48 offset:33792
    s_waitcnt lgkmcnt(7)
    v_mfma_f32_16x16x32_bf16 v[96:99], v[40:43], v[32:35], v[96:99]
    ds_read_b128 v[64:67], v48 offset:34816
    ds_read_b128 v[68:71], v48 offset:35840
    s_waitcnt lgkmcnt(8)
    v_mfma_f32_16x16x32_bf16 v[100:103], v[40:43], v[36:39], v[100:103]
    buffer_load_dwordx4 v10, s[56:59], s82 offen offset:1024 sc1 lds
    ds_read_b64_tr_b16 v[76:77], v81 offset:45056
L_pad12:
    s_cbranch_execz L_vret3
    ds_read_b64_tr_b16 v[78:79], v81 offset:45568
    s_waitcnt lgkmcnt(8)
    v_mfma_f32_16x16x32_bf16 v[104:107], v[44:47], v[24:27], v[104:107]
    v_mfma_f32_16x16x32_bf16 v[108:111], v[44:47], v[28:31], v[108:111]
    buffer_load_dwordx4 v10, s[56:59], s82 offen offset:2048 sc1 lds
    v_mfma_f32_16x16x32_bf16 v[112:115], v[44:47], v[32:35], v[112:115]
    v_mfma_f32_16x16x32_bf16 v[116:119], v[44:47], v[36:39], v[116:119]
    s_waitcnt vmcnt(9) lgkmcnt(0)
    s_barrier
    v_mfma_f32_16x16x32_bf16 v[88:91], v[72:75], v[56:59], v[88:91]
    ds_read_b64_tr_b16 v[40:41], v82 offset:16384
    ds_read_b64_tr_b16 v[42:43], v82 offset:16896
    v_mfma_f32_16x16x32_bf16 v[92:95], v[72:75], v[60:63], v[92:95]
    buffer_load_dwordx4 v10, s[56:59], s82 offen offset:3072 sc1 lds
    s_add_u32 s82, s82, 16384
    ds_read_b128 v[24:27], v49 offset:0
    ds_read_b128 v[28:31], v49 offset:1024
    v_mfma_f32_16x16x32_bf16 v[96:99], v[72:75], v[64:67], v[96:99]
    ds_read_b128 v[32:35], v49 offset:2048
    s_lshl1_add_u32 m0, s33, 16384
    v_mfma_f32_16x16x32_bf16 v[100:103], v[72:75], v[68:71], v[100:103]
    buffer_load_dwordx4 v4, s[60:63], s83 offen lds
    ds_read_b128 v[36:39], v49 offset:3072
    ds_read_b64_tr_b16 v[44:45], v83 offset:16384
    v_mfma_f32_16x16x32_bf16 v[104:107], v[76:79], v[56:59], v[104:107]
    ds_read_b64_tr_b16 v[46:47], v83 offset:16896
    s_lshl1_add_u32 m0, s33, 17408
    v_mfma_f32_16x16x32_bf16 v[108:111], v[76:79], v[60:63], v[108:111]
    buffer_load_dwordx4 v5, s[60:63], s83 offen lds
    s_add_u32 s83, s83, 131072
    v_mfma_f32_16x16x32_bf16 v[112:115], v[76:79], v[64:67], v[112:115]
    v_mfma_f32_16x16x32_bf16 v[116:119], v[76:79], v[68:71], v[116:119]
    s_waitcnt lgkmcnt(5)
    v_mfma_f32_16x16x32_bf16 v[88:91], v[40:43], v[24:27], v[88:91]
    ds_read_b64_tr_b16 v[72:73], v82 offset:20480
    ds_read_b64_tr_b16 v[74:75], v82 offset:20992
    s_lshl2_add_u32 m0, s33, 98304
    s_waitcnt lgkmcnt(6)
    v_mfma_f32_16x16x32_bf16 v[92:95], v[40:43], v[28:31], v[92:95]
    buffer_load_dwordx4 v10, s[56:59], s82 offen offset:0 sc1 lds
    ds_read_b128 v[56:59], v49 offset:8192
    ds_read_b128 v[60:63], v49 offset:9216
    s_waitcnt lgkmcnt(7)
    v_mfma_f32_16x16x32_bf16 v[96:99], v[40:43], v[32:35], v[96:99]
    ds_read_b128 v[64:67], v49 offset:10240
    ds_read_b128 v[68:71], v49 offset:11264
    s_waitcnt lgkmcnt(8)
    v_mfma_f32_16x16x32_bf16 v[100:103], v[40:43], v[36:39], v[100:103]
    buffer_load_dwordx4 v10, s[56:59], s82 offen offset:1024 sc1 lds
    ds_read_b64_tr_b16 v[76:77], v83 offset:20480
    ds_read_b64_tr_b16 v[78:79], v83 offset:20992
    s_waitcnt lgkmcnt(8)
    v_mfma_f32_16x16x32_bf16 v[104:107], v[44:47], v[24:27], v[104:107]
    v_mfma_f32_16x16x32_bf16 v[108:111], v[44:47], v[28:31], v[108:111]
    buffer_load_dwordx4 v10, s[56:59], s82 offen offset:2048 sc1 lds
    v_mfma_f32_16x16x32_bf16 v[112:115], v[44:47], v[32:35], v[112:115]
    v_mfma_f32_16x16x32_bf16 v[116:119], v[44:47], v[36:39], v[116:119]
    s_waitcnt vmcnt(9) lgkmcnt(0)
    s_barrier
    v_mfma_f32_16x16x32_bf16 v[88:91], v[72:75], v[56:59], v[88:91]
    ds_read_b64_tr_b16 v[40:41], v82 offset:40960
    ds_read_b64_tr_b16 v[42:43], v82 offset:41472
    v_mfma_f32_16x16x32_bf16 v[92:95], v[72:75], v[60:63], v[92:95]
    buffer_load_dwordx4 v10, s[56:59], s82 offen offset:3072 sc1 lds
    s_add_u32 s82, s82, 16384
    ds_read_b128 v[24:27], v49 offset:24576
    ds_read_b128 v[28:31], v49 offset:25600
    v_mfma_f32_16x16x32_bf16 v[96:99], v[72:75], v[64:67], v[96:99]
    ds_read_b128 v[32:35], v49 offset:26624
    s_lshl1_add_u32 m0, s33, 114688
    v_mfma_f32_16x16x32_bf16 v[100:103], v[72:75], v[68:71], v[100:103]
    buffer_load_dwordx4 v4, s[60:63], s83 offen lds
    ds_read_b128 v[36:39], v49 offset:27648
    ds_read_b64_tr_b16 v[44:45], v83 offset:40960
    v_mfma_f32_16x16x32_bf16 v[104:107], v[76:79], v[56:59], v[104:107]
    ds_read_b64_tr_b16 v[46:47], v83 offset:41472
    s_lshl1_add_u32 m0, s33, 115712
    v_mfma_f32_16x16x32_bf16 v[108:111], v[76:79], v[60:63], v[108:111]
    buffer_load_dwordx4 v5, s[60:63], s83 offen lds
    s_add_u32 s83, s83, 131072
    v_mfma_f32_16x16x32_bf16 v[112:115], v[76:79], v[64:67], v[112:115]
    v_mfma_f32_16x16x32_bf16 v[116:119], v[76:79], v[68:71], v[116:119]
    s_waitcnt lgkmcnt(5)
    v_mfma_f32_16x16x32_bf16 v[88:91], v[40:43], v[24:27], v[88:91]
    ds_read_b64_tr_b16 v[72:73], v82 offset:45056
    ds_read_b64_tr_b16 v[74:75], v82 offset:45568
    s_lshl2_add_u32 m0, s33, 122880
    s_waitcnt lgkmcnt(6)
    v_mfma_f32_16x16x32_bf16 v[92:95], v[40:43], v[28:31], v[92:95]
    buffer_load_dwordx4 v10, s[56:59], s82 offen offset:0 sc1 lds
    ds_read_b128 v[56:59], v49 offset:32768
    ds_read_b128 v[60:63], v49 offset:33792
    s_waitcnt lgkmcnt(7)
    v_mfma_f32_16x16x32_bf16 v[96:99], v[40:43], v[32:35], v[96:99]
    ds_read_b128 v[64:67], v49 offset:34816
    ds_read_b128 v[68:71], v49 offset:35840
    s_waitcnt lgkmcnt(8)
    v_mfma_f32_16x16x32_bf16 v[100:103], v[40:43], v[36:39], v[100:103]
    buffer_load_dwordx4 v10, s[56:59], s82 offen offset:1024 sc1 lds
    ds_read_b64_tr_b16 v[76:77], v83 offset:45056
    ds_read_b64_tr_b16 v[78:79], v83 offset:45568
    s_waitcnt lgkmcnt(8)
    v_mfma_f32_16x16x32_bf16 v[104:107], v[44:47], v[24:27], v[104:107]
    v_mfma_f32_16x16x32_bf16 v[108:111], v[44:47], v[28:31], v[108:111]
    buffer_load_dwordx4 v10, s[56:59], s82 offen offset:2048 sc1 lds
    v_mfma_f32_16x16x32_bf16 v[112:115], v[44:47], v[32:35], v[112:115]
    v_mfma_f32_16x16x32_bf16 v[116:119], v[44:47], v[36:39], v[116:119]
    s_waitcnt vmcnt(9) lgkmcnt(0)
    s_barrier
    v_mfma_f32_16x16x32_bf16 v[88:91], v[72:75], v[56:59], v[88:91]
    ds_read_b64_tr_b16 v[40:41], v80 offset:16384
    ds_read_b64_tr_b16 v[42:43], v80 offset:16896
    v_mfma_f32_16x16x32_bf16 v[92:95], v[72:75], v[60:63], v[92:95]
    buffer_load_dwordx4 v10, s[56:59], s82 offen offset:3072 sc1 lds
    s_add_u32 s82, s82, 16384
    ds_read_b128 v[24:27], v48 offset:0
    ds_read_b128 v[28:31], v48 offset:1024
    v_mfma_f32_16x16x32_bf16 v[96:99], v[72:75], v[64:67], v[96:99]
    ds_read_b128 v[32:35], v48 offset:2048
    s_lshl1_add_u32 m0, s33, 139264
    v_mfma_f32_16x16x32_bf16 v[100:103], v[72:75], v[68:71], v[100:103]
    buffer_load_dwordx4 v4, s[60:63], s83 offen lds
    ds_read_b128 v[36:39], v48 offset:3072
    ds_read_b64_tr_b16 v[44:45], v81 offset:16384
    v_mfma_f32_16x16x32_bf16 v[104:107], v[76:79], v[56:59], v[104:107]
    ds_read_b64_tr_b16 v[46:47], v81 offset:16896
    s_lshl1_add_u32 m0, s33, 140288
    v_mfma_f32_16x16x32_bf16 v[108:111], v[76:79], v[60:63], v[108:111]
    buffer_load_dwordx4 v5, s[60:63], s83 offen lds
    s_add_u32 s83, s83, 131072
    v_mfma_f32_16x16x32_bf16 v[112:115], v[76:79], v[64:67], v[112:115]
    v_mfma_f32_16x16x32_bf16 v[116:119], v[76:79], v[68:71], v[116:119]
    s_waitcnt lgkmcnt(5)
    v_mfma_f32_16x16x32_bf16 v[88:91], v[40:43], v[24:27], v[88:91]
    ds_read_b64_tr_b16 v[72:73], v80 offset:20480
    ds_read_b64_tr_b16 v[74:75], v80 offset:20992
    s_lshl2_add_u32 m0, s33, 24576
    s_waitcnt lgkmcnt(6)
    v_mfma_f32_16x16x32_bf16 v[92:95], v[40:43], v[28:31], v[92:95]
    buffer_load_dwordx4 v10, s[56:59], s82 offen offset:0 sc1 lds
    ds_read_b128 v[56:59], v48 offset:8192
    ds_read_b128 v[60:63], v48 offset:9216
    s_waitcnt lgkmcnt(7)
    v_mfma_f32_16x16x32_bf16 v[96:99], v[40:43], v[32:35], v[96:99]
    ds_read_b128 v[64:67], v48 offset:10240
    ds_read_b128 v[68:71], v48 offset:11264
    s_waitcnt lgkmcnt(8)
    v_mfma_f32_16x16x32_bf16 v[100:103], v[40:43], v[36:39], v[100:103]
    buffer_load_dwordx4 v10, s[56:59], s82 offen offset:1024 sc1 lds
    ds_read_b64_tr_b16 v[76:77], v81 offset:20480
    ds_read_b64_tr_b16 v[78:79], v81 offset:20992
    s_waitcnt lgkmcnt(8)
    v_mfma_f32_16x16x32_bf16 v[104:107], v[44:47], v[24:27], v[104:107]
    v_mfma_f32_16x16x32_bf16 v[108:111], v[44:47], v[28:31], v[108:111]
    buffer_load_dwordx4 v10, s[56:59], s82 offen offset:2048 sc1 lds
    v_mfma_f32_16x16x32_bf16 v[112:115], v[44:47], v[32:35], v[112:115]
    v_mfma_f32_16x16x32_bf16 v[116:119], v[44:47], v[36:39], v[116:119]
    s_waitcnt vmcnt(9) lgkmcnt(0)
    s_barrier
    v_mfma_f32_16x16x32_bf16 v[88:91], v[72:75], v[56:59], v[88:91]
    ds_read_b64_tr_b16 v[40:41], v84 offset:16384
    ds_read_b64_tr_b16 v[42:43], v84 offset:16896
    v_mfma_f32_16x16x32_bf16 v[92:95], v[72:75], v[60:63], v[92:95]
    buffer_load_dwordx4 v10, s[56:59], s82 offen offset:3072 sc1 lds
    s_add_u32 s82, s82, 16384
    ds_read_b128 v[24:27], v50 offset:0
    ds_read_b128 v[28:31], v50 offset:1024
    v_mfma_f32_16x16x32_bf16 v[96:99], v[72:75], v[64:67], v[96:99]
    ds_read_b128 v[32:35], v50 offset:2048
    s_lshl1_add_u32 m0, s33, 40960
    v_mfma_f32_16x16x32_bf16 v[100:103], v[72:75], v[68:71], v[100:103]
    buffer_load_dwordx4 v4, s[60:63], s83 offen lds
    ds_read_b128 v[36:39], v50 offset:3072
    ds_read_b64_tr_b16 v[44:45], v85 offset:16384
    v_mfma_f32_16x16x32_bf16 v[104:107], v[76:79], v[56:59], v[104:107]
    ds_read_b64_tr_b16 v[46:47], v85 offset:16896
    s_lshl1_add_u32 m0, s33, 41984
    v_mfma_f32_16x16x32_bf16 v[108:111], v[76:79], v[60:63], v[108:111]
    buffer_load_dwordx4 v5, s[60:63], s83 offen lds
    s_add_u32 s83, s83, 131072
    v_mfma_f32_16x16x32_bf16 v[112:115], v[76:79], v[64:67], v[112:115]
    v_mfma_f32_16x16x32_bf16 v[116:119], v[76:79], v[68:71], v[116:119]
    s_waitcnt lgkmcnt(5)
    v_mfma_f32_16x16x32_bf16 v[88:91], v[40:43], v[24:27], v[88:91]
    ds_read_b64_tr_b16 v[72:73], v84 offset:20480
    ds_read_b64_tr_b16 v[74:75], v84 offset:20992
    s_waitcnt lgkmcnt(6)
    v_mfma_f32_16x16x32_bf16 v[92:95], v[40:43], v[28:31], v[92:95]
    ds_read_b128 v[56:59], v50 offset:8192
    ds_read_b128 v[60:63], v50 offset:9216
    s_waitcnt lgkmcnt(7)
    v_mfma_f32_16x16x32_bf16 v[96:99], v[40:43], v[32:35], v[96:99]
    ds_read_b128 v[64:67], v50 offset:10240
    ds_read_b128 v[68:71], v50 offset:11264
    s_waitcnt lgkmcnt(8)
    v_mfma_f32_16x16x32_bf16 v[100:103], v[40:43], v[36:39], v[100:103]
    ds_read_b64_tr_b16 v[76:77], v85 offset:20480
    ds_read_b64_tr_b16 v[78:79], v85 offset:20992
    s_mov_b32 s84, 0
    s_waitcnt lgkmcnt(8)
    v_mfma_f32_16x16x32_bf16 v[104:107], v[44:47], v[24:27], v[104:107]
    buffer_load_dwordx4 v[120:123], v13, s[72:75], s84 offen
    v_mfma_f32_16x16x32_bf16 v[108:111], v[44:47], v[28:31], v[108:111]
    v_mfma_f32_16x16x32_bf16 v[112:115], v[44:47], v[32:35], v[112:115]
    s_mov_b32 s84, 32768
    v_mfma_f32_16x16x32_bf16 v[116:119], v[44:47], v[36:39], v[116:119]
    buffer_load_dwordx4 v[124:127], v13, s[72:75], s84 offen
    s_waitcnt vmcnt(8) lgkmcnt(0)
    s_barrier
    v_mfma_f32_16x16x32_bf16 v[88:91], v[72:75], v[56:59], v[88:91]
    ds_read_b64_tr_b16 v[40:41], v84 offset:40960
    ds_read_b64_tr_b16 v[42:43], v84 offset:41472
    v_mfma_f32_16x16x32_bf16 v[92:95], v[72:75], v[60:63], v[92:95]
    ds_read_b128 v[24:27], v50 offset:24576
    ds_read_b128 v[28:31], v50 offset:25600
    v_mfma_f32_16x16x32_bf16 v[96:99], v[72:75], v[64:67], v[96:99]
    ds_read_b128 v[32:35], v50 offset:26624
    v_mfma_f32_16x16x32_bf16 v[100:103], v[72:75], v[68:71], v[100:103]
    ds_read_b128 v[36:39], v50 offset:27648
    ds_read_b64_tr_b16 v[44:45], v85 offset:40960
    s_mov_b32 s84, 65536
    v_mfma_f32_16x16x32_bf16 v[104:107], v[76:79], v[56:59], v[104:107]
    ds_read_b64_tr_b16 v[46:47], v85 offset:41472
    buffer_load_dwordx4 v[128:131], v13, s[72:75], s84 offen
    v_mfma_f32_16x16x32_bf16 v[108:111], v[76:79], v[60:63], v[108:111]
    v_mfma_f32_16x16x32_bf16 v[112:115], v[76:79], v[64:67], v[112:115]
    s_mov_b32 s84, 98304
    v_mfma_f32_16x16x32_bf16 v[116:119], v[76:79], v[68:71], v[116:119]
    buffer_load_dwordx4 v[132:135], v13, s[72:75], s84 offen
    s_waitcnt lgkmcnt(5)
    v_mfma_f32_16x16x32_bf16 v[88:91], v[40:43], v[24:27], v[88:91]
    ds_read_b64_tr_b16 v[72:73], v84 offset:45056
    ds_read_b64_tr_b16 v[74:75], v84 offset:45568
    s_waitcnt lgkmcnt(6)
    v_mfma_f32_16x16x32_bf16 v[92:95], v[40:43], v[28:31], v[92:95]
    ds_read_b128 v[56:59], v50 offset:32768
    ds_read_b128 v[60:63], v50 offset:33792
    s_waitcnt lgkmcnt(7)
    v_mfma_f32_16x16x32_bf16 v[96:99], v[40:43], v[32:35], v[96:99]
    ds_read_b128 v[64:67], v50 offset:34816
    ds_read_b128 v[68:71], v50 offset:35840
    s_waitcnt lgkmcnt(8)
    v_mfma_f32_16x16x32_bf16 v[100:103], v[40:43], v[36:39], v[100:103]
    ds_read_b64_tr_b16 v[76:77], v85 offset:45056
    ds_read_b64_tr_b16 v[78:79], v85 offset:45568
    s_waitcnt lgkmcnt(8)
    v_mfma_f32_16x16x32_bf16 v[104:107], v[44:47], v[24:27], v[104:107]
    v_mfma_f32_16x16x32_bf16 v[108:111], v[44:47], v[28:31], v[108:111]
    v_mfma_f32_16x16x32_bf16 v[112:115], v[44:47], v[32:35], v[112:115]
    v_mfma_f32_16x16x32_bf16 v[116:119], v[44:47], v[36:39], v[116:119]
    s_waitcnt vmcnt(4) lgkmcnt(0)
    s_barrier
    v_mfma_f32_16x16x32_bf16 v[88:91], v[72:75], v[56:59], v[88:91]
    ds_read_b64_tr_b16 v[40:41], v80 offset:40960
    ds_read_b64_tr_b16 v[42:43], v80 offset:41472
    v_mfma_f32_16x16x32_bf16 v[92:95], v[72:75], v[60:63], v[92:95]
    ds_read_b128 v[24:27], v48 offset:24576
    ds_read_b128 v[28:31], v48 offset:25600
    v_mfma_f32_16x16x32_bf16 v[96:99], v[72:75], v[64:67], v[96:99]
    ds_read_b128 v[32:35], v48 offset:26624
    v_mfma_f32_16x16x32_bf16 v[100:103], v[72:75], v[68:71], v[100:103]
    ds_read_b128 v[36:39], v48 offset:27648
    ds_read_b64_tr_b16 v[44:45], v81 offset:40960
    v_mfma_f32_16x16x32_bf16 v[104:107], v[76:79], v[56:59], v[104:107]
    ds_read_b64_tr_b16 v[46:47], v81 offset:41472
    v_mfma_f32_16x16x32_bf16 v[108:111], v[76:79], v[60:63], v[108:111]
    ds_read_b64 v[168:169], v3 offset:0
    ds_read_b64 v[170:171], v3 offset:512
    ds_read_b64 v[172:173], v3 offset:1024
    v_mfma_f32_16x16x32_bf16 v[112:115], v[76:79], v[64:67], v[112:115]
    ds_read_b64 v[174:175], v3 offset:1536
    ds_read_b64 v[176:177], v3 offset:2048
    ds_read_b64 v[178:179], v3 offset:2560
    v_mfma_f32_16x16x32_bf16 v[116:119], v[76:79], v[68:71], v[116:119]
    ds_read_b64 v[180:181], v3 offset:3072
    ds_read_b64 v[182:183], v3 offset:3584
    s_waitcnt lgkmcnt(13)
    v_mfma_f32_16x16x32_bf16 v[88:91], v[40:43], v[24:27], v[88:91]
    ds_read_b64_tr_b16 v[72:73], v80 offset:45056
    ds_read_b64_tr_b16 v[74:75], v80 offset:45568
    s_waitcnt lgkmcnt(14)
    v_mfma_f32_16x16x32_bf16 v[92:95], v[40:43], v[28:31], v[92:95]
    ds_read_b128 v[56:59], v48 offset:32768
    ds_read_b128 v[60:63], v48 offset:33792
    s_waitcnt lgkmcnt(15)
    v_mfma_f32_16x16x32_bf16 v[96:99], v[40:43], v[32:35], v[96:99]
    ds_read_b128 v[64:67], v48 offset:34816
    ds_read_b128 v[68:71], v48 offset:35840
    s_waitcnt lgkmcnt(15)
    v_mfma_f32_16x16x32_bf16 v[100:103], v[40:43], v[36:39], v[100:103]
    ds_read_b64_tr_b16 v[76:77], v81 offset:45056
    ds_read_b64_tr_b16 v[78:79], v81 offset:45568
    s_waitcnt lgkmcnt(15)
    v_mfma_f32_16x16x32_bf16 v[104:107], v[44:47], v[24:27], v[104:107]
    v_lshlrev_b32 v184, 16, v168
    v_and_b32 v185, 0xffff0000, v168
    v_mfma_f32_16x16x32_bf16 v[108:111], v[44:47], v[28:31], v[108:111]
    v_lshlrev_b32 v186, 16, v169
    v_and_b32 v187, 0xffff0000, v169
    v_mfma_f32_16x16x32_bf16 v[112:115], v[44:47], v[32:35], v[112:115]
    s_waitcnt lgkmcnt(14)
    v_lshlrev_b32 v188, 16, v170
    v_and_b32 v189, 0xffff0000, v170
    v_mfma_f32_16x16x32_bf16 v[116:119], v[44:47], v[36:39], v[116:119]
    v_lshlrev_b32 v190, 16, v171
    v_and_b32 v191, 0xffff0000, v171
    s_waitcnt lgkmcnt(5)
    v_mfma_f32_16x16x32_bf16 v[88:91], v[72:75], v[56:59], v[88:91]
    v_lshlrev_b32 v192, 16, v172
    v_and_b32 v193, 0xffff0000, v172
    s_waitcnt lgkmcnt(4)
    v_mfma_f32_16x16x32_bf16 v[92:95], v[72:75], v[60:63], v[92:95]
    v_lshlrev_b32 v194, 16, v173
    v_and_b32 v195, 0xffff0000, v173
    s_waitcnt lgkmcnt(3)
    v_mfma_f32_16x16x32_bf16 v[96:99], v[72:75], v[64:67], v[96:99]
    v_lshlrev_b32 v196, 16, v174
    v_and_b32 v197, 0xffff0000, v174
    s_waitcnt lgkmcnt(2)
    v_mfma_f32_16x16x32_bf16 v[100:103], v[72:75], v[68:71], v[100:103]
    v_lshlrev_b32 v198, 16, v175
    v_and_b32 v199, 0xffff0000, v175
    s_waitcnt lgkmcnt(0)
    v_mfma_f32_16x16x32_bf16 v[104:107], v[76:79], v[56:59], v[104:107]
    s_mov_b32 s72, s22
    v_lshlrev_b32 v200, 16, v176
    v_and_b32 v201, 0xffff0000, v176
    v_mfma_f32_16x16x32_bf16 v[108:111], v[76:79], v[60:63], v[108:111]
    s_mov_b32 s73, s23
    v_lshlrev_b32 v202, 16, v177
    v_and_b32 v203, 0xffff0000, v177
    v_mfma_f32_16x16x32_bf16 v[112:115], v[76:79], v[64:67], v[112:115]
    s_mov_b32 s74, 0x400000
    v_lshlrev_b32 v204, 16, v178
    v_and_b32 v205, 0xffff0000, v178
    v_mfma_f32_16x16x32_bf16 v[116:119], v[76:79], v[68:71], v[116:119]
    s_mov_b32 s75, 0x20000
    v_lshlrev_b32 v206, 16, v179
    v_and_b32 v207, 0xffff0000, v179
    v_lshlrev_b32 v208, 16, v180
    v_and_b32 v209, 0xffff0000, v180
    v_lshlrev_b32 v210, 16, v181
    v_and_b32 v211, 0xffff0000, v181
    v_lshlrev_b32 v212, 16, v182
    v_and_b32 v213, 0xffff0000, v182
    v_lshlrev_b32 v214, 16, v183
    v_and_b32 v215, 0xffff0000, v183
    v_cvt_pk_bf16_f32 v40, v88, v89
    v_cvt_pk_bf16_f32 v41, v90, v91
    v_lshlrev_b32 v88, 16, v40
    v_and_b32 v89, 0xffff0000, v40
    v_lshlrev_b32 v90, 16, v41
    v_and_b32 v91, 0xffff0000, v41
    v_cvt_pk_bf16_f32 v42, v104, v105
    v_cvt_pk_bf16_f32 v43, v106, v107
    v_lshlrev_b32 v104, 16, v42
    v_and_b32 v105, 0xffff0000, v42
    v_lshlrev_b32 v106, 16, v43
    v_and_b32 v107, 0xffff0000, v43
    v_pk_mul_f32 v[88:89], v[88:89], v[184:185]
    v_pk_mul_f32 v[90:91], v[90:91], v[186:187]
    v_pk_mul_f32 v[104:105], v[104:105], v[200:201]
    v_pk_mul_f32 v[106:107], v[106:107], v[202:203]
    v_cvt_pk_bf16_f32 v88, v88, v89
    v_cvt_pk_bf16_f32 v89, v90, v91
    ds_write_b64 v14, v[88:89] offset:0
    v_cvt_pk_bf16_f32 v104, v104, v105
    v_cvt_pk_bf16_f32 v105, v106, v107
    ds_write_b64 v15, v[104:105] offset:0
    ds_read_b128 v[48:51], v17 offset:0
    v_cvt_pk_bf16_f32 v40, v92, v93
    v_cvt_pk_bf16_f32 v41, v94, v95
    v_lshlrev_b32 v92, 16, v40
    v_and_b32 v93, 0xffff0000, v40
    v_lshlrev_b32 v94, 16, v41
    v_and_b32 v95, 0xffff0000, v41
    v_cvt_pk_bf16_f32 v42, v108, v109
    v_cvt_pk_bf16_f32 v43, v110, v111
    v_lshlrev_b32 v108, 16, v42
    v_and_b32 v109, 0xffff0000, v42
    v_lshlrev_b32 v110, 16, v43
    v_and_b32 v111, 0xffff0000, v43
    v_pk_mul_f32 v[92:93], v[92:93], v[188:189]
    v_pk_mul_f32 v[94:95], v[94:95], v[190:191]
    v_pk_mul_f32 v[108:109], v[108:109], v[204:205]
    v_pk_mul_f32 v[110:111], v[110:111], v[206:207]
    v_cvt_pk_bf16_f32 v92, v92, v93
    v_cvt_pk_bf16_f32 v93, v94, v95
    ds_write_b64 v14, v[92:93] offset:1024
    v_cvt_pk_bf16_f32 v108, v108, v109
    v_cvt_pk_bf16_f32 v109, v110, v111
    ds_write_b64 v15, v[108:109] offset:1024
    ds_read_b128 v[52:55], v17 offset:1024
    s_waitcnt vmcnt(0)
    v_lshlrev_b32 v136, 16, v120
    v_and_b32 v137, 0xffff0000, v120
    v_lshlrev_b32 v138, 16, v121
    v_and_b32 v139, 0xffff0000, v121
    v_lshlrev_b32 v140, 16, v122
    v_and_b32 v141, 0xffff0000, v122
    v_lshlrev_b32 v142, 16, v123
    v_and_b32 v143, 0xffff0000, v123
    s_waitcnt lgkmcnt(3)
    v_lshlrev_b32 v24, 16, v48
    v_and_b32 v25, 0xffff0000, v48
    v_lshlrev_b32 v26, 16, v49
    v_and_b32 v27, 0xffff0000, v49
    v_lshlrev_b32 v28, 16, v50
    v_and_b32 v29, 0xffff0000, v50
    v_lshlrev_b32 v30, 16, v51
    v_and_b32 v31, 0xffff0000, v51
    v_pk_add_f32 v[24:25], v[24:25], v[136:137]
    v_pk_add_f32 v[26:27], v[26:27], v[138:139]
    v_pk_add_f32 v[28:29], v[28:29], v[140:141]
    v_pk_add_f32 v[30:31], v[30:31], v[142:143]
    v_cvt_pk_bf16_f32 v48, v24, v25
    v_cvt_pk_bf16_f32 v49, v26, v27
    v_cvt_pk_bf16_f32 v50, v28, v29
    v_cvt_pk_bf16_f32 v51, v30, v31
    s_mov_b32 s84, 0
    buffer_store_dwordx4 v[48:51], v13, s[72:75], s84 offen
    v_cvt_pk_bf16_f32 v40, v96, v97
    v_cvt_pk_bf16_f32 v41, v98, v99
    v_lshlrev_b32 v96, 16, v40
    v_and_b32 v97, 0xffff0000, v40
    v_lshlrev_b32 v98, 16, v41
    v_and_b32 v99, 0xffff0000, v41
    v_cvt_pk_bf16_f32 v42, v112, v113
    v_cvt_pk_bf16_f32 v43, v114, v115
    v_lshlrev_b32 v112, 16, v42
    v_and_b32 v113, 0xffff0000, v42
    v_lshlrev_b32 v114, 16, v43
    v_and_b32 v115, 0xffff0000, v43
    v_pk_mul_f32 v[96:97], v[96:97], v[192:193]
    v_pk_mul_f32 v[98:99], v[98:99], v[194:195]
    v_pk_mul_f32 v[112:113], v[112:113], v[208:209]
    v_pk_mul_f32 v[114:115], v[114:115], v[210:211]
    v_cvt_pk_bf16_f32 v96, v96, v97
    v_cvt_pk_bf16_f32 v97, v98, v99
    ds_write_b64 v14, v[96:97] offset:2048
    v_cvt_pk_bf16_f32 v112, v112, v113
    v_cvt_pk_bf16_f32 v113, v114, v115
    ds_write_b64 v15, v[112:113] offset:2048
    ds_read_b128 v[56:59], v17 offset:2048
    v_lshlrev_b32 v144, 16, v124
    v_and_b32 v145, 0xffff0000, v124
    v_lshlrev_b32 v146, 16, v125
    v_and_b32 v147, 0xffff0000, v125
    v_lshlrev_b32 v148, 16, v126
    v_and_b32 v149, 0xffff0000, v126
    v_lshlrev_b32 v150, 16, v127
    v_and_b32 v151, 0xffff0000, v127
    s_waitcnt lgkmcnt(3)
    v_lshlrev_b32 v24, 16, v52
    v_and_b32 v25, 0xffff0000, v52
    v_lshlrev_b32 v26, 16, v53
    v_and_b32 v27, 0xffff0000, v53
    v_lshlrev_b32 v28, 16, v54
    v_and_b32 v29, 0xffff0000, v54
    v_lshlrev_b32 v30, 16, v55
    v_and_b32 v31, 0xffff0000, v55
    v_pk_add_f32 v[24:25], v[24:25], v[144:145]
    v_pk_add_f32 v[26:27], v[26:27], v[146:147]
    v_pk_add_f32 v[28:29], v[28:29], v[148:149]
    v_pk_add_f32 v[30:31], v[30:31], v[150:151]
    v_cvt_pk_bf16_f32 v52, v24, v25
    v_cvt_pk_bf16_f32 v53, v26, v27
    v_cvt_pk_bf16_f32 v54, v28, v29
    v_cvt_pk_bf16_f32 v55, v30, v31
    s_mov_b32 s84, 32768
    buffer_store_dwordx4 v[52:55], v13, s[72:75], s84 offen
    v_cvt_pk_bf16_f32 v40, v100, v101
    v_cvt_pk_bf16_f32 v41, v102, v103
    v_lshlrev_b32 v100, 16, v40
    v_and_b32 v101, 0xffff0000, v40
    v_lshlrev_b32 v102, 16, v41
    v_and_b32 v103, 0xffff0000, v41
    v_cvt_pk_bf16_f32 v42, v116, v117
    v_cvt_pk_bf16_f32 v43, v118, v119
    v_lshlrev_b32 v116, 16, v42
    v_and_b32 v117, 0xffff0000, v42
    v_lshlrev_b32 v118, 16, v43
    v_and_b32 v119, 0xffff0000, v43
    v_pk_mul_f32 v[100:101], v[100:101], v[196:197]
    v_pk_mul_f32 v[102:103], v[102:103], v[198:199]
    v_pk_mul_f32 v[116:117], v[116:117], v[212:213]
    v_pk_mul_f32 v[118:119], v[118:119], v[214:215]
    v_cvt_pk_bf16_f32 v100, v100, v101
    v_cvt_pk_bf16_f32 v101, v102, v103
    ds_write_b64 v14, v[100:101] offset:3072
    v_cvt_pk_bf16_f32 v116, v116, v117
    v_cvt_pk_bf16_f32 v117, v118, v119
    ds_write_b64 v15, v[116:117] offset:3072
    ds_read_b128 v[60:63], v17 offset:3072
    v_lshlrev_b32 v152, 16, v128
    v_and_b32 v153, 0xffff0000, v128
    v_lshlrev_b32 v154, 16, v129
    v_and_b32 v155, 0xffff0000, v129
    v_lshlrev_b32 v156, 16, v130
    v_and_b32 v157, 0xffff0000, v130
    v_lshlrev_b32 v158, 16, v131
    v_and_b32 v159, 0xffff0000, v131
    s_waitcnt lgkmcnt(3)
    v_lshlrev_b32 v24, 16, v56
    v_and_b32 v25, 0xffff0000, v56
    v_lshlrev_b32 v26, 16, v57
    v_and_b32 v27, 0xffff0000, v57
    v_lshlrev_b32 v28, 16, v58
    v_and_b32 v29, 0xffff0000, v58
    v_lshlrev_b32 v30, 16, v59
    v_and_b32 v31, 0xffff0000, v59
    v_pk_add_f32 v[24:25], v[24:25], v[152:153]
    v_pk_add_f32 v[26:27], v[26:27], v[154:155]
    v_pk_add_f32 v[28:29], v[28:29], v[156:157]
    v_pk_add_f32 v[30:31], v[30:31], v[158:159]
    v_cvt_pk_bf16_f32 v56, v24, v25
    v_cvt_pk_bf16_f32 v57, v26, v27
    v_cvt_pk_bf16_f32 v58, v28, v29
    v_cvt_pk_bf16_f32 v59, v30, v31
    s_mov_b32 s84, 65536
    buffer_store_dwordx4 v[56:59], v13, s[72:75], s84 offen
    v_lshlrev_b32 v160, 16, v132
    v_and_b32 v161, 0xffff0000, v132
    v_lshlrev_b32 v162, 16, v133
    v_and_b32 v163, 0xffff0000, v133
    v_lshlrev_b32 v164, 16, v134
    v_and_b32 v165, 0xffff0000, v134
    v_lshlrev_b32 v166, 16, v135
    v_and_b32 v167, 0xffff0000, v135
    s_waitcnt lgkmcnt(0)
    v_lshlrev_b32 v24, 16, v60
    v_and_b32 v25, 0xffff0000, v60
    v_lshlrev_b32 v26, 16, v61
    v_and_b32 v27, 0xffff0000, v61
    v_lshlrev_b32 v28, 16, v62
    v_and_b32 v29, 0xffff0000, v62
    v_lshlrev_b32 v30, 16, v63
    v_and_b32 v31, 0xffff0000, v63
    v_pk_add_f32 v[24:25], v[24:25], v[160:161]
    v_pk_add_f32 v[26:27], v[26:27], v[162:163]
    v_pk_add_f32 v[28:29], v[28:29], v[164:165]
    v_pk_add_f32 v[30:31], v[30:31], v[166:167]
    v_cvt_pk_bf16_f32 v60, v24, v25
    v_cvt_pk_bf16_f32 v61, v26, v27
    v_cvt_pk_bf16_f32 v62, v28, v29
    v_cvt_pk_bf16_f32 v63, v30, v31
    s_mov_b32 s84, 98304
    buffer_store_dwordx4 v[60:63], v13, s[72:75], s84 offen
L_fin:
L_end:
    s_endpgm
L_code_end:
.section .rodata,"a"
.p2align 6
.amdhsa_kernel recurrent_scan__sliding_local_dilated__glu_gated_geglu__prompt_kernel
  .amdhsa_next_free_vgpr 256
  .amdhsa_next_free_sgpr 102
  .amdhsa_accum_offset 256
  .amdhsa_group_segment_fixed_size 0
  .amdhsa_kernarg_size 80
  .amdhsa_user_sgpr_count 2
  .amdhsa_user_sgpr_kernarg_segment_ptr 1
  .amdhsa_system_sgpr_workgroup_id_x 1
.end_amdhsa_kernel
```

```asm
; @launch grid=(256,1,1) block=(512,1,1) lds=163840
.amdgcn_target "amdgcn-amd-amdhsa--gfx950"
.text
.globl recurrent_scan__sliding_local_dilated__glu_gated_geglu__prompt_kernel
.p2align 12
.p2align 8
.type recurrent_scan__sliding_local_dilated__glu_gated_geglu__prompt_kernel,@function
recurrent_scan__sliding_local_dilated__glu_gated_geglu__prompt_kernel:
    s_cmp_ge_u32 s2, 256
    s_cbranch_scc1 L_end
    s_load_dwordx4 s[8:11], s[0:1], 0
    s_load_dwordx2 s[12:13], s[0:1], 16
    s_load_dwordx4 s[16:19], s[0:1], 32
    s_load_dwordx4 s[20:23], s[0:1], 48
    s_load_dwordx4 s[24:27], s[0:1], 64
    v_lshrrev_b32 v3, 6, v0
    v_and_b32 v1, 63, v0
    v_readfirstlane_b32 s3, v3
    s_and_b32 s84, s2, 7
    s_lshr_b32 s85, s2, 3
    s_mov_b32 s15, s85
    s_and_b32 s32, s84, 1
    s_lshl_b32 s86, s32, 3
    s_and_b32 s87, s85, 7
    s_add_u32 s28, s86, s87
    s_lshr_b32 s86, s84, 1
    s_lshl_b32 s86, s86, 2
    s_lshr_b32 s87, s85, 3
    s_add_u32 s29, s86, s87
    s_lshl_b32 s87, s32, 3
    s_xor_b32 s86, s86, s87
    s_and_b32 s87, s85, 3
    s_add_u32 s30, s86, s87
    s_lshr_b32 s31, s85, 2
    s_and_b32 s4, s3, 3
    s_lshr_b32 s5, s4, 1
    s_and_b32 s6, s4, 1
    s_lshr_b32 s7, s3, 2
    s_lshl_b32 s33, s4, 10
    s_mov_b64 exec, 0
    s_cmp_eq_u32 s3, 5
    s_cbranch_scc1 L_fan5
    s_cmp_eq_u32 s3, 6
    s_cbranch_scc1 L_fan6
    s_cmp_eq_u32 s3, 7
    s_cbranch_scc1 L_fan7
    s_cmp_lg_u32 s7, 0
    s_cbranch_scc1 L_teamB
L_teamA:
    s_mov_b64 exec, -1
    v_lshrrev_b32 v64, 4, v1
    v_bfe_u32 v65, v1, 2, 2
    v_and_b32 v66, 3, v1
    v_and_b32 v67, 15, v1
    v_lshrrev_b32 v68, 3, v1
    v_and_b32 v69, 7, v1
    s_lshl_b32 s85, s28, 7
    s_lshl_b32 s86, s4, 5
    s_add_u32 s86, s85, s86
    v_add_u32 v71, s86, v68
    v_xor_b32 v70, v69, v64
    v_lshlrev_b32 v70, 4, v70
    v_lshl_add_u32 v20, v71, 11, v70
    v_xor_b32 v21, 64, v20
    v_add_u32 v21, 16384, v21
    s_lshl_b32 s79, s4, 12
    s_and_b32 s72, s28, 3
    s_bitcmp1_b32 s28, 3
    s_cselect_b32 s91, 4, 0
    s_add_u32 s72, s72, s91
    s_mul_i32 s72, s72, 256
    s_sub_u32 s72, s72, 128
    s_lshl_b32 s85, s4, 3
    s_and_b32 s86, s4, 1
    s_lshl_b32 s86, s86, 2
    v_and_b32 v70, 2, v68
    v_xor_b32 v70, v70, v69
    v_xor_b32 v70, s86, v70
    v_add_u32 v71, s85, v68
    v_mul_u32_u24 v71, 7168, v71
    v_lshl_add_u32 v22, v70, 4, v71
    v_lshrrev_b32 v71, 2, v1
    s_lshl_b32 s86, s86, 2
    v_add_u32 v71, s86, v71
    v_mul_u32_u24 v71, 7168, v71
    v_and_b32 v70, 2, v64
    v_xor_b32 v70, v70, v66
    v_lshl_add_u32 v76, v70, 4, v71
    s_and_b32 s77, s28, 3
    s_bitcmp1_b32 s28, 3
    s_cselect_b32 s91, 4, 0
    s_add_u32 s77, s77, s91
    s_mul_i32 s77, s77, 917504
    s_add_u32 s77, s77, 0xfffc8000
    s_waitcnt lgkmcnt(0)
    s_mov_b32 s36, s8
    s_mov_b32 s37, s9
    s_mov_b32 s38, 0x400000
    s_mov_b32 s39, 0x20000
    s_add_u32 m0, s79, 116736
    s_add_u32 s72, s72, 128
    s_and_b32 s78, s72, 0x7ff
    buffer_load_dwordx4 v20, s[36:39], s78 offen lds
    s_add_u32 m0, s79, 117760
    s_nop 0
    buffer_load_dwordx4 v21, s[36:39], s78 offen lds
    s_add_u32 m0, s79, 118784
    s_add_u32 s78, s78, 32768
    buffer_load_dwordx4 v20, s[36:39], s78 offen lds
    s_add_u32 m0, s79, 119808
    s_nop 0
    buffer_load_dwordx4 v21, s[36:39], s78 offen lds
    s_mul_i32 s85, s29, 320
    s_and_b32 s86, s29, 1
    s_lshl_b32 s87, s86, 6
    s_add_u32 s87, s87, s85
    s_add_u32 s40, s16, s87
    s_addc_u32 s41, s17, 0
    s_sub_u32 s42, 7340032, s87
    s_mov_b32 s43, 0x20000
    s_add_u32 s44, s18, s87
    s_addc_u32 s45, s19, 0
    s_sub_u32 s46, 7340032, s87
    s_mov_b32 s47, 0x20000
    s_xor_b32 s86, s86, 1
    s_lshl_b32 s86, s86, 8
    s_add_u32 s87, s86, s85
    s_cmp_lt_u32 s4, 2
    s_cselect_b32 s88, s16, s18
    s_cselect_b32 s89, s17, s19
    s_add_u32 s48, s88, s87
    s_addc_u32 s49, s89, 0
    s_sub_u32 s50, 7340032, s87
    s_mov_b32 s51, 0x20000
    s_add_u32 m0, s33, 16384
    s_add_u32 s77, s77, 229376
    buffer_load_dwordx4 v22, s[40:43], s77 offen offset:0 lds
    s_add_u32 m0, s33, 20352
    s_nop 0
    buffer_load_dwordx4 v22, s[40:43], s77 offen offset:128 lds
    s_add_u32 m0, s33, 24576
    s_nop 0
    buffer_load_dwordx4 v22, s[44:47], s77 offen offset:0 lds
    s_add_u32 m0, s33, 28544
    s_nop 0
    buffer_load_dwordx4 v22, s[44:47], s77 offen offset:128 lds
    s_add_u32 m0, s33, 32768
    s_nop 0
    buffer_load_dwordx4 v76, s[48:51], s77 offen lds
    s_add_u32 m0, s33, 36864
    s_add_u32 s77, s77, 229376
    buffer_load_dwordx4 v22, s[40:43], s77 offen offset:0 lds
    s_add_u32 m0, s33, 40832
    s_nop 0
    buffer_load_dwordx4 v22, s[40:43], s77 offen offset:128 lds
    s_add_u32 m0, s33, 45056
    s_nop 0
    buffer_load_dwordx4 v22, s[44:47], s77 offen offset:0 lds
    s_add_u32 m0, s33, 49024
    s_nop 0
    buffer_load_dwordx4 v22, s[44:47], s77 offen offset:128 lds
    s_add_u32 m0, s33, 53248
    s_nop 0
    buffer_load_dwordx4 v76, s[48:51], s77 offen lds
    s_mov_b32 s68, s26
    s_mov_b32 s69, s27
    s_mov_b32 s70, 0x10000000
    s_mov_b32 s71, 0x20000
    s_getpc_b64 s[92:93]
L_pc:
    s_lshl2_add_u32 s91, s15, s4
    s_lshl_b32 s91, s91, 9
    s_min_u32 s91, s91, L_code_end - L_pc - 512
    s_load_dword s94, s[92:93], s91 offset:0
    s_load_dword s94, s[92:93], s91 offset:64
    s_load_dword s94, s[92:93], s91 offset:128
    s_load_dword s94, s[92:93], s91 offset:192
    s_load_dword s94, s[92:93], s91 offset:256
    s_load_dword s94, s[92:93], s91 offset:320
    s_load_dword s94, s[92:93], s91 offset:384
    s_load_dword s94, s[92:93], s91 offset:448
    v_lshrrev_b32 v64, 4, v1
    v_bfe_u32 v65, v1, 2, 2
    v_and_b32 v66, 3, v1
    v_and_b32 v67, 15, v1
    v_lshrrev_b32 v68, 3, v1
    v_and_b32 v69, 7, v1
    s_lshl_b32 s85, s6, 12
    s_add_u32 s85, s85, 16384
    v_lshl_add_u32 v70, v64, 3, v65
    v_lshlrev_b32 v70, 7, v70
    v_and_b32 v71, 1, v66
    v_lshl_add_u32 v70, v71, 3, v70
    v_add_u32 v70, s85, v70
    v_and_b32 v71, 2, v65
    v_and_b32 v72, 1, v64
    v_lshl_add_u32 v71, v72, 2, v71
    v_lshrrev_b32 v72, 1, v66
    v_xor_b32 v71, v71, v72
    v_xor_b32 v72, 0, v71
    v_lshl_add_u32 v4, v72, 4, v70
    v_add_u32 v9, 40960, v4
    v_xor_b32 v72, 2, v71
    v_lshl_add_u32 v5, v72, 4, v70
    v_add_u32 v10, 40960, v5
    v_xor_b32 v72, 4, v71
    v_lshl_add_u32 v6, v72, 4, v70
    v_add_u32 v11, 40960, v6
    v_xor_b32 v72, 6, v71
    v_lshl_add_u32 v7, v72, 4, v70
    v_add_u32 v12, 40960, v7
    v_lshl_add_u32 v70, v64, 3, v65
    v_lshlrev_b32 v70, 6, v70
    v_and_b32 v71, 1, v66
    v_lshl_add_u32 v70, v71, 3, v70
    v_and_b32 v71, 1, v64
    v_xor_b32 v71, s6, v71
    v_lshl_add_u32 v70, v71, 5, v70
    v_lshrrev_b32 v71, 1, v66
    v_lshl_add_u32 v70, v71, 4, v70
    v_add_u32 v8, 16384, v70
    v_add_u32 v13, 57344, v70
    v_lshrrev_b32 v70, 1, v67
    v_xor_b32 v70, v70, v64
    v_lshlrev_b32 v70, 4, v70
    v_lshl_add_u32 v70, v67, 7, v70
    s_lshl_b32 s85, s5, 13
    v_add_u32 v16, s85, v70
    v_xor_b32 v17, 64, v16
    s_mov_b32 s80, 116736
    s_lshl_b32 s86, s28, 7
    s_sub_u32 s86, s86, 16
    s_max_i32 s86, s86, 0
    s_lshl_b32 s87, s4, 2
    v_add_u32 v71, s87, v68
    v_lshrrev_b32 v70, 1, v71
    v_and_b32 v70, 7, v70
    v_xor_b32 v70, v70, v69
    v_lshlrev_b32 v70, 4, v70
    v_add_u32 v71, s86, v71
    v_lshl_add_u32 v3, v71, 11, v70
    s_lshl_b32 s81, s4, 9
    s_lshl_b32 s85, s4, 3
    s_and_b32 s86, s4, 1
    s_lshl_b32 s86, s86, 2
    v_and_b32 v70, 2, v68
    v_xor_b32 v70, v70, v69
    v_xor_b32 v70, s86, v70
    v_add_u32 v71, s85, v68
    v_mul_u32_u24 v71, 6144, v71
    v_lshl_add_u32 v23, v70, 4, v71
    s_lshl_b32 s85, s6, 2
    v_lshl_add_u32 v70, v64, 3, v65
    v_lshlrev_b32 v70, 7, v70
    v_and_b32 v71, 1, v66
    v_lshl_add_u32 v70, v71, 3, v70
    v_add_u32 v70, 0, v70
    v_and_b32 v71, 2, v65
    v_and_b32 v72, 1, v64
    v_lshl_add_u32 v71, v72, 2, v71
    v_lshrrev_b32 v72, 1, v66
    v_xor_b32 v71, v71, v72
    v_xor_b32 v71, s85, v71
    v_xor_b32 v72, 0, v71
    v_lshl_add_u32 v250, v72, 4, v70
    v_add_u32 v252, 65536, v250
    v_xor_b32 v72, 2, v71
    v_lshl_add_u32 v251, v72, 4, v70
    v_add_u32 v253, 65536, v251
    s_lshl_b32 s85, s5, 12
    v_lshl_add_u32 v248, v1, 4, s85
    v_add_u32 v249, 65536, v248
    s_lshl_b32 s85, s4, 12
    v_lshl_add_u32 v18, v1, 4, s85
    s_lshl_b32 s85, s4, 4
    v_and_b32 v70, 2, v68
    v_xor_b32 v70, v70, v69
    v_xor_b32 v70, 0, v70
    v_add_u32 v71, s85, v68
    v_mul_u32_u24 v71, 2048, v71
    v_lshl_add_u32 v254, v70, 4, v71
    s_add_u32 s85, s85, 8
    v_and_b32 v70, 2, v68
    v_xor_b32 v70, v70, v69
    v_xor_b32 v70, 4, v70
    v_add_u32 v71, s85, v68
    v_mul_u32_u24 v71, 2048, v71
    v_lshl_add_u32 v255, v70, 4, v71
    s_lshl_b32 s85, s31, 8
    s_lshl_b32 s86, s32, 7
    s_add_u32 s86, s85, s86
    s_xor_b32 s87, s86, 128
    s_lshr_b32 s91, s31, 2
    s_lshl1_add_u32 s91, s91, s32
    s_lshl_b32 s91, s91, 13
    s_add_u32 s91, s91, 0x2000000
    s_xor_b32 s85, s91, 8192
    s_and_b32 s92, s31, 3
    s_cmp_eq_u32 s92, 1
    s_cselect_b32 s86, s91, s86
    s_cselect_b32 s87, s85, s87
    s_cselect_b32 s91, 0x2a00000, 0
    s_cselect_b32 s92, s26, s20
    s_cselect_b32 s93, s27, s21
    s_max_u32 s91, s91, 7340032
    s_add_u32 s60, s92, s86
    s_addc_u32 s61, s93, 0
    s_sub_u32 s62, s91, s86
    s_mov_b32 s63, 0x20000
    s_add_u32 s64, s92, s87
    s_addc_u32 s65, s93, 0
    s_sub_u32 s66, s91, s87
    s_mov_b32 s67, 0x20000
    s_add_u32 s56, s26, 0x400000
    s_addc_u32 s57, s27, 0
    s_mov_b32 s58, 0xe00000
    s_mov_b32 s59, 0x20000
    s_mul_i32 s82, s30, 917504
    s_mul_i32 s85, s32, 327680
    s_add_u32 s82, s82, s85
    s_mul_i32 s83, s32, 2621440
    s_mul_i32 s85, s32, 10
    s_sub_u32 s85, 40, s85
    s_lshl_b32 s14, s85, 13
    s_lshl_b32 s35, s85, 16
    s_and_b32 s85, s31, 3
    s_cmp_eq_u32 s85, 1
    s_cselect_b64 vcc, -1, 0
    s_lshl_b32 s85, s4, 11
    v_lshl_add_u32 v70, v1, 4, s85
    v_add_u32 v71, 1024, v70
    v_cndmask_b32 v254, v254, v70, vcc
    v_cndmask_b32 v255, v255, v71, vcc
    v_lshrrev_b32 v78, 4, v1
    v_and_b32 v79, 1, v78
    v_lshrrev_b32 v78, 1, v78
    v_lshlrev_b32 v78, 8, v78
    v_lshl_add_u32 v78, v79, 10, v78
    v_and_b32 v79, 15, v1
    v_lshl_add_u32 v19, v79, 4, v78
    s_mul_i32 s84, s28, 112
    s_mul_i32 s85, s29, 5
    s_add_u32 s84, s84, s85
    s_lshl_b32 s84, s84, 13
    s_lshl_b32 s85, s5, 12
    s_add_u32 s84, s84, s85
    s_add_u32 s84, s84, 0x400000
    s_and_b32 s85, s29, 1
    s_lshl1_add_u32 s86, s6, s85
    s_lshl_b32 s86, s86, 13
    s_add_u32 s72, s84, s86
    s_add_u32 s73, s72, 8192
    s_xor_b32 s85, s85, 1
    s_lshl_b32 s85, s85, 15
    s_add_u32 s84, s84, s85
    s_lshl_b32 s85, s6, 9
    s_add_u32 s74, s84, s85
    s_lshl2_add_u32 s91, s2, s4
    s_lshl_b32 s75, s91, 9
    s_lshr_b32 s92, s91, 2
    s_mul_i32 s92, s92, 7168
    s_and_b32 s91, s91, 3
    s_lshl_b32 s91, s91, 9
    s_add_u32 s92, s92, s91
    s_add_u32 s99, s92, 5120
    s_mov_b32 s36, s26
    s_mov_b32 s37, s27
    s_mov_b32 s38, 0x400000
    s_mov_b32 s39, 0x20000
    s_lshl_b32 s85, s29, 7
    s_add_u32 s40, s10, s85
    s_addc_u32 s41, s11, 0
    s_sub_u32 s42, 6291456, s85
    s_mov_b32 s43, 0x20000
    s_add_u32 s86, s85, 4096
    s_add_u32 s44, s10, s86
    s_addc_u32 s45, s11, 0
    s_sub_u32 s46, 6291456, s86
    s_mov_b32 s47, 0x20000
    s_add_u32 s86, s85, 128
    s_and_b32 s86, s86, 0x7ff
    s_add_u32 s86, s86, 5120
    s_add_u32 s48, s16, s86
    s_addc_u32 s49, s17, 0
    s_sub_u32 s50, 7340032, s86
    s_mov_b32 s51, 0x20000
    s_add_u32 s52, s18, s86
    s_addc_u32 s53, s19, 0
    s_sub_u32 s54, 7340032, s86
    s_mov_b32 s55, 0x20000
    s_mov_b64 exec, 0
    s_cmp_eq_u32 s4, 0
    s_cbranch_scc1 L_pad6
    s_cmp_eq_u32 s4, 1
    s_cbranch_scc1 L_pad7
    s_cmp_eq_u32 s4, 2
    s_cbranch_scc1 L_pad0
    s_cmp_eq_u32 s4, 3
    s_cbranch_scc1 L_pad8
L_vret0:
    s_mov_b64 exec, -1
    s_mov_b64 exec, 0
    s_cmp_eq_u32 s4, 0
    s_cbranch_scc1 L_pad9
    s_cmp_eq_u32 s4, 1
    s_cbranch_scc1 L_pad1
    s_cmp_eq_u32 s4, 2
    s_cbranch_scc1 L_pad2
    s_cmp_eq_u32 s4, 3
    s_cbranch_scc1 L_pad3
L_vret1:
    s_mov_b64 exec, -1
    s_setprio 1
    s_waitcnt vmcnt(5)
    s_barrier
    v_add_u32 v14, s80, v16
    v_add_u32 v15, s80, v17
    s_add_u32 s80, s80, 18432
    s_cmp_ge_u32 s80, 153600
    s_cselect_b32 s84, 55296, 0
    s_sub_u32 s80, s80, s84
    ds_read_b64_tr_b16 v[64:65], v4 offset:0
    ds_read_b64_tr_b16 v[66:67], v4 offset:512
    ds_read_b128 v[24:27], v14 offset:0
    ds_read_b128 v[28:31], v14 offset:2048
    ds_read_b128 v[32:35], v14 offset:4096
    ds_read_b128 v[36:39], v14 offset:6144
    ds_read_b64_tr_b16 v[68:69], v4 offset:8192
    ds_read_b64_tr_b16 v[70:71], v4 offset:8704
    ds_read_b64_tr_b16 v[72:73], v5 offset:0
    ds_read_b64_tr_b16 v[74:75], v5 offset:512
    s_waitcnt lgkmcnt(7)
    v_mfma_f32_16x16x32_bf16 v[88:91], v[64:67], v[24:27], 0
    ds_read_b64_tr_b16 v[76:77], v5 offset:8192
    s_waitcnt lgkmcnt(7)
    v_mfma_f32_16x16x32_bf16 v[92:95], v[64:67], v[28:31], 0
    ds_read_b64_tr_b16 v[78:79], v5 offset:8704
    s_waitcnt lgkmcnt(7)
    v_mfma_f32_16x16x32_bf16 v[96:99], v[64:67], v[32:35], 0
    ds_read_b64_tr_b16 v[80:81], v6 offset:0
    s_waitcnt lgkmcnt(7)
    v_mfma_f32_16x16x32_bf16 v[100:103], v[64:67], v[36:39], 0
    ds_read_b64_tr_b16 v[82:83], v6 offset:512
    s_waitcnt lgkmcnt(6)
    v_mfma_f32_16x16x32_bf16 v[104:107], v[68:71], v[24:27], 0
    ds_read_b64_tr_b16 v[64:65], v6 offset:8192
    v_mfma_f32_16x16x32_bf16 v[108:111], v[68:71], v[28:31], 0
    v_mfma_f32_16x16x32_bf16 v[112:115], v[68:71], v[32:35], 0
    ds_read_b64_tr_b16 v[66:67], v6 offset:8704
    v_mfma_f32_16x16x32_bf16 v[116:119], v[68:71], v[36:39], 0
    s_waitcnt lgkmcnt(6)
    v_mfma_f32_16x16x32_bf16 v[120:123], v[72:75], v[24:27], 0
    ds_read_b64_tr_b16 v[68:69], v7 offset:0
    v_mfma_f32_16x16x32_bf16 v[124:127], v[72:75], v[28:31], 0
    v_mfma_f32_16x16x32_bf16 v[128:131], v[72:75], v[32:35], 0
    ds_read_b64_tr_b16 v[70:71], v7 offset:512
    v_mfma_f32_16x16x32_bf16 v[132:135], v[72:75], v[36:39], 0
    s_waitcnt lgkmcnt(6)
    v_mfma_f32_16x16x32_bf16 v[136:139], v[76:79], v[24:27], 0
    ds_read_b64_tr_b16 v[72:73], v7 offset:8192
    v_mfma_f32_16x16x32_bf16 v[140:143], v[76:79], v[28:31], 0
    v_mfma_f32_16x16x32_bf16 v[144:147], v[76:79], v[32:35], 0
    ds_read_b64_tr_b16 v[74:75], v7 offset:8704
    v_mfma_f32_16x16x32_bf16 v[148:151], v[76:79], v[36:39], 0
    s_waitcnt lgkmcnt(6)
    v_mfma_f32_16x16x32_bf16 v[152:155], v[80:83], v[24:27], 0
    ds_read_b64_tr_b16 v[76:77], v8 offset:16384
    v_mfma_f32_16x16x32_bf16 v[156:159], v[80:83], v[28:31], 0
    v_mfma_f32_16x16x32_bf16 v[160:163], v[80:83], v[32:35], 0
    ds_read_b64_tr_b16 v[78:79], v8 offset:16640
    v_mfma_f32_16x16x32_bf16 v[164:167], v[80:83], v[36:39], 0
    s_waitcnt lgkmcnt(6)
    v_mfma_f32_16x16x32_bf16 v[168:171], v[64:67], v[24:27], 0
    ds_read_b64_tr_b16 v[80:81], v8 offset:18432
    v_mfma_f32_16x16x32_bf16 v[172:175], v[64:67], v[28:31], 0
    v_mfma_f32_16x16x32_bf16 v[176:179], v[64:67], v[32:35], 0
    ds_read_b64_tr_b16 v[82:83], v8 offset:18688
    v_mfma_f32_16x16x32_bf16 v[180:183], v[64:67], v[36:39], 0
    s_waitcnt lgkmcnt(6)
    v_mfma_f32_16x16x32_bf16 v[184:187], v[68:71], v[24:27], 0
    v_mfma_f32_16x16x32_bf16 v[188:191], v[68:71], v[28:31], 0
    v_mfma_f32_16x16x32_bf16 v[192:195], v[68:71], v[32:35], 0
    v_mfma_f32_16x16x32_bf16 v[196:199], v[68:71], v[36:39], 0
    s_waitcnt vmcnt(0) lgkmcnt(0)
    s_barrier
    v_mfma_f32_16x16x32_bf16 v[200:203], v[72:75], v[24:27], 0
    ds_read_b64_tr_b16 v[64:65], v4 offset:20480
    v_mfma_f32_16x16x32_bf16 v[204:207], v[72:75], v[28:31], 0
    ds_read_b64_tr_b16 v[66:67], v4 offset:20992
    v_mfma_f32_16x16x32_bf16 v[208:211], v[72:75], v[32:35], 0
    ds_read_b128 v[40:43], v15 offset:0
    v_mfma_f32_16x16x32_bf16 v[212:215], v[72:75], v[36:39], 0
    ds_read_b128 v[44:47], v15 offset:2048
    v_mfma_f32_16x16x32_bf16 v[216:219], v[76:79], v[24:27], 0
    ds_read_b128 v[48:51], v15 offset:4096
    v_mfma_f32_16x16x32_bf16 v[220:223], v[76:79], v[28:31], 0
    ds_read_b128 v[52:55], v15 offset:6144
    v_mfma_f32_16x16x32_bf16 v[224:227], v[76:79], v[32:35], 0
    ds_read_b64_tr_b16 v[68:69], v4 offset:28672
    v_mfma_f32_16x16x32_bf16 v[228:231], v[76:79], v[36:39], 0
    ds_read_b64_tr_b16 v[70:71], v4 offset:29184
    v_mfma_f32_16x16x32_bf16 v[232:235], v[80:83], v[24:27], 0
    ds_read_b64_tr_b16 v[72:73], v5 offset:20480
    v_mfma_f32_16x16x32_bf16 v[236:239], v[80:83], v[28:31], 0
    v_mfma_f32_16x16x32_bf16 v[240:243], v[80:83], v[32:35], 0
    ds_read_b64_tr_b16 v[74:75], v5 offset:20992
    v_mfma_f32_16x16x32_bf16 v[244:247], v[80:83], v[36:39], 0
    s_waitcnt lgkmcnt(7)
    v_mfma_f32_16x16x32_bf16 v[88:91], v[64:67], v[40:43], v[88:91]
    ds_read_b64_tr_b16 v[76:77], v5 offset:28672
    s_waitcnt lgkmcnt(7)
    v_mfma_f32_16x16x32_bf16 v[92:95], v[64:67], v[44:47], v[92:95]
    ds_read_b64_tr_b16 v[78:79], v5 offset:29184
    s_waitcnt lgkmcnt(7)
    v_mfma_f32_16x16x32_bf16 v[96:99], v[64:67], v[48:51], v[96:99]
    ds_read_b64_tr_b16 v[80:81], v6 offset:20480
    s_waitcnt lgkmcnt(7)
    v_mfma_f32_16x16x32_bf16 v[100:103], v[64:67], v[52:55], v[100:103]
    ds_read_b64_tr_b16 v[82:83], v6 offset:20992
    s_waitcnt lgkmcnt(6)
    v_mfma_f32_16x16x32_bf16 v[104:107], v[68:71], v[40:43], v[104:107]
    ds_read_b64_tr_b16 v[64:65], v6 offset:28672
    v_mfma_f32_16x16x32_bf16 v[108:111], v[68:71], v[44:47], v[108:111]
    v_add_u32 v14, s80, v16
    v_mfma_f32_16x16x32_bf16 v[112:115], v[68:71], v[48:51], v[112:115]
    ds_read_b64_tr_b16 v[66:67], v6 offset:29184
    v_mfma_f32_16x16x32_bf16 v[116:119], v[68:71], v[52:55], v[116:119]
    v_add_u32 v15, s80, v17
    s_waitcnt lgkmcnt(6)
    v_mfma_f32_16x16x32_bf16 v[120:123], v[72:75], v[40:43], v[120:123]
    ds_read_b64_tr_b16 v[68:69], v7 offset:20480
    v_mfma_f32_16x16x32_bf16 v[124:127], v[72:75], v[44:47], v[124:127]
    s_add_u32 s80, s80, 18432
    v_mfma_f32_16x16x32_bf16 v[128:131], v[72:75], v[48:51], v[128:131]
    ds_read_b64_tr_b16 v[70:71], v7 offset:20992
    v_mfma_f32_16x16x32_bf16 v[132:135], v[72:75], v[52:55], v[132:135]
    s_cmp_ge_u32 s80, 153600
    s_cselect_b32 s84, 55296, 0
    s_waitcnt lgkmcnt(6)
    v_mfma_f32_16x16x32_bf16 v[136:139], v[76:79], v[40:43], v[136:139]
    ds_read_b64_tr_b16 v[72:73], v7 offset:28672
    v_mfma_f32_16x16x32_bf16 v[140:143], v[76:79], v[44:47], v[140:143]
    s_sub_u32 s80, s80, s84
    v_mfma_f32_16x16x32_bf16 v[144:147], v[76:79], v[48:51], v[144:147]
    ds_read_b64_tr_b16 v[74:75], v7 offset:29184
    v_mfma_f32_16x16x32_bf16 v[148:151], v[76:79], v[52:55], v[148:151]
    s_waitcnt lgkmcnt(6)
    v_mfma_f32_16x16x32_bf16 v[152:155], v[80:83], v[40:43], v[152:155]
    ds_read_b64_tr_b16 v[76:77], v8 offset:36864
    v_mfma_f32_16x16x32_bf16 v[156:159], v[80:83], v[44:47], v[156:159]
    v_mfma_f32_16x16x32_bf16 v[160:163], v[80:83], v[48:51], v[160:163]
    ds_read_b64_tr_b16 v[78:79], v8 offset:37120
    v_mfma_f32_16x16x32_bf16 v[164:167], v[80:83], v[52:55], v[164:167]
    s_waitcnt lgkmcnt(6)
    v_mfma_f32_16x16x32_bf16 v[168:171], v[64:67], v[40:43], v[168:171]
    ds_read_b64_tr_b16 v[80:81], v8 offset:38912
    v_mfma_f32_16x16x32_bf16 v[172:175], v[64:67], v[44:47], v[172:175]
    v_mfma_f32_16x16x32_bf16 v[176:179], v[64:67], v[48:51], v[176:179]
    ds_read_b64_tr_b16 v[82:83], v8 offset:39168
    v_mfma_f32_16x16x32_bf16 v[180:183], v[64:67], v[52:55], v[180:183]
    s_waitcnt lgkmcnt(6)
    v_mfma_f32_16x16x32_bf16 v[184:187], v[68:71], v[40:43], v[184:187]
    v_mfma_f32_16x16x32_bf16 v[188:191], v[68:71], v[44:47], v[188:191]
    v_mfma_f32_16x16x32_bf16 v[192:195], v[68:71], v[48:51], v[192:195]
    v_mfma_f32_16x16x32_bf16 v[196:199], v[68:71], v[52:55], v[196:199]
    s_waitcnt lgkmcnt(0)
    s_barrier
    v_mfma_f32_16x16x32_bf16 v[200:203], v[72:75], v[40:43], v[200:203]
    ds_read_b64_tr_b16 v[64:65], v9 offset:0
    v_mfma_f32_16x16x32_bf16 v[204:207], v[72:75], v[44:47], v[204:207]
    ds_read_b64_tr_b16 v[66:67], v9 offset:512
    v_mfma_f32_16x16x32_bf16 v[208:211], v[72:75], v[48:51], v[208:211]
    ds_read_b128 v[24:27], v14 offset:0
    v_mfma_f32_16x16x32_bf16 v[212:215], v[72:75], v[52:55], v[212:215]
    ds_read_b128 v[28:31], v14 offset:2048
    v_mfma_f32_16x16x32_bf16 v[216:219], v[76:79], v[40:43], v[216:219]
    ds_read_b128 v[32:35], v14 offset:4096
    v_mfma_f32_16x16x32_bf16 v[220:223], v[76:79], v[44:47], v[220:223]
    ds_read_b128 v[36:39], v14 offset:6144
    v_mfma_f32_16x16x32_bf16 v[224:227], v[76:79], v[48:51], v[224:227]
    ds_read_b64_tr_b16 v[68:69], v9 offset:8192
    v_mfma_f32_16x16x32_bf16 v[228:231], v[76:79], v[52:55], v[228:231]
    ds_read_b64_tr_b16 v[70:71], v9 offset:8704
    v_mfma_f32_16x16x32_bf16 v[232:235], v[80:83], v[40:43], v[232:235]
    ds_read_b64_tr_b16 v[72:73], v10 offset:0
    v_mfma_f32_16x16x32_bf16 v[236:239], v[80:83], v[44:47], v[236:239]
    v_mfma_f32_16x16x32_bf16 v[240:243], v[80:83], v[48:51], v[240:243]
    ds_read_b64_tr_b16 v[74:75], v10 offset:512
    v_mfma_f32_16x16x32_bf16 v[244:247], v[80:83], v[52:55], v[244:247]
    s_waitcnt lgkmcnt(7)
    v_mfma_f32_16x16x32_bf16 v[88:91], v[64:67], v[24:27], v[88:91]
    ds_read_b64_tr_b16 v[76:77], v10 offset:8192
    s_waitcnt lgkmcnt(7)
    v_mfma_f32_16x16x32_bf16 v[92:95], v[64:67], v[28:31], v[92:95]
    ds_read_b64_tr_b16 v[78:79], v10 offset:8704
    s_waitcnt lgkmcnt(7)
    v_mfma_f32_16x16x32_bf16 v[96:99], v[64:67], v[32:35], v[96:99]
    ds_read_b64_tr_b16 v[80:81], v11 offset:0
    s_waitcnt lgkmcnt(7)
    v_mfma_f32_16x16x32_bf16 v[100:103], v[64:67], v[36:39], v[100:103]
    ds_read_b64_tr_b16 v[82:83], v11 offset:512
    s_waitcnt lgkmcnt(6)
    v_mfma_f32_16x16x32_bf16 v[104:107], v[68:71], v[24:27], v[104:107]
    ds_read_b64_tr_b16 v[64:65], v11 offset:8192
    v_mfma_f32_16x16x32_bf16 v[108:111], v[68:71], v[28:31], v[108:111]
    v_mfma_f32_16x16x32_bf16 v[112:115], v[68:71], v[32:35], v[112:115]
    ds_read_b64_tr_b16 v[66:67], v11 offset:8704
    v_mfma_f32_16x16x32_bf16 v[116:119], v[68:71], v[36:39], v[116:119]
    s_waitcnt lgkmcnt(6)
    v_mfma_f32_16x16x32_bf16 v[120:123], v[72:75], v[24:27], v[120:123]
    ds_read_b64_tr_b16 v[68:69], v12 offset:0
    v_mfma_f32_16x16x32_bf16 v[124:127], v[72:75], v[28:31], v[124:127]
    v_mfma_f32_16x16x32_bf16 v[128:131], v[72:75], v[32:35], v[128:131]
    ds_read_b64_tr_b16 v[70:71], v12 offset:512
    v_mfma_f32_16x16x32_bf16 v[132:135], v[72:75], v[36:39], v[132:135]
    s_waitcnt lgkmcnt(6)
    v_mfma_f32_16x16x32_bf16 v[136:139], v[76:79], v[24:27], v[136:139]
    ds_read_b64_tr_b16 v[72:73], v12 offset:8192
    v_mfma_f32_16x16x32_bf16 v[140:143], v[76:79], v[28:31], v[140:143]
    v_mfma_f32_16x16x32_bf16 v[144:147], v[76:79], v[32:35], v[144:147]
    ds_read_b64_tr_b16 v[74:75], v12 offset:8704
    v_mfma_f32_16x16x32_bf16 v[148:151], v[76:79], v[36:39], v[148:151]
    s_waitcnt lgkmcnt(6)
    v_mfma_f32_16x16x32_bf16 v[152:155], v[80:83], v[24:27], v[152:155]
    ds_read_b64_tr_b16 v[76:77], v13 offset:16384
    v_mfma_f32_16x16x32_bf16 v[156:159], v[80:83], v[28:31], v[156:159]
    v_mfma_f32_16x16x32_bf16 v[160:163], v[80:83], v[32:35], v[160:163]
    ds_read_b64_tr_b16 v[78:79], v13 offset:16640
    v_mfma_f32_16x16x32_bf16 v[164:167], v[80:83], v[36:39], v[164:167]
    s_waitcnt lgkmcnt(6)
    v_mfma_f32_16x16x32_bf16 v[168:171], v[64:67], v[24:27], v[168:171]
    ds_read_b64_tr_b16 v[80:81], v13 offset:18432
    v_mfma_f32_16x16x32_bf16 v[172:175], v[64:67], v[28:31], v[172:175]
    v_mfma_f32_16x16x32_bf16 v[176:179], v[64:67], v[32:35], v[176:179]
    ds_read_b64_tr_b16 v[82:83], v13 offset:18688
    v_mfma_f32_16x16x32_bf16 v[180:183], v[64:67], v[36:39], v[180:183]
    s_waitcnt lgkmcnt(6)
    v_mfma_f32_16x16x32_bf16 v[184:187], v[68:71], v[24:27], v[184:187]
    v_mfma_f32_16x16x32_bf16 v[188:191], v[68:71], v[28:31], v[188:191]
    v_mfma_f32_16x16x32_bf16 v[192:195], v[68:71], v[32:35], v[192:195]
    v_mfma_f32_16x16x32_bf16 v[196:199], v[68:71], v[36:39], v[196:199]
    s_waitcnt lgkmcnt(0)
    s_barrier
    v_mfma_f32_16x16x32_bf16 v[200:203], v[72:75], v[24:27], v[200:203]
    ds_read_b64_tr_b16 v[64:65], v9 offset:20480
    v_mfma_f32_16x16x32_bf16 v[204:207], v[72:75], v[28:31], v[204:207]
    ds_read_b64_tr_b16 v[66:67], v9 offset:20992
    v_mfma_f32_16x16x32_bf16 v[208:211], v[72:75], v[32:35], v[208:211]
    ds_read_b128 v[40:43], v15 offset:0
    v_mfma_f32_16x16x32_bf16 v[212:215], v[72:75], v[36:39], v[212:215]
    ds_read_b128 v[44:47], v15 offset:2048
    v_mfma_f32_16x16x32_bf16 v[216:219], v[76:79], v[24:27], v[216:219]
    ds_read_b128 v[48:51], v15 offset:4096
    v_mfma_f32_16x16x32_bf16 v[220:223], v[76:79], v[28:31], v[220:223]
    ds_read_b128 v[52:55], v15 offset:6144
    v_mfma_f32_16x16x32_bf16 v[224:227], v[76:79], v[32:35], v[224:227]
    ds_read_b64_tr_b16 v[68:69], v9 offset:28672
    v_mfma_f32_16x16x32_bf16 v[228:231], v[76:79], v[36:39], v[228:231]
    ds_read_b64_tr_b16 v[70:71], v9 offset:29184
    v_mfma_f32_16x16x32_bf16 v[232:235], v[80:83], v[24:27], v[232:235]
    ds_read_b64_tr_b16 v[72:73], v10 offset:20480
    v_mfma_f32_16x16x32_bf16 v[236:239], v[80:83], v[28:31], v[236:239]
    v_mfma_f32_16x16x32_bf16 v[240:243], v[80:83], v[32:35], v[240:243]
    ds_read_b64_tr_b16 v[74:75], v10 offset:20992
    v_mfma_f32_16x16x32_bf16 v[244:247], v[80:83], v[36:39], v[244:247]
    s_waitcnt lgkmcnt(7)
    v_mfma_f32_16x16x32_bf16 v[88:91], v[64:67], v[40:43], v[88:91]
    ds_read_b64_tr_b16 v[76:77], v10 offset:28672
    s_waitcnt lgkmcnt(7)
    v_mfma_f32_16x16x32_bf16 v[92:95], v[64:67], v[44:47], v[92:95]
    ds_read_b64_tr_b16 v[78:79], v10 offset:29184
    s_waitcnt lgkmcnt(7)
    v_mfma_f32_16x16x32_bf16 v[96:99], v[64:67], v[48:51], v[96:99]
    ds_read_b64_tr_b16 v[80:81], v11 offset:20480
    s_waitcnt lgkmcnt(7)
    v_mfma_f32_16x16x32_bf16 v[100:103], v[64:67], v[52:55], v[100:103]
    ds_read_b64_tr_b16 v[82:83], v11 offset:20992
    s_waitcnt lgkmcnt(6)
    v_mfma_f32_16x16x32_bf16 v[104:107], v[68:71], v[40:43], v[104:107]
    ds_read_b64_tr_b16 v[64:65], v11 offset:28672
    v_mfma_f32_16x16x32_bf16 v[108:111], v[68:71], v[44:47], v[108:111]
    v_add_u32 v14, s80, v16
    v_mfma_f32_16x16x32_bf16 v[112:115], v[68:71], v[48:51], v[112:115]
    ds_read_b64_tr_b16 v[66:67], v11 offset:29184
    v_mfma_f32_16x16x32_bf16 v[116:119], v[68:71], v[52:55], v[116:119]
    v_add_u32 v15, s80, v17
    s_waitcnt lgkmcnt(6)
    v_mfma_f32_16x16x32_bf16 v[120:123], v[72:75], v[40:43], v[120:123]
    ds_read_b64_tr_b16 v[68:69], v12 offset:20480
    v_mfma_f32_16x16x32_bf16 v[124:127], v[72:75], v[44:47], v[124:127]
    s_add_u32 s80, s80, 18432
    v_mfma_f32_16x16x32_bf16 v[128:131], v[72:75], v[48:51], v[128:131]
    ds_read_b64_tr_b16 v[70:71], v12 offset:20992
    v_mfma_f32_16x16x32_bf16 v[132:135], v[72:75], v[52:55], v[132:135]
    s_cmp_ge_u32 s80, 153600
    s_cselect_b32 s84, 55296, 0
    s_waitcnt lgkmcnt(6)
    v_mfma_f32_16x16x32_bf16 v[136:139], v[76:79], v[40:43], v[136:139]
    ds_read_b64_tr_b16 v[72:73], v12 offset:28672
    v_mfma_f32_16x16x32_bf16 v[140:143], v[76:79], v[44:47], v[140:143]
    s_sub_u32 s80, s80, s84
    v_mfma_f32_16x16x32_bf16 v[144:147], v[76:79], v[48:51], v[144:147]
    ds_read_b64_tr_b16 v[74:75], v12 offset:29184
    v_mfma_f32_16x16x32_bf16 v[148:151], v[76:79], v[52:55], v[148:151]
    s_waitcnt lgkmcnt(6)
    v_mfma_f32_16x16x32_bf16 v[152:155], v[80:83], v[40:43], v[152:155]
    ds_read_b64_tr_b16 v[76:77], v13 offset:36864
    v_mfma_f32_16x16x32_bf16 v[156:159], v[80:83], v[44:47], v[156:159]
    v_mfma_f32_16x16x32_bf16 v[160:163], v[80:83], v[48:51], v[160:163]
    ds_read_b64_tr_b16 v[78:79], v13 offset:37120
    v_mfma_f32_16x16x32_bf16 v[164:167], v[80:83], v[52:55], v[164:167]
    s_waitcnt lgkmcnt(6)
    v_mfma_f32_16x16x32_bf16 v[168:171], v[64:67], v[40:43], v[168:171]
    ds_read_b64_tr_b16 v[80:81], v13 offset:38912
    v_mfma_f32_16x16x32_bf16 v[172:175], v[64:67], v[44:47], v[172:175]
    v_mfma_f32_16x16x32_bf16 v[176:179], v[64:67], v[48:51], v[176:179]
    ds_read_b64_tr_b16 v[82:83], v13 offset:39168
    v_mfma_f32_16x16x32_bf16 v[180:183], v[64:67], v[52:55], v[180:183]
    s_waitcnt lgkmcnt(6)
    v_mfma_f32_16x16x32_bf16 v[184:187], v[68:71], v[40:43], v[184:187]
    v_mfma_f32_16x16x32_bf16 v[188:191], v[68:71], v[44:47], v[188:191]
    v_mfma_f32_16x16x32_bf16 v[192:195], v[68:71], v[48:51], v[192:195]
    v_mfma_f32_16x16x32_bf16 v[196:199], v[68:71], v[52:55], v[196:199]
    s_waitcnt lgkmcnt(0)
    s_barrier
    v_mfma_f32_16x16x32_bf16 v[200:203], v[72:75], v[40:43], v[200:203]
    ds_read_b64_tr_b16 v[64:65], v4 offset:0
    v_mfma_f32_16x16x32_bf16 v[204:207], v[72:75], v[44:47], v[204:207]
    ds_read_b64_tr_b16 v[66:67], v4 offset:512
    v_mfma_f32_16x16x32_bf16 v[208:211], v[72:75], v[48:51], v[208:211]
    ds_read_b128 v[24:27], v14 offset:0
    v_mfma_f32_16x16x32_bf16 v[212:215], v[72:75], v[52:55], v[212:215]
    ds_read_b128 v[28:31], v14 offset:2048
    v_mfma_f32_16x16x32_bf16 v[216:219], v[76:79], v[40:43], v[216:219]
    ds_read_b128 v[32:35], v14 offset:4096
    v_mfma_f32_16x16x32_bf16 v[220:223], v[76:79], v[44:47], v[220:223]
    ds_read_b128 v[36:39], v14 offset:6144
    v_mfma_f32_16x16x32_bf16 v[224:227], v[76:79], v[48:51], v[224:227]
    ds_read_b64_tr_b16 v[68:69], v4 offset:8192
    v_mfma_f32_16x16x32_bf16 v[228:231], v[76:79], v[52:55], v[228:231]
    ds_read_b64_tr_b16 v[70:71], v4 offset:8704
    v_mfma_f32_16x16x32_bf16 v[232:235], v[80:83], v[40:43], v[232:235]
    ds_read_b64_tr_b16 v[72:73], v5 offset:0
    v_mfma_f32_16x16x32_bf16 v[236:239], v[80:83], v[44:47], v[236:239]
    v_mfma_f32_16x16x32_bf16 v[240:243], v[80:83], v[48:51], v[240:243]
    ds_read_b64_tr_b16 v[74:75], v5 offset:512
    v_mfma_f32_16x16x32_bf16 v[244:247], v[80:83], v[52:55], v[244:247]
    s_or_b32 s91, s2, s4
    s_cbranch_scc1 L_notok
    s_memrealtime s[92:93]
    v_mov_b32 v60, 0
    s_waitcnt lgkmcnt(0)
    s_or_b32 s92, s92, 1
    v_mov_b32 v62, s92
    v_mov_b32 v63, s93
    s_mov_b64 exec, 1
    global_store_dwordx2 v60, v[62:63], s[24:25] sc1
    s_mov_b64 exec, -1
L_notok:
    s_mov_b32 s34, 6
.p2align 6
L_p1:
    s_waitcnt lgkmcnt(7)
    v_mfma_f32_16x16x32_bf16 v[88:91], v[64:67], v[24:27], v[88:91]
    ds_read_b64_tr_b16 v[76:77], v5 offset:8192
    s_waitcnt lgkmcnt(7)
    v_mfma_f32_16x16x32_bf16 v[92:95], v[64:67], v[28:31], v[92:95]
    ds_read_b64_tr_b16 v[78:79], v5 offset:8704
    s_waitcnt lgkmcnt(7)
    v_mfma_f32_16x16x32_bf16 v[96:99], v[64:67], v[32:35], v[96:99]
    ds_read_b64_tr_b16 v[80:81], v6 offset:0
    s_waitcnt lgkmcnt(7)
    v_mfma_f32_16x16x32_bf16 v[100:103], v[64:67], v[36:39], v[100:103]
    ds_read_b64_tr_b16 v[82:83], v6 offset:512
    s_waitcnt lgkmcnt(6)
    v_mfma_f32_16x16x32_bf16 v[104:107], v[68:71], v[24:27], v[104:107]
    ds_read_b64_tr_b16 v[64:65], v6 offset:8192
    v_mfma_f32_16x16x32_bf16 v[108:111], v[68:71], v[28:31], v[108:111]
    v_mfma_f32_16x16x32_bf16 v[112:115], v[68:71], v[32:35], v[112:115]
    ds_read_b64_tr_b16 v[66:67], v6 offset:8704
    v_mfma_f32_16x16x32_bf16 v[116:119], v[68:71], v[36:39], v[116:119]
    s_waitcnt lgkmcnt(6)
    v_mfma_f32_16x16x32_bf16 v[120:123], v[72:75], v[24:27], v[120:123]
    ds_read_b64_tr_b16 v[68:69], v7 offset:0
    v_mfma_f32_16x16x32_bf16 v[124:127], v[72:75], v[28:31], v[124:127]
    v_mfma_f32_16x16x32_bf16 v[128:131], v[72:75], v[32:35], v[128:131]
    ds_read_b64_tr_b16 v[70:71], v7 offset:512
    v_mfma_f32_16x16x32_bf16 v[132:135], v[72:75], v[36:39], v[132:135]
    s_waitcnt lgkmcnt(6)
    v_mfma_f32_16x16x32_bf16 v[136:139], v[76:79], v[24:27], v[136:139]
    ds_read_b64_tr_b16 v[72:73], v7 offset:8192
    v_mfma_f32_16x16x32_bf16 v[140:143], v[76:79], v[28:31], v[140:143]
    v_mfma_f32_16x16x32_bf16 v[144:147], v[76:79], v[32:35], v[144:147]
    ds_read_b64_tr_b16 v[74:75], v7 offset:8704
    v_mfma_f32_16x16x32_bf16 v[148:151], v[76:79], v[36:39], v[148:151]
    s_waitcnt lgkmcnt(6)
    v_mfma_f32_16x16x32_bf16 v[152:155], v[80:83], v[24:27], v[152:155]
    ds_read_b64_tr_b16 v[76:77], v8 offset:16384
    v_mfma_f32_16x16x32_bf16 v[156:159], v[80:83], v[28:31], v[156:159]
    v_mfma_f32_16x16x32_bf16 v[160:163], v[80:83], v[32:35], v[160:163]
    ds_read_b64_tr_b16 v[78:79], v8 offset:16640
    v_mfma_f32_16x16x32_bf16 v[164:167], v[80:83], v[36:39], v[164:167]
    s_waitcnt lgkmcnt(6)
    v_mfma_f32_16x16x32_bf16 v[168:171], v[64:67], v[24:27], v[168:171]
    ds_read_b64_tr_b16 v[80:81], v8 offset:18432
    v_mfma_f32_16x16x32_bf16 v[172:175], v[64:67], v[28:31], v[172:175]
    v_mfma_f32_16x16x32_bf16 v[176:179], v[64:67], v[32:35], v[176:179]
    ds_read_b64_tr_b16 v[82:83], v8 offset:18688
    v_mfma_f32_16x16x32_bf16 v[180:183], v[64:67], v[36:39], v[180:183]
    s_waitcnt lgkmcnt(6)
    v_mfma_f32_16x16x32_bf16 v[184:187], v[68:71], v[24:27], v[184:187]
    v_mfma_f32_16x16x32_bf16 v[188:191], v[68:71], v[28:31], v[188:191]
    v_mfma_f32_16x16x32_bf16 v[192:195], v[68:71], v[32:35], v[192:195]
    v_mfma_f32_16x16x32_bf16 v[196:199], v[68:71], v[36:39], v[196:199]
    s_waitcnt lgkmcnt(0)
    s_barrier
    v_mfma_f32_16x16x32_bf16 v[200:203], v[72:75], v[24:27], v[200:203]
    ds_read_b64_tr_b16 v[64:65], v4 offset:20480
    v_mfma_f32_16x16x32_bf16 v[204:207], v[72:75], v[28:31], v[204:207]
    ds_read_b64_tr_b16 v[66:67], v4 offset:20992
    v_mfma_f32_16x16x32_bf16 v[208:211], v[72:75], v[32:35], v[208:211]
    ds_read_b128 v[40:43], v15 offset:0
    v_mfma_f32_16x16x32_bf16 v[212:215], v[72:75], v[36:39], v[212:215]
    ds_read_b128 v[44:47], v15 offset:2048
    v_mfma_f32_16x16x32_bf16 v[216:219], v[76:79], v[24:27], v[216:219]
    ds_read_b128 v[48:51], v15 offset:4096
    v_mfma_f32_16x16x32_bf16 v[220:223], v[76:79], v[28:31], v[220:223]
    ds_read_b128 v[52:55], v15 offset:6144
    v_mfma_f32_16x16x32_bf16 v[224:227], v[76:79], v[32:35], v[224:227]
    ds_read_b64_tr_b16 v[68:69], v4 offset:28672
    v_mfma_f32_16x16x32_bf16 v[228:231], v[76:79], v[36:39], v[228:231]
    ds_read_b64_tr_b16 v[70:71], v4 offset:29184
    v_mfma_f32_16x16x32_bf16 v[232:235], v[80:83], v[24:27], v[232:235]
    ds_read_b64_tr_b16 v[72:73], v5 offset:20480
    v_mfma_f32_16x16x32_bf16 v[236:239], v[80:83], v[28:31], v[236:239]
    v_mfma_f32_16x16x32_bf16 v[240:243], v[80:83], v[32:35], v[240:243]
    ds_read_b64_tr_b16 v[74:75], v5 offset:20992
    v_mfma_f32_16x16x32_bf16 v[244:247], v[80:83], v[36:39], v[244:247]
    s_waitcnt lgkmcnt(7)
    v_mfma_f32_16x16x32_bf16 v[88:91], v[64:67], v[40:43], v[88:91]
    ds_read_b64_tr_b16 v[76:77], v5 offset:28672
    s_waitcnt lgkmcnt(7)
    v_mfma_f32_16x16x32_bf16 v[92:95], v[64:67], v[44:47], v[92:95]
    ds_read_b64_tr_b16 v[78:79], v5 offset:29184
    s_waitcnt lgkmcnt(7)
    v_mfma_f32_16x16x32_bf16 v[96:99], v[64:67], v[48:51], v[96:99]
    ds_read_b64_tr_b16 v[80:81], v6 offset:20480
    s_waitcnt lgkmcnt(7)
    v_mfma_f32_16x16x32_bf16 v[100:103], v[64:67], v[52:55], v[100:103]
    ds_read_b64_tr_b16 v[82:83], v6 offset:20992
    s_waitcnt lgkmcnt(6)
    v_mfma_f32_16x16x32_bf16 v[104:107], v[68:71], v[40:43], v[104:107]
    ds_read_b64_tr_b16 v[64:65], v6 offset:28672
    v_mfma_f32_16x16x32_bf16 v[108:111], v[68:71], v[44:47], v[108:111]
    v_add_u32 v14, s80, v16
    v_mfma_f32_16x16x32_bf16 v[112:115], v[68:71], v[48:51], v[112:115]
    ds_read_b64_tr_b16 v[66:67], v6 offset:29184
    v_mfma_f32_16x16x32_bf16 v[116:119], v[68:71], v[52:55], v[116:119]
    v_add_u32 v15, s80, v17
    s_waitcnt lgkmcnt(6)
    v_mfma_f32_16x16x32_bf16 v[120:123], v[72:75], v[40:43], v[120:123]
    ds_read_b64_tr_b16 v[68:69], v7 offset:20480
    v_mfma_f32_16x16x32_bf16 v[124:127], v[72:75], v[44:47], v[124:127]
    s_add_u32 s80, s80, 18432
    v_mfma_f32_16x16x32_bf16 v[128:131], v[72:75], v[48:51], v[128:131]
    ds_read_b64_tr_b16 v[70:71], v7 offset:20992
    v_mfma_f32_16x16x32_bf16 v[132:135], v[72:75], v[52:55], v[132:135]
    s_cmp_ge_u32 s80, 153600
    s_cselect_b32 s84, 55296, 0
    s_waitcnt lgkmcnt(6)
    v_mfma_f32_16x16x32_bf16 v[136:139], v[76:79], v[40:43], v[136:139]
    ds_read_b64_tr_b16 v[72:73], v7 offset:28672
    v_mfma_f32_16x16x32_bf16 v[140:143], v[76:79], v[44:47], v[140:143]
    s_sub_u32 s80, s80, s84
    v_mfma_f32_16x16x32_bf16 v[144:147], v[76:79], v[48:51], v[144:147]
    ds_read_b64_tr_b16 v[74:75], v7 offset:29184
    v_mfma_f32_16x16x32_bf16 v[148:151], v[76:79], v[52:55], v[148:151]
    s_waitcnt lgkmcnt(6)
    v_mfma_f32_16x16x32_bf16 v[152:155], v[80:83], v[40:43], v[152:155]
    ds_read_b64_tr_b16 v[76:77], v8 offset:36864
    v_mfma_f32_16x16x32_bf16 v[156:159], v[80:83], v[44:47], v[156:159]
    v_mfma_f32_16x16x32_bf16 v[160:163], v[80:83], v[48:51], v[160:163]
    ds_read_b64_tr_b16 v[78:79], v8 offset:37120
    v_mfma_f32_16x16x32_bf16 v[164:167], v[80:83], v[52:55], v[164:167]
    s_waitcnt lgkmcnt(6)
    v_mfma_f32_16x16x32_bf16 v[168:171], v[64:67], v[40:43], v[168:171]
    ds_read_b64_tr_b16 v[80:81], v8 offset:38912
    v_mfma_f32_16x16x32_bf16 v[172:175], v[64:67], v[44:47], v[172:175]
    v_mfma_f32_16x16x32_bf16 v[176:179], v[64:67], v[48:51], v[176:179]
    ds_read_b64_tr_b16 v[82:83], v8 offset:39168
    v_mfma_f32_16x16x32_bf16 v[180:183], v[64:67], v[52:55], v[180:183]
    s_waitcnt lgkmcnt(6)
    v_mfma_f32_16x16x32_bf16 v[184:187], v[68:71], v[40:43], v[184:187]
    v_mfma_f32_16x16x32_bf16 v[188:191], v[68:71], v[44:47], v[188:191]
    v_mfma_f32_16x16x32_bf16 v[192:195], v[68:71], v[48:51], v[192:195]
    v_mfma_f32_16x16x32_bf16 v[196:199], v[68:71], v[52:55], v[196:199]
    s_waitcnt lgkmcnt(0)
    s_barrier
    v_mfma_f32_16x16x32_bf16 v[200:203], v[72:75], v[40:43], v[200:203]
    ds_read_b64_tr_b16 v[64:65], v9 offset:0
    v_mfma_f32_16x16x32_bf16 v[204:207], v[72:75], v[44:47], v[204:207]
    ds_read_b64_tr_b16 v[66:67], v9 offset:512
    v_mfma_f32_16x16x32_bf16 v[208:211], v[72:75], v[48:51], v[208:211]
    ds_read_b128 v[24:27], v14 offset:0
    v_mfma_f32_16x16x32_bf16 v[212:215], v[72:75], v[52:55], v[212:215]
    ds_read_b128 v[28:31], v14 offset:2048
    v_mfma_f32_16x16x32_bf16 v[216:219], v[76:79], v[40:43], v[216:219]
    ds_read_b128 v[32:35], v14 offset:4096
    v_mfma_f32_16x16x32_bf16 v[220:223], v[76:79], v[44:47], v[220:223]
    ds_read_b128 v[36:39], v14 offset:6144
    v_mfma_f32_16x16x32_bf16 v[224:227], v[76:79], v[48:51], v[224:227]
    ds_read_b64_tr_b16 v[68:69], v9 offset:8192
    v_mfma_f32_16x16x32_bf16 v[228:231], v[76:79], v[52:55], v[228:231]
    ds_read_b64_tr_b16 v[70:71], v9 offset:8704
    v_mfma_f32_16x16x32_bf16 v[232:235], v[80:83], v[40:43], v[232:235]
    ds_read_b64_tr_b16 v[72:73], v10 offset:0
    v_mfma_f32_16x16x32_bf16 v[236:239], v[80:83], v[44:47], v[236:239]
    v_mfma_f32_16x16x32_bf16 v[240:243], v[80:83], v[48:51], v[240:243]
    ds_read_b64_tr_b16 v[74:75], v10 offset:512
    v_mfma_f32_16x16x32_bf16 v[244:247], v[80:83], v[52:55], v[244:247]
    s_waitcnt lgkmcnt(7)
    v_mfma_f32_16x16x32_bf16 v[88:91], v[64:67], v[24:27], v[88:91]
    ds_read_b64_tr_b16 v[76:77], v10 offset:8192
    s_waitcnt lgkmcnt(7)
    v_mfma_f32_16x16x32_bf16 v[92:95], v[64:67], v[28:31], v[92:95]
    ds_read_b64_tr_b16 v[78:79], v10 offset:8704
    s_waitcnt lgkmcnt(7)
    v_mfma_f32_16x16x32_bf16 v[96:99], v[64:67], v[32:35], v[96:99]
    ds_read_b64_tr_b16 v[80:81], v11 offset:0
    s_waitcnt lgkmcnt(7)
    v_mfma_f32_16x16x32_bf16 v[100:103], v[64:67], v[36:39], v[100:103]
    ds_read_b64_tr_b16 v[82:83], v11 offset:512
    s_waitcnt lgkmcnt(6)
    v_mfma_f32_16x16x32_bf16 v[104:107], v[68:71], v[24:27], v[104:107]
    ds_read_b64_tr_b16 v[64:65], v11 offset:8192
    v_mfma_f32_16x16x32_bf16 v[108:111], v[68:71], v[28:31], v[108:111]
    v_mfma_f32_16x16x32_bf16 v[112:115], v[68:71], v[32:35], v[112:115]
    ds_read_b64_tr_b16 v[66:67], v11 offset:8704
    v_mfma_f32_16x16x32_bf16 v[116:119], v[68:71], v[36:39], v[116:119]
    s_waitcnt lgkmcnt(6)
    v_mfma_f32_16x16x32_bf16 v[120:123], v[72:75], v[24:27], v[120:123]
    ds_read_b64_tr_b16 v[68:69], v12 offset:0
    v_mfma_f32_16x16x32_bf16 v[124:127], v[72:75], v[28:31], v[124:127]
    v_mfma_f32_16x16x32_bf16 v[128:131], v[72:75], v[32:35], v[128:131]
    ds_read_b64_tr_b16 v[70:71], v12 offset:512
    v_mfma_f32_16x16x32_bf16 v[132:135], v[72:75], v[36:39], v[132:135]
    s_waitcnt lgkmcnt(6)
    v_mfma_f32_16x16x32_bf16 v[136:139], v[76:79], v[24:27], v[136:139]
    ds_read_b64_tr_b16 v[72:73], v12 offset:8192
    v_mfma_f32_16x16x32_bf16 v[140:143], v[76:79], v[28:31], v[140:143]
    v_mfma_f32_16x16x32_bf16 v[144:147], v[76:79], v[32:35], v[144:147]
    ds_read_b64_tr_b16 v[74:75], v12 offset:8704
    v_mfma_f32_16x16x32_bf16 v[148:151], v[76:79], v[36:39], v[148:151]
    s_waitcnt lgkmcnt(6)
    v_mfma_f32_16x16x32_bf16 v[152:155], v[80:83], v[24:27], v[152:155]
    ds_read_b64_tr_b16 v[76:77], v13 offset:16384
    v_mfma_f32_16x16x32_bf16 v[156:159], v[80:83], v[28:31], v[156:159]
    v_mfma_f32_16x16x32_bf16 v[160:163], v[80:83], v[32:35], v[160:163]
    ds_read_b64_tr_b16 v[78:79], v13 offset:16640
    v_mfma_f32_16x16x32_bf16 v[164:167], v[80:83], v[36:39], v[164:167]
    s_waitcnt lgkmcnt(6)
    v_mfma_f32_16x16x32_bf16 v[168:171], v[64:67], v[24:27], v[168:171]
    ds_read_b64_tr_b16 v[80:81], v13 offset:18432
    v_mfma_f32_16x16x32_bf16 v[172:175], v[64:67], v[28:31], v[172:175]
    v_mfma_f32_16x16x32_bf16 v[176:179], v[64:67], v[32:35], v[176:179]
    ds_read_b64_tr_b16 v[82:83], v13 offset:18688
    v_mfma_f32_16x16x32_bf16 v[180:183], v[64:67], v[36:39], v[180:183]
    s_waitcnt lgkmcnt(6)
    v_mfma_f32_16x16x32_bf16 v[184:187], v[68:71], v[24:27], v[184:187]
    v_mfma_f32_16x16x32_bf16 v[188:191], v[68:71], v[28:31], v[188:191]
    v_mfma_f32_16x16x32_bf16 v[192:195], v[68:71], v[32:35], v[192:195]
    v_mfma_f32_16x16x32_bf16 v[196:199], v[68:71], v[36:39], v[196:199]
    s_waitcnt lgkmcnt(0)
    s_barrier
    v_mfma_f32_16x16x32_bf16 v[200:203], v[72:75], v[24:27], v[200:203]
    ds_read_b64_tr_b16 v[64:65], v9 offset:20480
    v_mfma_f32_16x16x32_bf16 v[204:207], v[72:75], v[28:31], v[204:207]
    ds_read_b64_tr_b16 v[66:67], v9 offset:20992
    v_mfma_f32_16x16x32_bf16 v[208:211], v[72:75], v[32:35], v[208:211]
    ds_read_b128 v[40:43], v15 offset:0
    v_mfma_f32_16x16x32_bf16 v[212:215], v[72:75], v[36:39], v[212:215]
    ds_read_b128 v[44:47], v15 offset:2048
    v_mfma_f32_16x16x32_bf16 v[216:219], v[76:79], v[24:27], v[216:219]
    ds_read_b128 v[48:51], v15 offset:4096
    v_mfma_f32_16x16x32_bf16 v[220:223], v[76:79], v[28:31], v[220:223]
    ds_read_b128 v[52:55], v15 offset:6144
    v_mfma_f32_16x16x32_bf16 v[224:227], v[76:79], v[32:35], v[224:227]
    ds_read_b64_tr_b16 v[68:69], v9 offset:28672
    v_mfma_f32_16x16x32_bf16 v[228:231], v[76:79], v[36:39], v[228:231]
    ds_read_b64_tr_b16 v[70:71], v9 offset:29184
    v_mfma_f32_16x16x32_bf16 v[232:235], v[80:83], v[24:27], v[232:235]
    ds_read_b64_tr_b16 v[72:73], v10 offset:20480
    v_mfma_f32_16x16x32_bf16 v[236:239], v[80:83], v[28:31], v[236:239]
    v_mfma_f32_16x16x32_bf16 v[240:243], v[80:83], v[32:35], v[240:243]
    ds_read_b64_tr_b16 v[74:75], v10 offset:20992
    v_mfma_f32_16x16x32_bf16 v[244:247], v[80:83], v[36:39], v[244:247]
    s_waitcnt lgkmcnt(7)
    v_mfma_f32_16x16x32_bf16 v[88:91], v[64:67], v[40:43], v[88:91]
    ds_read_b64_tr_b16 v[76:77], v10 offset:28672
    s_waitcnt lgkmcnt(7)
    v_mfma_f32_16x16x32_bf16 v[92:95], v[64:67], v[44:47], v[92:95]
    ds_read_b64_tr_b16 v[78:79], v10 offset:29184
    s_waitcnt lgkmcnt(7)
    v_mfma_f32_16x16x32_bf16 v[96:99], v[64:67], v[48:51], v[96:99]
    ds_read_b64_tr_b16 v[80:81], v11 offset:20480
    s_waitcnt lgkmcnt(7)
    v_mfma_f32_16x16x32_bf16 v[100:103], v[64:67], v[52:55], v[100:103]
    ds_read_b64_tr_b16 v[82:83], v11 offset:20992
    s_waitcnt lgkmcnt(6)
    v_mfma_f32_16x16x32_bf16 v[104:107], v[68:71], v[40:43], v[104:107]
    ds_read_b64_tr_b16 v[64:65], v11 offset:28672
    v_mfma_f32_16x16x32_bf16 v[108:111], v[68:71], v[44:47], v[108:111]
    v_add_u32 v14, s80, v16
    v_mfma_f32_16x16x32_bf16 v[112:115], v[68:71], v[48:51], v[112:115]
    ds_read_b64_tr_b16 v[66:67], v11 offset:29184
    v_mfma_f32_16x16x32_bf16 v[116:119], v[68:71], v[52:55], v[116:119]
    v_add_u32 v15, s80, v17
    s_waitcnt lgkmcnt(6)
    v_mfma_f32_16x16x32_bf16 v[120:123], v[72:75], v[40:43], v[120:123]
    ds_read_b64_tr_b16 v[68:69], v12 offset:20480
    v_mfma_f32_16x16x32_bf16 v[124:127], v[72:75], v[44:47], v[124:127]
    s_add_u32 s80, s80, 18432
    v_mfma_f32_16x16x32_bf16 v[128:131], v[72:75], v[48:51], v[128:131]
    ds_read_b64_tr_b16 v[70:71], v12 offset:20992
    v_mfma_f32_16x16x32_bf16 v[132:135], v[72:75], v[52:55], v[132:135]
    s_cmp_ge_u32 s80, 153600
    s_cselect_b32 s84, 55296, 0
    s_waitcnt lgkmcnt(6)
    v_mfma_f32_16x16x32_bf16 v[136:139], v[76:79], v[40:43], v[136:139]
    ds_read_b64_tr_b16 v[72:73], v12 offset:28672
    v_mfma_f32_16x16x32_bf16 v[140:143], v[76:79], v[44:47], v[140:143]
    s_sub_u32 s80, s80, s84
    v_mfma_f32_16x16x32_bf16 v[144:147], v[76:79], v[48:51], v[144:147]
    ds_read_b64_tr_b16 v[74:75], v12 offset:29184
    v_mfma_f32_16x16x32_bf16 v[148:151], v[76:79], v[52:55], v[148:151]
    s_waitcnt lgkmcnt(6)
    v_mfma_f32_16x16x32_bf16 v[152:155], v[80:83], v[40:43], v[152:155]
    ds_read_b64_tr_b16 v[76:77], v13 offset:36864
    v_mfma_f32_16x16x32_bf16 v[156:159], v[80:83], v[44:47], v[156:159]
    v_mfma_f32_16x16x32_bf16 v[160:163], v[80:83], v[48:51], v[160:163]
    ds_read_b64_tr_b16 v[78:79], v13 offset:37120
    v_mfma_f32_16x16x32_bf16 v[164:167], v[80:83], v[52:55], v[164:167]
    s_waitcnt lgkmcnt(6)
    v_mfma_f32_16x16x32_bf16 v[168:171], v[64:67], v[40:43], v[168:171]
    ds_read_b64_tr_b16 v[80:81], v13 offset:38912
    v_mfma_f32_16x16x32_bf16 v[172:175], v[64:67], v[44:47], v[172:175]
    v_mfma_f32_16x16x32_bf16 v[176:179], v[64:67], v[48:51], v[176:179]
    ds_read_b64_tr_b16 v[82:83], v13 offset:39168
    v_mfma_f32_16x16x32_bf16 v[180:183], v[64:67], v[52:55], v[180:183]
    s_waitcnt lgkmcnt(6)
    v_mfma_f32_16x16x32_bf16 v[184:187], v[68:71], v[40:43], v[184:187]
    v_mfma_f32_16x16x32_bf16 v[188:191], v[68:71], v[44:47], v[188:191]
    v_mfma_f32_16x16x32_bf16 v[192:195], v[68:71], v[48:51], v[192:195]
    v_mfma_f32_16x16x32_bf16 v[196:199], v[68:71], v[52:55], v[196:199]
    s_waitcnt lgkmcnt(0)
    s_barrier
    v_mfma_f32_16x16x32_bf16 v[200:203], v[72:75], v[40:43], v[200:203]
    ds_read_b64_tr_b16 v[64:65], v4 offset:0
    v_mfma_f32_16x16x32_bf16 v[204:207], v[72:75], v[44:47], v[204:207]
    ds_read_b64_tr_b16 v[66:67], v4 offset:512
    v_mfma_f32_16x16x32_bf16 v[208:211], v[72:75], v[48:51], v[208:211]
    ds_read_b128 v[24:27], v14 offset:0
    v_mfma_f32_16x16x32_bf16 v[212:215], v[72:75], v[52:55], v[212:215]
    ds_read_b128 v[28:31], v14 offset:2048
    v_mfma_f32_16x16x32_bf16 v[216:219], v[76:79], v[40:43], v[216:219]
    ds_read_b128 v[32:35], v14 offset:4096
    v_mfma_f32_16x16x32_bf16 v[220:223], v[76:79], v[44:47], v[220:223]
    ds_read_b128 v[36:39], v14 offset:6144
    v_mfma_f32_16x16x32_bf16 v[224:227], v[76:79], v[48:51], v[224:227]
    ds_read_b64_tr_b16 v[68:69], v4 offset:8192
    v_mfma_f32_16x16x32_bf16 v[228:231], v[76:79], v[52:55], v[228:231]
    ds_read_b64_tr_b16 v[70:71], v4 offset:8704
    v_mfma_f32_16x16x32_bf16 v[232:235], v[80:83], v[40:43], v[232:235]
    ds_read_b64_tr_b16 v[72:73], v5 offset:0
    v_mfma_f32_16x16x32_bf16 v[236:239], v[80:83], v[44:47], v[236:239]
    v_mfma_f32_16x16x32_bf16 v[240:243], v[80:83], v[48:51], v[240:243]
    ds_read_b64_tr_b16 v[74:75], v5 offset:512
    v_mfma_f32_16x16x32_bf16 v[244:247], v[80:83], v[52:55], v[244:247]
    s_sub_u32 s34, s34, 1
    s_cmp_lg_u32 s34, 0
    s_cbranch_scc1 L_p1
    s_waitcnt lgkmcnt(7)
    v_mfma_f32_16x16x32_bf16 v[88:91], v[64:67], v[24:27], v[88:91]
    ds_read_b64_tr_b16 v[76:77], v5 offset:8192
    s_waitcnt lgkmcnt(7)
    v_mfma_f32_16x16x32_bf16 v[92:95], v[64:67], v[28:31], v[92:95]
    ds_read_b64_tr_b16 v[78:79], v5 offset:8704
    s_waitcnt lgkmcnt(7)
    v_mfma_f32_16x16x32_bf16 v[96:99], v[64:67], v[32:35], v[96:99]
    ds_read_b64_tr_b16 v[80:81], v6 offset:0
    s_waitcnt lgkmcnt(7)
    v_mfma_f32_16x16x32_bf16 v[100:103], v[64:67], v[36:39], v[100:103]
    ds_read_b64_tr_b16 v[82:83], v6 offset:512
    s_waitcnt lgkmcnt(6)
    v_mfma_f32_16x16x32_bf16 v[104:107], v[68:71], v[24:27], v[104:107]
    ds_read_b64_tr_b16 v[64:65], v6 offset:8192
    v_mfma_f32_16x16x32_bf16 v[108:111], v[68:71], v[28:31], v[108:111]
    v_mfma_f32_16x16x32_bf16 v[112:115], v[68:71], v[32:35], v[112:115]
    ds_read_b64_tr_b16 v[66:67], v6 offset:8704
    v_mfma_f32_16x16x32_bf16 v[116:119], v[68:71], v[36:39], v[116:119]
    s_waitcnt lgkmcnt(6)
    v_mfma_f32_16x16x32_bf16 v[120:123], v[72:75], v[24:27], v[120:123]
    ds_read_b64_tr_b16 v[68:69], v7 offset:0
    v_mfma_f32_16x16x32_bf16 v[124:127], v[72:75], v[28:31], v[124:127]
    v_mfma_f32_16x16x32_bf16 v[128:131], v[72:75], v[32:35], v[128:131]
    ds_read_b64_tr_b16 v[70:71], v7 offset:512
    v_mfma_f32_16x16x32_bf16 v[132:135], v[72:75], v[36:39], v[132:135]
    s_waitcnt lgkmcnt(6)
    v_mfma_f32_16x16x32_bf16 v[136:139], v[76:79], v[24:27], v[136:139]
    ds_read_b64_tr_b16 v[72:73], v7 offset:8192
    v_mfma_f32_16x16x32_bf16 v[140:143], v[76:79], v[28:31], v[140:143]
    v_mfma_f32_16x16x32_bf16 v[144:147], v[76:79], v[32:35], v[144:147]
    ds_read_b64_tr_b16 v[74:75], v7 offset:8704
    v_mfma_f32_16x16x32_bf16 v[148:151], v[76:79], v[36:39], v[148:151]
    s_waitcnt lgkmcnt(6)
    v_mfma_f32_16x16x32_bf16 v[152:155], v[80:83], v[24:27], v[152:155]
    ds_read_b64_tr_b16 v[76:77], v8 offset:16384
    v_mfma_f32_16x16x32_bf16 v[156:159], v[80:83], v[28:31], v[156:159]
    v_mfma_f32_16x16x32_bf16 v[160:163], v[80:83], v[32:35], v[160:163]
    ds_read_b64_tr_b16 v[78:79], v8 offset:16640
    v_mfma_f32_16x16x32_bf16 v[164:167], v[80:83], v[36:39], v[164:167]
    s_waitcnt lgkmcnt(6)
    v_mfma_f32_16x16x32_bf16 v[168:171], v[64:67], v[24:27], v[168:171]
    ds_read_b64_tr_b16 v[80:81], v8 offset:18432
    v_mfma_f32_16x16x32_bf16 v[172:175], v[64:67], v[28:31], v[172:175]
    v_mfma_f32_16x16x32_bf16 v[176:179], v[64:67], v[32:35], v[176:179]
    ds_read_b64_tr_b16 v[82:83], v8 offset:18688
    v_mfma_f32_16x16x32_bf16 v[180:183], v[64:67], v[36:39], v[180:183]
    s_waitcnt lgkmcnt(6)
    v_mfma_f32_16x16x32_bf16 v[184:187], v[68:71], v[24:27], v[184:187]
    v_mfma_f32_16x16x32_bf16 v[188:191], v[68:71], v[28:31], v[188:191]
    v_mfma_f32_16x16x32_bf16 v[192:195], v[68:71], v[32:35], v[192:195]
    v_mfma_f32_16x16x32_bf16 v[196:199], v[68:71], v[36:39], v[196:199]
    s_waitcnt lgkmcnt(0)
    s_barrier
    v_mfma_f32_16x16x32_bf16 v[200:203], v[72:75], v[24:27], v[200:203]
    ds_read_b64_tr_b16 v[64:65], v4 offset:20480
    v_mfma_f32_16x16x32_bf16 v[204:207], v[72:75], v[28:31], v[204:207]
    ds_read_b64_tr_b16 v[66:67], v4 offset:20992
    v_mfma_f32_16x16x32_bf16 v[208:211], v[72:75], v[32:35], v[208:211]
    ds_read_b128 v[40:43], v15 offset:0
L_pad0:
    s_cbranch_execz L_vret0
    v_mfma_f32_16x16x32_bf16 v[212:215], v[72:75], v[36:39], v[212:215]
    ds_read_b128 v[44:47], v15 offset:2048
    v_mfma_f32_16x16x32_bf16 v[216:219], v[76:79], v[24:27], v[216:219]
    ds_read_b128 v[48:51], v15 offset:4096
    v_mfma_f32_16x16x32_bf16 v[220:223], v[76:79], v[28:31], v[220:223]
    ds_read_b128 v[52:55], v15 offset:6144
    v_mfma_f32_16x16x32_bf16 v[224:227], v[76:79], v[32:35], v[224:227]
    ds_read_b64_tr_b16 v[68:69], v4 offset:28672
    v_mfma_f32_16x16x32_bf16 v[228:231], v[76:79], v[36:39], v[228:231]
    ds_read_b64_tr_b16 v[70:71], v4 offset:29184
    v_mfma_f32_16x16x32_bf16 v[232:235], v[80:83], v[24:27], v[232:235]
    ds_read_b64_tr_b16 v[72:73], v5 offset:20480
    v_mfma_f32_16x16x32_bf16 v[236:239], v[80:83], v[28:31], v[236:239]
    v_mfma_f32_16x16x32_bf16 v[240:243], v[80:83], v[32:35], v[240:243]
    ds_read_b64_tr_b16 v[74:75], v5 offset:20992
    v_mfma_f32_16x16x32_bf16 v[244:247], v[80:83], v[36:39], v[244:247]
    s_waitcnt lgkmcnt(7)
    v_mfma_f32_16x16x32_bf16 v[88:91], v[64:67], v[40:43], v[88:91]
    ds_read_b64_tr_b16 v[76:77], v5 offset:28672
    s_waitcnt lgkmcnt(7)
    v_mfma_f32_16x16x32_bf16 v[92:95], v[64:67], v[44:47], v[92:95]
    ds_read_b64_tr_b16 v[78:79], v5 offset:29184
    s_waitcnt lgkmcnt(7)
    v_mfma_f32_16x16x32_bf16 v[96:99], v[64:67], v[48:51], v[96:99]
    ds_read_b64_tr_b16 v[80:81], v6 offset:20480
    s_waitcnt lgkmcnt(7)
    v_mfma_f32_16x16x32_bf16 v[100:103], v[64:67], v[52:55], v[100:103]
    ds_read_b64_tr_b16 v[82:83], v6 offset:20992
    s_waitcnt lgkmcnt(6)
    v_mfma_f32_16x16x32_bf16 v[104:107], v[68:71], v[40:43], v[104:107]
    ds_read_b64_tr_b16 v[64:65], v6 offset:28672
    v_mfma_f32_16x16x32_bf16 v[108:111], v[68:71], v[44:47], v[108:111]
    v_add_u32 v14, s80, v16
    v_mfma_f32_16x16x32_bf16 v[112:115], v[68:71], v[48:51], v[112:115]
    ds_read_b64_tr_b16 v[66:67], v6 offset:29184
    v_mfma_f32_16x16x32_bf16 v[116:119], v[68:71], v[52:55], v[116:119]
    v_add_u32 v15, s80, v17
    s_waitcnt lgkmcnt(6)
    v_mfma_f32_16x16x32_bf16 v[120:123], v[72:75], v[40:43], v[120:123]
    ds_read_b64_tr_b16 v[68:69], v7 offset:20480
    v_mfma_f32_16x16x32_bf16 v[124:127], v[72:75], v[44:47], v[124:127]
    s_add_u32 s80, s80, 18432
    v_mfma_f32_16x16x32_bf16 v[128:131], v[72:75], v[48:51], v[128:131]
    ds_read_b64_tr_b16 v[70:71], v7 offset:20992
    v_mfma_f32_16x16x32_bf16 v[132:135], v[72:75], v[52:55], v[132:135]
    s_cmp_ge_u32 s80, 153600
    s_cselect_b32 s84, 55296, 0
    s_waitcnt lgkmcnt(6)
    v_mfma_f32_16x16x32_bf16 v[136:139], v[76:79], v[40:43], v[136:139]
    ds_read_b64_tr_b16 v[72:73], v7 offset:28672
    v_mfma_f32_16x16x32_bf16 v[140:143], v[76:79], v[44:47], v[140:143]
    s_sub_u32 s80, s80, s84
    v_mfma_f32_16x16x32_bf16 v[144:147], v[76:79], v[48:51], v[144:147]
    ds_read_b64_tr_b16 v[74:75], v7 offset:29184
    v_mfma_f32_16x16x32_bf16 v[148:151], v[76:79], v[52:55], v[148:151]
    s_waitcnt lgkmcnt(6)
    v_mfma_f32_16x16x32_bf16 v[152:155], v[80:83], v[40:43], v[152:155]
    ds_read_b64_tr_b16 v[76:77], v8 offset:36864
    v_mfma_f32_16x16x32_bf16 v[156:159], v[80:83], v[44:47], v[156:159]
    v_mfma_f32_16x16x32_bf16 v[160:163], v[80:83], v[48:51], v[160:163]
    ds_read_b64_tr_b16 v[78:79], v8 offset:37120
    v_mfma_f32_16x16x32_bf16 v[164:167], v[80:83], v[52:55], v[164:167]
    s_waitcnt lgkmcnt(6)
    v_mfma_f32_16x16x32_bf16 v[168:171], v[64:67], v[40:43], v[168:171]
    ds_read_b64_tr_b16 v[80:81], v8 offset:38912
    v_mfma_f32_16x16x32_bf16 v[172:175], v[64:67], v[44:47], v[172:175]
    v_mfma_f32_16x16x32_bf16 v[176:179], v[64:67], v[48:51], v[176:179]
    ds_read_b64_tr_b16 v[82:83], v8 offset:39168
    v_mfma_f32_16x16x32_bf16 v[180:183], v[64:67], v[52:55], v[180:183]
    s_waitcnt lgkmcnt(6)
    v_mfma_f32_16x16x32_bf16 v[184:187], v[68:71], v[40:43], v[184:187]
    v_mfma_f32_16x16x32_bf16 v[188:191], v[68:71], v[44:47], v[188:191]
    v_mfma_f32_16x16x32_bf16 v[192:195], v[68:71], v[48:51], v[192:195]
    v_mfma_f32_16x16x32_bf16 v[196:199], v[68:71], v[52:55], v[196:199]
    s_waitcnt lgkmcnt(0)
    s_barrier
    v_mfma_f32_16x16x32_bf16 v[200:203], v[72:75], v[40:43], v[200:203]
    ds_read_b64_tr_b16 v[64:65], v9 offset:0
    v_mfma_f32_16x16x32_bf16 v[204:207], v[72:75], v[44:47], v[204:207]
    ds_read_b64_tr_b16 v[66:67], v9 offset:512
    v_mfma_f32_16x16x32_bf16 v[208:211], v[72:75], v[48:51], v[208:211]
    ds_read_b128 v[24:27], v14 offset:0
    v_mfma_f32_16x16x32_bf16 v[212:215], v[72:75], v[52:55], v[212:215]
    ds_read_b128 v[28:31], v14 offset:2048
    v_mfma_f32_16x16x32_bf16 v[216:219], v[76:79], v[40:43], v[216:219]
    ds_read_b128 v[32:35], v14 offset:4096
    v_mfma_f32_16x16x32_bf16 v[220:223], v[76:79], v[44:47], v[220:223]
    ds_read_b128 v[36:39], v14 offset:6144
    v_mfma_f32_16x16x32_bf16 v[224:227], v[76:79], v[48:51], v[224:227]
    ds_read_b64_tr_b16 v[68:69], v9 offset:8192
    v_mfma_f32_16x16x32_bf16 v[228:231], v[76:79], v[52:55], v[228:231]
    ds_read_b64_tr_b16 v[70:71], v9 offset:8704
    v_mfma_f32_16x16x32_bf16 v[232:235], v[80:83], v[40:43], v[232:235]
    ds_read_b64_tr_b16 v[72:73], v10 offset:0
    v_mfma_f32_16x16x32_bf16 v[236:239], v[80:83], v[44:47], v[236:239]
    v_mfma_f32_16x16x32_bf16 v[240:243], v[80:83], v[48:51], v[240:243]
    ds_read_b64_tr_b16 v[74:75], v10 offset:512
    v_mfma_f32_16x16x32_bf16 v[244:247], v[80:83], v[52:55], v[244:247]
    s_waitcnt lgkmcnt(7)
    v_mfma_f32_16x16x32_bf16 v[88:91], v[64:67], v[24:27], v[88:91]
    ds_read_b64_tr_b16 v[76:77], v10 offset:8192
    s_waitcnt lgkmcnt(7)
    v_mfma_f32_16x16x32_bf16 v[92:95], v[64:67], v[28:31], v[92:95]
    ds_read_b64_tr_b16 v[78:79], v10 offset:8704
    s_waitcnt lgkmcnt(7)
    v_mfma_f32_16x16x32_bf16 v[96:99], v[64:67], v[32:35], v[96:99]
    ds_read_b64_tr_b16 v[80:81], v11 offset:0
    s_waitcnt lgkmcnt(7)
    v_mfma_f32_16x16x32_bf16 v[100:103], v[64:67], v[36:39], v[100:103]
    ds_read_b64_tr_b16 v[82:83], v11 offset:512
    s_waitcnt lgkmcnt(6)
    v_mfma_f32_16x16x32_bf16 v[104:107], v[68:71], v[24:27], v[104:107]
    ds_read_b64_tr_b16 v[64:65], v11 offset:8192
    v_mfma_f32_16x16x32_bf16 v[108:111], v[68:71], v[28:31], v[108:111]
    v_mfma_f32_16x16x32_bf16 v[112:115], v[68:71], v[32:35], v[112:115]
    ds_read_b64_tr_b16 v[66:67], v11 offset:8704
    v_mfma_f32_16x16x32_bf16 v[116:119], v[68:71], v[36:39], v[116:119]
    s_waitcnt lgkmcnt(6)
    v_mfma_f32_16x16x32_bf16 v[120:123], v[72:75], v[24:27], v[120:123]
    ds_read_b64_tr_b16 v[68:69], v12 offset:0
    v_mfma_f32_16x16x32_bf16 v[124:127], v[72:75], v[28:31], v[124:127]
    v_mfma_f32_16x16x32_bf16 v[128:131], v[72:75], v[32:35], v[128:131]
    ds_read_b64_tr_b16 v[70:71], v12 offset:512
    v_mfma_f32_16x16x32_bf16 v[132:135], v[72:75], v[36:39], v[132:135]
    s_waitcnt lgkmcnt(6)
    v_mfma_f32_16x16x32_bf16 v[136:139], v[76:79], v[24:27], v[136:139]
    ds_read_b64_tr_b16 v[72:73], v12 offset:8192
    v_mfma_f32_16x16x32_bf16 v[140:143], v[76:79], v[28:31], v[140:143]
    v_mfma_f32_16x16x32_bf16 v[144:147], v[76:79], v[32:35], v[144:147]
    ds_read_b64_tr_b16 v[74:75], v12 offset:8704
    v_mfma_f32_16x16x32_bf16 v[148:151], v[76:79], v[36:39], v[148:151]
    s_waitcnt lgkmcnt(6)
    v_mfma_f32_16x16x32_bf16 v[152:155], v[80:83], v[24:27], v[152:155]
    ds_read_b64_tr_b16 v[76:77], v13 offset:16384
    v_mfma_f32_16x16x32_bf16 v[156:159], v[80:83], v[28:31], v[156:159]
    v_mfma_f32_16x16x32_bf16 v[160:163], v[80:83], v[32:35], v[160:163]
    ds_read_b64_tr_b16 v[78:79], v13 offset:16640
    v_mfma_f32_16x16x32_bf16 v[164:167], v[80:83], v[36:39], v[164:167]
    s_waitcnt lgkmcnt(6)
    v_mfma_f32_16x16x32_bf16 v[168:171], v[64:67], v[24:27], v[168:171]
    ds_read_b64_tr_b16 v[80:81], v13 offset:18432
    v_mfma_f32_16x16x32_bf16 v[172:175], v[64:67], v[28:31], v[172:175]
    v_mfma_f32_16x16x32_bf16 v[176:179], v[64:67], v[32:35], v[176:179]
    ds_read_b64_tr_b16 v[82:83], v13 offset:18688
    v_mfma_f32_16x16x32_bf16 v[180:183], v[64:67], v[36:39], v[180:183]
    s_waitcnt lgkmcnt(6)
    v_mfma_f32_16x16x32_bf16 v[184:187], v[68:71], v[24:27], v[184:187]
    v_mfma_f32_16x16x32_bf16 v[188:191], v[68:71], v[28:31], v[188:191]
    v_mfma_f32_16x16x32_bf16 v[192:195], v[68:71], v[32:35], v[192:195]
    v_mfma_f32_16x16x32_bf16 v[196:199], v[68:71], v[36:39], v[196:199]
    s_waitcnt lgkmcnt(0)
    s_barrier
    v_mfma_f32_16x16x32_bf16 v[200:203], v[72:75], v[24:27], v[200:203]
    ds_read_b64_tr_b16 v[64:65], v9 offset:20480
    v_mfma_f32_16x16x32_bf16 v[204:207], v[72:75], v[28:31], v[204:207]
    ds_read_b64_tr_b16 v[66:67], v9 offset:20992
    v_mfma_f32_16x16x32_bf16 v[208:211], v[72:75], v[32:35], v[208:211]
    ds_read_b128 v[40:43], v15 offset:0
    v_mfma_f32_16x16x32_bf16 v[212:215], v[72:75], v[36:39], v[212:215]
    ds_read_b128 v[44:47], v15 offset:2048
    v_mfma_f32_16x16x32_bf16 v[216:219], v[76:79], v[24:27], v[216:219]
    ds_read_b128 v[48:51], v15 offset:4096
    v_mfma_f32_16x16x32_bf16 v[220:223], v[76:79], v[28:31], v[220:223]
    ds_read_b128 v[52:55], v15 offset:6144
    v_mfma_f32_16x16x32_bf16 v[224:227], v[76:79], v[32:35], v[224:227]
    ds_read_b64_tr_b16 v[68:69], v9 offset:28672
    v_mfma_f32_16x16x32_bf16 v[228:231], v[76:79], v[36:39], v[228:231]
    ds_read_b64_tr_b16 v[70:71], v9 offset:29184
    v_mfma_f32_16x16x32_bf16 v[232:235], v[80:83], v[24:27], v[232:235]
    ds_read_b64_tr_b16 v[72:73], v10 offset:20480
    v_mfma_f32_16x16x32_bf16 v[236:239], v[80:83], v[28:31], v[236:239]
    v_mfma_f32_16x16x32_bf16 v[240:243], v[80:83], v[32:35], v[240:243]
    ds_read_b64_tr_b16 v[74:75], v10 offset:20992
    v_mfma_f32_16x16x32_bf16 v[244:247], v[80:83], v[36:39], v[244:247]
    s_waitcnt lgkmcnt(7)
    v_mfma_f32_16x16x32_bf16 v[88:91], v[64:67], v[40:43], v[88:91]
    ds_read_b64_tr_b16 v[76:77], v10 offset:28672
    s_waitcnt lgkmcnt(7)
    v_mfma_f32_16x16x32_bf16 v[92:95], v[64:67], v[44:47], v[92:95]
    ds_read_b64_tr_b16 v[78:79], v10 offset:29184
    s_waitcnt lgkmcnt(7)
    v_mfma_f32_16x16x32_bf16 v[96:99], v[64:67], v[48:51], v[96:99]
    ds_read_b64_tr_b16 v[80:81], v11 offset:20480
    s_waitcnt lgkmcnt(7)
    v_mfma_f32_16x16x32_bf16 v[100:103], v[64:67], v[52:55], v[100:103]
    ds_read_b64_tr_b16 v[82:83], v11 offset:20992
    s_waitcnt lgkmcnt(6)
    v_mfma_f32_16x16x32_bf16 v[104:107], v[68:71], v[40:43], v[104:107]
    ds_read_b64_tr_b16 v[64:65], v11 offset:28672
    v_mfma_f32_16x16x32_bf16 v[108:111], v[68:71], v[44:47], v[108:111]
    v_mfma_f32_16x16x32_bf16 v[112:115], v[68:71], v[48:51], v[112:115]
    ds_read_b64_tr_b16 v[66:67], v11 offset:29184
    v_mfma_f32_16x16x32_bf16 v[116:119], v[68:71], v[52:55], v[116:119]
    s_waitcnt lgkmcnt(6)
    v_mfma_f32_16x16x32_bf16 v[120:123], v[72:75], v[40:43], v[120:123]
    ds_read_b64_tr_b16 v[68:69], v12 offset:20480
    v_mfma_f32_16x16x32_bf16 v[124:127], v[72:75], v[44:47], v[124:127]
    v_mfma_f32_16x16x32_bf16 v[128:131], v[72:75], v[48:51], v[128:131]
    ds_read_b64_tr_b16 v[70:71], v12 offset:20992
    v_mfma_f32_16x16x32_bf16 v[132:135], v[72:75], v[52:55], v[132:135]
    s_waitcnt lgkmcnt(6)
    v_mfma_f32_16x16x32_bf16 v[136:139], v[76:79], v[40:43], v[136:139]
    ds_read_b64_tr_b16 v[72:73], v12 offset:28672
    v_mfma_f32_16x16x32_bf16 v[140:143], v[76:79], v[44:47], v[140:143]
    v_mfma_f32_16x16x32_bf16 v[144:147], v[76:79], v[48:51], v[144:147]
    ds_read_b64_tr_b16 v[74:75], v12 offset:29184
    v_mfma_f32_16x16x32_bf16 v[148:151], v[76:79], v[52:55], v[148:151]
    s_waitcnt lgkmcnt(6)
    v_mfma_f32_16x16x32_bf16 v[152:155], v[80:83], v[40:43], v[152:155]
    ds_read_b64_tr_b16 v[76:77], v13 offset:36864
    v_mfma_f32_16x16x32_bf16 v[156:159], v[80:83], v[44:47], v[156:159]
    v_mfma_f32_16x16x32_bf16 v[160:163], v[80:83], v[48:51], v[160:163]
    ds_read_b64_tr_b16 v[78:79], v13 offset:37120
    v_mfma_f32_16x16x32_bf16 v[164:167], v[80:83], v[52:55], v[164:167]
    s_waitcnt lgkmcnt(6)
    v_mfma_f32_16x16x32_bf16 v[168:171], v[64:67], v[40:43], v[168:171]
    ds_read_b64_tr_b16 v[80:81], v13 offset:38912
    v_mfma_f32_16x16x32_bf16 v[172:175], v[64:67], v[44:47], v[172:175]
    v_mfma_f32_16x16x32_bf16 v[176:179], v[64:67], v[48:51], v[176:179]
    ds_read_b64_tr_b16 v[82:83], v13 offset:39168
    v_mfma_f32_16x16x32_bf16 v[180:183], v[64:67], v[52:55], v[180:183]
    s_waitcnt lgkmcnt(6)
    v_mfma_f32_16x16x32_bf16 v[184:187], v[68:71], v[40:43], v[184:187]
    v_mfma_f32_16x16x32_bf16 v[188:191], v[68:71], v[44:47], v[188:191]
    v_mfma_f32_16x16x32_bf16 v[192:195], v[68:71], v[48:51], v[192:195]
    v_mfma_f32_16x16x32_bf16 v[196:199], v[68:71], v[52:55], v[196:199]
    s_waitcnt lgkmcnt(0)
    s_barrier
    v_mfma_f32_16x16x32_bf16 v[200:203], v[72:75], v[40:43], v[200:203]
    v_mfma_f32_16x16x32_bf16 v[204:207], v[72:75], v[44:47], v[204:207]
    v_mfma_f32_16x16x32_bf16 v[208:211], v[72:75], v[48:51], v[208:211]
    v_mfma_f32_16x16x32_bf16 v[212:215], v[72:75], v[52:55], v[212:215]
    v_mfma_f32_16x16x32_bf16 v[216:219], v[76:79], v[40:43], v[216:219]
    v_mfma_f32_16x16x32_bf16 v[220:223], v[76:79], v[44:47], v[220:223]
    v_mfma_f32_16x16x32_bf16 v[224:227], v[76:79], v[48:51], v[224:227]
    v_mfma_f32_16x16x32_bf16 v[228:231], v[76:79], v[52:55], v[228:231]
    v_mfma_f32_16x16x32_bf16 v[232:235], v[80:83], v[40:43], v[232:235]
    v_mfma_f32_16x16x32_bf16 v[236:239], v[80:83], v[44:47], v[236:239]
    v_mfma_f32_16x16x32_bf16 v[240:243], v[80:83], v[48:51], v[240:243]
    v_mfma_f32_16x16x32_bf16 v[244:247], v[80:83], v[52:55], v[244:247]
    s_setprio 0
    s_lshl_b32 s84, s5, 10
    s_add_u32 s84, s84, 161024
    v_and_b32 v16, 15, v1
    v_lshl_add_u32 v16, v16, 4, s84
    ds_read_b128 v[64:67], v16 offset:0
    ds_read_b128 v[68:71], v16 offset:256
    ds_read_b128 v[72:75], v16 offset:512
    ds_read_b128 v[76:79], v16 offset:768
    v_and_b32 v17, 48, v1
    s_lshl_b32 s84, s6, 8
    s_add_u32 s84, s84, 159744
    v_add_u32 v16, s84, v17
    s_lshl_b32 s84, s6, 6
    s_add_u32 s84, s84, 159744
    v_add_u32 v17, s84, v17
    ds_read_b128 v[24:27], v16 offset:0
    ds_read_b128 v[28:31], v16 offset:640
    ds_read_b128 v[32:35], v16 offset:64
    ds_read_b128 v[36:39], v16 offset:704
    ds_read_b128 v[40:43], v16 offset:128
    ds_read_b128 v[44:47], v16 offset:768
    ds_read_b128 v[48:51], v16 offset:192
    ds_read_b128 v[52:55], v16 offset:832
    ds_read_b128 v[56:59], v17 offset:512
    ds_read_b128 v[60:63], v17 offset:1152
    s_memrealtime s[92:93]
    s_memtime s[90:91]
    s_add_u32 m0, s79, 116736
    s_mov_b32 s78, 256
    buffer_load_dwordx4 v20, s[36:39], s78 offen sc1 lds
    s_waitcnt lgkmcnt(0)
    s_mov_b32 s34, s92
    s_mov_b32 s35, s90
    v_fmac_f32 v88, v24, v64
    v_fmac_f32 v89, v25, v64
    v_fmac_f32 v90, v26, v64
    v_fmac_f32 v91, v27, v64
    v_fmac_f32 v104, v28, v64
    v_fmac_f32 v105, v29, v64
    v_fmac_f32 v106, v30, v64
    v_fmac_f32 v107, v31, v64
    s_add_u32 m0, s79, 117760
    s_nop 0
    buffer_load_dwordx4 v21, s[36:39], s78 offen sc1 lds
    s_add_u32 m0, s33, 77824
    s_mov_b32 s76, 589824
    buffer_load_dwordx4 v23, s[40:43], s76 offen offset:0 lds
    s_add_u32 m0, s33, 79872
    s_nop 0
    buffer_load_dwordx4 v23, s[40:43], s76 offen offset:2048 lds
    s_add_u32 m0, s33, 86016
    s_nop 0
    buffer_load_dwordx4 v23, s[44:47], s76 offen offset:0 lds
    v_mul_f32 v80, v88, v88
    v_mul_f32 v81, v89, v89
    v_mul_f32 v82, v90, v90
    v_mul_f32 v83, v91, v91
    v_fma_f32 v80, v80, v66, v65
    v_fma_f32 v81, v81, v66, v65
    v_fma_f32 v82, v82, v66, v65
    v_fma_f32 v83, v83, v66, v65
    s_add_u32 m0, s33, 90112
    s_mov_b32 s77, 688128
    buffer_load_dwordx4 v22, s[48:51], s77 offen offset:0 lds
    s_add_u32 m0, s33, 94208
    s_nop 0
    buffer_load_dwordx4 v22, s[52:55], s77 offen offset:0 lds
    s_barrier
    s_add_u32 m0, s79, 118784
    s_mov_b32 s78, 33024
    buffer_load_dwordx4 v20, s[36:39], s78 offen sc1 lds
    v_mul_f32 v80, v80, v88
    v_mul_f32 v81, v81, v89
    v_mul_f32 v82, v82, v90
    v_mul_f32 v83, v83, v91
    v_exp_f32 v80, v80
    v_mul_f32 v88, v88, v104
    v_exp_f32 v81, v81
    s_add_u32 m0, s79, 119808
    s_nop 0
    buffer_load_dwordx4 v21, s[36:39], s78 offen sc1 lds
    v_mul_f32 v89, v89, v105
    v_exp_f32 v82, v82
    v_mul_f32 v90, v90, v106
    v_exp_f32 v83, v83
    v_mul_f32 v91, v91, v107
    v_fma_f32 v80, v80, v67, v67
    s_add_u32 m0, s81, 133120
    s_mov_b32 s78, 256
    s_mov_b64 exec, 0xffffffff
    buffer_load_dwordx4 v3, s[36:39], s78 offen sc1 lds
    s_mov_b64 exec, -1
    v_fma_f32 v81, v81, v67, v67
    v_fma_f32 v82, v82, v67, v67
    v_fma_f32 v83, v83, v67, v67
    v_rcp_f32 v80, v80
    v_rcp_f32 v81, v81
    v_rcp_f32 v82, v82
    s_add_u32 m0, s33, 16384
    s_mov_b32 s76, 786432
    buffer_load_dwordx4 v23, s[40:43], s76 offen offset:0 lds
    s_add_u32 m0, s33, 18432
    s_nop 0
    buffer_load_dwordx4 v23, s[40:43], s76 offen offset:2048 lds
    v_rcp_f32 v83, v83
    s_nop 0
    v_mul_f32 v88, v88, v80
    v_mul_f32 v89, v89, v81
    v_mul_f32 v90, v90, v82
    v_mul_f32 v91, v91, v83
    v_cvt_pk_bf16_f32 v88, v88, v89
    v_cvt_pk_bf16_f32 v89, v90, v91
    s_add_u32 m0, s33, 24576
    s_nop 0
    buffer_load_dwordx4 v23, s[44:47], s76 offen offset:0 lds
    v_fmac_f32 v92, v24, v68
    v_fmac_f32 v93, v25, v68
    v_fmac_f32 v94, v26, v68
    v_fmac_f32 v95, v27, v68
    v_fmac_f32 v108, v28, v68
    v_fmac_f32 v109, v29, v68
    v_fmac_f32 v110, v30, v68
    v_fmac_f32 v111, v31, v68
    s_add_u32 m0, s33, 28672
    s_mov_b32 s77, 917504
    buffer_load_dwordx4 v22, s[48:51], s77 offen offset:0 lds
    v_mul_f32 v80, v92, v92
    v_mul_f32 v81, v93, v93
    v_mul_f32 v82, v94, v94
    v_mul_f32 v83, v95, v95
    v_fma_f32 v80, v80, v70, v69
    v_fma_f32 v81, v81, v70, v69
    v_fma_f32 v82, v82, v70, v69
    v_fma_f32 v83, v83, v70, v69
    s_add_u32 m0, s33, 32768
    s_nop 0
    buffer_load_dwordx4 v22, s[52:55], s77 offen offset:0 lds
    s_add_u32 s75, s75, 0x300000
    s_load_dword s94, s[10:11], s75 offset:0x0
    s_load_dword s94, s[10:11], s75 offset:0x40
    s_load_dword s94, s[10:11], s75 offset:0x80
    s_load_dword s94, s[10:11], s75 offset:0xc0
    s_load_dword s94, s[10:11], s75 offset:0x100
    v_mov_b32 v5, 0
    s_mov_b64 exec, 1
    global_load_dwordx2 v[6:7], v5, s[24:25] sc1
    s_mov_b64 exec, -1
    s_barrier
    s_add_u32 m0, s79, 135168
    s_mov_b32 s78, 384
    buffer_load_dwordx4 v20, s[36:39], s78 offen sc1 lds
    v_mul_f32 v80, v80, v92
    v_mul_f32 v81, v81, v93
    v_mul_f32 v82, v82, v94
    v_mul_f32 v83, v83, v95
    v_exp_f32 v80, v80
    v_mul_f32 v92, v92, v108
    v_exp_f32 v81, v81
    s_add_u32 m0, s79, 136192
    s_nop 0
    buffer_load_dwordx4 v21, s[36:39], s78 offen sc1 lds
    v_mul_f32 v93, v93, v109
    v_exp_f32 v82, v82
    v_mul_f32 v94, v94, v110
    v_exp_f32 v83, v83
    v_mul_f32 v95, v95, v111
    v_fma_f32 v80, v80, v71, v71
    s_add_u32 m0, s33, 36864
    s_mov_b32 s76, 983040
    buffer_load_dwordx4 v23, s[40:43], s76 offen offset:0 lds
    v_fma_f32 v81, v81, v71, v71
    v_fma_f32 v82, v82, v71, v71
    v_fma_f32 v83, v83, v71, v71
    v_rcp_f32 v80, v80
    v_rcp_f32 v81, v81
    v_rcp_f32 v82, v82
    s_add_u32 m0, s33, 38912
    s_nop 0
    buffer_load_dwordx4 v23, s[40:43], s76 offen offset:2048 lds
    v_rcp_f32 v83, v83
    s_nop 0
    v_mul_f32 v92, v92, v80
    v_mul_f32 v93, v93, v81
    v_mul_f32 v94, v94, v82
    v_mul_f32 v95, v95, v83
    v_cvt_pk_bf16_f32 v90, v92, v93
    v_cvt_pk_bf16_f32 v91, v94, v95
    s_add_u32 m0, s33, 45056
    s_nop 0
    buffer_load_dwordx4 v23, s[44:47], s76 offen offset:0 lds
    s_nop 1
    v_permlane16_swap_b32 v88, v90
    v_permlane16_swap_b32 v89, v91
    s_add_u32 m0, s33, 49152
    s_mov_b32 s77, 1146880
    buffer_load_dwordx4 v22, s[48:51], s77 offen offset:0 lds
    v_fmac_f32 v96, v24, v72
    v_fmac_f32 v97, v25, v72
    v_fmac_f32 v98, v26, v72
    v_fmac_f32 v99, v27, v72
    v_fmac_f32 v112, v28, v72
    v_fmac_f32 v113, v29, v72
    v_fmac_f32 v114, v30, v72
    v_fmac_f32 v115, v31, v72
    s_add_u32 m0, s33, 53248
    s_nop 0
    buffer_load_dwordx4 v22, s[52:55], s77 offen offset:0 lds
    v_mul_f32 v80, v96, v96
    v_mul_f32 v81, v97, v97
    v_mul_f32 v82, v98, v98
    v_mul_f32 v83, v99, v99
    v_fma_f32 v80, v80, v74, v73
    v_fma_f32 v81, v81, v74, v73
    v_fma_f32 v82, v82, v74, v73
    v_fma_f32 v83, v83, v74, v73
    buffer_store_dwordx4 v[88:91], v19, s[68:71], s72 offen offset:0 sc1
    s_load_dword s94, s[10:11], s75 offset:0x140
    s_load_dword s94, s[10:11], s75 offset:0x180
    s_load_dword s94, s[10:11], s75 offset:0x1c0
    s_add_u32 s99, s99, 0x380000
    s_load_dword s94, s[16:17], s99 offset:0x0
    s_load_dword s94, s[16:17], s99 offset:0x40
    s_waitcnt vmcnt(17)
    s_barrier
    s_add_u32 m0, s79, 137216
    s_mov_b32 s78, 33152
    buffer_load_dwordx4 v20, s[36:39], s78 offen sc1 lds
    v_mul_f32 v80, v80, v96
    v_mul_f32 v81, v81, v97
    v_mul_f32 v82, v82, v98
    v_mul_f32 v83, v83, v99
    v_exp_f32 v80, v80
    v_mul_f32 v96, v96, v112
    v_exp_f32 v81, v81
    s_add_u32 m0, s79, 138240
    s_nop 0
    buffer_load_dwordx4 v21, s[36:39], s78 offen sc1 lds
    v_mul_f32 v97, v97, v113
    v_exp_f32 v82, v82
    v_mul_f32 v98, v98, v114
    v_exp_f32 v83, v83
    v_mul_f32 v99, v99, v115
    v_fma_f32 v80, v80, v75, v75
    s_add_u32 m0, s81, 151552
    s_mov_b32 s78, 384
    s_mov_b64 exec, 0xffffffff
    buffer_load_dwordx4 v3, s[36:39], s78 offen sc1 lds
    s_mov_b64 exec, -1
    v_fma_f32 v81, v81, v75, v75
    v_fma_f32 v82, v82, v75, v75
    v_fma_f32 v83, v83, v75, v75
    v_rcp_f32 v80, v80
    v_rcp_f32 v81, v81
    v_rcp_f32 v82, v82
    s_add_u32 m0, s33, 57344
    s_mov_b32 s76, 1179648
    buffer_load_dwordx4 v23, s[40:43], s76 offen offset:0 lds
    s_add_u32 m0, s33, 59392
    s_nop 0
    buffer_load_dwordx4 v23, s[40:43], s76 offen offset:2048 lds
    v_rcp_f32 v83, v83
    s_nop 0
    v_mul_f32 v96, v96, v80
    v_mul_f32 v97, v97, v81
    v_mul_f32 v98, v98, v82
    v_mul_f32 v99, v99, v83
    v_cvt_pk_bf16_f32 v96, v96, v97
    v_cvt_pk_bf16_f32 v97, v98, v99
    s_add_u32 m0, s33, 65536
    s_nop 0
    buffer_load_dwordx4 v23, s[44:47], s76 offen offset:0 lds
    v_fmac_f32 v100, v24, v76
    v_fmac_f32 v101, v25, v76
    v_fmac_f32 v102, v26, v76
    v_fmac_f32 v103, v27, v76
    v_fmac_f32 v116, v28, v76
    v_fmac_f32 v117, v29, v76
    v_fmac_f32 v118, v30, v76
    v_fmac_f32 v119, v31, v76
    s_add_u32 m0, s33, 69632
    s_mov_b32 s77, 1376256
    buffer_load_dwordx4 v22, s[48:51], s77 offen offset:0 lds
    v_mul_f32 v80, v100, v100
    v_mul_f32 v81, v101, v101
    v_mul_f32 v82, v102, v102
    v_mul_f32 v83, v103, v103
    v_fma_f32 v80, v80, v78, v77
    v_fma_f32 v81, v81, v78, v77
    v_fma_f32 v82, v82, v78, v77
    v_fma_f32 v83, v83, v78, v77
    s_add_u32 m0, s33, 73728
    s_nop 0
    buffer_load_dwordx4 v22, s[52:55], s77 offen offset:0 lds
    s_load_dword s94, s[16:17], s99 offset:0x80
    s_load_dword s94, s[16:17], s99 offset:0xc0
    s_load_dword s94, s[16:17], s99 offset:0x100
    s_load_dword s94, s[16:17], s99 offset:0x140
    s_load_dword s94, s[16:17], s99 offset:0x180
    s_waitcnt vmcnt(17)
    s_barrier
    s_add_u32 m0, s79, 98304
    s_mov_b32 s78, 512
    buffer_load_dwordx4 v20, s[36:39], s78 offen sc1 lds
    v_mul_f32 v80, v80, v100
    v_mul_f32 v81, v81, v101
    v_mul_f32 v82, v82, v102
    v_mul_f32 v83, v83, v103
    v_exp_f32 v80, v80
    v_mul_f32 v100, v100, v116
    v_exp_f32 v81, v81
    s_add_u32 m0, s79, 99328
    s_nop 0
    buffer_load_dwordx4 v21, s[36:39], s78 offen sc1 lds
    v_mul_f32 v101, v101, v117
    v_exp_f32 v82, v82
    v_mul_f32 v102, v102, v118
    v_exp_f32 v83, v83
    v_mul_f32 v103, v103, v119
    v_fma_f32 v80, v80, v79, v79
    s_add_u32 m0, s33, 77824
    s_mov_b32 s76, 1376256
    buffer_load_dwordx4 v23, s[40:43], s76 offen offset:0 lds
    v_fma_f32 v81, v81, v79, v79
    v_fma_f32 v82, v82, v79, v79
    v_fma_f32 v83, v83, v79, v79
    v_rcp_f32 v80, v80
    v_rcp_f32 v81, v81
    v_rcp_f32 v82, v82
    s_add_u32 m0, s33, 79872
    s_nop 0
    buffer_load_dwordx4 v23, s[40:43], s76 offen offset:2048 lds
    v_rcp_f32 v83, v83
    s_nop 0
    v_mul_f32 v100, v100, v80
    v_mul_f32 v101, v101, v81
    v_mul_f32 v102, v102, v82
    v_mul_f32 v103, v103, v83
    v_cvt_pk_bf16_f32 v98, v100, v101
    v_cvt_pk_bf16_f32 v99, v102, v103
    s_add_u32 m0, s33, 86016
    s_nop 0
    buffer_load_dwordx4 v23, s[44:47], s76 offen offset:0 lds
    s_nop 1
    v_permlane16_swap_b32 v96, v98
    v_permlane16_swap_b32 v97, v99
    s_add_u32 m0, s33, 90112
    s_mov_b32 s77, 1605632
    buffer_load_dwordx4 v22, s[48:51], s77 offen offset:0 lds
    v_fmac_f32 v120, v32, v64
    v_fmac_f32 v121, v33, v64
    v_fmac_f32 v122, v34, v64
    v_fmac_f32 v123, v35, v64
    v_fmac_f32 v136, v36, v64
    v_fmac_f32 v137, v37, v64
    v_fmac_f32 v138, v38, v64
    v_fmac_f32 v139, v39, v64
    s_add_u32 m0, s33, 94208
    s_nop 0
    buffer_load_dwordx4 v22, s[52:55], s77 offen offset:0 lds
    v_mul_f32 v80, v120, v120
    v_mul_f32 v81, v121, v121
    v_mul_f32 v82, v122, v122
    v_mul_f32 v83, v123, v123
    v_fma_f32 v80, v80, v66, v65
    v_fma_f32 v81, v81, v66, v65
    v_fma_f32 v82, v82, v66, v65
    v_fma_f32 v83, v83, v66, v65
    buffer_store_dwordx4 v[96:99], v19, s[68:71], s72 offen offset:2048 sc1
    s_load_dword s94, s[16:17], s99 offset:0x1c0
    s_load_dword s94, s[18:19], s99 offset:0x0
    s_load_dword s94, s[18:19], s99 offset:0x40
    s_load_dword s94, s[18:19], s99 offset:0x80
    s_load_dword s94, s[18:19], s99 offset:0xc0
    s_waitcnt vmcnt(17)
    s_barrier
    s_add_u32 m0, s79, 100352
    s_mov_b32 s78, 33280
    buffer_load_dwordx4 v20, s[36:39], s78 offen sc1 lds
    v_mul_f32 v80, v80, v120
    v_mul_f32 v81, v81, v121
    v_mul_f32 v82, v82, v122
    v_mul_f32 v83, v83, v123
    v_exp_f32 v80, v80
    v_mul_f32 v120, v120, v136
    v_exp_f32 v81, v81
    s_add_u32 m0, s79, 101376
    s_nop 0
    buffer_load_dwordx4 v21, s[36:39], s78 offen sc1 lds
    v_mul_f32 v121, v121, v137
    v_exp_f32 v82, v82
    v_mul_f32 v122, v122, v138
    v_exp_f32 v83, v83
    v_mul_f32 v123, v123, v139
L_pad1:
    s_cbranch_execz L_vret1
    v_fma_f32 v80, v80, v67, v67
    s_add_u32 m0, s81, 114688
    s_mov_b32 s78, 512
    s_mov_b64 exec, 0xffffffff
    buffer_load_dwordx4 v3, s[36:39], s78 offen sc1 lds
    s_mov_b64 exec, -1
    v_fma_f32 v81, v81, v67, v67
    v_fma_f32 v82, v82, v67, v67
    v_fma_f32 v83, v83, v67, v67
    v_rcp_f32 v80, v80
    v_rcp_f32 v81, v81
    v_rcp_f32 v82, v82
    s_add_u32 m0, s33, 16384
    s_mov_b32 s76, 1572864
    buffer_load_dwordx4 v23, s[40:43], s76 offen offset:0 lds
    s_add_u32 m0, s33, 18432
    s_nop 0
    buffer_load_dwordx4 v23, s[40:43], s76 offen offset:2048 lds
    v_rcp_f32 v83, v83
    s_nop 0
    v_mul_f32 v120, v120, v80
    v_mul_f32 v121, v121, v81
    v_mul_f32 v122, v122, v82
    v_mul_f32 v123, v123, v83
    v_cvt_pk_bf16_f32 v120, v120, v121
    v_cvt_pk_bf16_f32 v121, v122, v123
    s_add_u32 m0, s33, 24576
    s_nop 0
    buffer_load_dwordx4 v23, s[44:47], s76 offen offset:0 lds
    v_fmac_f32 v124, v32, v68
    v_fmac_f32 v125, v33, v68
    v_fmac_f32 v126, v34, v68
    v_fmac_f32 v127, v35, v68
    v_fmac_f32 v140, v36, v68
    v_fmac_f32 v141, v37, v68
    v_fmac_f32 v142, v38, v68
    v_fmac_f32 v143, v39, v68
    s_add_u32 m0, s33, 28672
    s_mov_b32 s77, 1835008
    buffer_load_dwordx4 v22, s[48:51], s77 offen offset:0 lds
    v_mul_f32 v80, v124, v124
    v_mul_f32 v81, v125, v125
    v_mul_f32 v82, v126, v126
    v_mul_f32 v83, v127, v127
    v_fma_f32 v80, v80, v70, v69
    v_fma_f32 v81, v81, v70, v69
    v_fma_f32 v82, v82, v70, v69
    v_fma_f32 v83, v83, v70, v69
    s_add_u32 m0, s33, 32768
    s_nop 0
    buffer_load_dwordx4 v22, s[52:55], s77 offen offset:0 lds
    s_load_dword s94, s[18:19], s99 offset:0x100
    s_load_dword s94, s[18:19], s99 offset:0x140
    s_load_dword s94, s[18:19], s99 offset:0x180
    s_load_dword s94, s[18:19], s99 offset:0x1c0
    s_load_dword s94, s[10:11], s75 offset:0x80000
    s_waitcnt vmcnt(16)
    s_barrier
    s_add_u32 m0, s79, 116736
    s_mov_b32 s78, 640
    buffer_load_dwordx4 v20, s[36:39], s78 offen sc1 lds
    v_mul_f32 v80, v80, v124
    v_mul_f32 v81, v81, v125
    v_mul_f32 v82, v82, v126
    v_mul_f32 v83, v83, v127
    v_exp_f32 v80, v80
    v_mul_f32 v124, v124, v140
    v_exp_f32 v81, v81
    s_add_u32 m0, s79, 117760
    s_nop 0
    buffer_load_dwordx4 v21, s[36:39], s78 offen sc1 lds
    v_mul_f32 v125, v125, v141
    v_exp_f32 v82, v82
    v_mul_f32 v126, v126, v142
    v_exp_f32 v83, v83
    v_mul_f32 v127, v127, v143
    v_fma_f32 v80, v80, v71, v71
    s_add_u32 m0, s33, 36864
    s_mov_b32 s76, 1769472
    buffer_load_dwordx4 v23, s[40:43], s76 offen offset:0 lds
    v_fma_f32 v81, v81, v71, v71
    v_fma_f32 v82, v82, v71, v71
    v_fma_f32 v83, v83, v71, v71
    v_rcp_f32 v80, v80
    v_rcp_f32 v81, v81
    v_rcp_f32 v82, v82
    s_add_u32 m0, s33, 38912
    s_nop 0
    buffer_load_dwordx4 v23, s[40:43], s76 offen offset:2048 lds
    v_rcp_f32 v83, v83
    s_nop 0
    v_mul_f32 v124, v124, v80
    v_mul_f32 v125, v125, v81
    v_mul_f32 v126, v126, v82
    v_mul_f32 v127, v127, v83
    v_cvt_pk_bf16_f32 v122, v124, v125
    v_cvt_pk_bf16_f32 v123, v126, v127
    s_add_u32 m0, s33, 45056
    s_nop 0
    buffer_load_dwordx4 v23, s[44:47], s76 offen offset:0 lds
    s_nop 1
    v_permlane16_swap_b32 v120, v122
    v_permlane16_swap_b32 v121, v123
    s_add_u32 m0, s33, 49152
    s_mov_b32 s77, 2064384
    buffer_load_dwordx4 v22, s[48:51], s77 offen offset:0 lds
    v_fmac_f32 v128, v32, v72
    v_fmac_f32 v129, v33, v72
    v_fmac_f32 v130, v34, v72
    v_fmac_f32 v131, v35, v72
    v_fmac_f32 v144, v36, v72
    v_fmac_f32 v145, v37, v72
    v_fmac_f32 v146, v38, v72
    v_fmac_f32 v147, v39, v72
    s_add_u32 m0, s33, 53248
    s_nop 0
    buffer_load_dwordx4 v22, s[52:55], s77 offen offset:0 lds
    v_mul_f32 v80, v128, v128
    v_mul_f32 v81, v129, v129
    v_mul_f32 v82, v130, v130
    v_mul_f32 v83, v131, v131
    v_fma_f32 v80, v80, v74, v73
    v_fma_f32 v81, v81, v74, v73
    v_fma_f32 v82, v82, v74, v73
    v_fma_f32 v83, v83, v74, v73
    buffer_store_dwordx4 v[120:123], v19, s[68:71], s72 offen offset:512 sc1
    s_load_dword s94, s[10:11], s75 offset:0x80040
    s_load_dword s94, s[10:11], s75 offset:0x80080
    s_load_dword s94, s[10:11], s75 offset:0x800c0
    s_load_dword s94, s[10:11], s75 offset:0x80100
    s_load_dword s94, s[10:11], s75 offset:0x80140
    s_waitcnt vmcnt(17)
    s_barrier
    s_add_u32 m0, s79, 118784
    s_mov_b32 s78, 33408
    buffer_load_dwordx4 v20, s[36:39], s78 offen sc1 lds
    v_mul_f32 v80, v80, v128
    v_mul_f32 v81, v81, v129
    v_mul_f32 v82, v82, v130
    v_mul_f32 v83, v83, v131
    v_exp_f32 v80, v80
    v_mul_f32 v128, v128, v144
    v_exp_f32 v81, v81
    s_add_u32 m0, s79, 119808
    s_nop 0
    buffer_load_dwordx4 v21, s[36:39], s78 offen sc1 lds
    v_mul_f32 v129, v129, v145
    v_exp_f32 v82, v82
    v_mul_f32 v130, v130, v146
    v_exp_f32 v83, v83
    v_mul_f32 v131, v131, v147
    v_fma_f32 v80, v80, v75, v75
    s_add_u32 m0, s81, 133120
    s_mov_b32 s78, 640
    s_mov_b64 exec, 0xffffffff
    buffer_load_dwordx4 v3, s[36:39], s78 offen sc1 lds
    s_mov_b64 exec, -1
    v_fma_f32 v81, v81, v75, v75
    v_fma_f32 v82, v82, v75, v75
    v_fma_f32 v83, v83, v75, v75
    v_rcp_f32 v80, v80
    v_rcp_f32 v81, v81
    v_rcp_f32 v82, v82
    s_add_u32 m0, s33, 57344
    s_mov_b32 s76, 1966080
    buffer_load_dwordx4 v23, s[40:43], s76 offen offset:0 lds
    s_add_u32 m0, s33, 59392
    s_nop 0
    buffer_load_dwordx4 v23, s[40:43], s76 offen offset:2048 lds
    v_rcp_f32 v83, v83
    s_nop 0
    v_mul_f32 v128, v128, v80
    v_mul_f32 v129, v129, v81
    v_mul_f32 v130, v130, v82
    v_mul_f32 v131, v131, v83
    v_cvt_pk_bf16_f32 v128, v128, v129
    v_cvt_pk_bf16_f32 v129, v130, v131
    s_add_u32 m0, s33, 65536
    s_nop 0
    buffer_load_dwordx4 v23, s[44:47], s76 offen offset:0 lds
    v_fmac_f32 v132, v32, v76
    v_fmac_f32 v133, v33, v76
    v_fmac_f32 v134, v34, v76
    v_fmac_f32 v135, v35, v76
    v_fmac_f32 v148, v36, v76
    v_fmac_f32 v149, v37, v76
    v_fmac_f32 v150, v38, v76
    v_fmac_f32 v151, v39, v76
    s_add_u32 m0, s33, 69632
    s_mov_b32 s77, 2293760
    buffer_load_dwordx4 v22, s[48:51], s77 offen offset:0 lds
    v_mul_f32 v80, v132, v132
    v_mul_f32 v81, v133, v133
    v_mul_f32 v82, v134, v134
    v_mul_f32 v83, v135, v135
    v_fma_f32 v80, v80, v78, v77
    v_fma_f32 v81, v81, v78, v77
    v_fma_f32 v82, v82, v78, v77
    v_fma_f32 v83, v83, v78, v77
    s_add_u32 m0, s33, 73728
    s_nop 0
    buffer_load_dwordx4 v22, s[52:55], s77 offen offset:0 lds
    s_load_dword s94, s[10:11], s75 offset:0x80180
    s_load_dword s94, s[10:11], s75 offset:0x801c0
    s_add_u32 s75, s75, 0x100000
    s_load_dword s94, s[10:11], s75 offset:0x0
    s_load_dword s94, s[10:11], s75 offset:0x40
    s_load_dword s94, s[10:11], s75 offset:0x80
    s_waitcnt vmcnt(16)
    s_barrier
    s_add_u32 m0, s79, 135168
    s_mov_b32 s78, 768
    buffer_load_dwordx4 v20, s[36:39], s78 offen sc1 lds
    v_mul_f32 v80, v80, v132
    v_mul_f32 v81, v81, v133
    v_mul_f32 v82, v82, v134
    v_mul_f32 v83, v83, v135
    v_exp_f32 v80, v80
    v_mul_f32 v132, v132, v148
    v_exp_f32 v81, v81
    s_add_u32 m0, s79, 136192
    s_nop 0
    buffer_load_dwordx4 v21, s[36:39], s78 offen sc1 lds
    v_mul_f32 v133, v133, v149
    v_exp_f32 v82, v82
    v_mul_f32 v134, v134, v150
    v_exp_f32 v83, v83
    v_mul_f32 v135, v135, v151
    v_fma_f32 v80, v80, v79, v79
    s_add_u32 m0, s33, 77824
    s_mov_b32 s76, 2162688
    buffer_load_dwordx4 v23, s[40:43], s76 offen offset:0 lds
    v_fma_f32 v81, v81, v79, v79
    v_fma_f32 v82, v82, v79, v79
    v_fma_f32 v83, v83, v79, v79
    v_rcp_f32 v80, v80
    v_rcp_f32 v81, v81
    v_rcp_f32 v82, v82
    s_add_u32 m0, s33, 79872
    s_nop 0
    buffer_load_dwordx4 v23, s[40:43], s76 offen offset:2048 lds
    v_rcp_f32 v83, v83
    s_nop 0
    v_mul_f32 v132, v132, v80
    v_mul_f32 v133, v133, v81
    v_mul_f32 v134, v134, v82
    v_mul_f32 v135, v135, v83
    v_cvt_pk_bf16_f32 v130, v132, v133
    v_cvt_pk_bf16_f32 v131, v134, v135
    s_add_u32 m0, s33, 86016
    s_nop 0
    buffer_load_dwordx4 v23, s[44:47], s76 offen offset:0 lds
    s_nop 1
    v_permlane16_swap_b32 v128, v130
    v_permlane16_swap_b32 v129, v131
    s_add_u32 m0, s33, 90112
    s_mov_b32 s77, 2523136
    buffer_load_dwordx4 v22, s[48:51], s77 offen offset:0 lds
    v_fmac_f32 v152, v40, v64
    v_fmac_f32 v153, v41, v64
    v_fmac_f32 v154, v42, v64
    v_fmac_f32 v155, v43, v64
    v_fmac_f32 v168, v44, v64
    v_fmac_f32 v169, v45, v64
    v_fmac_f32 v170, v46, v64
    v_fmac_f32 v171, v47, v64
    s_add_u32 m0, s33, 94208
    s_nop 0
    buffer_load_dwordx4 v22, s[52:55], s77 offen offset:0 lds
    v_mul_f32 v80, v152, v152
    v_mul_f32 v81, v153, v153
    v_mul_f32 v82, v154, v154
    v_mul_f32 v83, v155, v155
    v_fma_f32 v80, v80, v66, v65
    v_fma_f32 v81, v81, v66, v65
    v_fma_f32 v82, v82, v66, v65
    v_fma_f32 v83, v83, v66, v65
    buffer_store_dwordx4 v[128:131], v19, s[68:71], s72 offen offset:2560 sc1
    s_load_dword s94, s[10:11], s75 offset:0xc0
    s_load_dword s94, s[10:11], s75 offset:0x100
    s_load_dword s94, s[10:11], s75 offset:0x140
    s_load_dword s94, s[10:11], s75 offset:0x180
    s_load_dword s94, s[10:11], s75 offset:0x1c0
    s_waitcnt vmcnt(56)
    s_movk_i32 s98, 0x4000
L_tokA_chk:
    v_readfirstlane_b32 s100, v6
    v_readfirstlane_b32 s101, v7
    s_nop 1
    s_cmp_lg_u32 s100, 0
    s_cbranch_scc1 L_tokA_ok
    s_sub_u32 s98, s98, 1
    s_cbranch_scc1 L_tokA_ok
    s_sleep 1
    global_load_dwordx2 v[6:7], v5, s[24:25] sc1
    s_waitcnt vmcnt(0)
    s_branch L_tokA_chk
L_tokA_ok:
    s_waitcnt vmcnt(17)
    s_barrier
    s_add_u32 m0, s79, 137216
    s_mov_b32 s78, 33536
    buffer_load_dwordx4 v20, s[36:39], s78 offen sc1 lds
    v_mul_f32 v80, v80, v152
    v_mul_f32 v81, v81, v153
    v_mul_f32 v82, v82, v154
    v_mul_f32 v83, v83, v155
    v_exp_f32 v80, v80
    v_mul_f32 v152, v152, v168
    v_exp_f32 v81, v81
    s_add_u32 m0, s79, 138240
    s_nop 0
    buffer_load_dwordx4 v21, s[36:39], s78 offen sc1 lds
    v_mul_f32 v153, v153, v169
    v_exp_f32 v82, v82
    v_mul_f32 v154, v154, v170
    v_exp_f32 v83, v83
    v_mul_f32 v155, v155, v171
    v_fma_f32 v80, v80, v67, v67
    s_add_u32 m0, s81, 151552
    s_mov_b32 s78, 768
    s_mov_b64 exec, 0xffffffff
    buffer_load_dwordx4 v3, s[36:39], s78 offen sc1 lds
    s_mov_b64 exec, -1
    v_fma_f32 v81, v81, v67, v67
    v_fma_f32 v82, v82, v67, v67
    v_fma_f32 v83, v83, v67, v67
    v_rcp_f32 v80, v80
    v_rcp_f32 v81, v81
    v_rcp_f32 v82, v82
    s_add_u32 m0, s33, 16384
    s_mov_b32 s76, 2359296
    buffer_load_dwordx4 v23, s[40:43], s76 offen offset:0 lds
    s_add_u32 m0, s33, 18432
    s_nop 0
    buffer_load_dwordx4 v23, s[40:43], s76 offen offset:2048 lds
    v_rcp_f32 v83, v83
    s_nop 0
    v_mul_f32 v152, v152, v80
    v_mul_f32 v153, v153, v81
    v_mul_f32 v154, v154, v82
    v_mul_f32 v155, v155, v83
    v_cvt_pk_bf16_f32 v152, v152, v153
    v_cvt_pk_bf16_f32 v153, v154, v155
    s_add_u32 m0, s33, 24576
    s_nop 0
    buffer_load_dwordx4 v23, s[44:47], s76 offen offset:0 lds
    v_fmac_f32 v156, v40, v68
    v_fmac_f32 v157, v41, v68
    v_fmac_f32 v158, v42, v68
    v_fmac_f32 v159, v43, v68
    v_fmac_f32 v172, v44, v68
    v_fmac_f32 v173, v45, v68
    v_fmac_f32 v174, v46, v68
    v_fmac_f32 v175, v47, v68
    s_add_u32 m0, s33, 28672
    s_mov_b32 s77, 2752512
    buffer_load_dwordx4 v22, s[48:51], s77 offen offset:0 lds
    v_mul_f32 v80, v156, v156
    v_mul_f32 v81, v157, v157
    v_mul_f32 v82, v158, v158
    v_mul_f32 v83, v159, v159
    v_fma_f32 v80, v80, v70, v69
    v_fma_f32 v81, v81, v70, v69
    v_fma_f32 v82, v82, v70, v69
    v_fma_f32 v83, v83, v70, v69
    s_add_u32 m0, s33, 32768
    s_nop 0
    buffer_load_dwordx4 v22, s[52:55], s77 offen offset:0 lds
    s_load_dword s94, s[10:11], s75 offset:0x80000
    s_load_dword s94, s[10:11], s75 offset:0x80040
    s_load_dword s94, s[10:11], s75 offset:0x80080
    s_load_dword s94, s[10:11], s75 offset:0x800c0
    s_load_dword s94, s[10:11], s75 offset:0x80100
    s_waitcnt vmcnt(16)
    s_barrier
    s_add_u32 m0, s79, 98304
    s_mov_b32 s78, 896
    buffer_load_dwordx4 v20, s[36:39], s78 offen sc1 lds
    v_mul_f32 v80, v80, v156
    v_mul_f32 v81, v81, v157
    v_mul_f32 v82, v82, v158
    v_mul_f32 v83, v83, v159
    v_exp_f32 v80, v80
    v_mul_f32 v156, v156, v172
    v_exp_f32 v81, v81
    s_add_u32 m0, s79, 99328
    s_nop 0
    buffer_load_dwordx4 v21, s[36:39], s78 offen sc1 lds
    v_mul_f32 v157, v157, v173
    v_exp_f32 v82, v82
    v_mul_f32 v158, v158, v174
    v_exp_f32 v83, v83
    v_mul_f32 v159, v159, v175
    v_fma_f32 v80, v80, v71, v71
    s_add_u32 m0, s33, 36864
    s_mov_b32 s76, 2555904
    buffer_load_dwordx4 v23, s[40:43], s76 offen offset:0 lds
    v_fma_f32 v81, v81, v71, v71
    v_fma_f32 v82, v82, v71, v71
    v_fma_f32 v83, v83, v71, v71
    v_rcp_f32 v80, v80
    v_rcp_f32 v81, v81
    v_rcp_f32 v82, v82
    s_add_u32 m0, s33, 38912
    s_nop 0
    buffer_load_dwordx4 v23, s[40:43], s76 offen offset:2048 lds
    v_rcp_f32 v83, v83
    s_nop 0
    v_mul_f32 v156, v156, v80
    v_mul_f32 v157, v157, v81
    v_mul_f32 v158, v158, v82
    v_mul_f32 v159, v159, v83
    v_cvt_pk_bf16_f32 v154, v156, v157
    v_cvt_pk_bf16_f32 v155, v158, v159
    s_add_u32 m0, s33, 45056
    s_nop 0
    buffer_load_dwordx4 v23, s[44:47], s76 offen offset:0 lds
    s_nop 1
    v_permlane16_swap_b32 v152, v154
    v_permlane16_swap_b32 v153, v155
    s_add_u32 m0, s33, 49152
    s_mov_b32 s77, 2981888
    buffer_load_dwordx4 v22, s[48:51], s77 offen offset:0 lds
    v_fmac_f32 v160, v40, v72
    v_fmac_f32 v161, v41, v72
    v_fmac_f32 v162, v42, v72
    v_fmac_f32 v163, v43, v72
    v_fmac_f32 v176, v44, v72
    v_fmac_f32 v177, v45, v72
    v_fmac_f32 v178, v46, v72
    v_fmac_f32 v179, v47, v72
    s_add_u32 m0, s33, 53248
    s_nop 0
    buffer_load_dwordx4 v22, s[52:55], s77 offen offset:0 lds
    v_mul_f32 v80, v160, v160
    v_mul_f32 v81, v161, v161
    v_mul_f32 v82, v162, v162
    v_mul_f32 v83, v163, v163
    v_fma_f32 v80, v80, v74, v73
    v_fma_f32 v81, v81, v74, v73
    v_fma_f32 v82, v82, v74, v73
    v_fma_f32 v83, v83, v74, v73
    buffer_store_dwordx4 v[152:155], v19, s[68:71], s73 offen offset:0 sc1
    s_load_dword s94, s[10:11], s75 offset:0x80140
    s_load_dword s94, s[10:11], s75 offset:0x80180
    s_load_dword s94, s[10:11], s75 offset:0x801c0
    s_add_u32 s99, s99, 0x1c0000
    s_load_dword s94, s[16:17], s99 offset:0x0
    s_load_dword s94, s[16:17], s99 offset:0x40
    s_waitcnt vmcnt(17)
    s_barrier
    s_add_u32 m0, s79, 100352
    s_mov_b32 s78, 33664
    buffer_load_dwordx4 v20, s[36:39], s78 offen sc1 lds
    v_mul_f32 v80, v80, v160
    v_mul_f32 v81, v81, v161
    v_mul_f32 v82, v82, v162
    v_mul_f32 v83, v83, v163
    v_exp_f32 v80, v80
    v_mul_f32 v160, v160, v176
    v_exp_f32 v81, v81
    s_add_u32 m0, s79, 101376
    s_nop 0
    buffer_load_dwordx4 v21, s[36:39], s78 offen sc1 lds
    v_mul_f32 v161, v161, v177
    v_exp_f32 v82, v82
    v_mul_f32 v162, v162, v178
    v_exp_f32 v83, v83
    v_mul_f32 v163, v163, v179
    v_fma_f32 v80, v80, v75, v75
    s_add_u32 m0, s81, 114688
    s_mov_b32 s78, 896
    s_mov_b64 exec, 0xffffffff
    buffer_load_dwordx4 v3, s[36:39], s78 offen sc1 lds
    s_mov_b64 exec, -1
    v_fma_f32 v81, v81, v75, v75
    v_fma_f32 v82, v82, v75, v75
    v_fma_f32 v83, v83, v75, v75
    v_rcp_f32 v80, v80
    v_rcp_f32 v81, v81
    v_rcp_f32 v82, v82
    s_add_u32 m0, s33, 57344
    s_mov_b32 s76, 2752512
    buffer_load_dwordx4 v23, s[40:43], s76 offen offset:0 lds
    s_add_u32 m0, s33, 59392
    s_nop 0
    buffer_load_dwordx4 v23, s[40:43], s76 offen offset:2048 lds
    v_rcp_f32 v83, v83
    s_nop 0
    v_mul_f32 v160, v160, v80
    v_mul_f32 v161, v161, v81
    v_mul_f32 v162, v162, v82
    v_mul_f32 v163, v163, v83
    v_cvt_pk_bf16_f32 v160, v160, v161
    v_cvt_pk_bf16_f32 v161, v162, v163
    s_add_u32 m0, s33, 65536
    s_nop 0
    buffer_load_dwordx4 v23, s[44:47], s76 offen offset:0 lds
    v_fmac_f32 v164, v40, v76
    v_fmac_f32 v165, v41, v76
    v_fmac_f32 v166, v42, v76
    v_fmac_f32 v167, v43, v76
    v_fmac_f32 v180, v44, v76
    v_fmac_f32 v181, v45, v76
    v_fmac_f32 v182, v46, v76
    v_fmac_f32 v183, v47, v76
    s_add_u32 m0, s33, 69632
    s_mov_b32 s77, 3211264
    buffer_load_dwordx4 v22, s[48:51], s77 offen offset:0 lds
    v_mul_f32 v80, v164, v164
    v_mul_f32 v81, v165, v165
    v_mul_f32 v82, v166, v166
    v_mul_f32 v83, v167, v167
    v_fma_f32 v80, v80, v78, v77
    v_fma_f32 v81, v81, v78, v77
    v_fma_f32 v82, v82, v78, v77
    v_fma_f32 v83, v83, v78, v77
    s_add_u32 m0, s33, 73728
    s_nop 0
    buffer_load_dwordx4 v22, s[52:55], s77 offen offset:0 lds
    s_load_dword s94, s[16:17], s99 offset:0x80
    s_load_dword s94, s[16:17], s99 offset:0xc0
    s_load_dword s94, s[16:17], s99 offset:0x100
    s_load_dword s94, s[16:17], s99 offset:0x140
    s_load_dword s94, s[16:17], s99 offset:0x180
    s_waitcnt vmcnt(16)
    s_barrier
    s_add_u32 m0, s79, 116736
    s_mov_b32 s78, 1024
    buffer_load_dwordx4 v20, s[36:39], s78 offen sc1 lds
    v_mul_f32 v80, v80, v164
    v_mul_f32 v81, v81, v165
    v_mul_f32 v82, v82, v166
    v_mul_f32 v83, v83, v167
    v_exp_f32 v80, v80
    v_mul_f32 v164, v164, v180
    v_exp_f32 v81, v81
    s_add_u32 m0, s79, 117760
    s_nop 0
    buffer_load_dwordx4 v21, s[36:39], s78 offen sc1 lds
    v_mul_f32 v165, v165, v181
    v_exp_f32 v82, v82
    v_mul_f32 v166, v166, v182
    v_exp_f32 v83, v83
    v_mul_f32 v167, v167, v183
    v_fma_f32 v80, v80, v79, v79
    s_add_u32 m0, s33, 77824
    s_mov_b32 s76, 2949120
    buffer_load_dwordx4 v23, s[40:43], s76 offen offset:0 lds
    v_fma_f32 v81, v81, v79, v79
    v_fma_f32 v82, v82, v79, v79
    v_fma_f32 v83, v83, v79, v79
    v_rcp_f32 v80, v80
    v_rcp_f32 v81, v81
    v_rcp_f32 v82, v82
    s_add_u32 m0, s33, 79872
    s_nop 0
    buffer_load_dwordx4 v23, s[40:43], s76 offen offset:2048 lds
    v_rcp_f32 v83, v83
    s_nop 0
    v_mul_f32 v164, v164, v80
    v_mul_f32 v165, v165, v81
    v_mul_f32 v166, v166, v82
    v_mul_f32 v167, v167, v83
    v_cvt_pk_bf16_f32 v162, v164, v165
    v_cvt_pk_bf16_f32 v163, v166, v167
    s_add_u32 m0, s33, 86016
    s_nop 0
    buffer_load_dwordx4 v23, s[44:47], s76 offen offset:0 lds
    s_nop 1
    v_permlane16_swap_b32 v160, v162
    v_permlane16_swap_b32 v161, v163
    s_add_u32 m0, s33, 90112
    s_mov_b32 s77, 3440640
    buffer_load_dwordx4 v22, s[48:51], s77 offen offset:0 lds
    v_fmac_f32 v184, v48, v64
    v_fmac_f32 v185, v49, v64
    v_fmac_f32 v186, v50, v64
    v_fmac_f32 v187, v51, v64
    v_fmac_f32 v200, v52, v64
    v_fmac_f32 v201, v53, v64
    v_fmac_f32 v202, v54, v64
    v_fmac_f32 v203, v55, v64
    s_add_u32 m0, s33, 94208
    s_nop 0
    buffer_load_dwordx4 v22, s[52:55], s77 offen offset:0 lds
    v_mul_f32 v80, v184, v184
    v_mul_f32 v81, v185, v185
    v_mul_f32 v82, v186, v186
    v_mul_f32 v83, v187, v187
    v_fma_f32 v80, v80, v66, v65
    v_fma_f32 v81, v81, v66, v65
    v_fma_f32 v82, v82, v66, v65
    v_fma_f32 v83, v83, v66, v65
    buffer_store_dwordx4 v[160:163], v19, s[68:71], s73 offen offset:2048 sc1
    s_load_dword s94, s[16:17], s99 offset:0x1c0
    s_load_dword s94, s[18:19], s99 offset:0x0
    s_load_dword s94, s[18:19], s99 offset:0x40
    s_load_dword s94, s[18:19], s99 offset:0x80
    s_load_dword s94, s[18:19], s99 offset:0xc0
    s_waitcnt vmcnt(17)
    s_barrier
    s_add_u32 m0, s79, 118784
    s_mov_b32 s78, 33792
    buffer_load_dwordx4 v20, s[36:39], s78 offen sc1 lds
    v_mul_f32 v80, v80, v184
    v_mul_f32 v81, v81, v185
    v_mul_f32 v82, v82, v186
    v_mul_f32 v83, v83, v187
    v_exp_f32 v80, v80
    v_mul_f32 v184, v184, v200
    v_exp_f32 v81, v81
    s_add_u32 m0, s79, 119808
    s_nop 0
    buffer_load_dwordx4 v21, s[36:39], s78 offen sc1 lds
    v_mul_f32 v185, v185, v201
    v_exp_f32 v82, v82
    v_mul_f32 v186, v186, v202
    v_exp_f32 v83, v83
    v_mul_f32 v187, v187, v203
    v_fma_f32 v80, v80, v67, v67
    s_add_u32 m0, s81, 133120
    s_mov_b32 s78, 1024
    s_mov_b64 exec, 0xffffffff
    buffer_load_dwordx4 v3, s[36:39], s78 offen sc1 lds
    s_mov_b64 exec, -1
    v_fma_f32 v81, v81, v67, v67
    v_fma_f32 v82, v82, v67, v67
    v_fma_f32 v83, v83, v67, v67
    v_rcp_f32 v80, v80
    v_rcp_f32 v81, v81
    v_rcp_f32 v82, v82
    s_add_u32 m0, s33, 16384
    s_mov_b32 s76, 3145728
    buffer_load_dwordx4 v23, s[40:43], s76 offen offset:0 lds
    s_add_u32 m0, s33, 18432
    s_nop 0
    buffer_load_dwordx4 v23, s[40:43], s76 offen offset:2048 lds
    v_rcp_f32 v83, v83
    s_nop 0
    v_mul_f32 v184, v184, v80
    v_mul_f32 v185, v185, v81
    v_mul_f32 v186, v186, v82
    v_mul_f32 v187, v187, v83
    v_cvt_pk_bf16_f32 v184, v184, v185
    v_cvt_pk_bf16_f32 v185, v186, v187
    s_add_u32 m0, s33, 24576
    s_nop 0
    buffer_load_dwordx4 v23, s[44:47], s76 offen offset:0 lds
    v_fmac_f32 v188, v48, v68
    v_fmac_f32 v189, v49, v68
    v_fmac_f32 v190, v50, v68
    v_fmac_f32 v191, v51, v68
    v_fmac_f32 v204, v52, v68
    v_fmac_f32 v205, v53, v68
    v_fmac_f32 v206, v54, v68
    v_fmac_f32 v207, v55, v68
    s_add_u32 m0, s33, 28672
    s_mov_b32 s77, 3670016
    buffer_load_dwordx4 v22, s[48:51], s77 offen offset:0 lds
    v_mul_f32 v80, v188, v188
    v_mul_f32 v81, v189, v189
    v_mul_f32 v82, v190, v190
    v_mul_f32 v83, v191, v191
    v_fma_f32 v80, v80, v70, v69
    v_fma_f32 v81, v81, v70, v69
    v_fma_f32 v82, v82, v70, v69
    v_fma_f32 v83, v83, v70, v69
    s_add_u32 m0, s33, 32768
    s_nop 0
    buffer_load_dwordx4 v22, s[52:55], s77 offen offset:0 lds
    s_load_dword s94, s[18:19], s99 offset:0x100
    s_load_dword s94, s[18:19], s99 offset:0x140
    s_load_dword s94, s[18:19], s99 offset:0x180
    s_load_dword s94, s[18:19], s99 offset:0x1c0
    s_add_u32 s75, s75, 0x100000
    s_load_dword s94, s[10:11], s75 offset:0x0
    s_waitcnt vmcnt(16)
    s_barrier
    s_add_u32 m0, s79, 135168
    s_mov_b32 s78, 1152
    buffer_load_dwordx4 v20, s[36:39], s78 offen sc1 lds
    v_mul_f32 v80, v80, v188
    v_mul_f32 v81, v81, v189
    v_mul_f32 v82, v82, v190
    v_mul_f32 v83, v83, v191
    v_exp_f32 v80, v80
    v_mul_f32 v188, v188, v204
    v_exp_f32 v81, v81
    s_add_u32 m0, s79, 136192
    s_nop 0
    buffer_load_dwordx4 v21, s[36:39], s78 offen sc1 lds
    v_mul_f32 v189, v189, v205
    v_exp_f32 v82, v82
    v_mul_f32 v190, v190, v206
    v_exp_f32 v83, v83
    v_mul_f32 v191, v191, v207
    v_fma_f32 v80, v80, v71, v71
    s_add_u32 m0, s33, 36864
    s_mov_b32 s76, 3342336
    buffer_load_dwordx4 v23, s[40:43], s76 offen offset:0 lds
    v_fma_f32 v81, v81, v71, v71
    v_fma_f32 v82, v82, v71, v71
L_pad2:
    s_cbranch_execz L_vret1
    v_fma_f32 v83, v83, v71, v71
    v_rcp_f32 v80, v80
    v_rcp_f32 v81, v81
    v_rcp_f32 v82, v82
    s_add_u32 m0, s33, 38912
    s_nop 0
    buffer_load_dwordx4 v23, s[40:43], s76 offen offset:2048 lds
    v_rcp_f32 v83, v83
    s_nop 0
    v_mul_f32 v188, v188, v80
    v_mul_f32 v189, v189, v81
    v_mul_f32 v190, v190, v82
    v_mul_f32 v191, v191, v83
    v_cvt_pk_bf16_f32 v186, v188, v189
    v_cvt_pk_bf16_f32 v187, v190, v191
    s_add_u32 m0, s33, 45056
    s_nop 0
    buffer_load_dwordx4 v23, s[44:47], s76 offen offset:0 lds
    s_nop 1
    v_permlane16_swap_b32 v184, v186
    v_permlane16_swap_b32 v185, v187
    s_add_u32 m0, s33, 49152
    s_mov_b32 s77, 3899392
    buffer_load_dwordx4 v22, s[48:51], s77 offen offset:0 lds
    v_fmac_f32 v192, v48, v72
    v_fmac_f32 v193, v49, v72
    v_fmac_f32 v194, v50, v72
    v_fmac_f32 v195, v51, v72
    v_fmac_f32 v208, v52, v72
    v_fmac_f32 v209, v53, v72
    v_fmac_f32 v210, v54, v72
    v_fmac_f32 v211, v55, v72
    s_add_u32 m0, s33, 53248
    s_nop 0
    buffer_load_dwordx4 v22, s[52:55], s77 offen offset:0 lds
    v_mul_f32 v80, v192, v192
    v_mul_f32 v81, v193, v193
    v_mul_f32 v82, v194, v194
    v_mul_f32 v83, v195, v195
    v_fma_f32 v80, v80, v74, v73
    v_fma_f32 v81, v81, v74, v73
    v_fma_f32 v82, v82, v74, v73
    v_fma_f32 v83, v83, v74, v73
    buffer_store_dwordx4 v[184:187], v19, s[68:71], s73 offen offset:512 sc1
    s_load_dword s94, s[10:11], s75 offset:0x40
    s_load_dword s94, s[10:11], s75 offset:0x80
    s_load_dword s94, s[10:11], s75 offset:0xc0
    s_load_dword s94, s[10:11], s75 offset:0x100
    s_load_dword s94, s[10:11], s75 offset:0x140
    s_waitcnt vmcnt(17)
    s_barrier
    s_add_u32 m0, s79, 137216
    s_mov_b32 s78, 33920
    buffer_load_dwordx4 v20, s[36:39], s78 offen sc1 lds
    v_mul_f32 v80, v80, v192
    v_mul_f32 v81, v81, v193
    v_mul_f32 v82, v82, v194
    v_mul_f32 v83, v83, v195
    v_exp_f32 v80, v80
    v_mul_f32 v192, v192, v208
    v_exp_f32 v81, v81
    s_add_u32 m0, s79, 138240
    s_nop 0
    buffer_load_dwordx4 v21, s[36:39], s78 offen sc1 lds
    v_mul_f32 v193, v193, v209
    v_exp_f32 v82, v82
    v_mul_f32 v194, v194, v210
    v_exp_f32 v83, v83
    v_mul_f32 v195, v195, v211
    v_fma_f32 v80, v80, v75, v75
    s_add_u32 m0, s81, 151552
    s_mov_b32 s78, 1152
    s_mov_b64 exec, 0xffffffff
    buffer_load_dwordx4 v3, s[36:39], s78 offen sc1 lds
    s_mov_b64 exec, -1
    v_fma_f32 v81, v81, v75, v75
    v_fma_f32 v82, v82, v75, v75
    v_fma_f32 v83, v83, v75, v75
    v_rcp_f32 v80, v80
    v_rcp_f32 v81, v81
    v_rcp_f32 v82, v82
    s_add_u32 m0, s33, 57344
    s_mov_b32 s76, 3538944
    buffer_load_dwordx4 v23, s[40:43], s76 offen offset:0 lds
    s_add_u32 m0, s33, 59392
    s_nop 0
    buffer_load_dwordx4 v23, s[40:43], s76 offen offset:2048 lds
    v_rcp_f32 v83, v83
    s_nop 0
    v_mul_f32 v192, v192, v80
    v_mul_f32 v193, v193, v81
    v_mul_f32 v194, v194, v82
    v_mul_f32 v195, v195, v83
    v_cvt_pk_bf16_f32 v192, v192, v193
    v_cvt_pk_bf16_f32 v193, v194, v195
    s_add_u32 m0, s33, 65536
    s_nop 0
    buffer_load_dwordx4 v23, s[44:47], s76 offen offset:0 lds
    v_fmac_f32 v196, v48, v76
    v_fmac_f32 v197, v49, v76
    v_fmac_f32 v198, v50, v76
    v_fmac_f32 v199, v51, v76
    v_fmac_f32 v212, v52, v76
    v_fmac_f32 v213, v53, v76
    v_fmac_f32 v214, v54, v76
    v_fmac_f32 v215, v55, v76
    s_add_u32 m0, s33, 69632
    s_mov_b32 s77, 4128768
    buffer_load_dwordx4 v22, s[48:51], s77 offen offset:0 lds
    v_mul_f32 v80, v196, v196
    v_mul_f32 v81, v197, v197
    v_mul_f32 v82, v198, v198
    v_mul_f32 v83, v199, v199
    v_fma_f32 v80, v80, v78, v77
    v_fma_f32 v81, v81, v78, v77
    v_fma_f32 v82, v82, v78, v77
    v_fma_f32 v83, v83, v78, v77
    s_add_u32 m0, s33, 73728
    s_nop 0
    buffer_load_dwordx4 v22, s[52:55], s77 offen offset:0 lds
    s_load_dword s94, s[10:11], s75 offset:0x180
    s_load_dword s94, s[10:11], s75 offset:0x1c0
    s_load_dword s94, s[10:11], s75 offset:0x80000
    s_load_dword s94, s[10:11], s75 offset:0x80040
    s_load_dword s94, s[10:11], s75 offset:0x80080
    s_waitcnt vmcnt(16)
    s_barrier
    s_add_u32 m0, s79, 98304
    s_mov_b32 s78, 1280
    buffer_load_dwordx4 v20, s[36:39], s78 offen sc1 lds
    v_mul_f32 v80, v80, v196
    v_mul_f32 v81, v81, v197
    v_mul_f32 v82, v82, v198
    v_mul_f32 v83, v83, v199
    v_exp_f32 v80, v80
    v_mul_f32 v196, v196, v212
    v_exp_f32 v81, v81
    s_add_u32 m0, s79, 99328
    s_nop 0
    buffer_load_dwordx4 v21, s[36:39], s78 offen sc1 lds
    v_mul_f32 v197, v197, v213
    v_exp_f32 v82, v82
    v_mul_f32 v198, v198, v214
    v_exp_f32 v83, v83
    v_mul_f32 v199, v199, v215
    v_fma_f32 v80, v80, v79, v79
    s_add_u32 m0, s33, 77824
    s_mov_b32 s76, 3735552
    buffer_load_dwordx4 v23, s[40:43], s76 offen offset:0 lds
    v_fma_f32 v81, v81, v79, v79
    v_fma_f32 v82, v82, v79, v79
    v_fma_f32 v83, v83, v79, v79
    v_rcp_f32 v80, v80
    v_rcp_f32 v81, v81
    v_rcp_f32 v82, v82
    s_add_u32 m0, s33, 79872
    s_nop 0
    buffer_load_dwordx4 v23, s[40:43], s76 offen offset:2048 lds
    v_rcp_f32 v83, v83
    s_nop 0
    v_mul_f32 v196, v196, v80
    v_mul_f32 v197, v197, v81
    v_mul_f32 v198, v198, v82
    v_mul_f32 v199, v199, v83
    v_cvt_pk_bf16_f32 v194, v196, v197
    v_cvt_pk_bf16_f32 v195, v198, v199
    s_add_u32 m0, s33, 86016
    s_nop 0
    buffer_load_dwordx4 v23, s[44:47], s76 offen offset:0 lds
    s_nop 1
    v_permlane16_swap_b32 v192, v194
    v_permlane16_swap_b32 v193, v195
    s_add_u32 m0, s33, 90112
    s_mov_b32 s77, 4358144
    buffer_load_dwordx4 v22, s[48:51], s77 offen offset:0 lds
    v_fmac_f32 v216, v56, v64
    v_fmac_f32 v217, v57, v64
    v_fmac_f32 v218, v58, v64
    v_fmac_f32 v219, v59, v64
    v_fmac_f32 v232, v60, v64
    v_fmac_f32 v233, v61, v64
    v_fmac_f32 v234, v62, v64
    v_fmac_f32 v235, v63, v64
    s_add_u32 m0, s33, 94208
    s_nop 0
    buffer_load_dwordx4 v22, s[52:55], s77 offen offset:0 lds
    v_mul_f32 v80, v216, v216
    v_mul_f32 v81, v217, v217
    v_mul_f32 v82, v218, v218
    v_mul_f32 v83, v219, v219
    v_fma_f32 v80, v80, v66, v65
    v_fma_f32 v81, v81, v66, v65
    v_fma_f32 v82, v82, v66, v65
    v_fma_f32 v83, v83, v66, v65
    buffer_store_dwordx4 v[192:195], v19, s[68:71], s73 offen offset:2560 sc1
    s_load_dword s94, s[10:11], s75 offset:0x800c0
    s_load_dword s94, s[10:11], s75 offset:0x80100
    s_load_dword s94, s[10:11], s75 offset:0x80140
    s_load_dword s94, s[10:11], s75 offset:0x80180
    s_load_dword s94, s[10:11], s75 offset:0x801c0
    s_waitcnt vmcnt(17)
    s_barrier
    s_add_u32 m0, s79, 100352
    s_mov_b32 s78, 34048
    buffer_load_dwordx4 v20, s[36:39], s78 offen sc1 lds
    v_mul_f32 v80, v80, v216
    v_mul_f32 v81, v81, v217
    v_mul_f32 v82, v82, v218
    v_mul_f32 v83, v83, v219
    v_exp_f32 v80, v80
    v_mul_f32 v216, v216, v232
    v_exp_f32 v81, v81
    s_add_u32 m0, s79, 101376
    s_nop 0
    buffer_load_dwordx4 v21, s[36:39], s78 offen sc1 lds
    v_mul_f32 v217, v217, v233
    v_exp_f32 v82, v82
    v_mul_f32 v218, v218, v234
    v_exp_f32 v83, v83
    v_mul_f32 v219, v219, v235
    v_fma_f32 v80, v80, v67, v67
    s_add_u32 m0, s81, 114688
    s_mov_b32 s78, 1280
    s_mov_b64 exec, 0xffffffff
    buffer_load_dwordx4 v3, s[36:39], s78 offen sc1 lds
    s_mov_b64 exec, -1
    v_fma_f32 v81, v81, v67, v67
    v_fma_f32 v82, v82, v67, v67
    v_fma_f32 v83, v83, v67, v67
    v_rcp_f32 v80, v80
    v_rcp_f32 v81, v81
    v_rcp_f32 v82, v82
    s_add_u32 m0, s33, 16384
    s_mov_b32 s76, 3932160
    buffer_load_dwordx4 v23, s[40:43], s76 offen offset:0 lds
    s_add_u32 m0, s33, 18432
    s_nop 0
    buffer_load_dwordx4 v23, s[40:43], s76 offen offset:2048 lds
    v_rcp_f32 v83, v83
    s_nop 0
    v_mul_f32 v216, v216, v80
    v_mul_f32 v217, v217, v81
    v_mul_f32 v218, v218, v82
    v_mul_f32 v219, v219, v83
    v_cvt_pk_bf16_f32 v216, v216, v217
    v_cvt_pk_bf16_f32 v217, v218, v219
    s_add_u32 m0, s33, 24576
    s_nop 0
    buffer_load_dwordx4 v23, s[44:47], s76 offen offset:0 lds
    v_fmac_f32 v220, v56, v68
    v_fmac_f32 v221, v57, v68
    v_fmac_f32 v222, v58, v68
    v_fmac_f32 v223, v59, v68
    v_fmac_f32 v236, v60, v68
    v_fmac_f32 v237, v61, v68
    v_fmac_f32 v238, v62, v68
    v_fmac_f32 v239, v63, v68
    s_add_u32 m0, s33, 28672
    s_mov_b32 s77, 4587520
    buffer_load_dwordx4 v22, s[48:51], s77 offen offset:0 lds
    v_mul_f32 v80, v220, v220
    v_mul_f32 v81, v221, v221
    v_mul_f32 v82, v222, v222
    v_mul_f32 v83, v223, v223
    v_fma_f32 v80, v80, v70, v69
    v_fma_f32 v81, v81, v70, v69
    v_fma_f32 v82, v82, v70, v69
    v_fma_f32 v83, v83, v70, v69
    s_add_u32 m0, s33, 32768
    s_nop 0
    buffer_load_dwordx4 v22, s[52:55], s77 offen offset:0 lds
    s_add_u32 s75, s75, 0xffb00000
    s_load_dword s94, s[20:21], s75 offset:0x0
    s_load_dword s94, s[20:21], s75 offset:0x40
    s_load_dword s94, s[20:21], s75 offset:0x80
    s_load_dword s94, s[20:21], s75 offset:0xc0
    s_load_dword s94, s[20:21], s75 offset:0x100
    s_waitcnt vmcnt(16)
    s_barrier
    s_add_u32 m0, s79, 116736
    s_mov_b32 s78, 1408
    buffer_load_dwordx4 v20, s[36:39], s78 offen sc1 lds
    v_mul_f32 v80, v80, v220
    v_mul_f32 v81, v81, v221
    v_mul_f32 v82, v82, v222
    v_mul_f32 v83, v83, v223
    v_exp_f32 v80, v80
    v_mul_f32 v220, v220, v236
    v_exp_f32 v81, v81
    s_add_u32 m0, s79, 117760
    s_nop 0
    buffer_load_dwordx4 v21, s[36:39], s78 offen sc1 lds
    v_mul_f32 v221, v221, v237
    v_exp_f32 v82, v82
    v_mul_f32 v222, v222, v238
    v_exp_f32 v83, v83
    v_mul_f32 v223, v223, v239
    v_fma_f32 v80, v80, v71, v71
    s_add_u32 m0, s33, 36864
    s_mov_b32 s76, 4128768
    buffer_load_dwordx4 v23, s[40:43], s76 offen offset:0 lds
    v_fma_f32 v81, v81, v71, v71
    v_fma_f32 v82, v82, v71, v71
    v_fma_f32 v83, v83, v71, v71
    v_rcp_f32 v80, v80
    v_rcp_f32 v81, v81
    v_rcp_f32 v82, v82
    s_add_u32 m0, s33, 38912
    s_nop 0
    buffer_load_dwordx4 v23, s[40:43], s76 offen offset:2048 lds
    v_rcp_f32 v83, v83
    s_nop 0
    v_mul_f32 v220, v220, v80
    v_mul_f32 v221, v221, v81
    v_mul_f32 v222, v222, v82
    v_mul_f32 v223, v223, v83
    v_cvt_pk_bf16_f32 v218, v220, v221
    v_cvt_pk_bf16_f32 v219, v222, v223
    s_add_u32 m0, s33, 45056
    s_nop 0
    buffer_load_dwordx4 v23, s[44:47], s76 offen offset:0 lds
    s_nop 1
    v_permlane16_swap_b32 v216, v218
    v_permlane16_swap_b32 v217, v219
    s_add_u32 m0, s33, 49152
    s_mov_b32 s77, 4816896
    buffer_load_dwordx4 v22, s[48:51], s77 offen offset:0 lds
    v_fmac_f32 v224, v56, v72
    v_fmac_f32 v225, v57, v72
    v_fmac_f32 v226, v58, v72
    v_fmac_f32 v227, v59, v72
    v_fmac_f32 v240, v60, v72
    v_fmac_f32 v241, v61, v72
    v_fmac_f32 v242, v62, v72
    v_fmac_f32 v243, v63, v72
    s_add_u32 m0, s33, 53248
    s_nop 0
    buffer_load_dwordx4 v22, s[52:55], s77 offen offset:0 lds
    v_mul_f32 v80, v224, v224
    v_mul_f32 v81, v225, v225
    v_mul_f32 v82, v226, v226
    v_mul_f32 v83, v227, v227
    v_fma_f32 v80, v80, v74, v73
    v_fma_f32 v81, v81, v74, v73
    v_fma_f32 v82, v82, v74, v73
    v_fma_f32 v83, v83, v74, v73
    buffer_store_dwordx4 v[216:219], v19, s[68:71], s74 offen offset:0 sc1
    s_load_dword s94, s[20:21], s75 offset:0x140
    s_load_dword s94, s[20:21], s75 offset:0x180
    s_load_dword s94, s[20:21], s75 offset:0x1c0
    s_add_u32 s75, s75, 0x280000
    s_load_dword s94, s[20:21], s75 offset:0x0
    s_load_dword s94, s[20:21], s75 offset:0x40
    s_waitcnt vmcnt(17)
    s_barrier
    s_add_u32 m0, s79, 118784
    s_mov_b32 s78, 34176
    buffer_load_dwordx4 v20, s[36:39], s78 offen sc1 lds
    v_mul_f32 v80, v80, v224
    v_mul_f32 v81, v81, v225
    v_mul_f32 v82, v82, v226
    v_mul_f32 v83, v83, v227
    v_exp_f32 v80, v80
    v_mul_f32 v224, v224, v240
    v_exp_f32 v81, v81
    s_add_u32 m0, s79, 119808
    s_nop 0
    buffer_load_dwordx4 v21, s[36:39], s78 offen sc1 lds
    v_mul_f32 v225, v225, v241
    v_exp_f32 v82, v82
    v_mul_f32 v226, v226, v242
    v_exp_f32 v83, v83
    v_mul_f32 v227, v227, v243
    v_fma_f32 v80, v80, v75, v75
    s_add_u32 m0, s81, 133120
    s_mov_b32 s78, 1408
    s_mov_b64 exec, 0xffffffff
    buffer_load_dwordx4 v3, s[36:39], s78 offen sc1 lds
    s_mov_b64 exec, -1
    v_fma_f32 v81, v81, v75, v75
    v_fma_f32 v82, v82, v75, v75
    v_fma_f32 v83, v83, v75, v75
    v_rcp_f32 v80, v80
    v_rcp_f32 v81, v81
    v_rcp_f32 v82, v82
    s_add_u32 m0, s33, 57344
    s_mov_b32 s76, 4325376
    buffer_load_dwordx4 v23, s[40:43], s76 offen offset:0 lds
    s_add_u32 m0, s33, 59392
    s_nop 0
    buffer_load_dwordx4 v23, s[40:43], s76 offen offset:2048 lds
    v_rcp_f32 v83, v83
    s_nop 0
    v_mul_f32 v224, v224, v80
    v_mul_f32 v225, v225, v81
    v_mul_f32 v226, v226, v82
    v_mul_f32 v227, v227, v83
    v_cvt_pk_bf16_f32 v224, v224, v225
    v_cvt_pk_bf16_f32 v225, v226, v227
    s_add_u32 m0, s33, 65536
    s_nop 0
    buffer_load_dwordx4 v23, s[44:47], s76 offen offset:0 lds
    v_fmac_f32 v228, v56, v76
    v_fmac_f32 v229, v57, v76
    v_fmac_f32 v230, v58, v76
    v_fmac_f32 v231, v59, v76
    v_fmac_f32 v244, v60, v76
    v_fmac_f32 v245, v61, v76
    v_fmac_f32 v246, v62, v76
    v_fmac_f32 v247, v63, v76
    s_add_u32 m0, s33, 69632
    s_mov_b32 s77, 5046272
    buffer_load_dwordx4 v22, s[48:51], s77 offen offset:0 lds
    v_mul_f32 v80, v228, v228
    v_mul_f32 v81, v229, v229
    v_mul_f32 v82, v230, v230
    v_mul_f32 v83, v231, v231
    v_fma_f32 v80, v80, v78, v77
    v_fma_f32 v81, v81, v78, v77
    v_fma_f32 v82, v82, v78, v77
    v_fma_f32 v83, v83, v78, v77
    s_add_u32 m0, s33, 73728
    s_nop 0
    buffer_load_dwordx4 v22, s[52:55], s77 offen offset:0 lds
    s_load_dword s94, s[20:21], s75 offset:0x80
    s_load_dword s94, s[20:21], s75 offset:0xc0
    s_load_dword s94, s[20:21], s75 offset:0x100
    s_load_dword s94, s[20:21], s75 offset:0x140
    s_load_dword s94, s[20:21], s75 offset:0x180
    s_lshl_b32 s91, s4, 6
    s_add_u32 s91, s91, s29
    s_lshl_b32 s91, s91, 7
    s_add_u32 s91, s91, 0x1eb0000
    v_lshl_add_u32 v13, v1, 11, s91
    s_mov_b64 exec, 15
    global_load_dwordx2 v[14:15], v13, s[26:27] sc1
    s_mov_b64 exec, -1
    s_waitcnt vmcnt(17)
    s_barrier
    s_mov_b64 exec, 0
    s_cmp_eq_u32 s4, 0
    s_cbranch_scc1 L_pad4
    s_cmp_eq_u32 s4, 1
    s_cbranch_scc1 L_pad5
    s_cmp_eq_u32 s4, 2
    s_cbranch_scc1 L_pad10
    s_cmp_eq_u32 s4, 3
    s_cbranch_scc1 L_pad11
L_vret2:
    s_mov_b64 exec, -1
    v_mul_f32 v80, v80, v228
    v_mul_f32 v81, v81, v229
    v_mul_f32 v82, v82, v230
    v_mul_f32 v83, v83, v231
    v_exp_f32 v80, v80
    v_mul_f32 v228, v228, v244
    v_exp_f32 v81, v81
    v_mul_f32 v229, v229, v245
    v_exp_f32 v82, v82
    v_mul_f32 v230, v230, v246
    v_exp_f32 v83, v83
    v_mul_f32 v231, v231, v247
    v_fma_f32 v80, v80, v79, v79
    v_fma_f32 v81, v81, v79, v79
    v_fma_f32 v82, v82, v79, v79
    v_fma_f32 v83, v83, v79, v79
    v_rcp_f32 v80, v80
    v_rcp_f32 v81, v81
    v_rcp_f32 v82, v82
    v_rcp_f32 v83, v83
    s_nop 0
    v_mul_f32 v228, v228, v80
    v_mul_f32 v229, v229, v81
    v_mul_f32 v230, v230, v82
    v_mul_f32 v231, v231, v83
    v_cvt_pk_bf16_f32 v226, v228, v229
    v_cvt_pk_bf16_f32 v227, v230, v231
    s_nop 1
    v_permlane16_swap_b32 v224, v226
    v_permlane16_swap_b32 v225, v227
    buffer_store_dwordx4 v[224:227], v19, s[68:71], s74 offen offset:2048 sc1
    s_load_dword s94, s[20:21], s75 offset:0x1c0
    s_add_u32 s75, s75, 0xffe00000
    s_load_dword s94, s[20:21], s75 offset:0x0
    s_load_dword s94, s[20:21], s75 offset:0x40
    s_load_dword s94, s[20:21], s75 offset:0x80
    s_load_dword s94, s[20:21], s75 offset:0xc0
    s_waitcnt vmcnt(11)
    s_barrier
    s_add_u32 m0, s79, 135168
    s_mov_b32 s78, 1536
    buffer_load_dwordx4 v20, s[36:39], s78 offen sc1 lds
    s_add_u32 m0, s79, 136192
    s_nop 0
    buffer_load_dwordx4 v21, s[36:39], s78 offen sc1 lds
    s_add_u32 m0, s33, 77824
    s_mov_b32 s76, 4521984
    buffer_load_dwordx4 v23, s[40:43], s76 offen offset:0 lds
    s_add_u32 m0, s33, 79872
    s_nop 0
    buffer_load_dwordx4 v23, s[40:43], s76 offen offset:2048 lds
    s_add_u32 m0, s33, 86016
    s_nop 0
    buffer_load_dwordx4 v23, s[44:47], s76 offen offset:0 lds
    s_add_u32 m0, s33, 90112
    s_mov_b32 s77, 5275648
    buffer_load_dwordx4 v22, s[48:51], s77 offen offset:0 lds
    s_add_u32 m0, s33, 94208
    s_nop 0
    buffer_load_dwordx4 v22, s[52:55], s77 offen offset:0 lds
    s_add_u32 m0, s79, 137216
    s_mov_b32 s78, 34304
    buffer_load_dwordx4 v20, s[36:39], s78 offen sc1 lds
    s_add_u32 m0, s79, 138240
    s_nop 0
    buffer_load_dwordx4 v21, s[36:39], s78 offen sc1 lds
    s_add_u32 m0, s81, 151552
    s_mov_b32 s78, 1536
    s_mov_b64 exec, 0xffffffff
    buffer_load_dwordx4 v3, s[36:39], s78 offen sc1 lds
    s_mov_b64 exec, -1
    s_load_dword s94, s[20:21], s75 offset:0x100
    s_load_dword s94, s[20:21], s75 offset:0x140
    s_load_dword s94, s[20:21], s75 offset:0x180
    s_load_dword s94, s[20:21], s75 offset:0x1c0
    s_add_u32 s75, s75, 0x280000
    s_load_dword s94, s[20:21], s75 offset:0x0
    s_waitcnt vmcnt(11)
    s_mov_b64 exec, 15
    s_movk_i32 s98, 0x4000
L_pC_chk:
    v_cmp_ne_u64 vcc, s[100:101], v[14:15]
    s_nop 1
    s_cmp_eq_u64 vcc, 0
    s_cbranch_scc1 L_pC_ok
    s_sub_u32 s98, s98, 1
    s_cbranch_scc1 L_pC_ok
    s_sleep 1
    global_load_dwordx2 v[14:15], v13, s[26:27] sc1
    s_waitcnt vmcnt(0)
    s_branch L_pC_chk
L_pC_ok:
    s_mov_b64 exec, -1
    s_waitcnt vmcnt(12)
    s_barrier
    s_add_u32 m0, s33, 16384
    s_mov_b32 s76, 4718592
    buffer_load_dwordx4 v23, s[40:43], s76 offen offset:0 lds
    s_add_u32 m0, s33, 18432
    s_nop 0
    buffer_load_dwordx4 v23, s[40:43], s76 offen offset:2048 lds
    s_add_u32 m0, s33, 24576
    s_nop 0
    buffer_load_dwordx4 v23, s[44:47], s76 offen offset:0 lds
    s_add_u32 m0, s33, 28672
    s_mov_b32 s77, 5505024
    buffer_load_dwordx4 v22, s[48:51], s77 offen offset:0 lds
    s_add_u32 m0, s33, 32768
    s_nop 0
    buffer_load_dwordx4 v22, s[52:55], s77 offen offset:0 lds
    s_add_u32 m0, s79, 98304
    s_mov_b32 s78, 1664
    buffer_load_dwordx4 v20, s[36:39], s78 offen sc1 lds
    s_add_u32 m0, s79, 99328
    s_nop 0
    buffer_load_dwordx4 v21, s[36:39], s78 offen sc1 lds
    s_add_u32 m0, s33, 36864
    s_mov_b32 s76, 4915200
    buffer_load_dwordx4 v23, s[40:43], s76 offen offset:0 lds
    s_add_u32 m0, s33, 38912
    s_nop 0
    buffer_load_dwordx4 v23, s[40:43], s76 offen offset:2048 lds
    s_add_u32 m0, s33, 45056
    s_nop 0
    buffer_load_dwordx4 v23, s[44:47], s76 offen offset:0 lds
    s_add_u32 m0, s33, 49152
    s_mov_b32 s77, 5734400
    buffer_load_dwordx4 v22, s[48:51], s77 offen offset:0 lds
    s_load_dword s94, s[20:21], s75 offset:0x40
    s_load_dword s94, s[20:21], s75 offset:0x80
    s_load_dword s94, s[20:21], s75 offset:0xc0
    s_load_dword s94, s[20:21], s75 offset:0x100
    s_load_dword s94, s[20:21], s75 offset:0x140
    s_waitcnt vmcnt(14)
    s_barrier
    s_add_u32 m0, s33, 53248
    s_nop 0
    buffer_load_dwordx4 v22, s[52:55], s77 offen offset:0 lds
    s_add_u32 m0, s79, 100352
    s_mov_b32 s78, 34432
    buffer_load_dwordx4 v20, s[36:39], s78 offen sc1 lds
    s_add_u32 m0, s79, 101376
    s_nop 0
    buffer_load_dwordx4 v21, s[36:39], s78 offen sc1 lds
    s_add_u32 m0, s81, 114688
    s_mov_b32 s78, 1664
    s_mov_b64 exec, 0xffffffff
    buffer_load_dwordx4 v3, s[36:39], s78 offen sc1 lds
    s_mov_b64 exec, -1
    s_add_u32 m0, s33, 57344
    s_mov_b32 s76, 5111808
    buffer_load_dwordx4 v23, s[40:43], s76 offen offset:0 lds
    s_add_u32 m0, s33, 59392
    s_nop 0
    buffer_load_dwordx4 v23, s[40:43], s76 offen offset:2048 lds
    s_add_u32 m0, s33, 65536
    s_nop 0
    buffer_load_dwordx4 v23, s[44:47], s76 offen offset:0 lds
    s_add_u32 m0, s33, 69632
    s_mov_b32 s77, 5963776
    buffer_load_dwordx4 v22, s[48:51], s77 offen offset:0 lds
    s_add_u32 m0, s33, 73728
    s_nop 0
    buffer_load_dwordx4 v22, s[52:55], s77 offen offset:0 lds
    s_load_dword s94, s[20:21], s75 offset:0x180
    s_load_dword s94, s[20:21], s75 offset:0x1c0
    s_add_u32 s75, s75, 0xffe00000
    s_load_dword s94, s[20:21], s75 offset:0x0
    s_load_dword s94, s[20:21], s75 offset:0x40
    s_load_dword s94, s[20:21], s75 offset:0x80
    s_waitcnt vmcnt(30)
    s_waitcnt vmcnt(15)
    s_barrier
    s_mov_b64 exec, 0
    s_cmp_eq_u32 s4, 0
    s_cbranch_scc1 L_pad12
L_vret3:
    s_mov_b64 exec, -1
    s_load_dword s94, s[20:21], s75 offset:0xc0
    s_load_dword s94, s[20:21], s75 offset:0x100
    s_load_dword s94, s[20:21], s75 offset:0x140
    s_load_dword s94, s[20:21], s75 offset:0x180
    s_load_dword s94, s[20:21], s75 offset:0x1c0
    s_cmp_lg_u32 s4, 0
    s_cbranch_scc1 L_fH1
    s_lshl_b32 s91, s28, 4
    s_add_u32 s91, s91, s29
    s_lshl_b32 s91, s91, 7
    s_add_u32 s91, s91, 0x1e88000
    v_mov_b32 v12, s91
    v_mov_b32 v14, s100
    v_mov_b32 v15, s101
    s_mov_b64 exec, 1
    global_store_dwordx2 v12, v[14:15], s[26:27] sc1
    s_mov_b64 exec, -1
L_fH1:
    s_waitcnt vmcnt(8)
    s_barrier
    s_add_u32 m0, s79, 116736
    s_mov_b32 s78, 1792
    buffer_load_dwordx4 v20, s[36:39], s78 offen sc1 lds
    s_add_u32 m0, s79, 117760
    s_nop 0
    buffer_load_dwordx4 v21, s[36:39], s78 offen sc1 lds
    s_add_u32 m0, s33, 77824
    s_mov_b32 s76, 5308416
    buffer_load_dwordx4 v23, s[40:43], s76 offen offset:0 lds
    s_add_u32 m0, s33, 79872
    s_nop 0
    buffer_load_dwordx4 v23, s[40:43], s76 offen offset:2048 lds
    s_add_u32 m0, s33, 86016
    s_nop 0
    buffer_load_dwordx4 v23, s[44:47], s76 offen offset:0 lds
    s_add_u32 m0, s33, 90112
    s_mov_b32 s77, 6193152
    buffer_load_dwordx4 v22, s[48:51], s77 offen offset:0 lds
    s_add_u32 m0, s33, 94208
    s_nop 0
    buffer_load_dwordx4 v22, s[52:55], s77 offen offset:0 lds
    s_add_u32 m0, s79, 118784
    s_mov_b32 s78, 34560
    buffer_load_dwordx4 v20, s[36:39], s78 offen sc1 lds
    s_add_u32 m0, s79, 119808
    s_nop 0
    buffer_load_dwordx4 v21, s[36:39], s78 offen sc1 lds
    s_add_u32 m0, s81, 133120
    s_mov_b32 s78, 1792
    s_mov_b64 exec, 0xffffffff
    buffer_load_dwordx4 v3, s[36:39], s78 offen sc1 lds
    s_mov_b64 exec, -1
    s_add_u32 s75, s75, 0x280000
    s_load_dword s94, s[20:21], s75 offset:0x0
    s_load_dword s94, s[20:21], s75 offset:0x40
L_pad3:
    s_cbranch_execz L_vret1
    s_load_dword s94, s[20:21], s75 offset:0x80
    s_load_dword s94, s[20:21], s75 offset:0xc0
    s_load_dword s94, s[20:21], s75 offset:0x100
    s_waitcnt vmcnt(10)
    s_barrier
    s_add_u32 m0, s33, 16384
    s_mov_b32 s76, 5505024
    buffer_load_dwordx4 v23, s[40:43], s76 offen offset:0 lds
    s_add_u32 m0, s33, 18432
    s_nop 0
    buffer_load_dwordx4 v23, s[40:43], s76 offen offset:2048 lds
    s_add_u32 m0, s33, 24576
    s_nop 0
    buffer_load_dwordx4 v23, s[44:47], s76 offen offset:0 lds
    s_add_u32 m0, s33, 28672
    s_mov_b32 s77, 6422528
    buffer_load_dwordx4 v22, s[48:51], s77 offen offset:0 lds
    s_add_u32 m0, s33, 32768
    s_nop 0
    buffer_load_dwordx4 v22, s[52:55], s77 offen offset:0 lds
    s_add_u32 m0, s79, 135168
    s_mov_b32 s78, 1920
    buffer_load_dwordx4 v20, s[36:39], s78 offen sc1 lds
    s_add_u32 m0, s79, 136192
    s_nop 0
    buffer_load_dwordx4 v21, s[36:39], s78 offen sc1 lds
    s_add_u32 m0, s33, 36864
    s_mov_b32 s76, 5701632
    buffer_load_dwordx4 v23, s[40:43], s76 offen offset:0 lds
    s_add_u32 m0, s33, 38912
    s_nop 0
    buffer_load_dwordx4 v23, s[40:43], s76 offen offset:2048 lds
    s_add_u32 m0, s33, 45056
    s_nop 0
    buffer_load_dwordx4 v23, s[44:47], s76 offen offset:0 lds
    s_add_u32 m0, s33, 49152
    s_mov_b32 s77, 6651904
    buffer_load_dwordx4 v22, s[48:51], s77 offen offset:0 lds
    s_load_dword s94, s[20:21], s75 offset:0x140
    s_load_dword s94, s[20:21], s75 offset:0x180
    s_load_dword s94, s[20:21], s75 offset:0x1c0
    s_add_u32 s75, s75, 0xffe00000
    s_load_dword s94, s[20:21], s75 offset:0x0
    s_load_dword s94, s[20:21], s75 offset:0x40
    s_waitcnt vmcnt(14)
    s_barrier
    s_add_u32 m0, s33, 53248
    s_nop 0
    buffer_load_dwordx4 v22, s[52:55], s77 offen offset:0 lds
    s_add_u32 m0, s79, 137216
    s_mov_b32 s78, 34688
    buffer_load_dwordx4 v20, s[36:39], s78 offen sc1 lds
    s_add_u32 m0, s79, 138240
    s_nop 0
    buffer_load_dwordx4 v21, s[36:39], s78 offen sc1 lds
    s_add_u32 m0, s81, 151552
    s_mov_b32 s78, 1920
    s_mov_b64 exec, 0xffffffff
    buffer_load_dwordx4 v3, s[36:39], s78 offen sc1 lds
    s_mov_b64 exec, -1
    s_add_u32 m0, s33, 57344
    s_mov_b32 s76, 5898240
    buffer_load_dwordx4 v23, s[40:43], s76 offen offset:0 lds
    s_add_u32 m0, s33, 59392
    s_nop 0
    buffer_load_dwordx4 v23, s[40:43], s76 offen offset:2048 lds
    s_add_u32 m0, s33, 65536
    s_nop 0
    buffer_load_dwordx4 v23, s[44:47], s76 offen offset:0 lds
    s_add_u32 m0, s33, 69632
    s_mov_b32 s77, 6881280
    buffer_load_dwordx4 v22, s[48:51], s77 offen offset:0 lds
    s_add_u32 m0, s33, 73728
    s_nop 0
    buffer_load_dwordx4 v22, s[52:55], s77 offen offset:0 lds
    s_lshl2_add_u32 s91, s30, s4
    s_lshl_b32 s91, s91, 9
    s_add_u32 s91, s91, 0x1e88000
    v_lshl_add_u32 v13, v1, 7, s91
    s_mov_b64 exec, 15
    global_load_dwordx2 v[14:15], v13, s[26:27] sc1
    s_mov_b64 exec, -1
    s_waitcnt vmcnt(16)
    s_barrier
    s_add_u32 m0, s33, 77824
    s_mov_b32 s76, 6094848
    buffer_load_dwordx4 v23, s[40:43], s76 offen offset:0 lds
    s_add_u32 m0, s33, 79872
    s_nop 0
    buffer_load_dwordx4 v23, s[40:43], s76 offen offset:2048 lds
    s_add_u32 m0, s33, 86016
    s_nop 0
    buffer_load_dwordx4 v23, s[44:47], s76 offen offset:0 lds
    s_add_u32 m0, s33, 90112
    s_mov_b32 s77, 7110656
    buffer_load_dwordx4 v22, s[48:51], s77 offen offset:0 lds
    s_add_u32 m0, s33, 94208
    s_nop 0
    buffer_load_dwordx4 v22, s[52:55], s77 offen offset:0 lds
    s_waitcnt vmcnt(5)
    s_mov_b64 exec, 15
    s_movk_i32 s98, 0x4000
L_pH1_chk:
    v_cmp_ne_u64 vcc, s[100:101], v[14:15]
    s_nop 1
    s_cmp_eq_u64 vcc, 0
    s_cbranch_scc1 L_pH1_ok
    s_sub_u32 s98, s98, 1
    s_cbranch_scc1 L_pH1_ok
    s_sleep 1
    global_load_dwordx2 v[14:15], v13, s[26:27] sc1
    s_waitcnt vmcnt(0)
    s_branch L_pH1_chk
L_pH1_ok:
    s_mov_b64 exec, -1
    s_waitcnt vmcnt(14)
    s_barrier
    s_mov_b32 s40, s34
    s_mov_b32 s42, s35
    s_memrealtime s[44:45]
    s_memtime s[46:47]
    s_lshl4_add_u32 s91, s28, s29
    s_lshl_b32 s91, s91, 7
    s_add_u32 s92, s91, 0x1ea8000
    s_xor_b32 s91, s91, 17408
    s_add_u32 s91, s91, 0x1ea8000
    v_mov_b32 v239, s92
    v_writelane_b32 v239, s91, 1
    s_lshl_b32 m0, s33, 2
    s_nop 0
    buffer_load_dwordx4 v18, s[56:59], s82 offen offset:0 sc1 lds
    buffer_load_dwordx4 v18, s[56:59], s82 offen offset:1024 sc1 lds
    buffer_load_dwordx4 v18, s[56:59], s82 offen offset:2048 sc1 lds
    buffer_load_dwordx4 v18, s[56:59], s82 offen offset:3072 sc1 lds
    s_add_u32 s82, s82, 16384
    s_lshl1_add_u32 m0, s33, 16384
    s_nop 0
    buffer_load_dwordx4 v254, s[60:63], s83 offen lds
    s_lshl1_add_u32 m0, s33, 17408
    s_nop 0
    buffer_load_dwordx4 v255, s[60:63], s83 offen lds
    s_lshl1_add_u32 m0, s33, 24576
    s_nop 0
    buffer_load_dwordx4 v254, s[64:67], s83 offen lds
    s_lshl1_add_u32 m0, s33, 25600
    s_nop 0
    buffer_load_dwordx4 v255, s[64:67], s83 offen lds
    s_add_u32 s83, s83, 131072
    s_lshl_b32 s84, s2, 15
    s_lshl_b32 s85, s4, 13
    s_add_u32 s84, s84, s85
    s_add_u32 s36, s84, 0x1600000
    s_add_u32 s37, s36, 4096
    s_xor_b32 s84, s84, 163840
    s_add_u32 s38, s84, 0x1600000
    s_add_u32 s39, s38, 4096
    v_lshlrev_b32 v4, 4, v1
    s_lshl_b32 s84, s4, 12
    s_add_u32 s84, s84, 147456
    v_lshl_add_u32 v5, v1, 3, s84
    v_lshlrev_b32 v6, 2, v1
    s_waitcnt vmcnt(14)
    s_barrier
    s_lshl2_add_u32 m0, s33, 98304
    s_nop 0
    buffer_load_dwordx4 v18, s[56:59], s82 offen offset:0 sc1 lds
    buffer_load_dwordx4 v18, s[56:59], s82 offen offset:1024 sc1 lds
    buffer_load_dwordx4 v18, s[56:59], s82 offen offset:2048 sc1 lds
    buffer_load_dwordx4 v18, s[56:59], s82 offen offset:3072 sc1 lds
    s_add_u32 s82, s82, 16384
    s_lshl1_add_u32 m0, s33, 114688
    s_nop 0
    buffer_load_dwordx4 v254, s[60:63], s83 offen lds
    s_lshl1_add_u32 m0, s33, 115712
    s_nop 0
    buffer_load_dwordx4 v255, s[60:63], s83 offen lds
    s_lshl1_add_u32 m0, s33, 122880
    s_nop 0
    buffer_load_dwordx4 v254, s[64:67], s83 offen lds
    s_lshl1_add_u32 m0, s33, 123904
    s_nop 0
    buffer_load_dwordx4 v255, s[64:67], s83 offen lds
    s_add_u32 s83, s83, 131072
    s_waitcnt lgkmcnt(0)
    s_sub_u32 s40, s44, s40
    s_sub_u32 s42, s46, s42
    v_cvt_f32_u32 v8, s42
    v_cvt_f32_u32 v9, s40
    v_rcp_f32 v8, v8
    v_mul_f32 v9, 0x463b8000, v9
    v_mul_f32 v8, v8, v9
    v_cvt_u32_f32 v10, v8
    v_add_u32 v10, s44, v10
    v_mov_b32 v8, s100
    v_mov_b32 v9, s101
    s_cmp_eq_u32 s4, 0
    s_cselect_b64 exec, 1, 0
    s_cbranch_execz L_tp
    global_store_dwordx3 v239, v[8:10], s[26:27] sc1
L_tp:
    s_mov_b64 exec, -1
    s_waitcnt vmcnt(8)
    s_barrier
    s_lshl2_add_u32 m0, s33, 32768
    s_nop 0
    buffer_load_dwordx4 v18, s[56:59], s82 offen offset:0 sc1 lds
    buffer_load_dwordx4 v18, s[56:59], s82 offen offset:1024 sc1 lds
    buffer_load_dwordx4 v18, s[56:59], s82 offen offset:2048 sc1 lds
    buffer_load_dwordx4 v18, s[56:59], s82 offen offset:3072 sc1 lds
    s_add_u32 s82, s82, 16384
    s_lshl1_add_u32 m0, s33, 49152
    s_nop 0
    buffer_load_dwordx4 v254, s[60:63], s83 offen lds
    s_lshl1_add_u32 m0, s33, 50176
    s_nop 0
    buffer_load_dwordx4 v255, s[60:63], s83 offen lds
    s_lshl1_add_u32 m0, s33, 57344
    s_nop 0
    buffer_load_dwordx4 v254, s[64:67], s83 offen lds
    s_lshl1_add_u32 m0, s33, 58368
    s_nop 0
    buffer_load_dwordx4 v255, s[64:67], s83 offen lds
    s_add_u32 s83, s83, 131072
    ds_read_b64_tr_b16 v[40:41], v250 offset:16384
    ds_read_b64_tr_b16 v[42:43], v250 offset:16896
    ds_read_b128 v[24:27], v248 offset:0
    ds_read_b128 v[28:31], v248 offset:1024
    ds_read_b128 v[32:35], v248 offset:2048
    ds_read_b128 v[36:39], v248 offset:3072
    ds_read_b64_tr_b16 v[44:45], v251 offset:16384
    ds_read_b64_tr_b16 v[46:47], v251 offset:16896
    ds_read_b64_tr_b16 v[48:49], v250 offset:24576
    ds_read_b64_tr_b16 v[50:51], v250 offset:25088
    ds_read_b64_tr_b16 v[52:53], v251 offset:24576
    ds_read_b64_tr_b16 v[54:55], v251 offset:25088
    s_barrier
    s_setprio 1
    s_lshl2_add_u32 m0, s33, 65536
    s_nop 0
    buffer_load_dwordx4 v18, s[56:59], s82 offen offset:0 sc1 lds
    buffer_load_dwordx4 v18, s[56:59], s82 offen offset:1024 sc1 lds
    buffer_load_dwordx4 v18, s[56:59], s82 offen offset:2048 sc1 lds
    buffer_load_dwordx4 v18, s[56:59], s82 offen offset:3072 sc1 lds
    s_add_u32 s82, s82, 16384
    s_waitcnt lgkmcnt(9)
    v_mfma_f32_16x16x32_bf16 v[88:91], v[40:43], v[24:27], 0
    ds_read_b64_tr_b16 v[72:73], v250 offset:20480
    ds_read_b64_tr_b16 v[74:75], v250 offset:20992
    s_waitcnt lgkmcnt(10)
    v_mfma_f32_16x16x32_bf16 v[92:95], v[40:43], v[28:31], 0
    ds_read_b128 v[56:59], v248 offset:8192
    s_lshl1_add_u32 m0, s33, 81920
    s_waitcnt lgkmcnt(10)
    v_mfma_f32_16x16x32_bf16 v[96:99], v[40:43], v[32:35], 0
    ds_read_b128 v[60:63], v248 offset:9216
    ds_read_b128 v[64:67], v248 offset:10240
    s_waitcnt lgkmcnt(11)
    v_mfma_f32_16x16x32_bf16 v[100:103], v[40:43], v[36:39], 0
    ds_read_b128 v[68:71], v248 offset:11264
    buffer_load_dwordx4 v254, s[60:63], s83 offen lds
    s_waitcnt lgkmcnt(10)
    v_mfma_f32_16x16x32_bf16 v[104:107], v[44:47], v[24:27], 0
    ds_read_b64_tr_b16 v[76:77], v251 offset:20480
    ds_read_b64_tr_b16 v[78:79], v251 offset:20992
    v_mfma_f32_16x16x32_bf16 v[108:111], v[44:47], v[28:31], 0
    ds_read_b64_tr_b16 v[80:81], v250 offset:28672
    s_lshl1_add_u32 m0, s33, 82944
    v_mfma_f32_16x16x32_bf16 v[112:115], v[44:47], v[32:35], 0
    ds_read_b64_tr_b16 v[82:83], v250 offset:29184
    ds_read_b64_tr_b16 v[84:85], v251 offset:28672
    v_mfma_f32_16x16x32_bf16 v[116:119], v[44:47], v[36:39], 0
    ds_read_b64_tr_b16 v[86:87], v251 offset:29184
    buffer_load_dwordx4 v255, s[60:63], s83 offen lds
    s_waitcnt lgkmcnt(14)
    v_mfma_f32_16x16x32_bf16 v[120:123], v[48:51], v[24:27], 0
    v_mfma_f32_16x16x32_bf16 v[124:127], v[48:51], v[28:31], 0
    s_lshl1_add_u32 m0, s33, 90112
    v_mfma_f32_16x16x32_bf16 v[128:131], v[48:51], v[32:35], 0
    v_mfma_f32_16x16x32_bf16 v[132:135], v[48:51], v[36:39], 0
    buffer_load_dwordx4 v254, s[64:67], s83 offen lds
    s_waitcnt lgkmcnt(12)
    v_mfma_f32_16x16x32_bf16 v[136:139], v[52:55], v[24:27], 0
    v_mfma_f32_16x16x32_bf16 v[140:143], v[52:55], v[28:31], 0
    s_lshl1_add_u32 m0, s33, 91136
    v_mfma_f32_16x16x32_bf16 v[144:147], v[52:55], v[32:35], 0
    v_mfma_f32_16x16x32_bf16 v[148:151], v[52:55], v[36:39], 0
    buffer_load_dwordx4 v255, s[64:67], s83 offen lds
    s_add_u32 s83, s83, 131072
    s_waitcnt vmcnt(16) lgkmcnt(0)
    s_barrier
    v_mfma_f32_16x16x32_bf16 v[88:91], v[72:75], v[56:59], v[88:91]
    ds_read_b64_tr_b16 v[40:41], v252 offset:49152
    ds_read_b64_tr_b16 v[42:43], v252 offset:49664
    v_mfma_f32_16x16x32_bf16 v[92:95], v[72:75], v[60:63], v[92:95]
    ds_read_b128 v[24:27], v249 offset:32768
    s_lshl_b32 m0, s33, 2
    v_mfma_f32_16x16x32_bf16 v[96:99], v[72:75], v[64:67], v[96:99]
    ds_read_b128 v[28:31], v249 offset:33792
    v_mfma_f32_16x16x32_bf16 v[100:103], v[72:75], v[68:71], v[100:103]
    ds_read_b128 v[32:35], v249 offset:34816
    buffer_load_dwordx4 v18, s[56:59], s82 offen offset:0 sc1 lds
    v_mfma_f32_16x16x32_bf16 v[104:107], v[76:79], v[56:59], v[104:107]
    ds_read_b128 v[36:39], v249 offset:35840
    v_mfma_f32_16x16x32_bf16 v[108:111], v[76:79], v[60:63], v[108:111]
    ds_read_b64_tr_b16 v[44:45], v253 offset:49152
    ds_read_b64_tr_b16 v[46:47], v253 offset:49664
    v_mfma_f32_16x16x32_bf16 v[112:115], v[76:79], v[64:67], v[112:115]
    ds_read_b64_tr_b16 v[48:49], v252 offset:57344
    v_mfma_f32_16x16x32_bf16 v[116:119], v[76:79], v[68:71], v[116:119]
    ds_read_b64_tr_b16 v[50:51], v252 offset:57856
    buffer_load_dwordx4 v18, s[56:59], s82 offen offset:1024 sc1 lds
    v_mfma_f32_16x16x32_bf16 v[120:123], v[80:83], v[56:59], v[120:123]
    ds_read_b64_tr_b16 v[52:53], v253 offset:57344
    v_mfma_f32_16x16x32_bf16 v[124:127], v[80:83], v[60:63], v[124:127]
    ds_read_b64_tr_b16 v[54:55], v253 offset:57856
    v_mfma_f32_16x16x32_bf16 v[128:131], v[80:83], v[64:67], v[128:131]
    v_mfma_f32_16x16x32_bf16 v[132:135], v[80:83], v[68:71], v[132:135]
    buffer_load_dwordx4 v18, s[56:59], s82 offen offset:2048 sc1 lds
    v_mfma_f32_16x16x32_bf16 v[136:139], v[84:87], v[56:59], v[136:139]
    v_mfma_f32_16x16x32_bf16 v[140:143], v[84:87], v[60:63], v[140:143]
    v_mfma_f32_16x16x32_bf16 v[144:147], v[84:87], v[64:67], v[144:147]
    v_mfma_f32_16x16x32_bf16 v[148:151], v[84:87], v[68:71], v[148:151]
    buffer_load_dwordx4 v18, s[56:59], s82 offen offset:3072 sc1 lds
    s_add_u32 s82, s82, 16384
    s_waitcnt lgkmcnt(9)
    v_mfma_f32_16x16x32_bf16 v[88:91], v[40:43], v[24:27], v[88:91]
    ds_read_b64_tr_b16 v[72:73], v252 offset:53248
    ds_read_b64_tr_b16 v[74:75], v252 offset:53760
    s_waitcnt lgkmcnt(10)
    v_mfma_f32_16x16x32_bf16 v[92:95], v[40:43], v[28:31], v[92:95]
    ds_read_b128 v[56:59], v249 offset:40960
    s_lshl1_add_u32 m0, s33, 16384
    s_waitcnt lgkmcnt(10)
    v_mfma_f32_16x16x32_bf16 v[96:99], v[40:43], v[32:35], v[96:99]
    ds_read_b128 v[60:63], v249 offset:41984
    ds_read_b128 v[64:67], v249 offset:43008
    s_waitcnt lgkmcnt(11)
    v_mfma_f32_16x16x32_bf16 v[100:103], v[40:43], v[36:39], v[100:103]
    ds_read_b128 v[68:71], v249 offset:44032
    buffer_load_dwordx4 v254, s[60:63], s83 offen lds
    s_waitcnt lgkmcnt(10)
    v_mfma_f32_16x16x32_bf16 v[104:107], v[44:47], v[24:27], v[104:107]
    ds_read_b64_tr_b16 v[76:77], v253 offset:53248
    ds_read_b64_tr_b16 v[78:79], v253 offset:53760
    v_mfma_f32_16x16x32_bf16 v[108:111], v[44:47], v[28:31], v[108:111]
    ds_read_b64_tr_b16 v[80:81], v252 offset:61440
    s_lshl1_add_u32 m0, s33, 17408
    v_mfma_f32_16x16x32_bf16 v[112:115], v[44:47], v[32:35], v[112:115]
    ds_read_b64_tr_b16 v[82:83], v252 offset:61952
    ds_read_b64_tr_b16 v[84:85], v253 offset:61440
    v_mfma_f32_16x16x32_bf16 v[116:119], v[44:47], v[36:39], v[116:119]
    ds_read_b64_tr_b16 v[86:87], v253 offset:61952
    buffer_load_dwordx4 v255, s[60:63], s83 offen lds
    s_waitcnt lgkmcnt(14)
    v_mfma_f32_16x16x32_bf16 v[120:123], v[48:51], v[24:27], v[120:123]
    v_mfma_f32_16x16x32_bf16 v[124:127], v[48:51], v[28:31], v[124:127]
    s_lshl1_add_u32 m0, s33, 24576
    v_mfma_f32_16x16x32_bf16 v[128:131], v[48:51], v[32:35], v[128:131]
    v_mfma_f32_16x16x32_bf16 v[132:135], v[48:51], v[36:39], v[132:135]
    buffer_load_dwordx4 v254, s[64:67], s83 offen lds
    s_waitcnt lgkmcnt(12)
    v_mfma_f32_16x16x32_bf16 v[136:139], v[52:55], v[24:27], v[136:139]
    v_mfma_f32_16x16x32_bf16 v[140:143], v[52:55], v[28:31], v[140:143]
    s_lshl1_add_u32 m0, s33, 25600
    v_mfma_f32_16x16x32_bf16 v[144:147], v[52:55], v[32:35], v[144:147]
    v_mfma_f32_16x16x32_bf16 v[148:151], v[52:55], v[36:39], v[148:151]
    buffer_load_dwordx4 v255, s[64:67], s83 offen lds
    s_add_u32 s83, s83, 131072
    s_waitcnt vmcnt(16) lgkmcnt(0)
    s_barrier
    v_mfma_f32_16x16x32_bf16 v[88:91], v[72:75], v[56:59], v[88:91]
    ds_read_b64_tr_b16 v[40:41], v250 offset:49152
    ds_read_b64_tr_b16 v[42:43], v250 offset:49664
    v_mfma_f32_16x16x32_bf16 v[92:95], v[72:75], v[60:63], v[92:95]
    ds_read_b128 v[24:27], v248 offset:32768
    s_lshl2_add_u32 m0, s33, 98304
    v_mfma_f32_16x16x32_bf16 v[96:99], v[72:75], v[64:67], v[96:99]
    ds_read_b128 v[28:31], v248 offset:33792
    v_mfma_f32_16x16x32_bf16 v[100:103], v[72:75], v[68:71], v[100:103]
    ds_read_b128 v[32:35], v248 offset:34816
    buffer_load_dwordx4 v18, s[56:59], s82 offen offset:0 sc1 lds
    v_mfma_f32_16x16x32_bf16 v[104:107], v[76:79], v[56:59], v[104:107]
    ds_read_b128 v[36:39], v248 offset:35840
    v_mfma_f32_16x16x32_bf16 v[108:111], v[76:79], v[60:63], v[108:111]
    ds_read_b64_tr_b16 v[44:45], v251 offset:49152
    ds_read_b64_tr_b16 v[46:47], v251 offset:49664
    v_mfma_f32_16x16x32_bf16 v[112:115], v[76:79], v[64:67], v[112:115]
    ds_read_b64_tr_b16 v[48:49], v250 offset:57344
    v_mfma_f32_16x16x32_bf16 v[116:119], v[76:79], v[68:71], v[116:119]
    ds_read_b64_tr_b16 v[50:51], v250 offset:57856
    buffer_load_dwordx4 v18, s[56:59], s82 offen offset:1024 sc1 lds
    v_mfma_f32_16x16x32_bf16 v[120:123], v[80:83], v[56:59], v[120:123]
    ds_read_b64_tr_b16 v[52:53], v251 offset:57344
    v_mfma_f32_16x16x32_bf16 v[124:127], v[80:83], v[60:63], v[124:127]
    ds_read_b64_tr_b16 v[54:55], v251 offset:57856
    v_mfma_f32_16x16x32_bf16 v[128:131], v[80:83], v[64:67], v[128:131]
    v_mfma_f32_16x16x32_bf16 v[132:135], v[80:83], v[68:71], v[132:135]
    buffer_load_dwordx4 v18, s[56:59], s82 offen offset:2048 sc1 lds
    v_mfma_f32_16x16x32_bf16 v[136:139], v[84:87], v[56:59], v[136:139]
    v_mfma_f32_16x16x32_bf16 v[140:143], v[84:87], v[60:63], v[140:143]
    v_mfma_f32_16x16x32_bf16 v[144:147], v[84:87], v[64:67], v[144:147]
    v_mfma_f32_16x16x32_bf16 v[148:151], v[84:87], v[68:71], v[148:151]
    buffer_load_dwordx4 v18, s[56:59], s82 offen offset:3072 sc1 lds
    s_add_u32 s82, s82, 16384
    s_waitcnt lgkmcnt(9)
    v_mfma_f32_16x16x32_bf16 v[88:91], v[40:43], v[24:27], v[88:91]
    ds_read_b64_tr_b16 v[72:73], v250 offset:53248
    ds_read_b64_tr_b16 v[74:75], v250 offset:53760
    s_waitcnt lgkmcnt(10)
    v_mfma_f32_16x16x32_bf16 v[92:95], v[40:43], v[28:31], v[92:95]
    ds_read_b128 v[56:59], v248 offset:40960
    s_lshl1_add_u32 m0, s33, 114688
    s_waitcnt lgkmcnt(10)
    v_mfma_f32_16x16x32_bf16 v[96:99], v[40:43], v[32:35], v[96:99]
    ds_read_b128 v[60:63], v248 offset:41984
    ds_read_b128 v[64:67], v248 offset:43008
    s_waitcnt lgkmcnt(11)
    v_mfma_f32_16x16x32_bf16 v[100:103], v[40:43], v[36:39], v[100:103]
    ds_read_b128 v[68:71], v248 offset:44032
    buffer_load_dwordx4 v254, s[60:63], s83 offen lds
    s_waitcnt lgkmcnt(10)
    v_mfma_f32_16x16x32_bf16 v[104:107], v[44:47], v[24:27], v[104:107]
    ds_read_b64_tr_b16 v[76:77], v251 offset:53248
    ds_read_b64_tr_b16 v[78:79], v251 offset:53760
    v_mfma_f32_16x16x32_bf16 v[108:111], v[44:47], v[28:31], v[108:111]
    ds_read_b64_tr_b16 v[80:81], v250 offset:61440
    s_lshl1_add_u32 m0, s33, 115712
    v_mfma_f32_16x16x32_bf16 v[112:115], v[44:47], v[32:35], v[112:115]
    ds_read_b64_tr_b16 v[82:83], v250 offset:61952
    ds_read_b64_tr_b16 v[84:85], v251 offset:61440
    v_mfma_f32_16x16x32_bf16 v[116:119], v[44:47], v[36:39], v[116:119]
    ds_read_b64_tr_b16 v[86:87], v251 offset:61952
    buffer_load_dwordx4 v255, s[60:63], s83 offen lds
    s_waitcnt lgkmcnt(14)
    v_mfma_f32_16x16x32_bf16 v[120:123], v[48:51], v[24:27], v[120:123]
    v_mfma_f32_16x16x32_bf16 v[124:127], v[48:51], v[28:31], v[124:127]
    s_lshl1_add_u32 m0, s33, 122880
    v_mfma_f32_16x16x32_bf16 v[128:131], v[48:51], v[32:35], v[128:131]
    v_mfma_f32_16x16x32_bf16 v[132:135], v[48:51], v[36:39], v[132:135]
    buffer_load_dwordx4 v254, s[64:67], s83 offen lds
    s_waitcnt lgkmcnt(12)
    v_mfma_f32_16x16x32_bf16 v[136:139], v[52:55], v[24:27], v[136:139]
    v_mfma_f32_16x16x32_bf16 v[140:143], v[52:55], v[28:31], v[140:143]
    s_lshl1_add_u32 m0, s33, 123904
    v_mfma_f32_16x16x32_bf16 v[144:147], v[52:55], v[32:35], v[144:147]
    v_mfma_f32_16x16x32_bf16 v[148:151], v[52:55], v[36:39], v[148:151]
    buffer_load_dwordx4 v255, s[64:67], s83 offen lds
    s_add_u32 s83, s83, 131072
    s_waitcnt vmcnt(16) lgkmcnt(0)
    s_barrier
    v_mfma_f32_16x16x32_bf16 v[88:91], v[72:75], v[56:59], v[88:91]
    ds_read_b64_tr_b16 v[40:41], v252 offset:16384
    ds_read_b64_tr_b16 v[42:43], v252 offset:16896
    v_mfma_f32_16x16x32_bf16 v[92:95], v[72:75], v[60:63], v[92:95]
    ds_read_b128 v[24:27], v249 offset:0
    s_lshl2_add_u32 m0, s33, 32768
    v_mfma_f32_16x16x32_bf16 v[96:99], v[72:75], v[64:67], v[96:99]
    ds_read_b128 v[28:31], v249 offset:1024
    v_mfma_f32_16x16x32_bf16 v[100:103], v[72:75], v[68:71], v[100:103]
    ds_read_b128 v[32:35], v249 offset:2048
    buffer_load_dwordx4 v18, s[56:59], s82 offen offset:0 sc1 lds
    v_mfma_f32_16x16x32_bf16 v[104:107], v[76:79], v[56:59], v[104:107]
    ds_read_b128 v[36:39], v249 offset:3072
    v_mfma_f32_16x16x32_bf16 v[108:111], v[76:79], v[60:63], v[108:111]
    ds_read_b64_tr_b16 v[44:45], v253 offset:16384
    ds_read_b64_tr_b16 v[46:47], v253 offset:16896
    v_mfma_f32_16x16x32_bf16 v[112:115], v[76:79], v[64:67], v[112:115]
    ds_read_b64_tr_b16 v[48:49], v252 offset:24576
    v_mfma_f32_16x16x32_bf16 v[116:119], v[76:79], v[68:71], v[116:119]
    ds_read_b64_tr_b16 v[50:51], v252 offset:25088
    buffer_load_dwordx4 v18, s[56:59], s82 offen offset:1024 sc1 lds
    v_mfma_f32_16x16x32_bf16 v[120:123], v[80:83], v[56:59], v[120:123]
    ds_read_b64_tr_b16 v[52:53], v253 offset:24576
    v_mfma_f32_16x16x32_bf16 v[124:127], v[80:83], v[60:63], v[124:127]
    ds_read_b64_tr_b16 v[54:55], v253 offset:25088
    v_mfma_f32_16x16x32_bf16 v[128:131], v[80:83], v[64:67], v[128:131]
    v_mfma_f32_16x16x32_bf16 v[132:135], v[80:83], v[68:71], v[132:135]
    buffer_load_dwordx4 v18, s[56:59], s82 offen offset:2048 sc1 lds
    v_mfma_f32_16x16x32_bf16 v[136:139], v[84:87], v[56:59], v[136:139]
    v_mfma_f32_16x16x32_bf16 v[140:143], v[84:87], v[60:63], v[140:143]
    v_mfma_f32_16x16x32_bf16 v[144:147], v[84:87], v[64:67], v[144:147]
    v_mfma_f32_16x16x32_bf16 v[148:151], v[84:87], v[68:71], v[148:151]
    buffer_load_dwordx4 v18, s[56:59], s82 offen offset:3072 sc1 lds
    s_add_u32 s82, s82, 16384
    s_waitcnt lgkmcnt(9)
    v_mfma_f32_16x16x32_bf16 v[88:91], v[40:43], v[24:27], v[88:91]
    ds_read_b64_tr_b16 v[72:73], v252 offset:20480
    ds_read_b64_tr_b16 v[74:75], v252 offset:20992
    s_waitcnt lgkmcnt(10)
    v_mfma_f32_16x16x32_bf16 v[92:95], v[40:43], v[28:31], v[92:95]
    ds_read_b128 v[56:59], v249 offset:8192
    s_lshl1_add_u32 m0, s33, 49152
    s_waitcnt lgkmcnt(10)
    v_mfma_f32_16x16x32_bf16 v[96:99], v[40:43], v[32:35], v[96:99]
    ds_read_b128 v[60:63], v249 offset:9216
    ds_read_b128 v[64:67], v249 offset:10240
    s_waitcnt lgkmcnt(11)
    v_mfma_f32_16x16x32_bf16 v[100:103], v[40:43], v[36:39], v[100:103]
    ds_read_b128 v[68:71], v249 offset:11264
    buffer_load_dwordx4 v254, s[60:63], s83 offen lds
    s_waitcnt lgkmcnt(10)
    v_mfma_f32_16x16x32_bf16 v[104:107], v[44:47], v[24:27], v[104:107]
    ds_read_b64_tr_b16 v[76:77], v253 offset:20480
    ds_read_b64_tr_b16 v[78:79], v253 offset:20992
    v_mfma_f32_16x16x32_bf16 v[108:111], v[44:47], v[28:31], v[108:111]
    ds_read_b64_tr_b16 v[80:81], v252 offset:28672
    s_lshl1_add_u32 m0, s33, 50176
    v_mfma_f32_16x16x32_bf16 v[112:115], v[44:47], v[32:35], v[112:115]
    ds_read_b64_tr_b16 v[82:83], v252 offset:29184
    ds_read_b64_tr_b16 v[84:85], v253 offset:28672
    v_mfma_f32_16x16x32_bf16 v[116:119], v[44:47], v[36:39], v[116:119]
    ds_read_b64_tr_b16 v[86:87], v253 offset:29184
    buffer_load_dwordx4 v255, s[60:63], s83 offen lds
    s_waitcnt lgkmcnt(14)
    v_mfma_f32_16x16x32_bf16 v[120:123], v[48:51], v[24:27], v[120:123]
    v_mfma_f32_16x16x32_bf16 v[124:127], v[48:51], v[28:31], v[124:127]
    s_lshl1_add_u32 m0, s33, 57344
    v_mfma_f32_16x16x32_bf16 v[128:131], v[48:51], v[32:35], v[128:131]
    v_mfma_f32_16x16x32_bf16 v[132:135], v[48:51], v[36:39], v[132:135]
    buffer_load_dwordx4 v254, s[64:67], s83 offen lds
    s_waitcnt lgkmcnt(12)
    v_mfma_f32_16x16x32_bf16 v[136:139], v[52:55], v[24:27], v[136:139]
    v_mfma_f32_16x16x32_bf16 v[140:143], v[52:55], v[28:31], v[140:143]
    s_lshl1_add_u32 m0, s33, 58368
    v_mfma_f32_16x16x32_bf16 v[144:147], v[52:55], v[32:35], v[144:147]
    v_mfma_f32_16x16x32_bf16 v[148:151], v[52:55], v[36:39], v[148:151]
    buffer_load_dwordx4 v255, s[64:67], s83 offen lds
    s_add_u32 s83, s83, 131072
    s_waitcnt vmcnt(16) lgkmcnt(0)
    s_barrier
    v_mfma_f32_16x16x32_bf16 v[88:91], v[72:75], v[56:59], v[88:91]
    ds_read_b64_tr_b16 v[40:41], v250 offset:16384
    ds_read_b64_tr_b16 v[42:43], v250 offset:16896
    v_mfma_f32_16x16x32_bf16 v[92:95], v[72:75], v[60:63], v[92:95]
    ds_read_b128 v[24:27], v248 offset:0
    s_lshl2_add_u32 m0, s33, 65536
    v_mfma_f32_16x16x32_bf16 v[96:99], v[72:75], v[64:67], v[96:99]
    ds_read_b128 v[28:31], v248 offset:1024
    v_mfma_f32_16x16x32_bf16 v[100:103], v[72:75], v[68:71], v[100:103]
    ds_read_b128 v[32:35], v248 offset:2048
    buffer_load_dwordx4 v18, s[56:59], s82 offen offset:0 sc1 lds
    v_mfma_f32_16x16x32_bf16 v[104:107], v[76:79], v[56:59], v[104:107]
    ds_read_b128 v[36:39], v248 offset:3072
    v_mfma_f32_16x16x32_bf16 v[108:111], v[76:79], v[60:63], v[108:111]
    ds_read_b64_tr_b16 v[44:45], v251 offset:16384
    ds_read_b64_tr_b16 v[46:47], v251 offset:16896
    v_mfma_f32_16x16x32_bf16 v[112:115], v[76:79], v[64:67], v[112:115]
    ds_read_b64_tr_b16 v[48:49], v250 offset:24576
    v_mfma_f32_16x16x32_bf16 v[116:119], v[76:79], v[68:71], v[116:119]
    ds_read_b64_tr_b16 v[50:51], v250 offset:25088
    buffer_load_dwordx4 v18, s[56:59], s82 offen offset:1024 sc1 lds
    v_mfma_f32_16x16x32_bf16 v[120:123], v[80:83], v[56:59], v[120:123]
    ds_read_b64_tr_b16 v[52:53], v251 offset:24576
    v_mfma_f32_16x16x32_bf16 v[124:127], v[80:83], v[60:63], v[124:127]
    ds_read_b64_tr_b16 v[54:55], v251 offset:25088
    v_mfma_f32_16x16x32_bf16 v[128:131], v[80:83], v[64:67], v[128:131]
    v_mfma_f32_16x16x32_bf16 v[132:135], v[80:83], v[68:71], v[132:135]
    buffer_load_dwordx4 v18, s[56:59], s82 offen offset:2048 sc1 lds
    v_mfma_f32_16x16x32_bf16 v[136:139], v[84:87], v[56:59], v[136:139]
    v_mfma_f32_16x16x32_bf16 v[140:143], v[84:87], v[60:63], v[140:143]
    v_mfma_f32_16x16x32_bf16 v[144:147], v[84:87], v[64:67], v[144:147]
    v_mfma_f32_16x16x32_bf16 v[148:151], v[84:87], v[68:71], v[148:151]
    buffer_load_dwordx4 v18, s[56:59], s82 offen offset:3072 sc1 lds
    s_add_u32 s82, s82, 16384
    s_waitcnt lgkmcnt(9)
    v_mfma_f32_16x16x32_bf16 v[88:91], v[40:43], v[24:27], v[88:91]
    ds_read_b64_tr_b16 v[72:73], v250 offset:20480
    ds_read_b64_tr_b16 v[74:75], v250 offset:20992
    s_waitcnt lgkmcnt(10)
    v_mfma_f32_16x16x32_bf16 v[92:95], v[40:43], v[28:31], v[92:95]
    ds_read_b128 v[56:59], v248 offset:8192
    s_lshl1_add_u32 m0, s33, 81920
    s_waitcnt lgkmcnt(10)
    v_mfma_f32_16x16x32_bf16 v[96:99], v[40:43], v[32:35], v[96:99]
    ds_read_b128 v[60:63], v248 offset:9216
    ds_read_b128 v[64:67], v248 offset:10240
    s_waitcnt lgkmcnt(11)
    v_mfma_f32_16x16x32_bf16 v[100:103], v[40:43], v[36:39], v[100:103]
    ds_read_b128 v[68:71], v248 offset:11264
    buffer_load_dwordx4 v254, s[60:63], s83 offen lds
L_pad4:
    s_cbranch_execz L_vret2
    s_waitcnt lgkmcnt(10)
    v_mfma_f32_16x16x32_bf16 v[104:107], v[44:47], v[24:27], v[104:107]
    ds_read_b64_tr_b16 v[76:77], v251 offset:20480
    ds_read_b64_tr_b16 v[78:79], v251 offset:20992
    v_mfma_f32_16x16x32_bf16 v[108:111], v[44:47], v[28:31], v[108:111]
    ds_read_b64_tr_b16 v[80:81], v250 offset:28672
    s_lshl1_add_u32 m0, s33, 82944
    v_mfma_f32_16x16x32_bf16 v[112:115], v[44:47], v[32:35], v[112:115]
    ds_read_b64_tr_b16 v[82:83], v250 offset:29184
    ds_read_b64_tr_b16 v[84:85], v251 offset:28672
    v_mfma_f32_16x16x32_bf16 v[116:119], v[44:47], v[36:39], v[116:119]
    ds_read_b64_tr_b16 v[86:87], v251 offset:29184
    buffer_load_dwordx4 v255, s[60:63], s83 offen lds
    s_waitcnt lgkmcnt(14)
    v_mfma_f32_16x16x32_bf16 v[120:123], v[48:51], v[24:27], v[120:123]
    v_mfma_f32_16x16x32_bf16 v[124:127], v[48:51], v[28:31], v[124:127]
    s_lshl1_add_u32 m0, s33, 90112
    v_mfma_f32_16x16x32_bf16 v[128:131], v[48:51], v[32:35], v[128:131]
    v_mfma_f32_16x16x32_bf16 v[132:135], v[48:51], v[36:39], v[132:135]
    buffer_load_dwordx4 v254, s[64:67], s83 offen lds
    s_waitcnt lgkmcnt(12)
    v_mfma_f32_16x16x32_bf16 v[136:139], v[52:55], v[24:27], v[136:139]
    v_mfma_f32_16x16x32_bf16 v[140:143], v[52:55], v[28:31], v[140:143]
    s_lshl1_add_u32 m0, s33, 91136
    v_mfma_f32_16x16x32_bf16 v[144:147], v[52:55], v[32:35], v[144:147]
    v_mfma_f32_16x16x32_bf16 v[148:151], v[52:55], v[36:39], v[148:151]
    buffer_load_dwordx4 v255, s[64:67], s83 offen lds
    s_add_u32 s83, s83, 131072
    s_waitcnt vmcnt(16) lgkmcnt(0)
    s_barrier
    v_mfma_f32_16x16x32_bf16 v[88:91], v[72:75], v[56:59], v[88:91]
    ds_read_b64_tr_b16 v[40:41], v252 offset:49152
    ds_read_b64_tr_b16 v[42:43], v252 offset:49664
    v_mfma_f32_16x16x32_bf16 v[92:95], v[72:75], v[60:63], v[92:95]
    ds_read_b128 v[24:27], v249 offset:32768
    s_lshl_b32 m0, s33, 2
    v_mfma_f32_16x16x32_bf16 v[96:99], v[72:75], v[64:67], v[96:99]
    ds_read_b128 v[28:31], v249 offset:33792
    v_mfma_f32_16x16x32_bf16 v[100:103], v[72:75], v[68:71], v[100:103]
    ds_read_b128 v[32:35], v249 offset:34816
    buffer_load_dwordx4 v18, s[56:59], s82 offen offset:0 sc1 lds
    v_mfma_f32_16x16x32_bf16 v[104:107], v[76:79], v[56:59], v[104:107]
    ds_read_b128 v[36:39], v249 offset:35840
    v_mfma_f32_16x16x32_bf16 v[108:111], v[76:79], v[60:63], v[108:111]
    ds_read_b64_tr_b16 v[44:45], v253 offset:49152
    ds_read_b64_tr_b16 v[46:47], v253 offset:49664
    v_mfma_f32_16x16x32_bf16 v[112:115], v[76:79], v[64:67], v[112:115]
    ds_read_b64_tr_b16 v[48:49], v252 offset:57344
    v_mfma_f32_16x16x32_bf16 v[116:119], v[76:79], v[68:71], v[116:119]
    ds_read_b64_tr_b16 v[50:51], v252 offset:57856
    buffer_load_dwordx4 v18, s[56:59], s82 offen offset:1024 sc1 lds
    v_mfma_f32_16x16x32_bf16 v[120:123], v[80:83], v[56:59], v[120:123]
    ds_read_b64_tr_b16 v[52:53], v253 offset:57344
    v_mfma_f32_16x16x32_bf16 v[124:127], v[80:83], v[60:63], v[124:127]
    ds_read_b64_tr_b16 v[54:55], v253 offset:57856
    v_mfma_f32_16x16x32_bf16 v[128:131], v[80:83], v[64:67], v[128:131]
    v_mfma_f32_16x16x32_bf16 v[132:135], v[80:83], v[68:71], v[132:135]
    buffer_load_dwordx4 v18, s[56:59], s82 offen offset:2048 sc1 lds
    v_mfma_f32_16x16x32_bf16 v[136:139], v[84:87], v[56:59], v[136:139]
    v_mfma_f32_16x16x32_bf16 v[140:143], v[84:87], v[60:63], v[140:143]
    v_mfma_f32_16x16x32_bf16 v[144:147], v[84:87], v[64:67], v[144:147]
    v_mfma_f32_16x16x32_bf16 v[148:151], v[84:87], v[68:71], v[148:151]
    buffer_load_dwordx4 v18, s[56:59], s82 offen offset:3072 sc1 lds
    s_add_u32 s82, s82, 16384
    s_waitcnt lgkmcnt(9)
    v_mfma_f32_16x16x32_bf16 v[88:91], v[40:43], v[24:27], v[88:91]
    ds_read_b64_tr_b16 v[72:73], v252 offset:53248
    ds_read_b64_tr_b16 v[74:75], v252 offset:53760
    s_waitcnt lgkmcnt(10)
    v_mfma_f32_16x16x32_bf16 v[92:95], v[40:43], v[28:31], v[92:95]
    ds_read_b128 v[56:59], v249 offset:40960
    s_lshl1_add_u32 m0, s33, 16384
    s_waitcnt lgkmcnt(10)
    v_mfma_f32_16x16x32_bf16 v[96:99], v[40:43], v[32:35], v[96:99]
    ds_read_b128 v[60:63], v249 offset:41984
    ds_read_b128 v[64:67], v249 offset:43008
    s_waitcnt lgkmcnt(11)
    v_mfma_f32_16x16x32_bf16 v[100:103], v[40:43], v[36:39], v[100:103]
    ds_read_b128 v[68:71], v249 offset:44032
    buffer_load_dwordx4 v254, s[60:63], s83 offen lds
    s_waitcnt lgkmcnt(10)
    v_mfma_f32_16x16x32_bf16 v[104:107], v[44:47], v[24:27], v[104:107]
    ds_read_b64_tr_b16 v[76:77], v253 offset:53248
    ds_read_b64_tr_b16 v[78:79], v253 offset:53760
    v_mfma_f32_16x16x32_bf16 v[108:111], v[44:47], v[28:31], v[108:111]
    ds_read_b64_tr_b16 v[80:81], v252 offset:61440
    s_lshl1_add_u32 m0, s33, 17408
    v_mfma_f32_16x16x32_bf16 v[112:115], v[44:47], v[32:35], v[112:115]
    ds_read_b64_tr_b16 v[82:83], v252 offset:61952
    ds_read_b64_tr_b16 v[84:85], v253 offset:61440
    v_mfma_f32_16x16x32_bf16 v[116:119], v[44:47], v[36:39], v[116:119]
    ds_read_b64_tr_b16 v[86:87], v253 offset:61952
    buffer_load_dwordx4 v255, s[60:63], s83 offen lds
    s_waitcnt lgkmcnt(14)
    v_mfma_f32_16x16x32_bf16 v[120:123], v[48:51], v[24:27], v[120:123]
    v_mfma_f32_16x16x32_bf16 v[124:127], v[48:51], v[28:31], v[124:127]
    s_lshl1_add_u32 m0, s33, 24576
    v_mfma_f32_16x16x32_bf16 v[128:131], v[48:51], v[32:35], v[128:131]
    v_mfma_f32_16x16x32_bf16 v[132:135], v[48:51], v[36:39], v[132:135]
    buffer_load_dwordx4 v254, s[64:67], s83 offen lds
    s_waitcnt lgkmcnt(12)
    v_mfma_f32_16x16x32_bf16 v[136:139], v[52:55], v[24:27], v[136:139]
    v_mfma_f32_16x16x32_bf16 v[140:143], v[52:55], v[28:31], v[140:143]
    s_lshl1_add_u32 m0, s33, 25600
    v_mfma_f32_16x16x32_bf16 v[144:147], v[52:55], v[32:35], v[144:147]
    v_mfma_f32_16x16x32_bf16 v[148:151], v[52:55], v[36:39], v[148:151]
    buffer_load_dwordx4 v255, s[64:67], s83 offen lds
    s_add_u32 s83, s83, 131072
    s_waitcnt vmcnt(16) lgkmcnt(0)
    s_barrier
    v_mfma_f32_16x16x32_bf16 v[88:91], v[72:75], v[56:59], v[88:91]
    ds_read_b64_tr_b16 v[40:41], v250 offset:49152
    ds_read_b64_tr_b16 v[42:43], v250 offset:49664
    v_mfma_f32_16x16x32_bf16 v[92:95], v[72:75], v[60:63], v[92:95]
    ds_read_b128 v[24:27], v248 offset:32768
    s_lshl2_add_u32 m0, s33, 98304
    v_mfma_f32_16x16x32_bf16 v[96:99], v[72:75], v[64:67], v[96:99]
    ds_read_b128 v[28:31], v248 offset:33792
    v_mfma_f32_16x16x32_bf16 v[100:103], v[72:75], v[68:71], v[100:103]
    ds_read_b128 v[32:35], v248 offset:34816
    buffer_load_dwordx4 v18, s[56:59], s82 offen offset:0 sc1 lds
    v_mfma_f32_16x16x32_bf16 v[104:107], v[76:79], v[56:59], v[104:107]
    ds_read_b128 v[36:39], v248 offset:35840
    v_mfma_f32_16x16x32_bf16 v[108:111], v[76:79], v[60:63], v[108:111]
    ds_read_b64_tr_b16 v[44:45], v251 offset:49152
    ds_read_b64_tr_b16 v[46:47], v251 offset:49664
    v_mfma_f32_16x16x32_bf16 v[112:115], v[76:79], v[64:67], v[112:115]
    ds_read_b64_tr_b16 v[48:49], v250 offset:57344
    v_mfma_f32_16x16x32_bf16 v[116:119], v[76:79], v[68:71], v[116:119]
    ds_read_b64_tr_b16 v[50:51], v250 offset:57856
    buffer_load_dwordx4 v18, s[56:59], s82 offen offset:1024 sc1 lds
    v_mfma_f32_16x16x32_bf16 v[120:123], v[80:83], v[56:59], v[120:123]
    ds_read_b64_tr_b16 v[52:53], v251 offset:57344
    v_mfma_f32_16x16x32_bf16 v[124:127], v[80:83], v[60:63], v[124:127]
    ds_read_b64_tr_b16 v[54:55], v251 offset:57856
    v_mfma_f32_16x16x32_bf16 v[128:131], v[80:83], v[64:67], v[128:131]
    v_mfma_f32_16x16x32_bf16 v[132:135], v[80:83], v[68:71], v[132:135]
    buffer_load_dwordx4 v18, s[56:59], s82 offen offset:2048 sc1 lds
    v_mfma_f32_16x16x32_bf16 v[136:139], v[84:87], v[56:59], v[136:139]
    v_mfma_f32_16x16x32_bf16 v[140:143], v[84:87], v[60:63], v[140:143]
    v_mfma_f32_16x16x32_bf16 v[144:147], v[84:87], v[64:67], v[144:147]
    v_mfma_f32_16x16x32_bf16 v[148:151], v[84:87], v[68:71], v[148:151]
    buffer_load_dwordx4 v18, s[56:59], s82 offen offset:3072 sc1 lds
    s_add_u32 s82, s82, 16384
    s_waitcnt lgkmcnt(9)
    v_mfma_f32_16x16x32_bf16 v[88:91], v[40:43], v[24:27], v[88:91]
    ds_read_b64_tr_b16 v[72:73], v250 offset:53248
    ds_read_b64_tr_b16 v[74:75], v250 offset:53760
    s_waitcnt lgkmcnt(10)
    v_mfma_f32_16x16x32_bf16 v[92:95], v[40:43], v[28:31], v[92:95]
    ds_read_b128 v[56:59], v248 offset:40960
    s_lshl1_add_u32 m0, s33, 114688
    s_waitcnt lgkmcnt(10)
    v_mfma_f32_16x16x32_bf16 v[96:99], v[40:43], v[32:35], v[96:99]
    ds_read_b128 v[60:63], v248 offset:41984
    ds_read_b128 v[64:67], v248 offset:43008
    s_waitcnt lgkmcnt(11)
    v_mfma_f32_16x16x32_bf16 v[100:103], v[40:43], v[36:39], v[100:103]
    ds_read_b128 v[68:71], v248 offset:44032
    buffer_load_dwordx4 v254, s[60:63], s83 offen lds
    s_waitcnt lgkmcnt(10)
    v_mfma_f32_16x16x32_bf16 v[104:107], v[44:47], v[24:27], v[104:107]
    ds_read_b64_tr_b16 v[76:77], v251 offset:53248
    ds_read_b64_tr_b16 v[78:79], v251 offset:53760
    v_mfma_f32_16x16x32_bf16 v[108:111], v[44:47], v[28:31], v[108:111]
    ds_read_b64_tr_b16 v[80:81], v250 offset:61440
    s_lshl1_add_u32 m0, s33, 115712
    v_mfma_f32_16x16x32_bf16 v[112:115], v[44:47], v[32:35], v[112:115]
    ds_read_b64_tr_b16 v[82:83], v250 offset:61952
    ds_read_b64_tr_b16 v[84:85], v251 offset:61440
    v_mfma_f32_16x16x32_bf16 v[116:119], v[44:47], v[36:39], v[116:119]
    ds_read_b64_tr_b16 v[86:87], v251 offset:61952
    buffer_load_dwordx4 v255, s[60:63], s83 offen lds
    s_waitcnt lgkmcnt(14)
    v_mfma_f32_16x16x32_bf16 v[120:123], v[48:51], v[24:27], v[120:123]
    v_mfma_f32_16x16x32_bf16 v[124:127], v[48:51], v[28:31], v[124:127]
    s_lshl1_add_u32 m0, s33, 122880
    v_mfma_f32_16x16x32_bf16 v[128:131], v[48:51], v[32:35], v[128:131]
    v_mfma_f32_16x16x32_bf16 v[132:135], v[48:51], v[36:39], v[132:135]
    buffer_load_dwordx4 v254, s[64:67], s83 offen lds
    s_waitcnt lgkmcnt(12)
    v_mfma_f32_16x16x32_bf16 v[136:139], v[52:55], v[24:27], v[136:139]
    v_mfma_f32_16x16x32_bf16 v[140:143], v[52:55], v[28:31], v[140:143]
    s_lshl1_add_u32 m0, s33, 123904
    v_mfma_f32_16x16x32_bf16 v[144:147], v[52:55], v[32:35], v[144:147]
    v_mfma_f32_16x16x32_bf16 v[148:151], v[52:55], v[36:39], v[148:151]
    buffer_load_dwordx4 v255, s[64:67], s83 offen lds
    s_add_u32 s83, s83, 131072
    s_waitcnt vmcnt(16) lgkmcnt(0)
    s_barrier
    v_mfma_f32_16x16x32_bf16 v[88:91], v[72:75], v[56:59], v[88:91]
    ds_read_b64_tr_b16 v[40:41], v252 offset:16384
    ds_read_b64_tr_b16 v[42:43], v252 offset:16896
    v_mfma_f32_16x16x32_bf16 v[92:95], v[72:75], v[60:63], v[92:95]
    ds_read_b128 v[24:27], v249 offset:0
    s_lshl2_add_u32 m0, s33, 32768
    v_mfma_f32_16x16x32_bf16 v[96:99], v[72:75], v[64:67], v[96:99]
    ds_read_b128 v[28:31], v249 offset:1024
    v_mfma_f32_16x16x32_bf16 v[100:103], v[72:75], v[68:71], v[100:103]
    ds_read_b128 v[32:35], v249 offset:2048
    buffer_load_dwordx4 v18, s[56:59], s82 offen offset:0 sc1 lds
    v_mfma_f32_16x16x32_bf16 v[104:107], v[76:79], v[56:59], v[104:107]
    ds_read_b128 v[36:39], v249 offset:3072
    v_mfma_f32_16x16x32_bf16 v[108:111], v[76:79], v[60:63], v[108:111]
    ds_read_b64_tr_b16 v[44:45], v253 offset:16384
    ds_read_b64_tr_b16 v[46:47], v253 offset:16896
    v_mfma_f32_16x16x32_bf16 v[112:115], v[76:79], v[64:67], v[112:115]
    ds_read_b64_tr_b16 v[48:49], v252 offset:24576
    v_mfma_f32_16x16x32_bf16 v[116:119], v[76:79], v[68:71], v[116:119]
    ds_read_b64_tr_b16 v[50:51], v252 offset:25088
    buffer_load_dwordx4 v18, s[56:59], s82 offen offset:1024 sc1 lds
    v_mfma_f32_16x16x32_bf16 v[120:123], v[80:83], v[56:59], v[120:123]
    ds_read_b64_tr_b16 v[52:53], v253 offset:24576
    v_mfma_f32_16x16x32_bf16 v[124:127], v[80:83], v[60:63], v[124:127]
    ds_read_b64_tr_b16 v[54:55], v253 offset:25088
    v_mfma_f32_16x16x32_bf16 v[128:131], v[80:83], v[64:67], v[128:131]
    v_mfma_f32_16x16x32_bf16 v[132:135], v[80:83], v[68:71], v[132:135]
    buffer_load_dwordx4 v18, s[56:59], s82 offen offset:2048 sc1 lds
    v_mfma_f32_16x16x32_bf16 v[136:139], v[84:87], v[56:59], v[136:139]
    v_mfma_f32_16x16x32_bf16 v[140:143], v[84:87], v[60:63], v[140:143]
    v_mfma_f32_16x16x32_bf16 v[144:147], v[84:87], v[64:67], v[144:147]
    v_mfma_f32_16x16x32_bf16 v[148:151], v[84:87], v[68:71], v[148:151]
    buffer_load_dwordx4 v18, s[56:59], s82 offen offset:3072 sc1 lds
    s_add_u32 s82, s82, 16384
    s_waitcnt lgkmcnt(9)
    v_mfma_f32_16x16x32_bf16 v[88:91], v[40:43], v[24:27], v[88:91]
    ds_read_b64_tr_b16 v[72:73], v252 offset:20480
    ds_read_b64_tr_b16 v[74:75], v252 offset:20992
    s_waitcnt lgkmcnt(10)
    v_mfma_f32_16x16x32_bf16 v[92:95], v[40:43], v[28:31], v[92:95]
    ds_read_b128 v[56:59], v249 offset:8192
    s_lshl1_add_u32 m0, s33, 49152
    s_waitcnt lgkmcnt(10)
    v_mfma_f32_16x16x32_bf16 v[96:99], v[40:43], v[32:35], v[96:99]
    ds_read_b128 v[60:63], v249 offset:9216
    ds_read_b128 v[64:67], v249 offset:10240
    s_waitcnt lgkmcnt(11)
    v_mfma_f32_16x16x32_bf16 v[100:103], v[40:43], v[36:39], v[100:103]
    ds_read_b128 v[68:71], v249 offset:11264
    buffer_load_dwordx4 v254, s[60:63], s83 offen lds
    s_waitcnt lgkmcnt(10)
    v_mfma_f32_16x16x32_bf16 v[104:107], v[44:47], v[24:27], v[104:107]
    ds_read_b64_tr_b16 v[76:77], v253 offset:20480
    ds_read_b64_tr_b16 v[78:79], v253 offset:20992
    v_mfma_f32_16x16x32_bf16 v[108:111], v[44:47], v[28:31], v[108:111]
    ds_read_b64_tr_b16 v[80:81], v252 offset:28672
    s_lshl1_add_u32 m0, s33, 50176
    v_mfma_f32_16x16x32_bf16 v[112:115], v[44:47], v[32:35], v[112:115]
    ds_read_b64_tr_b16 v[82:83], v252 offset:29184
    ds_read_b64_tr_b16 v[84:85], v253 offset:28672
    v_mfma_f32_16x16x32_bf16 v[116:119], v[44:47], v[36:39], v[116:119]
    ds_read_b64_tr_b16 v[86:87], v253 offset:29184
    buffer_load_dwordx4 v255, s[60:63], s83 offen lds
    s_waitcnt lgkmcnt(14)
    v_mfma_f32_16x16x32_bf16 v[120:123], v[48:51], v[24:27], v[120:123]
    v_mfma_f32_16x16x32_bf16 v[124:127], v[48:51], v[28:31], v[124:127]
    s_lshl1_add_u32 m0, s33, 57344
    v_mfma_f32_16x16x32_bf16 v[128:131], v[48:51], v[32:35], v[128:131]
    v_mfma_f32_16x16x32_bf16 v[132:135], v[48:51], v[36:39], v[132:135]
    buffer_load_dwordx4 v254, s[64:67], s83 offen lds
    s_waitcnt lgkmcnt(12)
    v_mfma_f32_16x16x32_bf16 v[136:139], v[52:55], v[24:27], v[136:139]
    v_mfma_f32_16x16x32_bf16 v[140:143], v[52:55], v[28:31], v[140:143]
    s_lshl1_add_u32 m0, s33, 58368
    v_mfma_f32_16x16x32_bf16 v[144:147], v[52:55], v[32:35], v[144:147]
    v_mfma_f32_16x16x32_bf16 v[148:151], v[52:55], v[36:39], v[148:151]
    buffer_load_dwordx4 v255, s[64:67], s83 offen lds
    s_add_u32 s83, s83, 131072
    s_waitcnt vmcnt(16) lgkmcnt(0)
    s_barrier
    v_mfma_f32_16x16x32_bf16 v[88:91], v[72:75], v[56:59], v[88:91]
    ds_read_b64_tr_b16 v[40:41], v250 offset:16384
    ds_read_b64_tr_b16 v[42:43], v250 offset:16896
    v_mfma_f32_16x16x32_bf16 v[92:95], v[72:75], v[60:63], v[92:95]
    ds_read_b128 v[24:27], v248 offset:0
    s_lshl2_add_u32 m0, s33, 65536
    v_mfma_f32_16x16x32_bf16 v[96:99], v[72:75], v[64:67], v[96:99]
    ds_read_b128 v[28:31], v248 offset:1024
    v_mfma_f32_16x16x32_bf16 v[100:103], v[72:75], v[68:71], v[100:103]
    ds_read_b128 v[32:35], v248 offset:2048
    buffer_load_dwordx4 v18, s[56:59], s82 offen offset:0 sc1 lds
    v_mfma_f32_16x16x32_bf16 v[104:107], v[76:79], v[56:59], v[104:107]
    ds_read_b128 v[36:39], v248 offset:3072
    v_mfma_f32_16x16x32_bf16 v[108:111], v[76:79], v[60:63], v[108:111]
    ds_read_b64_tr_b16 v[44:45], v251 offset:16384
    ds_read_b64_tr_b16 v[46:47], v251 offset:16896
    v_mfma_f32_16x16x32_bf16 v[112:115], v[76:79], v[64:67], v[112:115]
    ds_read_b64_tr_b16 v[48:49], v250 offset:24576
    v_mfma_f32_16x16x32_bf16 v[116:119], v[76:79], v[68:71], v[116:119]
    ds_read_b64_tr_b16 v[50:51], v250 offset:25088
    buffer_load_dwordx4 v18, s[56:59], s82 offen offset:1024 sc1 lds
    v_mfma_f32_16x16x32_bf16 v[120:123], v[80:83], v[56:59], v[120:123]
    ds_read_b64_tr_b16 v[52:53], v251 offset:24576
    v_mfma_f32_16x16x32_bf16 v[124:127], v[80:83], v[60:63], v[124:127]
    ds_read_b64_tr_b16 v[54:55], v251 offset:25088
    v_mfma_f32_16x16x32_bf16 v[128:131], v[80:83], v[64:67], v[128:131]
    v_mfma_f32_16x16x32_bf16 v[132:135], v[80:83], v[68:71], v[132:135]
    buffer_load_dwordx4 v18, s[56:59], s82 offen offset:2048 sc1 lds
    v_mfma_f32_16x16x32_bf16 v[136:139], v[84:87], v[56:59], v[136:139]
    v_mfma_f32_16x16x32_bf16 v[140:143], v[84:87], v[60:63], v[140:143]
    v_mfma_f32_16x16x32_bf16 v[144:147], v[84:87], v[64:67], v[144:147]
    v_mfma_f32_16x16x32_bf16 v[148:151], v[84:87], v[68:71], v[148:151]
    buffer_load_dwordx4 v18, s[56:59], s82 offen offset:3072 sc1 lds
    s_add_u32 s82, s82, 16384
    s_waitcnt lgkmcnt(9)
    v_mfma_f32_16x16x32_bf16 v[88:91], v[40:43], v[24:27], v[88:91]
    ds_read_b64_tr_b16 v[72:73], v250 offset:20480
    ds_read_b64_tr_b16 v[74:75], v250 offset:20992
    s_waitcnt lgkmcnt(10)
    v_mfma_f32_16x16x32_bf16 v[92:95], v[40:43], v[28:31], v[92:95]
    ds_read_b128 v[56:59], v248 offset:8192
    s_waitcnt lgkmcnt(10)
    v_mfma_f32_16x16x32_bf16 v[96:99], v[40:43], v[32:35], v[96:99]
    ds_read_b128 v[60:63], v248 offset:9216
    ds_read_b128 v[64:67], v248 offset:10240
    s_waitcnt lgkmcnt(11)
    v_mfma_f32_16x16x32_bf16 v[100:103], v[40:43], v[36:39], v[100:103]
    ds_read_b128 v[68:71], v248 offset:11264
    s_waitcnt lgkmcnt(10)
    v_mfma_f32_16x16x32_bf16 v[104:107], v[44:47], v[24:27], v[104:107]
    ds_read_b64_tr_b16 v[76:77], v251 offset:20480
    ds_read_b64_tr_b16 v[78:79], v251 offset:20992
    v_mfma_f32_16x16x32_bf16 v[108:111], v[44:47], v[28:31], v[108:111]
    ds_read_b64_tr_b16 v[80:81], v250 offset:28672
    v_mfma_f32_16x16x32_bf16 v[112:115], v[44:47], v[32:35], v[112:115]
    ds_read_b64_tr_b16 v[82:83], v250 offset:29184
    ds_read_b64_tr_b16 v[84:85], v251 offset:28672
    v_mfma_f32_16x16x32_bf16 v[116:119], v[44:47], v[36:39], v[116:119]
    ds_read_b64_tr_b16 v[86:87], v251 offset:29184
    s_waitcnt lgkmcnt(14)
    v_mfma_f32_16x16x32_bf16 v[120:123], v[48:51], v[24:27], v[120:123]
    v_mfma_f32_16x16x32_bf16 v[124:127], v[48:51], v[28:31], v[124:127]
    v_mfma_f32_16x16x32_bf16 v[128:131], v[48:51], v[32:35], v[128:131]
    v_mfma_f32_16x16x32_bf16 v[132:135], v[48:51], v[36:39], v[132:135]
    s_waitcnt lgkmcnt(12)
    v_mfma_f32_16x16x32_bf16 v[136:139], v[52:55], v[24:27], v[136:139]
    v_mfma_f32_16x16x32_bf16 v[140:143], v[52:55], v[28:31], v[140:143]
    v_mfma_f32_16x16x32_bf16 v[144:147], v[52:55], v[32:35], v[144:147]
    v_mfma_f32_16x16x32_bf16 v[148:151], v[52:55], v[36:39], v[148:151]
    s_waitcnt vmcnt(12) lgkmcnt(0)
    s_barrier
    v_mfma_f32_16x16x32_bf16 v[88:91], v[72:75], v[56:59], v[88:91]
    ds_read_b64_tr_b16 v[40:41], v252 offset:49152
    ds_read_b64_tr_b16 v[42:43], v252 offset:49664
    v_mfma_f32_16x16x32_bf16 v[92:95], v[72:75], v[60:63], v[92:95]
    ds_read_b128 v[24:27], v249 offset:32768
    v_mfma_f32_16x16x32_bf16 v[96:99], v[72:75], v[64:67], v[96:99]
    ds_read_b128 v[28:31], v249 offset:33792
    v_mfma_f32_16x16x32_bf16 v[100:103], v[72:75], v[68:71], v[100:103]
    ds_read_b128 v[32:35], v249 offset:34816
    v_mfma_f32_16x16x32_bf16 v[104:107], v[76:79], v[56:59], v[104:107]
    ds_read_b128 v[36:39], v249 offset:35840
    v_mfma_f32_16x16x32_bf16 v[108:111], v[76:79], v[60:63], v[108:111]
    ds_read_b64_tr_b16 v[44:45], v253 offset:49152
    ds_read_b64_tr_b16 v[46:47], v253 offset:49664
    v_mfma_f32_16x16x32_bf16 v[112:115], v[76:79], v[64:67], v[112:115]
    ds_read_b64_tr_b16 v[48:49], v252 offset:57344
    v_mfma_f32_16x16x32_bf16 v[116:119], v[76:79], v[68:71], v[116:119]
    ds_read_b64_tr_b16 v[50:51], v252 offset:57856
    v_mfma_f32_16x16x32_bf16 v[120:123], v[80:83], v[56:59], v[120:123]
    ds_read_b64_tr_b16 v[52:53], v253 offset:57344
    v_mfma_f32_16x16x32_bf16 v[124:127], v[80:83], v[60:63], v[124:127]
    ds_read_b64_tr_b16 v[54:55], v253 offset:57856
    v_mfma_f32_16x16x32_bf16 v[128:131], v[80:83], v[64:67], v[128:131]
    v_mfma_f32_16x16x32_bf16 v[132:135], v[80:83], v[68:71], v[132:135]
    v_mfma_f32_16x16x32_bf16 v[136:139], v[84:87], v[56:59], v[136:139]
    s_mov_b64 exec, 3
    global_load_dwordx3 v[236:238], v239, s[26:27] sc1
    s_mov_b64 exec, -1
    v_mfma_f32_16x16x32_bf16 v[140:143], v[84:87], v[60:63], v[140:143]
    v_mfma_f32_16x16x32_bf16 v[144:147], v[84:87], v[64:67], v[144:147]
    v_mfma_f32_16x16x32_bf16 v[148:151], v[84:87], v[68:71], v[148:151]
    s_waitcnt lgkmcnt(9)
    v_mfma_f32_16x16x32_bf16 v[88:91], v[40:43], v[24:27], v[88:91]
    ds_read_b64_tr_b16 v[72:73], v252 offset:53248
    ds_read_b64_tr_b16 v[74:75], v252 offset:53760
    s_waitcnt lgkmcnt(10)
    v_mfma_f32_16x16x32_bf16 v[92:95], v[40:43], v[28:31], v[92:95]
    ds_read_b128 v[56:59], v249 offset:40960
    s_waitcnt lgkmcnt(10)
    v_mfma_f32_16x16x32_bf16 v[96:99], v[40:43], v[32:35], v[96:99]
    ds_read_b128 v[60:63], v249 offset:41984
    ds_read_b128 v[64:67], v249 offset:43008
    s_waitcnt lgkmcnt(11)
    v_mfma_f32_16x16x32_bf16 v[100:103], v[40:43], v[36:39], v[100:103]
    ds_read_b128 v[68:71], v249 offset:44032
    s_waitcnt lgkmcnt(10)
    v_mfma_f32_16x16x32_bf16 v[104:107], v[44:47], v[24:27], v[104:107]
    ds_read_b64_tr_b16 v[76:77], v253 offset:53248
    ds_read_b64_tr_b16 v[78:79], v253 offset:53760
    v_mfma_f32_16x16x32_bf16 v[108:111], v[44:47], v[28:31], v[108:111]
    ds_read_b64_tr_b16 v[80:81], v252 offset:61440
    v_mfma_f32_16x16x32_bf16 v[112:115], v[44:47], v[32:35], v[112:115]
    ds_read_b64_tr_b16 v[82:83], v252 offset:61952
    ds_read_b64_tr_b16 v[84:85], v253 offset:61440
    v_mfma_f32_16x16x32_bf16 v[116:119], v[44:47], v[36:39], v[116:119]
    ds_read_b64_tr_b16 v[86:87], v253 offset:61952
    s_waitcnt lgkmcnt(14)
    v_mfma_f32_16x16x32_bf16 v[120:123], v[48:51], v[24:27], v[120:123]
    v_mfma_f32_16x16x32_bf16 v[124:127], v[48:51], v[28:31], v[124:127]
    v_mfma_f32_16x16x32_bf16 v[128:131], v[48:51], v[32:35], v[128:131]
    v_mfma_f32_16x16x32_bf16 v[132:135], v[48:51], v[36:39], v[132:135]
    s_waitcnt lgkmcnt(12)
    v_mfma_f32_16x16x32_bf16 v[136:139], v[52:55], v[24:27], v[136:139]
    v_mfma_f32_16x16x32_bf16 v[140:143], v[52:55], v[28:31], v[140:143]
    v_mfma_f32_16x16x32_bf16 v[144:147], v[52:55], v[32:35], v[144:147]
    v_mfma_f32_16x16x32_bf16 v[148:151], v[52:55], v[36:39], v[148:151]
    s_waitcnt vmcnt(5) lgkmcnt(0)
    s_barrier
    v_mfma_f32_16x16x32_bf16 v[88:91], v[72:75], v[56:59], v[88:91]
    ds_read_b64_tr_b16 v[40:41], v250 offset:49152
    ds_read_b64_tr_b16 v[42:43], v250 offset:49664
    v_mfma_f32_16x16x32_bf16 v[92:95], v[72:75], v[60:63], v[92:95]
    ds_read_b128 v[24:27], v248 offset:32768
    v_mfma_f32_16x16x32_bf16 v[96:99], v[72:75], v[64:67], v[96:99]
    ds_read_b128 v[28:31], v248 offset:33792
    v_mfma_f32_16x16x32_bf16 v[100:103], v[72:75], v[68:71], v[100:103]
    ds_read_b128 v[32:35], v248 offset:34816
    v_mfma_f32_16x16x32_bf16 v[104:107], v[76:79], v[56:59], v[104:107]
    ds_read_b128 v[36:39], v248 offset:35840
    v_mfma_f32_16x16x32_bf16 v[108:111], v[76:79], v[60:63], v[108:111]
    ds_read_b64_tr_b16 v[44:45], v251 offset:49152
    ds_read_b64_tr_b16 v[46:47], v251 offset:49664
    v_mfma_f32_16x16x32_bf16 v[112:115], v[76:79], v[64:67], v[112:115]
    ds_read_b64_tr_b16 v[48:49], v250 offset:57344
    v_mfma_f32_16x16x32_bf16 v[116:119], v[76:79], v[68:71], v[116:119]
    ds_read_b64_tr_b16 v[50:51], v250 offset:57856
    v_mfma_f32_16x16x32_bf16 v[120:123], v[80:83], v[56:59], v[120:123]
    ds_read_b64_tr_b16 v[52:53], v251 offset:57344
    v_mfma_f32_16x16x32_bf16 v[124:127], v[80:83], v[60:63], v[124:127]
    ds_read_b64_tr_b16 v[54:55], v251 offset:57856
    v_mfma_f32_16x16x32_bf16 v[128:131], v[80:83], v[64:67], v[128:131]
    v_mfma_f32_16x16x32_bf16 v[132:135], v[80:83], v[68:71], v[132:135]
    v_mfma_f32_16x16x32_bf16 v[136:139], v[84:87], v[56:59], v[136:139]
    v_mfma_f32_16x16x32_bf16 v[140:143], v[84:87], v[60:63], v[140:143]
    v_mfma_f32_16x16x32_bf16 v[144:147], v[84:87], v[64:67], v[144:147]
    v_mfma_f32_16x16x32_bf16 v[148:151], v[84:87], v[68:71], v[148:151]
    s_waitcnt lgkmcnt(9)
    v_mfma_f32_16x16x32_bf16 v[88:91], v[40:43], v[24:27], v[88:91]
    ds_read_b64_tr_b16 v[72:73], v250 offset:53248
    ds_read_b64_tr_b16 v[74:75], v250 offset:53760
    s_waitcnt lgkmcnt(10)
    v_mfma_f32_16x16x32_bf16 v[92:95], v[40:43], v[28:31], v[92:95]
    ds_read_b128 v[56:59], v248 offset:40960
    s_waitcnt lgkmcnt(10)
    v_mfma_f32_16x16x32_bf16 v[96:99], v[40:43], v[32:35], v[96:99]
    ds_read_b128 v[60:63], v248 offset:41984
    ds_read_b128 v[64:67], v248 offset:43008
    s_waitcnt lgkmcnt(11)
    v_mfma_f32_16x16x32_bf16 v[100:103], v[40:43], v[36:39], v[100:103]
    ds_read_b128 v[68:71], v248 offset:44032
    s_waitcnt lgkmcnt(10)
    v_mfma_f32_16x16x32_bf16 v[104:107], v[44:47], v[24:27], v[104:107]
    ds_read_b64_tr_b16 v[76:77], v251 offset:53248
    ds_read_b64_tr_b16 v[78:79], v251 offset:53760
    v_mfma_f32_16x16x32_bf16 v[108:111], v[44:47], v[28:31], v[108:111]
    ds_read_b64_tr_b16 v[80:81], v250 offset:61440
    v_mfma_f32_16x16x32_bf16 v[112:115], v[44:47], v[32:35], v[112:115]
    ds_read_b64_tr_b16 v[82:83], v250 offset:61952
    ds_read_b64_tr_b16 v[84:85], v251 offset:61440
    v_mfma_f32_16x16x32_bf16 v[116:119], v[44:47], v[36:39], v[116:119]
    ds_read_b64_tr_b16 v[86:87], v251 offset:61952
    s_waitcnt lgkmcnt(14)
    v_mfma_f32_16x16x32_bf16 v[120:123], v[48:51], v[24:27], v[120:123]
    v_mfma_f32_16x16x32_bf16 v[124:127], v[48:51], v[28:31], v[124:127]
    v_mfma_f32_16x16x32_bf16 v[128:131], v[48:51], v[32:35], v[128:131]
    v_mfma_f32_16x16x32_bf16 v[132:135], v[48:51], v[36:39], v[132:135]
    s_waitcnt lgkmcnt(12)
    v_mfma_f32_16x16x32_bf16 v[136:139], v[52:55], v[24:27], v[136:139]
    v_mfma_f32_16x16x32_bf16 v[140:143], v[52:55], v[28:31], v[140:143]
    v_mfma_f32_16x16x32_bf16 v[144:147], v[52:55], v[32:35], v[144:147]
    v_mfma_f32_16x16x32_bf16 v[148:151], v[52:55], v[36:39], v[148:151]
    s_waitcnt vmcnt(0) lgkmcnt(0)
    s_barrier
    v_mfma_f32_16x16x32_bf16 v[88:91], v[72:75], v[56:59], v[88:91]
    ds_read_b64_tr_b16 v[40:41], v252 offset:16384
    ds_read_b64_tr_b16 v[42:43], v252 offset:16896
    v_readlane_b32 s90, v238, 0
    v_readlane_b32 s91, v238, 1
    v_mfma_f32_16x16x32_bf16 v[92:95], v[72:75], v[60:63], v[92:95]
    ds_read_b128 v[24:27], v249 offset:0
    s_nop 1
    s_sub_u32 s90, s91, s90
    v_mfma_f32_16x16x32_bf16 v[96:99], v[72:75], v[64:67], v[96:99]
    ds_read_b128 v[28:31], v249 offset:1024
    s_abs_i32 s91, s90
    v_mfma_f32_16x16x32_bf16 v[100:103], v[72:75], v[68:71], v[100:103]
    ds_read_b128 v[32:35], v249 offset:2048
    s_min_u32 s91, s91, 0x1000
    s_add_u32 s91, s91, 35
    v_mfma_f32_16x16x32_bf16 v[104:107], v[76:79], v[56:59], v[104:107]
    ds_read_b128 v[36:39], v249 offset:3072
    s_mul_i32 s91, s91, 937
    s_lshr_b32 s91, s91, 16
    v_mfma_f32_16x16x32_bf16 v[108:111], v[76:79], v[60:63], v[108:111]
    ds_read_b64_tr_b16 v[44:45], v253 offset:16384
    ds_read_b64_tr_b16 v[46:47], v253 offset:16896
    s_min_u32 s91, s91, 4
    v_mfma_f32_16x16x32_bf16 v[112:115], v[76:79], v[64:67], v[112:115]
    ds_read_b64_tr_b16 v[48:49], v252 offset:24576
    s_sub_u32 s92, 0, s91
    s_cmp_lt_i32 s90, 0
    v_mfma_f32_16x16x32_bf16 v[116:119], v[76:79], v[68:71], v[116:119]
    ds_read_b64_tr_b16 v[50:51], v252 offset:25088
    s_cselect_b32 s91, s92, s91
    v_mfma_f32_16x16x32_bf16 v[120:123], v[80:83], v[56:59], v[120:123]
    ds_read_b64_tr_b16 v[52:53], v253 offset:24576
    s_add_u32 s34, s91, 16
    s_and_b32 s91, s91, 3
    v_mfma_f32_16x16x32_bf16 v[124:127], v[80:83], v[60:63], v[124:127]
    ds_read_b64_tr_b16 v[54:55], v253 offset:25088
    s_mov_b32 s46, 0x9a69a69a
    s_mov_b32 s47, 0x269a69a6
    v_mfma_f32_16x16x32_bf16 v[128:131], v[80:83], v[64:67], v[128:131]
    s_cmp_eq_u32 s91, 1
    v_mfma_f32_16x16x32_bf16 v[132:135], v[80:83], v[68:71], v[132:135]
    s_cselect_b32 s46, 0xd34d34e6, s46
    s_cselect_b32 s47, 0x34d34d34, s47
    v_mfma_f32_16x16x32_bf16 v[136:139], v[84:87], v[56:59], v[136:139]
    s_cmp_eq_u32 s91, 2
    s_cselect_b32 s46, 0x9a7334e6, s46
    v_mfma_f32_16x16x32_bf16 v[140:143], v[84:87], v[60:63], v[140:143]
    s_cselect_b32 s47, 0x269a69a6, s47
    v_mfma_f32_16x16x32_bf16 v[144:147], v[84:87], v[64:67], v[144:147]
    s_cmp_eq_u32 s91, 3
    s_cselect_b32 s46, 0x9a7334e6, s46
    v_mfma_f32_16x16x32_bf16 v[148:151], v[84:87], v[68:71], v[148:151]
    s_cselect_b32 s47, 0x34d34d39, s47
    s_waitcnt lgkmcnt(9)
    v_mfma_f32_16x16x32_bf16 v[88:91], v[40:43], v[24:27], v[88:91]
    ds_read_b64_tr_b16 v[72:73], v252 offset:20480
    ds_read_b64_tr_b16 v[74:75], v252 offset:20992
    s_waitcnt lgkmcnt(10)
    v_mfma_f32_16x16x32_bf16 v[92:95], v[40:43], v[28:31], v[92:95]
    ds_read_b128 v[56:59], v249 offset:8192
    s_waitcnt lgkmcnt(10)
    v_mfma_f32_16x16x32_bf16 v[96:99], v[40:43], v[32:35], v[96:99]
    ds_read_b128 v[60:63], v249 offset:9216
    ds_read_b128 v[64:67], v249 offset:10240
    s_waitcnt lgkmcnt(11)
    v_mfma_f32_16x16x32_bf16 v[100:103], v[40:43], v[36:39], v[100:103]
    ds_read_b128 v[68:71], v249 offset:11264
    s_waitcnt lgkmcnt(10)
    v_mfma_f32_16x16x32_bf16 v[104:107], v[44:47], v[24:27], v[104:107]
    ds_read_b64_tr_b16 v[76:77], v253 offset:20480
    ds_read_b64_tr_b16 v[78:79], v253 offset:20992
    v_mfma_f32_16x16x32_bf16 v[108:111], v[44:47], v[28:31], v[108:111]
    ds_read_b64_tr_b16 v[80:81], v252 offset:28672
    v_mfma_f32_16x16x32_bf16 v[112:115], v[44:47], v[32:35], v[112:115]
    ds_read_b64_tr_b16 v[82:83], v252 offset:29184
    ds_read_b64_tr_b16 v[84:85], v253 offset:28672
    v_mfma_f32_16x16x32_bf16 v[116:119], v[44:47], v[36:39], v[116:119]
L_pad5:
    s_cbranch_execz L_vret2
    ds_read_b64_tr_b16 v[86:87], v253 offset:29184
    s_waitcnt lgkmcnt(14)
    v_mfma_f32_16x16x32_bf16 v[120:123], v[48:51], v[24:27], v[120:123]
    v_mfma_f32_16x16x32_bf16 v[124:127], v[48:51], v[28:31], v[124:127]
    s_lshl_b32 s48, s46, 15
    s_and_b32 s48, s48, 0x38000
    v_mfma_f32_16x16x32_bf16 v[128:131], v[48:51], v[32:35], v[128:131]
    s_lshr_b64 s[46:47], s[46:47], 3
    v_mfma_f32_16x16x32_bf16 v[132:135], v[48:51], v[36:39], v[132:135]
    v_xor_b32 v252, s48, v252
    s_waitcnt lgkmcnt(12)
    v_mfma_f32_16x16x32_bf16 v[136:139], v[52:55], v[24:27], v[136:139]
    v_xor_b32 v249, s48, v249
    v_mfma_f32_16x16x32_bf16 v[140:143], v[52:55], v[28:31], v[140:143]
    v_xor_b32 v253, s48, v253
    v_mfma_f32_16x16x32_bf16 v[144:147], v[52:55], v[32:35], v[144:147]
    s_sub_u32 s34, s34, 1
    v_mfma_f32_16x16x32_bf16 v[148:151], v[52:55], v[36:39], v[148:151]
.p2align 6
L_dl:
    s_waitcnt lgkmcnt(0)
    s_barrier
    v_mfma_f32_16x16x32_bf16 v[88:91], v[72:75], v[56:59], v[88:91]
    ds_read_b64_tr_b16 v[40:41], v252 offset:16384
    ds_read_b64_tr_b16 v[42:43], v252 offset:16896
    v_mfma_f32_16x16x32_bf16 v[92:95], v[72:75], v[60:63], v[92:95]
    ds_read_b128 v[24:27], v249 offset:0
    v_mfma_f32_16x16x32_bf16 v[96:99], v[72:75], v[64:67], v[96:99]
    ds_read_b128 v[28:31], v249 offset:1024
    v_mfma_f32_16x16x32_bf16 v[100:103], v[72:75], v[68:71], v[100:103]
    ds_read_b128 v[32:35], v249 offset:2048
    v_mfma_f32_16x16x32_bf16 v[104:107], v[76:79], v[56:59], v[104:107]
    ds_read_b128 v[36:39], v249 offset:3072
    v_mfma_f32_16x16x32_bf16 v[108:111], v[76:79], v[60:63], v[108:111]
    ds_read_b64_tr_b16 v[44:45], v253 offset:16384
    ds_read_b64_tr_b16 v[46:47], v253 offset:16896
    v_mfma_f32_16x16x32_bf16 v[112:115], v[76:79], v[64:67], v[112:115]
    ds_read_b64_tr_b16 v[48:49], v252 offset:24576
    v_mfma_f32_16x16x32_bf16 v[116:119], v[76:79], v[68:71], v[116:119]
    ds_read_b64_tr_b16 v[50:51], v252 offset:25088
    v_mfma_f32_16x16x32_bf16 v[120:123], v[80:83], v[56:59], v[120:123]
    ds_read_b64_tr_b16 v[52:53], v253 offset:24576
    v_mfma_f32_16x16x32_bf16 v[124:127], v[80:83], v[60:63], v[124:127]
    ds_read_b64_tr_b16 v[54:55], v253 offset:25088
    v_mfma_f32_16x16x32_bf16 v[128:131], v[80:83], v[64:67], v[128:131]
    v_mfma_f32_16x16x32_bf16 v[132:135], v[80:83], v[68:71], v[132:135]
    v_mfma_f32_16x16x32_bf16 v[136:139], v[84:87], v[56:59], v[136:139]
    v_mfma_f32_16x16x32_bf16 v[140:143], v[84:87], v[60:63], v[140:143]
    v_mfma_f32_16x16x32_bf16 v[144:147], v[84:87], v[64:67], v[144:147]
    v_mfma_f32_16x16x32_bf16 v[148:151], v[84:87], v[68:71], v[148:151]
    s_waitcnt lgkmcnt(9)
    v_mfma_f32_16x16x32_bf16 v[88:91], v[40:43], v[24:27], v[88:91]
    ds_read_b64_tr_b16 v[72:73], v252 offset:20480
    ds_read_b64_tr_b16 v[74:75], v252 offset:20992
    s_waitcnt lgkmcnt(10)
    v_mfma_f32_16x16x32_bf16 v[92:95], v[40:43], v[28:31], v[92:95]
    ds_read_b128 v[56:59], v249 offset:8192
    s_waitcnt lgkmcnt(10)
    v_mfma_f32_16x16x32_bf16 v[96:99], v[40:43], v[32:35], v[96:99]
    ds_read_b128 v[60:63], v249 offset:9216
    ds_read_b128 v[64:67], v249 offset:10240
    s_waitcnt lgkmcnt(11)
    v_mfma_f32_16x16x32_bf16 v[100:103], v[40:43], v[36:39], v[100:103]
    ds_read_b128 v[68:71], v249 offset:11264
    s_waitcnt lgkmcnt(10)
    v_mfma_f32_16x16x32_bf16 v[104:107], v[44:47], v[24:27], v[104:107]
    ds_read_b64_tr_b16 v[76:77], v253 offset:20480
    ds_read_b64_tr_b16 v[78:79], v253 offset:20992
    v_mfma_f32_16x16x32_bf16 v[108:111], v[44:47], v[28:31], v[108:111]
    ds_read_b64_tr_b16 v[80:81], v252 offset:28672
    v_mfma_f32_16x16x32_bf16 v[112:115], v[44:47], v[32:35], v[112:115]
    ds_read_b64_tr_b16 v[82:83], v252 offset:29184
    ds_read_b64_tr_b16 v[84:85], v253 offset:28672
    v_mfma_f32_16x16x32_bf16 v[116:119], v[44:47], v[36:39], v[116:119]
    ds_read_b64_tr_b16 v[86:87], v253 offset:29184
    s_waitcnt lgkmcnt(14)
    v_mfma_f32_16x16x32_bf16 v[120:123], v[48:51], v[24:27], v[120:123]
    v_mfma_f32_16x16x32_bf16 v[124:127], v[48:51], v[28:31], v[124:127]
    s_lshl_b32 s48, s46, 15
    s_and_b32 s48, s48, 0x38000
    v_mfma_f32_16x16x32_bf16 v[128:131], v[48:51], v[32:35], v[128:131]
    s_lshr_b64 s[46:47], s[46:47], 3
    v_mfma_f32_16x16x32_bf16 v[132:135], v[48:51], v[36:39], v[132:135]
    v_xor_b32 v252, s48, v252
    s_waitcnt lgkmcnt(12)
    v_mfma_f32_16x16x32_bf16 v[136:139], v[52:55], v[24:27], v[136:139]
    v_xor_b32 v249, s48, v249
    v_mfma_f32_16x16x32_bf16 v[140:143], v[52:55], v[28:31], v[140:143]
    v_xor_b32 v253, s48, v253
    v_mfma_f32_16x16x32_bf16 v[144:147], v[52:55], v[32:35], v[144:147]
    s_sub_u32 s34, s34, 1
    v_mfma_f32_16x16x32_bf16 v[148:151], v[52:55], v[36:39], v[148:151]
    s_cbranch_scc0 L_dl
    s_waitcnt lgkmcnt(0)
    s_barrier
    v_mfma_f32_16x16x32_bf16 v[88:91], v[72:75], v[56:59], v[88:91]
    v_mfma_f32_16x16x32_bf16 v[92:95], v[72:75], v[60:63], v[92:95]
    v_mfma_f32_16x16x32_bf16 v[96:99], v[72:75], v[64:67], v[96:99]
    v_mfma_f32_16x16x32_bf16 v[100:103], v[72:75], v[68:71], v[100:103]
    v_mfma_f32_16x16x32_bf16 v[104:107], v[76:79], v[56:59], v[104:107]
    v_mfma_f32_16x16x32_bf16 v[108:111], v[76:79], v[60:63], v[108:111]
    v_mfma_f32_16x16x32_bf16 v[112:115], v[76:79], v[64:67], v[112:115]
    v_mfma_f32_16x16x32_bf16 v[116:119], v[76:79], v[68:71], v[116:119]
    v_mfma_f32_16x16x32_bf16 v[120:123], v[80:83], v[56:59], v[120:123]
    v_mfma_f32_16x16x32_bf16 v[124:127], v[80:83], v[60:63], v[124:127]
    v_mfma_f32_16x16x32_bf16 v[128:131], v[80:83], v[64:67], v[128:131]
    v_mfma_f32_16x16x32_bf16 v[132:135], v[80:83], v[68:71], v[132:135]
    v_mfma_f32_16x16x32_bf16 v[136:139], v[84:87], v[56:59], v[136:139]
    v_mfma_f32_16x16x32_bf16 v[140:143], v[84:87], v[60:63], v[140:143]
    v_mfma_f32_16x16x32_bf16 v[144:147], v[84:87], v[64:67], v[144:147]
    v_mfma_f32_16x16x32_bf16 v[148:151], v[84:87], v[68:71], v[148:151]
    s_setprio 0
    s_lshl4_add_u32 s91, s28, s29
    s_xor_b32 s91, s91, 136
    s_lshl_b32 s91, s91, 7
    s_add_u32 s91, s91, 0x1ea0000
    v_mov_b32 v13, s91
    s_nop 7
    v_max_f32_e64 v8, |v120|, |v121|
    v_max_f32_e64 v9, |v128|, |v129|
    v_max_f32_e64 v10, |v136|, |v137|
    v_max_f32_e64 v11, |v144|, |v145|
    v_max3_f32 v8, |v122|, |v123|, v8
    v_max3_f32 v9, |v130|, |v131|, v9
    v_max3_f32 v10, |v138|, |v139|, v10
    v_max3_f32 v11, |v146|, |v147|, v11
    v_max3_f32 v8, |v124|, |v125|, v8
    v_max3_f32 v9, |v132|, |v133|, v9
    v_max3_f32 v10, |v140|, |v141|, v10
    v_max3_f32 v11, |v148|, |v149|, v11
    v_max3_f32 v8, |v126|, |v127|, v8
    v_max3_f32 v9, |v134|, |v135|, v9
    v_max3_f32 v10, |v142|, |v143|, v10
    v_max3_f32 v11, |v150|, |v151|, v11
    v_max3_f32 v8, v8, v9, v10
    v_max_f32 v8, v8, v11
    v_min_f32 v8, 0x7f7fffff, v8
    v_frexp_exp_i32_f32 v8, v8
    v_max_i32 v8, -100, v8
    v_sub_u32 v9, 15, v8
    v_add_u32 v8, -15, v8
    v_ldexp_f32 v9, 1.0, v9
    v_ldexp_f32 v8, 1.0, v8
    buffer_store_dword v8, v6, s[68:71], s37 offen sc1
    v_fma_mixlo_f16 v32, v120, v9, 0
    v_fma_mixlo_f16 v33, v122, v9, 0
    v_fma_mixlo_f16 v34, v124, v9, 0
    v_fma_mixlo_f16 v35, v126, v9, 0
    v_fma_mixhi_f16 v32, v121, v9, 0
    v_fma_mixhi_f16 v33, v123, v9, 0
    v_fma_mixhi_f16 v34, v125, v9, 0
    v_fma_mixhi_f16 v35, v127, v9, 0
    s_nop 0
    buffer_store_dwordx4 v[32:35], v4, s[68:71], s36 offen offset:0 sc1
    v_fma_mixlo_f16 v36, v128, v9, 0
    v_fma_mixlo_f16 v37, v130, v9, 0
    v_fma_mixlo_f16 v38, v132, v9, 0
    v_fma_mixlo_f16 v39, v134, v9, 0
    v_fma_mixhi_f16 v36, v129, v9, 0
    v_fma_mixhi_f16 v37, v131, v9, 0
    v_fma_mixhi_f16 v38, v133, v9, 0
    v_fma_mixhi_f16 v39, v135, v9, 0
    s_nop 0
    buffer_store_dwordx4 v[36:39], v4, s[68:71], s36 offen offset:1024 sc1
    s_barrier
    v_fma_mixlo_f16 v40, v136, v9, 0
    v_fma_mixlo_f16 v41, v138, v9, 0
    v_fma_mixlo_f16 v42, v140, v9, 0
    v_fma_mixlo_f16 v43, v142, v9, 0
    v_fma_mixhi_f16 v40, v137, v9, 0
    v_fma_mixhi_f16 v41, v139, v9, 0
    v_fma_mixhi_f16 v42, v141, v9, 0
    v_fma_mixhi_f16 v43, v143, v9, 0
    s_nop 0
    buffer_store_dwordx4 v[40:43], v4, s[68:71], s36 offen offset:2048 sc1
    v_fma_mixlo_f16 v44, v144, v9, 0
    v_fma_mixlo_f16 v45, v146, v9, 0
    v_fma_mixlo_f16 v46, v148, v9, 0
    v_fma_mixlo_f16 v47, v150, v9, 0
    v_fma_mixhi_f16 v44, v145, v9, 0
    v_fma_mixhi_f16 v45, v147, v9, 0
    v_fma_mixhi_f16 v46, v149, v9, 0
    v_fma_mixhi_f16 v47, v151, v9, 0
    s_nop 0
    buffer_store_dwordx4 v[44:47], v4, s[68:71], s36 offen offset:3072 sc1
    s_barrier
    s_barrier
    s_waitcnt vmcnt(0)
    s_barrier
    s_cmp_lg_u32 s4, 0
    s_cbranch_scc1 L_fP
    s_lshl_b32 s91, s28, 4
    s_add_u32 s91, s91, s29
    s_lshl_b32 s91, s91, 7
    s_add_u32 s91, s91, 0x1ea0000
    v_mov_b32 v16, s91
    v_mov_b32 v18, s100
    v_mov_b32 v19, s101
    s_mov_b64 exec, 1
    global_store_dwordx2 v16, v[18:19], s[26:27] sc1
    s_mov_b64 exec, -1
L_fP:
    s_barrier
    s_mov_b64 exec, 1
    global_load_dwordx2 v[14:15], v13, s[26:27] sc1
    s_mov_b64 exec, -1
    s_barrier
    s_barrier
    s_waitcnt vmcnt(0)
    s_mov_b64 exec, 1
    s_movk_i32 s98, 0x4000
L_pP_chk:
    v_cmp_ne_u64 vcc, s[100:101], v[14:15]
    s_nop 1
    s_cmp_eq_u64 vcc, 0
    s_cbranch_scc1 L_pP_ok
    s_sub_u32 s98, s98, 1
    s_cbranch_scc1 L_pP_ok
    s_sleep 1
    global_load_dwordx2 v[14:15], v13, s[26:27] sc1
    s_waitcnt vmcnt(0)
    s_branch L_pP_chk
L_pP_ok:
    s_mov_b64 exec, -1
    buffer_load_dword v168, v6, s[68:71], s39 offen sc1
    buffer_load_dwordx4 v[152:155], v4, s[68:71], s38 offen offset:0 sc1
    buffer_load_dwordx4 v[156:159], v4, s[68:71], s38 offen offset:1024 sc1
    buffer_load_dwordx4 v[160:163], v4, s[68:71], s38 offen offset:2048 sc1
    buffer_load_dwordx4 v[164:167], v4, s[68:71], s38 offen offset:3072 sc1
    s_barrier
    s_barrier
    s_barrier
    s_waitcnt vmcnt(3)
    v_fma_mix_f32 v88, v152, v168, v88 op_sel:[0,0,0] op_sel_hi:[1,0,0]
    v_fma_mix_f32 v89, v152, v168, v89 op_sel:[1,0,0] op_sel_hi:[1,0,0]
    v_fma_mix_f32 v90, v153, v168, v90 op_sel:[0,0,0] op_sel_hi:[1,0,0]
    v_fma_mix_f32 v91, v153, v168, v91 op_sel:[1,0,0] op_sel_hi:[1,0,0]
    v_cvt_pk_bf16_f32 v28, v88, v89
    v_cvt_pk_bf16_f32 v29, v90, v91
    v_lshlrev_b32 v88, 16, v28
    v_and_b32 v89, 0xffff0000, v28
    v_lshlrev_b32 v90, 16, v29
    v_and_b32 v91, 0xffff0000, v29
    v_mul_f32 v24, 0xbfb8aa3b, v88
    v_mul_f32 v25, 0xbfb8aa3b, v89
    v_mul_f32 v26, 0xbfb8aa3b, v90
    v_mul_f32 v27, 0xbfb8aa3b, v91
    v_exp_f32 v24, v24
    v_exp_f32 v25, v25
    v_exp_f32 v26, v26
    v_exp_f32 v27, v27
    s_nop 0
    v_add_f32 v24, 1.0, v24
    v_add_f32 v25, 1.0, v25
    v_add_f32 v26, 1.0, v26
    v_add_f32 v27, 1.0, v27
    v_rcp_f32 v24, v24
    v_rcp_f32 v25, v25
    v_rcp_f32 v26, v26
    v_rcp_f32 v27, v27
    s_nop 0
    v_mul_f32 v24, v24, v88
    v_mul_f32 v25, v25, v89
    v_mul_f32 v26, v26, v90
    v_mul_f32 v27, v27, v91
    v_cvt_pk_bf16_f32 v88, v24, v25
    v_cvt_pk_bf16_f32 v89, v26, v27
    ds_write_b64 v5, v[88:89] offset:0
    v_fma_mix_f32 v92, v154, v168, v92 op_sel:[0,0,0] op_sel_hi:[1,0,0]
    v_fma_mix_f32 v93, v154, v168, v93 op_sel:[1,0,0] op_sel_hi:[1,0,0]
    v_fma_mix_f32 v94, v155, v168, v94 op_sel:[0,0,0] op_sel_hi:[1,0,0]
    v_fma_mix_f32 v95, v155, v168, v95 op_sel:[1,0,0] op_sel_hi:[1,0,0]
    v_cvt_pk_bf16_f32 v28, v92, v93
    v_cvt_pk_bf16_f32 v29, v94, v95
    v_lshlrev_b32 v92, 16, v28
    v_and_b32 v93, 0xffff0000, v28
    v_lshlrev_b32 v94, 16, v29
    v_and_b32 v95, 0xffff0000, v29
    v_mul_f32 v24, 0xbfb8aa3b, v92
    v_mul_f32 v25, 0xbfb8aa3b, v93
    v_mul_f32 v26, 0xbfb8aa3b, v94
    v_mul_f32 v27, 0xbfb8aa3b, v95
    v_exp_f32 v24, v24
    v_exp_f32 v25, v25
    v_exp_f32 v26, v26
    v_exp_f32 v27, v27
    s_nop 0
    v_add_f32 v24, 1.0, v24
    v_add_f32 v25, 1.0, v25
    v_add_f32 v26, 1.0, v26
    v_add_f32 v27, 1.0, v27
    v_rcp_f32 v24, v24
    v_rcp_f32 v25, v25
    v_rcp_f32 v26, v26
    s_barrier
    v_rcp_f32 v27, v27
    s_nop 0
    v_mul_f32 v24, v24, v92
    v_mul_f32 v25, v25, v93
    v_mul_f32 v26, v26, v94
    v_mul_f32 v27, v27, v95
    v_cvt_pk_bf16_f32 v92, v24, v25
    v_cvt_pk_bf16_f32 v93, v26, v27
    ds_write_b64 v5, v[92:93] offset:512
    s_waitcnt vmcnt(2)
    v_fma_mix_f32 v96, v156, v168, v96 op_sel:[0,0,0] op_sel_hi:[1,0,0]
    v_fma_mix_f32 v97, v156, v168, v97 op_sel:[1,0,0] op_sel_hi:[1,0,0]
    v_fma_mix_f32 v98, v157, v168, v98 op_sel:[0,0,0] op_sel_hi:[1,0,0]
    v_fma_mix_f32 v99, v157, v168, v99 op_sel:[1,0,0] op_sel_hi:[1,0,0]
    v_cvt_pk_bf16_f32 v28, v96, v97
    v_cvt_pk_bf16_f32 v29, v98, v99
    v_lshlrev_b32 v96, 16, v28
    v_and_b32 v97, 0xffff0000, v28
    v_lshlrev_b32 v98, 16, v29
    v_and_b32 v99, 0xffff0000, v29
    v_mul_f32 v24, 0xbfb8aa3b, v96
    v_mul_f32 v25, 0xbfb8aa3b, v97
    v_mul_f32 v26, 0xbfb8aa3b, v98
    v_mul_f32 v27, 0xbfb8aa3b, v99
    v_exp_f32 v24, v24
    v_exp_f32 v25, v25
    v_exp_f32 v26, v26
    v_exp_f32 v27, v27
    s_nop 0
    v_add_f32 v24, 1.0, v24
    v_add_f32 v25, 1.0, v25
    v_add_f32 v26, 1.0, v26
    v_add_f32 v27, 1.0, v27
    v_rcp_f32 v24, v24
    v_rcp_f32 v25, v25
    v_rcp_f32 v26, v26
    v_rcp_f32 v27, v27
    s_nop 0
    v_mul_f32 v24, v24, v96
    v_mul_f32 v25, v25, v97
    v_mul_f32 v26, v26, v98
    v_mul_f32 v27, v27, v99
    v_cvt_pk_bf16_f32 v96, v24, v25
    v_cvt_pk_bf16_f32 v97, v26, v27
    ds_write_b64 v5, v[96:97] offset:1024
    v_fma_mix_f32 v100, v158, v168, v100 op_sel:[0,0,0] op_sel_hi:[1,0,0]
    v_fma_mix_f32 v101, v158, v168, v101 op_sel:[1,0,0] op_sel_hi:[1,0,0]
    v_fma_mix_f32 v102, v159, v168, v102 op_sel:[0,0,0] op_sel_hi:[1,0,0]
    v_fma_mix_f32 v103, v159, v168, v103 op_sel:[1,0,0] op_sel_hi:[1,0,0]
    v_cvt_pk_bf16_f32 v28, v100, v101
    v_cvt_pk_bf16_f32 v29, v102, v103
    v_lshlrev_b32 v100, 16, v28
    v_and_b32 v101, 0xffff0000, v28
    v_lshlrev_b32 v102, 16, v29
    v_and_b32 v103, 0xffff0000, v29
    v_mul_f32 v24, 0xbfb8aa3b, v100
    v_mul_f32 v25, 0xbfb8aa3b, v101
    v_mul_f32 v26, 0xbfb8aa3b, v102
    v_mul_f32 v27, 0xbfb8aa3b, v103
    v_exp_f32 v24, v24
    v_exp_f32 v25, v25
    v_exp_f32 v26, v26
    v_exp_f32 v27, v27
    s_nop 0
    v_add_f32 v24, 1.0, v24
    v_add_f32 v25, 1.0, v25
    s_barrier
    v_add_f32 v26, 1.0, v26
    v_add_f32 v27, 1.0, v27
    v_rcp_f32 v24, v24
    v_rcp_f32 v25, v25
    v_rcp_f32 v26, v26
    v_rcp_f32 v27, v27
    s_nop 0
    v_mul_f32 v24, v24, v100
    v_mul_f32 v25, v25, v101
    v_mul_f32 v26, v26, v102
    v_mul_f32 v27, v27, v103
    v_cvt_pk_bf16_f32 v100, v24, v25
    v_cvt_pk_bf16_f32 v101, v26, v27
    ds_write_b64 v5, v[100:101] offset:1536
    s_waitcnt vmcnt(1)
    v_fma_mix_f32 v104, v160, v168, v104 op_sel:[0,0,0] op_sel_hi:[1,0,0]
    v_fma_mix_f32 v105, v160, v168, v105 op_sel:[1,0,0] op_sel_hi:[1,0,0]
    v_fma_mix_f32 v106, v161, v168, v106 op_sel:[0,0,0] op_sel_hi:[1,0,0]
    v_fma_mix_f32 v107, v161, v168, v107 op_sel:[1,0,0] op_sel_hi:[1,0,0]
    v_cvt_pk_bf16_f32 v28, v104, v105
    v_cvt_pk_bf16_f32 v29, v106, v107
    v_lshlrev_b32 v104, 16, v28
    v_and_b32 v105, 0xffff0000, v28
    v_lshlrev_b32 v106, 16, v29
    v_and_b32 v107, 0xffff0000, v29
    v_mul_f32 v24, 0xbfb8aa3b, v104
    v_mul_f32 v25, 0xbfb8aa3b, v105
    v_mul_f32 v26, 0xbfb8aa3b, v106
    v_mul_f32 v27, 0xbfb8aa3b, v107
    v_exp_f32 v24, v24
    v_exp_f32 v25, v25
    v_exp_f32 v26, v26
    v_exp_f32 v27, v27
    s_nop 0
    v_add_f32 v24, 1.0, v24
    v_add_f32 v25, 1.0, v25
    v_add_f32 v26, 1.0, v26
    v_add_f32 v27, 1.0, v27
    v_rcp_f32 v24, v24
    v_rcp_f32 v25, v25
    v_rcp_f32 v26, v26
    v_rcp_f32 v27, v27
    s_nop 0
    v_mul_f32 v24, v24, v104
    v_mul_f32 v25, v25, v105
    v_mul_f32 v26, v26, v106
    v_mul_f32 v27, v27, v107
    v_cvt_pk_bf16_f32 v104, v24, v25
    v_cvt_pk_bf16_f32 v105, v26, v27
    ds_write_b64 v5, v[104:105] offset:2048
    v_fma_mix_f32 v108, v162, v168, v108 op_sel:[0,0,0] op_sel_hi:[1,0,0]
    v_fma_mix_f32 v109, v162, v168, v109 op_sel:[1,0,0] op_sel_hi:[1,0,0]
    v_fma_mix_f32 v110, v163, v168, v110 op_sel:[0,0,0] op_sel_hi:[1,0,0]
    v_fma_mix_f32 v111, v163, v168, v111 op_sel:[1,0,0] op_sel_hi:[1,0,0]
    v_cvt_pk_bf16_f32 v28, v108, v109
    v_cvt_pk_bf16_f32 v29, v110, v111
    v_lshlrev_b32 v108, 16, v28
    v_and_b32 v109, 0xffff0000, v28
    v_lshlrev_b32 v110, 16, v29
    v_and_b32 v111, 0xffff0000, v29
    v_mul_f32 v24, 0xbfb8aa3b, v108
    v_mul_f32 v25, 0xbfb8aa3b, v109
    v_mul_f32 v26, 0xbfb8aa3b, v110
    v_mul_f32 v27, 0xbfb8aa3b, v111
    v_exp_f32 v24, v24
    s_barrier
    v_exp_f32 v25, v25
    v_exp_f32 v26, v26
    v_exp_f32 v27, v27
    s_nop 0
    v_add_f32 v24, 1.0, v24
    v_add_f32 v25, 1.0, v25
    v_add_f32 v26, 1.0, v26
    v_add_f32 v27, 1.0, v27
    v_rcp_f32 v24, v24
    v_rcp_f32 v25, v25
    v_rcp_f32 v26, v26
    v_rcp_f32 v27, v27
    s_nop 0
    v_mul_f32 v24, v24, v108
    v_mul_f32 v25, v25, v109
    v_mul_f32 v26, v26, v110
    v_mul_f32 v27, v27, v111
    v_cvt_pk_bf16_f32 v108, v24, v25
    v_cvt_pk_bf16_f32 v109, v26, v27
    ds_write_b64 v5, v[108:109] offset:2560
    s_waitcnt vmcnt(0)
    v_fma_mix_f32 v112, v164, v168, v112 op_sel:[0,0,0] op_sel_hi:[1,0,0]
    v_fma_mix_f32 v113, v164, v168, v113 op_sel:[1,0,0] op_sel_hi:[1,0,0]
    v_fma_mix_f32 v114, v165, v168, v114 op_sel:[0,0,0] op_sel_hi:[1,0,0]
    v_fma_mix_f32 v115, v165, v168, v115 op_sel:[1,0,0] op_sel_hi:[1,0,0]
    v_cvt_pk_bf16_f32 v28, v112, v113
    v_cvt_pk_bf16_f32 v29, v114, v115
    v_lshlrev_b32 v112, 16, v28
    v_and_b32 v113, 0xffff0000, v28
    v_lshlrev_b32 v114, 16, v29
    v_and_b32 v115, 0xffff0000, v29
    v_mul_f32 v24, 0xbfb8aa3b, v112
    v_mul_f32 v25, 0xbfb8aa3b, v113
    v_mul_f32 v26, 0xbfb8aa3b, v114
    v_mul_f32 v27, 0xbfb8aa3b, v115
    v_exp_f32 v24, v24
    v_exp_f32 v25, v25
    v_exp_f32 v26, v26
    v_exp_f32 v27, v27
    s_nop 0
    v_add_f32 v24, 1.0, v24
    v_add_f32 v25, 1.0, v25
    v_add_f32 v26, 1.0, v26
    v_add_f32 v27, 1.0, v27
    v_rcp_f32 v24, v24
    v_rcp_f32 v25, v25
    v_rcp_f32 v26, v26
    v_rcp_f32 v27, v27
    s_nop 0
    v_mul_f32 v24, v24, v112
    v_mul_f32 v25, v25, v113
    v_mul_f32 v26, v26, v114
    v_mul_f32 v27, v27, v115
    v_cvt_pk_bf16_f32 v112, v24, v25
    v_cvt_pk_bf16_f32 v113, v26, v27
    ds_write_b64 v5, v[112:113] offset:3072
    v_fma_mix_f32 v116, v166, v168, v116 op_sel:[0,0,0] op_sel_hi:[1,0,0]
    v_fma_mix_f32 v117, v166, v168, v117 op_sel:[1,0,0] op_sel_hi:[1,0,0]
    v_fma_mix_f32 v118, v167, v168, v118 op_sel:[0,0,0] op_sel_hi:[1,0,0]
    v_fma_mix_f32 v119, v167, v168, v119 op_sel:[1,0,0] op_sel_hi:[1,0,0]
    v_cvt_pk_bf16_f32 v28, v116, v117
    v_cvt_pk_bf16_f32 v29, v118, v119
    v_lshlrev_b32 v116, 16, v28
    v_and_b32 v117, 0xffff0000, v28
    s_barrier
    v_lshlrev_b32 v118, 16, v29
    v_and_b32 v119, 0xffff0000, v29
    v_mul_f32 v24, 0xbfb8aa3b, v116
    v_mul_f32 v25, 0xbfb8aa3b, v117
    v_mul_f32 v26, 0xbfb8aa3b, v118
    v_mul_f32 v27, 0xbfb8aa3b, v119
    v_exp_f32 v24, v24
    v_exp_f32 v25, v25
    v_exp_f32 v26, v26
    v_exp_f32 v27, v27
    s_nop 0
    v_add_f32 v24, 1.0, v24
    v_add_f32 v25, 1.0, v25
    v_add_f32 v26, 1.0, v26
    v_add_f32 v27, 1.0, v27
    v_rcp_f32 v24, v24
    v_rcp_f32 v25, v25
    v_rcp_f32 v26, v26
    v_rcp_f32 v27, v27
    s_nop 0
    v_mul_f32 v24, v24, v116
    v_mul_f32 v25, v25, v117
    v_mul_f32 v26, v26, v118
    v_mul_f32 v27, v27, v119
    v_cvt_pk_bf16_f32 v116, v24, v25
    v_cvt_pk_bf16_f32 v117, v26, v27
    ds_write_b64 v5, v[116:117] offset:3584
    s_waitcnt lgkmcnt(0)
    s_barrier
    s_branch L_fin
.p2align 12
L_teamB:
    s_mov_b64 exec, -1
    s_setprio 3
    v_lshrrev_b32 v64, 4, v1
    v_bfe_u32 v65, v1, 2, 2
    v_and_b32 v66, 3, v1
    v_and_b32 v67, 15, v1
    v_lshrrev_b32 v68, 3, v1
    v_and_b32 v69, 7, v1
    s_lshl_b32 s85, s28, 7
    s_lshl_b32 s86, s4, 5
    s_add_u32 s86, s85, s86
    v_add_u32 v71, s86, v68
    v_xor_b32 v70, v69, v64
    v_lshlrev_b32 v70, 4, v70
    v_lshl_add_u32 v20, v71, 11, v70
    v_xor_b32 v21, 64, v20
    v_add_u32 v21, 16384, v21
    s_lshl_b32 s79, s4, 12
    s_and_b32 s72, s28, 3
    s_bitcmp1_b32 s28, 3
    s_cselect_b32 s91, 4, 0
    s_add_u32 s72, s72, s91
    s_mul_i32 s72, s72, 256
    s_waitcnt lgkmcnt(0)
    s_mov_b32 s36, s8
    s_mov_b32 s37, s9
    s_mov_b32 s38, 0x400000
    s_mov_b32 s39, 0x20000
    s_add_u32 m0, s79, 135168
    s_add_u32 s72, s72, 128
    s_and_b32 s78, s72, 0x7ff
    buffer_load_dwordx4 v20, s[36:39], s78 offen lds
    s_add_u32 m0, s79, 136192
    s_nop 0
    buffer_load_dwordx4 v21, s[36:39], s78 offen lds
    s_add_u32 m0, s79, 137216
    s_add_u32 s78, s78, 32768
    buffer_load_dwordx4 v20, s[36:39], s78 offen lds
    s_add_u32 m0, s79, 138240
    s_nop 0
    buffer_load_dwordx4 v21, s[36:39], s78 offen lds
    s_setprio 0
    s_mov_b32 s68, s26
    s_mov_b32 s69, s27
    s_mov_b32 s70, 0x10000000
    s_mov_b32 s71, 0x20000
L_fan5:
    s_cbranch_execz L_teamB
    s_lshl_b32 s85, s4, 3
    s_and_b32 s86, s4, 1
    s_lshl_b32 s86, s86, 2
    v_and_b32 v70, 2, v68
    v_xor_b32 v70, v70, v69
    v_xor_b32 v70, s86, v70
    v_add_u32 v71, s85, v68
    v_mul_u32_u24 v71, 7168, v71
    v_lshl_add_u32 v22, v70, 4, v71
    v_lshrrev_b32 v71, 2, v1
    s_lshl_b32 s86, s86, 2
    v_add_u32 v71, s86, v71
    v_mul_u32_u24 v71, 7168, v71
    v_and_b32 v70, 2, v64
    v_xor_b32 v70, v70, v66
    v_lshl_add_u32 v9, v70, 4, v71
    s_mul_i32 s85, s29, 320
    s_and_b32 s86, s29, 1
    s_lshl_b32 s87, s86, 6
    s_add_u32 s87, s87, s85
    s_add_u32 s40, s16, s87
    s_addc_u32 s41, s17, 0
    s_sub_u32 s42, 7340032, s87
    s_mov_b32 s43, 0x20000
    s_add_u32 s44, s18, s87
    s_addc_u32 s45, s19, 0
    s_sub_u32 s46, 7340032, s87
    s_mov_b32 s47, 0x20000
    s_xor_b32 s86, s86, 1
    s_lshl_b32 s86, s86, 8
    s_add_u32 s87, s86, s85
    s_cmp_lt_u32 s4, 2
    s_cselect_b32 s88, s16, s18
    s_cselect_b32 s89, s17, s19
    s_add_u32 s48, s88, s87
    s_addc_u32 s49, s89, 0
    s_sub_u32 s50, 7340032, s87
    s_mov_b32 s51, 0x20000
    s_and_b32 s77, s28, 3
    s_bitcmp1_b32 s28, 3
    s_cselect_b32 s91, 4, 0
    s_add_u32 s77, s77, s91
    s_mul_i32 s77, s77, 917504
    s_add_u32 s77, s77, 0x38000
    s_add_u32 m0, s33, 57344
    s_add_u32 s77, s77, 229376
    s_cmp_eq_u32 s77, 7340032
    s_cselect_b32 s77, 0, s77
L_fan6:
    s_cbranch_execz L_teamB
    buffer_load_dwordx4 v22, s[40:43], s77 offen offset:0 lds
    s_add_u32 m0, s33, 61312
    s_nop 0
    buffer_load_dwordx4 v22, s[40:43], s77 offen offset:128 lds
    s_add_u32 m0, s33, 65536
    s_nop 0
    buffer_load_dwordx4 v22, s[44:47], s77 offen offset:0 lds
    s_add_u32 m0, s33, 69504
    s_nop 0
    buffer_load_dwordx4 v22, s[44:47], s77 offen offset:128 lds
    s_add_u32 m0, s33, 73728
    s_nop 0
    buffer_load_dwordx4 v9, s[48:51], s77 offen lds
    s_lshl_b32 s84, s28, 7
    s_lshl_b32 s85, s29, 3
    s_add_u32 s84, s84, s85
    s_lshl1_add_u32 s84, s4, s84
    s_lshl_b32 s90, s84, 3
    s_lshl_b32 s84, s84, 11
    v_lshl_add_u32 v86, v1, 4, s84
    v_and_b32 v70, 1, v67
    v_lshlrev_b32 v70, 4, v70
    v_mov_b32 v71, 0x3f80
    v_lshlrev_b32 v70, v70, v71
    v_lshrrev_b32 v71, 1, v67
    v_cmp_eq_u32 vcc, 0, v71
    s_nop 1
    v_cndmask_b32 v144, 0, v70, vcc
    v_cmp_eq_u32 vcc, 1, v71
    s_nop 1
    v_cndmask_b32 v145, 0, v70, vcc
    v_cmp_eq_u32 vcc, 2, v71
    s_nop 1
    v_cndmask_b32 v146, 0, v70, vcc
    v_cmp_eq_u32 vcc, 3, v71
    s_nop 1
    v_cndmask_b32 v147, 0, v70, vcc
    s_lshl_b32 s91, s4, 12
    s_add_u32 s91, s91, 16384
    v_lshlrev_b32 v70, 1, v64
    v_xor_b32 v71, v69, v70
    v_lshl_add_u32 v71, v71, 4, s91
    v_and_b32 v148, 4, v70
    v_add_u32 v70, v70, v148
    v_and_b32 v148, 1, v68
    v_add_u32 v70, v70, v148
    v_lshl_add_u32 v148, v70, 7, v71
    s_lshl_b32 s91, s5, 11
    s_add_u32 s91, s91, 32768
L_fan7:
    s_cbranch_execz L_teamB
    v_and_b32 v70, 2, v64
    v_xor_b32 v70, v66, v70
    v_lshl_add_u32 v70, v70, 4, s91
    v_lshrrev_b32 v71, 2, v1
    v_lshl_add_u32 v149, v71, 6, v70
    s_lshl2_add_u32 s91, s2, s4
    s_lshl_b32 s52, s91, 9
    s_lshr_b32 s92, s91, 2
    s_mul_i32 s92, s92, 7168
    s_and_b32 s91, s91, 3
    s_lshl_b32 s91, s91, 9
    s_add_u32 s92, s92, s91
    s_add_u32 s53, s92, 5120
    s_barrier
    s_and_b32 s91, s28, 4
    s_cmp_eq_u32 s91, 0
    s_cbranch_scc0 L_cr0
    ds_read_b128 v[112:115], v148 offset:0
    ds_read_b128 v[116:119], v148 offset:512
    ds_read_b128 v[120:123], v148 offset:2048
    ds_read_b128 v[124:127], v148 offset:2560
    ds_read_b128 v[128:131], v149 offset:0
    ds_read_b128 v[132:135], v149 offset:1024
L_cr0:
    s_add_u32 m0, s33, 77824
    s_add_u32 s77, s77, 229376
    buffer_load_dwordx4 v22, s[40:43], s77 offen offset:0 lds
    s_add_u32 m0, s33, 81792
    s_nop 0
    buffer_load_dwordx4 v22, s[40:43], s77 offen offset:128 lds
    s_add_u32 m0, s33, 86016
    s_nop 0
    buffer_load_dwordx4 v22, s[44:47], s77 offen offset:0 lds
    s_add_u32 m0, s33, 89984
    s_nop 0
    buffer_load_dwordx4 v22, s[44:47], s77 offen offset:128 lds
    s_add_u32 m0, s33, 94208
    s_nop 0
    buffer_load_dwordx4 v9, s[48:51], s77 offen lds
    s_add_u32 m0, s79, 98304
    s_add_u32 s72, s72, 128
    s_and_b32 s78, s72, 0x7ff
    buffer_load_dwordx4 v20, s[36:39], s78 offen lds
    s_add_u32 m0, s79, 99328
    s_nop 0
    buffer_load_dwordx4 v21, s[36:39], s78 offen lds
    s_and_b32 s91, s28, 4
    s_cmp_eq_u32 s91, 0
    s_cbranch_scc0 L_cm0
    s_waitcnt lgkmcnt(0)
    s_setprio 2
    v_mfma_f32_16x16x32_bf16 v[136:139], v[144:147], v[112:115], 0
    v_mfma_f32_16x16x32_bf16 v[140:143], v[144:147], v[128:131], 0
    v_mfma_f32_16x16x32_bf16 v[136:139], v[144:147], v[116:119], v[136:139]
    v_mfma_f32_16x16x32_bf16 v[140:143], v[144:147], v[132:135], v[140:143]
    v_mfma_f32_16x16x32_bf16 v[136:139], v[144:147], v[120:123], v[136:139]
    v_mfma_f32_16x16x32_bf16 v[136:139], v[144:147], v[124:127], v[136:139]
    s_setprio 0
L_cm0:
    s_barrier
    s_and_b32 s91, s28, 4
    s_cmp_eq_u32 s91, 0
    s_cbranch_scc0 L_cr1
    ds_read_b128 v[112:115], v148 offset:20480
    ds_read_b128 v[116:119], v148 offset:20992
    ds_read_b128 v[120:123], v148 offset:22528
    ds_read_b128 v[124:127], v148 offset:23040
    ds_read_b128 v[128:131], v149 offset:20480
    ds_read_b128 v[132:135], v149 offset:21504
L_cr1:
    s_add_u32 m0, s79, 100352
    s_add_u32 s78, s78, 32768
    buffer_load_dwordx4 v20, s[36:39], s78 offen lds
    s_add_u32 m0, s79, 101376
    s_nop 0
    buffer_load_dwordx4 v21, s[36:39], s78 offen lds
    s_add_u32 m0, s33, 16384
    s_add_u32 s77, s77, 229376
    s_cmp_eq_u32 s77, 7340032
    s_cselect_b32 s77, 0, s77
    buffer_load_dwordx4 v22, s[40:43], s77 offen offset:0 lds
    s_add_u32 m0, s33, 20352
    s_nop 0
    buffer_load_dwordx4 v22, s[40:43], s77 offen offset:128 lds
    s_add_u32 m0, s33, 24576
    s_nop 0
    buffer_load_dwordx4 v22, s[44:47], s77 offen offset:0 lds
    s_add_u32 m0, s33, 28544
    s_nop 0
    buffer_load_dwordx4 v22, s[44:47], s77 offen offset:128 lds
    s_add_u32 m0, s33, 32768
    s_nop 0
    buffer_load_dwordx4 v9, s[48:51], s77 offen lds
    s_and_b32 s91, s28, 4
    s_cmp_eq_u32 s91, 0
    s_cbranch_scc0 L_cm1
    s_waitcnt lgkmcnt(0)
    s_setprio 2
    v_mfma_f32_16x16x32_bf16 v[136:139], v[144:147], v[112:115], v[136:139]
    v_mfma_f32_16x16x32_bf16 v[140:143], v[144:147], v[128:131], v[140:143]
    v_mfma_f32_16x16x32_bf16 v[136:139], v[144:147], v[116:119], v[136:139]
    v_mfma_f32_16x16x32_bf16 v[140:143], v[144:147], v[132:135], v[140:143]
    v_mfma_f32_16x16x32_bf16 v[136:139], v[144:147], v[120:123], v[136:139]
    v_mfma_f32_16x16x32_bf16 v[136:139], v[144:147], v[124:127], v[136:139]
    s_setprio 0
L_cm1:
    s_waitcnt vmcnt(14)
    s_barrier
    s_and_b32 s91, s28, 4
    s_cmp_eq_u32 s91, 4
    s_cbranch_scc0 L_cr2
    ds_read_b128 v[112:115], v148 offset:40960
    ds_read_b128 v[116:119], v148 offset:41472
    ds_read_b128 v[120:123], v148 offset:43008
    ds_read_b128 v[124:127], v148 offset:43520
    ds_read_b128 v[128:131], v149 offset:40960
    ds_read_b128 v[132:135], v149 offset:41984
L_cr2:
    global_load_dwordx4 v[24:27], v86, s[8:9] offset:0
    global_load_dwordx4 v[32:35], v86, s[8:9] offset:2048
    global_load_dwordx4 v[28:31], v86, s[8:9] offset:1024
    global_load_dwordx4 v[36:39], v86, s[8:9] offset:3072
    s_add_u32 m0, s79, 116736
    s_add_u32 s72, s72, 128
    s_and_b32 s78, s72, 0x7ff
    buffer_load_dwordx4 v20, s[36:39], s78 offen lds
    s_add_u32 m0, s79, 117760
    s_nop 0
    buffer_load_dwordx4 v21, s[36:39], s78 offen lds
    s_add_u32 m0, s33, 36864
    s_add_u32 s77, s77, 229376
    buffer_load_dwordx4 v22, s[40:43], s77 offen offset:0 lds
    s_add_u32 m0, s33, 40832
    s_nop 0
    buffer_load_dwordx4 v22, s[40:43], s77 offen offset:128 lds
    s_add_u32 m0, s33, 45056
    s_nop 0
    buffer_load_dwordx4 v22, s[44:47], s77 offen offset:0 lds
    s_add_u32 m0, s33, 49024
    s_nop 0
    buffer_load_dwordx4 v22, s[44:47], s77 offen offset:128 lds
    s_add_u32 m0, s33, 53248
    s_nop 0
    buffer_load_dwordx4 v9, s[48:51], s77 offen lds
    s_and_b32 s91, s28, 4
    s_cmp_eq_u32 s91, 4
    s_cbranch_scc0 L_cm2
    s_waitcnt lgkmcnt(0)
    s_setprio 2
    v_mfma_f32_16x16x32_bf16 v[136:139], v[144:147], v[112:115], 0
    v_mfma_f32_16x16x32_bf16 v[140:143], v[144:147], v[128:131], 0
    v_mfma_f32_16x16x32_bf16 v[136:139], v[144:147], v[116:119], v[136:139]
    v_mfma_f32_16x16x32_bf16 v[140:143], v[144:147], v[132:135], v[140:143]
    v_mfma_f32_16x16x32_bf16 v[136:139], v[144:147], v[120:123], v[136:139]
    v_mfma_f32_16x16x32_bf16 v[136:139], v[144:147], v[124:127], v[136:139]
    s_setprio 0
L_cm2:
    s_waitcnt vmcnt(20)
    s_barrier
    s_and_b32 s91, s28, 4
    s_cmp_eq_u32 s91, 4
    s_cbranch_scc0 L_cr3
    ds_read_b128 v[112:115], v148 offset:61440
    ds_read_b128 v[116:119], v148 offset:61952
    ds_read_b128 v[120:123], v148 offset:63488
    ds_read_b128 v[124:127], v148 offset:64000
    ds_read_b128 v[128:131], v149 offset:61440
    ds_read_b128 v[132:135], v149 offset:62464
L_cr3:
    s_add_u32 m0, s79, 118784
    s_add_u32 s78, s78, 32768
    buffer_load_dwordx4 v20, s[36:39], s78 offen lds
    s_add_u32 m0, s79, 119808
    s_nop 0
    buffer_load_dwordx4 v21, s[36:39], s78 offen lds
    s_add_u32 m0, s33, 57344
    s_add_u32 s77, s77, 229376
    s_cmp_eq_u32 s77, 7340032
    s_cselect_b32 s77, 0, s77
    buffer_load_dwordx4 v22, s[40:43], s77 offen offset:0 lds
    s_add_u32 m0, s33, 61312
    s_nop 0
    buffer_load_dwordx4 v22, s[40:43], s77 offen offset:128 lds
    s_add_u32 m0, s33, 65536
    s_nop 0
    buffer_load_dwordx4 v22, s[44:47], s77 offen offset:0 lds
    s_add_u32 m0, s33, 69504
    s_nop 0
    buffer_load_dwordx4 v22, s[44:47], s77 offen offset:128 lds
    s_add_u32 m0, s33, 73728
    s_nop 0
    buffer_load_dwordx4 v9, s[48:51], s77 offen lds
    s_and_b32 s91, s28, 4
    s_cmp_eq_u32 s91, 4
    s_cbranch_scc0 L_cm3
    s_waitcnt lgkmcnt(0)
    s_setprio 2
    v_mfma_f32_16x16x32_bf16 v[136:139], v[144:147], v[112:115], v[136:139]
    v_mfma_f32_16x16x32_bf16 v[140:143], v[144:147], v[128:131], v[140:143]
    v_mfma_f32_16x16x32_bf16 v[136:139], v[144:147], v[116:119], v[136:139]
    v_mfma_f32_16x16x32_bf16 v[140:143], v[144:147], v[132:135], v[140:143]
    v_mfma_f32_16x16x32_bf16 v[136:139], v[144:147], v[120:123], v[136:139]
    v_mfma_f32_16x16x32_bf16 v[136:139], v[144:147], v[124:127], v[136:139]
    s_setprio 0
L_cm3:
    s_sub_u32 s91, s2, 224
    s_lshl1_add_u32 s91, s91, 1
    s_cmp_ge_u32 s2, 224
    s_cselect_b32 s91, s91, s2
    s_cselect_b32 s88, s12, s20
    s_cselect_b32 s89, s13, s21
    s_cselect_b32 s34, 0x800000, 0
    s_lshr_b32 s92, s91, 2
    s_lshl_b32 s92, s92, 17
    s_add_u32 s34, s34, s92
    s_and_b32 s93, s91, 3
    s_lshl_b32 s93, s93, 13
    s_add_u32 s34, s34, s93
    s_and_b32 s93, s91, 1
    s_lshl_b32 s93, s93, 7
    s_add_u32 s92, s92, s93
    s_and_b32 s93, s91, 2
    s_lshl_b32 s93, s93, 9
    s_add_u32 s92, s92, s93
    s_add_u32 s92, s92, 256
    s_add_u32 s88, s88, s92
    s_addc_u32 s89, s89, 0
    s_lshl_b32 s76, s4, 15
    s_waitcnt vmcnt(18)
    s_barrier
    s_add_u32 m0, s79, 135168
    s_add_u32 s72, s72, 128
    s_and_b32 s78, s72, 0x7ff
    buffer_load_dwordx4 v20, s[36:39], s78 offen lds
    s_add_u32 m0, s79, 136192
    s_nop 0
    buffer_load_dwordx4 v21, s[36:39], s78 offen lds
    s_add_u32 m0, s33, 77824
    s_add_u32 s77, s77, 229376
    buffer_load_dwordx4 v22, s[40:43], s77 offen offset:0 lds
    s_add_u32 m0, s33, 81792
    s_nop 0
    buffer_load_dwordx4 v22, s[40:43], s77 offen offset:128 lds
    s_add_u32 m0, s33, 86016
    s_nop 0
    buffer_load_dwordx4 v22, s[44:47], s77 offen offset:0 lds
    s_add_u32 m0, s33, 89984
    s_nop 0
    buffer_load_dwordx4 v22, s[44:47], s77 offen offset:128 lds
    s_add_u32 m0, s33, 94208
    s_nop 0
    buffer_load_dwordx4 v9, s[48:51], s77 offen lds
    v_add_f32_dpp v136, v136, v136 row_ror:8 row_mask:0xf bank_mask:0xf
    v_add_f32_dpp v137, v137, v137 row_ror:8 row_mask:0xf bank_mask:0xf
    v_add_f32_dpp v138, v138, v138 row_ror:8 row_mask:0xf bank_mask:0xf
    v_add_f32_dpp v139, v139, v139 row_ror:8 row_mask:0xf bank_mask:0xf
    v_add_f32_dpp v140, v140, v140 row_ror:8 row_mask:0xf bank_mask:0xf
    v_add_f32_dpp v141, v141, v141 row_ror:8 row_mask:0xf bank_mask:0xf
    v_add_f32_dpp v142, v142, v142 row_ror:8 row_mask:0xf bank_mask:0xf
    v_add_f32_dpp v143, v143, v143 row_ror:8 row_mask:0xf bank_mask:0xf
    v_add_f32_dpp v140, v140, v140 row_ror:4 row_mask:0xf bank_mask:0xf
    v_add_f32_dpp v141, v141, v141 row_ror:4 row_mask:0xf bank_mask:0xf
    v_add_f32_dpp v142, v142, v142 row_ror:4 row_mask:0xf bank_mask:0xf
    v_add_f32_dpp v143, v143, v143 row_ror:4 row_mask:0xf bank_mask:0xf
    s_lshl_b32 s91, s29, 4
    s_add_u32 s91, s91, s28
    s_mul_i32 s91, s91, 1280
    s_mul_i32 s92, s5, 640
    s_add_u32 s91, s91, s92
    s_add_u32 s91, s91, 0x1e10000
    s_lshl_b32 s92, s6, 8
    v_and_b32 v112, 8, v1
    v_cmp_eq_u32 vcc, 0, v112
    v_mov_b32 v112, s92
    v_mov_b32 v113, 256
    v_cndmask_b32 v112, v113, v112, vcc
    v_cndmask_b32 v136, v140, v136, vcc
    v_cndmask_b32 v137, v141, v137, vcc
    v_cndmask_b32 v138, v142, v138, vcc
    v_cndmask_b32 v139, v143, v139, vcc
    v_and_b32 v113, 15, v1
    v_lshl_add_u32 v112, v113, 5, v112
    v_and_b32 v113, 16, v1
    v_add3_u32 v112, v112, v113, s91
    s_mov_b64 exec, 0x0fff0fff
    global_store_dwordx4 v112, v[136:139], s[26:27] sc1
    s_mov_b64 exec, -1
    s_load_dword s94, s[88:89], s76 offset:0
    s_load_dword s94, s[88:89], s76 offset:64
    s_load_dword s94, s[88:89], s76 offset:2048
    s_load_dword s94, s[88:89], s76 offset:2112
    s_waitcnt vmcnt(15)
    s_barrier
    s_add_u32 m0, s79, 137216
    s_add_u32 s78, s78, 32768
    buffer_load_dwordx4 v20, s[36:39], s78 offen lds
    s_waitcnt vmcnt(23)
    v_lshlrev_b32 v40, 16, v24
    v_and_b32 v41, 0xffff0000, v24
    v_lshlrev_b32 v42, 16, v25
    v_and_b32 v43, 0xffff0000, v25
    v_lshlrev_b32 v44, 16, v26
    v_and_b32 v45, 0xffff0000, v26
    v_lshlrev_b32 v46, 16, v27
    v_and_b32 v47, 0xffff0000, v27
    s_add_u32 m0, s79, 138240
    s_nop 0
    buffer_load_dwordx4 v21, s[36:39], s78 offen lds
    v_lshlrev_b32 v48, 16, v28
    v_and_b32 v49, 0xffff0000, v28
    v_lshlrev_b32 v50, 16, v29
    v_and_b32 v51, 0xffff0000, v29
    v_lshlrev_b32 v52, 16, v30
    v_and_b32 v53, 0xffff0000, v30
    v_lshlrev_b32 v54, 16, v31
    v_and_b32 v55, 0xffff0000, v31
    s_add_u32 m0, s33, 16384
    s_add_u32 s77, s77, 229376
    s_cmp_eq_u32 s77, 7340032
    s_cselect_b32 s77, 0, s77
    buffer_load_dwordx4 v22, s[40:43], s77 offen offset:0 lds
    v_lshlrev_b32 v56, 16, v32
    v_and_b32 v57, 0xffff0000, v32
    v_lshlrev_b32 v58, 16, v33
    v_and_b32 v59, 0xffff0000, v33
    v_lshlrev_b32 v60, 16, v34
    v_and_b32 v61, 0xffff0000, v34
    v_lshlrev_b32 v62, 16, v35
    v_and_b32 v63, 0xffff0000, v35
    s_add_u32 m0, s33, 20352
    s_nop 0
    buffer_load_dwordx4 v22, s[40:43], s77 offen offset:128 lds
    v_lshlrev_b32 v64, 16, v36
    v_and_b32 v65, 0xffff0000, v36
    v_lshlrev_b32 v66, 16, v37
    v_and_b32 v67, 0xffff0000, v37
    v_lshlrev_b32 v68, 16, v38
    v_and_b32 v69, 0xffff0000, v38
    v_lshlrev_b32 v70, 16, v39
    v_and_b32 v71, 0xffff0000, v39
    s_add_u32 m0, s33, 24576
    s_nop 0
    buffer_load_dwordx4 v22, s[44:47], s77 offen offset:0 lds
    v_add_f32 v72, v40, v41
    v_add_f32 v74, v56, v57
    v_add_f32 v72, v72, v42
    v_add_f32 v74, v74, v58
    v_add_f32 v72, v72, v43
    v_add_f32 v74, v74, v59
    v_add_f32 v72, v72, v44
    v_add_f32 v74, v74, v60
    s_add_u32 m0, s33, 28544
    s_nop 0
    buffer_load_dwordx4 v22, s[44:47], s77 offen offset:128 lds
    s_add_u32 m0, s33, 32768
    s_nop 0
    buffer_load_dwordx4 v9, s[48:51], s77 offen lds
    v_add_f32 v72, v72, v45
    v_add_f32 v74, v74, v61
    v_add_f32 v72, v72, v46
    v_add_f32 v74, v74, v62
    v_add_f32 v72, v72, v47
    v_add_f32 v74, v74, v63
    v_add_f32 v72, v72, v48
    v_add_f32 v74, v74, v64
    s_load_dword s94, s[88:89], s76 offset:4096
    s_load_dword s94, s[88:89], s76 offset:4160
    s_load_dword s94, s[88:89], s76 offset:6144
    s_load_dword s94, s[88:89], s76 offset:6208
    s_waitcnt vmcnt(15)
    s_barrier
    s_add_u32 m0, s79, 98304
    s_add_u32 s72, s72, 128
    s_and_b32 s78, s72, 0x7ff
    buffer_load_dwordx4 v20, s[36:39], s78 offen lds
    v_add_f32 v72, v72, v49
    v_add_f32 v74, v74, v65
    v_add_f32 v72, v72, v50
    v_add_f32 v74, v74, v66
    v_add_f32 v72, v72, v51
    v_add_f32 v74, v74, v67
    v_add_f32 v72, v72, v52
    v_add_f32 v74, v74, v68
    s_add_u32 m0, s79, 99328
    s_nop 0
    buffer_load_dwordx4 v21, s[36:39], s78 offen lds
    v_add_f32 v72, v72, v53
    v_add_f32 v74, v74, v69
    v_add_f32 v72, v72, v54
    v_add_f32 v74, v74, v70
    v_add_f32 v72, v72, v55
    v_add_f32 v74, v74, v71
    s_nop 0
    v_add_f32_dpp v72, v72, v72 quad_perm:[1,0,3,2] row_mask:0xf bank_mask:0xf
    v_add_f32_dpp v74, v74, v74 quad_perm:[1,0,3,2] row_mask:0xf bank_mask:0xf
    s_add_u32 m0, s33, 36864
    s_add_u32 s77, s77, 229376
    buffer_load_dwordx4 v22, s[40:43], s77 offen offset:0 lds
    s_nop 0
    v_add_f32_dpp v72, v72, v72 quad_perm:[2,3,0,1] row_mask:0xf bank_mask:0xf
    v_add_f32_dpp v74, v74, v74 quad_perm:[2,3,0,1] row_mask:0xf bank_mask:0xf
    s_nop 0
    v_add_f32_dpp v72, v72, v72 row_half_mirror row_mask:0xf bank_mask:0xf
    v_add_f32_dpp v74, v74, v74 row_half_mirror row_mask:0xf bank_mask:0xf
    s_nop 0
    v_add_f32_dpp v72, v72, v72 row_mirror row_mask:0xf bank_mask:0xf
    v_add_f32_dpp v74, v74, v74 row_mirror row_mask:0xf bank_mask:0xf
    v_mov_b32 v78, v72
    s_add_u32 m0, s33, 40832
    s_nop 0
    buffer_load_dwordx4 v22, s[40:43], s77 offen offset:128 lds
    v_mov_b32 v79, v74
    s_nop 0
    v_permlane16_swap_b32 v72, v78
    v_permlane16_swap_b32 v74, v79
    v_add_f32 v72, v72, v78
    v_add_f32 v74, v74, v79
    v_mov_b32 v78, v72
    v_mov_b32 v79, v74
    s_nop 0
    v_permlane32_swap_b32 v72, v78
    s_add_u32 m0, s33, 45056
    s_nop 0
    buffer_load_dwordx4 v22, s[44:47], s77 offen offset:0 lds
    s_add_u32 m0, s33, 49024
    s_nop 0
    buffer_load_dwordx4 v22, s[44:47], s77 offen offset:128 lds
    v_permlane32_swap_b32 v74, v79
    v_add_f32 v72, v72, v78
    v_add_f32 v74, v74, v79
    v_mul_f32 v72, 0x3a800000, v72
    v_mul_f32 v74, 0x3a800000, v74
    v_sub_f32 v78, v40, v72
    v_sub_f32 v79, v56, v74
    v_mul_f32 v73, v78, v78
    s_add_u32 m0, s33, 53248
    s_nop 0
    buffer_load_dwordx4 v9, s[48:51], s77 offen lds
    v_mul_f32 v75, v79, v79
    v_sub_f32 v78, v41, v72
    v_sub_f32 v79, v57, v74
    v_fmac_f32 v73, v78, v78
    v_fmac_f32 v75, v79, v79
    v_sub_f32 v78, v42, v72
    v_sub_f32 v79, v58, v74
    v_fmac_f32 v73, v78, v78
    s_load_dword s94, s[88:89], s76 offset:8192
    s_load_dword s94, s[88:89], s76 offset:8256
    s_load_dword s94, s[88:89], s76 offset:10240
    s_load_dword s94, s[88:89], s76 offset:10304
    s_waitcnt vmcnt(15)
    s_barrier
    s_add_u32 m0, s79, 100352
    s_add_u32 s78, s78, 32768
    buffer_load_dwordx4 v20, s[36:39], s78 offen lds
    v_fmac_f32 v75, v79, v79
    v_sub_f32 v78, v43, v72
    v_sub_f32 v79, v59, v74
    v_fmac_f32 v73, v78, v78
    v_fmac_f32 v75, v79, v79
    v_sub_f32 v78, v44, v72
    v_sub_f32 v79, v60, v74
    v_fmac_f32 v73, v78, v78
    s_add_u32 m0, s79, 101376
    s_nop 0
    buffer_load_dwordx4 v21, s[36:39], s78 offen lds
    v_fmac_f32 v75, v79, v79
    v_sub_f32 v78, v45, v72
    v_sub_f32 v79, v61, v74
    v_fmac_f32 v73, v78, v78
    v_fmac_f32 v75, v79, v79
    v_sub_f32 v78, v46, v72
    v_sub_f32 v79, v62, v74
    v_fmac_f32 v73, v78, v78
    s_add_u32 m0, s33, 57344
    s_add_u32 s77, s77, 229376
    s_cmp_eq_u32 s77, 7340032
    s_cselect_b32 s77, 0, s77
    buffer_load_dwordx4 v22, s[40:43], s77 offen offset:0 lds
    v_fmac_f32 v75, v79, v79
    v_sub_f32 v78, v47, v72
    v_sub_f32 v79, v63, v74
    v_fmac_f32 v73, v78, v78
    v_fmac_f32 v75, v79, v79
    v_sub_f32 v78, v48, v72
    v_sub_f32 v79, v64, v74
    v_fmac_f32 v73, v78, v78
    s_add_u32 m0, s33, 61312
    s_nop 0
    buffer_load_dwordx4 v22, s[40:43], s77 offen offset:128 lds
    v_fmac_f32 v75, v79, v79
    v_sub_f32 v78, v49, v72
    v_sub_f32 v79, v65, v74
    v_fmac_f32 v73, v78, v78
    v_fmac_f32 v75, v79, v79
    v_sub_f32 v78, v50, v72
    v_sub_f32 v79, v66, v74
    v_fmac_f32 v73, v78, v78
    s_add_u32 m0, s33, 65536
    s_nop 0
    buffer_load_dwordx4 v22, s[44:47], s77 offen offset:0 lds
    v_fmac_f32 v75, v79, v79
    v_sub_f32 v78, v51, v72
    v_sub_f32 v79, v67, v74
    v_fmac_f32 v73, v78, v78
    v_fmac_f32 v75, v79, v79
    v_sub_f32 v78, v52, v72
    v_sub_f32 v79, v68, v74
    v_fmac_f32 v73, v78, v78
    s_add_u32 m0, s33, 69504
    s_nop 0
    buffer_load_dwordx4 v22, s[44:47], s77 offen offset:128 lds
    s_add_u32 m0, s33, 73728
    s_nop 0
    buffer_load_dwordx4 v9, s[48:51], s77 offen lds
    v_fmac_f32 v75, v79, v79
    v_sub_f32 v78, v53, v72
    v_sub_f32 v79, v69, v74
    v_fmac_f32 v73, v78, v78
    v_fmac_f32 v75, v79, v79
    v_sub_f32 v78, v54, v72
    v_sub_f32 v79, v70, v74
    v_fmac_f32 v73, v78, v78
    s_load_dword s94, s[88:89], s76 offset:12288
    s_load_dword s94, s[88:89], s76 offset:12352
    s_load_dword s94, s[88:89], s76 offset:14336
    s_load_dword s94, s[88:89], s76 offset:14400
    s_waitcnt vmcnt(14)
    s_barrier
    s_add_u32 m0, s79, 116736
    s_add_u32 s72, s72, 128
    s_and_b32 s78, s72, 0x7ff
    buffer_load_dwordx4 v20, s[36:39], s78 offen lds
    v_fmac_f32 v75, v79, v79
    v_sub_f32 v78, v55, v72
    v_sub_f32 v79, v71, v74
    v_fmac_f32 v73, v78, v78
    v_fmac_f32 v75, v79, v79
    s_nop 0
    v_add_f32_dpp v73, v73, v73 quad_perm:[1,0,3,2] row_mask:0xf bank_mask:0xf
    v_add_f32_dpp v75, v75, v75 quad_perm:[1,0,3,2] row_mask:0xf bank_mask:0xf
    s_nop 0
    v_add_f32_dpp v73, v73, v73 quad_perm:[2,3,0,1] row_mask:0xf bank_mask:0xf
    s_add_u32 m0, s79, 117760
    s_nop 0
    buffer_load_dwordx4 v21, s[36:39], s78 offen lds
    v_add_f32_dpp v75, v75, v75 quad_perm:[2,3,0,1] row_mask:0xf bank_mask:0xf
    s_nop 0
    v_add_f32_dpp v73, v73, v73 row_half_mirror row_mask:0xf bank_mask:0xf
    v_add_f32_dpp v75, v75, v75 row_half_mirror row_mask:0xf bank_mask:0xf
    s_nop 0
    v_add_f32_dpp v73, v73, v73 row_mirror row_mask:0xf bank_mask:0xf
    v_add_f32_dpp v75, v75, v75 row_mirror row_mask:0xf bank_mask:0xf
    v_mov_b32 v78, v73
    v_mov_b32 v79, v75
    s_add_u32 m0, s33, 77824
    s_add_u32 s77, s77, 229376
    buffer_load_dwordx4 v22, s[40:43], s77 offen offset:0 lds
    s_nop 0
    v_permlane16_swap_b32 v73, v78
    v_permlane16_swap_b32 v75, v79
L_pad6:
    s_cbranch_execz L_vret0
    v_add_f32 v73, v73, v78
    v_add_f32 v75, v75, v79
    v_mov_b32 v78, v73
    v_mov_b32 v79, v75
    s_nop 0
    v_permlane32_swap_b32 v73, v78
    s_add_u32 m0, s33, 81792
    s_nop 0
    buffer_load_dwordx4 v22, s[40:43], s77 offen offset:128 lds
    v_permlane32_swap_b32 v75, v79
    v_add_f32 v73, v73, v78
    v_add_f32 v75, v75, v79
    v_mul_f32 v73, 0x3a800000, v73
    v_mul_f32 v75, 0x3a800000, v75
    v_cvt_pk_bf16_f32 v72, v72, v72
    v_lshlrev_b32 v72, 16, v72
    v_cvt_pk_bf16_f32 v73, v73, v73
    s_add_u32 m0, s33, 86016
    s_nop 0
    buffer_load_dwordx4 v22, s[44:47], s77 offen offset:0 lds
    s_add_u32 m0, s33, 89984
    s_nop 0
    buffer_load_dwordx4 v22, s[44:47], s77 offen offset:128 lds
    v_lshlrev_b32 v73, 16, v73
    v_add_f32 v73, 0x3727c5ac, v73
    v_cvt_pk_bf16_f32 v73, v73, v73
    v_lshlrev_b32 v73, 16, v73
    v_sqrt_f32 v73, v73
    v_cvt_pk_bf16_f32 v74, v74, v74
    v_lshlrev_b32 v74, 16, v74
    s_add_u32 m0, s33, 94208
    s_nop 0
    buffer_load_dwordx4 v9, s[48:51], s77 offen lds
    v_cvt_pk_bf16_f32 v75, v75, v75
    v_lshlrev_b32 v75, 16, v75
    v_add_f32 v75, 0x3727c5ac, v75
    v_cvt_pk_bf16_f32 v75, v75, v75
    v_lshlrev_b32 v75, 16, v75
    v_sqrt_f32 v75, v75
    s_nop 0
    v_cvt_pk_bf16_f32 v73, v73, v73
    s_load_dword s94, s[88:89], s76 offset:16384
    s_load_dword s94, s[88:89], s76 offset:16448
    s_load_dword s94, s[88:89], s76 offset:18432
    s_load_dword s94, s[88:89], s76 offset:18496
    s_waitcnt vmcnt(14)
    s_barrier
    s_add_u32 m0, s79, 118784
    s_add_u32 s78, s78, 32768
    buffer_load_dwordx4 v20, s[36:39], s78 offen lds
    v_lshlrev_b32 v73, 16, v73
    v_rcp_f32 v76, v73
    s_nop 0
    v_cvt_pk_bf16_f32 v75, v75, v75
    v_lshlrev_b32 v75, 16, v75
    v_rcp_f32 v77, v75
    s_nop 0
    v_fma_f32 v78, -v73, v76, 1.0
    s_add_u32 m0, s79, 119808
    s_nop 0
    buffer_load_dwordx4 v21, s[36:39], s78 offen lds
    v_fma_f32 v76, v78, v76, v76
    s_nop 0
    v_fma_f32 v79, -v75, v77, 1.0
    v_fma_f32 v77, v79, v77, v77
    v_sub_f32 v80, v40, v72
    v_sub_f32 v81, v41, v72
    v_cvt_pk_bf16_f32 v80, v80, v81
    v_and_b32 v81, 0xffff0000, v80
    v_lshlrev_b32 v80, 16, v80
    s_add_u32 m0, s33, 16384
    s_add_u32 s77, s77, 229376
    s_cmp_eq_u32 s77, 7340032
    s_cselect_b32 s77, 0, s77
    buffer_load_dwordx4 v22, s[40:43], s77 offen offset:0 lds
    v_mul_f32 v80, v80, v76
    v_mul_f32 v81, v81, v76
    v_cvt_pk_bf16_f32 v24, v80, v81
    v_sub_f32 v80, v42, v72
    v_sub_f32 v81, v43, v72
    v_cvt_pk_bf16_f32 v80, v80, v81
    v_and_b32 v81, 0xffff0000, v80
    v_lshlrev_b32 v80, 16, v80
    s_add_u32 m0, s33, 20352
    s_nop 0
    buffer_load_dwordx4 v22, s[40:43], s77 offen offset:128 lds
    v_mul_f32 v80, v80, v76
    v_mul_f32 v81, v81, v76
    v_cvt_pk_bf16_f32 v25, v80, v81
    v_sub_f32 v80, v44, v72
    v_sub_f32 v81, v45, v72
    v_cvt_pk_bf16_f32 v80, v80, v81
    v_and_b32 v81, 0xffff0000, v80
    v_lshlrev_b32 v80, 16, v80
    s_add_u32 m0, s33, 24576
    s_nop 0
    buffer_load_dwordx4 v22, s[44:47], s77 offen offset:0 lds
    s_add_u32 m0, s33, 28544
    s_nop 0
    buffer_load_dwordx4 v22, s[44:47], s77 offen offset:128 lds
    v_mul_f32 v80, v80, v76
    v_mul_f32 v81, v81, v76
    v_cvt_pk_bf16_f32 v26, v80, v81
    v_sub_f32 v80, v46, v72
    v_sub_f32 v81, v47, v72
    v_cvt_pk_bf16_f32 v80, v80, v81
    v_and_b32 v81, 0xffff0000, v80
    v_lshlrev_b32 v80, 16, v80
    s_add_u32 m0, s33, 32768
    s_nop 0
    buffer_load_dwordx4 v9, s[48:51], s77 offen lds
    v_mul_f32 v80, v80, v76
    v_mul_f32 v81, v81, v76
    v_cvt_pk_bf16_f32 v27, v80, v81
    v_sub_f32 v80, v48, v72
    v_sub_f32 v81, v49, v72
    v_cvt_pk_bf16_f32 v80, v80, v81
    v_and_b32 v81, 0xffff0000, v80
    v_lshlrev_b32 v80, 16, v80
    s_load_dword s94, s[88:89], s76 offset:20480
    s_load_dword s94, s[88:89], s76 offset:20544
    s_load_dword s94, s[88:89], s76 offset:22528
    s_load_dword s94, s[88:89], s76 offset:22592
    s_waitcnt vmcnt(14)
    s_barrier
    s_add_u32 m0, s79, 135168
    s_add_u32 s72, s72, 128
    s_and_b32 s78, s72, 0x7ff
    buffer_load_dwordx4 v20, s[36:39], s78 offen lds
    v_mul_f32 v80, v80, v76
    v_mul_f32 v81, v81, v76
    v_cvt_pk_bf16_f32 v28, v80, v81
    v_sub_f32 v80, v50, v72
    v_sub_f32 v81, v51, v72
    v_cvt_pk_bf16_f32 v80, v80, v81
    v_and_b32 v81, 0xffff0000, v80
    v_lshlrev_b32 v80, 16, v80
    s_add_u32 m0, s79, 136192
    s_nop 0
    buffer_load_dwordx4 v21, s[36:39], s78 offen lds
    v_mul_f32 v80, v80, v76
    v_mul_f32 v81, v81, v76
    v_cvt_pk_bf16_f32 v29, v80, v81
    v_sub_f32 v80, v52, v72
    v_sub_f32 v81, v53, v72
    v_cvt_pk_bf16_f32 v80, v80, v81
    v_and_b32 v81, 0xffff0000, v80
    v_lshlrev_b32 v80, 16, v80
    s_add_u32 m0, s33, 36864
    s_add_u32 s77, s77, 229376
    buffer_load_dwordx4 v22, s[40:43], s77 offen offset:0 lds
    v_mul_f32 v80, v80, v76
    v_mul_f32 v81, v81, v76
    v_cvt_pk_bf16_f32 v30, v80, v81
    v_sub_f32 v80, v54, v72
    v_sub_f32 v81, v55, v72
    v_cvt_pk_bf16_f32 v80, v80, v81
    v_and_b32 v81, 0xffff0000, v80
    v_lshlrev_b32 v80, 16, v80
    s_add_u32 m0, s33, 40832
    s_nop 0
    buffer_load_dwordx4 v22, s[40:43], s77 offen offset:128 lds
    v_mul_f32 v80, v80, v76
    v_mul_f32 v81, v81, v76
    v_cvt_pk_bf16_f32 v31, v80, v81
    v_sub_f32 v80, v56, v74
    v_sub_f32 v81, v57, v74
    v_cvt_pk_bf16_f32 v80, v80, v81
    v_and_b32 v81, 0xffff0000, v80
    v_lshlrev_b32 v80, 16, v80
    s_add_u32 m0, s33, 45056
    s_nop 0
    buffer_load_dwordx4 v22, s[44:47], s77 offen offset:0 lds
    v_mul_f32 v80, v80, v77
    v_mul_f32 v81, v81, v77
    v_cvt_pk_bf16_f32 v32, v80, v81
    v_sub_f32 v80, v58, v74
    v_sub_f32 v81, v59, v74
    v_cvt_pk_bf16_f32 v80, v80, v81
    v_and_b32 v81, 0xffff0000, v80
    v_lshlrev_b32 v80, 16, v80
    s_add_u32 m0, s33, 49024
    s_nop 0
    buffer_load_dwordx4 v22, s[44:47], s77 offen offset:128 lds
    s_add_u32 m0, s33, 53248
    s_nop 0
    buffer_load_dwordx4 v9, s[48:51], s77 offen lds
    v_mul_f32 v80, v80, v77
    v_mul_f32 v81, v81, v77
    v_cvt_pk_bf16_f32 v33, v80, v81
    v_sub_f32 v80, v60, v74
    v_sub_f32 v81, v61, v74
    v_cvt_pk_bf16_f32 v80, v80, v81
    v_and_b32 v81, 0xffff0000, v80
    v_lshlrev_b32 v80, 16, v80
    s_load_dword s94, s[88:89], s76 offset:24576
    s_load_dword s94, s[88:89], s76 offset:24640
    s_load_dword s94, s[88:89], s76 offset:26624
    s_load_dword s94, s[88:89], s76 offset:26688
    s_waitcnt vmcnt(14)
    s_barrier
    s_add_u32 m0, s79, 137216
    s_add_u32 s78, s78, 32768
    buffer_load_dwordx4 v20, s[36:39], s78 offen lds
    v_mul_f32 v80, v80, v77
    v_mul_f32 v81, v81, v77
    v_cvt_pk_bf16_f32 v34, v80, v81
    v_sub_f32 v80, v62, v74
    v_sub_f32 v81, v63, v74
    v_cvt_pk_bf16_f32 v80, v80, v81
    v_and_b32 v81, 0xffff0000, v80
    v_lshlrev_b32 v80, 16, v80
    s_add_u32 m0, s79, 138240
    s_nop 0
    buffer_load_dwordx4 v21, s[36:39], s78 offen lds
    v_mul_f32 v80, v80, v77
    v_mul_f32 v81, v81, v77
    v_cvt_pk_bf16_f32 v35, v80, v81
    v_sub_f32 v80, v64, v74
    v_sub_f32 v81, v65, v74
    v_cvt_pk_bf16_f32 v80, v80, v81
    v_and_b32 v81, 0xffff0000, v80
    v_lshlrev_b32 v80, 16, v80
    s_add_u32 m0, s33, 57344
    s_add_u32 s77, s77, 229376
    s_cmp_eq_u32 s77, 7340032
    s_cselect_b32 s77, 0, s77
    buffer_load_dwordx4 v22, s[40:43], s77 offen offset:0 lds
    v_mul_f32 v80, v80, v77
    v_mul_f32 v81, v81, v77
    v_cvt_pk_bf16_f32 v36, v80, v81
    v_sub_f32 v80, v66, v74
    v_sub_f32 v81, v67, v74
    v_cvt_pk_bf16_f32 v80, v80, v81
    v_and_b32 v81, 0xffff0000, v80
    v_lshlrev_b32 v80, 16, v80
    s_add_u32 m0, s33, 61312
    s_nop 0
    buffer_load_dwordx4 v22, s[40:43], s77 offen offset:128 lds
    v_mul_f32 v80, v80, v77
    v_mul_f32 v81, v81, v77
    v_cvt_pk_bf16_f32 v37, v80, v81
    v_sub_f32 v80, v68, v74
    v_sub_f32 v81, v69, v74
    v_cvt_pk_bf16_f32 v80, v80, v81
    v_and_b32 v81, 0xffff0000, v80
    v_lshlrev_b32 v80, 16, v80
    s_add_u32 m0, s33, 65536
    s_nop 0
    buffer_load_dwordx4 v22, s[44:47], s77 offen offset:0 lds
    v_mul_f32 v80, v80, v77
    v_mul_f32 v81, v81, v77
    v_cvt_pk_bf16_f32 v38, v80, v81
    v_sub_f32 v80, v70, v74
    v_sub_f32 v81, v71, v74
    v_cvt_pk_bf16_f32 v80, v80, v81
    v_and_b32 v81, 0xffff0000, v80
    v_lshlrev_b32 v80, 16, v80
    s_add_u32 m0, s33, 69504
    s_nop 0
    buffer_load_dwordx4 v22, s[44:47], s77 offen offset:128 lds
    s_add_u32 m0, s33, 73728
    s_nop 0
    buffer_load_dwordx4 v9, s[48:51], s77 offen lds
    v_mul_f32 v80, v80, v77
    v_mul_f32 v81, v81, v77
    v_cvt_pk_bf16_f32 v39, v80, v81
    s_add_u32 s90, s90, 0x1e00000
    v_mov_b32 v7, s90
    s_mov_b64 exec, 1
    global_store_dwordx4 v7, v[72:75], s[26:27] sc1
    s_mov_b64 exec, -1
    v_lshrrev_b32 v64, 4, v1
    v_bfe_u32 v65, v1, 2, 2
    v_and_b32 v66, 3, v1
    v_and_b32 v67, 15, v1
    v_lshrrev_b32 v68, 3, v1
    v_and_b32 v69, 7, v1
    s_lshl_b32 s85, s6, 2
    s_lshl_b32 s86, s5, 1
    s_or_b32 s85, s85, s86
    v_lshl_add_u32 v70, v64, 3, v65
    v_lshlrev_b32 v70, 7, v70
    global_store_dwordx4 v86, v[24:27], s[26:27] offset:0 sc1
    s_load_dword s94, s[88:89], s76 offset:28672
    s_load_dword s94, s[88:89], s76 offset:28736
    s_load_dword s94, s[88:89], s76 offset:30720
    s_load_dword s94, s[88:89], s76 offset:30784
    s_waitcnt vmcnt(16)
    s_barrier
    s_add_u32 m0, s79, 98304
    s_add_u32 s72, s72, 128
    s_and_b32 s78, s72, 0x7ff
    buffer_load_dwordx4 v20, s[36:39], s78 offen lds
    v_and_b32 v71, 1, v66
    v_lshl_add_u32 v70, v71, 3, v70
    v_add_u32 v70, 16384, v70
    v_and_b32 v71, 2, v65
    v_and_b32 v72, 1, v64
    v_lshl_add_u32 v71, v72, 2, v71
    v_lshrrev_b32 v72, 1, v66
    v_xor_b32 v71, v71, v72
    s_add_u32 m0, s79, 99328
    s_nop 0
    buffer_load_dwordx4 v21, s[36:39], s78 offen lds
    v_xor_b32 v71, s85, v71
    v_xor_b32 v72, 0, v71
    v_lshl_add_u32 v4, v72, 4, v70
    v_add_u32 v6, 40960, v4
    v_xor_b32 v72, 2, v71
    v_lshl_add_u32 v5, v72, 4, v70
    v_add_u32 v7, 40960, v5
    v_lshrrev_b32 v70, 1, v67
    s_add_u32 m0, s33, 77824
    s_add_u32 s77, s77, 229376
    buffer_load_dwordx4 v22, s[40:43], s77 offen offset:0 lds
    v_xor_b32 v70, v70, v64
    v_lshlrev_b32 v70, 4, v70
    v_lshl_add_u32 v70, v67, 7, v70
    s_lshl_b32 s85, s5, 13
    v_add_u32 v16, s85, v70
    v_xor_b32 v17, 64, v16
    s_sub_u32 s95, 16384, s85
    s_mov_b32 s80, 135168
    s_lshl_b32 s86, s28, 7
    s_sub_u32 s86, s86, 16
    s_max_i32 s86, s86, 0
    s_lshl_b32 s87, s4, 2
    v_add_u32 v71, s87, v68
    s_add_u32 m0, s33, 81792
    s_nop 0
    buffer_load_dwordx4 v22, s[40:43], s77 offen offset:128 lds
    v_lshrrev_b32 v70, 1, v71
    v_and_b32 v70, 7, v70
    v_xor_b32 v70, v70, v69
    v_lshlrev_b32 v70, 4, v70
    v_add_u32 v71, s86, v71
    v_lshl_add_u32 v3, v71, 11, v70
    s_lshl_b32 s81, s4, 9
    s_lshl_b32 s85, s4, 3
    s_and_b32 s86, s4, 1
    s_lshl_b32 s86, s86, 2
    v_and_b32 v70, 2, v68
    s_add_u32 m0, s33, 86016
    s_nop 0
    buffer_load_dwordx4 v22, s[44:47], s77 offen offset:0 lds
    v_xor_b32 v70, v70, v69
    v_xor_b32 v70, s86, v70
    v_add_u32 v71, s85, v68
    v_mul_u32_u24 v71, 6144, v71
    v_lshl_add_u32 v23, v70, 4, v71
    s_lshl_b32 s85, s4, 12
    v_lshl_add_u32 v10, v1, 4, s85
    s_lshl_b32 s85, s4, 4
    v_and_b32 v70, 2, v68
    v_xor_b32 v70, v70, v69
    s_add_u32 m0, s33, 89984
    s_nop 0
    buffer_load_dwordx4 v22, s[44:47], s77 offen offset:128 lds
    s_add_u32 m0, s33, 94208
    s_nop 0
    buffer_load_dwordx4 v9, s[48:51], s77 offen lds
    v_xor_b32 v70, 0, v70
    v_add_u32 v71, s85, v68
    v_mul_u32_u24 v71, 2048, v71
    v_lshl_add_u32 v11, v70, 4, v71
    s_add_u32 s85, s85, 8
    v_and_b32 v70, 2, v68
    v_xor_b32 v70, v70, v69
    v_xor_b32 v70, 4, v70
    v_add_u32 v71, s85, v68
    s_load_dword s94, s[10:11], s52 offset:0x0
    s_load_dword s94, s[10:11], s52 offset:0x40
    s_load_dword s94, s[10:11], s52 offset:0x80
    s_load_dword s94, s[10:11], s52 offset:0xc0
    s_load_dword s94, s[10:11], s52 offset:0x100
    global_store_dwordx4 v86, v[28:31], s[26:27] offset:1024 sc1
    v_mov_b32 v87, 0
    s_mov_b64 exec, 1
    global_load_dwordx2 v[18:19], v87, s[24:25] sc1
    s_mov_b64 exec, -1
    s_waitcnt vmcnt(18)
    s_barrier
    s_add_u32 m0, s79, 100352
    s_add_u32 s78, s78, 32768
    buffer_load_dwordx4 v20, s[36:39], s78 offen lds
    v_mul_u32_u24 v71, 2048, v71
    v_lshl_add_u32 v12, v70, 4, v71
    s_lshl_b32 s85, s31, 8
    s_lshl_b32 s86, s32, 7
    s_add_u32 s86, s85, s86
    s_xor_b32 s87, s86, 128
    s_lshr_b32 s91, s31, 2
    s_lshl1_add_u32 s91, s91, s32
    s_lshl_b32 s91, s91, 13
    s_add_u32 s91, s91, 0x2000000
    s_xor_b32 s85, s91, 8192
    s_and_b32 s92, s31, 3
    s_cmp_eq_u32 s92, 1
    s_cselect_b32 s86, s91, s86
    s_cselect_b32 s87, s85, s87
    s_cselect_b32 s91, 0x2a00000, 0
    s_cselect_b32 s92, s26, s20
    s_cselect_b32 s93, s27, s21
    s_max_u32 s91, s91, 7340032
    s_add_u32 s60, s92, s86
    s_addc_u32 s61, s93, 0
    s_sub_u32 s62, s91, s86
    s_mov_b32 s63, 0x20000
    s_add_u32 m0, s79, 101376
    s_nop 0
    buffer_load_dwordx4 v21, s[36:39], s78 offen lds
    s_add_u32 s64, s92, s87
    s_addc_u32 s65, s93, 0
    s_sub_u32 s66, s91, s87
    s_mov_b32 s67, 0x20000
    s_add_u32 s56, s26, 0x400000
    s_addc_u32 s57, s27, 0
    s_mov_b32 s58, 0xe00000
    s_mov_b32 s59, 0x20000
    s_mul_i32 s82, s30, 917504
    s_mul_i32 s85, s32, 327680
    s_add_u32 s82, s82, s85
    s_mul_i32 s83, s32, 2621440
    s_mul_i32 s85, s32, 10
    s_sub_u32 s85, 40, s85
    s_lshl_b32 s14, s85, 13
    s_lshl_b32 s35, s85, 16
    s_add_u32 s83, s83, 1441792
    s_add_u32 s82, s82, 196608
    s_lshl_b32 s84, s30, 7
    s_lshl_b32 s85, s5, 6
    s_add_u32 s84, s84, s85
    s_lshl_b32 s84, s84, 11
    s_lshl_b32 s85, s31, 8
    s_add_u32 s84, s84, s85
    s_lshl_b32 s85, s32, 7
    s_add_u32 s84, s84, s85
    s_lshl_b32 s85, s6, 6
    s_add_u32 m0, s33, 16384
    s_add_u32 s77, s77, 229376
    s_cmp_eq_u32 s77, 7340032
    s_cselect_b32 s77, 0, s77
    buffer_load_dwordx4 v22, s[40:43], s77 offen offset:0 lds
    s_add_u32 s84, s84, s85
    v_lshrrev_b32 v70, 2, v1
    v_lshl_add_u32 v71, v66, 4, s84
    v_lshl_add_u32 v13, v70, 11, v71
    v_lshrrev_b32 v72, 4, v1
    v_and_b32 v73, 15, v1
    v_and_b32 v74, 1, v72
    v_xor_b32 v74, s5, v74
    v_lshrrev_b32 v75, 1, v72
    s_add_u32 m0, s33, 20352
    s_nop 0
    buffer_load_dwordx4 v22, s[40:43], s77 offen offset:128 lds
    v_lshl_add_u32 v74, v74, 1, v75
    v_lshlrev_b32 v74, 8, v74
    v_lshl_add_u32 v0, v73, 4, v74
    v_lshrrev_b32 v72, 4, v1
    v_and_b32 v73, 1, v72
    v_lshrrev_b32 v72, 1, v72
    v_lshlrev_b32 v72, 8, v72
    v_lshl_add_u32 v72, v73, 10, v72
    s_add_u32 m0, s33, 24576
    s_nop 0
    buffer_load_dwordx4 v22, s[44:47], s77 offen offset:0 lds
    v_and_b32 v73, 15, v1
    v_lshl_add_u32 v8, v73, 4, v72
    s_mov_b32 s54, 7332992
    s_mov_b32 s55, 0x20000
    s_mul_i32 s84, s6, 3072
    s_add_u32 s84, s84, 153600
    v_lshl_add_u32 v85, v1, 3, s84
    s_mul_i32 s84, s28, 112
    s_lshl1_add_u32 s85, s29, s6
    s_add_u32 s86, s85, 2
    s_and_b32 s86, s86, 31
    s_add_u32 s84, s84, s86
    s_add_u32 s84, s84, 80
    s_lshl_b32 s84, s84, 13
    s_lshl_b32 s86, s5, 12
    s_add_u32 s84, s84, s86
    s_add_u32 s84, s84, 0x400000
    s_lshl_b32 s87, s5, 9
    s_add_u32 s73, s84, s87
    s_xor_b32 s87, s87, 512
    s_add_u32 m0, s33, 28544
    s_nop 0
    buffer_load_dwordx4 v22, s[44:47], s77 offen offset:128 lds
    s_add_u32 m0, s33, 32768
    s_nop 0
    buffer_load_dwordx4 v9, s[48:51], s77 offen lds
    s_add_u32 s74, s84, s87
    s_lshl_b32 s84, s28, 5
    s_add_u32 s84, s84, s85
    s_lshl_b32 s84, s84, 13
    s_add_u32 s84, s84, s86
    s_add_u32 s75, s84, 0x1200000
    v_mov_b32 v84, 0xc0135761
    v_mov_b32 v152, 0
    v_mov_b32 v153, 0
    v_mov_b32 v154, 0
    v_mov_b32 v155, 0
    v_mov_b32 v156, 0
    v_mov_b32 v157, 0
    s_load_dword s94, s[10:11], s52 offset:0x140
    s_load_dword s94, s[10:11], s52 offset:0x180
    s_load_dword s94, s[10:11], s52 offset:0x1c0
    s_load_dword s94, s[16:17], s53 offset:0x0
    s_load_dword s94, s[16:17], s53 offset:0x40
    global_store_dwordx4 v86, v[32:35], s[26:27] offset:2048 sc1
    s_waitcnt vmcnt(19)
    s_barrier
    s_add_u32 m0, s79, 116736
    s_add_u32 s72, s72, 128
    s_and_b32 s78, s72, 0x7ff
    buffer_load_dwordx4 v20, s[36:39], s78 offen lds
    v_mov_b32 v158, 0
    v_mov_b32 v159, 0
    v_mov_b32 v160, 0
    v_mov_b32 v161, 0
    v_mov_b32 v162, 0
    v_mov_b32 v163, 0
    v_mov_b32 v164, 0
    v_mov_b32 v165, 0
    s_add_u32 m0, s79, 117760
    s_nop 0
    buffer_load_dwordx4 v21, s[36:39], s78 offen lds
    v_mov_b32 v166, 0
    v_mov_b32 v167, 0
    v_mov_b32 v168, 0
    v_mov_b32 v169, 0
    v_mov_b32 v170, 0
    v_mov_b32 v171, 0
    v_mov_b32 v172, 0
    v_mov_b32 v173, 0
    s_add_u32 m0, s33, 36864
    s_add_u32 s77, s77, 229376
    buffer_load_dwordx4 v22, s[40:43], s77 offen offset:0 lds
    v_mov_b32 v174, 0
    v_mov_b32 v175, 0
    v_mov_b32 v176, 0
    v_mov_b32 v177, 0
    v_mov_b32 v178, 0
    v_mov_b32 v179, 0
    v_mov_b32 v180, 0
    v_mov_b32 v181, 0
    s_add_u32 m0, s33, 40832
    s_nop 0
    buffer_load_dwordx4 v22, s[40:43], s77 offen offset:128 lds
    v_mov_b32 v182, 0
    v_mov_b32 v183, 0
    v_mov_b32 v184, 0
    v_mov_b32 v185, 0
    v_mov_b32 v186, 0
    v_mov_b32 v187, 0
    v_mov_b32 v188, 0
    v_mov_b32 v189, 0
    s_add_u32 m0, s33, 45056
    s_nop 0
    buffer_load_dwordx4 v22, s[44:47], s77 offen offset:0 lds
    v_mov_b32 v190, 0
    v_mov_b32 v191, 0
    v_mov_b32 v192, 0
    v_mov_b32 v193, 0
    v_mov_b32 v194, 0
    v_mov_b32 v195, 0
    v_mov_b32 v196, 0
    v_mov_b32 v197, 0
    s_add_u32 m0, s33, 49024
    s_nop 0
    buffer_load_dwordx4 v22, s[44:47], s77 offen offset:128 lds
    s_add_u32 m0, s33, 53248
    s_nop 0
    buffer_load_dwordx4 v9, s[48:51], s77 offen lds
    v_mov_b32 v198, 0
    v_mov_b32 v199, 0
    v_mov_b32 v200, 0
    v_mov_b32 v201, 0
    v_mov_b32 v202, 0
    v_mov_b32 v203, 0
    v_mov_b32 v204, 0
    v_mov_b32 v205, 0
    s_load_dword s94, s[16:17], s53 offset:0x80
    s_load_dword s94, s[16:17], s53 offset:0xc0
    s_load_dword s94, s[16:17], s53 offset:0x100
    s_load_dword s94, s[16:17], s53 offset:0x140
    s_load_dword s94, s[16:17], s53 offset:0x180
    global_store_dwordx4 v86, v[36:39], s[26:27] offset:3072 sc1
    s_waitcnt vmcnt(18)
    s_barrier
    s_add_u32 m0, s79, 118784
    s_add_u32 s78, s78, 32768
    buffer_load_dwordx4 v20, s[36:39], s78 offen lds
    v_mov_b32 v206, 0
    v_mov_b32 v207, 0
    v_mov_b32 v208, 0
    v_mov_b32 v209, 0
    v_mov_b32 v210, 0
    v_mov_b32 v211, 0
    v_mov_b32 v212, 0
    v_mov_b32 v213, 0
    s_add_u32 m0, s79, 119808
    s_nop 0
    buffer_load_dwordx4 v21, s[36:39], s78 offen lds
    v_mov_b32 v214, 0
    v_mov_b32 v215, 0
    v_mov_b32 v216, 0
    v_mov_b32 v217, 0
    v_mov_b32 v218, 0
    v_mov_b32 v219, 0
    v_mov_b32 v220, 0
    v_mov_b32 v221, 0
    s_add_u32 m0, s33, 57344
    s_add_u32 s77, s77, 229376
    s_cmp_eq_u32 s77, 7340032
    s_cselect_b32 s77, 0, s77
    buffer_load_dwordx4 v22, s[40:43], s77 offen offset:0 lds
    v_mov_b32 v222, 0
    v_mov_b32 v223, 0
    v_mov_b32 v224, 0
    v_mov_b32 v225, 0
    v_mov_b32 v226, 0
    v_mov_b32 v227, 0
    v_mov_b32 v228, 0
    v_mov_b32 v229, 0
    s_add_u32 m0, s33, 61312
    s_nop 0
    buffer_load_dwordx4 v22, s[40:43], s77 offen offset:128 lds
    v_mov_b32 v230, 0
    v_mov_b32 v231, 0
    v_mov_b32 v232, 0
    v_mov_b32 v233, 0
    v_mov_b32 v234, 0
    v_mov_b32 v235, 0
    v_mov_b32 v236, 0
    v_mov_b32 v237, 0
    s_add_u32 m0, s33, 65536
    s_nop 0
    buffer_load_dwordx4 v22, s[44:47], s77 offen offset:0 lds
    v_mov_b32 v238, 0
    v_mov_b32 v239, 0
    v_mov_b32 v240, 0
    v_mov_b32 v241, 0
    v_mov_b32 v242, 0
    v_mov_b32 v243, 0
    v_mov_b32 v244, 0
    v_mov_b32 v245, 0
    s_add_u32 m0, s33, 69504
    s_nop 0
    buffer_load_dwordx4 v22, s[44:47], s77 offen offset:128 lds
    s_add_u32 m0, s33, 73728
    s_nop 0
    buffer_load_dwordx4 v9, s[48:51], s77 offen lds
    v_mov_b32 v246, 0
    v_mov_b32 v247, 0
    v_mov_b32 v248, 0
    v_mov_b32 v249, 0
    v_mov_b32 v250, 0
    v_mov_b32 v251, 0
    v_mov_b32 v252, 0
    v_mov_b32 v253, 0
    s_load_dword s94, s[16:17], s53 offset:0x1c0
    s_load_dword s94, s[18:19], s53 offset:0x0
    s_load_dword s94, s[18:19], s53 offset:0x40
    s_load_dword s94, s[18:19], s53 offset:0x80
    s_load_dword s94, s[18:19], s53 offset:0xc0
    s_waitcnt vmcnt(16)
    s_barrier
    s_add_u32 m0, s79, 135168
    s_add_u32 s72, s72, 128
    s_and_b32 s78, s72, 0x7ff
    buffer_load_dwordx4 v20, s[36:39], s78 offen lds
    v_mov_b32 v254, 0
    v_mov_b32 v255, 0
    v_mov_b32 v112, 0
    v_mov_b32 v113, 0
    v_mov_b32 v114, 0
    v_mov_b32 v115, 0
    v_mov_b32 v116, 0
    v_mov_b32 v117, 0
    v_mov_b32 v118, 0
    v_mov_b32 v119, 0
    s_add_u32 m0, s79, 136192
    s_nop 0
    buffer_load_dwordx4 v21, s[36:39], s78 offen lds
    v_mov_b32 v120, 0
    v_mov_b32 v121, 0
    v_mov_b32 v122, 0
    v_mov_b32 v123, 0
    v_mov_b32 v124, 0
    v_mov_b32 v125, 0
    v_mov_b32 v126, 0
    v_mov_b32 v127, 0
    s_add_u32 m0, s33, 77824
    s_add_u32 s77, s77, 229376
    buffer_load_dwordx4 v22, s[40:43], s77 offen offset:0 lds
    v_mov_b32 v128, 0
    v_mov_b32 v129, 0
    v_mov_b32 v130, 0
    v_mov_b32 v131, 0
    v_mov_b32 v132, 0
    v_mov_b32 v133, 0
    v_mov_b32 v134, 0
    v_mov_b32 v135, 0
    s_add_u32 m0, s33, 81792
    s_nop 0
    buffer_load_dwordx4 v22, s[40:43], s77 offen offset:128 lds
    v_mov_b32 v136, 0
    v_mov_b32 v137, 0
    v_mov_b32 v138, 0
    v_mov_b32 v139, 0
    v_mov_b32 v140, 0
    v_mov_b32 v141, 0
    v_mov_b32 v142, 0
    v_mov_b32 v143, 0
    s_add_u32 m0, s33, 86016
    s_nop 0
    buffer_load_dwordx4 v22, s[44:47], s77 offen offset:0 lds
    s_add_u32 m0, s33, 89984
    s_nop 0
    buffer_load_dwordx4 v22, s[44:47], s77 offen offset:128 lds
L_pad7:
    s_cbranch_execz L_vret0
    v_mov_b32 v144, 0
    v_mov_b32 v145, 0
    v_mov_b32 v146, 0
    v_mov_b32 v147, 0
    v_mov_b32 v148, 0
    v_mov_b32 v149, 0
    v_mov_b32 v150, 0
    v_mov_b32 v151, 0
    s_add_u32 m0, s33, 94208
    s_nop 0
    buffer_load_dwordx4 v9, s[48:51], s77 offen lds
    s_load_dword s94, s[18:19], s53 offset:0x100
    s_load_dword s94, s[18:19], s53 offset:0x140
    s_load_dword s94, s[18:19], s53 offset:0x180
    s_load_dword s94, s[18:19], s53 offset:0x1c0
    s_load_dword s94, s[10:11], s52 offset:0x80000
    s_waitcnt vmcnt(30)
    s_movk_i32 s98, 0x4000
L_tokB_chk:
    v_readfirstlane_b32 s100, v18
    v_readfirstlane_b32 s101, v19
    s_nop 1
    s_cmp_lg_u32 s100, 0
    s_cbranch_scc1 L_tokB_ok
    s_sub_u32 s98, s98, 1
    s_cbranch_scc1 L_tokB_ok
    s_sleep 1
    global_load_dwordx2 v[18:19], v87, s[24:25] sc1
    s_waitcnt vmcnt(0)
    s_branch L_tokB_chk
L_tokB_ok:
    s_waitcnt vmcnt(14)
    s_waitcnt vmcnt(15)
    s_barrier
    s_add_u32 m0, s79, 137216
    s_add_u32 s78, s78, 32768
    buffer_load_dwordx4 v20, s[36:39], s78 offen lds
    s_add_u32 m0, s79, 138240
    s_nop 0
    buffer_load_dwordx4 v21, s[36:39], s78 offen lds
    s_add_u32 m0, s33, 16384
    s_add_u32 s77, s77, 229376
    s_cmp_eq_u32 s77, 7340032
    s_cselect_b32 s77, 0, s77
    buffer_load_dwordx4 v22, s[40:43], s77 offen offset:0 lds
    s_add_u32 m0, s33, 20352
    s_nop 0
    buffer_load_dwordx4 v22, s[40:43], s77 offen offset:128 lds
    s_add_u32 m0, s33, 24576
    s_nop 0
    buffer_load_dwordx4 v22, s[44:47], s77 offen offset:0 lds
    s_add_u32 m0, s33, 28544
    s_nop 0
    buffer_load_dwordx4 v22, s[44:47], s77 offen offset:128 lds
    s_add_u32 m0, s33, 32768
    s_nop 0
    buffer_load_dwordx4 v9, s[48:51], s77 offen lds
    s_load_dword s94, s[10:11], s52 offset:0x80040
    s_load_dword s94, s[10:11], s52 offset:0x80080
    s_load_dword s94, s[10:11], s52 offset:0x800c0
    s_load_dword s94, s[10:11], s52 offset:0x80100
    s_load_dword s94, s[10:11], s52 offset:0x80140
    s_cmp_lg_u32 s4, 0
    s_cbranch_scc1 L_fLN
    s_lshl_b32 s91, s28, 4
    s_add_u32 s91, s91, s29
    s_lshl_b32 s91, s91, 7
    s_add_u32 s91, s91, 0x1e80000
    v_mov_b32 v24, s91
    v_mov_b32 v26, s100
    v_mov_b32 v27, s101
    s_mov_b64 exec, 1
    global_store_dwordx2 v24, v[26:27], s[26:27] sc1
    s_mov_b64 exec, -1
L_fLN:
    s_waitcnt vmcnt(14)
    s_barrier
    s_add_u32 m0, s79, 98304
    s_add_u32 s72, s72, 128
    s_and_b32 s78, s72, 0x7ff
    buffer_load_dwordx4 v20, s[36:39], s78 offen lds
    s_add_u32 m0, s79, 99328
    s_nop 0
    buffer_load_dwordx4 v21, s[36:39], s78 offen lds
    s_add_u32 m0, s33, 36864
    s_add_u32 s77, s77, 229376
    buffer_load_dwordx4 v22, s[40:43], s77 offen offset:0 lds
    s_add_u32 m0, s33, 40832
    s_nop 0
    buffer_load_dwordx4 v22, s[40:43], s77 offen offset:128 lds
    s_add_u32 m0, s33, 45056
    s_nop 0
    buffer_load_dwordx4 v22, s[44:47], s77 offen offset:0 lds
    s_add_u32 m0, s33, 49024
    s_nop 0
    buffer_load_dwordx4 v22, s[44:47], s77 offen offset:128 lds
    s_add_u32 m0, s33, 53248
    s_nop 0
    buffer_load_dwordx4 v9, s[48:51], s77 offen lds
    s_load_dword s94, s[10:11], s52 offset:0x80180
    s_load_dword s94, s[10:11], s52 offset:0x801c0
    s_add_u32 s52, s52, 0x100000
    s_load_dword s94, s[10:11], s52 offset:0x0
    s_load_dword s94, s[10:11], s52 offset:0x40
    s_load_dword s94, s[10:11], s52 offset:0x80
    global_load_dwordx4 v[24:27], v11, s[88:89]
    s_waitcnt vmcnt(15)
    s_barrier
    s_add_u32 m0, s79, 100352
    s_add_u32 s78, s78, 32768
    buffer_load_dwordx4 v20, s[36:39], s78 offen lds
    s_add_u32 m0, s79, 101376
    s_nop 0
    buffer_load_dwordx4 v21, s[36:39], s78 offen lds
    s_add_u32 m0, s33, 57344
    s_add_u32 s77, s77, 229376
    s_cmp_eq_u32 s77, 7340032
    s_cselect_b32 s77, 0, s77
    buffer_load_dwordx4 v22, s[40:43], s77 offen offset:0 lds
    s_add_u32 m0, s33, 61312
    s_nop 0
    buffer_load_dwordx4 v22, s[40:43], s77 offen offset:128 lds
    s_add_u32 m0, s33, 65536
    s_nop 0
    buffer_load_dwordx4 v22, s[44:47], s77 offen offset:0 lds
    s_add_u32 m0, s33, 69504
    s_nop 0
    buffer_load_dwordx4 v22, s[44:47], s77 offen offset:128 lds
    s_add_u32 m0, s33, 73728
    s_nop 0
    buffer_load_dwordx4 v9, s[48:51], s77 offen lds
    s_load_dword s94, s[10:11], s52 offset:0xc0
    s_load_dword s94, s[10:11], s52 offset:0x100
    s_load_dword s94, s[10:11], s52 offset:0x140
    s_load_dword s94, s[10:11], s52 offset:0x180
    s_load_dword s94, s[10:11], s52 offset:0x1c0
    global_load_dwordx4 v[28:31], v12, s[88:89]
    s_waitcnt vmcnt(16)
    s_barrier
    s_add_u32 m0, s79, 116736
    s_add_u32 s72, s72, 128
    s_and_b32 s78, s72, 0x7ff
    buffer_load_dwordx4 v20, s[36:39], s78 offen lds
    s_add_u32 m0, s79, 117760
    s_nop 0
    buffer_load_dwordx4 v21, s[36:39], s78 offen lds
    s_add_u32 m0, s33, 77824
    s_add_u32 s77, s77, 229376
    buffer_load_dwordx4 v22, s[40:43], s77 offen offset:0 lds
    s_add_u32 m0, s33, 81792
    s_nop 0
    buffer_load_dwordx4 v22, s[40:43], s77 offen offset:128 lds
    s_add_u32 m0, s33, 86016
    s_nop 0
    buffer_load_dwordx4 v22, s[44:47], s77 offen offset:0 lds
    s_add_u32 m0, s33, 89984
    s_nop 0
    buffer_load_dwordx4 v22, s[44:47], s77 offen offset:128 lds
    s_add_u32 m0, s33, 94208
    s_nop 0
    buffer_load_dwordx4 v9, s[48:51], s77 offen lds
    s_load_dword s94, s[10:11], s52 offset:0x80000
    s_load_dword s94, s[10:11], s52 offset:0x80040
    s_load_dword s94, s[10:11], s52 offset:0x80080
    s_load_dword s94, s[10:11], s52 offset:0x800c0
    s_load_dword s94, s[10:11], s52 offset:0x80100
    s_lshl1_add_u32 s91, s33, s34
    s_add_u32 s91, s91, 0x2000000
    v_lshl_add_u32 v32, v1, 4, s91
    s_and_b32 s85, s31, 3
    s_cmp_eq_u32 s85, 1
    s_cselect_b64 vcc, -1, 0
    s_lshl_b32 s85, s4, 11
    v_lshl_add_u32 v70, v1, 4, s85
    v_add_u32 v71, 1024, v70
    v_cndmask_b32 v11, v11, v70, vcc
    v_cndmask_b32 v12, v12, v71, vcc
    s_waitcnt vmcnt(15)
    global_store_dwordx4 v32, v[24:27], s[26:27] offset:0 sc1
    s_waitcnt vmcnt(17)
    s_barrier
    s_add_u32 m0, s79, 118784
    s_add_u32 s78, s78, 32768
    buffer_load_dwordx4 v20, s[36:39], s78 offen lds
    s_add_u32 m0, s79, 119808
    s_nop 0
    buffer_load_dwordx4 v21, s[36:39], s78 offen lds
    s_add_u32 m0, s33, 16384
    s_add_u32 s77, s77, 229376
    s_cmp_eq_u32 s77, 7340032
    s_cselect_b32 s77, 0, s77
    buffer_load_dwordx4 v22, s[40:43], s77 offen offset:0 lds
    s_add_u32 m0, s33, 20352
    s_nop 0
    buffer_load_dwordx4 v22, s[40:43], s77 offen offset:128 lds
    s_add_u32 m0, s33, 24576
    s_nop 0
    buffer_load_dwordx4 v22, s[44:47], s77 offen offset:0 lds
    s_add_u32 m0, s33, 28544
    s_nop 0
    buffer_load_dwordx4 v22, s[44:47], s77 offen offset:128 lds
    s_add_u32 m0, s33, 32768
    s_nop 0
    buffer_load_dwordx4 v9, s[48:51], s77 offen lds
    s_load_dword s94, s[10:11], s52 offset:0x80140
    s_load_dword s94, s[10:11], s52 offset:0x80180
    s_load_dword s94, s[10:11], s52 offset:0x801c0
    s_add_u32 s53, s53, 0x1c0000
    s_load_dword s94, s[16:17], s53 offset:0x0
    s_load_dword s94, s[16:17], s53 offset:0x40
    s_waitcnt vmcnt(15)
    global_store_dwordx4 v32, v[28:31], s[26:27] offset:1024 sc1
    s_waitcnt vmcnt(17)
    s_barrier
    s_add_u32 m0, s79, 135168
    s_add_u32 s72, s72, 128
    s_and_b32 s78, s72, 0x7ff
    buffer_load_dwordx4 v20, s[36:39], s78 offen lds
    s_add_u32 m0, s79, 136192
    s_nop 0
    buffer_load_dwordx4 v21, s[36:39], s78 offen lds
    s_add_u32 m0, s33, 36864
    s_add_u32 s77, s77, 229376
    buffer_load_dwordx4 v22, s[40:43], s77 offen offset:0 lds
    s_add_u32 m0, s33, 40832
    s_nop 0
    buffer_load_dwordx4 v22, s[40:43], s77 offen offset:128 lds
    s_add_u32 m0, s33, 45056
    s_nop 0
    buffer_load_dwordx4 v22, s[44:47], s77 offen offset:0 lds
    s_add_u32 m0, s33, 49024
    s_nop 0
    buffer_load_dwordx4 v22, s[44:47], s77 offen offset:128 lds
    s_add_u32 m0, s33, 53248
    s_nop 0
    buffer_load_dwordx4 v9, s[48:51], s77 offen lds
    s_load_dword s94, s[16:17], s53 offset:0x80
    s_load_dword s94, s[16:17], s53 offset:0xc0
    s_load_dword s94, s[16:17], s53 offset:0x100
    s_load_dword s94, s[16:17], s53 offset:0x140
    s_load_dword s94, s[16:17], s53 offset:0x180
    s_waitcnt vmcnt(16)
    s_barrier
    s_add_u32 m0, s79, 137216
    s_add_u32 s78, s78, 32768
    buffer_load_dwordx4 v20, s[36:39], s78 offen lds
    s_add_u32 m0, s79, 138240
    s_nop 0
    buffer_load_dwordx4 v21, s[36:39], s78 offen lds
    s_add_u32 m0, s33, 57344
    s_add_u32 s77, s77, 229376
    s_cmp_eq_u32 s77, 7340032
    s_cselect_b32 s77, 0, s77
    buffer_load_dwordx4 v22, s[40:43], s77 offen offset:0 lds
    s_add_u32 m0, s33, 61312
    s_nop 0
    buffer_load_dwordx4 v22, s[40:43], s77 offen offset:128 lds
    s_add_u32 m0, s33, 65536
    s_nop 0
    buffer_load_dwordx4 v22, s[44:47], s77 offen offset:0 lds
    s_add_u32 m0, s33, 69504
    s_nop 0
    buffer_load_dwordx4 v22, s[44:47], s77 offen offset:128 lds
    s_add_u32 m0, s33, 73728
    s_nop 0
    buffer_load_dwordx4 v9, s[48:51], s77 offen lds
    s_load_dword s94, s[16:17], s53 offset:0x1c0
    s_load_dword s94, s[18:19], s53 offset:0x0
    s_load_dword s94, s[18:19], s53 offset:0x40
    s_load_dword s94, s[18:19], s53 offset:0x80
    s_load_dword s94, s[18:19], s53 offset:0xc0
    s_sub_u32 s91, s28, s6
    s_max_i32 s91, s91, 0
    s_lshl_b32 s91, s91, 4
    s_cmp_lg_u32 s5, 0
    s_cselect_b32 s91, s29, s91
    s_cselect_b32 s92, 11, 7
    s_lshl_b32 s91, s91, 7
    s_add_u32 s91, s91, 0x1e80000
    v_lshlrev_b32 v87, s92, v1
    v_add_u32 v87, s91, v87
    s_mov_b64 exec, 0xffff
    global_load_dwordx2 v[18:19], v87, s[26:27] sc1
    s_mov_b64 exec, -1
    s_waitcnt vmcnt(16)
    s_barrier
    s_add_u32 m0, s79, 98304
    s_add_u32 s72, s72, 128
    s_and_b32 s78, s72, 0x7ff
    buffer_load_dwordx4 v20, s[36:39], s78 offen lds
    s_add_u32 m0, s79, 99328
    s_nop 0
    buffer_load_dwordx4 v21, s[36:39], s78 offen lds
    s_add_u32 m0, s33, 77824
    s_add_u32 s77, s77, 229376
    buffer_load_dwordx4 v22, s[40:43], s77 offen offset:0 lds
    s_add_u32 m0, s33, 81792
    s_nop 0
    buffer_load_dwordx4 v22, s[40:43], s77 offen offset:128 lds
    s_add_u32 m0, s33, 86016
    s_nop 0
    buffer_load_dwordx4 v22, s[44:47], s77 offen offset:0 lds
    s_add_u32 m0, s33, 89984
    s_nop 0
    buffer_load_dwordx4 v22, s[44:47], s77 offen offset:128 lds
    s_add_u32 m0, s33, 94208
    s_nop 0
    buffer_load_dwordx4 v9, s[48:51], s77 offen lds
    s_load_dword s94, s[18:19], s53 offset:0x100
    s_load_dword s94, s[18:19], s53 offset:0x140
    s_load_dword s94, s[18:19], s53 offset:0x180
    s_load_dword s94, s[18:19], s53 offset:0x1c0
    s_add_u32 s52, s52, 0x100000
    s_load_dword s94, s[10:11], s52 offset:0x0
    s_waitcnt vmcnt(7)
    s_mov_b64 exec, 0xffff
    s_movk_i32 s98, 0x4000
L_pLN_chk:
    v_cmp_ne_u64 vcc, s[100:101], v[18:19]
    s_nop 1
    s_cmp_eq_u64 vcc, 0
    s_cbranch_scc1 L_pLN_ok
    s_sub_u32 s98, s98, 1
    s_cbranch_scc1 L_pLN_ok
    s_sleep 1
    global_load_dwordx2 v[18:19], v87, s[26:27] sc1
    s_waitcnt vmcnt(0)
    s_branch L_pLN_chk
L_pLN_ok:
    s_mov_b64 exec, -1
    s_waitcnt vmcnt(15)
    s_barrier
    s_mul_i32 s91, s29, 20480
    s_mul_i32 s92, s4, 320
    s_add_u32 s91, s91, s92
    s_add_u32 s91, s91, 0x1e10000
    v_lshrrev_b32 v24, 2, v1
    v_mul_u32_u24 v24, 1280, v24
    v_and_b32 v25, 3, v1
    v_lshlrev_b32 v25, 4, v25
    v_add3_u32 v24, v24, v25, s91
    global_load_dwordx4 v[88:91], v24, s[26:27] offset:0
    global_load_dwordx4 v[92:95], v24, s[26:27] offset:64
    global_load_dwordx4 v[96:99], v24, s[26:27] offset:128
    global_load_dwordx4 v[100:103], v24, s[26:27] offset:192
    global_load_dwordx4 v[104:107], v24, s[26:27] offset:256
    s_add_u32 s92, s92, 159744
    v_lshrrev_b32 v37, 4, v1
    v_add_u32 v25, s92, v25
    v_lshl_add_u32 v36, v37, 2, v25
    v_lshl_add_u32 v25, v37, 6, v25
    s_lshl_b32 s91, s28, 2
    s_add_u32 s91, s91, s4
    s_lshl_b32 s91, s91, 8
    s_add_u32 s91, s91, 0x1e00000
    v_and_b32 v27, 31, v1
    v_lshl_add_u32 v26, v27, 3, s91
    global_load_dwordx2 v[28:29], v26, s[26:27]
    s_lshl_b32 s91, s4, 9
    s_add_u32 s91, s91, 161024
    v_lshl_add_u32 v27, v27, 4, s91
    s_add_u32 m0, s79, 100352
    s_add_u32 s78, s78, 32768
    buffer_load_dwordx4 v20, s[36:39], s78 offen lds
    s_add_u32 m0, s79, 101376
    s_nop 0
    buffer_load_dwordx4 v21, s[36:39], s78 offen lds
    s_add_u32 m0, s33, 16384
    s_add_u32 s77, s77, 229376
    s_cmp_eq_u32 s77, 7340032
    s_cselect_b32 s77, 0, s77
    buffer_load_dwordx4 v22, s[40:43], s77 offen offset:0 lds
    s_add_u32 m0, s33, 20352
    s_nop 0
    buffer_load_dwordx4 v22, s[40:43], s77 offen offset:128 lds
    s_add_u32 m0, s33, 24576
    s_nop 0
    buffer_load_dwordx4 v22, s[44:47], s77 offen offset:0 lds
    s_add_u32 m0, s33, 28544
    s_nop 0
    buffer_load_dwordx4 v22, s[44:47], s77 offen offset:128 lds
    s_add_u32 m0, s33, 32768
    s_nop 0
    buffer_load_dwordx4 v9, s[48:51], s77 offen lds
    s_load_dword s94, s[10:11], s52 offset:0x40
    s_load_dword s94, s[10:11], s52 offset:0x80
    s_load_dword s94, s[10:11], s52 offset:0xc0
    s_load_dword s94, s[10:11], s52 offset:0x100
    s_load_dword s94, s[10:11], s52 offset:0x140
    s_waitcnt vmcnt(35)
    s_waitcnt vmcnt(21)
    s_barrier
    s_add_u32 m0, s79, 116736
    s_add_u32 s72, s72, 128
    s_and_b32 s78, s72, 0x7ff
    buffer_load_dwordx4 v20, s[36:39], s78 offen lds
    s_add_u32 m0, s79, 117760
    s_nop 0
    buffer_load_dwordx4 v21, s[36:39], s78 offen lds
    s_add_u32 m0, s33, 36864
    s_add_u32 s77, s77, 229376
    buffer_load_dwordx4 v22, s[40:43], s77 offen offset:0 lds
    s_add_u32 m0, s33, 40832
    s_nop 0
    buffer_load_dwordx4 v22, s[40:43], s77 offen offset:128 lds
    s_add_u32 m0, s33, 45056
    s_nop 0
    buffer_load_dwordx4 v22, s[44:47], s77 offen offset:0 lds
    s_add_u32 m0, s33, 49024
    s_nop 0
    buffer_load_dwordx4 v22, s[44:47], s77 offen offset:128 lds
    s_add_u32 m0, s33, 53248
    s_nop 0
    buffer_load_dwordx4 v9, s[48:51], s77 offen lds
    s_load_dword s94, s[10:11], s52 offset:0x180
    s_load_dword s94, s[10:11], s52 offset:0x1c0
    s_load_dword s94, s[10:11], s52 offset:0x80000
    s_load_dword s94, s[10:11], s52 offset:0x80040
    s_load_dword s94, s[10:11], s52 offset:0x80080
    s_cmp_lg_u32 s4, 0
    s_cbranch_scc1 L_fC
    s_lshl_b32 s91, s28, 4
    s_add_u32 s91, s91, s29
    s_lshl_b32 s91, s91, 7
    s_add_u32 s91, s91, 0x1eb0000
    v_mov_b32 v32, s91
    v_mov_b32 v34, s100
    v_mov_b32 v35, s101
    s_mov_b64 exec, 1
    global_store_dwordx2 v32, v[34:35], s[26:27] sc1
    s_mov_b64 exec, -1
L_fC:
    s_waitcnt vmcnt(20)
    s_barrier
    s_add_u32 m0, s79, 118784
    s_add_u32 s78, s78, 32768
    buffer_load_dwordx4 v20, s[36:39], s78 offen lds
    s_waitcnt vmcnt(15)
    v_rcp_f32 v30, v29
    v_mul_f32 v32, -1.0, v28
    v_mul_f32 v35, v29, v29
    v_fma_f32 v31, -v29, v30, 1.0
    v_fma_f32 v30, v31, v30, v30
    v_mul_f32 v33, 0xc0135761, v30
    v_mul_f32 v31, v30, v30
    s_add_u32 m0, s79, 119808
    s_nop 0
    buffer_load_dwordx4 v21, s[36:39], s78 offen lds
    v_mul_f32 v31, v31, v30
    v_mul_f32 v34, 0xbdd2d3e8, v31
    ds_write_b128 v27, v[32:35]
    v_permlane16_swap_b32 v88, v92
    v_permlane16_swap_b32 v96, v100
    v_permlane16_swap_b32 v89, v93
    v_permlane16_swap_b32 v97, v101
    v_permlane16_swap_b32 v90, v94
    v_permlane16_swap_b32 v98, v102
    s_add_u32 m0, s33, 57344
    s_add_u32 s77, s77, 229376
    s_cmp_eq_u32 s77, 7340032
    s_cselect_b32 s77, 0, s77
    buffer_load_dwordx4 v22, s[40:43], s77 offen offset:0 lds
    v_permlane16_swap_b32 v91, v95
    v_permlane16_swap_b32 v99, v103
    v_permlane16_swap_b32 v104, v105
    v_permlane16_swap_b32 v106, v107
    v_add_f32 v88, v88, v92
    v_add_f32 v96, v96, v100
    v_add_f32 v89, v89, v93
    v_add_f32 v97, v97, v101
    s_add_u32 m0, s33, 61312
    s_nop 0
    buffer_load_dwordx4 v22, s[40:43], s77 offen offset:128 lds
    v_add_f32 v90, v90, v94
    v_add_f32 v98, v98, v102
    v_add_f32 v91, v91, v95
    v_add_f32 v99, v99, v103
    v_add_f32 v104, v104, v105
    v_add_f32 v106, v106, v107
    s_nop 0
    v_permlane32_swap_b32 v88, v96
    v_permlane32_swap_b32 v89, v97
    s_add_u32 m0, s33, 65536
    s_nop 0
    buffer_load_dwordx4 v22, s[44:47], s77 offen offset:0 lds
    v_permlane32_swap_b32 v90, v98
    v_permlane32_swap_b32 v91, v99
    v_permlane32_swap_b32 v104, v106
    v_add_f32 v88, v88, v96
    v_add_f32 v89, v89, v97
    v_add_f32 v90, v90, v98
    v_add_f32 v91, v91, v99
    v_add_f32 v104, v104, v106
    s_add_u32 m0, s33, 69504
    s_nop 0
    buffer_load_dwordx4 v22, s[44:47], s77 offen offset:128 lds
    s_add_u32 m0, s33, 73728
    s_nop 0
    buffer_load_dwordx4 v9, s[48:51], s77 offen lds
    v_add_f32_dpp v88, v88, v88 row_ror:8 row_mask:0xf bank_mask:0xf
    v_add_f32_dpp v89, v89, v89 row_ror:8 row_mask:0xf bank_mask:0xf
    v_add_f32_dpp v90, v90, v90 row_ror:8 row_mask:0xf bank_mask:0xf
    v_add_f32_dpp v91, v91, v91 row_ror:8 row_mask:0xf bank_mask:0xf
    v_add_f32_dpp v104, v104, v104 row_ror:8 row_mask:0xf bank_mask:0xf
    v_add_f32_dpp v88, v88, v88 row_ror:4 row_mask:0xf bank_mask:0xf
    v_add_f32_dpp v89, v89, v89 row_ror:4 row_mask:0xf bank_mask:0xf
    v_add_f32_dpp v90, v90, v90 row_ror:4 row_mask:0xf bank_mask:0xf
    s_load_dword s94, s[10:11], s52 offset:0x800c0
    s_load_dword s94, s[10:11], s52 offset:0x80100
    s_load_dword s94, s[10:11], s52 offset:0x80140
    s_load_dword s94, s[10:11], s52 offset:0x80180
    s_load_dword s94, s[10:11], s52 offset:0x801c0
    s_waitcnt vmcnt(14)
    s_barrier
    s_mov_b32 s36, s26
    s_mov_b32 s37, s27
    s_mov_b32 s38, 0x400000
    s_mov_b32 s39, 0x20000
    s_add_u32 m0, s33, 77824
    s_add_u32 s77, s77, 229376
    buffer_load_dwordx4 v22, s[40:43], s77 offen offset:0 lds
    v_add_f32_dpp v91, v91, v91 row_ror:4 row_mask:0xf bank_mask:0xf
    v_add_f32_dpp v104, v104, v104 row_ror:4 row_mask:0xf bank_mask:0xf
    s_mov_b32 s92, 0x000f000f
    s_mov_b32 s93, s92
    s_mov_b64 exec, s[92:93]
    ds_write_b128 v25, v[88:91]
    ds_write_b32 v36, v104 offset:256
    s_mov_b64 exec, -1
    v_mov_b32 v88, 0
    v_mov_b32 v89, 0
    v_mov_b32 v90, 0
    v_mov_b32 v91, 0
    v_mov_b32 v92, 0
    v_mov_b32 v93, 0
    v_mov_b32 v94, 0
    v_mov_b32 v95, 0
    s_add_u32 m0, s33, 81792
    s_nop 0
    buffer_load_dwordx4 v22, s[40:43], s77 offen offset:128 lds
    s_add_u32 m0, s33, 86016
    s_nop 0
    buffer_load_dwordx4 v22, s[44:47], s77 offen offset:0 lds
    v_mov_b32 v96, 0
    v_mov_b32 v97, 0
    v_mov_b32 v98, 0
    v_mov_b32 v99, 0
    v_mov_b32 v100, 0
    v_mov_b32 v101, 0
    v_mov_b32 v102, 0
    v_mov_b32 v103, 0
    s_add_u32 m0, s33, 89984
    s_nop 0
    buffer_load_dwordx4 v22, s[44:47], s77 offen offset:128 lds
    v_mov_b32 v104, 0
    v_mov_b32 v105, 0
    v_mov_b32 v106, 0
    v_mov_b32 v107, 0
    v_mov_b32 v108, 0
    v_mov_b32 v109, 0
    v_mov_b32 v110, 0
    v_mov_b32 v111, 0
    s_add_u32 m0, s33, 94208
    s_nop 0
    buffer_load_dwordx4 v9, s[48:51], s77 offen lds
    s_add_u32 m0, s79, 135168
    s_mov_b32 s78, 0
    buffer_load_dwordx4 v20, s[36:39], s78 offen sc1 lds
    s_add_u32 m0, s79, 136192
    s_nop 0
    buffer_load_dwordx4 v21, s[36:39], s78 offen sc1 lds
    s_waitcnt vmcnt(14)
    s_barrier
    s_lshl_b32 s85, s29, 7
    s_add_u32 s86, s85, 4096
    s_add_u32 s87, s85, 128
    s_and_b32 s87, s87, 0x7ff
    s_add_u32 s87, s87, 5120
    s_add_u32 s40, s10, s85
    s_addc_u32 s41, s11, 0
    s_add_u32 s44, s10, s86
    s_addc_u32 s45, s11, 0
    s_add_u32 s48, s16, s87
    s_addc_u32 s49, s17, 0
    s_add_u32 s52, s18, s87
    s_addc_u32 s53, s19, 0
    s_sub_u32 s42, 6291456, s85
    s_sub_u32 s46, 6291456, s86
    s_mov_b32 s50, s54
    s_add_u32 m0, s79, 137216
    s_mov_b32 s78, 32768
    buffer_load_dwordx4 v20, s[36:39], s78 offen sc1 lds
    s_add_u32 m0, s79, 138240
    s_nop 0
    buffer_load_dwordx4 v21, s[36:39], s78 offen sc1 lds
    s_add_u32 m0, s81, 151552
    s_mov_b32 s78, 0
    s_mov_b64 exec, 0xffffffff
    buffer_load_dwordx4 v3, s[36:39], s78 offen sc1 lds
    s_mov_b64 exec, -1
    s_add_u32 m0, s33, 16384
    s_mov_b32 s76, 0
    buffer_load_dwordx4 v23, s[40:43], s76 offen offset:0 lds
    s_add_u32 m0, s33, 18432
    s_nop 0
    buffer_load_dwordx4 v23, s[40:43], s76 offen offset:2048 lds
    s_add_u32 m0, s33, 24576
    s_nop 0
    buffer_load_dwordx4 v23, s[44:47], s76 offen offset:0 lds
    s_add_u32 m0, s33, 28672
    s_mov_b32 s77, 0
    buffer_load_dwordx4 v22, s[48:51], s77 offen offset:0 lds
    s_add_u32 m0, s33, 32768
    s_nop 0
    buffer_load_dwordx4 v22, s[52:55], s77 offen offset:0 lds
    s_waitcnt vmcnt(15)
    s_barrier
    s_add_u32 m0, s79, 98304
    s_mov_b32 s78, 128
    buffer_load_dwordx4 v20, s[36:39], s78 offen sc1 lds
    s_add_u32 m0, s79, 99328
    s_nop 0
    buffer_load_dwordx4 v21, s[36:39], s78 offen sc1 lds
    s_add_u32 m0, s33, 36864
    s_mov_b32 s76, 196608
    buffer_load_dwordx4 v23, s[40:43], s76 offen offset:0 lds
    s_add_u32 m0, s33, 38912
    s_nop 0
    buffer_load_dwordx4 v23, s[40:43], s76 offen offset:2048 lds
    s_add_u32 m0, s33, 45056
    s_nop 0
    buffer_load_dwordx4 v23, s[44:47], s76 offen offset:0 lds
    s_add_u32 m0, s33, 49152
    s_mov_b32 s77, 229376
    buffer_load_dwordx4 v22, s[48:51], s77 offen offset:0 lds
    s_add_u32 m0, s33, 53248
    s_nop 0
    buffer_load_dwordx4 v22, s[52:55], s77 offen offset:0 lds
    s_waitcnt vmcnt(7)
    s_barrier
    s_add_u32 m0, s79, 100352
    s_mov_b32 s78, 32896
    buffer_load_dwordx4 v20, s[36:39], s78 offen sc1 lds
    s_add_u32 m0, s79, 101376
    s_nop 0
    buffer_load_dwordx4 v21, s[36:39], s78 offen sc1 lds
    s_add_u32 m0, s81, 114688
    s_mov_b32 s78, 128
    s_mov_b64 exec, 0xffffffff
    buffer_load_dwordx4 v3, s[36:39], s78 offen sc1 lds
    s_mov_b64 exec, -1
    s_add_u32 m0, s33, 57344
    s_mov_b32 s76, 393216
L_pad8:
    s_cbranch_execz L_vret0
    buffer_load_dwordx4 v23, s[40:43], s76 offen offset:0 lds
    s_add_u32 m0, s33, 59392
    s_nop 0
    buffer_load_dwordx4 v23, s[40:43], s76 offen offset:2048 lds
    s_add_u32 m0, s33, 65536
    s_nop 0
    buffer_load_dwordx4 v23, s[44:47], s76 offen offset:0 lds
    s_add_u32 m0, s33, 69632
    s_mov_b32 s77, 458752
    buffer_load_dwordx4 v22, s[48:51], s77 offen offset:0 lds
    s_add_u32 m0, s33, 73728
    s_nop 0
    buffer_load_dwordx4 v22, s[52:55], s77 offen offset:0 lds
    s_waitcnt lgkmcnt(0)
    v_add_u32 v14, s80, v16
    v_add_u32 v15, s80, v17
    s_add_u32 s84, s80, s95
    v_add_u32 v18, s84, v16
    v_add_u32 v19, s84, v17
    s_add_u32 s80, s80, 18432
    s_cmp_ge_u32 s80, 153600
    s_cselect_b32 s84, 55296, 0
    s_sub_u32 s80, s80, s84
    ds_read_b64_tr_b16 v[64:65], v4 offset:4096
    ds_read_b64_tr_b16 v[66:67], v4 offset:4608
    ds_read_b128 v[24:27], v14 offset:0
    ds_read_b128 v[28:31], v14 offset:2048
    ds_read_b128 v[32:35], v14 offset:4096
    ds_read_b128 v[36:39], v14 offset:6144
    ds_read_b64_tr_b16 v[68:69], v5 offset:4096
    ds_read_b64_tr_b16 v[70:71], v5 offset:4608
    ds_read_b64_tr_b16 v[72:73], v4 offset:8192
    ds_read_b64_tr_b16 v[74:75], v4 offset:8704
    ds_read_b128 v[56:59], v18
    s_barrier
    s_setprio 1
    s_mov_b32 s34, 7
.p2align 6
L_p2:
    s_waitcnt lgkmcnt(8)
    v_mfma_f32_16x16x32_bf16 v[88:91], v[64:67], v[24:27], v[88:91]
    ds_read_b64_tr_b16 v[76:77], v5 offset:8192
    s_waitcnt lgkmcnt(8)
    v_mfma_f32_16x16x32_bf16 v[92:95], v[64:67], v[28:31], v[92:95]
    ds_read_b64_tr_b16 v[78:79], v5 offset:8704
    s_waitcnt lgkmcnt(8)
    v_mfma_f32_16x16x32_bf16 v[96:99], v[64:67], v[32:35], v[96:99]
    ds_read_b64_tr_b16 v[80:81], v4 offset:0
    s_waitcnt lgkmcnt(8)
    v_mfma_f32_16x16x32_bf16 v[100:103], v[64:67], v[36:39], v[100:103]
    ds_read_b64_tr_b16 v[82:83], v4 offset:512
    s_waitcnt lgkmcnt(4)
    v_mfma_f32_16x16x32_bf16 v[248:251], v[64:67], v[56:59], v[248:251]
    v_mfma_f32_16x16x32_bf16 v[104:107], v[68:71], v[24:27], v[104:107]
    ds_read_b64_tr_b16 v[64:65], v5 offset:0
    v_mfma_f32_16x16x32_bf16 v[108:111], v[68:71], v[28:31], v[108:111]
    v_mfma_f32_16x16x32_bf16 v[112:115], v[68:71], v[32:35], v[112:115]
    ds_read_b64_tr_b16 v[66:67], v5 offset:512
    v_mfma_f32_16x16x32_bf16 v[116:119], v[68:71], v[36:39], v[116:119]
    v_mfma_f32_16x16x32_bf16 v[120:123], v[24:27], v[72:75], v[120:123]
    ds_read_b64_tr_b16 v[68:69], v4 offset:12288
    v_mfma_f32_16x16x32_bf16 v[124:127], v[28:31], v[72:75], v[124:127]
    v_mfma_f32_16x16x32_bf16 v[128:131], v[32:35], v[72:75], v[128:131]
    ds_read_b64_tr_b16 v[70:71], v4 offset:12800
    v_mfma_f32_16x16x32_bf16 v[132:135], v[36:39], v[72:75], v[132:135]
    v_mfma_f32_16x16x32_bf16 v[252:255], v[56:59], v[72:75], v[252:255]
    s_waitcnt lgkmcnt(6)
    v_mfma_f32_16x16x32_bf16 v[136:139], v[24:27], v[76:79], v[136:139]
    ds_read_b64_tr_b16 v[72:73], v4 offset:16384
    v_mfma_f32_16x16x32_bf16 v[140:143], v[28:31], v[76:79], v[140:143]
    v_mfma_f32_16x16x32_bf16 v[144:147], v[32:35], v[76:79], v[144:147]
    ds_read_b64_tr_b16 v[74:75], v4 offset:16896
    v_mfma_f32_16x16x32_bf16 v[148:151], v[36:39], v[76:79], v[148:151]
    s_waitcnt lgkmcnt(6)
    v_mfma_f32_16x16x32_bf16 v[152:155], v[80:83], v[24:27], v[152:155]
    ds_read_b64_tr_b16 v[76:77], v5 offset:12288
    v_mfma_f32_16x16x32_bf16 v[156:159], v[80:83], v[28:31], v[156:159]
    v_mfma_f32_16x16x32_bf16 v[160:163], v[80:83], v[32:35], v[160:163]
    ds_read_b64_tr_b16 v[78:79], v5 offset:12800
    v_mfma_f32_16x16x32_bf16 v[164:167], v[80:83], v[36:39], v[164:167]
    s_waitcnt lgkmcnt(6)
    v_mfma_f32_16x16x32_bf16 v[168:171], v[64:67], v[24:27], v[168:171]
    ds_read_b64_tr_b16 v[80:81], v5 offset:16384
    v_mfma_f32_16x16x32_bf16 v[172:175], v[64:67], v[28:31], v[172:175]
    v_mfma_f32_16x16x32_bf16 v[176:179], v[64:67], v[32:35], v[176:179]
    ds_read_b64_tr_b16 v[82:83], v5 offset:16896
    v_mfma_f32_16x16x32_bf16 v[180:183], v[64:67], v[36:39], v[180:183]
    s_waitcnt lgkmcnt(6)
    v_mfma_f32_16x16x32_bf16 v[184:187], v[68:71], v[24:27], v[184:187]
    v_mfma_f32_16x16x32_bf16 v[188:191], v[68:71], v[28:31], v[188:191]
    v_mfma_f32_16x16x32_bf16 v[192:195], v[68:71], v[32:35], v[192:195]
    v_mfma_f32_16x16x32_bf16 v[196:199], v[68:71], v[36:39], v[196:199]
    s_waitcnt vmcnt(8) lgkmcnt(0)
    s_barrier
    v_mfma_f32_16x16x32_bf16 v[200:203], v[72:75], v[24:27], v[200:203]
    ds_read_b64_tr_b16 v[64:65], v4 offset:24576
    v_mfma_f32_16x16x32_bf16 v[204:207], v[72:75], v[28:31], v[204:207]
    ds_read_b64_tr_b16 v[66:67], v4 offset:25088
    v_mfma_f32_16x16x32_bf16 v[208:211], v[72:75], v[32:35], v[208:211]
    ds_read_b128 v[40:43], v15 offset:0
    v_mfma_f32_16x16x32_bf16 v[212:215], v[72:75], v[36:39], v[212:215]
    ds_read_b128 v[44:47], v15 offset:2048
    v_mfma_f32_16x16x32_bf16 v[216:219], v[76:79], v[24:27], v[216:219]
    ds_read_b128 v[48:51], v15 offset:4096
    v_mfma_f32_16x16x32_bf16 v[220:223], v[76:79], v[28:31], v[220:223]
    ds_read_b128 v[52:55], v15 offset:6144
    v_mfma_f32_16x16x32_bf16 v[224:227], v[76:79], v[32:35], v[224:227]
    ds_read_b64_tr_b16 v[68:69], v5 offset:24576
    v_mfma_f32_16x16x32_bf16 v[228:231], v[76:79], v[36:39], v[228:231]
    ds_read_b64_tr_b16 v[70:71], v5 offset:25088
    v_mfma_f32_16x16x32_bf16 v[232:235], v[80:83], v[24:27], v[232:235]
    ds_read_b64_tr_b16 v[72:73], v4 offset:28672
    v_mfma_f32_16x16x32_bf16 v[236:239], v[80:83], v[28:31], v[236:239]
    ds_read_b64_tr_b16 v[74:75], v4 offset:29184
    v_mfma_f32_16x16x32_bf16 v[240:243], v[80:83], v[32:35], v[240:243]
    ds_read_b128 v[60:63], v19
    v_mfma_f32_16x16x32_bf16 v[244:247], v[80:83], v[36:39], v[244:247]
    s_waitcnt lgkmcnt(8)
    v_mfma_f32_16x16x32_bf16 v[88:91], v[64:67], v[40:43], v[88:91]
    ds_read_b64_tr_b16 v[76:77], v5 offset:28672
    s_waitcnt lgkmcnt(8)
    v_mfma_f32_16x16x32_bf16 v[92:95], v[64:67], v[44:47], v[92:95]
    ds_read_b64_tr_b16 v[78:79], v5 offset:29184
    s_waitcnt lgkmcnt(8)
    v_mfma_f32_16x16x32_bf16 v[96:99], v[64:67], v[48:51], v[96:99]
    ds_read_b64_tr_b16 v[80:81], v4 offset:20480
    s_waitcnt lgkmcnt(8)
    v_mfma_f32_16x16x32_bf16 v[100:103], v[64:67], v[52:55], v[100:103]
    ds_read_b64_tr_b16 v[82:83], v4 offset:20992
    s_waitcnt lgkmcnt(4)
    v_mfma_f32_16x16x32_bf16 v[248:251], v[64:67], v[60:63], v[248:251]
    v_mfma_f32_16x16x32_bf16 v[104:107], v[68:71], v[40:43], v[104:107]
    ds_read_b64_tr_b16 v[64:65], v5 offset:20480
    v_mfma_f32_16x16x32_bf16 v[108:111], v[68:71], v[44:47], v[108:111]
    v_add_u32 v14, s80, v16
    v_mfma_f32_16x16x32_bf16 v[112:115], v[68:71], v[48:51], v[112:115]
    ds_read_b64_tr_b16 v[66:67], v5 offset:20992
    v_mfma_f32_16x16x32_bf16 v[116:119], v[68:71], v[52:55], v[116:119]
    v_add_u32 v15, s80, v17
    v_mfma_f32_16x16x32_bf16 v[120:123], v[40:43], v[72:75], v[120:123]
    ds_read_b64_tr_b16 v[68:69], v4 offset:32768
    v_mfma_f32_16x16x32_bf16 v[124:127], v[44:47], v[72:75], v[124:127]
    s_add_u32 s84, s80, s95
    v_mfma_f32_16x16x32_bf16 v[128:131], v[48:51], v[72:75], v[128:131]
    ds_read_b64_tr_b16 v[70:71], v4 offset:33280
    v_mfma_f32_16x16x32_bf16 v[132:135], v[52:55], v[72:75], v[132:135]
    v_add_u32 v18, s84, v16
    v_mfma_f32_16x16x32_bf16 v[252:255], v[60:63], v[72:75], v[252:255]
    s_waitcnt lgkmcnt(6)
    v_mfma_f32_16x16x32_bf16 v[136:139], v[40:43], v[76:79], v[136:139]
    ds_read_b64_tr_b16 v[72:73], v4 offset:36864
    v_mfma_f32_16x16x32_bf16 v[140:143], v[44:47], v[76:79], v[140:143]
    v_add_u32 v19, s84, v17
    v_mfma_f32_16x16x32_bf16 v[144:147], v[48:51], v[76:79], v[144:147]
    ds_read_b64_tr_b16 v[74:75], v4 offset:37376
    v_mfma_f32_16x16x32_bf16 v[148:151], v[52:55], v[76:79], v[148:151]
    s_add_u32 s80, s80, 18432
    s_waitcnt lgkmcnt(6)
    v_mfma_f32_16x16x32_bf16 v[152:155], v[80:83], v[40:43], v[152:155]
    ds_read_b64_tr_b16 v[76:77], v5 offset:32768
    v_mfma_f32_16x16x32_bf16 v[156:159], v[80:83], v[44:47], v[156:159]
    s_cmp_ge_u32 s80, 153600
    s_cselect_b32 s84, 55296, 0
    v_mfma_f32_16x16x32_bf16 v[160:163], v[80:83], v[48:51], v[160:163]
    ds_read_b64_tr_b16 v[78:79], v5 offset:33280
    v_mfma_f32_16x16x32_bf16 v[164:167], v[80:83], v[52:55], v[164:167]
    s_sub_u32 s80, s80, s84
    s_waitcnt lgkmcnt(6)
    v_mfma_f32_16x16x32_bf16 v[168:171], v[64:67], v[40:43], v[168:171]
    ds_read_b64_tr_b16 v[80:81], v5 offset:36864
    v_mfma_f32_16x16x32_bf16 v[172:175], v[64:67], v[44:47], v[172:175]
    v_mfma_f32_16x16x32_bf16 v[176:179], v[64:67], v[48:51], v[176:179]
    ds_read_b64_tr_b16 v[82:83], v5 offset:37376
    v_mfma_f32_16x16x32_bf16 v[180:183], v[64:67], v[52:55], v[180:183]
    s_waitcnt lgkmcnt(6)
    v_mfma_f32_16x16x32_bf16 v[184:187], v[68:71], v[40:43], v[184:187]
    v_mfma_f32_16x16x32_bf16 v[188:191], v[68:71], v[44:47], v[188:191]
    v_mfma_f32_16x16x32_bf16 v[192:195], v[68:71], v[48:51], v[192:195]
    v_mfma_f32_16x16x32_bf16 v[196:199], v[68:71], v[52:55], v[196:199]
    s_waitcnt vmcnt(0) lgkmcnt(0)
    s_barrier
    v_mfma_f32_16x16x32_bf16 v[200:203], v[72:75], v[40:43], v[200:203]
    ds_read_b64_tr_b16 v[64:65], v6 offset:4096
    v_mfma_f32_16x16x32_bf16 v[204:207], v[72:75], v[44:47], v[204:207]
    ds_read_b64_tr_b16 v[66:67], v6 offset:4608
    v_mfma_f32_16x16x32_bf16 v[208:211], v[72:75], v[48:51], v[208:211]
    ds_read_b128 v[24:27], v14 offset:0
    v_mfma_f32_16x16x32_bf16 v[212:215], v[72:75], v[52:55], v[212:215]
    ds_read_b128 v[28:31], v14 offset:2048
    v_mfma_f32_16x16x32_bf16 v[216:219], v[76:79], v[40:43], v[216:219]
    ds_read_b128 v[32:35], v14 offset:4096
    v_mfma_f32_16x16x32_bf16 v[220:223], v[76:79], v[44:47], v[220:223]
    ds_read_b128 v[36:39], v14 offset:6144
    v_mfma_f32_16x16x32_bf16 v[224:227], v[76:79], v[48:51], v[224:227]
    ds_read_b64_tr_b16 v[68:69], v7 offset:4096
    v_mfma_f32_16x16x32_bf16 v[228:231], v[76:79], v[52:55], v[228:231]
    ds_read_b64_tr_b16 v[70:71], v7 offset:4608
    v_mfma_f32_16x16x32_bf16 v[232:235], v[80:83], v[40:43], v[232:235]
    ds_read_b64_tr_b16 v[72:73], v6 offset:8192
    v_mfma_f32_16x16x32_bf16 v[236:239], v[80:83], v[44:47], v[236:239]
    ds_read_b64_tr_b16 v[74:75], v6 offset:8704
    v_mfma_f32_16x16x32_bf16 v[240:243], v[80:83], v[48:51], v[240:243]
    ds_read_b128 v[56:59], v18
    v_mfma_f32_16x16x32_bf16 v[244:247], v[80:83], v[52:55], v[244:247]
    s_waitcnt lgkmcnt(8)
    v_mfma_f32_16x16x32_bf16 v[88:91], v[64:67], v[24:27], v[88:91]
    ds_read_b64_tr_b16 v[76:77], v7 offset:8192
    s_waitcnt lgkmcnt(8)
    v_mfma_f32_16x16x32_bf16 v[92:95], v[64:67], v[28:31], v[92:95]
    ds_read_b64_tr_b16 v[78:79], v7 offset:8704
    s_waitcnt lgkmcnt(8)
    v_mfma_f32_16x16x32_bf16 v[96:99], v[64:67], v[32:35], v[96:99]
    ds_read_b64_tr_b16 v[80:81], v6 offset:0
    s_waitcnt lgkmcnt(8)
    v_mfma_f32_16x16x32_bf16 v[100:103], v[64:67], v[36:39], v[100:103]
    ds_read_b64_tr_b16 v[82:83], v6 offset:512
    s_waitcnt lgkmcnt(4)
    v_mfma_f32_16x16x32_bf16 v[248:251], v[64:67], v[56:59], v[248:251]
    v_mfma_f32_16x16x32_bf16 v[104:107], v[68:71], v[24:27], v[104:107]
    ds_read_b64_tr_b16 v[64:65], v7 offset:0
    v_mfma_f32_16x16x32_bf16 v[108:111], v[68:71], v[28:31], v[108:111]
    v_mfma_f32_16x16x32_bf16 v[112:115], v[68:71], v[32:35], v[112:115]
    ds_read_b64_tr_b16 v[66:67], v7 offset:512
    v_mfma_f32_16x16x32_bf16 v[116:119], v[68:71], v[36:39], v[116:119]
    v_mfma_f32_16x16x32_bf16 v[120:123], v[24:27], v[72:75], v[120:123]
    ds_read_b64_tr_b16 v[68:69], v6 offset:12288
    v_mfma_f32_16x16x32_bf16 v[124:127], v[28:31], v[72:75], v[124:127]
    v_mfma_f32_16x16x32_bf16 v[128:131], v[32:35], v[72:75], v[128:131]
    ds_read_b64_tr_b16 v[70:71], v6 offset:12800
    v_mfma_f32_16x16x32_bf16 v[132:135], v[36:39], v[72:75], v[132:135]
    v_mfma_f32_16x16x32_bf16 v[252:255], v[56:59], v[72:75], v[252:255]
    s_waitcnt lgkmcnt(6)
    v_mfma_f32_16x16x32_bf16 v[136:139], v[24:27], v[76:79], v[136:139]
    ds_read_b64_tr_b16 v[72:73], v6 offset:16384
    v_mfma_f32_16x16x32_bf16 v[140:143], v[28:31], v[76:79], v[140:143]
    v_mfma_f32_16x16x32_bf16 v[144:147], v[32:35], v[76:79], v[144:147]
    ds_read_b64_tr_b16 v[74:75], v6 offset:16896
    v_mfma_f32_16x16x32_bf16 v[148:151], v[36:39], v[76:79], v[148:151]
    s_waitcnt lgkmcnt(6)
    v_mfma_f32_16x16x32_bf16 v[152:155], v[80:83], v[24:27], v[152:155]
    ds_read_b64_tr_b16 v[76:77], v7 offset:12288
    v_mfma_f32_16x16x32_bf16 v[156:159], v[80:83], v[28:31], v[156:159]
    v_mfma_f32_16x16x32_bf16 v[160:163], v[80:83], v[32:35], v[160:163]
    ds_read_b64_tr_b16 v[78:79], v7 offset:12800
    v_mfma_f32_16x16x32_bf16 v[164:167], v[80:83], v[36:39], v[164:167]
    s_waitcnt lgkmcnt(6)
    v_mfma_f32_16x16x32_bf16 v[168:171], v[64:67], v[24:27], v[168:171]
    ds_read_b64_tr_b16 v[80:81], v7 offset:16384
    v_mfma_f32_16x16x32_bf16 v[172:175], v[64:67], v[28:31], v[172:175]
    v_mfma_f32_16x16x32_bf16 v[176:179], v[64:67], v[32:35], v[176:179]
    ds_read_b64_tr_b16 v[82:83], v7 offset:16896
    v_mfma_f32_16x16x32_bf16 v[180:183], v[64:67], v[36:39], v[180:183]
    s_waitcnt lgkmcnt(6)
    v_mfma_f32_16x16x32_bf16 v[184:187], v[68:71], v[24:27], v[184:187]
    v_mfma_f32_16x16x32_bf16 v[188:191], v[68:71], v[28:31], v[188:191]
    v_mfma_f32_16x16x32_bf16 v[192:195], v[68:71], v[32:35], v[192:195]
    v_mfma_f32_16x16x32_bf16 v[196:199], v[68:71], v[36:39], v[196:199]
    s_waitcnt lgkmcnt(0)
    s_barrier
    v_mfma_f32_16x16x32_bf16 v[200:203], v[72:75], v[24:27], v[200:203]
    ds_read_b64_tr_b16 v[64:65], v6 offset:24576
    v_mfma_f32_16x16x32_bf16 v[204:207], v[72:75], v[28:31], v[204:207]
    ds_read_b64_tr_b16 v[66:67], v6 offset:25088
    v_mfma_f32_16x16x32_bf16 v[208:211], v[72:75], v[32:35], v[208:211]
    ds_read_b128 v[40:43], v15 offset:0
    v_mfma_f32_16x16x32_bf16 v[212:215], v[72:75], v[36:39], v[212:215]
    ds_read_b128 v[44:47], v15 offset:2048
    v_mfma_f32_16x16x32_bf16 v[216:219], v[76:79], v[24:27], v[216:219]
    ds_read_b128 v[48:51], v15 offset:4096
    v_mfma_f32_16x16x32_bf16 v[220:223], v[76:79], v[28:31], v[220:223]
    ds_read_b128 v[52:55], v15 offset:6144
    v_mfma_f32_16x16x32_bf16 v[224:227], v[76:79], v[32:35], v[224:227]
    ds_read_b64_tr_b16 v[68:69], v7 offset:24576
    v_mfma_f32_16x16x32_bf16 v[228:231], v[76:79], v[36:39], v[228:231]
    ds_read_b64_tr_b16 v[70:71], v7 offset:25088
    v_mfma_f32_16x16x32_bf16 v[232:235], v[80:83], v[24:27], v[232:235]
    ds_read_b64_tr_b16 v[72:73], v6 offset:28672
    v_mfma_f32_16x16x32_bf16 v[236:239], v[80:83], v[28:31], v[236:239]
    ds_read_b64_tr_b16 v[74:75], v6 offset:29184
    v_mfma_f32_16x16x32_bf16 v[240:243], v[80:83], v[32:35], v[240:243]
    ds_read_b128 v[60:63], v19
    v_mfma_f32_16x16x32_bf16 v[244:247], v[80:83], v[36:39], v[244:247]
    s_waitcnt lgkmcnt(8)
    v_mfma_f32_16x16x32_bf16 v[88:91], v[64:67], v[40:43], v[88:91]
    ds_read_b64_tr_b16 v[76:77], v7 offset:28672
    s_waitcnt lgkmcnt(8)
    v_mfma_f32_16x16x32_bf16 v[92:95], v[64:67], v[44:47], v[92:95]
    ds_read_b64_tr_b16 v[78:79], v7 offset:29184
    s_waitcnt lgkmcnt(8)
    v_mfma_f32_16x16x32_bf16 v[96:99], v[64:67], v[48:51], v[96:99]
    ds_read_b64_tr_b16 v[80:81], v6 offset:20480
    s_waitcnt lgkmcnt(8)
    v_mfma_f32_16x16x32_bf16 v[100:103], v[64:67], v[52:55], v[100:103]
    ds_read_b64_tr_b16 v[82:83], v6 offset:20992
    s_waitcnt lgkmcnt(4)
    v_mfma_f32_16x16x32_bf16 v[248:251], v[64:67], v[60:63], v[248:251]
    v_mfma_f32_16x16x32_bf16 v[104:107], v[68:71], v[40:43], v[104:107]
    ds_read_b64_tr_b16 v[64:65], v7 offset:20480
    v_mfma_f32_16x16x32_bf16 v[108:111], v[68:71], v[44:47], v[108:111]
    v_add_u32 v14, s80, v16
    v_mfma_f32_16x16x32_bf16 v[112:115], v[68:71], v[48:51], v[112:115]
    ds_read_b64_tr_b16 v[66:67], v7 offset:20992
    v_mfma_f32_16x16x32_bf16 v[116:119], v[68:71], v[52:55], v[116:119]
    v_add_u32 v15, s80, v17
    v_mfma_f32_16x16x32_bf16 v[120:123], v[40:43], v[72:75], v[120:123]
    ds_read_b64_tr_b16 v[68:69], v6 offset:32768
    v_mfma_f32_16x16x32_bf16 v[124:127], v[44:47], v[72:75], v[124:127]
    s_add_u32 s84, s80, s95
    v_mfma_f32_16x16x32_bf16 v[128:131], v[48:51], v[72:75], v[128:131]
    ds_read_b64_tr_b16 v[70:71], v6 offset:33280
    v_mfma_f32_16x16x32_bf16 v[132:135], v[52:55], v[72:75], v[132:135]
    v_add_u32 v18, s84, v16
    v_mfma_f32_16x16x32_bf16 v[252:255], v[60:63], v[72:75], v[252:255]
    s_waitcnt lgkmcnt(6)
    v_mfma_f32_16x16x32_bf16 v[136:139], v[40:43], v[76:79], v[136:139]
    ds_read_b64_tr_b16 v[72:73], v6 offset:36864
    v_mfma_f32_16x16x32_bf16 v[140:143], v[44:47], v[76:79], v[140:143]
    v_add_u32 v19, s84, v17
    v_mfma_f32_16x16x32_bf16 v[144:147], v[48:51], v[76:79], v[144:147]
    ds_read_b64_tr_b16 v[74:75], v6 offset:37376
    v_mfma_f32_16x16x32_bf16 v[148:151], v[52:55], v[76:79], v[148:151]
    s_add_u32 s80, s80, 18432
    s_waitcnt lgkmcnt(6)
    v_mfma_f32_16x16x32_bf16 v[152:155], v[80:83], v[40:43], v[152:155]
    ds_read_b64_tr_b16 v[76:77], v7 offset:32768
    v_mfma_f32_16x16x32_bf16 v[156:159], v[80:83], v[44:47], v[156:159]
    s_cmp_ge_u32 s80, 153600
    s_cselect_b32 s84, 55296, 0
    v_mfma_f32_16x16x32_bf16 v[160:163], v[80:83], v[48:51], v[160:163]
    ds_read_b64_tr_b16 v[78:79], v7 offset:33280
    v_mfma_f32_16x16x32_bf16 v[164:167], v[80:83], v[52:55], v[164:167]
    s_sub_u32 s80, s80, s84
    s_waitcnt lgkmcnt(6)
    v_mfma_f32_16x16x32_bf16 v[168:171], v[64:67], v[40:43], v[168:171]
    ds_read_b64_tr_b16 v[80:81], v7 offset:36864
    v_mfma_f32_16x16x32_bf16 v[172:175], v[64:67], v[44:47], v[172:175]
    v_mfma_f32_16x16x32_bf16 v[176:179], v[64:67], v[48:51], v[176:179]
    ds_read_b64_tr_b16 v[82:83], v7 offset:37376
    v_mfma_f32_16x16x32_bf16 v[180:183], v[64:67], v[52:55], v[180:183]
    s_waitcnt lgkmcnt(6)
    v_mfma_f32_16x16x32_bf16 v[184:187], v[68:71], v[40:43], v[184:187]
    v_mfma_f32_16x16x32_bf16 v[188:191], v[68:71], v[44:47], v[188:191]
    v_mfma_f32_16x16x32_bf16 v[192:195], v[68:71], v[48:51], v[192:195]
    v_mfma_f32_16x16x32_bf16 v[196:199], v[68:71], v[52:55], v[196:199]
    s_waitcnt lgkmcnt(0)
    s_barrier
    v_mfma_f32_16x16x32_bf16 v[200:203], v[72:75], v[40:43], v[200:203]
    ds_read_b64_tr_b16 v[64:65], v4 offset:4096
    v_mfma_f32_16x16x32_bf16 v[204:207], v[72:75], v[44:47], v[204:207]
    ds_read_b64_tr_b16 v[66:67], v4 offset:4608
    v_mfma_f32_16x16x32_bf16 v[208:211], v[72:75], v[48:51], v[208:211]
    ds_read_b128 v[24:27], v14 offset:0
    v_mfma_f32_16x16x32_bf16 v[212:215], v[72:75], v[52:55], v[212:215]
    ds_read_b128 v[28:31], v14 offset:2048
    v_mfma_f32_16x16x32_bf16 v[216:219], v[76:79], v[40:43], v[216:219]
    ds_read_b128 v[32:35], v14 offset:4096
    v_mfma_f32_16x16x32_bf16 v[220:223], v[76:79], v[44:47], v[220:223]
    ds_read_b128 v[36:39], v14 offset:6144
    v_mfma_f32_16x16x32_bf16 v[224:227], v[76:79], v[48:51], v[224:227]
    ds_read_b64_tr_b16 v[68:69], v5 offset:4096
    v_mfma_f32_16x16x32_bf16 v[228:231], v[76:79], v[52:55], v[228:231]
    ds_read_b64_tr_b16 v[70:71], v5 offset:4608
    v_mfma_f32_16x16x32_bf16 v[232:235], v[80:83], v[40:43], v[232:235]
    ds_read_b64_tr_b16 v[72:73], v4 offset:8192
    v_mfma_f32_16x16x32_bf16 v[236:239], v[80:83], v[44:47], v[236:239]
    ds_read_b64_tr_b16 v[74:75], v4 offset:8704
    v_mfma_f32_16x16x32_bf16 v[240:243], v[80:83], v[48:51], v[240:243]
    ds_read_b128 v[56:59], v18
    v_mfma_f32_16x16x32_bf16 v[244:247], v[80:83], v[52:55], v[244:247]
    s_sub_u32 s34, s34, 1
    s_cmp_lg_u32 s34, 0
    s_cbranch_scc1 L_p2
    s_waitcnt lgkmcnt(8)
    v_mfma_f32_16x16x32_bf16 v[88:91], v[64:67], v[24:27], v[88:91]
    ds_read_b64_tr_b16 v[76:77], v5 offset:8192
    s_waitcnt lgkmcnt(8)
    v_mfma_f32_16x16x32_bf16 v[92:95], v[64:67], v[28:31], v[92:95]
    ds_read_b64_tr_b16 v[78:79], v5 offset:8704
    s_waitcnt lgkmcnt(8)
    v_mfma_f32_16x16x32_bf16 v[96:99], v[64:67], v[32:35], v[96:99]
    ds_read_b64_tr_b16 v[80:81], v4 offset:0
    s_waitcnt lgkmcnt(8)
    v_mfma_f32_16x16x32_bf16 v[100:103], v[64:67], v[36:39], v[100:103]
    ds_read_b64_tr_b16 v[82:83], v4 offset:512
    s_waitcnt lgkmcnt(4)
    v_mfma_f32_16x16x32_bf16 v[248:251], v[64:67], v[56:59], v[248:251]
    v_mfma_f32_16x16x32_bf16 v[104:107], v[68:71], v[24:27], v[104:107]
    ds_read_b64_tr_b16 v[64:65], v5 offset:0
    v_mfma_f32_16x16x32_bf16 v[108:111], v[68:71], v[28:31], v[108:111]
    v_mfma_f32_16x16x32_bf16 v[112:115], v[68:71], v[32:35], v[112:115]
    ds_read_b64_tr_b16 v[66:67], v5 offset:512
    v_mfma_f32_16x16x32_bf16 v[116:119], v[68:71], v[36:39], v[116:119]
    v_mfma_f32_16x16x32_bf16 v[120:123], v[24:27], v[72:75], v[120:123]
    ds_read_b64_tr_b16 v[68:69], v4 offset:12288
    v_mfma_f32_16x16x32_bf16 v[124:127], v[28:31], v[72:75], v[124:127]
    v_mfma_f32_16x16x32_bf16 v[128:131], v[32:35], v[72:75], v[128:131]
    ds_read_b64_tr_b16 v[70:71], v4 offset:12800
    v_mfma_f32_16x16x32_bf16 v[132:135], v[36:39], v[72:75], v[132:135]
    v_mfma_f32_16x16x32_bf16 v[252:255], v[56:59], v[72:75], v[252:255]
    s_waitcnt lgkmcnt(6)
    v_mfma_f32_16x16x32_bf16 v[136:139], v[24:27], v[76:79], v[136:139]
    ds_read_b64_tr_b16 v[72:73], v4 offset:16384
    v_mfma_f32_16x16x32_bf16 v[140:143], v[28:31], v[76:79], v[140:143]
    v_mfma_f32_16x16x32_bf16 v[144:147], v[32:35], v[76:79], v[144:147]
    ds_read_b64_tr_b16 v[74:75], v4 offset:16896
    v_mfma_f32_16x16x32_bf16 v[148:151], v[36:39], v[76:79], v[148:151]
    s_waitcnt lgkmcnt(6)
    v_mfma_f32_16x16x32_bf16 v[152:155], v[80:83], v[24:27], v[152:155]
    ds_read_b64_tr_b16 v[76:77], v5 offset:12288
    v_mfma_f32_16x16x32_bf16 v[156:159], v[80:83], v[28:31], v[156:159]
    v_mfma_f32_16x16x32_bf16 v[160:163], v[80:83], v[32:35], v[160:163]
    ds_read_b64_tr_b16 v[78:79], v5 offset:12800
    v_mfma_f32_16x16x32_bf16 v[164:167], v[80:83], v[36:39], v[164:167]
    s_waitcnt lgkmcnt(6)
    v_mfma_f32_16x16x32_bf16 v[168:171], v[64:67], v[24:27], v[168:171]
    ds_read_b64_tr_b16 v[80:81], v5 offset:16384
    v_mfma_f32_16x16x32_bf16 v[172:175], v[64:67], v[28:31], v[172:175]
    v_mfma_f32_16x16x32_bf16 v[176:179], v[64:67], v[32:35], v[176:179]
    ds_read_b64_tr_b16 v[82:83], v5 offset:16896
    v_mfma_f32_16x16x32_bf16 v[180:183], v[64:67], v[36:39], v[180:183]
    s_waitcnt lgkmcnt(6)
    v_mfma_f32_16x16x32_bf16 v[184:187], v[68:71], v[24:27], v[184:187]
    v_mfma_f32_16x16x32_bf16 v[188:191], v[68:71], v[28:31], v[188:191]
    v_mfma_f32_16x16x32_bf16 v[192:195], v[68:71], v[32:35], v[192:195]
    v_mfma_f32_16x16x32_bf16 v[196:199], v[68:71], v[36:39], v[196:199]
    s_waitcnt lgkmcnt(0)
    s_barrier
    v_mfma_f32_16x16x32_bf16 v[200:203], v[72:75], v[24:27], v[200:203]
    ds_read_b64_tr_b16 v[64:65], v4 offset:24576
    v_mfma_f32_16x16x32_bf16 v[204:207], v[72:75], v[28:31], v[204:207]
    ds_read_b64_tr_b16 v[66:67], v4 offset:25088
    v_mfma_f32_16x16x32_bf16 v[208:211], v[72:75], v[32:35], v[208:211]
    ds_read_b128 v[40:43], v15 offset:0
    v_mfma_f32_16x16x32_bf16 v[212:215], v[72:75], v[36:39], v[212:215]
    ds_read_b128 v[44:47], v15 offset:2048
    v_mfma_f32_16x16x32_bf16 v[216:219], v[76:79], v[24:27], v[216:219]
    ds_read_b128 v[48:51], v15 offset:4096
    v_mfma_f32_16x16x32_bf16 v[220:223], v[76:79], v[28:31], v[220:223]
    ds_read_b128 v[52:55], v15 offset:6144
    v_mfma_f32_16x16x32_bf16 v[224:227], v[76:79], v[32:35], v[224:227]
    ds_read_b64_tr_b16 v[68:69], v5 offset:24576
    v_mfma_f32_16x16x32_bf16 v[228:231], v[76:79], v[36:39], v[228:231]
    ds_read_b64_tr_b16 v[70:71], v5 offset:25088
    v_mfma_f32_16x16x32_bf16 v[232:235], v[80:83], v[24:27], v[232:235]
    ds_read_b64_tr_b16 v[72:73], v4 offset:28672
    v_mfma_f32_16x16x32_bf16 v[236:239], v[80:83], v[28:31], v[236:239]
    ds_read_b64_tr_b16 v[74:75], v4 offset:29184
    v_mfma_f32_16x16x32_bf16 v[240:243], v[80:83], v[32:35], v[240:243]
    ds_read_b128 v[60:63], v19
    v_mfma_f32_16x16x32_bf16 v[244:247], v[80:83], v[36:39], v[244:247]
    s_waitcnt lgkmcnt(8)
    v_mfma_f32_16x16x32_bf16 v[88:91], v[64:67], v[40:43], v[88:91]
    ds_read_b64_tr_b16 v[76:77], v5 offset:28672
    s_waitcnt lgkmcnt(8)
    v_mfma_f32_16x16x32_bf16 v[92:95], v[64:67], v[44:47], v[92:95]
    ds_read_b64_tr_b16 v[78:79], v5 offset:29184
    s_waitcnt lgkmcnt(8)
    v_mfma_f32_16x16x32_bf16 v[96:99], v[64:67], v[48:51], v[96:99]
    ds_read_b64_tr_b16 v[80:81], v4 offset:20480
    s_waitcnt lgkmcnt(8)
    v_mfma_f32_16x16x32_bf16 v[100:103], v[64:67], v[52:55], v[100:103]
    ds_read_b64_tr_b16 v[82:83], v4 offset:20992
    s_waitcnt lgkmcnt(4)
    v_mfma_f32_16x16x32_bf16 v[248:251], v[64:67], v[60:63], v[248:251]
    v_mfma_f32_16x16x32_bf16 v[104:107], v[68:71], v[40:43], v[104:107]
    ds_read_b64_tr_b16 v[64:65], v5 offset:20480
    v_mfma_f32_16x16x32_bf16 v[108:111], v[68:71], v[44:47], v[108:111]
    v_add_u32 v14, s80, v16
    v_mfma_f32_16x16x32_bf16 v[112:115], v[68:71], v[48:51], v[112:115]
    ds_read_b64_tr_b16 v[66:67], v5 offset:20992
    v_mfma_f32_16x16x32_bf16 v[116:119], v[68:71], v[52:55], v[116:119]
    v_add_u32 v15, s80, v17
    v_mfma_f32_16x16x32_bf16 v[120:123], v[40:43], v[72:75], v[120:123]
    ds_read_b64_tr_b16 v[68:69], v4 offset:32768
    v_mfma_f32_16x16x32_bf16 v[124:127], v[44:47], v[72:75], v[124:127]
    s_add_u32 s84, s80, s95
    v_mfma_f32_16x16x32_bf16 v[128:131], v[48:51], v[72:75], v[128:131]
    ds_read_b64_tr_b16 v[70:71], v4 offset:33280
    v_mfma_f32_16x16x32_bf16 v[132:135], v[52:55], v[72:75], v[132:135]
    v_add_u32 v18, s84, v16
    v_mfma_f32_16x16x32_bf16 v[252:255], v[60:63], v[72:75], v[252:255]
    s_waitcnt lgkmcnt(6)
    v_mfma_f32_16x16x32_bf16 v[136:139], v[40:43], v[76:79], v[136:139]
    ds_read_b64_tr_b16 v[72:73], v4 offset:36864
    v_mfma_f32_16x16x32_bf16 v[140:143], v[44:47], v[76:79], v[140:143]
    v_add_u32 v19, s84, v17
    v_mfma_f32_16x16x32_bf16 v[144:147], v[48:51], v[76:79], v[144:147]
    ds_read_b64_tr_b16 v[74:75], v4 offset:37376
    v_mfma_f32_16x16x32_bf16 v[148:151], v[52:55], v[76:79], v[148:151]
    s_add_u32 s80, s80, 18432
    s_waitcnt lgkmcnt(6)
    v_mfma_f32_16x16x32_bf16 v[152:155], v[80:83], v[40:43], v[152:155]
    ds_read_b64_tr_b16 v[76:77], v5 offset:32768
    v_mfma_f32_16x16x32_bf16 v[156:159], v[80:83], v[44:47], v[156:159]
    s_cmp_ge_u32 s80, 153600
    s_cselect_b32 s84, 55296, 0
    v_mfma_f32_16x16x32_bf16 v[160:163], v[80:83], v[48:51], v[160:163]
    ds_read_b64_tr_b16 v[78:79], v5 offset:33280
    v_mfma_f32_16x16x32_bf16 v[164:167], v[80:83], v[52:55], v[164:167]
    s_sub_u32 s80, s80, s84
    s_waitcnt lgkmcnt(6)
    v_mfma_f32_16x16x32_bf16 v[168:171], v[64:67], v[40:43], v[168:171]
    ds_read_b64_tr_b16 v[80:81], v5 offset:36864
    v_mfma_f32_16x16x32_bf16 v[172:175], v[64:67], v[44:47], v[172:175]
    v_mfma_f32_16x16x32_bf16 v[176:179], v[64:67], v[48:51], v[176:179]
    ds_read_b64_tr_b16 v[82:83], v5 offset:37376
    v_mfma_f32_16x16x32_bf16 v[180:183], v[64:67], v[52:55], v[180:183]
    s_waitcnt lgkmcnt(6)
    v_mfma_f32_16x16x32_bf16 v[184:187], v[68:71], v[40:43], v[184:187]
    v_mfma_f32_16x16x32_bf16 v[188:191], v[68:71], v[44:47], v[188:191]
    v_mfma_f32_16x16x32_bf16 v[192:195], v[68:71], v[48:51], v[192:195]
    v_mfma_f32_16x16x32_bf16 v[196:199], v[68:71], v[52:55], v[196:199]
    s_waitcnt lgkmcnt(0)
    s_barrier
    v_mfma_f32_16x16x32_bf16 v[200:203], v[72:75], v[40:43], v[200:203]
    ds_read_b64_tr_b16 v[64:65], v6 offset:4096
    v_mfma_f32_16x16x32_bf16 v[204:207], v[72:75], v[44:47], v[204:207]
    ds_read_b64_tr_b16 v[66:67], v6 offset:4608
    v_mfma_f32_16x16x32_bf16 v[208:211], v[72:75], v[48:51], v[208:211]
    ds_read_b128 v[24:27], v14 offset:0
    v_mfma_f32_16x16x32_bf16 v[212:215], v[72:75], v[52:55], v[212:215]
    ds_read_b128 v[28:31], v14 offset:2048
    v_mfma_f32_16x16x32_bf16 v[216:219], v[76:79], v[40:43], v[216:219]
    ds_read_b128 v[32:35], v14 offset:4096
    v_mfma_f32_16x16x32_bf16 v[220:223], v[76:79], v[44:47], v[220:223]
    ds_read_b128 v[36:39], v14 offset:6144
    v_mfma_f32_16x16x32_bf16 v[224:227], v[76:79], v[48:51], v[224:227]
    ds_read_b64_tr_b16 v[68:69], v7 offset:4096
    v_mfma_f32_16x16x32_bf16 v[228:231], v[76:79], v[52:55], v[228:231]
    ds_read_b64_tr_b16 v[70:71], v7 offset:4608
    v_mfma_f32_16x16x32_bf16 v[232:235], v[80:83], v[40:43], v[232:235]
    ds_read_b64_tr_b16 v[72:73], v6 offset:8192
    v_mfma_f32_16x16x32_bf16 v[236:239], v[80:83], v[44:47], v[236:239]
    ds_read_b64_tr_b16 v[74:75], v6 offset:8704
    v_mfma_f32_16x16x32_bf16 v[240:243], v[80:83], v[48:51], v[240:243]
    ds_read_b128 v[56:59], v18
    v_mfma_f32_16x16x32_bf16 v[244:247], v[80:83], v[52:55], v[244:247]
    s_waitcnt lgkmcnt(8)
    v_mfma_f32_16x16x32_bf16 v[88:91], v[64:67], v[24:27], v[88:91]
    ds_read_b64_tr_b16 v[76:77], v7 offset:8192
    s_waitcnt lgkmcnt(8)
    v_mfma_f32_16x16x32_bf16 v[92:95], v[64:67], v[28:31], v[92:95]
    ds_read_b64_tr_b16 v[78:79], v7 offset:8704
    s_waitcnt lgkmcnt(8)
    v_mfma_f32_16x16x32_bf16 v[96:99], v[64:67], v[32:35], v[96:99]
    ds_read_b64_tr_b16 v[80:81], v6 offset:0
    s_waitcnt lgkmcnt(8)
    v_mfma_f32_16x16x32_bf16 v[100:103], v[64:67], v[36:39], v[100:103]
    ds_read_b64_tr_b16 v[82:83], v6 offset:512
    s_waitcnt lgkmcnt(4)
    v_mfma_f32_16x16x32_bf16 v[248:251], v[64:67], v[56:59], v[248:251]
    v_mfma_f32_16x16x32_bf16 v[104:107], v[68:71], v[24:27], v[104:107]
    ds_read_b64_tr_b16 v[64:65], v7 offset:0
    v_mfma_f32_16x16x32_bf16 v[108:111], v[68:71], v[28:31], v[108:111]
    v_mfma_f32_16x16x32_bf16 v[112:115], v[68:71], v[32:35], v[112:115]
    ds_read_b64_tr_b16 v[66:67], v7 offset:512
    v_mfma_f32_16x16x32_bf16 v[116:119], v[68:71], v[36:39], v[116:119]
    v_mfma_f32_16x16x32_bf16 v[120:123], v[24:27], v[72:75], v[120:123]
    ds_read_b64_tr_b16 v[68:69], v6 offset:12288
    v_mfma_f32_16x16x32_bf16 v[124:127], v[28:31], v[72:75], v[124:127]
    v_mfma_f32_16x16x32_bf16 v[128:131], v[32:35], v[72:75], v[128:131]
    ds_read_b64_tr_b16 v[70:71], v6 offset:12800
    v_mfma_f32_16x16x32_bf16 v[132:135], v[36:39], v[72:75], v[132:135]
    v_mfma_f32_16x16x32_bf16 v[252:255], v[56:59], v[72:75], v[252:255]
    s_waitcnt lgkmcnt(6)
    v_mfma_f32_16x16x32_bf16 v[136:139], v[24:27], v[76:79], v[136:139]
L_pad9:
    s_cbranch_execz L_vret1
    ds_read_b64_tr_b16 v[72:73], v6 offset:16384
    v_mfma_f32_16x16x32_bf16 v[140:143], v[28:31], v[76:79], v[140:143]
    v_mfma_f32_16x16x32_bf16 v[144:147], v[32:35], v[76:79], v[144:147]
    ds_read_b64_tr_b16 v[74:75], v6 offset:16896
    v_mfma_f32_16x16x32_bf16 v[148:151], v[36:39], v[76:79], v[148:151]
    s_waitcnt lgkmcnt(6)
    v_mfma_f32_16x16x32_bf16 v[152:155], v[80:83], v[24:27], v[152:155]
    ds_read_b64_tr_b16 v[76:77], v7 offset:12288
    v_mfma_f32_16x16x32_bf16 v[156:159], v[80:83], v[28:31], v[156:159]
    v_mfma_f32_16x16x32_bf16 v[160:163], v[80:83], v[32:35], v[160:163]
    ds_read_b64_tr_b16 v[78:79], v7 offset:12800
    v_mfma_f32_16x16x32_bf16 v[164:167], v[80:83], v[36:39], v[164:167]
    s_waitcnt lgkmcnt(6)
    v_mfma_f32_16x16x32_bf16 v[168:171], v[64:67], v[24:27], v[168:171]
    ds_read_b64_tr_b16 v[80:81], v7 offset:16384
    v_mfma_f32_16x16x32_bf16 v[172:175], v[64:67], v[28:31], v[172:175]
    v_mfma_f32_16x16x32_bf16 v[176:179], v[64:67], v[32:35], v[176:179]
    ds_read_b64_tr_b16 v[82:83], v7 offset:16896
    v_mfma_f32_16x16x32_bf16 v[180:183], v[64:67], v[36:39], v[180:183]
    s_waitcnt lgkmcnt(6)
    v_mfma_f32_16x16x32_bf16 v[184:187], v[68:71], v[24:27], v[184:187]
    v_mfma_f32_16x16x32_bf16 v[188:191], v[68:71], v[28:31], v[188:191]
    v_mfma_f32_16x16x32_bf16 v[192:195], v[68:71], v[32:35], v[192:195]
    v_mfma_f32_16x16x32_bf16 v[196:199], v[68:71], v[36:39], v[196:199]
    s_waitcnt lgkmcnt(0)
    s_barrier
    v_mfma_f32_16x16x32_bf16 v[200:203], v[72:75], v[24:27], v[200:203]
    ds_read_b64_tr_b16 v[64:65], v6 offset:24576
    v_mfma_f32_16x16x32_bf16 v[204:207], v[72:75], v[28:31], v[204:207]
    ds_read_b64_tr_b16 v[66:67], v6 offset:25088
    v_mfma_f32_16x16x32_bf16 v[208:211], v[72:75], v[32:35], v[208:211]
    ds_read_b128 v[40:43], v15 offset:0
    v_mfma_f32_16x16x32_bf16 v[212:215], v[72:75], v[36:39], v[212:215]
    ds_read_b128 v[44:47], v15 offset:2048
    v_mfma_f32_16x16x32_bf16 v[216:219], v[76:79], v[24:27], v[216:219]
    ds_read_b128 v[48:51], v15 offset:4096
    v_mfma_f32_16x16x32_bf16 v[220:223], v[76:79], v[28:31], v[220:223]
    ds_read_b128 v[52:55], v15 offset:6144
    v_mfma_f32_16x16x32_bf16 v[224:227], v[76:79], v[32:35], v[224:227]
    ds_read_b64_tr_b16 v[68:69], v7 offset:24576
    v_mfma_f32_16x16x32_bf16 v[228:231], v[76:79], v[36:39], v[228:231]
    ds_read_b64_tr_b16 v[70:71], v7 offset:25088
    v_mfma_f32_16x16x32_bf16 v[232:235], v[80:83], v[24:27], v[232:235]
    ds_read_b64_tr_b16 v[72:73], v6 offset:28672
    v_mfma_f32_16x16x32_bf16 v[236:239], v[80:83], v[28:31], v[236:239]
    ds_read_b64_tr_b16 v[74:75], v6 offset:29184
    v_mfma_f32_16x16x32_bf16 v[240:243], v[80:83], v[32:35], v[240:243]
    ds_read_b128 v[60:63], v19
    v_mfma_f32_16x16x32_bf16 v[244:247], v[80:83], v[36:39], v[244:247]
    s_waitcnt lgkmcnt(8)
    v_mfma_f32_16x16x32_bf16 v[88:91], v[64:67], v[40:43], v[88:91]
    ds_read_b64_tr_b16 v[76:77], v7 offset:28672
    s_waitcnt lgkmcnt(8)
    v_mfma_f32_16x16x32_bf16 v[92:95], v[64:67], v[44:47], v[92:95]
    ds_read_b64_tr_b16 v[78:79], v7 offset:29184
    s_waitcnt lgkmcnt(8)
    v_mfma_f32_16x16x32_bf16 v[96:99], v[64:67], v[48:51], v[96:99]
    ds_read_b64_tr_b16 v[80:81], v6 offset:20480
    s_waitcnt lgkmcnt(8)
    v_mfma_f32_16x16x32_bf16 v[100:103], v[64:67], v[52:55], v[100:103]
    ds_read_b64_tr_b16 v[82:83], v6 offset:20992
    s_waitcnt lgkmcnt(4)
    v_mfma_f32_16x16x32_bf16 v[248:251], v[64:67], v[60:63], v[248:251]
    v_mfma_f32_16x16x32_bf16 v[104:107], v[68:71], v[40:43], v[104:107]
    ds_read_b64_tr_b16 v[64:65], v7 offset:20480
    v_mfma_f32_16x16x32_bf16 v[108:111], v[68:71], v[44:47], v[108:111]
    v_mfma_f32_16x16x32_bf16 v[112:115], v[68:71], v[48:51], v[112:115]
    ds_read_b64_tr_b16 v[66:67], v7 offset:20992
    v_mfma_f32_16x16x32_bf16 v[116:119], v[68:71], v[52:55], v[116:119]
    v_mfma_f32_16x16x32_bf16 v[120:123], v[40:43], v[72:75], v[120:123]
    ds_read_b64_tr_b16 v[68:69], v6 offset:32768
    v_mfma_f32_16x16x32_bf16 v[124:127], v[44:47], v[72:75], v[124:127]
    v_mfma_f32_16x16x32_bf16 v[128:131], v[48:51], v[72:75], v[128:131]
    ds_read_b64_tr_b16 v[70:71], v6 offset:33280
    v_mfma_f32_16x16x32_bf16 v[132:135], v[52:55], v[72:75], v[132:135]
    v_mfma_f32_16x16x32_bf16 v[252:255], v[60:63], v[72:75], v[252:255]
    s_waitcnt lgkmcnt(6)
    v_mfma_f32_16x16x32_bf16 v[136:139], v[40:43], v[76:79], v[136:139]
    ds_read_b64_tr_b16 v[72:73], v6 offset:36864
    v_mfma_f32_16x16x32_bf16 v[140:143], v[44:47], v[76:79], v[140:143]
    v_mfma_f32_16x16x32_bf16 v[144:147], v[48:51], v[76:79], v[144:147]
    ds_read_b64_tr_b16 v[74:75], v6 offset:37376
    v_mfma_f32_16x16x32_bf16 v[148:151], v[52:55], v[76:79], v[148:151]
    s_waitcnt lgkmcnt(6)
    v_mfma_f32_16x16x32_bf16 v[152:155], v[80:83], v[40:43], v[152:155]
    ds_read_b64_tr_b16 v[76:77], v7 offset:32768
    v_mfma_f32_16x16x32_bf16 v[156:159], v[80:83], v[44:47], v[156:159]
    v_mfma_f32_16x16x32_bf16 v[160:163], v[80:83], v[48:51], v[160:163]
    ds_read_b64_tr_b16 v[78:79], v7 offset:33280
    v_mfma_f32_16x16x32_bf16 v[164:167], v[80:83], v[52:55], v[164:167]
    s_waitcnt lgkmcnt(6)
    v_mfma_f32_16x16x32_bf16 v[168:171], v[64:67], v[40:43], v[168:171]
    ds_read_b64_tr_b16 v[80:81], v7 offset:36864
    v_mfma_f32_16x16x32_bf16 v[172:175], v[64:67], v[44:47], v[172:175]
    v_mfma_f32_16x16x32_bf16 v[176:179], v[64:67], v[48:51], v[176:179]
    ds_read_b64_tr_b16 v[82:83], v7 offset:37376
    v_mfma_f32_16x16x32_bf16 v[180:183], v[64:67], v[52:55], v[180:183]
    s_waitcnt lgkmcnt(6)
    v_mfma_f32_16x16x32_bf16 v[184:187], v[68:71], v[40:43], v[184:187]
    v_mfma_f32_16x16x32_bf16 v[188:191], v[68:71], v[44:47], v[188:191]
    v_mfma_f32_16x16x32_bf16 v[192:195], v[68:71], v[48:51], v[192:195]
    v_mfma_f32_16x16x32_bf16 v[196:199], v[68:71], v[52:55], v[196:199]
    s_waitcnt lgkmcnt(0)
    s_barrier
    v_mfma_f32_16x16x32_bf16 v[200:203], v[72:75], v[40:43], v[200:203]
    v_mfma_f32_16x16x32_bf16 v[204:207], v[72:75], v[44:47], v[204:207]
    v_mfma_f32_16x16x32_bf16 v[208:211], v[72:75], v[48:51], v[208:211]
    v_mfma_f32_16x16x32_bf16 v[212:215], v[72:75], v[52:55], v[212:215]
    v_mfma_f32_16x16x32_bf16 v[216:219], v[76:79], v[40:43], v[216:219]
    v_mfma_f32_16x16x32_bf16 v[220:223], v[76:79], v[44:47], v[220:223]
    v_mfma_f32_16x16x32_bf16 v[224:227], v[76:79], v[48:51], v[224:227]
    v_mfma_f32_16x16x32_bf16 v[228:231], v[76:79], v[52:55], v[228:231]
    v_mfma_f32_16x16x32_bf16 v[232:235], v[80:83], v[40:43], v[232:235]
    v_mfma_f32_16x16x32_bf16 v[236:239], v[80:83], v[44:47], v[236:239]
    v_mfma_f32_16x16x32_bf16 v[240:243], v[80:83], v[48:51], v[240:243]
    v_mfma_f32_16x16x32_bf16 v[244:247], v[80:83], v[52:55], v[244:247]
    s_setprio 0
    s_mov_b32 s76, 0xbdd2d3e8
    v_cvt_pk_bf16_f32 v100, v100, v101
    v_cvt_pk_bf16_f32 v101, v102, v103
    v_cvt_pk_bf16_f32 v102, v116, v117
    v_cvt_pk_bf16_f32 v103, v118, v119
    v_cvt_pk_bf16_f32 v32, v132, v133
    v_cvt_pk_bf16_f32 v33, v134, v135
    v_cvt_pk_bf16_f32 v42, v148, v149
    v_cvt_pk_bf16_f32 v43, v150, v151
    v_cvt_pk_bf16_f32 v44, v248, v249
    v_cvt_pk_bf16_f32 v45, v250, v251
    v_cvt_pk_bf16_f32 v24, v252, v253
    v_cvt_pk_bf16_f32 v25, v254, v255
    s_cmp_lg_u32 s5, 0
    s_cbranch_scc1 L_hx1
    ds_write_b64 v85, v[100:101]
    ds_write_b64 v85, v[102:103] offset:512
    ds_write_b64 v85, v[32:33] offset:1024
    ds_write_b64 v85, v[42:43] offset:1536
    s_branch L_hx2
L_hx1:
    ds_write_b64 v85, v[44:45] offset:2048
    ds_write_b64 v85, v[24:25] offset:2560
L_hx2:
    s_waitcnt lgkmcnt(0)
    v_mul_f32 v80, v184, v184
    v_mul_f32 v81, v185, v185
    v_mul_f32 v82, v186, v186
    v_mul_f32 v83, v187, v187
    v_fma_f32 v80, v80, s76, v84
    v_fma_f32 v81, v81, s76, v84
    v_fma_f32 v82, v82, s76, v84
    v_fma_f32 v83, v83, s76, v84
    v_mul_f32 v80, v80, v184
    v_mul_f32 v81, v81, v185
    v_mul_f32 v82, v82, v186
    v_mul_f32 v83, v83, v187
    v_exp_f32 v80, v80
    v_mul_f32 v184, v184, v200
    v_exp_f32 v81, v81
    v_mul_f32 v185, v185, v201
    v_exp_f32 v82, v82
    v_mul_f32 v186, v186, v202
    v_exp_f32 v83, v83
    v_mul_f32 v187, v187, v203
    v_add_f32 v80, 1.0, v80
    v_add_f32 v81, 1.0, v81
    v_add_f32 v82, 1.0, v82
    v_add_f32 v83, 1.0, v83
    v_rcp_f32 v80, v80
    v_rcp_f32 v81, v81
    v_rcp_f32 v82, v82
    v_rcp_f32 v83, v83
    s_nop 0
    v_mul_f32 v184, v184, v80
    v_mul_f32 v185, v185, v81
    v_mul_f32 v186, v186, v82
    v_mul_f32 v187, v187, v83
    v_cvt_pk_bf16_f32 v184, v184, v185
    v_cvt_pk_bf16_f32 v185, v186, v187
    v_mul_f32 v80, v188, v188
    v_mul_f32 v81, v189, v189
    v_mul_f32 v82, v190, v190
    v_mul_f32 v83, v191, v191
    v_fma_f32 v80, v80, s76, v84
    v_fma_f32 v81, v81, s76, v84
    v_fma_f32 v82, v82, s76, v84
    v_fma_f32 v83, v83, s76, v84
    v_mul_f32 v80, v80, v188
    v_mul_f32 v81, v81, v189
    v_mul_f32 v82, v82, v190
    v_mul_f32 v83, v83, v191
    v_exp_f32 v80, v80
    v_mul_f32 v188, v188, v204
    v_exp_f32 v81, v81
    v_mul_f32 v189, v189, v205
    v_exp_f32 v82, v82
    v_mul_f32 v190, v190, v206
    v_exp_f32 v83, v83
    v_mul_f32 v191, v191, v207
    v_add_f32 v80, 1.0, v80
    v_add_f32 v81, 1.0, v81
    v_add_f32 v82, 1.0, v82
    v_add_f32 v83, 1.0, v83
    v_rcp_f32 v80, v80
    v_rcp_f32 v81, v81
    v_rcp_f32 v82, v82
    s_barrier
    s_cmp_lg_u32 s5, 0
    s_cbranch_scc1 L_hx3
    ds_read_b64 v[46:47], v85 offset:2048
    ds_read_b64 v[34:35], v85 offset:2560
    s_branch L_hx4
L_hx3:
    ds_read_b64 v[44:45], v85 offset:512
    ds_read_b64 v[46:47], v85
    ds_read_b64 v[24:25], v85 offset:1536
    ds_read_b64 v[34:35], v85 offset:1024
L_hx4:
    v_rcp_f32 v83, v83
    s_nop 0
    v_mul_f32 v188, v188, v80
    v_mul_f32 v189, v189, v81
    v_mul_f32 v190, v190, v82
    v_mul_f32 v191, v191, v83
    v_cvt_pk_bf16_f32 v186, v188, v189
    v_cvt_pk_bf16_f32 v187, v190, v191
    s_nop 1
    v_permlane16_swap_b32 v184, v186
    v_permlane16_swap_b32 v185, v187
    buffer_store_dwordx4 v[184:187], v8, s[68:71], s73 offen offset:0 sc1
    v_mul_f32 v80, v192, v192
    v_mul_f32 v81, v193, v193
    v_mul_f32 v82, v194, v194
    v_mul_f32 v83, v195, v195
    v_fma_f32 v80, v80, s76, v84
    v_fma_f32 v81, v81, s76, v84
    v_fma_f32 v82, v82, s76, v84
    v_fma_f32 v83, v83, s76, v84
    v_mul_f32 v80, v80, v192
    v_mul_f32 v81, v81, v193
    v_mul_f32 v82, v82, v194
    v_mul_f32 v83, v83, v195
    v_exp_f32 v80, v80
    v_mul_f32 v192, v192, v208
    v_exp_f32 v81, v81
    v_mul_f32 v193, v193, v209
    v_exp_f32 v82, v82
    v_mul_f32 v194, v194, v210
    v_exp_f32 v83, v83
    v_mul_f32 v195, v195, v211
    v_add_f32 v80, 1.0, v80
    v_add_f32 v81, 1.0, v81
    v_add_f32 v82, 1.0, v82
    v_add_f32 v83, 1.0, v83
    v_rcp_f32 v80, v80
    v_rcp_f32 v81, v81
    v_rcp_f32 v82, v82
    v_rcp_f32 v83, v83
    s_nop 0
    v_mul_f32 v192, v192, v80
    v_mul_f32 v193, v193, v81
    v_mul_f32 v194, v194, v82
    v_mul_f32 v195, v195, v83
    v_cvt_pk_bf16_f32 v192, v192, v193
    v_cvt_pk_bf16_f32 v193, v194, v195
    v_mul_f32 v80, v196, v196
    v_mul_f32 v81, v197, v197
    v_mul_f32 v82, v198, v198
    v_mul_f32 v83, v199, v199
    v_fma_f32 v80, v80, s76, v84
    v_fma_f32 v81, v81, s76, v84
    v_fma_f32 v82, v82, s76, v84
    v_fma_f32 v83, v83, s76, v84
    v_mul_f32 v80, v80, v196
    v_mul_f32 v81, v81, v197
    v_mul_f32 v82, v82, v198
    v_mul_f32 v83, v83, v199
    v_exp_f32 v80, v80
    v_mul_f32 v196, v196, v212
    v_exp_f32 v81, v81
    v_mul_f32 v197, v197, v213
    v_exp_f32 v82, v82
    v_mul_f32 v198, v198, v214
    v_exp_f32 v83, v83
    v_mul_f32 v199, v199, v215
    v_add_f32 v80, 1.0, v80
    s_barrier
    s_waitcnt lgkmcnt(0)
    v_add_f32 v81, 1.0, v81
    v_add_f32 v82, 1.0, v82
    v_add_f32 v83, 1.0, v83
    v_rcp_f32 v80, v80
    v_rcp_f32 v81, v81
    v_rcp_f32 v82, v82
    v_rcp_f32 v83, v83
    s_nop 0
    v_mul_f32 v196, v196, v80
    v_mul_f32 v197, v197, v81
    v_mul_f32 v198, v198, v82
    v_mul_f32 v199, v199, v83
    v_cvt_pk_bf16_f32 v194, v196, v197
    v_cvt_pk_bf16_f32 v195, v198, v199
    s_nop 1
    v_permlane16_swap_b32 v192, v194
    v_permlane16_swap_b32 v193, v195
    buffer_store_dwordx4 v[192:195], v8, s[68:71], s73 offen offset:2048 sc1
    v_mul_f32 v80, v216, v216
    v_mul_f32 v81, v217, v217
    v_mul_f32 v82, v218, v218
    v_mul_f32 v83, v219, v219
    v_fma_f32 v80, v80, s76, v84
    v_fma_f32 v81, v81, s76, v84
    v_fma_f32 v82, v82, s76, v84
    v_fma_f32 v83, v83, s76, v84
    v_mul_f32 v80, v80, v216
    v_mul_f32 v81, v81, v217
    v_mul_f32 v82, v82, v218
    v_mul_f32 v83, v83, v219
    v_exp_f32 v80, v80
    v_mul_f32 v216, v216, v232
    v_exp_f32 v81, v81
    v_mul_f32 v217, v217, v233
    v_exp_f32 v82, v82
    v_mul_f32 v218, v218, v234
    v_exp_f32 v83, v83
    v_mul_f32 v219, v219, v235
    v_add_f32 v80, 1.0, v80
    v_add_f32 v81, 1.0, v81
    v_add_f32 v82, 1.0, v82
    v_add_f32 v83, 1.0, v83
    v_rcp_f32 v80, v80
    v_rcp_f32 v81, v81
    v_rcp_f32 v82, v82
    v_rcp_f32 v83, v83
    s_nop 0
    v_mul_f32 v216, v216, v80
    v_mul_f32 v217, v217, v81
    v_mul_f32 v218, v218, v82
    v_mul_f32 v219, v219, v83
    v_cvt_pk_bf16_f32 v216, v216, v217
    v_cvt_pk_bf16_f32 v217, v218, v219
    v_mul_f32 v80, v220, v220
    v_mul_f32 v81, v221, v221
    v_mul_f32 v82, v222, v222
    v_mul_f32 v83, v223, v223
    v_fma_f32 v80, v80, s76, v84
    v_fma_f32 v81, v81, s76, v84
    v_fma_f32 v82, v82, s76, v84
    v_fma_f32 v83, v83, s76, v84
    v_mul_f32 v80, v80, v220
    v_mul_f32 v81, v81, v221
    v_mul_f32 v82, v82, v222
    v_mul_f32 v83, v83, v223
    v_exp_f32 v80, v80
    v_mul_f32 v220, v220, v236
    v_exp_f32 v81, v81
    s_lshl2_add_u32 s91, s2, s4
    s_lshl_b32 s39, s91, 9
    s_lshr_b32 s92, s91, 2
    s_mul_i32 s92, s92, 7168
    s_and_b32 s91, s91, 3
    s_lshl_b32 s91, s91, 9
    s_add_u32 s92, s92, s91
    s_add_u32 s34, s92, 5120
    s_add_u32 s39, s39, 0x180080
    s_load_dword s94, s[20:21], s39 offset:0x0
    s_load_dword s94, s[20:21], s39 offset:0x40
    s_load_dword s94, s[20:21], s39 offset:0x80
    s_load_dword s94, s[20:21], s39 offset:0xc0
    s_load_dword s94, s[20:21], s39 offset:0x100
    s_barrier
    v_mul_f32 v221, v221, v237
    v_exp_f32 v82, v82
    v_mul_f32 v222, v222, v238
    v_exp_f32 v83, v83
    v_mul_f32 v223, v223, v239
    v_add_f32 v80, 1.0, v80
    v_add_f32 v81, 1.0, v81
    v_add_f32 v82, 1.0, v82
    v_add_f32 v83, 1.0, v83
    v_rcp_f32 v80, v80
    v_rcp_f32 v81, v81
    v_rcp_f32 v82, v82
    v_rcp_f32 v83, v83
    s_nop 0
    v_mul_f32 v220, v220, v80
    v_mul_f32 v221, v221, v81
    v_mul_f32 v222, v222, v82
    v_mul_f32 v223, v223, v83
    v_cvt_pk_bf16_f32 v218, v220, v221
    v_cvt_pk_bf16_f32 v219, v222, v223
    s_nop 1
    v_permlane16_swap_b32 v216, v218
    v_permlane16_swap_b32 v217, v219
    buffer_store_dwordx4 v[216:219], v8, s[68:71], s74 offen offset:0 sc1
    v_mul_f32 v80, v224, v224
    v_mul_f32 v81, v225, v225
    v_mul_f32 v82, v226, v226
    v_mul_f32 v83, v227, v227
    v_fma_f32 v80, v80, s76, v84
    v_fma_f32 v81, v81, s76, v84
    v_fma_f32 v82, v82, s76, v84
    v_fma_f32 v83, v83, s76, v84
    v_mul_f32 v80, v80, v224
    v_mul_f32 v81, v81, v225
    v_mul_f32 v82, v82, v226
    v_mul_f32 v83, v83, v227
    v_exp_f32 v80, v80
    v_mul_f32 v224, v224, v240
    v_exp_f32 v81, v81
    v_mul_f32 v225, v225, v241
    v_exp_f32 v82, v82
    v_mul_f32 v226, v226, v242
    v_exp_f32 v83, v83
    v_mul_f32 v227, v227, v243
    v_add_f32 v80, 1.0, v80
    v_add_f32 v81, 1.0, v81
    v_add_f32 v82, 1.0, v82
    v_add_f32 v83, 1.0, v83
    v_rcp_f32 v80, v80
    v_rcp_f32 v81, v81
    v_rcp_f32 v82, v82
    v_rcp_f32 v83, v83
    s_nop 0
    v_mul_f32 v224, v224, v80
    v_mul_f32 v225, v225, v81
    v_mul_f32 v226, v226, v82
    v_mul_f32 v227, v227, v83
    v_cvt_pk_bf16_f32 v224, v224, v225
    v_cvt_pk_bf16_f32 v225, v226, v227
    v_mul_f32 v80, v228, v228
    v_mul_f32 v81, v229, v229
    v_mul_f32 v82, v230, v230
    v_mul_f32 v83, v231, v231
    v_fma_f32 v80, v80, s76, v84
    v_fma_f32 v81, v81, s76, v84
    v_fma_f32 v82, v82, s76, v84
    v_fma_f32 v83, v83, s76, v84
    s_load_dword s94, s[20:21], s39 offset:0x140
    s_add_u32 s39, s39, 0x27ff80
    s_load_dword s94, s[20:21], s39 offset:0x0
    s_load_dword s94, s[20:21], s39 offset:0x40
    s_load_dword s94, s[20:21], s39 offset:0x80
    s_load_dword s94, s[20:21], s39 offset:0xc0
    s_barrier
    v_mul_f32 v80, v80, v228
    v_mul_f32 v81, v81, v229
    v_mul_f32 v82, v82, v230
    v_mul_f32 v83, v83, v231
    v_exp_f32 v80, v80
    v_mul_f32 v228, v228, v244
    v_exp_f32 v81, v81
    v_mul_f32 v229, v229, v245
    v_exp_f32 v82, v82
    v_mul_f32 v230, v230, v246
    v_exp_f32 v83, v83
    v_mul_f32 v231, v231, v247
    v_add_f32 v80, 1.0, v80
    v_add_f32 v81, 1.0, v81
    v_add_f32 v82, 1.0, v82
    v_add_f32 v83, 1.0, v83
    v_rcp_f32 v80, v80
    v_rcp_f32 v81, v81
    v_rcp_f32 v82, v82
    v_rcp_f32 v83, v83
    s_nop 0
    v_mul_f32 v228, v228, v80
    v_mul_f32 v229, v229, v81
    v_mul_f32 v230, v230, v82
    v_mul_f32 v231, v231, v83
    v_cvt_pk_bf16_f32 v226, v228, v229
    v_cvt_pk_bf16_f32 v227, v230, v231
    s_nop 1
    v_permlane16_swap_b32 v224, v226
    v_permlane16_swap_b32 v225, v227
    buffer_store_dwordx4 v[224:227], v8, s[68:71], s74 offen offset:2048 sc1
    v_lshrrev_b32 v64, 4, v1
    v_and_b32 v66, 14, v1
    v_lshlrev_b32 v64, 2, v64
    v_sub_u32 v64, v66, v64
    v_and_b32 v65, 1, v1
    v_cmp_le_i32 s[40:41], 0, v64
    v_cmp_le_i32 s[42:43], 2, v64
    v_mul_u32_u24 v66, 0x202, v65
    s_mov_b32 s80, 0x01000c0c
    v_lshl_add_u32 v66, v66, 16, s80
    v_add_u32 v67, 0x04040000, v66
    v_cndmask_b32 v76, v66, v67, s[40:41]
    v_cndmask_b32 v77, v66, v67, s[42:43]
    v_lshlrev_b32 v65, 4, v65
    v_mov_b32 v68, 0x0c0c0c0c
    v_mov_b32 v66, 0xc0c0100
    v_alignbit_b32 v66, v66, v66, v65
    v_cndmask_b32 v78, v66, v68, s[40:41]
    v_cndmask_b32 v86, v68, v66, s[40:41]
    v_mov_b32 v66, 0xc0c0302
    v_alignbit_b32 v66, v66, v66, v65
    v_cndmask_b32 v79, v66, v68, s[42:43]
    v_cndmask_b32 v87, v68, v66, s[42:43]
    s_or_b32 s80, s28, s5
    s_cmp_eq_u32 s80, 0
    s_cselect_b64 s[80:81], 0, -1
    s_or_b64 s[40:41], s[40:41], s[80:81]
    s_or_b64 s[42:43], s[42:43], s[80:81]
    v_mov_b32 v7, 0xce6e6b28
    s_mov_b32 s77, 0x3e3504f3
    s_mov_b32 s78, 0x3fb8aa3b
    v_cvt_pk_bf16_f32 v88, v88, v89
    v_cvt_pk_bf16_f32 v89, v90, v91
    v_cvt_pk_bf16_f32 v90, v104, v105
    v_cvt_pk_bf16_f32 v91, v106, v107
    v_cvt_pk_bf16_f32 v152, v152, v153
    v_cvt_pk_bf16_f32 v153, v154, v155
    v_cvt_pk_bf16_f32 v154, v168, v169
    v_cvt_pk_bf16_f32 v155, v170, v171
    v_cvt_pk_bf16_f32 v92, v92, v93
    v_cvt_pk_bf16_f32 v93, v94, v95
    v_cvt_pk_bf16_f32 v94, v108, v109
    v_cvt_pk_bf16_f32 v95, v110, v111
    v_cvt_pk_bf16_f32 v156, v156, v157
    v_cvt_pk_bf16_f32 v157, v158, v159
    v_cvt_pk_bf16_f32 v158, v172, v173
    v_cvt_pk_bf16_f32 v159, v174, v175
    s_load_dword s94, s[20:21], s39 offset:0x100
    s_load_dword s94, s[20:21], s39 offset:0x140
    s_load_dword s94, s[20:21], s39 offset:0x180
    s_load_dword s94, s[20:21], s39 offset:0x1c0
    s_add_u32 s39, s39, 0xffe00000
    s_load_dword s94, s[20:21], s39 offset:0x0
    s_barrier
    s_setprio 3
    v_mfma_f32_16x16x32_bf16 v[48:51], v[44:47], v[152:155], 0
    v_mfma_f32_16x16x32_bf16 v[52:55], v[88:91], v[152:155], 0
    s_setprio 0
    v_cvt_pk_bf16_f32 v96, v96, v97
    v_cvt_pk_bf16_f32 v97, v98, v99
    v_cvt_pk_bf16_f32 v98, v112, v113
    v_cvt_pk_bf16_f32 v99, v114, v115
    v_cvt_pk_bf16_f32 v160, v160, v161
    v_cvt_pk_bf16_f32 v161, v162, v163
    v_cvt_pk_bf16_f32 v162, v176, v177
    v_cvt_pk_bf16_f32 v163, v178, v179
    s_setprio 3
    v_mfma_f32_16x16x32_bf16 v[56:59], v[88:91], v[156:159], 0
    v_mfma_f32_16x16x32_bf16 v[60:63], v[92:95], v[156:159], 0
    s_setprio 0
    v_cvt_pk_bf16_f32 v48, v48, v49
    v_cvt_pk_bf16_f32 v49, v50, v51
    v_cvt_pk_bf16_f32 v50, v52, v53
    v_cvt_pk_bf16_f32 v51, v54, v55
    v_perm_b32 v64, v50, v48, v76
    v_perm_b32 v65, v51, v49, v77
    v_mul_f32 v64, s77, v64
    v_mul_f32 v65, s77, v65
    v_cvt_pk_bf16_f32 v65, v64, v65
    v_lshlrev_b32 v64, 16, v65
    v_and_b32 v65, 0xffff0000, v65
    v_cndmask_b32 v64, v7, v64, s[40:41]
    v_cndmask_b32 v65, v7, v65, s[42:43]
    v_max_f32 v72, v64, v65
    v_cvt_pk_bf16_f32 v164, v164, v165
    v_cvt_pk_bf16_f32 v165, v166, v167
    v_cvt_pk_bf16_f32 v166, v180, v181
    v_cvt_pk_bf16_f32 v167, v182, v183
    s_setprio 3
    v_mfma_f32_16x16x32_bf16 v[48:51], v[92:95], v[160:163], 0
    v_mfma_f32_16x16x32_bf16 v[52:55], v[96:99], v[160:163], 0
    s_setprio 0
    v_cvt_pk_bf16_f32 v56, v56, v57
    v_cvt_pk_bf16_f32 v57, v58, v59
    v_cvt_pk_bf16_f32 v58, v60, v61
    v_cvt_pk_bf16_f32 v59, v62, v63
    v_perm_b32 v66, v58, v56, v76
    v_perm_b32 v67, v59, v57, v77
    v_mul_f32 v66, s77, v66
    v_mul_f32 v67, s77, v67
    v_cvt_pk_bf16_f32 v67, v66, v67
    v_lshlrev_b32 v66, 16, v67
    v_and_b32 v67, 0xffff0000, v67
    v_max_f32 v73, v66, v67
    s_setprio 3
    v_mfma_f32_16x16x32_bf16 v[56:59], v[96:99], v[164:167], 0
    v_mfma_f32_16x16x32_bf16 v[60:63], v[100:103], v[164:167], 0
    s_setprio 0
    v_cvt_pk_bf16_f32 v26, v120, v121
    v_cvt_pk_bf16_f32 v27, v122, v123
    v_cvt_pk_bf16_f32 v36, v136, v137
    v_cvt_pk_bf16_f32 v37, v138, v139
    s_load_dword s94, s[20:21], s39 offset:0x40
    s_load_dword s94, s[20:21], s39 offset:0x80
    s_load_dword s94, s[20:21], s39 offset:0xc0
    s_load_dword s94, s[20:21], s39 offset:0x100
    s_load_dword s94, s[20:21], s39 offset:0x140
    s_barrier
    v_cvt_pk_bf16_f32 v28, v124, v125
    v_cvt_pk_bf16_f32 v29, v126, v127
    v_cvt_pk_bf16_f32 v38, v140, v141
    v_cvt_pk_bf16_f32 v39, v142, v143
    v_cvt_pk_bf16_f32 v30, v128, v129
    v_cvt_pk_bf16_f32 v31, v130, v131
    v_cvt_pk_bf16_f32 v40, v144, v145
    v_cvt_pk_bf16_f32 v41, v146, v147
    v_cvt_pk_bf16_f32 v48, v48, v49
    v_cvt_pk_bf16_f32 v49, v50, v51
    v_cvt_pk_bf16_f32 v50, v52, v53
    v_cvt_pk_bf16_f32 v51, v54, v55
    v_perm_b32 v68, v50, v48, v76
    v_perm_b32 v69, v51, v49, v77
    v_mul_f32 v68, s77, v68
    v_mul_f32 v69, s77, v69
    v_cvt_pk_bf16_f32 v69, v68, v69
    v_lshlrev_b32 v68, 16, v69
    v_and_b32 v69, 0xffff0000, v69
    v_max_f32 v74, v68, v69
    v_cvt_pk_bf16_f32 v56, v56, v57
    v_cvt_pk_bf16_f32 v57, v58, v59
    v_cvt_pk_bf16_f32 v58, v60, v61
    v_cvt_pk_bf16_f32 v59, v62, v63
    v_perm_b32 v70, v58, v56, v76
    v_perm_b32 v71, v59, v57, v77
    v_mul_f32 v70, s77, v70
    v_mul_f32 v71, s77, v71
    v_cvt_pk_bf16_f32 v71, v70, v71
    v_lshlrev_b32 v70, 16, v71
    v_and_b32 v71, 0xffff0000, v71
    v_max_f32 v75, v70, v71
    v_permlane32_swap_b32 v72, v73
    v_max_f32 v72, v72, v73
    v_permlane32_swap_b32 v74, v75
    v_max_f32 v74, v74, v75
    s_nop 1
    v_permlane16_swap_b32 v72, v74
    v_max_f32 v72, v72, v74
    v_mov_b32 v74, v72
    s_nop 1
    v_permlane16_swap_b32 v72, v74
    v_mov_b32 v73, v72
    v_mov_b32 v75, v74
    s_nop 0
    v_permlane32_swap_b32 v72, v73
    v_permlane32_swap_b32 v74, v75
    v_sub_f32 v64, v64, v72
    v_sub_f32 v65, v65, v72
    v_sub_f32 v66, v66, v73
    v_sub_f32 v67, v67, v73
    v_sub_f32 v68, v68, v74
    v_sub_f32 v69, v69, v74
    v_sub_f32 v70, v70, v75
    v_sub_f32 v71, v71, v75
    v_mul_f32 v64, s78, v64
    v_mul_f32 v65, s78, v65
    v_mul_f32 v66, s78, v66
    v_mul_f32 v67, s78, v67
    v_mul_f32 v68, s78, v68
    v_mul_f32 v69, s78, v69
    v_mul_f32 v70, s78, v70
    v_mul_f32 v71, s78, v71
    v_exp_f32 v64, v64
    v_exp_f32 v65, v65
    v_exp_f32 v66, v66
    v_exp_f32 v67, v67
    v_exp_f32 v68, v68
    v_exp_f32 v69, v69
    v_exp_f32 v70, v70
    v_exp_f32 v71, v71
    v_add_f32 v72, v64, v65
    v_add_f32 v73, v66, v67
    s_load_dword s94, s[20:21], s39 offset:0x180
    s_load_dword s94, s[20:21], s39 offset:0x1c0
    s_add_u32 s39, s39, 0x280000
    s_load_dword s94, s[20:21], s39 offset:0x0
    s_load_dword s94, s[20:21], s39 offset:0x40
    s_load_dword s94, s[20:21], s39 offset:0x80
    s_lshl4_add_u32 s91, s28, s29
    s_lshl_b32 s91, s91, 7
    s_add_u32 s92, s91, 0x1ea8000
    s_xor_b32 s91, s91, 17408
    s_add_u32 s91, s91, 0x1ea8000
    v_mov_b32 v23, s92
    v_writelane_b32 v23, s91, 1
    s_mov_b64 exec, 3
    global_load_dwordx3 v[20:22], v23, s[26:27] sc1
    s_mov_b64 exec, -1
    s_barrier
    v_add_f32 v74, v68, v69
    v_add_f32 v75, v70, v71
    v_permlane32_swap_b32 v72, v73
    v_add_f32 v72, v72, v73
    v_permlane32_swap_b32 v74, v75
    v_add_f32 v74, v74, v75
    s_nop 1
    v_permlane16_swap_b32 v72, v74
    v_add_f32 v72, v72, v74
    v_rcp_f32 v72, v72
    s_nop 0
    v_mov_b32 v74, v72
    s_nop 1
    v_permlane16_swap_b32 v72, v74
    v_mov_b32 v73, v72
    v_mov_b32 v75, v74
    s_nop 0
    v_permlane32_swap_b32 v72, v73
    v_permlane32_swap_b32 v74, v75
    v_mul_f32 v64, v64, v72
    v_mul_f32 v65, v65, v72
    v_mul_f32 v66, v66, v73
    v_mul_f32 v67, v67, v73
    v_mul_f32 v68, v68, v74
    v_mul_f32 v69, v69, v74
    v_mul_f32 v70, v70, v75
    v_mul_f32 v71, v71, v75
    v_cvt_pk_bf16_f32 v72, v64, v65
L_pad10:
    s_cbranch_execz L_vret2
    v_cvt_pk_bf16_f32 v73, v66, v67
    v_cvt_pk_bf16_f32 v74, v68, v69
    v_cvt_pk_bf16_f32 v75, v70, v71
    v_perm_b32 v152, v72, v72, v78
    v_perm_b32 v153, v72, v72, v79
    v_perm_b32 v154, v72, v72, v86
    v_perm_b32 v155, v72, v72, v87
    v_perm_b32 v156, v73, v73, v78
    v_perm_b32 v157, v73, v73, v79
    v_perm_b32 v158, v73, v73, v86
    v_perm_b32 v159, v73, v73, v87
    s_setprio 3
    v_mfma_f32_16x16x32_bf16 v[48:51], v[24:27], v[152:155], 0
    v_mfma_f32_16x16x32_bf16 v[52:55], v[34:37], v[152:155], 0
    s_setprio 0
    v_perm_b32 v160, v74, v74, v78
    v_perm_b32 v161, v74, v74, v79
    v_perm_b32 v162, v74, v74, v86
    v_perm_b32 v163, v74, v74, v87
    s_setprio 3
    v_mfma_f32_16x16x32_bf16 v[56:59], v[26:29], v[156:159], 0
    v_mfma_f32_16x16x32_bf16 v[60:63], v[36:39], v[156:159], 0
    s_setprio 0
    v_perm_b32 v164, v75, v75, v78
    v_perm_b32 v165, v75, v75, v79
    v_perm_b32 v166, v75, v75, v86
    v_perm_b32 v167, v75, v75, v87
    v_cvt_pk_bf16_f32 v168, v48, v49
    v_cvt_pk_bf16_f32 v169, v50, v51
    v_cvt_pk_bf16_f32 v170, v52, v53
    v_cvt_pk_bf16_f32 v171, v54, v55
    s_setprio 3
    v_mfma_f32_16x16x32_bf16 v[48:51], v[28:31], v[160:163], 0
    v_mfma_f32_16x16x32_bf16 v[52:55], v[38:41], v[160:163], 0
    s_load_dword s94, s[20:21], s39 offset:0xc0
    s_load_dword s94, s[20:21], s39 offset:0x100
    s_load_dword s94, s[20:21], s39 offset:0x140
    s_load_dword s94, s[20:21], s39 offset:0x180
    s_load_dword s94, s[20:21], s39 offset:0x1c0
    s_waitcnt vmcnt(1)
    s_barrier
    s_lshl1_add_u32 m0, s33, 81920
    s_nop 0
    buffer_load_dwordx4 v11, s[60:63], s83 offen lds
    s_setprio 0
    v_cvt_pk_bf16_f32 v172, v56, v57
    v_cvt_pk_bf16_f32 v173, v58, v59
    v_cvt_pk_bf16_f32 v174, v60, v61
    v_cvt_pk_bf16_f32 v175, v62, v63
    s_setprio 3
    v_mfma_f32_16x16x32_bf16 v[56:59], v[30:33], v[164:167], 0
    v_mfma_f32_16x16x32_bf16 v[60:63], v[40:43], v[164:167], 0
    s_setprio 0
    v_permlane16_swap_b32 v168, v170
    v_permlane16_swap_b32 v169, v171
    buffer_store_dwordx4 v[168:171], v0, s[68:71], s75 offen offset:0 sc1
    v_permlane16_swap_b32 v172, v174
    v_permlane16_swap_b32 v173, v175
    buffer_store_dwordx4 v[172:175], v0, s[68:71], s75 offen offset:1024 sc1
    s_lshl1_add_u32 m0, s33, 82944
    s_nop 0
    buffer_load_dwordx4 v12, s[60:63], s83 offen lds
    v_cvt_pk_bf16_f32 v176, v48, v49
    v_cvt_pk_bf16_f32 v177, v50, v51
    v_cvt_pk_bf16_f32 v178, v52, v53
    v_cvt_pk_bf16_f32 v179, v54, v55
    v_cvt_pk_bf16_f32 v180, v56, v57
    v_cvt_pk_bf16_f32 v181, v58, v59
    v_cvt_pk_bf16_f32 v182, v60, v61
    v_cvt_pk_bf16_f32 v183, v62, v63
    v_permlane16_swap_b32 v176, v178
    v_permlane16_swap_b32 v177, v179
    buffer_store_dwordx4 v[176:179], v0, s[68:71], s75 offen offset:2048 sc1
    v_permlane16_swap_b32 v180, v182
    v_permlane16_swap_b32 v181, v183
    buffer_store_dwordx4 v[180:183], v0, s[68:71], s75 offen offset:3072 sc1
    v_lshrrev_b32 v64, 4, v1
    v_bfe_u32 v65, v1, 2, 2
    v_and_b32 v66, 3, v1
    v_and_b32 v67, 15, v1
    v_lshrrev_b32 v68, 3, v1
    v_and_b32 v69, 7, v1
    s_lshl_b32 s85, s6, 2
    v_lshl_add_u32 v70, v64, 3, v65
    v_lshlrev_b32 v70, 7, v70
    s_lshl1_add_u32 m0, s33, 90112
    s_nop 0
    buffer_load_dwordx4 v11, s[64:67], s83 offen lds
    v_and_b32 v71, 1, v66
    v_lshl_add_u32 v70, v71, 3, v70
    v_add_u32 v70, 0, v70
    v_and_b32 v71, 2, v65
    v_and_b32 v72, 1, v64
    v_lshl_add_u32 v71, v72, 2, v71
    v_lshrrev_b32 v72, 1, v66
    v_xor_b32 v71, v71, v72
    v_xor_b32 v71, s85, v71
    v_xor_b32 v72, 0, v71
    v_lshl_add_u32 v80, v72, 4, v70
    v_add_u32 v82, 49152, v80
    v_add_u32 v84, 98304, v80
    v_xor_b32 v72, 2, v71
    v_lshl_add_u32 v81, v72, 4, v70
    v_add_u32 v83, 49152, v81
    s_lshl1_add_u32 m0, s33, 91136
    s_nop 0
    buffer_load_dwordx4 v12, s[64:67], s83 offen lds
    s_add_u32 s83, s83, 131072
    v_add_u32 v85, 98304, v81
    s_lshl_b32 s85, s5, 12
    v_lshl_add_u32 v48, v1, 4, s85
    v_add_u32 v49, 49152, v48
    v_add_u32 v50, 98304, v48
    v_mov_b32 v88, 0
    v_mov_b32 v89, 0
    v_mov_b32 v90, 0
    v_mov_b32 v91, 0
    v_mov_b32 v92, 0
    v_mov_b32 v93, 0
    v_mov_b32 v94, 0
    v_mov_b32 v95, 0
    v_mov_b32 v96, 0
    v_mov_b32 v97, 0
    v_mov_b32 v98, 0
    v_mov_b32 v99, 0
    v_mov_b32 v100, 0
    v_mov_b32 v101, 0
    v_mov_b32 v102, 0
    v_mov_b32 v103, 0
    v_mov_b32 v104, 0
    v_mov_b32 v105, 0
    v_mov_b32 v106, 0
    v_mov_b32 v107, 0
    s_load_dword s94, s[20:21], s39 offset:0x80000
    s_load_dword s94, s[20:21], s39 offset:0x80040
    s_load_dword s94, s[20:21], s39 offset:0x80080
    s_load_dword s94, s[20:21], s39 offset:0x800c0
    s_load_dword s94, s[20:21], s39 offset:0x80100
    s_cmp_lg_u32 s4, 0
    s_cbranch_scc1 L_fH2
    s_lshl_b32 s91, s28, 4
    s_add_u32 s91, s91, s29
    s_lshl_b32 s91, s91, 7
    s_add_u32 s91, s91, 0x1e90000
    v_mov_b32 v16, s91
    v_mov_b32 v18, s100
    v_mov_b32 v19, s101
    s_mov_b64 exec, 1
    global_store_dwordx2 v16, v[18:19], s[26:27] sc1
    s_mov_b64 exec, -1
L_fH2:
    s_waitcnt vmcnt(8)
    s_mov_b64 exec, 3
    s_movk_i32 s98, 0x4000
L_pT_chk:
    v_cmp_ne_u64 vcc, s[100:101], v[20:21]
    s_nop 1
    s_cmp_eq_u64 vcc, 0
    s_cbranch_scc1 L_pT_ok
    s_sub_u32 s98, s98, 1
    s_cbranch_scc1 L_pT_ok
    s_sleep 1
    global_load_dwordx3 v[20:22], v23, s[26:27] sc1
    s_waitcnt vmcnt(0)
    s_branch L_pT_chk
L_pT_ok:
    s_mov_b64 exec, -1
    v_readlane_b32 s90, v22, 0
    v_readlane_b32 s91, v22, 1
    s_nop 1
    s_sub_u32 s90, s91, s90
    s_abs_i32 s91, s90
    s_min_u32 s91, s91, 0x1000
    s_add_u32 s91, s91, 35
    s_mul_i32 s91, s91, 937
    s_lshr_b32 s91, s91, 16
    s_min_u32 s91, s91, 4
    s_sub_u32 s92, 0, s91
    s_cmp_lt_i32 s90, 0
    s_cselect_b32 s91, s92, s91
    s_add_u32 s50, s91, 4
    s_and_b32 s91, s91, 3
    s_mov_b32 s46, 0x58458458
    s_mov_b32 s47, 0x4584584
    s_cmp_eq_u32 s91, 1
    s_cselect_b32 s46, 0xc22c22c4, s46
    s_cselect_b32 s47, 0x22c22c22, s47
    s_cmp_eq_u32 s91, 2
    s_cselect_b32 s46, 0x116222c4, s46
    s_cselect_b32 s47, 0x16116116, s47
    s_cmp_eq_u32 s91, 3
    s_cselect_b32 s46, 0x116222c4, s46
    s_cselect_b32 s47, 0x308b08b1, s47
    s_movk_i32 s44, 0x4000
    s_mov_b32 s45, 131072
    s_barrier
    s_lshl_b32 s48, s46, 15
    s_and_b32 s48, s48, 0x38000
    s_lshr_b64 s[46:47], s[46:47], 3
    s_lshl2_add_u32 m0, s33, s48
    s_lshl1_add_u32 s49, s33, s48
    buffer_load_dwordx4 v10, s[56:59], s82 offen offset:0 sc1 lds
    v_mov_b32 v108, 0
    v_mov_b32 v109, 0
    v_mov_b32 v110, 0
    v_mov_b32 v111, 0
    v_mov_b32 v112, 0
    v_mov_b32 v113, 0
    v_mov_b32 v114, 0
    v_mov_b32 v115, 0
    v_mov_b32 v116, 0
    v_mov_b32 v117, 0
    v_mov_b32 v118, 0
    v_mov_b32 v119, 0
    s_lshl_b32 s84, s4, 12
    s_add_u32 s84, s84, 147456
    v_lshl_add_u32 v3, v1, 3, s84
    v_lshrrev_b32 v70, 1, v64
    v_xor_b32 v70, v70, v65
    v_lshl_add_u32 v70, v70, 4, s84
    buffer_load_dwordx4 v10, s[56:59], s82 offen offset:1024 sc1 lds
    v_lshl_add_u32 v70, v67, 6, v70
    v_and_b32 v71, 1, v64
    v_lshl_add_u32 v14, v71, 3, v70
    v_xor_b32 v15, 32, v14
    v_xor_b32 v70, v66, v64
    v_lshl_add_u32 v70, v70, 4, s84
    v_lshrrev_b32 v71, 2, v1
    v_lshl_add_u32 v17, v71, 6, v70
    buffer_load_dwordx4 v10, s[56:59], s82 offen offset:2048 sc1 lds
    s_lshl_b32 s85, s4, 12
    v_lshl_add_u32 v72, v1, 4, s85
    s_lshl_b32 s85, s4, 4
    v_and_b32 v70, 2, v68
    v_xor_b32 v70, v70, v69
    v_xor_b32 v70, 0, v70
    v_add_u32 v71, s85, v68
    v_mul_u32_u24 v71, 2048, v71
    v_lshl_add_u32 v4, v70, 4, v71
    s_add_u32 s85, s85, 8
    v_and_b32 v70, 2, v68
    buffer_load_dwordx4 v10, s[56:59], s82 offen offset:3072 sc1 lds
    s_add_u32 s82, s82, s44
    v_xor_b32 v70, v70, v69
    v_xor_b32 v70, 4, v70
    v_add_u32 v71, s85, v68
    v_mul_u32_u24 v71, 2048, v71
    v_lshl_add_u32 v5, v70, 4, v71
    s_and_b32 s85, s31, 3
    s_lshl1_add_u32 s85, s85, s32
    s_cmp_eq_u32 s85, 3
    s_cselect_b64 vcc, -1, 0
    s_lshl_b32 s85, s4, 11
    v_lshl_add_u32 v70, v1, 4, s85
    v_add_u32 v71, 1024, v70
    s_add_u32 m0, s49, 16384
    s_nop 0
    buffer_load_dwordx4 v11, s[60:63], s83 offen lds
    v_cndmask_b32 v4, v4, v70, vcc
    v_cndmask_b32 v5, v5, v71, vcc
    s_mov_b32 s72, s8
    s_mov_b32 s73, s9
    s_mov_b32 s74, 0x400000
    s_mov_b32 s75, 0x20000
    s_add_u32 m0, s49, 17408
    s_nop 0
    buffer_load_dwordx4 v12, s[60:63], s83 offen lds
    s_add_u32 m0, s49, 24576
    s_nop 0
    buffer_load_dwordx4 v11, s[64:67], s83 offen lds
    s_add_u32 m0, s49, 25600
    s_nop 0
    buffer_load_dwordx4 v12, s[64:67], s83 offen lds
    s_add_u32 s83, s83, s45
    s_load_dword s94, s[20:21], s39 offset:0x80140
    s_load_dword s94, s[20:21], s39 offset:0x80180
    s_load_dword s94, s[20:21], s39 offset:0x801c0
    s_add_u32 s39, s39, 0x180000
    s_load_dword s94, s[20:21], s39 offset:0x0
    s_load_dword s94, s[20:21], s39 offset:0x40
    s_barrier
    s_lshl_b32 s48, s46, 15
    s_and_b32 s48, s48, 0x38000
    s_lshr_b64 s[46:47], s[46:47], 3
    s_lshl2_add_u32 m0, s33, s48
    s_lshl1_add_u32 s49, s33, s48
    buffer_load_dwordx4 v10, s[56:59], s82 offen offset:0 sc1 lds
    buffer_load_dwordx4 v10, s[56:59], s82 offen offset:1024 sc1 lds
    buffer_load_dwordx4 v10, s[56:59], s82 offen offset:2048 sc1 lds
    buffer_load_dwordx4 v10, s[56:59], s82 offen offset:3072 sc1 lds
    s_add_u32 s82, s82, s44
    s_add_u32 m0, s49, 16384
    s_nop 0
    buffer_load_dwordx4 v11, s[60:63], s83 offen lds
    s_add_u32 m0, s49, 17408
    s_nop 0
    buffer_load_dwordx4 v12, s[60:63], s83 offen lds
    s_add_u32 m0, s49, 24576
    s_nop 0
    buffer_load_dwordx4 v11, s[64:67], s83 offen lds
    s_add_u32 m0, s49, 25600
    s_nop 0
    buffer_load_dwordx4 v12, s[64:67], s83 offen lds
    s_add_u32 s83, s83, s45
    s_load_dword s94, s[20:21], s39 offset:0x80
    s_load_dword s94, s[20:21], s39 offset:0xc0
    s_load_dword s94, s[20:21], s39 offset:0x100
    s_load_dword s94, s[20:21], s39 offset:0x140
    s_load_dword s94, s[20:21], s39 offset:0x180
    s_waitcnt vmcnt(16)
    s_barrier
    s_lshl_b32 s48, s46, 15
    s_and_b32 s48, s48, 0x38000
    s_lshr_b64 s[46:47], s[46:47], 3
    s_lshl2_add_u32 m0, s33, s48
    s_lshl1_add_u32 s49, s33, s48
    buffer_load_dwordx4 v10, s[56:59], s82 offen offset:0 sc1 lds
    buffer_load_dwordx4 v10, s[56:59], s82 offen offset:1024 sc1 lds
    buffer_load_dwordx4 v10, s[56:59], s82 offen offset:2048 sc1 lds
    buffer_load_dwordx4 v10, s[56:59], s82 offen offset:3072 sc1 lds
    s_add_u32 s82, s82, s44
    s_add_u32 m0, s49, 16384
    s_nop 0
    buffer_load_dwordx4 v11, s[60:63], s83 offen lds
    s_add_u32 m0, s49, 17408
    s_nop 0
    buffer_load_dwordx4 v12, s[60:63], s83 offen lds
    s_add_u32 m0, s49, 24576
    s_nop 0
    buffer_load_dwordx4 v11, s[64:67], s83 offen lds
    s_add_u32 m0, s49, 25600
    s_nop 0
    buffer_load_dwordx4 v12, s[64:67], s83 offen lds
    s_add_u32 s83, s83, s45
    s_load_dword s94, s[20:21], s39 offset:0x1c0
    s_add_u32 s39, s39, 0xfff80000
    s_load_dword s94, s[20:21], s39 offset:0x0
    s_load_dword s94, s[20:21], s39 offset:0x40
    s_load_dword s94, s[20:21], s39 offset:0x80
    s_load_dword s94, s[20:21], s39 offset:0xc0
    s_waitcnt vmcnt(16)
    s_barrier
    s_lshl_b32 s48, s46, 15
    s_and_b32 s48, s48, 0x38000
    s_lshr_b64 s[46:47], s[46:47], 3
    s_lshl2_add_u32 m0, s33, s48
    s_lshl1_add_u32 s49, s33, s48
    buffer_load_dwordx4 v10, s[56:59], s82 offen offset:0 sc1 lds
    buffer_load_dwordx4 v10, s[56:59], s82 offen offset:1024 sc1 lds
    buffer_load_dwordx4 v10, s[56:59], s82 offen offset:2048 sc1 lds
    buffer_load_dwordx4 v10, s[56:59], s82 offen offset:3072 sc1 lds
    s_add_u32 s82, s82, s44
    s_add_u32 m0, s49, 16384
    s_nop 0
    buffer_load_dwordx4 v11, s[60:63], s83 offen lds
    s_add_u32 m0, s49, 17408
    s_nop 0
    buffer_load_dwordx4 v12, s[60:63], s83 offen lds
    s_add_u32 m0, s49, 24576
    s_nop 0
    buffer_load_dwordx4 v11, s[64:67], s83 offen lds
    s_add_u32 m0, s49, 25600
    s_nop 0
    buffer_load_dwordx4 v12, s[64:67], s83 offen lds
    s_add_u32 s83, s83, s45
    s_load_dword s94, s[20:21], s39 offset:0x100
    s_load_dword s94, s[20:21], s39 offset:0x140
    s_load_dword s94, s[20:21], s39 offset:0x180
    s_load_dword s94, s[20:21], s39 offset:0x1c0
    s_add_u32 s39, s39, 0x100000
    s_load_dword s94, s[20:21], s39 offset:0x0
    s_waitcnt vmcnt(16)
    s_barrier
    s_lshl_b32 s48, s46, 15
    s_and_b32 s48, s48, 0x38000
    s_lshr_b64 s[46:47], s[46:47], 3
    s_lshl2_add_u32 m0, s33, s48
    s_lshl1_add_u32 s49, s33, s48
    buffer_load_dwordx4 v10, s[56:59], s82 offen offset:0 sc1 lds
    buffer_load_dwordx4 v10, s[56:59], s82 offen offset:1024 sc1 lds
    buffer_load_dwordx4 v10, s[56:59], s82 offen offset:2048 sc1 lds
    buffer_load_dwordx4 v10, s[56:59], s82 offen offset:3072 sc1 lds
    s_add_u32 s82, s82, s44
    s_add_u32 m0, s49, 16384
    s_nop 0
    buffer_load_dwordx4 v11, s[60:63], s83 offen lds
    s_add_u32 m0, s49, 17408
    s_nop 0
    buffer_load_dwordx4 v12, s[60:63], s83 offen lds
    s_add_u32 m0, s49, 24576
    s_nop 0
    buffer_load_dwordx4 v11, s[64:67], s83 offen lds
    s_add_u32 m0, s49, 25600
    s_nop 0
    buffer_load_dwordx4 v12, s[64:67], s83 offen lds
    s_add_u32 s83, s83, s45
    s_load_dword s94, s[20:21], s39 offset:0x40
    s_load_dword s94, s[20:21], s39 offset:0x80
    s_load_dword s94, s[20:21], s39 offset:0xc0
    s_load_dword s94, s[20:21], s39 offset:0x100
    s_load_dword s94, s[20:21], s39 offset:0x140
    s_waitcnt vmcnt(42)
    s_waitcnt vmcnt(16)
    s_barrier
    s_lshl_b32 s48, s46, 15
    s_and_b32 s48, s48, 0x38000
    s_lshr_b64 s[46:47], s[46:47], 3
    s_lshl2_add_u32 m0, s33, s48
    s_lshl1_add_u32 s49, s33, s48
    buffer_load_dwordx4 v10, s[56:59], s82 offen offset:0 sc1 lds
    buffer_load_dwordx4 v10, s[56:59], s82 offen offset:1024 sc1 lds
    buffer_load_dwordx4 v10, s[56:59], s82 offen offset:2048 sc1 lds
    buffer_load_dwordx4 v10, s[56:59], s82 offen offset:3072 sc1 lds
    s_add_u32 s82, s82, s44
    s_add_u32 m0, s49, 16384
    s_nop 0
    buffer_load_dwordx4 v11, s[60:63], s83 offen lds
    s_add_u32 m0, s49, 17408
    s_nop 0
    buffer_load_dwordx4 v12, s[60:63], s83 offen lds
    s_add_u32 m0, s49, 24576
    s_nop 0
    buffer_load_dwordx4 v11, s[64:67], s83 offen lds
    s_add_u32 m0, s49, 25600
    s_nop 0
    buffer_load_dwordx4 v12, s[64:67], s83 offen lds
    s_add_u32 s83, s83, s45
    s_load_dword s94, s[20:21], s39 offset:0x180
    s_load_dword s94, s[20:21], s39 offset:0x1c0
    s_add_u32 s39, s39, 0xff980000
    s_load_dword s94, s[12:13], s39 offset:0x0
    s_load_dword s94, s[12:13], s39 offset:0x40
    s_load_dword s94, s[12:13], s39 offset:0x80
    s_lshl2_add_u32 s91, s30, s4
    s_lshl_b32 s91, s91, 9
    s_add_u32 s91, s91, 0x1e90000
    v_lshl_add_u32 v20, v1, 7, s91
    s_mov_b64 exec, 15
    global_load_dwordx2 v[22:23], v20, s[26:27] sc1
    s_mov_b64 exec, -1
    s_cmp_lg_u32 s4, 0
    s_cbranch_scc1 L_fO
    s_lshl_b32 s91, s28, 4
    s_add_u32 s91, s91, s29
    s_lshl_b32 s91, s91, 7
    s_add_u32 s91, s91, 0x1e98000
    v_mov_b32 v16, s91
    v_mov_b32 v18, s100
    v_mov_b32 v19, s101
    s_mov_b64 exec, 1
    global_store_dwordx2 v16, v[18:19], s[26:27] sc1
    s_mov_b64 exec, -1
L_fO:
    s_waitcnt vmcnt(17)
    s_barrier
    s_lshl_b32 s48, s46, 15
    s_and_b32 s48, s48, 0x38000
    s_lshr_b64 s[46:47], s[46:47], 3
    s_lshl2_add_u32 m0, s33, s48
    s_lshl1_add_u32 s49, s33, s48
    buffer_load_dwordx4 v10, s[56:59], s82 offen offset:0 sc1 lds
    buffer_load_dwordx4 v10, s[56:59], s82 offen offset:1024 sc1 lds
    buffer_load_dwordx4 v10, s[56:59], s82 offen offset:2048 sc1 lds
    buffer_load_dwordx4 v10, s[56:59], s82 offen offset:3072 sc1 lds
    s_add_u32 s82, s82, s44
    s_add_u32 m0, s49, 16384
    s_nop 0
    buffer_load_dwordx4 v11, s[60:63], s83 offen lds
    s_add_u32 m0, s49, 17408
    s_nop 0
    buffer_load_dwordx4 v12, s[60:63], s83 offen lds
    s_add_u32 m0, s49, 24576
    s_nop 0
    buffer_load_dwordx4 v11, s[64:67], s83 offen lds
    s_add_u32 m0, s49, 25600
    s_nop 0
    buffer_load_dwordx4 v12, s[64:67], s83 offen lds
    s_add_u32 s83, s83, s45
    s_load_dword s94, s[12:13], s39 offset:0xc0
    s_load_dword s94, s[12:13], s39 offset:0x100
    s_load_dword s94, s[12:13], s39 offset:0x140
    s_load_dword s94, s[12:13], s39 offset:0x180
    s_load_dword s94, s[12:13], s39 offset:0x1c0
    s_waitcnt vmcnt(17)
    s_barrier
    s_lshl_b32 s48, s46, 15
    s_and_b32 s48, s48, 0x38000
    s_lshr_b64 s[46:47], s[46:47], 3
    s_lshl2_add_u32 m0, s33, s48
    s_lshl1_add_u32 s49, s33, s48
    buffer_load_dwordx4 v10, s[56:59], s82 offen offset:0 sc1 lds
    buffer_load_dwordx4 v10, s[56:59], s82 offen offset:1024 sc1 lds
    buffer_load_dwordx4 v10, s[56:59], s82 offen offset:2048 sc1 lds
    buffer_load_dwordx4 v10, s[56:59], s82 offen offset:3072 sc1 lds
    s_add_u32 s82, s82, s44
    s_add_u32 m0, s49, 16384
    s_nop 0
    buffer_load_dwordx4 v11, s[60:63], s83 offen lds
    s_add_u32 m0, s49, 17408
    s_nop 0
    buffer_load_dwordx4 v12, s[60:63], s83 offen lds
    s_add_u32 m0, s49, 24576
    s_nop 0
    buffer_load_dwordx4 v11, s[64:67], s83 offen lds
    s_add_u32 m0, s49, 25600
    s_nop 0
    buffer_load_dwordx4 v12, s[64:67], s83 offen lds
    s_add_u32 s83, s83, s45
    s_load_dword s94, s[12:13], s39 offset:0x80000
    s_load_dword s94, s[12:13], s39 offset:0x80040
    s_load_dword s94, s[12:13], s39 offset:0x80080
    s_load_dword s94, s[12:13], s39 offset:0x800c0
    s_load_dword s94, s[12:13], s39 offset:0x80100
    s_waitcnt vmcnt(16)
    s_mov_b64 exec, 15
    s_movk_i32 s98, 0x4000
L_pH2_chk:
    v_cmp_ne_u64 vcc, s[100:101], v[22:23]
    s_nop 1
    s_cmp_eq_u64 vcc, 0
    s_cbranch_scc1 L_pH2_ok
    s_sub_u32 s98, s98, 1
    s_cbranch_scc1 L_pH2_ok
    s_sleep 1
    global_load_dwordx2 v[22:23], v20, s[26:27] sc1
    s_waitcnt vmcnt(0)
    s_branch L_pH2_chk
L_pH2_ok:
    s_mov_b64 exec, -1
    s_add_u32 s82, s82, s14
    s_add_u32 s83, s83, s35
    s_cmp_lg_u32 s32, 0
    s_cselect_b32 s44, 0xffffc000, s44
    s_lshl_b32 s45, s44, 3
    s_waitcnt vmcnt(17)
    s_barrier
    s_cmp_eq_u32 s50, 0
    s_cbranch_scc1 L_bl_end
L_bl:
    s_lshl_b32 s48, s46, 15
    s_and_b32 s48, s48, 0x38000
    s_lshr_b64 s[46:47], s[46:47], 3
    s_lshl2_add_u32 m0, s33, s48
    s_lshl1_add_u32 s49, s33, s48
    buffer_load_dwordx4 v10, s[56:59], s82 offen offset:0 sc1 lds
    buffer_load_dwordx4 v10, s[56:59], s82 offen offset:1024 sc1 lds
    buffer_load_dwordx4 v10, s[56:59], s82 offen offset:2048 sc1 lds
    buffer_load_dwordx4 v10, s[56:59], s82 offen offset:3072 sc1 lds
    s_add_u32 s82, s82, s44
    s_add_u32 m0, s49, 16384
    s_nop 0
    buffer_load_dwordx4 v11, s[60:63], s83 offen lds
    s_add_u32 m0, s49, 17408
    s_nop 0
    buffer_load_dwordx4 v12, s[60:63], s83 offen lds
    s_add_u32 m0, s49, 24576
    s_nop 0
    buffer_load_dwordx4 v11, s[64:67], s83 offen lds
    s_add_u32 m0, s49, 25600
    s_nop 0
    buffer_load_dwordx4 v12, s[64:67], s83 offen lds
    s_add_u32 s83, s83, s45
    s_sub_u32 s50, s50, 1
    s_cmp_lg_u32 s50, 0
    s_waitcnt vmcnt(16)
    s_barrier
    s_cbranch_scc1 L_bl
L_bl_end:
    s_lshl_b32 m0, s33, 2
    s_nop 0
    buffer_load_dwordx4 v10, s[56:59], s82 offen offset:0 sc1 lds
    buffer_load_dwordx4 v10, s[56:59], s82 offen offset:1024 sc1 lds
    buffer_load_dwordx4 v10, s[56:59], s82 offen offset:2048 sc1 lds
    buffer_load_dwordx4 v10, s[56:59], s82 offen offset:3072 sc1 lds
    s_add_u32 s82, s82, s44
    s_lshl1_add_u32 m0, s33, 16384
    s_nop 0
    buffer_load_dwordx4 v11, s[60:63], s83 offen lds
    s_lshl1_add_u32 m0, s33, 17408
    s_nop 0
    buffer_load_dwordx4 v12, s[60:63], s83 offen lds
    s_lshl1_add_u32 m0, s33, 24576
    s_nop 0
    buffer_load_dwordx4 v11, s[64:67], s83 offen lds
    s_lshl1_add_u32 m0, s33, 25600
    s_nop 0
    buffer_load_dwordx4 v12, s[64:67], s83 offen lds
    s_add_u32 s83, s83, s45
    s_load_dword s94, s[12:13], s39 offset:0x80140
    s_load_dword s94, s[12:13], s39 offset:0x80180
    s_load_dword s94, s[12:13], s39 offset:0x801c0
    s_add_u32 s39, s39, 0x100000
    s_load_dword s94, s[12:13], s39 offset:0x0
    s_load_dword s94, s[12:13], s39 offset:0x40
    s_waitcnt vmcnt(16)
    s_barrier
    s_lshl2_add_u32 m0, s33, 98304
    s_nop 0
    buffer_load_dwordx4 v10, s[56:59], s82 offen offset:0 sc1 lds
    buffer_load_dwordx4 v10, s[56:59], s82 offen offset:1024 sc1 lds
    buffer_load_dwordx4 v10, s[56:59], s82 offen offset:2048 sc1 lds
    buffer_load_dwordx4 v10, s[56:59], s82 offen offset:3072 sc1 lds
    s_add_u32 s82, s82, s44
    s_lshl1_add_u32 m0, s33, 114688
    s_nop 0
    buffer_load_dwordx4 v11, s[60:63], s83 offen lds
    s_lshl1_add_u32 m0, s33, 115712
    s_nop 0
    buffer_load_dwordx4 v12, s[60:63], s83 offen lds
    s_lshl1_add_u32 m0, s33, 122880
    s_nop 0
    buffer_load_dwordx4 v11, s[64:67], s83 offen lds
    s_lshl1_add_u32 m0, s33, 123904
    s_nop 0
    buffer_load_dwordx4 v12, s[64:67], s83 offen lds
    s_add_u32 s83, s83, s45
    s_load_dword s94, s[12:13], s39 offset:0x80
    s_load_dword s94, s[12:13], s39 offset:0xc0
    s_load_dword s94, s[12:13], s39 offset:0x100
    s_load_dword s94, s[12:13], s39 offset:0x140
    s_load_dword s94, s[12:13], s39 offset:0x180
    s_lshl2_add_u32 s91, s30, s4
    s_lshl_b32 s91, s91, 9
    s_add_u32 s91, s91, 0x1e98000
    v_lshl_add_u32 v20, v1, 7, s91
    s_mov_b64 exec, 15
    global_load_dwordx2 v[22:23], v20, s[26:27] sc1
    s_mov_b64 exec, -1
    s_waitcnt vmcnt(17)
    s_barrier
    s_lshl2_add_u32 m0, s33, 32768
    s_nop 0
    buffer_load_dwordx4 v10, s[56:59], s82 offen offset:0 sc1 lds
    buffer_load_dwordx4 v10, s[56:59], s82 offen offset:1024 sc1 lds
    buffer_load_dwordx4 v10, s[56:59], s82 offen offset:2048 sc1 lds
    buffer_load_dwordx4 v10, s[56:59], s82 offen offset:3072 sc1 lds
    s_add_u32 s82, s82, s44
    s_lshl1_add_u32 m0, s33, 49152
    s_nop 0
    buffer_load_dwordx4 v11, s[60:63], s83 offen lds
    s_lshl1_add_u32 m0, s33, 50176
    s_nop 0
    buffer_load_dwordx4 v12, s[60:63], s83 offen lds
    s_lshl1_add_u32 m0, s33, 57344
    s_nop 0
    buffer_load_dwordx4 v11, s[64:67], s83 offen lds
    s_lshl1_add_u32 m0, s33, 58368
    s_nop 0
    buffer_load_dwordx4 v12, s[64:67], s83 offen lds
    s_add_u32 s83, s83, s45
    s_load_dword s94, s[12:13], s39 offset:0x1c0
    s_load_dword s94, s[12:13], s39 offset:0x80000
    s_load_dword s94, s[12:13], s39 offset:0x80040
    s_load_dword s94, s[12:13], s39 offset:0x80080
    s_load_dword s94, s[12:13], s39 offset:0x800c0
    s_waitcnt vmcnt(17)
    s_barrier
    s_lshl2_add_u32 m0, s33, 65536
    s_nop 0
    buffer_load_dwordx4 v10, s[56:59], s82 offen offset:0 sc1 lds
    buffer_load_dwordx4 v10, s[56:59], s82 offen offset:1024 sc1 lds
    buffer_load_dwordx4 v10, s[56:59], s82 offen offset:2048 sc1 lds
    buffer_load_dwordx4 v10, s[56:59], s82 offen offset:3072 sc1 lds
    s_add_u32 s82, s82, s44
    s_lshl1_add_u32 m0, s33, 81920
    s_nop 0
    buffer_load_dwordx4 v11, s[60:63], s83 offen lds
    s_lshl1_add_u32 m0, s33, 82944
    s_nop 0
    buffer_load_dwordx4 v12, s[60:63], s83 offen lds
    s_lshl1_add_u32 m0, s33, 90112
    s_nop 0
    buffer_load_dwordx4 v11, s[64:67], s83 offen lds
    s_lshl1_add_u32 m0, s33, 91136
    s_nop 0
    buffer_load_dwordx4 v12, s[64:67], s83 offen lds
    s_add_u32 s83, s83, s45
    s_load_dword s94, s[12:13], s39 offset:0x80100
    s_load_dword s94, s[12:13], s39 offset:0x80140
    s_load_dword s94, s[12:13], s39 offset:0x80180
L_pad11:
    s_cbranch_execz L_vret2
    s_load_dword s94, s[12:13], s39 offset:0x801c0
    s_waitcnt vmcnt(16)
    s_mov_b64 exec, 15
    s_movk_i32 s98, 0x4000
L_pO_chk:
    v_cmp_ne_u64 vcc, s[100:101], v[22:23]
    s_nop 1
    s_cmp_eq_u64 vcc, 0
    s_cbranch_scc1 L_pO_ok
    s_sub_u32 s98, s98, 1
    s_cbranch_scc1 L_pO_ok
    s_sleep 1
    global_load_dwordx2 v[22:23], v20, s[26:27] sc1
    s_waitcnt vmcnt(0)
    s_branch L_pO_chk
L_pO_ok:
    s_mov_b64 exec, -1
    s_waitcnt vmcnt(17)
    s_barrier
    s_lshl_b32 s85, s31, 8
    s_lshl_b32 s86, s32, 7
    s_add_u32 s86, s85, s86
    s_xor_b32 s87, s86, 128
    s_lshr_b32 s91, s31, 2
    s_lshl1_add_u32 s91, s91, s32
    s_lshl_b32 s91, s91, 13
    s_add_u32 s91, s91, 0x2800000
    s_xor_b32 s85, s91, 8192
    s_and_b32 s92, s31, 3
    s_lshl1_add_u32 s92, s92, s32
    s_cmp_eq_u32 s92, 3
    s_cselect_b32 s86, s91, s86
    s_cselect_b32 s87, s85, s87
    s_cselect_b32 s91, 0x2a00000, 0
    s_cselect_b32 s92, s26, s12
    s_cselect_b32 s93, s27, s13
    s_max_u32 s91, s91, 2097152
    s_add_u32 s60, s92, s86
    s_addc_u32 s61, s93, 0
    s_sub_u32 s62, s91, s86
    s_mov_b32 s63, 0x20000
    s_add_u32 s56, s26, 0x1200000
    s_addc_u32 s57, s27, 0
    s_mov_b32 s58, 0x400000
    s_mov_b32 s59, 0x20000
    s_lshl_b32 s82, s30, 18
    s_mov_b32 s83, 0
    s_lshl_b32 m0, s33, 2
    s_nop 0
    buffer_load_dwordx4 v10, s[56:59], s82 offen offset:0 sc1 lds
    buffer_load_dwordx4 v10, s[56:59], s82 offen offset:1024 sc1 lds
    buffer_load_dwordx4 v10, s[56:59], s82 offen offset:2048 sc1 lds
    buffer_load_dwordx4 v10, s[56:59], s82 offen offset:3072 sc1 lds
    s_add_u32 s82, s82, 16384
    s_lshl1_add_u32 m0, s33, 16384
    s_nop 0
    buffer_load_dwordx4 v4, s[60:63], s83 offen lds
    s_lshl1_add_u32 m0, s33, 17408
    s_nop 0
    buffer_load_dwordx4 v5, s[60:63], s83 offen lds
    s_add_u32 s83, s83, 131072
    s_waitcnt vmcnt(14)
    s_barrier
    s_lshl2_add_u32 m0, s33, 98304
    s_nop 0
    buffer_load_dwordx4 v10, s[56:59], s82 offen offset:0 sc1 lds
    buffer_load_dwordx4 v10, s[56:59], s82 offen offset:1024 sc1 lds
    buffer_load_dwordx4 v10, s[56:59], s82 offen offset:2048 sc1 lds
    buffer_load_dwordx4 v10, s[56:59], s82 offen offset:3072 sc1 lds
    s_add_u32 s82, s82, 16384
    s_lshl1_add_u32 m0, s33, 114688
    s_nop 0
    buffer_load_dwordx4 v4, s[60:63], s83 offen lds
    s_lshl1_add_u32 m0, s33, 115712
    s_nop 0
    buffer_load_dwordx4 v5, s[60:63], s83 offen lds
    s_add_u32 s83, s83, 131072
    s_lshl2_add_u32 m0, s33, 122880
    s_nop 0
    buffer_load_dwordx4 v10, s[56:59], s82 offen offset:0 sc1 lds
    buffer_load_dwordx4 v10, s[56:59], s82 offen offset:1024 sc1 lds
    buffer_load_dwordx4 v10, s[56:59], s82 offen offset:2048 sc1 lds
    buffer_load_dwordx4 v10, s[56:59], s82 offen offset:3072 sc1 lds
    s_add_u32 s82, s82, 16384
    s_lshl1_add_u32 m0, s33, 139264
    s_nop 0
    buffer_load_dwordx4 v4, s[60:63], s83 offen lds
    s_lshl1_add_u32 m0, s33, 140288
    s_nop 0
    buffer_load_dwordx4 v5, s[60:63], s83 offen lds
    s_add_u32 s83, s83, 131072
    s_waitcnt vmcnt(12)
    s_barrier
    s_lshl2_add_u32 m0, s33, 24576
    s_nop 0
    buffer_load_dwordx4 v10, s[56:59], s82 offen offset:0 sc1 lds
    buffer_load_dwordx4 v10, s[56:59], s82 offen offset:1024 sc1 lds
    buffer_load_dwordx4 v10, s[56:59], s82 offen offset:2048 sc1 lds
    buffer_load_dwordx4 v10, s[56:59], s82 offen offset:3072 sc1 lds
    s_add_u32 s82, s82, 16384
    s_lshl1_add_u32 m0, s33, 40960
    s_nop 0
    buffer_load_dwordx4 v4, s[60:63], s83 offen lds
    s_lshl1_add_u32 m0, s33, 41984
    s_nop 0
    buffer_load_dwordx4 v5, s[60:63], s83 offen lds
    s_add_u32 s83, s83, 131072
    s_waitcnt lgkmcnt(0)
    ds_read_b64_tr_b16 v[40:41], v80 offset:16384
    ds_read_b64_tr_b16 v[42:43], v80 offset:16896
    ds_read_b128 v[24:27], v48 offset:0
    ds_read_b128 v[28:31], v48 offset:1024
    ds_read_b128 v[32:35], v48 offset:2048
    ds_read_b128 v[36:39], v48 offset:3072
    ds_read_b64_tr_b16 v[44:45], v81 offset:16384
    ds_read_b64_tr_b16 v[46:47], v81 offset:16896
    s_barrier
    s_setprio 1
    s_waitcnt lgkmcnt(5)
    v_mfma_f32_16x16x32_bf16 v[88:91], v[40:43], v[24:27], v[88:91]
    ds_read_b64_tr_b16 v[72:73], v80 offset:20480
    ds_read_b64_tr_b16 v[74:75], v80 offset:20992
    s_lshl2_add_u32 m0, s33, 49152
    s_waitcnt lgkmcnt(6)
    v_mfma_f32_16x16x32_bf16 v[92:95], v[40:43], v[28:31], v[92:95]
    buffer_load_dwordx4 v10, s[56:59], s82 offen offset:0 sc1 lds
    ds_read_b128 v[56:59], v48 offset:8192
    ds_read_b128 v[60:63], v48 offset:9216
    s_waitcnt lgkmcnt(7)
    v_mfma_f32_16x16x32_bf16 v[96:99], v[40:43], v[32:35], v[96:99]
    ds_read_b128 v[64:67], v48 offset:10240
    ds_read_b128 v[68:71], v48 offset:11264
    s_waitcnt lgkmcnt(8)
    v_mfma_f32_16x16x32_bf16 v[100:103], v[40:43], v[36:39], v[100:103]
    ds_read_b64_tr_b16 v[76:77], v81 offset:20480
    ds_read_b64_tr_b16 v[78:79], v81 offset:20992
    s_waitcnt lgkmcnt(8)
    v_mfma_f32_16x16x32_bf16 v[104:107], v[44:47], v[24:27], v[104:107]
    buffer_load_dwordx4 v10, s[56:59], s82 offen offset:1024 sc1 lds
    v_mfma_f32_16x16x32_bf16 v[108:111], v[44:47], v[28:31], v[108:111]
    v_mfma_f32_16x16x32_bf16 v[112:115], v[44:47], v[32:35], v[112:115]
    v_mfma_f32_16x16x32_bf16 v[116:119], v[44:47], v[36:39], v[116:119]
    s_waitcnt vmcnt(14) lgkmcnt(0)
    s_barrier
    v_mfma_f32_16x16x32_bf16 v[88:91], v[72:75], v[56:59], v[88:91]
    ds_read_b64_tr_b16 v[40:41], v84 offset:16384
    ds_read_b64_tr_b16 v[42:43], v84 offset:16896
    v_mfma_f32_16x16x32_bf16 v[92:95], v[72:75], v[60:63], v[92:95]
    buffer_load_dwordx4 v10, s[56:59], s82 offen offset:2048 sc1 lds
    ds_read_b128 v[24:27], v50 offset:0
    ds_read_b128 v[28:31], v50 offset:1024
    v_mfma_f32_16x16x32_bf16 v[96:99], v[72:75], v[64:67], v[96:99]
    ds_read_b128 v[32:35], v50 offset:2048
    v_mfma_f32_16x16x32_bf16 v[100:103], v[72:75], v[68:71], v[100:103]
    ds_read_b128 v[36:39], v50 offset:3072
    ds_read_b64_tr_b16 v[44:45], v85 offset:16384
    v_mfma_f32_16x16x32_bf16 v[104:107], v[76:79], v[56:59], v[104:107]
    buffer_load_dwordx4 v10, s[56:59], s82 offen offset:3072 sc1 lds
    s_add_u32 s82, s82, 16384
    ds_read_b64_tr_b16 v[46:47], v85 offset:16896
    v_mfma_f32_16x16x32_bf16 v[108:111], v[76:79], v[60:63], v[108:111]
    v_mfma_f32_16x16x32_bf16 v[112:115], v[76:79], v[64:67], v[112:115]
    v_mfma_f32_16x16x32_bf16 v[116:119], v[76:79], v[68:71], v[116:119]
    s_waitcnt lgkmcnt(5)
    v_mfma_f32_16x16x32_bf16 v[88:91], v[40:43], v[24:27], v[88:91]
    ds_read_b64_tr_b16 v[72:73], v84 offset:20480
    ds_read_b64_tr_b16 v[74:75], v84 offset:20992
    s_lshl1_add_u32 m0, s33, 65536
    s_waitcnt lgkmcnt(6)
    v_mfma_f32_16x16x32_bf16 v[92:95], v[40:43], v[28:31], v[92:95]
    buffer_load_dwordx4 v4, s[60:63], s83 offen lds
    ds_read_b128 v[56:59], v50 offset:8192
    ds_read_b128 v[60:63], v50 offset:9216
    s_waitcnt lgkmcnt(7)
    v_mfma_f32_16x16x32_bf16 v[96:99], v[40:43], v[32:35], v[96:99]
    ds_read_b128 v[64:67], v50 offset:10240
    ds_read_b128 v[68:71], v50 offset:11264
    s_waitcnt lgkmcnt(8)
    v_mfma_f32_16x16x32_bf16 v[100:103], v[40:43], v[36:39], v[100:103]
    ds_read_b64_tr_b16 v[76:77], v85 offset:20480
    ds_read_b64_tr_b16 v[78:79], v85 offset:20992
    s_lshl1_add_u32 m0, s33, 66560
    s_waitcnt lgkmcnt(8)
    v_mfma_f32_16x16x32_bf16 v[104:107], v[44:47], v[24:27], v[104:107]
    buffer_load_dwordx4 v5, s[60:63], s83 offen lds
    s_add_u32 s83, s83, 131072
    v_mfma_f32_16x16x32_bf16 v[108:111], v[44:47], v[28:31], v[108:111]
    v_mfma_f32_16x16x32_bf16 v[112:115], v[44:47], v[32:35], v[112:115]
    v_mfma_f32_16x16x32_bf16 v[116:119], v[44:47], v[36:39], v[116:119]
    s_waitcnt vmcnt(12) lgkmcnt(0)
    s_barrier
    v_mfma_f32_16x16x32_bf16 v[88:91], v[72:75], v[56:59], v[88:91]
    ds_read_b64_tr_b16 v[40:41], v84 offset:40960
    ds_read_b64_tr_b16 v[42:43], v84 offset:41472
    s_lshl2_add_u32 m0, s33, 73728
    v_mfma_f32_16x16x32_bf16 v[92:95], v[72:75], v[60:63], v[92:95]
    buffer_load_dwordx4 v10, s[56:59], s82 offen offset:0 sc1 lds
    ds_read_b128 v[24:27], v50 offset:24576
    ds_read_b128 v[28:31], v50 offset:25600
    v_mfma_f32_16x16x32_bf16 v[96:99], v[72:75], v[64:67], v[96:99]
    ds_read_b128 v[32:35], v50 offset:26624
    v_mfma_f32_16x16x32_bf16 v[100:103], v[72:75], v[68:71], v[100:103]
    ds_read_b128 v[36:39], v50 offset:27648
    ds_read_b64_tr_b16 v[44:45], v85 offset:40960
    v_mfma_f32_16x16x32_bf16 v[104:107], v[76:79], v[56:59], v[104:107]
    buffer_load_dwordx4 v10, s[56:59], s82 offen offset:1024 sc1 lds
    ds_read_b64_tr_b16 v[46:47], v85 offset:41472
    v_mfma_f32_16x16x32_bf16 v[108:111], v[76:79], v[60:63], v[108:111]
    v_mfma_f32_16x16x32_bf16 v[112:115], v[76:79], v[64:67], v[112:115]
    v_mfma_f32_16x16x32_bf16 v[116:119], v[76:79], v[68:71], v[116:119]
    s_waitcnt lgkmcnt(5)
    v_mfma_f32_16x16x32_bf16 v[88:91], v[40:43], v[24:27], v[88:91]
    ds_read_b64_tr_b16 v[72:73], v84 offset:45056
    ds_read_b64_tr_b16 v[74:75], v84 offset:45568
    s_waitcnt lgkmcnt(6)
    v_mfma_f32_16x16x32_bf16 v[92:95], v[40:43], v[28:31], v[92:95]
    buffer_load_dwordx4 v10, s[56:59], s82 offen offset:2048 sc1 lds
    ds_read_b128 v[56:59], v50 offset:32768
    ds_read_b128 v[60:63], v50 offset:33792
    s_waitcnt lgkmcnt(7)
    v_mfma_f32_16x16x32_bf16 v[96:99], v[40:43], v[32:35], v[96:99]
    ds_read_b128 v[64:67], v50 offset:34816
    ds_read_b128 v[68:71], v50 offset:35840
    s_waitcnt lgkmcnt(8)
    v_mfma_f32_16x16x32_bf16 v[100:103], v[40:43], v[36:39], v[100:103]
    ds_read_b64_tr_b16 v[76:77], v85 offset:45056
    ds_read_b64_tr_b16 v[78:79], v85 offset:45568
    s_waitcnt lgkmcnt(8)
    v_mfma_f32_16x16x32_bf16 v[104:107], v[44:47], v[24:27], v[104:107]
    buffer_load_dwordx4 v10, s[56:59], s82 offen offset:3072 sc1 lds
    s_add_u32 s82, s82, 16384
    v_mfma_f32_16x16x32_bf16 v[108:111], v[44:47], v[28:31], v[108:111]
    v_mfma_f32_16x16x32_bf16 v[112:115], v[44:47], v[32:35], v[112:115]
    v_mfma_f32_16x16x32_bf16 v[116:119], v[44:47], v[36:39], v[116:119]
    s_waitcnt vmcnt(10) lgkmcnt(0)
    s_barrier
    v_mfma_f32_16x16x32_bf16 v[88:91], v[72:75], v[56:59], v[88:91]
    ds_read_b64_tr_b16 v[40:41], v80 offset:40960
    ds_read_b64_tr_b16 v[42:43], v80 offset:41472
    s_lshl1_add_u32 m0, s33, 90112
    v_mfma_f32_16x16x32_bf16 v[92:95], v[72:75], v[60:63], v[92:95]
    buffer_load_dwordx4 v4, s[60:63], s83 offen lds
    ds_read_b128 v[24:27], v48 offset:24576
    ds_read_b128 v[28:31], v48 offset:25600
    v_mfma_f32_16x16x32_bf16 v[96:99], v[72:75], v[64:67], v[96:99]
    ds_read_b128 v[32:35], v48 offset:26624
    v_mfma_f32_16x16x32_bf16 v[100:103], v[72:75], v[68:71], v[100:103]
    ds_read_b128 v[36:39], v48 offset:27648
    ds_read_b64_tr_b16 v[44:45], v81 offset:40960
    s_lshl1_add_u32 m0, s33, 91136
    v_mfma_f32_16x16x32_bf16 v[104:107], v[76:79], v[56:59], v[104:107]
    buffer_load_dwordx4 v5, s[60:63], s83 offen lds
    s_add_u32 s83, s83, 131072
    ds_read_b64_tr_b16 v[46:47], v81 offset:41472
    v_mfma_f32_16x16x32_bf16 v[108:111], v[76:79], v[60:63], v[108:111]
    v_mfma_f32_16x16x32_bf16 v[112:115], v[76:79], v[64:67], v[112:115]
    v_mfma_f32_16x16x32_bf16 v[116:119], v[76:79], v[68:71], v[116:119]
    s_waitcnt lgkmcnt(5)
    v_mfma_f32_16x16x32_bf16 v[88:91], v[40:43], v[24:27], v[88:91]
    ds_read_b64_tr_b16 v[72:73], v80 offset:45056
    ds_read_b64_tr_b16 v[74:75], v80 offset:45568
    s_lshl_b32 m0, s33, 2
    s_waitcnt lgkmcnt(6)
    v_mfma_f32_16x16x32_bf16 v[92:95], v[40:43], v[28:31], v[92:95]
    buffer_load_dwordx4 v10, s[56:59], s82 offen offset:0 sc1 lds
    ds_read_b128 v[56:59], v48 offset:32768
    ds_read_b128 v[60:63], v48 offset:33792
    s_waitcnt lgkmcnt(7)
    v_mfma_f32_16x16x32_bf16 v[96:99], v[40:43], v[32:35], v[96:99]
    ds_read_b128 v[64:67], v48 offset:34816
    ds_read_b128 v[68:71], v48 offset:35840
    s_waitcnt lgkmcnt(8)
    v_mfma_f32_16x16x32_bf16 v[100:103], v[40:43], v[36:39], v[100:103]
    buffer_load_dwordx4 v10, s[56:59], s82 offen offset:1024 sc1 lds
    ds_read_b64_tr_b16 v[76:77], v81 offset:45056
    ds_read_b64_tr_b16 v[78:79], v81 offset:45568
    s_waitcnt lgkmcnt(8)
    v_mfma_f32_16x16x32_bf16 v[104:107], v[44:47], v[24:27], v[104:107]
    v_mfma_f32_16x16x32_bf16 v[108:111], v[44:47], v[28:31], v[108:111]
    buffer_load_dwordx4 v10, s[56:59], s82 offen offset:2048 sc1 lds
    v_mfma_f32_16x16x32_bf16 v[112:115], v[44:47], v[32:35], v[112:115]
    v_mfma_f32_16x16x32_bf16 v[116:119], v[44:47], v[36:39], v[116:119]
    s_waitcnt vmcnt(9) lgkmcnt(0)
    s_barrier
    v_mfma_f32_16x16x32_bf16 v[88:91], v[72:75], v[56:59], v[88:91]
    ds_read_b64_tr_b16 v[40:41], v82 offset:16384
    ds_read_b64_tr_b16 v[42:43], v82 offset:16896
    v_mfma_f32_16x16x32_bf16 v[92:95], v[72:75], v[60:63], v[92:95]
    buffer_load_dwordx4 v10, s[56:59], s82 offen offset:3072 sc1 lds
    s_add_u32 s82, s82, 16384
    ds_read_b128 v[24:27], v49 offset:0
    ds_read_b128 v[28:31], v49 offset:1024
    v_mfma_f32_16x16x32_bf16 v[96:99], v[72:75], v[64:67], v[96:99]
    ds_read_b128 v[32:35], v49 offset:2048
    s_lshl1_add_u32 m0, s33, 16384
    v_mfma_f32_16x16x32_bf16 v[100:103], v[72:75], v[68:71], v[100:103]
    buffer_load_dwordx4 v4, s[60:63], s83 offen lds
    ds_read_b128 v[36:39], v49 offset:3072
    ds_read_b64_tr_b16 v[44:45], v83 offset:16384
    v_mfma_f32_16x16x32_bf16 v[104:107], v[76:79], v[56:59], v[104:107]
    ds_read_b64_tr_b16 v[46:47], v83 offset:16896
    s_lshl1_add_u32 m0, s33, 17408
    v_mfma_f32_16x16x32_bf16 v[108:111], v[76:79], v[60:63], v[108:111]
    buffer_load_dwordx4 v5, s[60:63], s83 offen lds
    s_add_u32 s83, s83, 131072
    v_mfma_f32_16x16x32_bf16 v[112:115], v[76:79], v[64:67], v[112:115]
    v_mfma_f32_16x16x32_bf16 v[116:119], v[76:79], v[68:71], v[116:119]
    s_waitcnt lgkmcnt(5)
    v_mfma_f32_16x16x32_bf16 v[88:91], v[40:43], v[24:27], v[88:91]
    ds_read_b64_tr_b16 v[72:73], v82 offset:20480
    ds_read_b64_tr_b16 v[74:75], v82 offset:20992
    s_lshl2_add_u32 m0, s33, 98304
    s_waitcnt lgkmcnt(6)
    v_mfma_f32_16x16x32_bf16 v[92:95], v[40:43], v[28:31], v[92:95]
    buffer_load_dwordx4 v10, s[56:59], s82 offen offset:0 sc1 lds
    ds_read_b128 v[56:59], v49 offset:8192
    ds_read_b128 v[60:63], v49 offset:9216
    s_waitcnt lgkmcnt(7)
    v_mfma_f32_16x16x32_bf16 v[96:99], v[40:43], v[32:35], v[96:99]
    ds_read_b128 v[64:67], v49 offset:10240
    ds_read_b128 v[68:71], v49 offset:11264
    s_waitcnt lgkmcnt(8)
    v_mfma_f32_16x16x32_bf16 v[100:103], v[40:43], v[36:39], v[100:103]
    buffer_load_dwordx4 v10, s[56:59], s82 offen offset:1024 sc1 lds
    ds_read_b64_tr_b16 v[76:77], v83 offset:20480
    ds_read_b64_tr_b16 v[78:79], v83 offset:20992
    s_waitcnt lgkmcnt(8)
    v_mfma_f32_16x16x32_bf16 v[104:107], v[44:47], v[24:27], v[104:107]
    v_mfma_f32_16x16x32_bf16 v[108:111], v[44:47], v[28:31], v[108:111]
    buffer_load_dwordx4 v10, s[56:59], s82 offen offset:2048 sc1 lds
    v_mfma_f32_16x16x32_bf16 v[112:115], v[44:47], v[32:35], v[112:115]
    v_mfma_f32_16x16x32_bf16 v[116:119], v[44:47], v[36:39], v[116:119]
    s_waitcnt vmcnt(9) lgkmcnt(0)
    s_barrier
    v_mfma_f32_16x16x32_bf16 v[88:91], v[72:75], v[56:59], v[88:91]
    ds_read_b64_tr_b16 v[40:41], v82 offset:40960
    ds_read_b64_tr_b16 v[42:43], v82 offset:41472
    v_mfma_f32_16x16x32_bf16 v[92:95], v[72:75], v[60:63], v[92:95]
    buffer_load_dwordx4 v10, s[56:59], s82 offen offset:3072 sc1 lds
    s_add_u32 s82, s82, 16384
    ds_read_b128 v[24:27], v49 offset:24576
    ds_read_b128 v[28:31], v49 offset:25600
    v_mfma_f32_16x16x32_bf16 v[96:99], v[72:75], v[64:67], v[96:99]
    ds_read_b128 v[32:35], v49 offset:26624
    s_lshl1_add_u32 m0, s33, 114688
    v_mfma_f32_16x16x32_bf16 v[100:103], v[72:75], v[68:71], v[100:103]
    buffer_load_dwordx4 v4, s[60:63], s83 offen lds
    ds_read_b128 v[36:39], v49 offset:27648
    ds_read_b64_tr_b16 v[44:45], v83 offset:40960
    v_mfma_f32_16x16x32_bf16 v[104:107], v[76:79], v[56:59], v[104:107]
    ds_read_b64_tr_b16 v[46:47], v83 offset:41472
    s_lshl1_add_u32 m0, s33, 115712
    v_mfma_f32_16x16x32_bf16 v[108:111], v[76:79], v[60:63], v[108:111]
    buffer_load_dwordx4 v5, s[60:63], s83 offen lds
    s_add_u32 s83, s83, 131072
    v_mfma_f32_16x16x32_bf16 v[112:115], v[76:79], v[64:67], v[112:115]
    v_mfma_f32_16x16x32_bf16 v[116:119], v[76:79], v[68:71], v[116:119]
    s_waitcnt lgkmcnt(5)
    v_mfma_f32_16x16x32_bf16 v[88:91], v[40:43], v[24:27], v[88:91]
    ds_read_b64_tr_b16 v[72:73], v82 offset:45056
    ds_read_b64_tr_b16 v[74:75], v82 offset:45568
    s_lshl2_add_u32 m0, s33, 122880
    s_waitcnt lgkmcnt(6)
    v_mfma_f32_16x16x32_bf16 v[92:95], v[40:43], v[28:31], v[92:95]
    buffer_load_dwordx4 v10, s[56:59], s82 offen offset:0 sc1 lds
    ds_read_b128 v[56:59], v49 offset:32768
    ds_read_b128 v[60:63], v49 offset:33792
    s_waitcnt lgkmcnt(7)
    v_mfma_f32_16x16x32_bf16 v[96:99], v[40:43], v[32:35], v[96:99]
    ds_read_b128 v[64:67], v49 offset:34816
    ds_read_b128 v[68:71], v49 offset:35840
    s_waitcnt lgkmcnt(8)
    v_mfma_f32_16x16x32_bf16 v[100:103], v[40:43], v[36:39], v[100:103]
    buffer_load_dwordx4 v10, s[56:59], s82 offen offset:1024 sc1 lds
    ds_read_b64_tr_b16 v[76:77], v83 offset:45056
    ds_read_b64_tr_b16 v[78:79], v83 offset:45568
    s_waitcnt lgkmcnt(8)
    v_mfma_f32_16x16x32_bf16 v[104:107], v[44:47], v[24:27], v[104:107]
    v_mfma_f32_16x16x32_bf16 v[108:111], v[44:47], v[28:31], v[108:111]
    buffer_load_dwordx4 v10, s[56:59], s82 offen offset:2048 sc1 lds
    v_mfma_f32_16x16x32_bf16 v[112:115], v[44:47], v[32:35], v[112:115]
    v_mfma_f32_16x16x32_bf16 v[116:119], v[44:47], v[36:39], v[116:119]
    s_waitcnt vmcnt(9) lgkmcnt(0)
    s_barrier
    v_mfma_f32_16x16x32_bf16 v[88:91], v[72:75], v[56:59], v[88:91]
    ds_read_b64_tr_b16 v[40:41], v80 offset:16384
    ds_read_b64_tr_b16 v[42:43], v80 offset:16896
    v_mfma_f32_16x16x32_bf16 v[92:95], v[72:75], v[60:63], v[92:95]
    buffer_load_dwordx4 v10, s[56:59], s82 offen offset:3072 sc1 lds
    s_add_u32 s82, s82, 16384
    ds_read_b128 v[24:27], v48 offset:0
    ds_read_b128 v[28:31], v48 offset:1024
    v_mfma_f32_16x16x32_bf16 v[96:99], v[72:75], v[64:67], v[96:99]
    ds_read_b128 v[32:35], v48 offset:2048
    s_lshl1_add_u32 m0, s33, 139264
    v_mfma_f32_16x16x32_bf16 v[100:103], v[72:75], v[68:71], v[100:103]
    buffer_load_dwordx4 v4, s[60:63], s83 offen lds
    ds_read_b128 v[36:39], v48 offset:3072
    ds_read_b64_tr_b16 v[44:45], v81 offset:16384
    v_mfma_f32_16x16x32_bf16 v[104:107], v[76:79], v[56:59], v[104:107]
    ds_read_b64_tr_b16 v[46:47], v81 offset:16896
    s_lshl1_add_u32 m0, s33, 140288
    v_mfma_f32_16x16x32_bf16 v[108:111], v[76:79], v[60:63], v[108:111]
    buffer_load_dwordx4 v5, s[60:63], s83 offen lds
    s_add_u32 s83, s83, 131072
    v_mfma_f32_16x16x32_bf16 v[112:115], v[76:79], v[64:67], v[112:115]
    v_mfma_f32_16x16x32_bf16 v[116:119], v[76:79], v[68:71], v[116:119]
    s_waitcnt lgkmcnt(5)
    v_mfma_f32_16x16x32_bf16 v[88:91], v[40:43], v[24:27], v[88:91]
    ds_read_b64_tr_b16 v[72:73], v80 offset:20480
    ds_read_b64_tr_b16 v[74:75], v80 offset:20992
    s_lshl2_add_u32 m0, s33, 24576
    s_waitcnt lgkmcnt(6)
    v_mfma_f32_16x16x32_bf16 v[92:95], v[40:43], v[28:31], v[92:95]
    buffer_load_dwordx4 v10, s[56:59], s82 offen offset:0 sc1 lds
    ds_read_b128 v[56:59], v48 offset:8192
    ds_read_b128 v[60:63], v48 offset:9216
    s_waitcnt lgkmcnt(7)
    v_mfma_f32_16x16x32_bf16 v[96:99], v[40:43], v[32:35], v[96:99]
    ds_read_b128 v[64:67], v48 offset:10240
    ds_read_b128 v[68:71], v48 offset:11264
    s_waitcnt lgkmcnt(8)
    v_mfma_f32_16x16x32_bf16 v[100:103], v[40:43], v[36:39], v[100:103]
    buffer_load_dwordx4 v10, s[56:59], s82 offen offset:1024 sc1 lds
    ds_read_b64_tr_b16 v[76:77], v81 offset:20480
    ds_read_b64_tr_b16 v[78:79], v81 offset:20992
    s_waitcnt lgkmcnt(8)
    v_mfma_f32_16x16x32_bf16 v[104:107], v[44:47], v[24:27], v[104:107]
    v_mfma_f32_16x16x32_bf16 v[108:111], v[44:47], v[28:31], v[108:111]
    buffer_load_dwordx4 v10, s[56:59], s82 offen offset:2048 sc1 lds
    v_mfma_f32_16x16x32_bf16 v[112:115], v[44:47], v[32:35], v[112:115]
    v_mfma_f32_16x16x32_bf16 v[116:119], v[44:47], v[36:39], v[116:119]
    s_waitcnt vmcnt(9) lgkmcnt(0)
    s_barrier
    v_mfma_f32_16x16x32_bf16 v[88:91], v[72:75], v[56:59], v[88:91]
    ds_read_b64_tr_b16 v[40:41], v84 offset:16384
    ds_read_b64_tr_b16 v[42:43], v84 offset:16896
    v_mfma_f32_16x16x32_bf16 v[92:95], v[72:75], v[60:63], v[92:95]
    buffer_load_dwordx4 v10, s[56:59], s82 offen offset:3072 sc1 lds
    s_add_u32 s82, s82, 16384
    ds_read_b128 v[24:27], v50 offset:0
    ds_read_b128 v[28:31], v50 offset:1024
    v_mfma_f32_16x16x32_bf16 v[96:99], v[72:75], v[64:67], v[96:99]
    ds_read_b128 v[32:35], v50 offset:2048
    s_lshl1_add_u32 m0, s33, 40960
    v_mfma_f32_16x16x32_bf16 v[100:103], v[72:75], v[68:71], v[100:103]
    buffer_load_dwordx4 v4, s[60:63], s83 offen lds
    ds_read_b128 v[36:39], v50 offset:3072
    ds_read_b64_tr_b16 v[44:45], v85 offset:16384
    v_mfma_f32_16x16x32_bf16 v[104:107], v[76:79], v[56:59], v[104:107]
    ds_read_b64_tr_b16 v[46:47], v85 offset:16896
    s_lshl1_add_u32 m0, s33, 41984
    v_mfma_f32_16x16x32_bf16 v[108:111], v[76:79], v[60:63], v[108:111]
    buffer_load_dwordx4 v5, s[60:63], s83 offen lds
    s_add_u32 s83, s83, 131072
    v_mfma_f32_16x16x32_bf16 v[112:115], v[76:79], v[64:67], v[112:115]
    v_mfma_f32_16x16x32_bf16 v[116:119], v[76:79], v[68:71], v[116:119]
    s_waitcnt lgkmcnt(5)
    v_mfma_f32_16x16x32_bf16 v[88:91], v[40:43], v[24:27], v[88:91]
    ds_read_b64_tr_b16 v[72:73], v84 offset:20480
    ds_read_b64_tr_b16 v[74:75], v84 offset:20992
    s_lshl2_add_u32 m0, s33, 49152
    s_waitcnt lgkmcnt(6)
    v_mfma_f32_16x16x32_bf16 v[92:95], v[40:43], v[28:31], v[92:95]
    buffer_load_dwordx4 v10, s[56:59], s82 offen offset:0 sc1 lds
    ds_read_b128 v[56:59], v50 offset:8192
    ds_read_b128 v[60:63], v50 offset:9216
    s_waitcnt lgkmcnt(7)
    v_mfma_f32_16x16x32_bf16 v[96:99], v[40:43], v[32:35], v[96:99]
    ds_read_b128 v[64:67], v50 offset:10240
    ds_read_b128 v[68:71], v50 offset:11264
    s_waitcnt lgkmcnt(8)
    v_mfma_f32_16x16x32_bf16 v[100:103], v[40:43], v[36:39], v[100:103]
    buffer_load_dwordx4 v10, s[56:59], s82 offen offset:1024 sc1 lds
    ds_read_b64_tr_b16 v[76:77], v85 offset:20480
    ds_read_b64_tr_b16 v[78:79], v85 offset:20992
    s_waitcnt lgkmcnt(8)
    v_mfma_f32_16x16x32_bf16 v[104:107], v[44:47], v[24:27], v[104:107]
    v_mfma_f32_16x16x32_bf16 v[108:111], v[44:47], v[28:31], v[108:111]
    buffer_load_dwordx4 v10, s[56:59], s82 offen offset:2048 sc1 lds
    v_mfma_f32_16x16x32_bf16 v[112:115], v[44:47], v[32:35], v[112:115]
    v_mfma_f32_16x16x32_bf16 v[116:119], v[44:47], v[36:39], v[116:119]
    s_waitcnt vmcnt(9) lgkmcnt(0)
    s_barrier
    v_mfma_f32_16x16x32_bf16 v[88:91], v[72:75], v[56:59], v[88:91]
    ds_read_b64_tr_b16 v[40:41], v84 offset:40960
    ds_read_b64_tr_b16 v[42:43], v84 offset:41472
    v_mfma_f32_16x16x32_bf16 v[92:95], v[72:75], v[60:63], v[92:95]
    buffer_load_dwordx4 v10, s[56:59], s82 offen offset:3072 sc1 lds
    s_add_u32 s82, s82, 16384
    ds_read_b128 v[24:27], v50 offset:24576
    ds_read_b128 v[28:31], v50 offset:25600
    v_mfma_f32_16x16x32_bf16 v[96:99], v[72:75], v[64:67], v[96:99]
    ds_read_b128 v[32:35], v50 offset:26624
    s_lshl1_add_u32 m0, s33, 65536
    v_mfma_f32_16x16x32_bf16 v[100:103], v[72:75], v[68:71], v[100:103]
    buffer_load_dwordx4 v4, s[60:63], s83 offen lds
    ds_read_b128 v[36:39], v50 offset:27648
    ds_read_b64_tr_b16 v[44:45], v85 offset:40960
    v_mfma_f32_16x16x32_bf16 v[104:107], v[76:79], v[56:59], v[104:107]
    ds_read_b64_tr_b16 v[46:47], v85 offset:41472
    s_lshl1_add_u32 m0, s33, 66560
    v_mfma_f32_16x16x32_bf16 v[108:111], v[76:79], v[60:63], v[108:111]
    buffer_load_dwordx4 v5, s[60:63], s83 offen lds
    s_add_u32 s83, s83, 131072
    v_mfma_f32_16x16x32_bf16 v[112:115], v[76:79], v[64:67], v[112:115]
    v_mfma_f32_16x16x32_bf16 v[116:119], v[76:79], v[68:71], v[116:119]
    s_waitcnt lgkmcnt(5)
    v_mfma_f32_16x16x32_bf16 v[88:91], v[40:43], v[24:27], v[88:91]
    ds_read_b64_tr_b16 v[72:73], v84 offset:45056
    ds_read_b64_tr_b16 v[74:75], v84 offset:45568
    s_lshl2_add_u32 m0, s33, 73728
    s_waitcnt lgkmcnt(6)
    v_mfma_f32_16x16x32_bf16 v[92:95], v[40:43], v[28:31], v[92:95]
    buffer_load_dwordx4 v10, s[56:59], s82 offen offset:0 sc1 lds
    ds_read_b128 v[56:59], v50 offset:32768
    ds_read_b128 v[60:63], v50 offset:33792
    s_waitcnt lgkmcnt(7)
    v_mfma_f32_16x16x32_bf16 v[96:99], v[40:43], v[32:35], v[96:99]
    ds_read_b128 v[64:67], v50 offset:34816
    ds_read_b128 v[68:71], v50 offset:35840
    s_waitcnt lgkmcnt(8)
    v_mfma_f32_16x16x32_bf16 v[100:103], v[40:43], v[36:39], v[100:103]
    buffer_load_dwordx4 v10, s[56:59], s82 offen offset:1024 sc1 lds
    ds_read_b64_tr_b16 v[76:77], v85 offset:45056
    ds_read_b64_tr_b16 v[78:79], v85 offset:45568
    s_waitcnt lgkmcnt(8)
    v_mfma_f32_16x16x32_bf16 v[104:107], v[44:47], v[24:27], v[104:107]
    v_mfma_f32_16x16x32_bf16 v[108:111], v[44:47], v[28:31], v[108:111]
    buffer_load_dwordx4 v10, s[56:59], s82 offen offset:2048 sc1 lds
    v_mfma_f32_16x16x32_bf16 v[112:115], v[44:47], v[32:35], v[112:115]
    v_mfma_f32_16x16x32_bf16 v[116:119], v[44:47], v[36:39], v[116:119]
    s_waitcnt vmcnt(9) lgkmcnt(0)
    s_barrier
    v_mfma_f32_16x16x32_bf16 v[88:91], v[72:75], v[56:59], v[88:91]
    ds_read_b64_tr_b16 v[40:41], v80 offset:40960
    ds_read_b64_tr_b16 v[42:43], v80 offset:41472
    v_mfma_f32_16x16x32_bf16 v[92:95], v[72:75], v[60:63], v[92:95]
    buffer_load_dwordx4 v10, s[56:59], s82 offen offset:3072 sc1 lds
    s_add_u32 s82, s82, 16384
    ds_read_b128 v[24:27], v48 offset:24576
    ds_read_b128 v[28:31], v48 offset:25600
    v_mfma_f32_16x16x32_bf16 v[96:99], v[72:75], v[64:67], v[96:99]
    ds_read_b128 v[32:35], v48 offset:26624
    s_lshl1_add_u32 m0, s33, 90112
    v_mfma_f32_16x16x32_bf16 v[100:103], v[72:75], v[68:71], v[100:103]
    buffer_load_dwordx4 v4, s[60:63], s83 offen lds
    ds_read_b128 v[36:39], v48 offset:27648
    ds_read_b64_tr_b16 v[44:45], v81 offset:40960
    v_mfma_f32_16x16x32_bf16 v[104:107], v[76:79], v[56:59], v[104:107]
    ds_read_b64_tr_b16 v[46:47], v81 offset:41472
    s_lshl1_add_u32 m0, s33, 91136
    v_mfma_f32_16x16x32_bf16 v[108:111], v[76:79], v[60:63], v[108:111]
    buffer_load_dwordx4 v5, s[60:63], s83 offen lds
    s_add_u32 s83, s83, 131072
    v_mfma_f32_16x16x32_bf16 v[112:115], v[76:79], v[64:67], v[112:115]
    v_mfma_f32_16x16x32_bf16 v[116:119], v[76:79], v[68:71], v[116:119]
    s_waitcnt lgkmcnt(5)
    v_mfma_f32_16x16x32_bf16 v[88:91], v[40:43], v[24:27], v[88:91]
    ds_read_b64_tr_b16 v[72:73], v80 offset:45056
    ds_read_b64_tr_b16 v[74:75], v80 offset:45568
    s_lshl_b32 m0, s33, 2
    s_waitcnt lgkmcnt(6)
    v_mfma_f32_16x16x32_bf16 v[92:95], v[40:43], v[28:31], v[92:95]
    buffer_load_dwordx4 v10, s[56:59], s82 offen offset:0 sc1 lds
    ds_read_b128 v[56:59], v48 offset:32768
    ds_read_b128 v[60:63], v48 offset:33792
    s_waitcnt lgkmcnt(7)
    v_mfma_f32_16x16x32_bf16 v[96:99], v[40:43], v[32:35], v[96:99]
    ds_read_b128 v[64:67], v48 offset:34816
    ds_read_b128 v[68:71], v48 offset:35840
    s_waitcnt lgkmcnt(8)
    v_mfma_f32_16x16x32_bf16 v[100:103], v[40:43], v[36:39], v[100:103]
    buffer_load_dwordx4 v10, s[56:59], s82 offen offset:1024 sc1 lds
    ds_read_b64_tr_b16 v[76:77], v81 offset:45056
L_pad12:
    s_cbranch_execz L_vret3
    ds_read_b64_tr_b16 v[78:79], v81 offset:45568
    s_waitcnt lgkmcnt(8)
    v_mfma_f32_16x16x32_bf16 v[104:107], v[44:47], v[24:27], v[104:107]
    v_mfma_f32_16x16x32_bf16 v[108:111], v[44:47], v[28:31], v[108:111]
    buffer_load_dwordx4 v10, s[56:59], s82 offen offset:2048 sc1 lds
    v_mfma_f32_16x16x32_bf16 v[112:115], v[44:47], v[32:35], v[112:115]
    v_mfma_f32_16x16x32_bf16 v[116:119], v[44:47], v[36:39], v[116:119]
    s_waitcnt vmcnt(9) lgkmcnt(0)
    s_barrier
    v_mfma_f32_16x16x32_bf16 v[88:91], v[72:75], v[56:59], v[88:91]
    ds_read_b64_tr_b16 v[40:41], v82 offset:16384
    ds_read_b64_tr_b16 v[42:43], v82 offset:16896
    v_mfma_f32_16x16x32_bf16 v[92:95], v[72:75], v[60:63], v[92:95]
    buffer_load_dwordx4 v10, s[56:59], s82 offen offset:3072 sc1 lds
    s_add_u32 s82, s82, 16384
    ds_read_b128 v[24:27], v49 offset:0
    ds_read_b128 v[28:31], v49 offset:1024
    v_mfma_f32_16x16x32_bf16 v[96:99], v[72:75], v[64:67], v[96:99]
    ds_read_b128 v[32:35], v49 offset:2048
    s_lshl1_add_u32 m0, s33, 16384
    v_mfma_f32_16x16x32_bf16 v[100:103], v[72:75], v[68:71], v[100:103]
    buffer_load_dwordx4 v4, s[60:63], s83 offen lds
    ds_read_b128 v[36:39], v49 offset:3072
    ds_read_b64_tr_b16 v[44:45], v83 offset:16384
    v_mfma_f32_16x16x32_bf16 v[104:107], v[76:79], v[56:59], v[104:107]
    ds_read_b64_tr_b16 v[46:47], v83 offset:16896
    s_lshl1_add_u32 m0, s33, 17408
    v_mfma_f32_16x16x32_bf16 v[108:111], v[76:79], v[60:63], v[108:111]
    buffer_load_dwordx4 v5, s[60:63], s83 offen lds
    s_add_u32 s83, s83, 131072
    v_mfma_f32_16x16x32_bf16 v[112:115], v[76:79], v[64:67], v[112:115]
    v_mfma_f32_16x16x32_bf16 v[116:119], v[76:79], v[68:71], v[116:119]
    s_waitcnt lgkmcnt(5)
    v_mfma_f32_16x16x32_bf16 v[88:91], v[40:43], v[24:27], v[88:91]
    ds_read_b64_tr_b16 v[72:73], v82 offset:20480
    ds_read_b64_tr_b16 v[74:75], v82 offset:20992
    s_lshl2_add_u32 m0, s33, 98304
    s_waitcnt lgkmcnt(6)
    v_mfma_f32_16x16x32_bf16 v[92:95], v[40:43], v[28:31], v[92:95]
    buffer_load_dwordx4 v10, s[56:59], s82 offen offset:0 sc1 lds
    ds_read_b128 v[56:59], v49 offset:8192
    ds_read_b128 v[60:63], v49 offset:9216
    s_waitcnt lgkmcnt(7)
    v_mfma_f32_16x16x32_bf16 v[96:99], v[40:43], v[32:35], v[96:99]
    ds_read_b128 v[64:67], v49 offset:10240
    ds_read_b128 v[68:71], v49 offset:11264
    s_waitcnt lgkmcnt(8)
    v_mfma_f32_16x16x32_bf16 v[100:103], v[40:43], v[36:39], v[100:103]
    buffer_load_dwordx4 v10, s[56:59], s82 offen offset:1024 sc1 lds
    ds_read_b64_tr_b16 v[76:77], v83 offset:20480
    ds_read_b64_tr_b16 v[78:79], v83 offset:20992
    s_waitcnt lgkmcnt(8)
    v_mfma_f32_16x16x32_bf16 v[104:107], v[44:47], v[24:27], v[104:107]
    v_mfma_f32_16x16x32_bf16 v[108:111], v[44:47], v[28:31], v[108:111]
    buffer_load_dwordx4 v10, s[56:59], s82 offen offset:2048 sc1 lds
    v_mfma_f32_16x16x32_bf16 v[112:115], v[44:47], v[32:35], v[112:115]
    v_mfma_f32_16x16x32_bf16 v[116:119], v[44:47], v[36:39], v[116:119]
    s_waitcnt vmcnt(9) lgkmcnt(0)
    s_barrier
    v_mfma_f32_16x16x32_bf16 v[88:91], v[72:75], v[56:59], v[88:91]
    ds_read_b64_tr_b16 v[40:41], v82 offset:40960
    ds_read_b64_tr_b16 v[42:43], v82 offset:41472
    v_mfma_f32_16x16x32_bf16 v[92:95], v[72:75], v[60:63], v[92:95]
    buffer_load_dwordx4 v10, s[56:59], s82 offen offset:3072 sc1 lds
    s_add_u32 s82, s82, 16384
    ds_read_b128 v[24:27], v49 offset:24576
    ds_read_b128 v[28:31], v49 offset:25600
    v_mfma_f32_16x16x32_bf16 v[96:99], v[72:75], v[64:67], v[96:99]
    ds_read_b128 v[32:35], v49 offset:26624
    s_lshl1_add_u32 m0, s33, 114688
    v_mfma_f32_16x16x32_bf16 v[100:103], v[72:75], v[68:71], v[100:103]
    buffer_load_dwordx4 v4, s[60:63], s83 offen lds
    ds_read_b128 v[36:39], v49 offset:27648
    ds_read_b64_tr_b16 v[44:45], v83 offset:40960
    v_mfma_f32_16x16x32_bf16 v[104:107], v[76:79], v[56:59], v[104:107]
    ds_read_b64_tr_b16 v[46:47], v83 offset:41472
    s_lshl1_add_u32 m0, s33, 115712
    v_mfma_f32_16x16x32_bf16 v[108:111], v[76:79], v[60:63], v[108:111]
    buffer_load_dwordx4 v5, s[60:63], s83 offen lds
    s_add_u32 s83, s83, 131072
    v_mfma_f32_16x16x32_bf16 v[112:115], v[76:79], v[64:67], v[112:115]
    v_mfma_f32_16x16x32_bf16 v[116:119], v[76:79], v[68:71], v[116:119]
    s_waitcnt lgkmcnt(5)
    v_mfma_f32_16x16x32_bf16 v[88:91], v[40:43], v[24:27], v[88:91]
    ds_read_b64_tr_b16 v[72:73], v82 offset:45056
    ds_read_b64_tr_b16 v[74:75], v82 offset:45568
    s_lshl2_add_u32 m0, s33, 122880
    s_waitcnt lgkmcnt(6)
    v_mfma_f32_16x16x32_bf16 v[92:95], v[40:43], v[28:31], v[92:95]
    buffer_load_dwordx4 v10, s[56:59], s82 offen offset:0 sc1 lds
    ds_read_b128 v[56:59], v49 offset:32768
    ds_read_b128 v[60:63], v49 offset:33792
    s_waitcnt lgkmcnt(7)
    v_mfma_f32_16x16x32_bf16 v[96:99], v[40:43], v[32:35], v[96:99]
    ds_read_b128 v[64:67], v49 offset:34816
    ds_read_b128 v[68:71], v49 offset:35840
    s_waitcnt lgkmcnt(8)
    v_mfma_f32_16x16x32_bf16 v[100:103], v[40:43], v[36:39], v[100:103]
    buffer_load_dwordx4 v10, s[56:59], s82 offen offset:1024 sc1 lds
    ds_read_b64_tr_b16 v[76:77], v83 offset:45056
    ds_read_b64_tr_b16 v[78:79], v83 offset:45568
    s_waitcnt lgkmcnt(8)
    v_mfma_f32_16x16x32_bf16 v[104:107], v[44:47], v[24:27], v[104:107]
    v_mfma_f32_16x16x32_bf16 v[108:111], v[44:47], v[28:31], v[108:111]
    buffer_load_dwordx4 v10, s[56:59], s82 offen offset:2048 sc1 lds
    v_mfma_f32_16x16x32_bf16 v[112:115], v[44:47], v[32:35], v[112:115]
    v_mfma_f32_16x16x32_bf16 v[116:119], v[44:47], v[36:39], v[116:119]
    s_waitcnt vmcnt(9) lgkmcnt(0)
    s_barrier
    v_mfma_f32_16x16x32_bf16 v[88:91], v[72:75], v[56:59], v[88:91]
    ds_read_b64_tr_b16 v[40:41], v80 offset:16384
    ds_read_b64_tr_b16 v[42:43], v80 offset:16896
    v_mfma_f32_16x16x32_bf16 v[92:95], v[72:75], v[60:63], v[92:95]
    buffer_load_dwordx4 v10, s[56:59], s82 offen offset:3072 sc1 lds
    s_add_u32 s82, s82, 16384
    ds_read_b128 v[24:27], v48 offset:0
    ds_read_b128 v[28:31], v48 offset:1024
    v_mfma_f32_16x16x32_bf16 v[96:99], v[72:75], v[64:67], v[96:99]
    ds_read_b128 v[32:35], v48 offset:2048
    s_lshl1_add_u32 m0, s33, 139264
    v_mfma_f32_16x16x32_bf16 v[100:103], v[72:75], v[68:71], v[100:103]
    buffer_load_dwordx4 v4, s[60:63], s83 offen lds
    ds_read_b128 v[36:39], v48 offset:3072
    ds_read_b64_tr_b16 v[44:45], v81 offset:16384
    v_mfma_f32_16x16x32_bf16 v[104:107], v[76:79], v[56:59], v[104:107]
    ds_read_b64_tr_b16 v[46:47], v81 offset:16896
    s_lshl1_add_u32 m0, s33, 140288
    v_mfma_f32_16x16x32_bf16 v[108:111], v[76:79], v[60:63], v[108:111]
    buffer_load_dwordx4 v5, s[60:63], s83 offen lds
    s_add_u32 s83, s83, 131072
    v_mfma_f32_16x16x32_bf16 v[112:115], v[76:79], v[64:67], v[112:115]
    v_mfma_f32_16x16x32_bf16 v[116:119], v[76:79], v[68:71], v[116:119]
    s_waitcnt lgkmcnt(5)
    v_mfma_f32_16x16x32_bf16 v[88:91], v[40:43], v[24:27], v[88:91]
    ds_read_b64_tr_b16 v[72:73], v80 offset:20480
    ds_read_b64_tr_b16 v[74:75], v80 offset:20992
    s_lshl2_add_u32 m0, s33, 24576
    s_waitcnt lgkmcnt(6)
    v_mfma_f32_16x16x32_bf16 v[92:95], v[40:43], v[28:31], v[92:95]
    buffer_load_dwordx4 v10, s[56:59], s82 offen offset:0 sc1 lds
    ds_read_b128 v[56:59], v48 offset:8192
    ds_read_b128 v[60:63], v48 offset:9216
    s_waitcnt lgkmcnt(7)
    v_mfma_f32_16x16x32_bf16 v[96:99], v[40:43], v[32:35], v[96:99]
    ds_read_b128 v[64:67], v48 offset:10240
    ds_read_b128 v[68:71], v48 offset:11264
    s_waitcnt lgkmcnt(8)
    v_mfma_f32_16x16x32_bf16 v[100:103], v[40:43], v[36:39], v[100:103]
    buffer_load_dwordx4 v10, s[56:59], s82 offen offset:1024 sc1 lds
    ds_read_b64_tr_b16 v[76:77], v81 offset:20480
    ds_read_b64_tr_b16 v[78:79], v81 offset:20992
    s_waitcnt lgkmcnt(8)
    v_mfma_f32_16x16x32_bf16 v[104:107], v[44:47], v[24:27], v[104:107]
    v_mfma_f32_16x16x32_bf16 v[108:111], v[44:47], v[28:31], v[108:111]
    buffer_load_dwordx4 v10, s[56:59], s82 offen offset:2048 sc1 lds
    v_mfma_f32_16x16x32_bf16 v[112:115], v[44:47], v[32:35], v[112:115]
    v_mfma_f32_16x16x32_bf16 v[116:119], v[44:47], v[36:39], v[116:119]
    s_waitcnt vmcnt(9) lgkmcnt(0)
    s_barrier
    v_mfma_f32_16x16x32_bf16 v[88:91], v[72:75], v[56:59], v[88:91]
    ds_read_b64_tr_b16 v[40:41], v84 offset:16384
    ds_read_b64_tr_b16 v[42:43], v84 offset:16896
    v_mfma_f32_16x16x32_bf16 v[92:95], v[72:75], v[60:63], v[92:95]
    buffer_load_dwordx4 v10, s[56:59], s82 offen offset:3072 sc1 lds
    s_add_u32 s82, s82, 16384
    ds_read_b128 v[24:27], v50 offset:0
    ds_read_b128 v[28:31], v50 offset:1024
    v_mfma_f32_16x16x32_bf16 v[96:99], v[72:75], v[64:67], v[96:99]
    ds_read_b128 v[32:35], v50 offset:2048
    s_lshl1_add_u32 m0, s33, 40960
    v_mfma_f32_16x16x32_bf16 v[100:103], v[72:75], v[68:71], v[100:103]
    buffer_load_dwordx4 v4, s[60:63], s83 offen lds
    ds_read_b128 v[36:39], v50 offset:3072
    ds_read_b64_tr_b16 v[44:45], v85 offset:16384
    v_mfma_f32_16x16x32_bf16 v[104:107], v[76:79], v[56:59], v[104:107]
    ds_read_b64_tr_b16 v[46:47], v85 offset:16896
    s_lshl1_add_u32 m0, s33, 41984
    v_mfma_f32_16x16x32_bf16 v[108:111], v[76:79], v[60:63], v[108:111]
    buffer_load_dwordx4 v5, s[60:63], s83 offen lds
    s_add_u32 s83, s83, 131072
    v_mfma_f32_16x16x32_bf16 v[112:115], v[76:79], v[64:67], v[112:115]
    v_mfma_f32_16x16x32_bf16 v[116:119], v[76:79], v[68:71], v[116:119]
    s_waitcnt lgkmcnt(5)
    v_mfma_f32_16x16x32_bf16 v[88:91], v[40:43], v[24:27], v[88:91]
    ds_read_b64_tr_b16 v[72:73], v84 offset:20480
    ds_read_b64_tr_b16 v[74:75], v84 offset:20992
    s_waitcnt lgkmcnt(6)
    v_mfma_f32_16x16x32_bf16 v[92:95], v[40:43], v[28:31], v[92:95]
    ds_read_b128 v[56:59], v50 offset:8192
    ds_read_b128 v[60:63], v50 offset:9216
    s_waitcnt lgkmcnt(7)
    v_mfma_f32_16x16x32_bf16 v[96:99], v[40:43], v[32:35], v[96:99]
    ds_read_b128 v[64:67], v50 offset:10240
    ds_read_b128 v[68:71], v50 offset:11264
    s_waitcnt lgkmcnt(8)
    v_mfma_f32_16x16x32_bf16 v[100:103], v[40:43], v[36:39], v[100:103]
    ds_read_b64_tr_b16 v[76:77], v85 offset:20480
    ds_read_b64_tr_b16 v[78:79], v85 offset:20992
    s_mov_b32 s84, 0
    s_waitcnt lgkmcnt(8)
    v_mfma_f32_16x16x32_bf16 v[104:107], v[44:47], v[24:27], v[104:107]
    buffer_load_dwordx4 v[120:123], v13, s[72:75], s84 offen
    v_mfma_f32_16x16x32_bf16 v[108:111], v[44:47], v[28:31], v[108:111]
    v_mfma_f32_16x16x32_bf16 v[112:115], v[44:47], v[32:35], v[112:115]
    s_mov_b32 s84, 32768
    v_mfma_f32_16x16x32_bf16 v[116:119], v[44:47], v[36:39], v[116:119]
    buffer_load_dwordx4 v[124:127], v13, s[72:75], s84 offen
    s_waitcnt vmcnt(8) lgkmcnt(0)
    s_barrier
    v_mfma_f32_16x16x32_bf16 v[88:91], v[72:75], v[56:59], v[88:91]
    ds_read_b64_tr_b16 v[40:41], v84 offset:40960
    ds_read_b64_tr_b16 v[42:43], v84 offset:41472
    v_mfma_f32_16x16x32_bf16 v[92:95], v[72:75], v[60:63], v[92:95]
    ds_read_b128 v[24:27], v50 offset:24576
    ds_read_b128 v[28:31], v50 offset:25600
    v_mfma_f32_16x16x32_bf16 v[96:99], v[72:75], v[64:67], v[96:99]
    ds_read_b128 v[32:35], v50 offset:26624
    v_mfma_f32_16x16x32_bf16 v[100:103], v[72:75], v[68:71], v[100:103]
    ds_read_b128 v[36:39], v50 offset:27648
    ds_read_b64_tr_b16 v[44:45], v85 offset:40960
    s_mov_b32 s84, 65536
    v_mfma_f32_16x16x32_bf16 v[104:107], v[76:79], v[56:59], v[104:107]
    ds_read_b64_tr_b16 v[46:47], v85 offset:41472
    buffer_load_dwordx4 v[128:131], v13, s[72:75], s84 offen
    v_mfma_f32_16x16x32_bf16 v[108:111], v[76:79], v[60:63], v[108:111]
    v_mfma_f32_16x16x32_bf16 v[112:115], v[76:79], v[64:67], v[112:115]
    s_mov_b32 s84, 98304
    v_mfma_f32_16x16x32_bf16 v[116:119], v[76:79], v[68:71], v[116:119]
    buffer_load_dwordx4 v[132:135], v13, s[72:75], s84 offen
    s_waitcnt lgkmcnt(5)
    v_mfma_f32_16x16x32_bf16 v[88:91], v[40:43], v[24:27], v[88:91]
    ds_read_b64_tr_b16 v[72:73], v84 offset:45056
    ds_read_b64_tr_b16 v[74:75], v84 offset:45568
    s_waitcnt lgkmcnt(6)
    v_mfma_f32_16x16x32_bf16 v[92:95], v[40:43], v[28:31], v[92:95]
    ds_read_b128 v[56:59], v50 offset:32768
    ds_read_b128 v[60:63], v50 offset:33792
    s_waitcnt lgkmcnt(7)
    v_mfma_f32_16x16x32_bf16 v[96:99], v[40:43], v[32:35], v[96:99]
    ds_read_b128 v[64:67], v50 offset:34816
    ds_read_b128 v[68:71], v50 offset:35840
    s_waitcnt lgkmcnt(8)
    v_mfma_f32_16x16x32_bf16 v[100:103], v[40:43], v[36:39], v[100:103]
    ds_read_b64_tr_b16 v[76:77], v85 offset:45056
    ds_read_b64_tr_b16 v[78:79], v85 offset:45568
    s_waitcnt lgkmcnt(8)
    v_mfma_f32_16x16x32_bf16 v[104:107], v[44:47], v[24:27], v[104:107]
    v_mfma_f32_16x16x32_bf16 v[108:111], v[44:47], v[28:31], v[108:111]
    v_mfma_f32_16x16x32_bf16 v[112:115], v[44:47], v[32:35], v[112:115]
    v_mfma_f32_16x16x32_bf16 v[116:119], v[44:47], v[36:39], v[116:119]
    s_waitcnt vmcnt(4) lgkmcnt(0)
    s_barrier
    v_mfma_f32_16x16x32_bf16 v[88:91], v[72:75], v[56:59], v[88:91]
    ds_read_b64_tr_b16 v[40:41], v80 offset:40960
    ds_read_b64_tr_b16 v[42:43], v80 offset:41472
    v_mfma_f32_16x16x32_bf16 v[92:95], v[72:75], v[60:63], v[92:95]
    ds_read_b128 v[24:27], v48 offset:24576
    ds_read_b128 v[28:31], v48 offset:25600
    v_mfma_f32_16x16x32_bf16 v[96:99], v[72:75], v[64:67], v[96:99]
    ds_read_b128 v[32:35], v48 offset:26624
    v_mfma_f32_16x16x32_bf16 v[100:103], v[72:75], v[68:71], v[100:103]
    ds_read_b128 v[36:39], v48 offset:27648
    ds_read_b64_tr_b16 v[44:45], v81 offset:40960
    v_mfma_f32_16x16x32_bf16 v[104:107], v[76:79], v[56:59], v[104:107]
    ds_read_b64_tr_b16 v[46:47], v81 offset:41472
    v_mfma_f32_16x16x32_bf16 v[108:111], v[76:79], v[60:63], v[108:111]
    ds_read_b64 v[168:169], v3 offset:0
    ds_read_b64 v[170:171], v3 offset:512
    ds_read_b64 v[172:173], v3 offset:1024
    v_mfma_f32_16x16x32_bf16 v[112:115], v[76:79], v[64:67], v[112:115]
    ds_read_b64 v[174:175], v3 offset:1536
    ds_read_b64 v[176:177], v3 offset:2048
    ds_read_b64 v[178:179], v3 offset:2560
    v_mfma_f32_16x16x32_bf16 v[116:119], v[76:79], v[68:71], v[116:119]
    ds_read_b64 v[180:181], v3 offset:3072
    ds_read_b64 v[182:183], v3 offset:3584
    s_waitcnt lgkmcnt(13)
    v_mfma_f32_16x16x32_bf16 v[88:91], v[40:43], v[24:27], v[88:91]
    ds_read_b64_tr_b16 v[72:73], v80 offset:45056
    ds_read_b64_tr_b16 v[74:75], v80 offset:45568
    s_waitcnt lgkmcnt(14)
    v_mfma_f32_16x16x32_bf16 v[92:95], v[40:43], v[28:31], v[92:95]
    ds_read_b128 v[56:59], v48 offset:32768
    ds_read_b128 v[60:63], v48 offset:33792
    s_waitcnt lgkmcnt(15)
    v_mfma_f32_16x16x32_bf16 v[96:99], v[40:43], v[32:35], v[96:99]
    ds_read_b128 v[64:67], v48 offset:34816
    ds_read_b128 v[68:71], v48 offset:35840
    s_waitcnt lgkmcnt(15)
    v_mfma_f32_16x16x32_bf16 v[100:103], v[40:43], v[36:39], v[100:103]
    ds_read_b64_tr_b16 v[76:77], v81 offset:45056
    ds_read_b64_tr_b16 v[78:79], v81 offset:45568
    s_waitcnt lgkmcnt(15)
    v_mfma_f32_16x16x32_bf16 v[104:107], v[44:47], v[24:27], v[104:107]
    v_lshlrev_b32 v184, 16, v168
    v_and_b32 v185, 0xffff0000, v168
    v_mfma_f32_16x16x32_bf16 v[108:111], v[44:47], v[28:31], v[108:111]
    v_lshlrev_b32 v186, 16, v169
    v_and_b32 v187, 0xffff0000, v169
    v_mfma_f32_16x16x32_bf16 v[112:115], v[44:47], v[32:35], v[112:115]
    s_waitcnt lgkmcnt(14)
    v_lshlrev_b32 v188, 16, v170
    v_and_b32 v189, 0xffff0000, v170
    v_mfma_f32_16x16x32_bf16 v[116:119], v[44:47], v[36:39], v[116:119]
    v_lshlrev_b32 v190, 16, v171
    v_and_b32 v191, 0xffff0000, v171
    s_waitcnt lgkmcnt(5)
    v_mfma_f32_16x16x32_bf16 v[88:91], v[72:75], v[56:59], v[88:91]
    v_lshlrev_b32 v192, 16, v172
    v_and_b32 v193, 0xffff0000, v172
    s_waitcnt lgkmcnt(4)
    v_mfma_f32_16x16x32_bf16 v[92:95], v[72:75], v[60:63], v[92:95]
    v_lshlrev_b32 v194, 16, v173
    v_and_b32 v195, 0xffff0000, v173
    s_waitcnt lgkmcnt(3)
    v_mfma_f32_16x16x32_bf16 v[96:99], v[72:75], v[64:67], v[96:99]
    v_lshlrev_b32 v196, 16, v174
    v_and_b32 v197, 0xffff0000, v174
    s_waitcnt lgkmcnt(2)
    v_mfma_f32_16x16x32_bf16 v[100:103], v[72:75], v[68:71], v[100:103]
    v_lshlrev_b32 v198, 16, v175
    v_and_b32 v199, 0xffff0000, v175
    s_waitcnt lgkmcnt(0)
    v_mfma_f32_16x16x32_bf16 v[104:107], v[76:79], v[56:59], v[104:107]
    s_mov_b32 s72, s22
    v_lshlrev_b32 v200, 16, v176
    v_and_b32 v201, 0xffff0000, v176
    v_mfma_f32_16x16x32_bf16 v[108:111], v[76:79], v[60:63], v[108:111]
    s_mov_b32 s73, s23
    v_lshlrev_b32 v202, 16, v177
    v_and_b32 v203, 0xffff0000, v177
    v_mfma_f32_16x16x32_bf16 v[112:115], v[76:79], v[64:67], v[112:115]
    s_mov_b32 s74, 0x400000
    v_lshlrev_b32 v204, 16, v178
    v_and_b32 v205, 0xffff0000, v178
    v_mfma_f32_16x16x32_bf16 v[116:119], v[76:79], v[68:71], v[116:119]
    s_mov_b32 s75, 0x20000
    v_lshlrev_b32 v206, 16, v179
    v_and_b32 v207, 0xffff0000, v179
    v_lshlrev_b32 v208, 16, v180
    v_and_b32 v209, 0xffff0000, v180
    v_lshlrev_b32 v210, 16, v181
    v_and_b32 v211, 0xffff0000, v181
    v_lshlrev_b32 v212, 16, v182
    v_and_b32 v213, 0xffff0000, v182
    v_lshlrev_b32 v214, 16, v183
    v_and_b32 v215, 0xffff0000, v183
    v_cvt_pk_bf16_f32 v40, v88, v89
    v_cvt_pk_bf16_f32 v41, v90, v91
    v_lshlrev_b32 v88, 16, v40
    v_and_b32 v89, 0xffff0000, v40
    v_lshlrev_b32 v90, 16, v41
    v_and_b32 v91, 0xffff0000, v41
    v_cvt_pk_bf16_f32 v42, v104, v105
    v_cvt_pk_bf16_f32 v43, v106, v107
    v_lshlrev_b32 v104, 16, v42
    v_and_b32 v105, 0xffff0000, v42
    v_lshlrev_b32 v106, 16, v43
    v_and_b32 v107, 0xffff0000, v43
    v_pk_mul_f32 v[88:89], v[88:89], v[184:185]
    v_pk_mul_f32 v[90:91], v[90:91], v[186:187]
    v_pk_mul_f32 v[104:105], v[104:105], v[200:201]
    v_pk_mul_f32 v[106:107], v[106:107], v[202:203]
    v_cvt_pk_bf16_f32 v88, v88, v89
    v_cvt_pk_bf16_f32 v89, v90, v91
    ds_write_b64 v14, v[88:89] offset:0
    v_cvt_pk_bf16_f32 v104, v104, v105
    v_cvt_pk_bf16_f32 v105, v106, v107
    ds_write_b64 v15, v[104:105] offset:0
    ds_read_b128 v[48:51], v17 offset:0
    v_cvt_pk_bf16_f32 v40, v92, v93
    v_cvt_pk_bf16_f32 v41, v94, v95
    v_lshlrev_b32 v92, 16, v40
    v_and_b32 v93, 0xffff0000, v40
    v_lshlrev_b32 v94, 16, v41
    v_and_b32 v95, 0xffff0000, v41
    v_cvt_pk_bf16_f32 v42, v108, v109
    v_cvt_pk_bf16_f32 v43, v110, v111
    v_lshlrev_b32 v108, 16, v42
    v_and_b32 v109, 0xffff0000, v42
    v_lshlrev_b32 v110, 16, v43
    v_and_b32 v111, 0xffff0000, v43
    v_pk_mul_f32 v[92:93], v[92:93], v[188:189]
    v_pk_mul_f32 v[94:95], v[94:95], v[190:191]
    v_pk_mul_f32 v[108:109], v[108:109], v[204:205]
    v_pk_mul_f32 v[110:111], v[110:111], v[206:207]
    v_cvt_pk_bf16_f32 v92, v92, v93
    v_cvt_pk_bf16_f32 v93, v94, v95
    ds_write_b64 v14, v[92:93] offset:1024
    v_cvt_pk_bf16_f32 v108, v108, v109
    v_cvt_pk_bf16_f32 v109, v110, v111
    ds_write_b64 v15, v[108:109] offset:1024
    ds_read_b128 v[52:55], v17 offset:1024
    s_waitcnt vmcnt(0)
    v_lshlrev_b32 v136, 16, v120
    v_and_b32 v137, 0xffff0000, v120
    v_lshlrev_b32 v138, 16, v121
    v_and_b32 v139, 0xffff0000, v121
    v_lshlrev_b32 v140, 16, v122
    v_and_b32 v141, 0xffff0000, v122
    v_lshlrev_b32 v142, 16, v123
    v_and_b32 v143, 0xffff0000, v123
    s_waitcnt lgkmcnt(3)
    v_lshlrev_b32 v24, 16, v48
    v_and_b32 v25, 0xffff0000, v48
    v_lshlrev_b32 v26, 16, v49
    v_and_b32 v27, 0xffff0000, v49
    v_lshlrev_b32 v28, 16, v50
    v_and_b32 v29, 0xffff0000, v50
    v_lshlrev_b32 v30, 16, v51
    v_and_b32 v31, 0xffff0000, v51
    v_pk_add_f32 v[24:25], v[24:25], v[136:137]
    v_pk_add_f32 v[26:27], v[26:27], v[138:139]
    v_pk_add_f32 v[28:29], v[28:29], v[140:141]
    v_pk_add_f32 v[30:31], v[30:31], v[142:143]
    v_cvt_pk_bf16_f32 v48, v24, v25
    v_cvt_pk_bf16_f32 v49, v26, v27
    v_cvt_pk_bf16_f32 v50, v28, v29
    v_cvt_pk_bf16_f32 v51, v30, v31
    s_mov_b32 s84, 0
    buffer_store_dwordx4 v[48:51], v13, s[72:75], s84 offen
    v_cvt_pk_bf16_f32 v40, v96, v97
    v_cvt_pk_bf16_f32 v41, v98, v99
    v_lshlrev_b32 v96, 16, v40
    v_and_b32 v97, 0xffff0000, v40
    v_lshlrev_b32 v98, 16, v41
    v_and_b32 v99, 0xffff0000, v41
    v_cvt_pk_bf16_f32 v42, v112, v113
    v_cvt_pk_bf16_f32 v43, v114, v115
    v_lshlrev_b32 v112, 16, v42
    v_and_b32 v113, 0xffff0000, v42
    v_lshlrev_b32 v114, 16, v43
    v_and_b32 v115, 0xffff0000, v43
    v_pk_mul_f32 v[96:97], v[96:97], v[192:193]
    v_pk_mul_f32 v[98:99], v[98:99], v[194:195]
    v_pk_mul_f32 v[112:113], v[112:113], v[208:209]
    v_pk_mul_f32 v[114:115], v[114:115], v[210:211]
    v_cvt_pk_bf16_f32 v96, v96, v97
    v_cvt_pk_bf16_f32 v97, v98, v99
    ds_write_b64 v14, v[96:97] offset:2048
    v_cvt_pk_bf16_f32 v112, v112, v113
    v_cvt_pk_bf16_f32 v113, v114, v115
    ds_write_b64 v15, v[112:113] offset:2048
    ds_read_b128 v[56:59], v17 offset:2048
    v_lshlrev_b32 v144, 16, v124
    v_and_b32 v145, 0xffff0000, v124
    v_lshlrev_b32 v146, 16, v125
    v_and_b32 v147, 0xffff0000, v125
    v_lshlrev_b32 v148, 16, v126
    v_and_b32 v149, 0xffff0000, v126
    v_lshlrev_b32 v150, 16, v127
    v_and_b32 v151, 0xffff0000, v127
    s_waitcnt lgkmcnt(3)
    v_lshlrev_b32 v24, 16, v52
    v_and_b32 v25, 0xffff0000, v52
    v_lshlrev_b32 v26, 16, v53
    v_and_b32 v27, 0xffff0000, v53
    v_lshlrev_b32 v28, 16, v54
    v_and_b32 v29, 0xffff0000, v54
    v_lshlrev_b32 v30, 16, v55
    v_and_b32 v31, 0xffff0000, v55
    v_pk_add_f32 v[24:25], v[24:25], v[144:145]
    v_pk_add_f32 v[26:27], v[26:27], v[146:147]
    v_pk_add_f32 v[28:29], v[28:29], v[148:149]
    v_pk_add_f32 v[30:31], v[30:31], v[150:151]
    v_cvt_pk_bf16_f32 v52, v24, v25
    v_cvt_pk_bf16_f32 v53, v26, v27
    v_cvt_pk_bf16_f32 v54, v28, v29
    v_cvt_pk_bf16_f32 v55, v30, v31
    s_mov_b32 s84, 32768
    buffer_store_dwordx4 v[52:55], v13, s[72:75], s84 offen
    v_cvt_pk_bf16_f32 v40, v100, v101
    v_cvt_pk_bf16_f32 v41, v102, v103
    v_lshlrev_b32 v100, 16, v40
    v_and_b32 v101, 0xffff0000, v40
    v_lshlrev_b32 v102, 16, v41
    v_and_b32 v103, 0xffff0000, v41
    v_cvt_pk_bf16_f32 v42, v116, v117
    v_cvt_pk_bf16_f32 v43, v118, v119
    v_lshlrev_b32 v116, 16, v42
    v_and_b32 v117, 0xffff0000, v42
    v_lshlrev_b32 v118, 16, v43
    v_and_b32 v119, 0xffff0000, v43
    v_pk_mul_f32 v[100:101], v[100:101], v[196:197]
    v_pk_mul_f32 v[102:103], v[102:103], v[198:199]
    v_pk_mul_f32 v[116:117], v[116:117], v[212:213]
    v_pk_mul_f32 v[118:119], v[118:119], v[214:215]
    v_cvt_pk_bf16_f32 v100, v100, v101
    v_cvt_pk_bf16_f32 v101, v102, v103
    ds_write_b64 v14, v[100:101] offset:3072
    v_cvt_pk_bf16_f32 v116, v116, v117
    v_cvt_pk_bf16_f32 v117, v118, v119
    ds_write_b64 v15, v[116:117] offset:3072
    ds_read_b128 v[60:63], v17 offset:3072
    v_lshlrev_b32 v152, 16, v128
    v_and_b32 v153, 0xffff0000, v128
    v_lshlrev_b32 v154, 16, v129
    v_and_b32 v155, 0xffff0000, v129
    v_lshlrev_b32 v156, 16, v130
    v_and_b32 v157, 0xffff0000, v130
    v_lshlrev_b32 v158, 16, v131
    v_and_b32 v159, 0xffff0000, v131
    s_waitcnt lgkmcnt(3)
    v_lshlrev_b32 v24, 16, v56
    v_and_b32 v25, 0xffff0000, v56
    v_lshlrev_b32 v26, 16, v57
    v_and_b32 v27, 0xffff0000, v57
    v_lshlrev_b32 v28, 16, v58
    v_and_b32 v29, 0xffff0000, v58
    v_lshlrev_b32 v30, 16, v59
    v_and_b32 v31, 0xffff0000, v59
    v_pk_add_f32 v[24:25], v[24:25], v[152:153]
    v_pk_add_f32 v[26:27], v[26:27], v[154:155]
    v_pk_add_f32 v[28:29], v[28:29], v[156:157]
    v_pk_add_f32 v[30:31], v[30:31], v[158:159]
    v_cvt_pk_bf16_f32 v56, v24, v25
    v_cvt_pk_bf16_f32 v57, v26, v27
    v_cvt_pk_bf16_f32 v58, v28, v29
    v_cvt_pk_bf16_f32 v59, v30, v31
    s_mov_b32 s84, 65536
    buffer_store_dwordx4 v[56:59], v13, s[72:75], s84 offen
    v_lshlrev_b32 v160, 16, v132
    v_and_b32 v161, 0xffff0000, v132
    v_lshlrev_b32 v162, 16, v133
    v_and_b32 v163, 0xffff0000, v133
    v_lshlrev_b32 v164, 16, v134
    v_and_b32 v165, 0xffff0000, v134
    v_lshlrev_b32 v166, 16, v135
    v_and_b32 v167, 0xffff0000, v135
    s_waitcnt lgkmcnt(0)
    v_lshlrev_b32 v24, 16, v60
    v_and_b32 v25, 0xffff0000, v60
    v_lshlrev_b32 v26, 16, v61
    v_and_b32 v27, 0xffff0000, v61
    v_lshlrev_b32 v28, 16, v62
    v_and_b32 v29, 0xffff0000, v62
    v_lshlrev_b32 v30, 16, v63
    v_and_b32 v31, 0xffff0000, v63
    v_pk_add_f32 v[24:25], v[24:25], v[160:161]
    v_pk_add_f32 v[26:27], v[26:27], v[162:163]
    v_pk_add_f32 v[28:29], v[28:29], v[164:165]
    v_pk_add_f32 v[30:31], v[30:31], v[166:167]
    v_cvt_pk_bf16_f32 v60, v24, v25
    v_cvt_pk_bf16_f32 v61, v26, v27
    v_cvt_pk_bf16_f32 v62, v28, v29
    v_cvt_pk_bf16_f32 v63, v30, v31
    s_mov_b32 s84, 98304
    buffer_store_dwordx4 v[60:63], v13, s[72:75], s84 offen
L_fin:
L_end:
    s_endpgm
L_code_end:
.section .rodata,"a"
.p2align 6
.amdhsa_kernel recurrent_scan__sliding_local_dilated__glu_gated_geglu__prompt_kernel
  .amdhsa_next_free_vgpr 256
  .amdhsa_next_free_sgpr 102
  .amdhsa_accum_offset 256
  .amdhsa_group_segment_fixed_size 0
  .amdhsa_kernarg_size 80
  .amdhsa_user_sgpr_count 2
  .amdhsa_user_sgpr_kernarg_segment_ptr 1
  .amdhsa_system_sgpr_workgroup_id_x 1
.end_amdhsa_kernel
```
